```python
import torch

def _softmax(x, axis=-1):
    return torch.softmax(x, dim=axis)
def _gelu(x):
    return torch.nn.functional.gelu(x, approximate="tanh")
def _silu(x):
    return torch.nn.functional.silu(x)
def _sigmoid(x):
    return torch.sigmoid(x)
def _layernorm(x, axis=-1, eps=1e-5):
    m = x.mean(dim=axis, keepdim=True)
    v = x.var(dim=axis, keepdim=True, unbiased=False)
    return (x - m) / torch.sqrt(v + eps)
def _scatter_add(tgt, idx, src, axis=0):
    return tgt.clone().index_add_(axis, idx, src)
def _segment_sum(src, seg, n):
    out = torch.zeros((n,) + src.shape[1:], dtype=src.dtype)
    return out.index_add_(0, seg, src)
def _pad(x, pw):
    flat = tuple(v for pair in reversed(pw) for v in pair)
    return torch.nn.functional.pad(x, flat)

kernel_name = 'recurrent_scan__mha_block_cached__mixer_token_mlp__prompt'

def setup_inputs():

    _w = (lambda a: (lambda t: t.to(torch.bfloat16) if t.is_floating_point() else t)(torch.as_tensor(a)))
    def _A_setup():
        B, Sq, D = 1, 2048, 1024
        H, Sk, Dh = 32, 2048, 128
        return {
            "x": _w((lambda *s: torch.randn(*s, dtype=torch.bfloat16) * 0.05)(B, Sq, D)),
            "k_cache": _w((lambda *s: torch.randn(*s, dtype=torch.bfloat16) * 3.2)(B, H, Sk, Dh)),
            "v_cache": _w((lambda *s: torch.randn(*s, dtype=torch.bfloat16) * 3.2)(B, H, Sk, Dh)),
            "wq": _w((lambda *s: torch.randn(*s, dtype=torch.bfloat16) * 3.2)(D, H * Dh) * (D ** -0.5)),
            "wo": _w((lambda *s: torch.randn(*s, dtype=torch.bfloat16) * 3.2)(H * Dh, D) * ((H * Dh) ** -0.5)),
        }
    _A_in = _A_setup()

    def _B_setup():
        B, S, D, F = 1, 2048, 1024, 3584
        return {
            "x": _w((lambda *s: torch.randn(*s, dtype=torch.bfloat16) * 0.05)(B, S, D)),
            "w1": _w((lambda *s: torch.randn(*s, dtype=torch.bfloat16) * 3.2)(S, F) * (S ** -0.5)),
            "b1": _w((lambda *s: torch.randn(*s, dtype=torch.bfloat16) * 3.2)(F) * 0.02),
            "w2": _w((lambda *s: torch.randn(*s, dtype=torch.bfloat16) * 0.4)(F, S) * (F ** -0.5)),
            "b2": _w((lambda *s: torch.randn(*s, dtype=torch.bfloat16) * 0.4)(S) * 0.02),
        }
    _B_in = _B_setup()

    return {
        "A_x": _A_in["x"],
        "A_k_cache": _A_in["k_cache"],
        "A_v_cache": _A_in["v_cache"],
        "A_wq": _A_in["wq"],
        "A_wo": _A_in["wo"],
        "B_x": _B_in["x"],
        "B_w1": _B_in["w1"],
        "B_b1": _B_in["b1"],
        "B_w2": _B_in["w2"],
        "B_b2": _B_in["b2"],
    }

def reference(A_x, A_k_cache, A_v_cache, A_wq, A_wo, B_x, B_w1, B_b1, B_w2, B_b2):
    def _A_ref(x, k_cache, v_cache, wq, wo):
        B, Sq, D = x.shape
        H, Dh = 32, 128
        q = (lambda x, *d: x.permute(*d))((x @ wq).reshape(B, Sq, H, Dh), 0, 2, 1, 3)
        scores = torch.einsum("bhqd,bhkd->bhqk", q, k_cache) * (Dh ** -0.5)
        p = _softmax(scores, axis=-1)
        o = torch.einsum("bhqk,bhkd->bhqd", p, v_cache)
        return (lambda x, *d: x.permute(*d))(o, 0, 2, 1, 3).reshape(B, Sq, H * Dh) @ wo

    def _B_ref(x, w1, b1, w2, b2):
        B, S, D = x.shape
        h = _layernorm(x, axis=-1)
        u = torch.einsum("bsd,sf->bdf", h, w1) + b1
        u = _gelu(u)
        y = torch.einsum("bdf,fs->bds", u, w2) + b2
        return (lambda x, *d: x.permute(*d))(y, 0, 2, 1)

    x = A_x
    xn = _layernorm(x, axis=-1)
    s = _A_ref(xn, A_k_cache, A_v_cache, A_wq, A_wo)
    g = _silu(_B_ref(xn, B_w1, B_b1, B_w2, B_b2))
    return x + s * g
```

```asm
; @launch grid=(256,1,1) block=(256,1,1) lds=163840
.amdgcn_target "amdgcn-amd-amdhsa--gfx950"
.text
.globl recurrent_scan__mha_block_cached__mixer_token_mlp__prompt_kernel
.p2align 8
.type recurrent_scan__mha_block_cached__mixer_token_mlp__prompt_kernel,@function
recurrent_scan__mha_block_cached__mixer_token_mlp__prompt_kernel:
 s_cmp_ge_u32 s2,256
 s_cbranch_scc1 L_end
 s_mov_b32 s45,0
L_restart:
 s_load_dwordx2 s[52:53],s[0:1],0
 s_load_dwordx2 s[28:29],s[0:1],24
 s_load_dwordx2 s[30:31],s[0:1],96
 s_load_dwordx4 s[24:27],s[0:1],8
 s_load_dwordx4 s[32:35],s[0:1],48
 s_load_dwordx2 s[36:37],s[0:1],32
 s_load_dwordx2 s[38:39],s[0:1],64
 s_load_dwordx2 s[54:55],s[0:1],72
 s_load_dwordx2 s[56:57],s[0:1],80
 s_load_dwordx2 s[50:51],s[0:1],88
 v_lshlrev_b32 v61,5,v0
 s_getpc_b64 s[60:61]
L_pc_a:
 s_add_u32 s60,s60,L_early_code-L_pc_a
 s_addc_u32 s61,s61,0
 s_mov_b32 s62,L_attn_last-L_early_code
 s_mov_b32 s63,0x20000
 s_bfe_u32 s77,s2,0x20003
 s_add_u32 s77,s77,1
 s_lshl_b32 s77,s77,13
 buffer_load_dword v59,v61,s[60:63],0 offen
 buffer_load_dword v59,v61,s[60:63],s77 offen
 v_and_b32 v1,63,v0
 v_lshrrev_b32 v2,6,v0
 v_lshrrev_b32 v3,4,v1
 v_readfirstlane_b32 s3,v2
 v_and_b32 v2,15,v1
 v_lshlrev_b32 v1,4,v1
 s_lshl_b32 s3,s3,12
 s_lshl_b32 s58,s3,1
 v_lshrrev_b32 v132,5,v0
 v_lshrrev_b32 v136,2,v132
 v_lshlrev_b32 v136,4,v136
 v_and_b32 v134,3,v132
 v_add_u32 v136,v136,v134
 v_and_b32 v134,31,v0
 v_lshlrev_b32 v134,4,v134
 v_lshl_add_u32 v133,v136,11,v134
 s_lshr_b32 s42,s2,2
 s_and_b32 s43,s2,3
 s_lshl_b32 s42,s42,3
 s_add_u32 s42,s42,s43
 s_lshl_b32 s49,s42,13
 s_and_b32 s46,s2,31
 s_lshr_b32 s47,s2,5
 s_lshl_b32 s41,s47,20
 s_sub_u32 s41,s41,524288
 s_lshl_b32 s59,s47,8
 s_sub_u32 s59,s59,128
 s_lshl_b32 s47,s47,2
 s_lshr_b32 s48,s3,12
 s_add_u32 s47,s47,s48
 s_lshr_b32 s48,s3,8
 v_add_u32 v62,s48,v3
 v_lshlrev_b32 v62,13,v62
 v_lshlrev_b32 v63,1,v3
 v_xor_b32 v63,v63,v2
 v_lshl_add_u32 v32,v63,4,v62
 v_xor_b32 v63,8,v63
 v_lshl_add_u32 v34,v63,4,v62
 v_add_u32 v34,63488,v34
 v_add_u32 v33,31744,v32
 v_add_u32 v35,31744,v34
 v_bfe_u32 v62,v0,3,3
 v_lshlrev_b32 v62,11,v62
 v_and_b32 v63,7,v0
 v_xor_b32 v63,v63,v3
 v_lshl_add_u32 v116,v63,4,v62
 v_xor_b32 v63,4,v63
 v_lshl_add_u32 v117,v63,4,v62
 v_add_u32 v117,15360,v117
 v_add_u32 v118,30720,v116
 v_add_u32 v119,30720,v117
 s_waitcnt lgkmcnt(0)
 s_add_u32 s12,s52,s49
 s_addc_u32 s13,s53,0
 s_mov_b32 s14,40960
 s_mov_b32 s15,0x20000
 buffer_load_dwordx4 v[144:147],v133,s[12:15],0 offen offset:0
 buffer_load_dwordx4 v[148:151],v133,s[12:15],0 offen offset:512
 buffer_load_dwordx4 v[152:155],v133,s[12:15],0 offen offset:1024
 buffer_load_dwordx4 v[156:159],v133,s[12:15],0 offen offset:1536
 s_lshl_b32 s48,s46,8
 s_sub_u32 s49,8388608,s48
 s_add_u32 s8,s28,s48
 s_addc_u32 s9,s29,0
 s_mov_b32 s10,s49
 s_mov_b32 s11,0x20000
 s_lshl_b32 s48,s47,17
 s_add_u32 s4,s52,s48
 s_addc_u32 s5,s53,0
 s_mov_b32 s6,131072
 s_mov_b32 s7,0x20000
 s_add_u32 m0,s3,65536
 s_add_u32 s41,s41,524288
 s_and_b32 s41,s41,8388607
 buffer_load_dwordx4 v32,s[8:11],s41 offen offset:0 lds
 buffer_load_dwordx4 v33,s[8:11],s41 offen offset:1024 lds
 buffer_load_dwordx4 v34,s[8:11],s41 offen offset:2048 lds
 buffer_load_dwordx4 v35,s[8:11],s41 offen offset:3072 lds
 s_branch L_early_code
.p2align 12
L_early_code:
 v_lshrrev_b32 v44,2,v2
 v_and_b32 v45,1,v3
 v_lshl_add_u32 v45,v45,2,v44
 v_lshl_add_u32 v44,v3,3,v44
 v_lshlrev_b32 v44,8,v44
 v_lshlrev_b32 v45,1,v45
 v_and_b32 v46,3,v2
 v_xor_b32 v45,v45,v46
 v_lshl_add_u32 v44,v45,4,v44
 s_lshr_b32 s48,s3,6
 s_add_u32 s48,s48,65536
 v_xor_b32 v44,s48,v44
 v_xor_b32 v16,0,v44
 v_xor_b32 v17,64,v44
 v_xor_b32 v18,128,v44
 v_xor_b32 v19,192,v44
 v_lshrrev_b32 v44,1,v2
 v_xor_b32 v44,v44,v3
 v_lshlrev_b32 v44,4,v44
 v_lshl_add_u32 v44,v2,7,v44
 v_add_u32 v112,s58,v44
 v_xor_b32 v113,64,v112
 v_add_u32 v114,131072,v112
 v_add_u32 v115,131072,v113
 v_lshrrev_b32 v44,1,v2
 v_lshrrev_b32 v45,1,v3
 v_cmp_eq_u32 vcc,v44,v45
 v_mov_b32 v44,0x3f803f80
 v_and_b32 v45,1,v2
 v_cndmask_b32 v20,0,v44,vcc
 v_cndmask_b32 v21,0,v44,vcc
 v_cndmask_b32 v22,0,v44,vcc
 v_cndmask_b32 v23,0,v44,vcc
 v_mul_u32_u24 v45,0xaaaa,v45
 v_add_u32 v60,0x4444,v45
 v_mov_b64 v[120:121],0
 v_mov_b64 v[122:123],0
 v_mov_b64 v[124:125],0
 v_mov_b64 v[126:127],0
 s_add_u32 s68,s30,0
 s_addc_u32 s69,s31,0
 s_mov_b32 s70,50331648
 s_mov_b32 s71,0x20000
 s_add_u32 s72,s50,0
 s_addc_u32 s73,s51,0
 s_mov_b32 s74,256
 s_mov_b32 s75,0x20000
 v_lshl_add_u32 v135,v132,11,v134
 v_add_u32 v135,114688,v135
 v_bfe_u32 v96,v0,2,2
 v_lshlrev_b32 v96,11,v96
 v_lshl_add_u32 v96,v132,6,v96
 v_bfe_u32 v141,v0,4,1
 v_lshl_add_u32 v96,v141,3,v96
 v_and_b32 v140,3,v0
 v_lshl_add_u32 v96,v140,4,v96
 v_add_u32 v96,114688,v96
 v_lshlrev_b32 v85,17,v132
 v_lshl_add_u32 v85,v141,10,v85
 v_lshl_add_u32 v85,v2,4,v85
 s_lshl_b32 s48,s42,2
 v_add_u32 v136,s48,v136
 v_min_u32 v134,1,v134
 v_lshlrev_b32 v134,30,v134
 v_lshl_add_u32 v86,v136,4,v134
 v_lshl_add_u32 v87,v136,2,v134
 s_lshr_b32 s42,s2,2
 s_lshl_b32 s42,s42,11
 s_lshl_b32 s43,s43,8
 s_add_u32 s43,s43,s42
 s_add_u32 s43,s43,4194304
 v_add_u32 v85,s43,v85
 s_add_u32 m0,s58,0
 s_add_u32 s59,s59,128
 s_and_b32 s59,s59,2047
 buffer_load_dwordx4 v116,s[4:7],s59 offen offset:0 lds
 buffer_load_dwordx4 v117,s[4:7],s59 offen offset:1024 lds
 buffer_load_dwordx4 v118,s[4:7],s59 offen offset:2048 lds
 buffer_load_dwordx4 v119,s[4:7],s59 offen offset:3072 lds
 s_mov_b64 exec,0
 s_cmp_eq_u32 s3,0
 s_cbranch_scc1 L_stub_a_0
 s_cmp_eq_u32 s3,4096
 s_cbranch_scc1 L_stub_a_1
 s_cmp_eq_u32 s3,8192
 s_cbranch_scc1 L_stub_a_2
 s_branch L_stub_a_3
L_warm_a_ret:
 s_mov_b64 exec,-1
 s_add_u32 m0,s58,4096
 s_add_u32 s40,s59,65536
 buffer_load_dwordx4 v116,s[4:7],s40 offen offset:0 lds
 buffer_load_dwordx4 v117,s[4:7],s40 offen offset:1024 lds
 buffer_load_dwordx4 v118,s[4:7],s40 offen offset:2048 lds
 buffer_load_dwordx4 v119,s[4:7],s40 offen offset:3072 lds
 s_mov_b32 s48,0xba800000
 s_mov_b32 s49,0x3727c5ac
 s_mov_b32 s50,0x3e0293ee
 s_waitcnt vmcnt(12)
 v_lshlrev_b32 v160,16,v144
 v_and_b32 v161,0xffff0000,v144
 v_lshlrev_b32 v162,16,v145
 v_and_b32 v163,0xffff0000,v145
 v_lshlrev_b32 v164,16,v146
 v_and_b32 v165,0xffff0000,v146
 v_lshlrev_b32 v166,16,v147
 v_and_b32 v167,0xffff0000,v147
 v_lshlrev_b32 v168,16,v148
 v_and_b32 v169,0xffff0000,v148
 v_lshlrev_b32 v170,16,v149
 v_and_b32 v171,0xffff0000,v149
 v_lshlrev_b32 v172,16,v150
 v_and_b32 v173,0xffff0000,v150
 v_lshlrev_b32 v174,16,v151
 v_and_b32 v175,0xffff0000,v151
 s_add_u32 m0,s58,131072
 s_add_u32 s59,s59,128
 s_and_b32 s59,s59,2047
 buffer_load_dwordx4 v116,s[4:7],s59 offen offset:0 lds
 v_lshlrev_b32 v176,16,v152
 v_and_b32 v177,0xffff0000,v152
 v_lshlrev_b32 v178,16,v153
 v_and_b32 v179,0xffff0000,v153
 v_lshlrev_b32 v180,16,v154
 v_and_b32 v181,0xffff0000,v154
 v_lshlrev_b32 v182,16,v155
 v_and_b32 v183,0xffff0000,v155
 v_lshlrev_b32 v184,16,v156
 v_and_b32 v185,0xffff0000,v156
 v_lshlrev_b32 v186,16,v157
 v_and_b32 v187,0xffff0000,v157
 v_lshlrev_b32 v188,16,v158
 v_and_b32 v189,0xffff0000,v158
 v_lshlrev_b32 v190,16,v159
 v_and_b32 v191,0xffff0000,v159
 buffer_load_dwordx4 v117,s[4:7],s59 offen offset:1024 lds
 v_pk_add_f32 v[192:193],v[160:161],v[162:163]
 v_pk_add_f32 v[194:195],v[164:165],v[166:167]
 v_pk_add_f32 v[192:193],v[192:193],v[168:169]
 v_pk_add_f32 v[194:195],v[194:195],v[170:171]
 v_pk_add_f32 v[192:193],v[192:193],v[172:173]
 v_pk_add_f32 v[194:195],v[194:195],v[174:175]
 v_pk_add_f32 v[192:193],v[192:193],v[176:177]
 v_pk_add_f32 v[194:195],v[194:195],v[178:179]
 v_pk_add_f32 v[192:193],v[192:193],v[180:181]
 v_pk_add_f32 v[194:195],v[194:195],v[182:183]
 v_pk_add_f32 v[192:193],v[192:193],v[184:185]
 v_pk_add_f32 v[194:195],v[194:195],v[186:187]
 v_pk_add_f32 v[192:193],v[192:193],v[188:189]
 v_pk_add_f32 v[194:195],v[194:195],v[190:191]
 buffer_load_dwordx4 v118,s[4:7],s59 offen offset:2048 lds
 v_pk_add_f32 v[192:193],v[192:193],v[194:195]
 v_add_f32 v192,v192,v193
 s_nop 1
 v_add_f32_dpp v192,v192,v192 quad_perm:[1,0,3,2] row_mask:0xf bank_mask:0xf
 s_nop 1
 v_add_f32_dpp v192,v192,v192 quad_perm:[2,3,0,1] row_mask:0xf bank_mask:0xf
 s_nop 1
 v_add_f32_dpp v192,v192,v192 row_half_mirror row_mask:0xf bank_mask:0xf
 s_nop 1
 v_add_f32_dpp v192,v192,v192 row_mirror row_mask:0xf bank_mask:0xf
 v_mov_b32 v194,v192
 s_nop 1
 v_permlane16_swap_b32 v192,v194
 v_add_f32 v192,v192,v194
 buffer_load_dwordx4 v119,s[4:7],s59 offen offset:3072 lds
 v_mul_f32 v192,s48,v192
 v_mov_b32 v193,v192
 v_pk_add_f32 v[160:161],v[160:161],v[192:193]
 v_pk_add_f32 v[162:163],v[162:163],v[192:193]
 v_pk_add_f32 v[164:165],v[164:165],v[192:193]
 v_pk_add_f32 v[166:167],v[166:167],v[192:193]
 v_pk_add_f32 v[168:169],v[168:169],v[192:193]
 v_pk_add_f32 v[170:171],v[170:171],v[192:193]
 v_pk_add_f32 v[172:173],v[172:173],v[192:193]
 v_pk_add_f32 v[174:175],v[174:175],v[192:193]
 v_pk_add_f32 v[176:177],v[176:177],v[192:193]
 v_pk_add_f32 v[178:179],v[178:179],v[192:193]
 v_pk_add_f32 v[180:181],v[180:181],v[192:193]
 v_pk_add_f32 v[182:183],v[182:183],v[192:193]
 v_pk_add_f32 v[184:185],v[184:185],v[192:193]
 v_pk_add_f32 v[186:187],v[186:187],v[192:193]
 v_pk_add_f32 v[188:189],v[188:189],v[192:193]
 v_pk_add_f32 v[190:191],v[190:191],v[192:193]
 v_cvt_pk_bf16_f32 v80,v192,v192
 v_and_b32 v194,0xffff0000,v80
 v_sub_f32 v194,v192,v194
 v_cvt_pk_bf16_f32 v81,v194,0
 v_mov_b64 v[82:83],v[80:81]
 s_add_u32 m0,s3,81920
 s_add_u32 s41,s41,524288
 s_and_b32 s41,s41,8388607
 buffer_load_dwordx4 v32,s[8:11],s41 offen offset:0 lds
 v_pk_mul_f32 v[192:193],v[160:161],v[160:161]
 v_pk_mul_f32 v[194:195],v[162:163],v[162:163]
 v_pk_fma_f32 v[192:193],v[164:165],v[164:165],v[192:193]
 v_pk_fma_f32 v[194:195],v[166:167],v[166:167],v[194:195]
 v_pk_fma_f32 v[192:193],v[168:169],v[168:169],v[192:193]
 v_pk_fma_f32 v[194:195],v[170:171],v[170:171],v[194:195]
 v_pk_fma_f32 v[192:193],v[172:173],v[172:173],v[192:193]
 v_pk_fma_f32 v[194:195],v[174:175],v[174:175],v[194:195]
 v_pk_fma_f32 v[192:193],v[176:177],v[176:177],v[192:193]
 v_pk_fma_f32 v[194:195],v[178:179],v[178:179],v[194:195]
 v_pk_fma_f32 v[192:193],v[180:181],v[180:181],v[192:193]
 v_pk_fma_f32 v[194:195],v[182:183],v[182:183],v[194:195]
 v_pk_fma_f32 v[192:193],v[184:185],v[184:185],v[192:193]
 v_pk_fma_f32 v[194:195],v[186:187],v[186:187],v[194:195]
 v_pk_fma_f32 v[192:193],v[188:189],v[188:189],v[192:193]
 v_pk_fma_f32 v[194:195],v[190:191],v[190:191],v[194:195]
 buffer_load_dwordx4 v33,s[8:11],s41 offen offset:1024 lds
 v_pk_add_f32 v[192:193],v[192:193],v[194:195]
 v_add_f32 v192,v192,v193
 s_nop 1
 v_add_f32_dpp v192,v192,v192 quad_perm:[1,0,3,2] row_mask:0xf bank_mask:0xf
 s_nop 1
 v_add_f32_dpp v192,v192,v192 quad_perm:[2,3,0,1] row_mask:0xf bank_mask:0xf
 s_nop 1
 v_add_f32_dpp v192,v192,v192 row_half_mirror row_mask:0xf bank_mask:0xf
 s_nop 1
 v_add_f32_dpp v192,v192,v192 row_mirror row_mask:0xf bank_mask:0xf
 v_mov_b32 v194,v192
 s_nop 1
 v_permlane16_swap_b32 v192,v194
 v_add_f32 v192,v192,v194
 buffer_load_dwordx4 v34,s[8:11],s41 offen offset:2048 lds
 v_mov_b32 v196,s49
 v_fma_f32 v196,-v192,s48,v196
 v_rsq_f32 v196,v196
 s_nop 0
 v_mul_f32 v84,s50,v196
 v_mov_b32 v197,v196
 v_pk_mul_f32 v[160:161],v[160:161],v[196:197]
 v_pk_mul_f32 v[162:163],v[162:163],v[196:197]
 v_pk_mul_f32 v[164:165],v[164:165],v[196:197]
 v_pk_mul_f32 v[166:167],v[166:167],v[196:197]
 v_pk_mul_f32 v[168:169],v[168:169],v[196:197]
 v_pk_mul_f32 v[170:171],v[170:171],v[196:197]
 v_pk_mul_f32 v[172:173],v[172:173],v[196:197]
 v_pk_mul_f32 v[174:175],v[174:175],v[196:197]
 v_pk_mul_f32 v[176:177],v[176:177],v[196:197]
 v_pk_mul_f32 v[178:179],v[178:179],v[196:197]
 v_pk_mul_f32 v[180:181],v[180:181],v[196:197]
 v_pk_mul_f32 v[182:183],v[182:183],v[196:197]
 v_pk_mul_f32 v[184:185],v[184:185],v[196:197]
 v_pk_mul_f32 v[186:187],v[186:187],v[196:197]
 v_pk_mul_f32 v[188:189],v[188:189],v[196:197]
 v_pk_mul_f32 v[190:191],v[190:191],v[196:197]
 buffer_load_dwordx4 v35,s[8:11],s41 offen offset:3072 lds
 v_pk_add_f32 v[192:193],v[160:161],v[162:163]
 v_pk_mul_f32 v[194:195],v[160:161],v[160:161]
 v_pk_fma_f32 v[194:195],v[162:163],v[162:163],v[194:195]
 v_pk_add_f32 v[192:193],v[192:193],v[164:165]
 v_pk_fma_f32 v[194:195],v[164:165],v[164:165],v[194:195]
 v_pk_add_f32 v[192:193],v[192:193],v[166:167]
 v_pk_fma_f32 v[194:195],v[166:167],v[166:167],v[194:195]
 v_pk_add_f32 v[192:193],v[192:193],v[168:169]
 v_pk_fma_f32 v[194:195],v[168:169],v[168:169],v[194:195]
 v_pk_add_f32 v[192:193],v[192:193],v[170:171]
 v_pk_fma_f32 v[194:195],v[170:171],v[170:171],v[194:195]
 v_pk_add_f32 v[192:193],v[192:193],v[172:173]
 v_pk_fma_f32 v[194:195],v[172:173],v[172:173],v[194:195]
 v_pk_add_f32 v[192:193],v[192:193],v[174:175]
 v_pk_fma_f32 v[194:195],v[174:175],v[174:175],v[194:195]
 s_add_u32 m0,s58,135168
 s_add_u32 s40,s59,65536
 buffer_load_dwordx4 v116,s[4:7],s40 offen offset:0 lds
 v_pk_add_f32 v[192:193],v[192:193],v[176:177]
 v_pk_fma_f32 v[194:195],v[176:177],v[176:177],v[194:195]
 v_pk_add_f32 v[192:193],v[192:193],v[178:179]
 v_pk_fma_f32 v[194:195],v[178:179],v[178:179],v[194:195]
 v_pk_add_f32 v[192:193],v[192:193],v[180:181]
 v_pk_fma_f32 v[194:195],v[180:181],v[180:181],v[194:195]
 v_pk_add_f32 v[192:193],v[192:193],v[182:183]
 v_pk_fma_f32 v[194:195],v[182:183],v[182:183],v[194:195]
 v_pk_add_f32 v[192:193],v[192:193],v[184:185]
 v_pk_fma_f32 v[194:195],v[184:185],v[184:185],v[194:195]
 v_pk_add_f32 v[192:193],v[192:193],v[186:187]
 v_pk_fma_f32 v[194:195],v[186:187],v[186:187],v[194:195]
 v_pk_add_f32 v[192:193],v[192:193],v[188:189]
 v_pk_fma_f32 v[194:195],v[188:189],v[188:189],v[194:195]
 v_pk_add_f32 v[192:193],v[192:193],v[190:191]
 v_pk_fma_f32 v[194:195],v[190:191],v[190:191],v[194:195]
 buffer_load_dwordx4 v117,s[4:7],s40 offen offset:1024 lds
 v_add_f32 v192,v192,v193
 v_add_f32 v193,v194,v195
 s_nop 0
 v_add_f32_dpp v192,v192,v192 quad_perm:[1,0,3,2] row_mask:0xf bank_mask:0xf
 v_add_f32_dpp v193,v193,v193 quad_perm:[1,0,3,2] row_mask:0xf bank_mask:0xf
 s_nop 0
 v_add_f32_dpp v192,v192,v192 quad_perm:[2,3,0,1] row_mask:0xf bank_mask:0xf
 v_add_f32_dpp v193,v193,v193 quad_perm:[2,3,0,1] row_mask:0xf bank_mask:0xf
 s_nop 0
 v_add_f32_dpp v192,v192,v192 row_half_mirror row_mask:0xf bank_mask:0xf
 v_add_f32_dpp v193,v193,v193 row_half_mirror row_mask:0xf bank_mask:0xf
 s_nop 0
 v_add_f32_dpp v192,v192,v192 row_mirror row_mask:0xf bank_mask:0xf
 v_add_f32_dpp v193,v193,v193 row_mirror row_mask:0xf bank_mask:0xf
 v_mov_b32 v194,v192
 v_mov_b32 v195,v193
 s_nop 0
 v_permlane16_swap_b32 v192,v194
 v_permlane16_swap_b32 v193,v195
 v_add_f32 v192,v192,v194
 v_add_f32 v193,v193,v195
 buffer_load_dwordx4 v118,s[4:7],s40 offen offset:2048 lds
 v_mul_f32 v192,s48,v192
 v_mul_f32 v193,s48,v193
 v_fma_f32 v193,-v192,v192,-v193
 v_max_f32 v193,0,v193
 v_add_f32 v193,s49,v193
 v_rsq_f32 v196,v193
 s_nop 0
 v_mul_f32 v196,0xbeeff558,v196
 v_mul_f32 v198,v192,v196
 v_mov_b32 v197,v196
 v_mov_b32 v199,v198
 v_pk_fma_f32 v[200:201],v[160:161],v[196:197],v[198:199]
 v_pk_fma_f32 v[202:203],v[162:163],v[196:197],v[198:199]
 v_pk_fma_f32 v[204:205],v[164:165],v[196:197],v[198:199]
 v_pk_fma_f32 v[206:207],v[166:167],v[196:197],v[198:199]
 v_cvt_pk_bf16_f32 v144,v200,v201
 v_cvt_pk_bf16_f32 v145,v202,v203
 v_cvt_pk_bf16_f32 v146,v204,v205
 v_cvt_pk_bf16_f32 v147,v206,v207
 ds_write_b128 v135,v[144:147] offset:0
 v_pk_fma_f32 v[200:201],v[168:169],v[196:197],v[198:199]
 v_pk_fma_f32 v[202:203],v[170:171],v[196:197],v[198:199]
 v_pk_fma_f32 v[204:205],v[172:173],v[196:197],v[198:199]
 v_pk_fma_f32 v[206:207],v[174:175],v[196:197],v[198:199]
 v_cvt_pk_bf16_f32 v148,v200,v201
 v_cvt_pk_bf16_f32 v149,v202,v203
 v_cvt_pk_bf16_f32 v150,v204,v205
 v_cvt_pk_bf16_f32 v151,v206,v207
 ds_write_b128 v135,v[148:151] offset:512
 buffer_load_dwordx4 v119,s[4:7],s40 offen offset:3072 lds
 v_pk_fma_f32 v[200:201],v[176:177],v[196:197],v[198:199]
 v_pk_fma_f32 v[202:203],v[178:179],v[196:197],v[198:199]
 v_pk_fma_f32 v[204:205],v[180:181],v[196:197],v[198:199]
 v_pk_fma_f32 v[206:207],v[182:183],v[196:197],v[198:199]
 v_cvt_pk_bf16_f32 v152,v200,v201
 v_cvt_pk_bf16_f32 v153,v202,v203
 v_cvt_pk_bf16_f32 v154,v204,v205
 v_cvt_pk_bf16_f32 v155,v206,v207
 ds_write_b128 v135,v[152:155] offset:1024
 v_pk_fma_f32 v[200:201],v[184:185],v[196:197],v[198:199]
 v_pk_fma_f32 v[202:203],v[186:187],v[196:197],v[198:199]
 v_pk_fma_f32 v[204:205],v[188:189],v[196:197],v[198:199]
 v_pk_fma_f32 v[206:207],v[190:191],v[196:197],v[198:199]
 v_cvt_pk_bf16_f32 v156,v200,v201
 v_cvt_pk_bf16_f32 v157,v202,v203
 v_cvt_pk_bf16_f32 v158,v204,v205
 v_cvt_pk_bf16_f32 v159,v206,v207
 ds_write_b128 v135,v[156:159] offset:1536
 s_waitcnt vmcnt(12)
 ds_read_b128 a[192:195],v112 offset:0
 ds_read_b128 a[208:211],v113 offset:0
 ds_read_b128 a[196:199],v112 offset:2048
 ds_read_b128 a[212:215],v113 offset:2048
 ds_read_b128 a[200:203],v112 offset:4096
 ds_read_b128 a[216:219],v113 offset:4096
 ds_read_b128 a[204:207],v112 offset:6144
 ds_read_b128 a[220:223],v113 offset:6144
 s_waitcnt lgkmcnt(8)
 s_barrier
 ds_read_b64_tr_b16 a[128:129],v16 offset:0
 ds_read_b64_tr_b16 a[130:131],v16 offset:1024
 ds_read_b64_tr_b16 a[132:133],v16 offset:8192
 ds_read_b64_tr_b16 a[134:135],v16 offset:9216
 ds_read_b64_tr_b16 a[136:137],v16 offset:8
 ds_read_b64_tr_b16 a[138:139],v16 offset:1032
 ds_read_b64_tr_b16 a[140:141],v16 offset:8200
 ds_read_b64_tr_b16 a[142:143],v16 offset:9224
 ds_read_b64_tr_b16 a[144:145],v17 offset:0
 ds_read_b64_tr_b16 a[146:147],v17 offset:1024
 ds_read_b64_tr_b16 a[148:149],v17 offset:8192
 ds_read_b64_tr_b16 a[150:151],v17 offset:9216
 ds_read_b64_tr_b16 a[152:153],v17 offset:8
 ds_read_b64_tr_b16 a[154:155],v17 offset:1032
 ds_read_b64_tr_b16 a[156:157],v17 offset:8200
 ds_read_b64_tr_b16 a[158:159],v17 offset:9224
 s_waitcnt lgkmcnt(12)
L_q_code:
 v_mfma_f32_16x16x32_bf16 v[128:131],a[128:131],a[192:195],0
 s_add_u32 m0,s58,32768
 ds_read_b64_tr_b16 v[64:65],v96 offset:0
 v_lshrrev_b32 v88,4,v0
 v_mfma_f32_16x16x32_bf16 v[128:131],a[132:135],a[208:211],v[128:131]
 s_add_u32 s59,s59,128
 s_and_b32 s59,s59,2047
 ds_read_b64_tr_b16 v[66:67],v96 offset:8192
 v_mfma_f32_16x16x32_bf16 v[132:135],a[128:131],a[196:199],0
 ds_read_b64_tr_b16 v[68:69],v96 offset:512
 buffer_load_dwordx4 v116,s[4:7],s59 offen offset:0 lds
 v_mfma_f32_16x16x32_bf16 v[132:135],a[132:135],a[212:215],v[132:135]
 ds_read_b64_tr_b16 v[70:71],v96 offset:8704
 v_or_b32 v88,s45,v88
 v_mfma_f32_16x16x32_bf16 v[136:139],a[128:131],a[200:203],0
 ds_read_b64_tr_b16 v[72:73],v96 offset:1024
 v_min_u32 v88,1,v88
 v_mfma_f32_16x16x32_bf16 v[136:139],a[132:135],a[216:219],v[136:139]
 ds_read_b64_tr_b16 v[74:75],v96 offset:9216
 v_lshlrev_b32 v88,30,v88
 v_mfma_f32_16x16x32_bf16 v[140:143],a[128:131],a[204:207],0
 ds_read_b64_tr_b16 v[76:77],v96 offset:1536
 s_waitcnt lgkmcnt(14)
 buffer_load_dwordx4 v117,s[4:7],s59 offen offset:1024 lds
 v_mfma_f32_16x16x32_bf16 v[140:143],a[132:135],a[220:223],v[140:143]
 ds_read_b64_tr_b16 v[78:79],v96 offset:9728
 v_smfmac_f32_16x16x64_bf16 v[120:123],v[20:23],a[128:135],v60
 v_mfma_f32_16x16x32_bf16 v[144:147],a[136:139],a[192:195],0
 ds_read_b64_tr_b16 a[160:161],v18 offset:0
 v_lshl_add_u32 v88,v0,2,v88
 v_mfma_f32_16x16x32_bf16 v[144:147],a[140:143],a[208:211],v[144:147]
 ds_read_b64_tr_b16 a[162:163],v18 offset:1024
 v_mov_b32 v89,0
 v_mfma_f32_16x16x32_bf16 v[148:151],a[136:139],a[196:199],0
 ds_read_b64_tr_b16 a[164:165],v18 offset:8192
 buffer_load_dwordx4 v118,s[4:7],s59 offen offset:2048 lds
 v_mfma_f32_16x16x32_bf16 v[148:151],a[140:143],a[212:215],v[148:151]
 ds_read_b64_tr_b16 a[166:167],v18 offset:9216
 v_or_b32 v95,s45,v0
 v_mfma_f32_16x16x32_bf16 v[152:155],a[136:139],a[200:203],0
 ds_read_b64_tr_b16 a[168:169],v18 offset:8
 v_lshlrev_b32 v95,8,v95
 v_mfma_f32_16x16x32_bf16 v[152:155],a[140:143],a[216:219],v[152:155]
 ds_read_b64_tr_b16 a[170:171],v18 offset:1032
 s_waitcnt vmcnt(11)
 v_min_u32 v97,1,v95
 v_mfma_f32_16x16x32_bf16 v[156:159],a[136:139],a[204:207],0
 s_waitcnt lgkmcnt(14)
 ds_read_b128 a[224:227],v114 offset:0
 buffer_load_dwordx4 v119,s[4:7],s59 offen offset:3072 lds
 v_mfma_f32_16x16x32_bf16 v[156:159],a[140:143],a[220:223],v[156:159]
 ds_read_b64_tr_b16 a[172:173],v18 offset:8200
 v_smfmac_f32_16x16x64_bf16 v[124:127],v[20:23],a[136:143],v60
 v_mfma_f32_16x16x32_bf16 v[160:163],a[144:147],a[192:195],0
 ds_read_b64_tr_b16 a[174:175],v18 offset:9224
 v_lshlrev_b32 v97,30,v97
 v_mfma_f32_16x16x32_bf16 v[160:163],a[148:151],a[208:211],v[160:163]
 s_add_u32 m0,s3,98304
 ds_read_b128 a[240:243],v115 offset:0
 v_mov_b32 v55,1
 v_mfma_f32_16x16x32_bf16 v[164:167],a[144:147],a[196:199],0
 s_add_u32 s41,s41,524288
 s_and_b32 s41,s41,8388607
 ds_read_b64_tr_b16 a[176:177],v19 offset:0
 v_mfma_f32_16x16x32_bf16 v[164:167],a[148:151],a[212:215],v[164:167]
 ds_read_b64_tr_b16 a[178:179],v19 offset:1024
 buffer_load_dwordx4 v32,s[8:11],s41 offen offset:0 lds
 v_mfma_f32_16x16x32_bf16 v[168:171],a[144:147],a[200:203],0
 ds_read_b128 a[228:231],v114 offset:2048
 v_min_u32 v94,1,v3
 v_mfma_f32_16x16x32_bf16 v[168:171],a[148:151],a[216:219],v[168:171]
 ds_read_b64_tr_b16 a[180:181],v19 offset:8192
 v_lshlrev_b32 v94,30,v94
 v_mfma_f32_16x16x32_bf16 v[172:175],a[144:147],a[204:207],0
 ds_read_b64_tr_b16 a[182:183],v19 offset:9216
 s_waitcnt lgkmcnt(14)
 v_lshl_add_u32 v94,v2,4,v94
 v_mfma_f32_16x16x32_bf16 v[172:175],a[148:151],a[220:223],v[172:175]
 s_lshl_b32 s48,s46,19
 ds_read_b128 a[244:247],v115 offset:2048
 buffer_load_dwordx4 v33,s[8:11],s41 offen offset:1024 lds
 v_mfma_f32_16x16x32_bf16 v[176:179],a[152:155],a[192:195],0
 s_add_u32 s12,s24,s48
 s_addc_u32 s13,s25,0
 ds_read_b64_tr_b16 a[184:185],v19 offset:8
 v_mfma_f32_16x16x32_bf16 v[176:179],a[156:159],a[208:211],v[176:179]
 s_mov_b32 s14,524288
 ds_read_b64_tr_b16 a[186:187],v19 offset:1032
 s_mov_b32 s15,0x20000
 v_mfma_f32_16x16x32_bf16 v[180:183],a[152:155],a[196:199],0
 s_add_u32 s16,s26,s48
 s_addc_u32 s17,s27,0
 ds_read_b64_tr_b16 a[188:189],v19 offset:8200
 v_mfma_f32_16x16x32_bf16 v[180:183],a[156:159],a[212:215],v[180:183]
 s_mov_b32 s18,524288
 ds_read_b64_tr_b16 a[190:191],v19 offset:9224
 buffer_load_dwordx4 v34,s[8:11],s41 offen offset:2048 lds
 v_mfma_f32_16x16x32_bf16 v[184:187],a[152:155],a[200:203],0
 s_mov_b32 s19,0x20000
 s_lshl_b32 s48,s47,19
 s_lshl_b32 s49,s46,13
 v_mfma_f32_16x16x32_bf16 v[184:187],a[156:159],a[216:219],v[184:187]
 s_add_u32 s48,s48,s49
 s_add_u32 s48,s48,8388608
 v_mfma_f32_16x16x32_bf16 v[188:191],a[152:155],a[204:207],0
 s_add_u32 s20,s30,s48
 s_addc_u32 s21,s31,0
 s_mov_b32 s22,270336
 v_mfma_f32_16x16x32_bf16 v[188:191],a[156:159],a[220:223],v[188:191]
 s_waitcnt vmcnt(11) lgkmcnt(0)
 s_barrier
 v_mfma_f32_16x16x32_bf16 v[192:195],a[160:163],a[192:195],0
 s_mov_b32 s23,0x20000
 ds_read_b64_tr_b16 a[128:129],v16 offset:16384
 s_mul_i32 s48,s2,57344
 v_mfma_f32_16x16x32_bf16 v[192:195],a[164:167],a[208:211],v[192:195]
 s_add_u32 s64,s32,s48
 s_addc_u32 s65,s33,0
 ds_read_b64_tr_b16 a[130:131],v16 offset:17408
 v_mfma_f32_16x16x32_bf16 v[196:199],a[160:163],a[196:199],0
 s_mov_b32 s66,57344
 buffer_load_dwordx4 v35,s[8:11],s41 offen offset:3072 lds
 s_mov_b32 s67,0x20000
 v_mfma_f32_16x16x32_bf16 v[196:199],a[164:167],a[212:215],v[196:199]
 s_mov_b32 s76,0
 ds_read_b64_tr_b16 a[132:133],v16 offset:24576
 s_mov_b32 s44,7
 v_mfma_f32_16x16x32_bf16 v[200:203],a[160:163],a[200:203],0
 s_add_u32 m0,s58,36864
 ds_read_b64_tr_b16 a[134:135],v16 offset:25600
 v_lshrrev_b32 v44,2,v2
 v_mfma_f32_16x16x32_bf16 v[200:203],a[164:167],a[216:219],v[200:203]
 s_add_u32 s40,s59,65536
 v_and_b32 v45,1,v3
 v_lshl_add_u32 v45,v45,2,v44
 v_mfma_f32_16x16x32_bf16 v[204:207],a[160:163],a[204:207],0
 ds_read_b64_tr_b16 a[136:137],v16 offset:16392
 buffer_load_dwordx4 v116,s[4:7],s40 offen offset:0 lds
 v_mfma_f32_16x16x32_bf16 v[204:207],a[164:167],a[220:223],v[204:207]
 ds_read_b64_tr_b16 a[138:139],v16 offset:17416
 v_lshl_add_u32 v44,v3,2,v44
 v_mfma_f32_16x16x32_bf16 v[208:211],a[168:171],a[192:195],0
 v_lshlrev_b32 v44,8,v44
 v_lshl_add_u32 v44,v45,5,v44
 v_mfma_f32_16x16x32_bf16 v[208:211],a[172:175],a[208:211],v[208:211]
 ds_read_b64_tr_b16 a[140:141],v16 offset:24584
 v_and_b32 v45,3,v2
 v_mfma_f32_16x16x32_bf16 v[212:215],a[168:171],a[196:199],0
 ds_read_b64_tr_b16 a[142:143],v16 offset:25608
 buffer_load_dwordx4 v117,s[4:7],s40 offen offset:1024 lds
 v_mfma_f32_16x16x32_bf16 v[212:215],a[172:175],a[212:215],v[212:215]
 v_lshl_add_u32 v44,v45,3,v44
 v_add_u32 v44,65536,v44
 v_mfma_f32_16x16x32_bf16 v[216:219],a[168:171],a[200:203],0
 ds_read_b64_tr_b16 a[144:145],v17 offset:16384
 v_xor_b32 v8,0,v44
 v_mfma_f32_16x16x32_bf16 v[216:219],a[172:175],a[216:219],v[216:219]
 ds_read_b64_tr_b16 a[146:147],v17 offset:17408
 s_waitcnt vmcnt(10)
 v_xor_b32 v9,32,v44
 v_mfma_f32_16x16x32_bf16 v[220:223],a[168:171],a[204:207],0
 ds_read_b128 a[232:235],v114 offset:4096
 buffer_load_dwordx4 v118,s[4:7],s40 offen offset:2048 lds
 v_mfma_f32_16x16x32_bf16 v[220:223],a[172:175],a[220:223],v[220:223]
 ds_read_b64_tr_b16 a[148:149],v17 offset:24576
 v_xor_b32 v10,64,v44
 v_mfma_f32_16x16x32_bf16 v[224:227],a[176:179],a[192:195],0
 ds_read_b64_tr_b16 a[150:151],v17 offset:25600
 v_xor_b32 v11,96,v44
 v_mfma_f32_16x16x32_bf16 v[224:227],a[180:183],a[208:211],v[224:227]
 ds_read_b128 a[248:251],v115 offset:4096
 v_xor_b32 v12,128,v44
 v_mfma_f32_16x16x32_bf16 v[228:231],a[176:179],a[196:199],0
 ds_read_b64_tr_b16 a[152:153],v17 offset:16392
 v_xor_b32 v13,160,v44
 v_mfma_f32_16x16x32_bf16 v[228:231],a[180:183],a[212:215],v[228:231]
 ds_read_b64_tr_b16 a[154:155],v17 offset:17416
 buffer_load_dwordx4 v119,s[4:7],s40 offen offset:3072 lds
 v_mfma_f32_16x16x32_bf16 v[232:235],a[176:179],a[200:203],0
 ds_read_b128 a[236:239],v114 offset:6144
 v_xor_b32 v14,192,v44
 v_mfma_f32_16x16x32_bf16 v[232:235],a[180:183],a[216:219],v[232:235]
 s_add_u32 m0,s58,0
 ds_read_b64_tr_b16 a[156:157],v17 offset:24584
 v_xor_b32 v15,224,v44
 v_mfma_f32_16x16x32_bf16 v[236:239],a[176:179],a[204:207],0
 s_add_u32 s59,s59,128
 s_and_b32 s59,s59,2047
 ds_read_b64_tr_b16 a[158:159],v17 offset:25608
 v_mfma_f32_16x16x32_bf16 v[236:239],a[180:183],a[220:223],v[236:239]
 ds_read_b128 a[252:255],v115 offset:6144
 buffer_load_dwordx4 v116,s[4:7],s59 offen offset:0 lds
 v_mfma_f32_16x16x32_bf16 v[240:243],a[184:187],a[192:195],0
 v_xor_b32 v44,v2,v3
 v_lshlrev_b32 v44,4,v44
 v_mfma_f32_16x16x32_bf16 v[240:243],a[188:191],a[208:211],v[240:243]
 v_lshl_add_u32 v44,v2,8,v44
 s_lshr_b32 s48,s3,6
 v_mfma_f32_16x16x32_bf16 v[244:247],a[184:187],a[196:199],0
 v_xor_b32 v44,s48,v44
 v_xor_b32 v4,0,v44
 v_mfma_f32_16x16x32_bf16 v[244:247],a[188:191],a[212:215],v[244:247]
 buffer_load_dwordx4 v117,s[4:7],s59 offen offset:1024 lds
 v_xor_b32 v5,64,v44
 v_mfma_f32_16x16x32_bf16 v[248:251],a[184:187],a[200:203],0
 v_xor_b32 v6,128,v44
 v_xor_b32 v7,192,v44
 v_mfma_f32_16x16x32_bf16 v[248:251],a[188:191],a[216:219],v[248:251]
 v_mfma_f32_16x16x32_bf16 v[252:255],a[184:187],a[204:207],0
 v_mfma_f32_16x16x32_bf16 v[252:255],a[188:191],a[220:223],v[252:255]
 s_waitcnt lgkmcnt(0)
 v_mfma_f32_16x16x32_bf16 v[128:131],a[128:131],a[224:227],v[128:131]
 ds_read_b64_tr_b16 a[160:161],v18 offset:16384
 v_mfma_f32_16x16x32_bf16 v[128:131],a[132:135],a[240:243],v[128:131]
 ds_read_b64_tr_b16 a[162:163],v18 offset:17408
 v_mfma_f32_16x16x32_bf16 v[132:135],a[132:135],a[244:247],v[132:135]
 buffer_load_dwordx4 v118,s[4:7],s59 offen offset:2048 lds
 v_mfma_f32_16x16x32_bf16 v[132:135],a[128:131],a[228:231],v[132:135]
L_stub_a_0:
 s_cbranch_execz L_stub_a_4
 ds_read_b64_tr_b16 a[164:165],v18 offset:24576
 v_mfma_f32_16x16x32_bf16 v[136:139],a[128:131],a[232:235],v[136:139]
 ds_read_b64_tr_b16 a[166:167],v18 offset:25600
 v_mfma_f32_16x16x32_bf16 v[136:139],a[132:135],a[248:251],v[136:139]
 v_mfma_f32_16x16x32_bf16 v[140:143],a[132:135],a[252:255],v[140:143]
 ds_read_b64_tr_b16 a[168:169],v18 offset:16392
 buffer_load_dwordx4 v119,s[4:7],s59 offen offset:3072 lds
 v_mfma_f32_16x16x32_bf16 v[140:143],a[128:131],a[236:239],v[140:143]
 ds_read_b64_tr_b16 a[170:171],v18 offset:17416
 v_smfmac_f32_16x16x64_bf16 v[120:123],v[20:23],a[128:135],v60
 v_mfma_f32_16x16x32_bf16 v[156:159],a[136:139],a[236:239],v[156:159]
 s_add_u32 m0,s3,114688
 v_mfma_f32_16x16x32_bf16 v[156:159],a[140:143],a[252:255],v[156:159]
 s_add_u32 s41,s41,524288
 s_and_b32 s41,s41,8388607
 ds_read_b64_tr_b16 a[172:173],v18 offset:24584
 v_mfma_f32_16x16x32_bf16 v[152:155],a[140:143],a[248:251],v[152:155]
 ds_read_b64_tr_b16 a[174:175],v18 offset:25608
 buffer_load_dwordx4 v32,s[8:11],s41 offen offset:0 lds
 v_mfma_f32_16x16x32_bf16 v[152:155],a[136:139],a[232:235],v[152:155]
 v_mfma_f32_16x16x32_bf16 v[148:151],a[136:139],a[228:231],v[148:151]
 ds_read_b64_tr_b16 a[176:177],v19 offset:16384
 v_mfma_f32_16x16x32_bf16 v[148:151],a[140:143],a[244:247],v[148:151]
 ds_read_b64_tr_b16 a[178:179],v19 offset:17408
 s_waitcnt vmcnt(13)
 v_mfma_f32_16x16x32_bf16 v[144:147],a[140:143],a[240:243],v[144:147]
 ds_read_b128 a[192:195],v112 offset:32768
 buffer_load_dwordx4 v33,s[8:11],s41 offen offset:1024 lds
 v_mfma_f32_16x16x32_bf16 v[144:147],a[136:139],a[224:227],v[144:147]
 ds_read_b64_tr_b16 a[180:181],v19 offset:24576
 v_smfmac_f32_16x16x64_bf16 v[124:127],v[20:23],a[136:143],v60
 v_mfma_f32_16x16x32_bf16 v[160:163],a[144:147],a[224:227],v[160:163]
 ds_read_b64_tr_b16 a[182:183],v19 offset:25600
 v_mfma_f32_16x16x32_bf16 v[160:163],a[148:151],a[240:243],v[160:163]
 ds_read_b128 a[208:211],v113 offset:32768
 v_mfma_f32_16x16x32_bf16 v[164:167],a[148:151],a[244:247],v[164:167]
 ds_read_b64_tr_b16 a[184:185],v19 offset:16392
 v_mfma_f32_16x16x32_bf16 v[164:167],a[144:147],a[228:231],v[164:167]
 ds_read_b64_tr_b16 a[186:187],v19 offset:17416
 buffer_load_dwordx4 v34,s[8:11],s41 offen offset:2048 lds
 v_mfma_f32_16x16x32_bf16 v[168:171],a[144:147],a[232:235],v[168:171]
 ds_read_b128 a[196:199],v112 offset:34816
 v_mfma_f32_16x16x32_bf16 v[168:171],a[148:151],a[248:251],v[168:171]
 ds_read_b64_tr_b16 a[188:189],v19 offset:24584
 v_mfma_f32_16x16x32_bf16 v[172:175],a[148:151],a[252:255],v[172:175]
 ds_read_b64_tr_b16 a[190:191],v19 offset:25608
 v_mfma_f32_16x16x32_bf16 v[172:175],a[144:147],a[236:239],v[172:175]
 ds_read_b128 a[212:215],v113 offset:34816
 buffer_load_dwordx4 v35,s[8:11],s41 offen offset:3072 lds
 v_mfma_f32_16x16x32_bf16 v[188:191],a[152:155],a[236:239],v[188:191]
 v_mfma_f32_16x16x32_bf16 v[188:191],a[156:159],a[252:255],v[188:191]
 s_add_u32 m0,s58,4096
 v_mfma_f32_16x16x32_bf16 v[184:187],a[156:159],a[248:251],v[184:187]
 s_add_u32 s40,s59,65536
 v_mfma_f32_16x16x32_bf16 v[184:187],a[152:155],a[232:235],v[184:187]
 buffer_load_dwordx4 v116,s[4:7],s40 offen offset:0 lds
 v_mfma_f32_16x16x32_bf16 v[180:183],a[152:155],a[228:231],v[180:183]
 v_mfma_f32_16x16x32_bf16 v[180:183],a[156:159],a[244:247],v[180:183]
 v_mfma_f32_16x16x32_bf16 v[176:179],a[156:159],a[240:243],v[176:179]
 v_mfma_f32_16x16x32_bf16 v[176:179],a[152:155],a[224:227],v[176:179]
 s_waitcnt vmcnt(13) lgkmcnt(0)
 s_barrier
 v_mfma_f32_16x16x32_bf16 v[192:195],a[160:163],a[224:227],v[192:195]
 ds_read_b64_tr_b16 a[128:129],v16 offset:32768
 v_add_f32 v120,v120,v121
 v_mfma_f32_16x16x32_bf16 v[192:195],a[164:167],a[240:243],v[192:195]
 ds_read_b64_tr_b16 a[130:131],v16 offset:33792
 v_add_f32 v122,v122,v123
 v_mfma_f32_16x16x32_bf16 v[196:199],a[164:167],a[244:247],v[196:199]
 buffer_store_dwordx4 v[80:83],v86,s[68:71],0 offen sc1
 v_add_f32 v120,v120,v122
 v_mfma_f32_16x16x32_bf16 v[196:199],a[160:163],a[228:231],v[196:199]
 ds_read_b64_tr_b16 a[132:133],v16 offset:40960
 v_cvt_pk_bf16_f32 v90,v120,v120
 v_mfma_f32_16x16x32_bf16 v[200:203],a[160:163],a[232:235],v[200:203]
 ds_read_b64_tr_b16 a[134:135],v16 offset:41984
 v_and_b32 v121,0xffff0000,v90
 v_mfma_f32_16x16x32_bf16 v[200:203],a[164:167],a[248:251],v[200:203]
 v_sub_f32 v121,v120,v121
 v_and_b32 v91,0xffff,v90
 v_mfma_f32_16x16x32_bf16 v[204:207],a[164:167],a[252:255],v[204:207]
 ds_read_b64_tr_b16 a[136:137],v16 offset:32776
 buffer_load_dwordx4 v117,s[4:7],s40 offen offset:1024 lds
 v_mfma_f32_16x16x32_bf16 v[204:207],a[160:163],a[236:239],v[204:207]
 ds_read_b64_tr_b16 a[138:139],v16 offset:33800
 v_cvt_pk_bf16_f32 v90,v120,v121
 v_mfma_f32_16x16x32_bf16 v[220:223],a[168:171],a[236:239],v[220:223]
 v_add_f32 v124,v124,v125
 v_add_f32 v126,v126,v127
 v_mfma_f32_16x16x32_bf16 v[220:223],a[172:175],a[252:255],v[220:223]
 ds_read_b64_tr_b16 a[140:141],v16 offset:40968
 v_add_f32 v124,v124,v126
 v_mfma_f32_16x16x32_bf16 v[216:219],a[172:175],a[248:251],v[216:219]
 ds_read_b64_tr_b16 a[142:143],v16 offset:41992
 buffer_load_dwordx4 v118,s[4:7],s40 offen offset:2048 lds
 v_mfma_f32_16x16x32_bf16 v[216:219],a[168:171],a[232:235],v[216:219]
 v_cvt_pk_bf16_f32 v92,v124,v124
 v_and_b32 v125,0xffff0000,v92
 v_mfma_f32_16x16x32_bf16 v[212:215],a[168:171],a[228:231],v[212:215]
 ds_read_b64_tr_b16 a[144:145],v17 offset:32768
 v_sub_f32 v125,v124,v125
 v_mfma_f32_16x16x32_bf16 v[212:215],a[172:175],a[244:247],v[212:215]
 ds_read_b64_tr_b16 a[146:147],v17 offset:33792
 s_waitcnt vmcnt(12)
 v_and_b32 v93,0xffff,v92
 v_mfma_f32_16x16x32_bf16 v[208:211],a[172:175],a[240:243],v[208:211]
 ds_read_b128 a[200:203],v112 offset:36864
 buffer_load_dwordx4 v119,s[4:7],s40 offen offset:3072 lds
 v_mfma_f32_16x16x32_bf16 v[208:211],a[168:171],a[224:227],v[208:211]
 ds_read_b64_tr_b16 a[148:149],v17 offset:40960
 v_cvt_pk_bf16_f32 v92,v124,v125
 v_mfma_f32_16x16x32_bf16 v[224:227],a[176:179],a[224:227],v[224:227]
 s_lshl_b32 s42,s46,13
 ds_read_b64_tr_b16 a[150:151],v17 offset:41984
 s_add_u32 s42,s42,65536
 v_mfma_f32_16x16x32_bf16 v[224:227],a[180:183],a[240:243],v[224:227]
 s_add_u32 m0,s58,131072
 ds_read_b128 a[216:219],v113 offset:36864
 s_lshr_b32 s48,s3,1
 v_mfma_f32_16x16x32_bf16 v[228:231],a[180:183],a[244:247],v[228:231]
 s_add_u32 s59,s59,128
 s_and_b32 s59,s59,2047
 ds_read_b64_tr_b16 a[152:153],v17 offset:32776
 v_mfma_f32_16x16x32_bf16 v[228:231],a[176:179],a[228:231],v[228:231]
 s_add_u32 s42,s42,s48
 ds_read_b64_tr_b16 a[154:155],v17 offset:33800
 buffer_load_dwordx4 v116,s[4:7],s59 offen offset:0 lds
 v_mfma_f32_16x16x32_bf16 v[232:235],a[176:179],a[232:235],v[232:235]
 s_lshr_b32 s48,s2,6
 ds_read_b128 a[204:207],v112 offset:38912
 s_lshl_b32 s48,s48,8
 v_mfma_f32_16x16x32_bf16 v[232:235],a[180:183],a[248:251],v[232:235]
 s_bfe_u32 s49,s2,0x10005
 ds_read_b64_tr_b16 a[156:157],v17 offset:40968
 s_lshl_b32 s49,s49,3
 v_mfma_f32_16x16x32_bf16 v[236:239],a[180:183],a[252:255],v[236:239]
 s_add_u32 s48,s48,s49
 ds_read_b64_tr_b16 a[158:159],v17 offset:41992
 s_add_u32 s51,s42,s48
 v_mfma_f32_16x16x32_bf16 v[236:239],a[176:179],a[236:239],v[236:239]
 ds_read_b128 a[220:223],v113 offset:38912
 buffer_load_dwordx4 v117,s[4:7],s59 offen offset:1024 lds
 v_mfma_f32_16x16x32_bf16 v[252:255],a[184:187],a[236:239],v[252:255]
 buffer_store_dwordx2 v[90:91],v94,s[68:71],s51 offen offset:0 sc1
 v_mfma_f32_16x16x32_bf16 v[252:255],a[188:191],a[252:255],v[252:255]
 buffer_store_dwordx2 v[92:93],v94,s[68:71],s51 offen offset:1024 sc1
 v_lshlrev_b32 v44,8,v3
 v_mfma_f32_16x16x32_bf16 v[248:251],a[188:191],a[248:251],v[248:251]
 v_add_u32 v44,s3,v44
 v_xor_b32 v45,v2,v3
 v_mfma_f32_16x16x32_bf16 v[248:251],a[184:187],a[232:235],v[248:251]
 buffer_load_dwordx4 v118,s[4:7],s59 offen offset:2048 lds
 v_xor_b32 v46,0,v45
 v_mfma_f32_16x16x32_bf16 v[244:247],a[184:187],a[228:231],v[244:247]
 v_lshl_add_u32 v24,v46,4,v44
 v_xor_b32 v46,4,v45
 v_mfma_f32_16x16x32_bf16 v[244:247],a[188:191],a[244:247],v[244:247]
 v_lshl_add_u32 v25,v46,4,v44
 v_xor_b32 v46,8,v45
 v_mfma_f32_16x16x32_bf16 v[240:243],a[188:191],a[240:243],v[240:243]
 v_lshl_add_u32 v26,v46,4,v44
 v_xor_b32 v46,12,v45
 v_mfma_f32_16x16x32_bf16 v[240:243],a[184:187],a[224:227],v[240:243]
 s_waitcnt lgkmcnt(0)
 v_lshl_add_u32 v27,v46,4,v44
 v_lshlrev_b32 v45,1,v3
 v_mfma_f32_16x16x32_bf16 v[128:131],a[128:131],a[192:195],v[128:131]
 ds_read_b64_tr_b16 a[160:161],v18 offset:32768
 v_xor_b32 v45,v45,v2
 v_mfma_f32_16x16x32_bf16 v[128:131],a[132:135],a[208:211],v[128:131]
 s_mov_b32 s50,32768
 ds_read_b64_tr_b16 a[162:163],v18 offset:33792
 v_xor_b32 v46,0,v45
 v_mfma_f32_16x16x32_bf16 v[132:135],a[132:135],a[212:215],v[132:135]
 buffer_store_dword v84,v87,s[68:71],s50 offen sc1
 v_lshl_add_u32 v28,v46,4,v44
 v_mfma_f32_16x16x32_bf16 v[132:135],a[128:131],a[196:199],v[132:135]
 ds_read_b64_tr_b16 a[164:165],v18 offset:40960
 v_xor_b32 v46,8,v45
 v_mfma_f32_16x16x32_bf16 v[136:139],a[128:131],a[200:203],v[136:139]
 ds_read_b64_tr_b16 a[166:167],v18 offset:41984
 v_lshl_add_u32 v29,v46,4,v44
 v_mfma_f32_16x16x32_bf16 v[136:139],a[132:135],a[216:219],v[136:139]
 v_mov_b32 v36,0
 v_mov_b32 v37,0
 v_mfma_f32_16x16x32_bf16 v[140:143],a[132:135],a[220:223],v[140:143]
 ds_read_b64_tr_b16 a[168:169],v18 offset:32776
 buffer_load_dwordx4 v119,s[4:7],s59 offen offset:3072 lds
 v_mfma_f32_16x16x32_bf16 v[140:143],a[128:131],a[204:207],v[140:143]
 ds_read_b64_tr_b16 a[170:171],v18 offset:33800
 v_mov_b32 v38,0
 v_mfma_f32_16x16x32_bf16 v[156:159],a[136:139],a[204:207],v[156:159]
 s_add_u32 m0,s3,65536
 v_mov_b32 v39,0
 v_mov_b32 v40,0
 v_mfma_f32_16x16x32_bf16 v[156:159],a[140:143],a[220:223],v[156:159]
 s_add_u32 s41,s41,524288
 s_and_b32 s41,s41,8388607
 ds_read_b64_tr_b16 a[172:173],v18 offset:40968
 v_mfma_f32_16x16x32_bf16 v[152:155],a[140:143],a[216:219],v[152:155]
 ds_read_b64_tr_b16 a[174:175],v18 offset:41992
 buffer_load_dwordx4 v32,s[8:11],s41 offen offset:0 lds
 v_mfma_f32_16x16x32_bf16 v[152:155],a[136:139],a[200:203],v[152:155]
 v_mov_b32 v41,0
 v_mov_b32 v42,0
 v_mfma_f32_16x16x32_bf16 v[148:151],a[136:139],a[196:199],v[148:151]
 ds_read_b64_tr_b16 a[176:177],v19 offset:32768
 v_mov_b32 v43,0
 v_mfma_f32_16x16x32_bf16 v[148:151],a[140:143],a[212:215],v[148:151]
 ds_read_b64_tr_b16 a[178:179],v19 offset:33792
 s_waitcnt vmcnt(17)
 v_accvgpr_write_b32 a48,0
 v_mfma_f32_16x16x32_bf16 v[144:147],a[140:143],a[208:211],v[144:147]
 ds_read_b128 a[224:227],v112 offset:0
 buffer_load_dwordx4 v33,s[8:11],s41 offen offset:1024 lds
 v_mfma_f32_16x16x32_bf16 v[144:147],a[136:139],a[192:195],v[144:147]
 ds_read_b64_tr_b16 a[180:181],v19 offset:40960
 v_accvgpr_write_b32 a49,0
 v_mfma_f32_16x16x32_bf16 v[160:163],a[144:147],a[192:195],v[160:163]
 ds_read_b64_tr_b16 a[182:183],v19 offset:41984
 v_accvgpr_write_b32 a50,0
 v_mfma_f32_16x16x32_bf16 v[160:163],a[148:151],a[208:211],v[160:163]
 ds_read_b128 a[240:243],v113 offset:0
 v_accvgpr_write_b32 a51,0
 v_mfma_f32_16x16x32_bf16 v[164:167],a[148:151],a[212:215],v[164:167]
 ds_read_b64_tr_b16 a[184:185],v19 offset:32776
 v_accvgpr_write_b32 a52,0
 v_mfma_f32_16x16x32_bf16 v[164:167],a[144:147],a[196:199],v[164:167]
 ds_read_b64_tr_b16 a[186:187],v19 offset:33800
 buffer_load_dwordx4 v34,s[8:11],s41 offen offset:2048 lds
 v_mfma_f32_16x16x32_bf16 v[168:171],a[144:147],a[200:203],v[168:171]
 ds_read_b128 a[228:231],v112 offset:2048
 v_accvgpr_write_b32 a53,0
 v_mfma_f32_16x16x32_bf16 v[168:171],a[148:151],a[216:219],v[168:171]
 ds_read_b64_tr_b16 a[188:189],v19 offset:40968
 v_accvgpr_write_b32 a54,0
 v_mfma_f32_16x16x32_bf16 v[172:175],a[148:151],a[220:223],v[172:175]
 ds_read_b64_tr_b16 a[190:191],v19 offset:41992
 v_accvgpr_write_b32 a55,0
 v_mfma_f32_16x16x32_bf16 v[172:175],a[144:147],a[204:207],v[172:175]
 ds_read_b128 a[244:247],v113 offset:2048
 buffer_load_dwordx4 v35,s[8:11],s41 offen offset:3072 lds
 v_mfma_f32_16x16x32_bf16 v[188:191],a[152:155],a[204:207],v[188:191]
 v_accvgpr_write_b32 a56,0
 v_accvgpr_write_b32 a57,0
 v_mfma_f32_16x16x32_bf16 v[188:191],a[156:159],a[220:223],v[188:191]
 s_add_u32 m0,s58,135168
 v_accvgpr_write_b32 a58,0
 v_accvgpr_write_b32 a59,0
 v_mfma_f32_16x16x32_bf16 v[184:187],a[156:159],a[216:219],v[184:187]
 s_add_u32 s40,s59,65536
 v_accvgpr_write_b32 a60,0
 v_accvgpr_write_b32 a61,0
 v_mfma_f32_16x16x32_bf16 v[184:187],a[152:155],a[200:203],v[184:187]
 buffer_load_dwordx4 v116,s[4:7],s40 offen offset:0 lds
 v_accvgpr_write_b32 a62,0
 v_mfma_f32_16x16x32_bf16 v[180:183],a[152:155],a[196:199],v[180:183]
 v_accvgpr_write_b32 a63,0
 v_accvgpr_write_b32 a64,0
 v_mfma_f32_16x16x32_bf16 v[180:183],a[156:159],a[212:215],v[180:183]
 v_accvgpr_write_b32 a65,0
 v_accvgpr_write_b32 a66,0
 v_mfma_f32_16x16x32_bf16 v[176:179],a[156:159],a[208:211],v[176:179]
 v_accvgpr_write_b32 a67,0
 v_accvgpr_write_b32 a68,0
 v_mfma_f32_16x16x32_bf16 v[176:179],a[152:155],a[192:195],v[176:179]
 s_waitcnt vmcnt(17) lgkmcnt(0)
 s_barrier
 v_mfma_f32_16x16x32_bf16 v[192:195],a[160:163],a[192:195],v[192:195]
 ds_read_b64_tr_b16 a[128:129],v16 offset:49152
 v_accvgpr_write_b32 a69,0
 v_mfma_f32_16x16x32_bf16 v[192:195],a[164:167],a[208:211],v[192:195]
 s_lshl_b32 s50,s2,6
 s_add_u32 s50,s50,41943040
 ds_read_b64_tr_b16 a[130:131],v16 offset:50176
 v_mfma_f32_16x16x32_bf16 v[196:199],a[164:167],a[212:215],v[196:199]
 buffer_store_dword v89,v88,s[68:71],s50 offen sc1
 v_accvgpr_write_b32 a70,0
 v_mfma_f32_16x16x32_bf16 v[196:199],a[160:163],a[196:199],v[196:199]
 ds_read_b64_tr_b16 a[132:133],v16 offset:57344
 v_accvgpr_write_b32 a71,0
 v_mfma_f32_16x16x32_bf16 v[200:203],a[160:163],a[200:203],v[200:203]
 ds_read_b64_tr_b16 a[134:135],v16 offset:58368
 v_accvgpr_write_b32 a72,0
 v_mfma_f32_16x16x32_bf16 v[200:203],a[164:167],a[216:219],v[200:203]
 v_accvgpr_write_b32 a73,0
 v_accvgpr_write_b32 a74,0
 v_mfma_f32_16x16x32_bf16 v[204:207],a[164:167],a[220:223],v[204:207]
 ds_read_b64_tr_b16 a[136:137],v16 offset:49160
 buffer_load_dwordx4 v117,s[4:7],s40 offen offset:1024 lds
 v_mfma_f32_16x16x32_bf16 v[204:207],a[160:163],a[204:207],v[204:207]
 ds_read_b64_tr_b16 a[138:139],v16 offset:50184
 v_accvgpr_write_b32 a75,0
 v_mfma_f32_16x16x32_bf16 v[220:223],a[168:171],a[204:207],v[220:223]
 v_accvgpr_write_b32 a76,0
 v_accvgpr_write_b32 a77,0
 v_mfma_f32_16x16x32_bf16 v[220:223],a[172:175],a[220:223],v[220:223]
 ds_read_b64_tr_b16 a[140:141],v16 offset:57352
 v_accvgpr_write_b32 a78,0
 v_mfma_f32_16x16x32_bf16 v[216:219],a[172:175],a[216:219],v[216:219]
 ds_read_b64_tr_b16 a[142:143],v16 offset:58376
 buffer_load_dwordx4 v118,s[4:7],s40 offen offset:2048 lds
 v_mfma_f32_16x16x32_bf16 v[216:219],a[168:171],a[200:203],v[216:219]
 v_accvgpr_write_b32 a79,0
 v_accvgpr_write_b32 a80,0
 v_mfma_f32_16x16x32_bf16 v[212:215],a[168:171],a[196:199],v[212:215]
 ds_read_b64_tr_b16 a[144:145],v17 offset:49152
 v_accvgpr_write_b32 a81,0
 v_mfma_f32_16x16x32_bf16 v[212:215],a[172:175],a[212:215],v[212:215]
 ds_read_b64_tr_b16 a[146:147],v17 offset:50176
 s_waitcnt vmcnt(15)
 v_accvgpr_write_b32 a82,0
 v_mfma_f32_16x16x32_bf16 v[208:211],a[172:175],a[208:211],v[208:211]
 ds_read_b128 a[232:235],v112 offset:4096
 buffer_load_dwordx4 v119,s[4:7],s40 offen offset:3072 lds
 v_mfma_f32_16x16x32_bf16 v[208:211],a[168:171],a[192:195],v[208:211]
 ds_read_b64_tr_b16 a[148:149],v17 offset:57344
 v_accvgpr_write_b32 a83,0
 v_mfma_f32_16x16x32_bf16 v[224:227],a[176:179],a[192:195],v[224:227]
 ds_read_b64_tr_b16 a[150:151],v17 offset:58368
 v_accvgpr_write_b32 a84,0
 v_mfma_f32_16x16x32_bf16 v[224:227],a[180:183],a[208:211],v[224:227]
 s_add_u32 m0,s58,32768
 ds_read_b128 a[248:251],v113 offset:4096
 v_accvgpr_write_b32 a85,0
 v_mfma_f32_16x16x32_bf16 v[228:231],a[180:183],a[212:215],v[228:231]
 s_add_u32 s59,s59,128
 s_and_b32 s59,s59,2047
 ds_read_b64_tr_b16 a[152:153],v17 offset:49160
 v_mfma_f32_16x16x32_bf16 v[228:231],a[176:179],a[196:199],v[228:231]
 ds_read_b64_tr_b16 a[154:155],v17 offset:50184
 buffer_load_dwordx4 v116,s[4:7],s59 offen offset:0 lds
 v_mfma_f32_16x16x32_bf16 v[232:235],a[176:179],a[200:203],v[232:235]
 ds_read_b128 a[236:239],v112 offset:6144
 v_accvgpr_write_b32 a86,0
 v_mfma_f32_16x16x32_bf16 v[232:235],a[180:183],a[216:219],v[232:235]
 ds_read_b64_tr_b16 a[156:157],v17 offset:57352
 v_accvgpr_write_b32 a87,0
 v_mfma_f32_16x16x32_bf16 v[236:239],a[180:183],a[220:223],v[236:239]
 ds_read_b64_tr_b16 a[158:159],v17 offset:58376
 v_accvgpr_write_b32 a88,0
 v_mfma_f32_16x16x32_bf16 v[236:239],a[176:179],a[204:207],v[236:239]
 ds_read_b128 a[252:255],v113 offset:6144
 buffer_load_dwordx4 v117,s[4:7],s59 offen offset:1024 lds
 v_mfma_f32_16x16x32_bf16 v[252:255],a[184:187],a[204:207],v[252:255]
 v_accvgpr_write_b32 a89,0
 v_accvgpr_write_b32 a90,0
 v_mfma_f32_16x16x32_bf16 v[252:255],a[188:191],a[220:223],v[252:255]
 v_accvgpr_write_b32 a91,0
 v_accvgpr_write_b32 a92,0
 v_mfma_f32_16x16x32_bf16 v[248:251],a[188:191],a[216:219],v[248:251]
 v_accvgpr_write_b32 a93,0
 v_accvgpr_write_b32 a94,0
 v_mfma_f32_16x16x32_bf16 v[248:251],a[184:187],a[200:203],v[248:251]
 buffer_load_dwordx4 v118,s[4:7],s59 offen offset:2048 lds
 v_accvgpr_write_b32 a95,0
 v_mfma_f32_16x16x32_bf16 v[244:247],a[184:187],a[196:199],v[244:247]
 v_accvgpr_write_b32 a96,0
 v_accvgpr_write_b32 a97,0
 v_mfma_f32_16x16x32_bf16 v[244:247],a[188:191],a[212:215],v[244:247]
 v_accvgpr_write_b32 a98,0
 v_accvgpr_write_b32 a99,0
 v_mfma_f32_16x16x32_bf16 v[240:243],a[188:191],a[208:211],v[240:243]
 v_accvgpr_write_b32 a100,0
 v_accvgpr_write_b32 a101,0
 v_mfma_f32_16x16x32_bf16 v[240:243],a[184:187],a[192:195],v[240:243]
 s_waitcnt lgkmcnt(0)
 v_accvgpr_write_b32 a102,0
 v_accvgpr_write_b32 a103,0
 v_mfma_f32_16x16x32_bf16 v[128:131],a[128:131],a[224:227],v[128:131]
 ds_read_b64_tr_b16 a[160:161],v18 offset:49152
 v_accvgpr_write_b32 a104,0
 v_mfma_f32_16x16x32_bf16 v[128:131],a[132:135],a[240:243],v[128:131]
 ds_read_b64_tr_b16 a[162:163],v18 offset:50176
 v_accvgpr_write_b32 a105,0
 v_mfma_f32_16x16x32_bf16 v[132:135],a[132:135],a[244:247],v[132:135]
 buffer_load_dwordx4 v119,s[4:7],s59 offen offset:3072 lds
 v_accvgpr_write_b32 a106,0
 v_mfma_f32_16x16x32_bf16 v[132:135],a[128:131],a[228:231],v[132:135]
 ds_read_b64_tr_b16 a[164:165],v18 offset:57344
 v_accvgpr_write_b32 a107,0
 v_mfma_f32_16x16x32_bf16 v[136:139],a[128:131],a[232:235],v[136:139]
 s_add_u32 m0,s3,81920
 ds_read_b64_tr_b16 a[166:167],v18 offset:58368
 v_accvgpr_write_b32 a108,0
 v_mfma_f32_16x16x32_bf16 v[136:139],a[132:135],a[248:251],v[136:139]
 s_add_u32 s41,s41,524288
 s_and_b32 s41,s41,8388607
 v_accvgpr_write_b32 a109,0
 v_mfma_f32_16x16x32_bf16 v[140:143],a[132:135],a[252:255],v[140:143]
 ds_read_b64_tr_b16 a[168:169],v18 offset:49160
 buffer_load_dwordx4 v32,s[8:11],s41 offen offset:0 lds
 v_mfma_f32_16x16x32_bf16 v[140:143],a[128:131],a[236:239],v[140:143]
 ds_read_b64_tr_b16 a[170:171],v18 offset:50184
 v_accvgpr_write_b32 a110,0
 v_mfma_f32_16x16x32_bf16 v[156:159],a[136:139],a[236:239],v[156:159]
 v_accvgpr_write_b32 a111,0
 v_accvgpr_write_b32 a112,0
 v_mfma_f32_16x16x32_bf16 v[156:159],a[140:143],a[252:255],v[156:159]
 ds_read_b64_tr_b16 a[172:173],v18 offset:57352
 v_accvgpr_write_b32 a113,0
 v_mfma_f32_16x16x32_bf16 v[152:155],a[140:143],a[248:251],v[152:155]
 ds_read_b64_tr_b16 a[174:175],v18 offset:58376
 buffer_load_dwordx4 v33,s[8:11],s41 offen offset:1024 lds
 v_mfma_f32_16x16x32_bf16 v[152:155],a[136:139],a[232:235],v[152:155]
 v_accvgpr_write_b32 a114,0
 v_accvgpr_write_b32 a115,0
 v_mfma_f32_16x16x32_bf16 v[148:151],a[136:139],a[228:231],v[148:151]
 ds_read_b64_tr_b16 a[176:177],v19 offset:49152
 v_accvgpr_write_b32 a116,0
 v_mfma_f32_16x16x32_bf16 v[148:151],a[140:143],a[244:247],v[148:151]
 ds_read_b64_tr_b16 a[178:179],v19 offset:50176
 s_waitcnt vmcnt(15)
 v_accvgpr_write_b32 a117,0
 v_mfma_f32_16x16x32_bf16 v[144:147],a[140:143],a[240:243],v[144:147]
 ds_read_b128 a[192:195],v114 offset:0
 buffer_load_dwordx4 v34,s[8:11],s41 offen offset:2048 lds
 v_mfma_f32_16x16x32_bf16 v[144:147],a[136:139],a[224:227],v[144:147]
 ds_read_b64_tr_b16 a[180:181],v19 offset:57344
 v_accvgpr_write_b32 a118,0
 v_mfma_f32_16x16x32_bf16 v[160:163],a[144:147],a[224:227],v[160:163]
 ds_read_b64_tr_b16 a[182:183],v19 offset:58368
 v_accvgpr_write_b32 a119,0
 v_mfma_f32_16x16x32_bf16 v[160:163],a[148:151],a[240:243],v[160:163]
 ds_read_b128 a[208:211],v115 offset:0
 v_accvgpr_write_b32 a120,0
 v_mfma_f32_16x16x32_bf16 v[164:167],a[148:151],a[244:247],v[164:167]
 ds_read_b64_tr_b16 a[184:185],v19 offset:49160
 v_accvgpr_write_b32 a121,0
 v_mfma_f32_16x16x32_bf16 v[164:167],a[144:147],a[228:231],v[164:167]
 ds_read_b64_tr_b16 a[186:187],v19 offset:50184
 buffer_load_dwordx4 v35,s[8:11],s41 offen offset:3072 lds
 v_mfma_f32_16x16x32_bf16 v[168:171],a[144:147],a[232:235],v[168:171]
 ds_read_b128 a[196:199],v114 offset:2048
 v_accvgpr_write_b32 a122,0
 v_mfma_f32_16x16x32_bf16 v[168:171],a[148:151],a[248:251],v[168:171]
 s_add_u32 m0,s58,36864
 ds_read_b64_tr_b16 a[188:189],v19 offset:57352
 v_accvgpr_write_b32 a123,0
 v_mfma_f32_16x16x32_bf16 v[172:175],a[148:151],a[252:255],v[172:175]
 s_add_u32 s40,s59,65536
 ds_read_b64_tr_b16 a[190:191],v19 offset:58376
 v_accvgpr_write_b32 a124,0
 v_mfma_f32_16x16x32_bf16 v[172:175],a[144:147],a[236:239],v[172:175]
 ds_read_b128 a[212:215],v115 offset:2048
 buffer_load_dwordx4 v116,s[4:7],s40 offen offset:0 lds
 v_mfma_f32_16x16x32_bf16 v[188:191],a[152:155],a[236:239],v[188:191]
 v_accvgpr_write_b32 a125,0
 v_accvgpr_write_b32 a126,0
 v_mfma_f32_16x16x32_bf16 v[188:191],a[156:159],a[252:255],v[188:191]
 v_accvgpr_write_b32 a127,0
 v_lshrrev_b32 v54,2,v1
 v_mfma_f32_16x16x32_bf16 v[184:187],a[156:159],a[248:251],v[184:187]
 v_lshlrev_b32 v62,4,v2
 v_lshlrev_b32 v63,2,v2
 v_mfma_f32_16x16x32_bf16 v[184:187],a[152:155],a[232:235],v[184:187]
 buffer_load_dwordx4 v117,s[4:7],s40 offen offset:1024 lds
 v_mfma_f32_16x16x32_bf16 v[180:183],a[152:155],a[228:231],v[180:183]
 v_mfma_f32_16x16x32_bf16 v[180:183],a[156:159],a[244:247],v[180:183]
 v_mfma_f32_16x16x32_bf16 v[176:179],a[156:159],a[240:243],v[176:179]
 v_mfma_f32_16x16x32_bf16 v[176:179],a[152:155],a[224:227],v[176:179]
 s_waitcnt vmcnt(15) lgkmcnt(0)
 s_barrier
 v_mfma_f32_16x16x32_bf16 v[192:195],a[160:163],a[224:227],v[192:195]
 ds_read_b64_tr_b16 a[128:129],v16 offset:0
 v_mfma_f32_16x16x32_bf16 v[192:195],a[164:167],a[240:243],v[192:195]
 ds_read_b64_tr_b16 a[130:131],v16 offset:1024
 v_mfma_f32_16x16x32_bf16 v[196:199],a[164:167],a[244:247],v[196:199]
 buffer_load_dwordx4 v118,s[4:7],s40 offen offset:2048 lds
 v_mfma_f32_16x16x32_bf16 v[196:199],a[160:163],a[228:231],v[196:199]
 ds_read_b64_tr_b16 a[132:133],v16 offset:8192
 v_mfma_f32_16x16x32_bf16 v[200:203],a[160:163],a[232:235],v[200:203]
 ds_read_b64_tr_b16 a[134:135],v16 offset:9216
 v_mfma_f32_16x16x32_bf16 v[200:203],a[164:167],a[248:251],v[200:203]
 v_mfma_f32_16x16x32_bf16 v[204:207],a[164:167],a[252:255],v[204:207]
 ds_read_b64_tr_b16 a[136:137],v16 offset:8
 buffer_load_dwordx4 v119,s[4:7],s40 offen offset:3072 lds
 v_mfma_f32_16x16x32_bf16 v[204:207],a[160:163],a[236:239],v[204:207]
 ds_read_b64_tr_b16 a[138:139],v16 offset:1032
 v_mfma_f32_16x16x32_bf16 v[220:223],a[168:171],a[236:239],v[220:223]
 s_add_u32 m0,s58,0
 v_mfma_f32_16x16x32_bf16 v[220:223],a[172:175],a[252:255],v[220:223]
 s_add_u32 s59,s59,128
 s_and_b32 s59,s59,2047
 ds_read_b64_tr_b16 a[140:141],v16 offset:8200
 v_mfma_f32_16x16x32_bf16 v[216:219],a[172:175],a[248:251],v[216:219]
 ds_read_b64_tr_b16 a[142:143],v16 offset:9224
 buffer_load_dwordx4 v116,s[4:7],s59 offen offset:0 lds
 v_mfma_f32_16x16x32_bf16 v[216:219],a[168:171],a[232:235],v[216:219]
 v_mfma_f32_16x16x32_bf16 v[212:215],a[168:171],a[228:231],v[212:215]
 ds_read_b64_tr_b16 a[144:145],v17 offset:0
 v_mfma_f32_16x16x32_bf16 v[212:215],a[172:175],a[244:247],v[212:215]
 ds_read_b64_tr_b16 a[146:147],v17 offset:1024
 s_waitcnt vmcnt(13)
 v_mfma_f32_16x16x32_bf16 v[208:211],a[172:175],a[240:243],v[208:211]
 ds_read_b128 a[200:203],v114 offset:4096
 buffer_load_dwordx4 v117,s[4:7],s59 offen offset:1024 lds
 v_mfma_f32_16x16x32_bf16 v[208:211],a[168:171],a[224:227],v[208:211]
 ds_read_b64_tr_b16 a[148:149],v17 offset:8192
 v_mfma_f32_16x16x32_bf16 v[224:227],a[176:179],a[224:227],v[224:227]
 ds_read_b64_tr_b16 a[150:151],v17 offset:9216
 v_mfma_f32_16x16x32_bf16 v[224:227],a[180:183],a[240:243],v[224:227]
 ds_read_b128 a[216:219],v115 offset:4096
 v_mfma_f32_16x16x32_bf16 v[228:231],a[180:183],a[244:247],v[228:231]
 ds_read_b64_tr_b16 a[152:153],v17 offset:8
 v_mfma_f32_16x16x32_bf16 v[228:231],a[176:179],a[228:231],v[228:231]
 ds_read_b64_tr_b16 a[154:155],v17 offset:1032
 buffer_load_dwordx4 v118,s[4:7],s59 offen offset:2048 lds
 v_mfma_f32_16x16x32_bf16 v[232:235],a[176:179],a[232:235],v[232:235]
 ds_read_b128 a[204:207],v114 offset:6144
 v_mfma_f32_16x16x32_bf16 v[232:235],a[180:183],a[248:251],v[232:235]
 ds_read_b64_tr_b16 a[156:157],v17 offset:8200
 v_mfma_f32_16x16x32_bf16 v[236:239],a[180:183],a[252:255],v[236:239]
 ds_read_b64_tr_b16 a[158:159],v17 offset:9224
 v_mfma_f32_16x16x32_bf16 v[236:239],a[176:179],a[236:239],v[236:239]
 ds_read_b128 a[220:223],v115 offset:6144
 buffer_load_dwordx4 v119,s[4:7],s59 offen offset:3072 lds
 v_mfma_f32_16x16x32_bf16 v[252:255],a[184:187],a[236:239],v[252:255]
 v_mfma_f32_16x16x32_bf16 v[252:255],a[188:191],a[252:255],v[252:255]
 s_add_u32 m0,s3,98304
 v_mfma_f32_16x16x32_bf16 v[248:251],a[188:191],a[248:251],v[248:251]
 s_add_u32 s41,s41,524288
 s_and_b32 s41,s41,8388607
 v_mfma_f32_16x16x32_bf16 v[248:251],a[184:187],a[232:235],v[248:251]
 buffer_load_dwordx4 v32,s[8:11],s41 offen offset:0 lds
 v_mfma_f32_16x16x32_bf16 v[244:247],a[184:187],a[228:231],v[244:247]
 v_mfma_f32_16x16x32_bf16 v[244:247],a[188:191],a[244:247],v[244:247]
 v_mfma_f32_16x16x32_bf16 v[240:243],a[188:191],a[240:243],v[240:243]
 v_mfma_f32_16x16x32_bf16 v[240:243],a[184:187],a[224:227],v[240:243]
 s_waitcnt lgkmcnt(0)
 v_mfma_f32_16x16x32_bf16 v[128:131],a[128:131],a[192:195],v[128:131]
 ds_read_b64_tr_b16 a[160:161],v18 offset:0
 v_mfma_f32_16x16x32_bf16 v[128:131],a[132:135],a[208:211],v[128:131]
 ds_read_b64_tr_b16 a[162:163],v18 offset:1024
 v_mfma_f32_16x16x32_bf16 v[132:135],a[132:135],a[212:215],v[132:135]
 buffer_load_dwordx4 v33,s[8:11],s41 offen offset:1024 lds
 v_mfma_f32_16x16x32_bf16 v[132:135],a[128:131],a[196:199],v[132:135]
 ds_read_b64_tr_b16 a[164:165],v18 offset:8192
 v_mfma_f32_16x16x32_bf16 v[136:139],a[128:131],a[200:203],v[136:139]
L_stub_a_1:
 s_cbranch_execz L_stub_a_5
 ds_read_b64_tr_b16 a[166:167],v18 offset:9216
 v_mfma_f32_16x16x32_bf16 v[136:139],a[132:135],a[216:219],v[136:139]
 v_mfma_f32_16x16x32_bf16 v[140:143],a[132:135],a[220:223],v[140:143]
 ds_read_b64_tr_b16 a[168:169],v18 offset:8
 buffer_load_dwordx4 v34,s[8:11],s41 offen offset:2048 lds
 v_mfma_f32_16x16x32_bf16 v[140:143],a[128:131],a[204:207],v[140:143]
 ds_read_b64_tr_b16 a[170:171],v18 offset:1032
 v_mfma_f32_16x16x32_bf16 v[156:159],a[136:139],a[204:207],v[156:159]
 v_mfma_f32_16x16x32_bf16 v[156:159],a[140:143],a[220:223],v[156:159]
 ds_read_b64_tr_b16 a[172:173],v18 offset:8200
 v_mfma_f32_16x16x32_bf16 v[152:155],a[140:143],a[216:219],v[152:155]
 ds_read_b64_tr_b16 a[174:175],v18 offset:9224
 buffer_load_dwordx4 v35,s[8:11],s41 offen offset:3072 lds
 v_mfma_f32_16x16x32_bf16 v[152:155],a[136:139],a[200:203],v[152:155]
 v_mfma_f32_16x16x32_bf16 v[148:151],a[136:139],a[196:199],v[148:151]
 s_add_u32 m0,s58,4096
 ds_read_b64_tr_b16 a[176:177],v19 offset:0
 v_mfma_f32_16x16x32_bf16 v[148:151],a[140:143],a[212:215],v[148:151]
 s_add_u32 s40,s59,65536
 ds_read_b64_tr_b16 a[178:179],v19 offset:1024
 s_waitcnt vmcnt(16)
 v_mfma_f32_16x16x32_bf16 v[144:147],a[140:143],a[208:211],v[144:147]
 ds_read_b128 a[224:227],v112 offset:32768
 buffer_load_dwordx4 v116,s[4:7],s40 offen offset:0 lds
 v_mfma_f32_16x16x32_bf16 v[144:147],a[136:139],a[192:195],v[144:147]
 ds_read_b64_tr_b16 a[180:181],v19 offset:8192
 v_mfma_f32_16x16x32_bf16 v[160:163],a[144:147],a[192:195],v[160:163]
 ds_read_b64_tr_b16 a[182:183],v19 offset:9216
 v_mfma_f32_16x16x32_bf16 v[160:163],a[148:151],a[208:211],v[160:163]
 ds_read_b128 a[240:243],v113 offset:32768
 v_mfma_f32_16x16x32_bf16 v[164:167],a[148:151],a[212:215],v[164:167]
 ds_read_b64_tr_b16 a[184:185],v19 offset:8
 v_mfma_f32_16x16x32_bf16 v[164:167],a[144:147],a[196:199],v[164:167]
 ds_read_b64_tr_b16 a[186:187],v19 offset:1032
 buffer_load_dwordx4 v117,s[4:7],s40 offen offset:1024 lds
 v_mfma_f32_16x16x32_bf16 v[168:171],a[144:147],a[200:203],v[168:171]
 ds_read_b128 a[228:231],v112 offset:34816
 v_mfma_f32_16x16x32_bf16 v[168:171],a[148:151],a[216:219],v[168:171]
 ds_read_b64_tr_b16 a[188:189],v19 offset:8200
 v_mfma_f32_16x16x32_bf16 v[172:175],a[148:151],a[220:223],v[172:175]
 ds_read_b64_tr_b16 a[190:191],v19 offset:9224
 v_mfma_f32_16x16x32_bf16 v[172:175],a[144:147],a[204:207],v[172:175]
 ds_read_b128 a[244:247],v113 offset:34816
 buffer_load_dwordx4 v118,s[4:7],s40 offen offset:2048 lds
 v_mfma_f32_16x16x32_bf16 v[188:191],a[152:155],a[204:207],v[188:191]
 v_mfma_f32_16x16x32_bf16 v[188:191],a[156:159],a[220:223],v[188:191]
 v_mfma_f32_16x16x32_bf16 v[184:187],a[156:159],a[216:219],v[184:187]
 v_mfma_f32_16x16x32_bf16 v[184:187],a[152:155],a[200:203],v[184:187]
 buffer_load_dwordx4 v119,s[4:7],s40 offen offset:3072 lds
 v_mfma_f32_16x16x32_bf16 v[180:183],a[152:155],a[196:199],v[180:183]
 v_mfma_f32_16x16x32_bf16 v[180:183],a[156:159],a[212:215],v[180:183]
 v_mfma_f32_16x16x32_bf16 v[176:179],a[156:159],a[208:211],v[176:179]
 v_mfma_f32_16x16x32_bf16 v[176:179],a[152:155],a[192:195],v[176:179]
 s_waitcnt vmcnt(16) lgkmcnt(0)
 s_barrier
 v_mfma_f32_16x16x32_bf16 v[192:195],a[160:163],a[192:195],v[192:195]
 s_add_u32 m0,s58,131072
 ds_read_b64_tr_b16 a[128:129],v16 offset:16384
 buffer_load_dword v59,v61,s[60:63],s77 offen
 v_mfma_f32_16x16x32_bf16 v[192:195],a[164:167],a[208:211],v[192:195]
 s_add_u32 s59,s59,128
 s_and_b32 s59,s59,2047
 ds_read_b64_tr_b16 a[130:131],v16 offset:17408
 v_mfma_f32_16x16x32_bf16 v[196:199],a[164:167],a[212:215],v[196:199]
 buffer_load_dwordx4 v116,s[4:7],s59 offen offset:0 lds
 v_mfma_f32_16x16x32_bf16 v[196:199],a[160:163],a[196:199],v[196:199]
 ds_read_b64_tr_b16 a[132:133],v16 offset:24576
 v_mfma_f32_16x16x32_bf16 v[200:203],a[160:163],a[200:203],v[200:203]
 ds_read_b64_tr_b16 a[134:135],v16 offset:25600
 v_mfma_f32_16x16x32_bf16 v[200:203],a[164:167],a[216:219],v[200:203]
 v_mfma_f32_16x16x32_bf16 v[204:207],a[164:167],a[220:223],v[204:207]
 ds_read_b64_tr_b16 a[136:137],v16 offset:16392
 buffer_load_dwordx4 v117,s[4:7],s59 offen offset:1024 lds
 v_mfma_f32_16x16x32_bf16 v[204:207],a[160:163],a[204:207],v[204:207]
 ds_read_b64_tr_b16 a[138:139],v16 offset:17416
 v_mfma_f32_16x16x32_bf16 v[220:223],a[168:171],a[204:207],v[220:223]
 v_mfma_f32_16x16x32_bf16 v[220:223],a[172:175],a[220:223],v[220:223]
 ds_read_b64_tr_b16 a[140:141],v16 offset:24584
 v_mfma_f32_16x16x32_bf16 v[216:219],a[172:175],a[216:219],v[216:219]
 ds_read_b64_tr_b16 a[142:143],v16 offset:25608
 buffer_load_dwordx4 v118,s[4:7],s59 offen offset:2048 lds
 v_mfma_f32_16x16x32_bf16 v[216:219],a[168:171],a[200:203],v[216:219]
 v_mfma_f32_16x16x32_bf16 v[212:215],a[168:171],a[196:199],v[212:215]
 ds_read_b64_tr_b16 a[144:145],v17 offset:16384
 v_mfma_f32_16x16x32_bf16 v[212:215],a[172:175],a[212:215],v[212:215]
 ds_read_b64_tr_b16 a[146:147],v17 offset:17408
 s_waitcnt vmcnt(16)
 v_mfma_f32_16x16x32_bf16 v[208:211],a[172:175],a[208:211],v[208:211]
 ds_read_b128 a[232:235],v112 offset:36864
 buffer_load_dwordx4 v119,s[4:7],s59 offen offset:3072 lds
 v_mfma_f32_16x16x32_bf16 v[208:211],a[168:171],a[192:195],v[208:211]
 ds_read_b64_tr_b16 a[148:149],v17 offset:24576
 v_mfma_f32_16x16x32_bf16 v[224:227],a[176:179],a[192:195],v[224:227]
 ds_read_b64_tr_b16 a[150:151],v17 offset:25600
 v_mfma_f32_16x16x32_bf16 v[224:227],a[180:183],a[208:211],v[224:227]
 s_add_u32 m0,s3,114688
 ds_read_b128 a[248:251],v113 offset:36864
 v_mfma_f32_16x16x32_bf16 v[228:231],a[180:183],a[212:215],v[228:231]
 s_add_u32 s41,s41,524288
 s_and_b32 s41,s41,8388607
 ds_read_b64_tr_b16 a[152:153],v17 offset:16392
 v_mfma_f32_16x16x32_bf16 v[228:231],a[176:179],a[196:199],v[228:231]
 ds_read_b64_tr_b16 a[154:155],v17 offset:17416
 buffer_load_dwordx4 v32,s[8:11],s41 offen offset:0 lds
 v_mfma_f32_16x16x32_bf16 v[232:235],a[176:179],a[200:203],v[232:235]
 ds_read_b128 a[236:239],v112 offset:38912
 v_mfma_f32_16x16x32_bf16 v[232:235],a[180:183],a[216:219],v[232:235]
 ds_read_b64_tr_b16 a[156:157],v17 offset:24584
 v_mfma_f32_16x16x32_bf16 v[236:239],a[180:183],a[220:223],v[236:239]
 ds_read_b64_tr_b16 a[158:159],v17 offset:25608
 v_mfma_f32_16x16x32_bf16 v[236:239],a[176:179],a[204:207],v[236:239]
 ds_read_b128 a[252:255],v113 offset:38912
 buffer_load_dwordx4 v33,s[8:11],s41 offen offset:1024 lds
 v_mfma_f32_16x16x32_bf16 v[252:255],a[184:187],a[204:207],v[252:255]
 v_mfma_f32_16x16x32_bf16 v[252:255],a[188:191],a[220:223],v[252:255]
 v_mfma_f32_16x16x32_bf16 v[248:251],a[188:191],a[216:219],v[248:251]
 v_mfma_f32_16x16x32_bf16 v[248:251],a[184:187],a[200:203],v[248:251]
 buffer_load_dwordx4 v34,s[8:11],s41 offen offset:2048 lds
 v_mfma_f32_16x16x32_bf16 v[244:247],a[184:187],a[196:199],v[244:247]
 s_and_b32 s50,s2,63
 s_lshl_b32 s50,s50,2
 v_mfma_f32_16x16x32_bf16 v[244:247],a[188:191],a[212:215],v[244:247]
 v_mfma_f32_16x16x32_bf16 v[240:243],a[188:191],a[208:211],v[240:243]
 buffer_atomic_add v55,v95,s[72:75],s50 offen sc1
 v_mfma_f32_16x16x32_bf16 v[240:243],a[184:187],a[192:195],v[240:243]
 s_waitcnt lgkmcnt(0)
 v_mfma_f32_16x16x32_bf16 v[128:131],a[128:131],a[224:227],v[128:131]
 ds_read_b64_tr_b16 a[160:161],v18 offset:16384
 v_mfma_f32_16x16x32_bf16 v[128:131],a[132:135],a[240:243],v[128:131]
 ds_read_b64_tr_b16 a[162:163],v18 offset:17408
 v_mfma_f32_16x16x32_bf16 v[132:135],a[132:135],a[244:247],v[132:135]
 buffer_load_dwordx4 v35,s[8:11],s41 offen offset:3072 lds
 v_mfma_f32_16x16x32_bf16 v[132:135],a[128:131],a[228:231],v[132:135]
 ds_read_b64_tr_b16 a[164:165],v18 offset:24576
 v_mfma_f32_16x16x32_bf16 v[136:139],a[128:131],a[232:235],v[136:139]
 s_add_u32 m0,s58,135168
 ds_read_b64_tr_b16 a[166:167],v18 offset:25600
 v_mfma_f32_16x16x32_bf16 v[136:139],a[132:135],a[248:251],v[136:139]
 s_add_u32 s40,s59,65536
 v_mfma_f32_16x16x32_bf16 v[140:143],a[132:135],a[252:255],v[140:143]
 ds_read_b64_tr_b16 a[168:169],v18 offset:16392
 buffer_load_dwordx4 v116,s[4:7],s40 offen offset:0 lds
 v_mfma_f32_16x16x32_bf16 v[140:143],a[128:131],a[236:239],v[140:143]
 ds_read_b64_tr_b16 a[170:171],v18 offset:17416
 v_mfma_f32_16x16x32_bf16 v[156:159],a[136:139],a[236:239],v[156:159]
 v_mfma_f32_16x16x32_bf16 v[156:159],a[140:143],a[252:255],v[156:159]
 ds_read_b64_tr_b16 a[172:173],v18 offset:24584
 v_mfma_f32_16x16x32_bf16 v[152:155],a[140:143],a[248:251],v[152:155]
 ds_read_b64_tr_b16 a[174:175],v18 offset:25608
 buffer_load_dwordx4 v117,s[4:7],s40 offen offset:1024 lds
 v_mfma_f32_16x16x32_bf16 v[152:155],a[136:139],a[232:235],v[152:155]
 v_mfma_f32_16x16x32_bf16 v[148:151],a[136:139],a[228:231],v[148:151]
 ds_read_b64_tr_b16 a[176:177],v19 offset:16384
 v_mfma_f32_16x16x32_bf16 v[148:151],a[140:143],a[244:247],v[148:151]
 ds_read_b64_tr_b16 a[178:179],v19 offset:17408
 s_waitcnt vmcnt(20)
 v_mfma_f32_16x16x32_bf16 v[144:147],a[140:143],a[240:243],v[144:147]
 ds_read_b128 a[192:195],v112 offset:0
 buffer_load_dwordx4 v118,s[4:7],s40 offen offset:2048 lds
 v_mfma_f32_16x16x32_bf16 v[144:147],a[136:139],a[224:227],v[144:147]
 ds_read_b64_tr_b16 a[180:181],v19 offset:24576
 v_mfma_f32_16x16x32_bf16 v[160:163],a[144:147],a[224:227],v[160:163]
 ds_read_b64_tr_b16 a[182:183],v19 offset:25600
 v_mfma_f32_16x16x32_bf16 v[160:163],a[148:151],a[240:243],v[160:163]
 ds_read_b128 a[208:211],v113 offset:0
 v_mfma_f32_16x16x32_bf16 v[164:167],a[148:151],a[244:247],v[164:167]
 ds_read_b64_tr_b16 a[184:185],v19 offset:16392
 v_mfma_f32_16x16x32_bf16 v[164:167],a[144:147],a[228:231],v[164:167]
 ds_read_b64_tr_b16 a[186:187],v19 offset:17416
 buffer_load_dwordx4 v119,s[4:7],s40 offen offset:3072 lds
 v_mfma_f32_16x16x32_bf16 v[168:171],a[144:147],a[232:235],v[168:171]
 ds_read_b128 a[196:199],v112 offset:2048
 v_mfma_f32_16x16x32_bf16 v[168:171],a[148:151],a[248:251],v[168:171]
 s_add_u32 m0,s58,32768
 ds_read_b64_tr_b16 a[188:189],v19 offset:24584
 v_mfma_f32_16x16x32_bf16 v[172:175],a[148:151],a[252:255],v[172:175]
 s_add_u32 s59,s59,128
 s_and_b32 s59,s59,2047
 ds_read_b64_tr_b16 a[190:191],v19 offset:25608
 v_mfma_f32_16x16x32_bf16 v[172:175],a[144:147],a[236:239],v[172:175]
 ds_read_b128 a[212:215],v113 offset:2048
 buffer_load_dwordx4 v116,s[4:7],s59 offen offset:0 lds
 v_mfma_f32_16x16x32_bf16 v[188:191],a[152:155],a[236:239],v[188:191]
 v_mfma_f32_16x16x32_bf16 v[188:191],a[156:159],a[252:255],v[188:191]
 v_mfma_f32_16x16x32_bf16 v[184:187],a[156:159],a[248:251],v[184:187]
 v_mfma_f32_16x16x32_bf16 v[184:187],a[152:155],a[232:235],v[184:187]
 buffer_load_dwordx4 v117,s[4:7],s59 offen offset:1024 lds
 v_mfma_f32_16x16x32_bf16 v[180:183],a[152:155],a[228:231],v[180:183]
 v_mfma_f32_16x16x32_bf16 v[180:183],a[156:159],a[244:247],v[180:183]
 v_mfma_f32_16x16x32_bf16 v[176:179],a[156:159],a[240:243],v[176:179]
 v_mfma_f32_16x16x32_bf16 v[176:179],a[152:155],a[224:227],v[176:179]
 s_waitcnt vmcnt(20) lgkmcnt(0)
 s_barrier
 v_mfma_f32_16x16x32_bf16 v[192:195],a[160:163],a[224:227],v[192:195]
 ds_read_b64_tr_b16 a[128:129],v16 offset:32768
 v_mfma_f32_16x16x32_bf16 v[192:195],a[164:167],a[240:243],v[192:195]
 ds_read_b64_tr_b16 a[130:131],v16 offset:33792
 v_mfma_f32_16x16x32_bf16 v[196:199],a[164:167],a[244:247],v[196:199]
 buffer_load_dwordx4 v118,s[4:7],s59 offen offset:2048 lds
 v_mfma_f32_16x16x32_bf16 v[196:199],a[160:163],a[228:231],v[196:199]
 ds_read_b64_tr_b16 a[132:133],v16 offset:40960
 v_mfma_f32_16x16x32_bf16 v[200:203],a[160:163],a[232:235],v[200:203]
 ds_read_b64_tr_b16 a[134:135],v16 offset:41984
 v_mfma_f32_16x16x32_bf16 v[200:203],a[164:167],a[248:251],v[200:203]
 v_mfma_f32_16x16x32_bf16 v[204:207],a[164:167],a[252:255],v[204:207]
 ds_read_b64_tr_b16 a[136:137],v16 offset:32776
 buffer_load_dwordx4 v119,s[4:7],s59 offen offset:3072 lds
 v_mfma_f32_16x16x32_bf16 v[204:207],a[160:163],a[236:239],v[204:207]
 ds_read_b64_tr_b16 a[138:139],v16 offset:33800
 v_mfma_f32_16x16x32_bf16 v[220:223],a[168:171],a[236:239],v[220:223]
 s_add_u32 m0,s3,65536
 v_mfma_f32_16x16x32_bf16 v[220:223],a[172:175],a[252:255],v[220:223]
 s_add_u32 s41,s41,524288
 s_and_b32 s41,s41,8388607
 ds_read_b64_tr_b16 a[140:141],v16 offset:40968
 v_mfma_f32_16x16x32_bf16 v[216:219],a[172:175],a[248:251],v[216:219]
 ds_read_b64_tr_b16 a[142:143],v16 offset:41992
 buffer_load_dwordx4 v32,s[8:11],s41 offen offset:0 lds
 v_mfma_f32_16x16x32_bf16 v[216:219],a[168:171],a[232:235],v[216:219]
 v_mfma_f32_16x16x32_bf16 v[212:215],a[168:171],a[228:231],v[212:215]
 ds_read_b64_tr_b16 a[144:145],v17 offset:32768
 v_mfma_f32_16x16x32_bf16 v[212:215],a[172:175],a[244:247],v[212:215]
 ds_read_b64_tr_b16 a[146:147],v17 offset:33792
 s_waitcnt vmcnt(19)
 v_mfma_f32_16x16x32_bf16 v[208:211],a[172:175],a[240:243],v[208:211]
 ds_read_b128 a[200:203],v112 offset:4096
 buffer_load_dwordx4 v33,s[8:11],s41 offen offset:1024 lds
 v_mfma_f32_16x16x32_bf16 v[208:211],a[168:171],a[224:227],v[208:211]
 ds_read_b64_tr_b16 a[148:149],v17 offset:40960
 v_mfma_f32_16x16x32_bf16 v[224:227],a[176:179],a[224:227],v[224:227]
 ds_read_b64_tr_b16 a[150:151],v17 offset:41984
 v_mfma_f32_16x16x32_bf16 v[224:227],a[180:183],a[240:243],v[224:227]
 ds_read_b128 a[216:219],v113 offset:4096
 v_mfma_f32_16x16x32_bf16 v[228:231],a[180:183],a[244:247],v[228:231]
 ds_read_b64_tr_b16 a[152:153],v17 offset:32776
 v_mfma_f32_16x16x32_bf16 v[228:231],a[176:179],a[228:231],v[228:231]
 ds_read_b64_tr_b16 a[154:155],v17 offset:33800
 buffer_load_dwordx4 v34,s[8:11],s41 offen offset:2048 lds
 v_mfma_f32_16x16x32_bf16 v[232:235],a[176:179],a[232:235],v[232:235]
 ds_read_b128 a[204:207],v112 offset:6144
 v_mfma_f32_16x16x32_bf16 v[232:235],a[180:183],a[248:251],v[232:235]
 ds_read_b64_tr_b16 a[156:157],v17 offset:40968
 v_mfma_f32_16x16x32_bf16 v[236:239],a[180:183],a[252:255],v[236:239]
 ds_read_b64_tr_b16 a[158:159],v17 offset:41992
 v_mfma_f32_16x16x32_bf16 v[236:239],a[176:179],a[236:239],v[236:239]
 ds_read_b128 a[220:223],v113 offset:6144
 buffer_load_dwordx4 v35,s[8:11],s41 offen offset:3072 lds
 v_mfma_f32_16x16x32_bf16 v[252:255],a[184:187],a[236:239],v[252:255]
 v_mfma_f32_16x16x32_bf16 v[252:255],a[188:191],a[252:255],v[252:255]
 s_add_u32 m0,s58,36864
 v_mfma_f32_16x16x32_bf16 v[248:251],a[188:191],a[248:251],v[248:251]
 s_add_u32 s40,s59,65536
 v_mfma_f32_16x16x32_bf16 v[248:251],a[184:187],a[232:235],v[248:251]
 buffer_load_dwordx4 v116,s[4:7],s40 offen offset:0 lds
 v_mfma_f32_16x16x32_bf16 v[244:247],a[184:187],a[228:231],v[244:247]
 v_mfma_f32_16x16x32_bf16 v[244:247],a[188:191],a[244:247],v[244:247]
 v_mfma_f32_16x16x32_bf16 v[240:243],a[188:191],a[240:243],v[240:243]
 v_mfma_f32_16x16x32_bf16 v[240:243],a[184:187],a[224:227],v[240:243]
 s_waitcnt lgkmcnt(0)
 v_mfma_f32_16x16x32_bf16 v[128:131],a[128:131],a[192:195],v[128:131]
 ds_read_b64_tr_b16 a[160:161],v18 offset:32768
 v_mfma_f32_16x16x32_bf16 v[128:131],a[132:135],a[208:211],v[128:131]
 ds_read_b64_tr_b16 a[162:163],v18 offset:33792
 v_mfma_f32_16x16x32_bf16 v[132:135],a[132:135],a[212:215],v[132:135]
 buffer_load_dwordx4 v117,s[4:7],s40 offen offset:1024 lds
 v_mfma_f32_16x16x32_bf16 v[132:135],a[128:131],a[196:199],v[132:135]
 ds_read_b64_tr_b16 a[164:165],v18 offset:40960
 v_mfma_f32_16x16x32_bf16 v[136:139],a[128:131],a[200:203],v[136:139]
 ds_read_b64_tr_b16 a[166:167],v18 offset:41984
 v_mfma_f32_16x16x32_bf16 v[136:139],a[132:135],a[216:219],v[136:139]
 v_mfma_f32_16x16x32_bf16 v[140:143],a[132:135],a[220:223],v[140:143]
 ds_read_b64_tr_b16 a[168:169],v18 offset:32776
 buffer_load_dwordx4 v118,s[4:7],s40 offen offset:2048 lds
 v_mfma_f32_16x16x32_bf16 v[140:143],a[128:131],a[204:207],v[140:143]
 ds_read_b64_tr_b16 a[170:171],v18 offset:33800
 v_mfma_f32_16x16x32_bf16 v[156:159],a[136:139],a[204:207],v[156:159]
 v_mfma_f32_16x16x32_bf16 v[156:159],a[140:143],a[220:223],v[156:159]
 ds_read_b64_tr_b16 a[172:173],v18 offset:40968
 v_mfma_f32_16x16x32_bf16 v[152:155],a[140:143],a[216:219],v[152:155]
 ds_read_b64_tr_b16 a[174:175],v18 offset:41992
 buffer_load_dwordx4 v119,s[4:7],s40 offen offset:3072 lds
 v_mfma_f32_16x16x32_bf16 v[152:155],a[136:139],a[200:203],v[152:155]
 v_mfma_f32_16x16x32_bf16 v[148:151],a[136:139],a[196:199],v[148:151]
 s_add_u32 m0,s58,0
 ds_read_b64_tr_b16 a[176:177],v19 offset:32768
 v_mfma_f32_16x16x32_bf16 v[148:151],a[140:143],a[212:215],v[148:151]
 s_add_u32 s59,s59,128
 s_and_b32 s59,s59,2047
 ds_read_b64_tr_b16 a[178:179],v19 offset:33792
 s_waitcnt vmcnt(21)
 v_mfma_f32_16x16x32_bf16 v[144:147],a[140:143],a[208:211],v[144:147]
 ds_read_b128 a[224:227],v114 offset:0
 buffer_load_dwordx4 v116,s[4:7],s59 offen offset:0 lds
 v_mfma_f32_16x16x32_bf16 v[144:147],a[136:139],a[192:195],v[144:147]
 ds_read_b64_tr_b16 a[180:181],v19 offset:40960
 v_mfma_f32_16x16x32_bf16 v[160:163],a[144:147],a[192:195],v[160:163]
 ds_read_b64_tr_b16 a[182:183],v19 offset:41984
 v_mfma_f32_16x16x32_bf16 v[160:163],a[148:151],a[208:211],v[160:163]
 ds_read_b128 a[240:243],v115 offset:0
 v_mfma_f32_16x16x32_bf16 v[164:167],a[148:151],a[212:215],v[164:167]
 ds_read_b64_tr_b16 a[184:185],v19 offset:32776
 v_mfma_f32_16x16x32_bf16 v[164:167],a[144:147],a[196:199],v[164:167]
 ds_read_b64_tr_b16 a[186:187],v19 offset:33800
 buffer_load_dwordx4 v117,s[4:7],s59 offen offset:1024 lds
 v_mfma_f32_16x16x32_bf16 v[168:171],a[144:147],a[200:203],v[168:171]
 ds_read_b128 a[228:231],v114 offset:2048
 v_mfma_f32_16x16x32_bf16 v[168:171],a[148:151],a[216:219],v[168:171]
 ds_read_b64_tr_b16 a[188:189],v19 offset:40968
 v_mfma_f32_16x16x32_bf16 v[172:175],a[148:151],a[220:223],v[172:175]
 ds_read_b64_tr_b16 a[190:191],v19 offset:41992
 v_mfma_f32_16x16x32_bf16 v[172:175],a[144:147],a[204:207],v[172:175]
 ds_read_b128 a[244:247],v115 offset:2048
 buffer_load_dwordx4 v118,s[4:7],s59 offen offset:2048 lds
 v_mfma_f32_16x16x32_bf16 v[188:191],a[152:155],a[204:207],v[188:191]
 v_mfma_f32_16x16x32_bf16 v[188:191],a[156:159],a[220:223],v[188:191]
 v_mfma_f32_16x16x32_bf16 v[184:187],a[156:159],a[216:219],v[184:187]
 v_mfma_f32_16x16x32_bf16 v[184:187],a[152:155],a[200:203],v[184:187]
 buffer_load_dwordx4 v119,s[4:7],s59 offen offset:3072 lds
 v_mfma_f32_16x16x32_bf16 v[180:183],a[152:155],a[196:199],v[180:183]
 v_mfma_f32_16x16x32_bf16 v[180:183],a[156:159],a[212:215],v[180:183]
 v_mfma_f32_16x16x32_bf16 v[176:179],a[156:159],a[208:211],v[176:179]
 v_mfma_f32_16x16x32_bf16 v[176:179],a[152:155],a[192:195],v[176:179]
 s_waitcnt vmcnt(20) lgkmcnt(0)
 s_barrier
 v_mfma_f32_16x16x32_bf16 v[192:195],a[160:163],a[192:195],v[192:195]
 s_add_u32 m0,s3,81920
 ds_read_b64_tr_b16 a[128:129],v16 offset:49152
 v_mfma_f32_16x16x32_bf16 v[192:195],a[164:167],a[208:211],v[192:195]
 s_add_u32 s41,s41,524288
 s_and_b32 s41,s41,8388607
 ds_read_b64_tr_b16 a[130:131],v16 offset:50176
 v_mfma_f32_16x16x32_bf16 v[196:199],a[164:167],a[212:215],v[196:199]
 buffer_load_dwordx4 v32,s[8:11],s41 offen offset:0 lds
 v_mfma_f32_16x16x32_bf16 v[196:199],a[160:163],a[196:199],v[196:199]
 ds_read_b64_tr_b16 a[132:133],v16 offset:57344
 v_mfma_f32_16x16x32_bf16 v[200:203],a[160:163],a[200:203],v[200:203]
 ds_read_b64_tr_b16 a[134:135],v16 offset:58368
 v_mfma_f32_16x16x32_bf16 v[200:203],a[164:167],a[216:219],v[200:203]
 v_mfma_f32_16x16x32_bf16 v[204:207],a[164:167],a[220:223],v[204:207]
 ds_read_b64_tr_b16 a[136:137],v16 offset:49160
 buffer_load_dwordx4 v33,s[8:11],s41 offen offset:1024 lds
 v_mfma_f32_16x16x32_bf16 v[204:207],a[160:163],a[204:207],v[204:207]
 ds_read_b64_tr_b16 a[138:139],v16 offset:50184
 v_mfma_f32_16x16x32_bf16 v[220:223],a[168:171],a[204:207],v[220:223]
 v_mfma_f32_16x16x32_bf16 v[220:223],a[172:175],a[220:223],v[220:223]
 ds_read_b64_tr_b16 a[140:141],v16 offset:57352
 v_mfma_f32_16x16x32_bf16 v[216:219],a[172:175],a[216:219],v[216:219]
 ds_read_b64_tr_b16 a[142:143],v16 offset:58376
 buffer_load_dwordx4 v34,s[8:11],s41 offen offset:2048 lds
 v_mfma_f32_16x16x32_bf16 v[216:219],a[168:171],a[200:203],v[216:219]
 v_mfma_f32_16x16x32_bf16 v[212:215],a[168:171],a[196:199],v[212:215]
 ds_read_b64_tr_b16 a[144:145],v17 offset:49152
 v_mfma_f32_16x16x32_bf16 v[212:215],a[172:175],a[212:215],v[212:215]
 ds_read_b64_tr_b16 a[146:147],v17 offset:50176
 s_waitcnt vmcnt(19)
 v_mfma_f32_16x16x32_bf16 v[208:211],a[172:175],a[208:211],v[208:211]
 ds_read_b128 a[232:235],v114 offset:4096
 buffer_load_dwordx4 v35,s[8:11],s41 offen offset:3072 lds
 v_mfma_f32_16x16x32_bf16 v[208:211],a[168:171],a[192:195],v[208:211]
 ds_read_b64_tr_b16 a[148:149],v17 offset:57344
 v_mfma_f32_16x16x32_bf16 v[224:227],a[176:179],a[192:195],v[224:227]
 ds_read_b64_tr_b16 a[150:151],v17 offset:58368
 v_mfma_f32_16x16x32_bf16 v[224:227],a[180:183],a[208:211],v[224:227]
 s_add_u32 m0,s58,4096
 ds_read_b128 a[248:251],v115 offset:4096
 v_mfma_f32_16x16x32_bf16 v[228:231],a[180:183],a[212:215],v[228:231]
 s_add_u32 s40,s59,65536
 ds_read_b64_tr_b16 a[152:153],v17 offset:49160
 v_mfma_f32_16x16x32_bf16 v[228:231],a[176:179],a[196:199],v[228:231]
 ds_read_b64_tr_b16 a[154:155],v17 offset:50184
 buffer_load_dwordx4 v116,s[4:7],s40 offen offset:0 lds
 v_mfma_f32_16x16x32_bf16 v[232:235],a[176:179],a[200:203],v[232:235]
 ds_read_b128 a[236:239],v114 offset:6144
 v_mfma_f32_16x16x32_bf16 v[232:235],a[180:183],a[216:219],v[232:235]
 ds_read_b64_tr_b16 a[156:157],v17 offset:57352
 v_mfma_f32_16x16x32_bf16 v[236:239],a[180:183],a[220:223],v[236:239]
 ds_read_b64_tr_b16 a[158:159],v17 offset:58376
 v_mfma_f32_16x16x32_bf16 v[236:239],a[176:179],a[204:207],v[236:239]
 ds_read_b128 a[252:255],v115 offset:6144
 buffer_load_dwordx4 v117,s[4:7],s40 offen offset:1024 lds
 v_mfma_f32_16x16x32_bf16 v[252:255],a[184:187],a[204:207],v[252:255]
 v_mfma_f32_16x16x32_bf16 v[252:255],a[188:191],a[220:223],v[252:255]
 v_mfma_f32_16x16x32_bf16 v[248:251],a[188:191],a[216:219],v[248:251]
 v_mfma_f32_16x16x32_bf16 v[248:251],a[184:187],a[200:203],v[248:251]
 buffer_load_dwordx4 v118,s[4:7],s40 offen offset:2048 lds
 v_mfma_f32_16x16x32_bf16 v[244:247],a[184:187],a[196:199],v[244:247]
 v_mfma_f32_16x16x32_bf16 v[244:247],a[188:191],a[212:215],v[244:247]
 v_mfma_f32_16x16x32_bf16 v[240:243],a[188:191],a[208:211],v[240:243]
 v_mfma_f32_16x16x32_bf16 v[240:243],a[184:187],a[192:195],v[240:243]
 s_waitcnt lgkmcnt(0)
 v_mfma_f32_16x16x32_bf16 v[128:131],a[128:131],a[224:227],v[128:131]
 ds_read_b64_tr_b16 a[160:161],v18 offset:49152
 v_mfma_f32_16x16x32_bf16 v[128:131],a[132:135],a[240:243],v[128:131]
 ds_read_b64_tr_b16 a[162:163],v18 offset:50176
 v_mfma_f32_16x16x32_bf16 v[132:135],a[132:135],a[244:247],v[132:135]
 buffer_load_dwordx4 v119,s[4:7],s40 offen offset:3072 lds
 v_mfma_f32_16x16x32_bf16 v[132:135],a[128:131],a[228:231],v[132:135]
 ds_read_b64_tr_b16 a[164:165],v18 offset:57344
 v_mfma_f32_16x16x32_bf16 v[136:139],a[128:131],a[232:235],v[136:139]
 s_add_u32 m0,s58,131072
 ds_read_b64_tr_b16 a[166:167],v18 offset:58368
 v_mfma_f32_16x16x32_bf16 v[136:139],a[132:135],a[248:251],v[136:139]
 s_add_u32 s59,s59,128
 s_and_b32 s59,s59,2047
 v_mfma_f32_16x16x32_bf16 v[140:143],a[132:135],a[252:255],v[140:143]
 ds_read_b64_tr_b16 a[168:169],v18 offset:49160
 buffer_load_dwordx4 v116,s[4:7],s59 offen offset:0 lds
 v_mfma_f32_16x16x32_bf16 v[140:143],a[128:131],a[236:239],v[140:143]
 ds_read_b64_tr_b16 a[170:171],v18 offset:50184
 v_mfma_f32_16x16x32_bf16 v[156:159],a[136:139],a[236:239],v[156:159]
 v_mfma_f32_16x16x32_bf16 v[156:159],a[140:143],a[252:255],v[156:159]
 ds_read_b64_tr_b16 a[172:173],v18 offset:57352
 v_mfma_f32_16x16x32_bf16 v[152:155],a[140:143],a[248:251],v[152:155]
 ds_read_b64_tr_b16 a[174:175],v18 offset:58376
 buffer_load_dwordx4 v117,s[4:7],s59 offen offset:1024 lds
 v_mfma_f32_16x16x32_bf16 v[152:155],a[136:139],a[232:235],v[152:155]
 v_mfma_f32_16x16x32_bf16 v[148:151],a[136:139],a[228:231],v[148:151]
 ds_read_b64_tr_b16 a[176:177],v19 offset:49152
 v_mfma_f32_16x16x32_bf16 v[148:151],a[140:143],a[244:247],v[148:151]
 ds_read_b64_tr_b16 a[178:179],v19 offset:50176
 s_waitcnt vmcnt(22)
 v_mfma_f32_16x16x32_bf16 v[144:147],a[140:143],a[240:243],v[144:147]
 ds_read_b128 a[192:195],v112 offset:32768
 buffer_load_dwordx4 v118,s[4:7],s59 offen offset:2048 lds
 v_mfma_f32_16x16x32_bf16 v[144:147],a[136:139],a[224:227],v[144:147]
 ds_read_b64_tr_b16 a[180:181],v19 offset:57344
 v_mfma_f32_16x16x32_bf16 v[160:163],a[144:147],a[224:227],v[160:163]
 ds_read_b64_tr_b16 a[182:183],v19 offset:58368
 v_mfma_f32_16x16x32_bf16 v[160:163],a[148:151],a[240:243],v[160:163]
 ds_read_b128 a[208:211],v113 offset:32768
 v_mfma_f32_16x16x32_bf16 v[164:167],a[148:151],a[244:247],v[164:167]
 ds_read_b64_tr_b16 a[184:185],v19 offset:49160
 v_mfma_f32_16x16x32_bf16 v[164:167],a[144:147],a[228:231],v[164:167]
 ds_read_b64_tr_b16 a[186:187],v19 offset:50184
 buffer_load_dwordx4 v119,s[4:7],s59 offen offset:3072 lds
 v_mfma_f32_16x16x32_bf16 v[168:171],a[144:147],a[232:235],v[168:171]
 ds_read_b128 a[196:199],v112 offset:34816
 v_mfma_f32_16x16x32_bf16 v[168:171],a[148:151],a[248:251],v[168:171]
 s_add_u32 m0,s3,98304
 ds_read_b64_tr_b16 a[188:189],v19 offset:57352
 v_mfma_f32_16x16x32_bf16 v[172:175],a[148:151],a[252:255],v[172:175]
 s_add_u32 s41,s41,524288
 s_and_b32 s41,s41,8388607
 ds_read_b64_tr_b16 a[190:191],v19 offset:58376
 v_mfma_f32_16x16x32_bf16 v[172:175],a[144:147],a[236:239],v[172:175]
 ds_read_b128 a[212:215],v113 offset:34816
 buffer_load_dwordx4 v32,s[8:11],s41 offen offset:0 lds
 v_mfma_f32_16x16x32_bf16 v[188:191],a[152:155],a[236:239],v[188:191]
 v_mfma_f32_16x16x32_bf16 v[188:191],a[156:159],a[252:255],v[188:191]
 v_mfma_f32_16x16x32_bf16 v[184:187],a[156:159],a[248:251],v[184:187]
 v_mfma_f32_16x16x32_bf16 v[184:187],a[152:155],a[232:235],v[184:187]
 buffer_load_dwordx4 v33,s[8:11],s41 offen offset:1024 lds
 v_mfma_f32_16x16x32_bf16 v[180:183],a[152:155],a[228:231],v[180:183]
 v_mfma_f32_16x16x32_bf16 v[180:183],a[156:159],a[244:247],v[180:183]
 v_mfma_f32_16x16x32_bf16 v[176:179],a[156:159],a[240:243],v[176:179]
 v_mfma_f32_16x16x32_bf16 v[176:179],a[152:155],a[224:227],v[176:179]
 s_waitcnt vmcnt(22) lgkmcnt(0)
 s_barrier
 v_mfma_f32_16x16x32_bf16 v[192:195],a[160:163],a[224:227],v[192:195]
 ds_read_b64_tr_b16 a[128:129],v16 offset:0
 v_mfma_f32_16x16x32_bf16 v[192:195],a[164:167],a[240:243],v[192:195]
 ds_read_b64_tr_b16 a[130:131],v16 offset:1024
 v_mfma_f32_16x16x32_bf16 v[196:199],a[164:167],a[244:247],v[196:199]
 buffer_load_dwordx4 v34,s[8:11],s41 offen offset:2048 lds
 v_mfma_f32_16x16x32_bf16 v[196:199],a[160:163],a[228:231],v[196:199]
 ds_read_b64_tr_b16 a[132:133],v16 offset:8192
 v_mfma_f32_16x16x32_bf16 v[200:203],a[160:163],a[232:235],v[200:203]
 ds_read_b64_tr_b16 a[134:135],v16 offset:9216
 v_mfma_f32_16x16x32_bf16 v[200:203],a[164:167],a[248:251],v[200:203]
 v_mfma_f32_16x16x32_bf16 v[204:207],a[164:167],a[252:255],v[204:207]
 ds_read_b64_tr_b16 a[136:137],v16 offset:8
 buffer_load_dwordx4 v35,s[8:11],s41 offen offset:3072 lds
 v_mfma_f32_16x16x32_bf16 v[204:207],a[160:163],a[236:239],v[204:207]
 ds_read_b64_tr_b16 a[138:139],v16 offset:1032
 v_mfma_f32_16x16x32_bf16 v[220:223],a[168:171],a[236:239],v[220:223]
 s_add_u32 m0,s58,135168
 v_mfma_f32_16x16x32_bf16 v[220:223],a[172:175],a[252:255],v[220:223]
 s_add_u32 s40,s59,65536
 ds_read_b64_tr_b16 a[140:141],v16 offset:8200
 v_mfma_f32_16x16x32_bf16 v[216:219],a[172:175],a[248:251],v[216:219]
 ds_read_b64_tr_b16 a[142:143],v16 offset:9224
 buffer_load_dwordx4 v116,s[4:7],s40 offen offset:0 lds
 v_mfma_f32_16x16x32_bf16 v[216:219],a[168:171],a[232:235],v[216:219]
 v_mfma_f32_16x16x32_bf16 v[212:215],a[168:171],a[228:231],v[212:215]
 ds_read_b64_tr_b16 a[144:145],v17 offset:0
 v_mfma_f32_16x16x32_bf16 v[212:215],a[172:175],a[244:247],v[212:215]
 ds_read_b64_tr_b16 a[146:147],v17 offset:1024
 s_waitcnt vmcnt(21)
 v_mfma_f32_16x16x32_bf16 v[208:211],a[172:175],a[240:243],v[208:211]
 ds_read_b128 a[200:203],v112 offset:36864
 buffer_load_dwordx4 v117,s[4:7],s40 offen offset:1024 lds
 v_mfma_f32_16x16x32_bf16 v[208:211],a[168:171],a[224:227],v[208:211]
 ds_read_b64_tr_b16 a[148:149],v17 offset:8192
 v_mfma_f32_16x16x32_bf16 v[224:227],a[176:179],a[224:227],v[224:227]
 ds_read_b64_tr_b16 a[150:151],v17 offset:9216
 v_mfma_f32_16x16x32_bf16 v[224:227],a[180:183],a[240:243],v[224:227]
 ds_read_b128 a[216:219],v113 offset:36864
 v_mfma_f32_16x16x32_bf16 v[228:231],a[180:183],a[244:247],v[228:231]
 ds_read_b64_tr_b16 a[152:153],v17 offset:8
 v_mfma_f32_16x16x32_bf16 v[228:231],a[176:179],a[228:231],v[228:231]
 ds_read_b64_tr_b16 a[154:155],v17 offset:1032
 buffer_load_dwordx4 v118,s[4:7],s40 offen offset:2048 lds
 v_mfma_f32_16x16x32_bf16 v[232:235],a[176:179],a[232:235],v[232:235]
 ds_read_b128 a[204:207],v112 offset:38912
 v_mfma_f32_16x16x32_bf16 v[232:235],a[180:183],a[248:251],v[232:235]
 ds_read_b64_tr_b16 a[156:157],v17 offset:8200
 v_mfma_f32_16x16x32_bf16 v[236:239],a[180:183],a[252:255],v[236:239]
 ds_read_b64_tr_b16 a[158:159],v17 offset:9224
 v_mfma_f32_16x16x32_bf16 v[236:239],a[176:179],a[236:239],v[236:239]
 ds_read_b128 a[220:223],v113 offset:38912
 buffer_load_dwordx4 v119,s[4:7],s40 offen offset:3072 lds
 v_mfma_f32_16x16x32_bf16 v[252:255],a[184:187],a[236:239],v[252:255]
 v_mfma_f32_16x16x32_bf16 v[252:255],a[188:191],a[252:255],v[252:255]
 s_add_u32 m0,s58,32768
 v_mfma_f32_16x16x32_bf16 v[248:251],a[188:191],a[248:251],v[248:251]
 s_add_u32 s59,s59,128
 s_and_b32 s59,s59,2047
 v_mfma_f32_16x16x32_bf16 v[248:251],a[184:187],a[232:235],v[248:251]
 buffer_load_dwordx4 v116,s[4:7],s59 offen offset:0 lds
 v_mfma_f32_16x16x32_bf16 v[244:247],a[184:187],a[228:231],v[244:247]
 v_mfma_f32_16x16x32_bf16 v[244:247],a[188:191],a[244:247],v[244:247]
L_stub_a_2:
 s_cbranch_execz L_stub_a_6
 v_mfma_f32_16x16x32_bf16 v[240:243],a[188:191],a[240:243],v[240:243]
 v_mfma_f32_16x16x32_bf16 v[240:243],a[184:187],a[224:227],v[240:243]
 s_waitcnt lgkmcnt(0)
 v_mfma_f32_16x16x32_bf16 v[128:131],a[128:131],a[192:195],v[128:131]
 ds_read_b64_tr_b16 a[160:161],v18 offset:0
 v_mfma_f32_16x16x32_bf16 v[128:131],a[132:135],a[208:211],v[128:131]
 ds_read_b64_tr_b16 a[162:163],v18 offset:1024
 v_mfma_f32_16x16x32_bf16 v[132:135],a[132:135],a[212:215],v[132:135]
 buffer_load_dwordx4 v117,s[4:7],s59 offen offset:1024 lds
 v_mfma_f32_16x16x32_bf16 v[132:135],a[128:131],a[196:199],v[132:135]
 ds_read_b64_tr_b16 a[164:165],v18 offset:8192
 v_mfma_f32_16x16x32_bf16 v[136:139],a[128:131],a[200:203],v[136:139]
 ds_read_b64_tr_b16 a[166:167],v18 offset:9216
 v_mfma_f32_16x16x32_bf16 v[136:139],a[132:135],a[216:219],v[136:139]
 v_mfma_f32_16x16x32_bf16 v[140:143],a[132:135],a[220:223],v[140:143]
 ds_read_b64_tr_b16 a[168:169],v18 offset:8
 buffer_load_dwordx4 v118,s[4:7],s59 offen offset:2048 lds
 v_mfma_f32_16x16x32_bf16 v[140:143],a[128:131],a[204:207],v[140:143]
 ds_read_b64_tr_b16 a[170:171],v18 offset:1032
 v_mfma_f32_16x16x32_bf16 v[156:159],a[136:139],a[204:207],v[156:159]
 v_mfma_f32_16x16x32_bf16 v[156:159],a[140:143],a[220:223],v[156:159]
 ds_read_b64_tr_b16 a[172:173],v18 offset:8200
 v_mfma_f32_16x16x32_bf16 v[152:155],a[140:143],a[216:219],v[152:155]
 ds_read_b64_tr_b16 a[174:175],v18 offset:9224
 buffer_load_dwordx4 v119,s[4:7],s59 offen offset:3072 lds
 v_mfma_f32_16x16x32_bf16 v[152:155],a[136:139],a[200:203],v[152:155]
 v_mfma_f32_16x16x32_bf16 v[148:151],a[136:139],a[196:199],v[148:151]
 s_add_u32 m0,s3,114688
 ds_read_b64_tr_b16 a[176:177],v19 offset:0
 v_mfma_f32_16x16x32_bf16 v[148:151],a[140:143],a[212:215],v[148:151]
 s_add_u32 s41,s41,524288
 s_and_b32 s41,s41,8388607
 ds_read_b64_tr_b16 a[178:179],v19 offset:1024
 s_waitcnt vmcnt(24)
 v_mfma_f32_16x16x32_bf16 v[144:147],a[140:143],a[208:211],v[144:147]
 ds_read_b128 a[224:227],v112 offset:0
 buffer_load_dwordx4 v32,s[8:11],s41 offen offset:0 lds
 v_mfma_f32_16x16x32_bf16 v[144:147],a[136:139],a[192:195],v[144:147]
 ds_read_b64_tr_b16 a[180:181],v19 offset:8192
 v_mfma_f32_16x16x32_bf16 v[160:163],a[144:147],a[192:195],v[160:163]
 ds_read_b64_tr_b16 a[182:183],v19 offset:9216
 v_mfma_f32_16x16x32_bf16 v[160:163],a[148:151],a[208:211],v[160:163]
 ds_read_b128 a[240:243],v113 offset:0
 v_mfma_f32_16x16x32_bf16 v[164:167],a[148:151],a[212:215],v[164:167]
 ds_read_b64_tr_b16 a[184:185],v19 offset:8
 v_mfma_f32_16x16x32_bf16 v[164:167],a[144:147],a[196:199],v[164:167]
 ds_read_b64_tr_b16 a[186:187],v19 offset:1032
 buffer_load_dwordx4 v33,s[8:11],s41 offen offset:1024 lds
 v_mfma_f32_16x16x32_bf16 v[168:171],a[144:147],a[200:203],v[168:171]
 ds_read_b128 a[228:231],v112 offset:2048
 v_mfma_f32_16x16x32_bf16 v[168:171],a[148:151],a[216:219],v[168:171]
 ds_read_b64_tr_b16 a[188:189],v19 offset:8200
 v_mfma_f32_16x16x32_bf16 v[172:175],a[148:151],a[220:223],v[172:175]
 ds_read_b64_tr_b16 a[190:191],v19 offset:9224
 v_mfma_f32_16x16x32_bf16 v[172:175],a[144:147],a[204:207],v[172:175]
 ds_read_b128 a[244:247],v113 offset:2048
 buffer_load_dwordx4 v34,s[8:11],s41 offen offset:2048 lds
 v_mfma_f32_16x16x32_bf16 v[188:191],a[152:155],a[204:207],v[188:191]
 v_mfma_f32_16x16x32_bf16 v[188:191],a[156:159],a[220:223],v[188:191]
 v_mfma_f32_16x16x32_bf16 v[184:187],a[156:159],a[216:219],v[184:187]
 v_mfma_f32_16x16x32_bf16 v[184:187],a[152:155],a[200:203],v[184:187]
 buffer_load_dwordx4 v35,s[8:11],s41 offen offset:3072 lds
 v_mfma_f32_16x16x32_bf16 v[180:183],a[152:155],a[196:199],v[180:183]
 v_mfma_f32_16x16x32_bf16 v[180:183],a[156:159],a[212:215],v[180:183]
 v_mfma_f32_16x16x32_bf16 v[176:179],a[156:159],a[208:211],v[176:179]
 buffer_load_dword v53,v54,s[72:75],0 offen sc1
 v_mfma_f32_16x16x32_bf16 v[176:179],a[152:155],a[192:195],v[176:179]
 s_waitcnt vmcnt(25) lgkmcnt(0)
 s_barrier
 v_mfma_f32_16x16x32_bf16 v[192:195],a[160:163],a[192:195],v[192:195]
 s_add_u32 m0,s58,36864
 ds_read_b64_tr_b16 a[128:129],v16 offset:16384
 v_mfma_f32_16x16x32_bf16 v[192:195],a[164:167],a[208:211],v[192:195]
 s_add_u32 s40,s59,65536
 ds_read_b64_tr_b16 a[130:131],v16 offset:17408
 v_mfma_f32_16x16x32_bf16 v[196:199],a[164:167],a[212:215],v[196:199]
 buffer_load_dwordx4 v116,s[4:7],s40 offen offset:0 lds
 v_mfma_f32_16x16x32_bf16 v[196:199],a[160:163],a[196:199],v[196:199]
 ds_read_b64_tr_b16 a[132:133],v16 offset:24576
 v_mfma_f32_16x16x32_bf16 v[200:203],a[160:163],a[200:203],v[200:203]
 ds_read_b64_tr_b16 a[134:135],v16 offset:25600
 v_mfma_f32_16x16x32_bf16 v[200:203],a[164:167],a[216:219],v[200:203]
 v_mfma_f32_16x16x32_bf16 v[204:207],a[164:167],a[220:223],v[204:207]
 ds_read_b64_tr_b16 a[136:137],v16 offset:16392
 buffer_load_dwordx4 v117,s[4:7],s40 offen offset:1024 lds
 v_mfma_f32_16x16x32_bf16 v[204:207],a[160:163],a[204:207],v[204:207]
 ds_read_b64_tr_b16 a[138:139],v16 offset:17416
 v_mfma_f32_16x16x32_bf16 v[220:223],a[168:171],a[204:207],v[220:223]
 v_mfma_f32_16x16x32_bf16 v[220:223],a[172:175],a[220:223],v[220:223]
 ds_read_b64_tr_b16 a[140:141],v16 offset:24584
 v_mfma_f32_16x16x32_bf16 v[216:219],a[172:175],a[216:219],v[216:219]
 ds_read_b64_tr_b16 a[142:143],v16 offset:25608
 buffer_load_dwordx4 v118,s[4:7],s40 offen offset:2048 lds
 v_mfma_f32_16x16x32_bf16 v[216:219],a[168:171],a[200:203],v[216:219]
 v_mfma_f32_16x16x32_bf16 v[212:215],a[168:171],a[196:199],v[212:215]
 ds_read_b64_tr_b16 a[144:145],v17 offset:16384
 v_mfma_f32_16x16x32_bf16 v[212:215],a[172:175],a[212:215],v[212:215]
 ds_read_b64_tr_b16 a[146:147],v17 offset:17408
 s_waitcnt vmcnt(24)
 v_mfma_f32_16x16x32_bf16 v[208:211],a[172:175],a[208:211],v[208:211]
 ds_read_b128 a[232:235],v112 offset:4096
 buffer_load_dwordx4 v119,s[4:7],s40 offen offset:3072 lds
 v_mfma_f32_16x16x32_bf16 v[208:211],a[168:171],a[192:195],v[208:211]
 ds_read_b64_tr_b16 a[148:149],v17 offset:24576
 v_mfma_f32_16x16x32_bf16 v[224:227],a[176:179],a[192:195],v[224:227]
 ds_read_b64_tr_b16 a[150:151],v17 offset:25600
 v_mfma_f32_16x16x32_bf16 v[224:227],a[180:183],a[208:211],v[224:227]
 s_add_u32 m0,s58,0
 ds_read_b128 a[248:251],v113 offset:4096
 v_mfma_f32_16x16x32_bf16 v[228:231],a[180:183],a[212:215],v[228:231]
 s_add_u32 s59,s59,128
 s_and_b32 s59,s59,2047
 ds_read_b64_tr_b16 a[152:153],v17 offset:16392
 v_mfma_f32_16x16x32_bf16 v[228:231],a[176:179],a[196:199],v[228:231]
 ds_read_b64_tr_b16 a[154:155],v17 offset:17416
 buffer_load_dwordx4 v116,s[4:7],s59 offen offset:0 lds
 v_mfma_f32_16x16x32_bf16 v[232:235],a[176:179],a[200:203],v[232:235]
 ds_read_b128 a[236:239],v112 offset:6144
 v_mfma_f32_16x16x32_bf16 v[232:235],a[180:183],a[216:219],v[232:235]
 ds_read_b64_tr_b16 a[156:157],v17 offset:24584
 v_mfma_f32_16x16x32_bf16 v[236:239],a[180:183],a[220:223],v[236:239]
 ds_read_b64_tr_b16 a[158:159],v17 offset:25608
 v_mfma_f32_16x16x32_bf16 v[236:239],a[176:179],a[204:207],v[236:239]
 ds_read_b128 a[252:255],v113 offset:6144
 buffer_load_dwordx4 v117,s[4:7],s59 offen offset:1024 lds
 v_mfma_f32_16x16x32_bf16 v[252:255],a[184:187],a[204:207],v[252:255]
 v_mfma_f32_16x16x32_bf16 v[252:255],a[188:191],a[220:223],v[252:255]
 v_mfma_f32_16x16x32_bf16 v[248:251],a[188:191],a[216:219],v[248:251]
 v_mfma_f32_16x16x32_bf16 v[248:251],a[184:187],a[200:203],v[248:251]
 buffer_load_dwordx4 v118,s[4:7],s59 offen offset:2048 lds
 v_mfma_f32_16x16x32_bf16 v[244:247],a[184:187],a[196:199],v[244:247]
 v_mfma_f32_16x16x32_bf16 v[244:247],a[188:191],a[212:215],v[244:247]
 v_mfma_f32_16x16x32_bf16 v[240:243],a[188:191],a[208:211],v[240:243]
 v_mfma_f32_16x16x32_bf16 v[240:243],a[184:187],a[192:195],v[240:243]
 s_waitcnt lgkmcnt(0)
 v_mfma_f32_16x16x32_bf16 v[128:131],a[128:131],a[224:227],v[128:131]
 ds_read_b64_tr_b16 a[160:161],v18 offset:16384
 v_mfma_f32_16x16x32_bf16 v[128:131],a[132:135],a[240:243],v[128:131]
 ds_read_b64_tr_b16 a[162:163],v18 offset:17408
 v_mfma_f32_16x16x32_bf16 v[132:135],a[132:135],a[244:247],v[132:135]
 buffer_load_dwordx4 v119,s[4:7],s59 offen offset:3072 lds
 v_mfma_f32_16x16x32_bf16 v[132:135],a[128:131],a[228:231],v[132:135]
 ds_read_b64_tr_b16 a[164:165],v18 offset:24576
 v_mfma_f32_16x16x32_bf16 v[136:139],a[128:131],a[232:235],v[136:139]
 s_add_u32 m0,s3,65536
 ds_read_b64_tr_b16 a[166:167],v18 offset:25600
 v_mfma_f32_16x16x32_bf16 v[136:139],a[132:135],a[248:251],v[136:139]
 s_add_u32 s41,s41,524288
 s_and_b32 s41,s41,8388607
 v_mfma_f32_16x16x32_bf16 v[140:143],a[132:135],a[252:255],v[140:143]
 ds_read_b64_tr_b16 a[168:169],v18 offset:16392
 buffer_load_dwordx4 v32,s[8:11],s41 offen offset:0 lds
 v_mfma_f32_16x16x32_bf16 v[140:143],a[128:131],a[236:239],v[140:143]
 ds_read_b64_tr_b16 a[170:171],v18 offset:17416
 v_mfma_f32_16x16x32_bf16 v[156:159],a[136:139],a[236:239],v[156:159]
 v_mfma_f32_16x16x32_bf16 v[156:159],a[140:143],a[252:255],v[156:159]
 ds_read_b64_tr_b16 a[172:173],v18 offset:24584
 v_mfma_f32_16x16x32_bf16 v[152:155],a[140:143],a[248:251],v[152:155]
 ds_read_b64_tr_b16 a[174:175],v18 offset:25608
 buffer_load_dwordx4 v33,s[8:11],s41 offen offset:1024 lds
 v_mfma_f32_16x16x32_bf16 v[152:155],a[136:139],a[232:235],v[152:155]
 v_mfma_f32_16x16x32_bf16 v[148:151],a[136:139],a[228:231],v[148:151]
 ds_read_b64_tr_b16 a[176:177],v19 offset:16384
 v_mfma_f32_16x16x32_bf16 v[148:151],a[140:143],a[244:247],v[148:151]
 ds_read_b64_tr_b16 a[178:179],v19 offset:17408
 s_waitcnt vmcnt(27)
 v_mfma_f32_16x16x32_bf16 v[144:147],a[140:143],a[240:243],v[144:147]
 ds_read_b128 a[192:195],v114 offset:0
 buffer_load_dwordx4 v34,s[8:11],s41 offen offset:2048 lds
 v_mfma_f32_16x16x32_bf16 v[144:147],a[136:139],a[224:227],v[144:147]
 ds_read_b64_tr_b16 a[180:181],v19 offset:24576
 v_mfma_f32_16x16x32_bf16 v[160:163],a[144:147],a[224:227],v[160:163]
 ds_read_b64_tr_b16 a[182:183],v19 offset:25600
 v_mfma_f32_16x16x32_bf16 v[160:163],a[148:151],a[240:243],v[160:163]
 ds_read_b128 a[208:211],v115 offset:0
 v_mfma_f32_16x16x32_bf16 v[164:167],a[148:151],a[244:247],v[164:167]
 ds_read_b64_tr_b16 a[184:185],v19 offset:16392
 v_mfma_f32_16x16x32_bf16 v[164:167],a[144:147],a[228:231],v[164:167]
 ds_read_b64_tr_b16 a[186:187],v19 offset:17416
 buffer_load_dwordx4 v35,s[8:11],s41 offen offset:3072 lds
 v_mfma_f32_16x16x32_bf16 v[168:171],a[144:147],a[232:235],v[168:171]
 ds_read_b128 a[196:199],v114 offset:2048
 v_mfma_f32_16x16x32_bf16 v[168:171],a[148:151],a[248:251],v[168:171]
 s_add_u32 m0,s58,4096
 ds_read_b64_tr_b16 a[188:189],v19 offset:24584
 v_mfma_f32_16x16x32_bf16 v[172:175],a[148:151],a[252:255],v[172:175]
 s_add_u32 s40,s59,65536
 ds_read_b64_tr_b16 a[190:191],v19 offset:25608
 v_mfma_f32_16x16x32_bf16 v[172:175],a[144:147],a[236:239],v[172:175]
 ds_read_b128 a[212:215],v115 offset:2048
 buffer_load_dwordx4 v116,s[4:7],s40 offen offset:0 lds
 v_mfma_f32_16x16x32_bf16 v[188:191],a[152:155],a[236:239],v[188:191]
 v_mfma_f32_16x16x32_bf16 v[188:191],a[156:159],a[252:255],v[188:191]
 v_mfma_f32_16x16x32_bf16 v[184:187],a[156:159],a[248:251],v[184:187]
 v_mfma_f32_16x16x32_bf16 v[184:187],a[152:155],a[232:235],v[184:187]
 buffer_load_dwordx4 v117,s[4:7],s40 offen offset:1024 lds
 v_mfma_f32_16x16x32_bf16 v[180:183],a[152:155],a[228:231],v[180:183]
 v_mfma_f32_16x16x32_bf16 v[180:183],a[156:159],a[244:247],v[180:183]
 v_mfma_f32_16x16x32_bf16 v[176:179],a[156:159],a[240:243],v[176:179]
 v_mfma_f32_16x16x32_bf16 v[176:179],a[152:155],a[224:227],v[176:179]
 s_waitcnt vmcnt(27) lgkmcnt(0)
 s_barrier
 v_mfma_f32_16x16x32_bf16 v[192:195],a[160:163],a[224:227],v[192:195]
 ds_read_b64_tr_b16 a[128:129],v16 offset:32768
 buffer_load_dword v59,v61,s[60:63],s77 offen
 v_mfma_f32_16x16x32_bf16 v[192:195],a[164:167],a[240:243],v[192:195]
 ds_read_b64_tr_b16 a[130:131],v16 offset:33792
 v_mfma_f32_16x16x32_bf16 v[196:199],a[164:167],a[244:247],v[196:199]
 buffer_load_dwordx4 v118,s[4:7],s40 offen offset:2048 lds
 v_mfma_f32_16x16x32_bf16 v[196:199],a[160:163],a[228:231],v[196:199]
 ds_read_b64_tr_b16 a[132:133],v16 offset:40960
 v_mfma_f32_16x16x32_bf16 v[200:203],a[160:163],a[232:235],v[200:203]
 ds_read_b64_tr_b16 a[134:135],v16 offset:41984
 v_mfma_f32_16x16x32_bf16 v[200:203],a[164:167],a[248:251],v[200:203]
 v_mfma_f32_16x16x32_bf16 v[204:207],a[164:167],a[252:255],v[204:207]
 ds_read_b64_tr_b16 a[136:137],v16 offset:32776
 buffer_load_dwordx4 v119,s[4:7],s40 offen offset:3072 lds
 v_mfma_f32_16x16x32_bf16 v[204:207],a[160:163],a[236:239],v[204:207]
 ds_read_b64_tr_b16 a[138:139],v16 offset:33800
 v_mfma_f32_16x16x32_bf16 v[220:223],a[168:171],a[236:239],v[220:223]
 s_add_u32 m0,s58,131072
 v_mfma_f32_16x16x32_bf16 v[220:223],a[172:175],a[252:255],v[220:223]
 s_add_u32 s59,s59,128
 s_and_b32 s59,s59,2047
 ds_read_b64_tr_b16 a[140:141],v16 offset:40968
 v_mfma_f32_16x16x32_bf16 v[216:219],a[172:175],a[248:251],v[216:219]
 ds_read_b64_tr_b16 a[142:143],v16 offset:41992
 buffer_load_dwordx4 v116,s[4:7],s59 offen offset:0 lds
 v_mfma_f32_16x16x32_bf16 v[216:219],a[168:171],a[232:235],v[216:219]
 v_mfma_f32_16x16x32_bf16 v[212:215],a[168:171],a[228:231],v[212:215]
 ds_read_b64_tr_b16 a[144:145],v17 offset:32768
 v_mfma_f32_16x16x32_bf16 v[212:215],a[172:175],a[244:247],v[212:215]
 ds_read_b64_tr_b16 a[146:147],v17 offset:33792
 s_waitcnt vmcnt(27)
 v_mfma_f32_16x16x32_bf16 v[208:211],a[172:175],a[240:243],v[208:211]
 ds_read_b128 a[200:203],v114 offset:4096
 buffer_load_dwordx4 v117,s[4:7],s59 offen offset:1024 lds
 v_mfma_f32_16x16x32_bf16 v[208:211],a[168:171],a[224:227],v[208:211]
 ds_read_b64_tr_b16 a[148:149],v17 offset:40960
 v_mfma_f32_16x16x32_bf16 v[224:227],a[176:179],a[224:227],v[224:227]
 ds_read_b64_tr_b16 a[150:151],v17 offset:41984
 v_mfma_f32_16x16x32_bf16 v[224:227],a[180:183],a[240:243],v[224:227]
 ds_read_b128 a[216:219],v115 offset:4096
 v_mfma_f32_16x16x32_bf16 v[228:231],a[180:183],a[244:247],v[228:231]
 ds_read_b64_tr_b16 a[152:153],v17 offset:32776
 v_mfma_f32_16x16x32_bf16 v[228:231],a[176:179],a[228:231],v[228:231]
 ds_read_b64_tr_b16 a[154:155],v17 offset:33800
 buffer_load_dwordx4 v118,s[4:7],s59 offen offset:2048 lds
 v_mfma_f32_16x16x32_bf16 v[232:235],a[176:179],a[232:235],v[232:235]
 ds_read_b128 a[204:207],v114 offset:6144
 v_mfma_f32_16x16x32_bf16 v[232:235],a[180:183],a[248:251],v[232:235]
 ds_read_b64_tr_b16 a[156:157],v17 offset:40968
 v_mfma_f32_16x16x32_bf16 v[236:239],a[180:183],a[252:255],v[236:239]
 ds_read_b64_tr_b16 a[158:159],v17 offset:41992
 v_mfma_f32_16x16x32_bf16 v[236:239],a[176:179],a[236:239],v[236:239]
 ds_read_b128 a[220:223],v115 offset:6144
 buffer_load_dwordx4 v119,s[4:7],s59 offen offset:3072 lds
 v_mfma_f32_16x16x32_bf16 v[252:255],a[184:187],a[236:239],v[252:255]
 v_mfma_f32_16x16x32_bf16 v[252:255],a[188:191],a[252:255],v[252:255]
 s_add_u32 m0,s3,81920
 v_mfma_f32_16x16x32_bf16 v[248:251],a[188:191],a[248:251],v[248:251]
 s_add_u32 s41,s41,524288
 s_and_b32 s41,s41,8388607
 v_mfma_f32_16x16x32_bf16 v[248:251],a[184:187],a[232:235],v[248:251]
 buffer_load_dwordx4 v32,s[8:11],s41 offen offset:0 lds
 v_mfma_f32_16x16x32_bf16 v[244:247],a[184:187],a[228:231],v[244:247]
 v_mfma_f32_16x16x32_bf16 v[244:247],a[188:191],a[244:247],v[244:247]
 v_mfma_f32_16x16x32_bf16 v[240:243],a[188:191],a[240:243],v[240:243]
 v_mfma_f32_16x16x32_bf16 v[240:243],a[184:187],a[224:227],v[240:243]
 s_waitcnt lgkmcnt(0)
 v_mfma_f32_16x16x32_bf16 v[128:131],a[128:131],a[192:195],v[128:131]
 ds_read_b64_tr_b16 a[160:161],v18 offset:32768
 v_mfma_f32_16x16x32_bf16 v[128:131],a[132:135],a[208:211],v[128:131]
 ds_read_b64_tr_b16 a[162:163],v18 offset:33792
 v_mfma_f32_16x16x32_bf16 v[132:135],a[132:135],a[212:215],v[132:135]
 buffer_load_dwordx4 v33,s[8:11],s41 offen offset:1024 lds
 v_mfma_f32_16x16x32_bf16 v[132:135],a[128:131],a[196:199],v[132:135]
 ds_read_b64_tr_b16 a[164:165],v18 offset:40960
 v_mfma_f32_16x16x32_bf16 v[136:139],a[128:131],a[200:203],v[136:139]
 ds_read_b64_tr_b16 a[166:167],v18 offset:41984
 v_mfma_f32_16x16x32_bf16 v[136:139],a[132:135],a[216:219],v[136:139]
 v_mfma_f32_16x16x32_bf16 v[140:143],a[132:135],a[220:223],v[140:143]
 ds_read_b64_tr_b16 a[168:169],v18 offset:32776
 buffer_load_dwordx4 v34,s[8:11],s41 offen offset:2048 lds
 v_mfma_f32_16x16x32_bf16 v[140:143],a[128:131],a[204:207],v[140:143]
 ds_read_b64_tr_b16 a[170:171],v18 offset:33800
 v_mfma_f32_16x16x32_bf16 v[156:159],a[136:139],a[204:207],v[156:159]
 v_mfma_f32_16x16x32_bf16 v[156:159],a[140:143],a[220:223],v[156:159]
 ds_read_b64_tr_b16 a[172:173],v18 offset:40968
 v_mfma_f32_16x16x32_bf16 v[152:155],a[140:143],a[216:219],v[152:155]
 ds_read_b64_tr_b16 a[174:175],v18 offset:41992
 buffer_load_dwordx4 v35,s[8:11],s41 offen offset:3072 lds
 v_mfma_f32_16x16x32_bf16 v[152:155],a[136:139],a[200:203],v[152:155]
 v_mfma_f32_16x16x32_bf16 v[148:151],a[136:139],a[196:199],v[148:151]
 s_add_u32 m0,s58,135168
 ds_read_b64_tr_b16 a[176:177],v19 offset:32768
 v_mfma_f32_16x16x32_bf16 v[148:151],a[140:143],a[212:215],v[148:151]
 s_add_u32 s40,s59,65536
 ds_read_b64_tr_b16 a[178:179],v19 offset:33792
 s_waitcnt vmcnt(30)
 v_mfma_f32_16x16x32_bf16 v[144:147],a[140:143],a[208:211],v[144:147]
 ds_read_b128 a[224:227],v112 offset:32768
 buffer_load_dwordx4 v116,s[4:7],s40 offen offset:0 lds
 v_mfma_f32_16x16x32_bf16 v[144:147],a[136:139],a[192:195],v[144:147]
 ds_read_b64_tr_b16 a[180:181],v19 offset:40960
 v_mfma_f32_16x16x32_bf16 v[160:163],a[144:147],a[192:195],v[160:163]
 ds_read_b64_tr_b16 a[182:183],v19 offset:41984
 v_mfma_f32_16x16x32_bf16 v[160:163],a[148:151],a[208:211],v[160:163]
 ds_read_b128 a[240:243],v113 offset:32768
 v_mfma_f32_16x16x32_bf16 v[164:167],a[148:151],a[212:215],v[164:167]
 ds_read_b64_tr_b16 a[184:185],v19 offset:32776
 v_mfma_f32_16x16x32_bf16 v[164:167],a[144:147],a[196:199],v[164:167]
 ds_read_b64_tr_b16 a[186:187],v19 offset:33800
 buffer_load_dwordx4 v117,s[4:7],s40 offen offset:1024 lds
 v_mfma_f32_16x16x32_bf16 v[168:171],a[144:147],a[200:203],v[168:171]
 ds_read_b128 a[228:231],v112 offset:34816
 v_mfma_f32_16x16x32_bf16 v[168:171],a[148:151],a[216:219],v[168:171]
 ds_read_b64_tr_b16 a[188:189],v19 offset:40968
 v_mfma_f32_16x16x32_bf16 v[172:175],a[148:151],a[220:223],v[172:175]
 ds_read_b64_tr_b16 a[190:191],v19 offset:41992
 v_mfma_f32_16x16x32_bf16 v[172:175],a[144:147],a[204:207],v[172:175]
 ds_read_b128 a[244:247],v113 offset:34816
 buffer_load_dwordx4 v118,s[4:7],s40 offen offset:2048 lds
 v_mfma_f32_16x16x32_bf16 v[188:191],a[152:155],a[204:207],v[188:191]
 s_waitcnt vmcnt(28)
 v_mfma_f32_16x16x32_bf16 v[188:191],a[156:159],a[220:223],v[188:191]
 v_cmp_gt_u32 vcc,4,v53
 v_mfma_f32_16x16x32_bf16 v[184:187],a[156:159],a[216:219],v[184:187]
 v_mfma_f32_16x16x32_bf16 v[184:187],a[152:155],a[200:203],v[184:187]
 buffer_load_dwordx4 v119,s[4:7],s40 offen offset:3072 lds
 v_mfma_f32_16x16x32_bf16 v[180:183],a[152:155],a[196:199],v[180:183]
 v_mfma_f32_16x16x32_bf16 v[180:183],a[156:159],a[212:215],v[180:183]
 s_cmp_lg_u64 vcc,0
 s_cbranch_scc1 L_spin_h
L_spin_h_ret:
 v_mfma_f32_16x16x32_bf16 v[176:179],a[156:159],a[208:211],v[176:179]
 v_mfma_f32_16x16x32_bf16 v[176:179],a[152:155],a[192:195],v[176:179]
 s_waitcnt vmcnt(30) lgkmcnt(0)
 s_barrier
 v_mfma_f32_16x16x32_bf16 v[192:195],a[160:163],a[192:195],v[192:195]
 ds_read_b64_tr_b16 a[128:129],v16 offset:49152
 v_mfma_f32_16x16x32_bf16 v[192:195],a[164:167],a[208:211],v[192:195]
 s_xor_b32 s50,s42,0
 ds_read_b64_tr_b16 a[130:131],v16 offset:50176
 v_mfma_f32_16x16x32_bf16 v[196:199],a[164:167],a[212:215],v[196:199]
 buffer_load_dwordx4 a[0:3],v1,s[68:71],s50 offen offset:0 sc1
 v_mfma_f32_16x16x32_bf16 v[196:199],a[160:163],a[196:199],v[196:199]
 ds_read_b64_tr_b16 a[132:133],v16 offset:57344
 v_mfma_f32_16x16x32_bf16 v[200:203],a[160:163],a[200:203],v[200:203]
 s_xor_b32 s50,s42,0
 ds_read_b64_tr_b16 a[134:135],v16 offset:58368
 v_mfma_f32_16x16x32_bf16 v[200:203],a[164:167],a[216:219],v[200:203]
 buffer_load_dwordx4 a[4:7],v1,s[68:71],s50 offen offset:1024 sc1
 v_mfma_f32_16x16x32_bf16 v[204:207],a[164:167],a[220:223],v[204:207]
 ds_read_b64_tr_b16 a[136:137],v16 offset:49160
 v_mfma_f32_16x16x32_bf16 v[204:207],a[160:163],a[204:207],v[204:207]
 s_xor_b32 s50,s42,2048
 ds_read_b64_tr_b16 a[138:139],v16 offset:50184
 v_mfma_f32_16x16x32_bf16 v[220:223],a[168:171],a[204:207],v[220:223]
 buffer_load_dwordx4 a[8:11],v1,s[68:71],s50 offen offset:0 sc1
 v_mfma_f32_16x16x32_bf16 v[220:223],a[172:175],a[220:223],v[220:223]
 ds_read_b64_tr_b16 a[140:141],v16 offset:57352
 v_mfma_f32_16x16x32_bf16 v[216:219],a[172:175],a[216:219],v[216:219]
 s_xor_b32 s50,s42,2048
 ds_read_b64_tr_b16 a[142:143],v16 offset:58376
 v_mfma_f32_16x16x32_bf16 v[216:219],a[168:171],a[200:203],v[216:219]
 buffer_load_dwordx4 a[12:15],v1,s[68:71],s50 offen offset:1024 sc1
 v_mfma_f32_16x16x32_bf16 v[212:215],a[168:171],a[196:199],v[212:215]
 s_add_u32 m0,s58,32768
 ds_read_b64_tr_b16 a[144:145],v17 offset:49152
 v_mfma_f32_16x16x32_bf16 v[212:215],a[172:175],a[212:215],v[212:215]
 s_add_u32 s59,s59,128
 s_and_b32 s59,s59,2047
 ds_read_b64_tr_b16 a[146:147],v17 offset:50176
 s_waitcnt vmcnt(29)
 v_mfma_f32_16x16x32_bf16 v[208:211],a[172:175],a[208:211],v[208:211]
 ds_read_b128 a[232:235],v112 offset:36864
 buffer_load_dwordx4 v116,s[4:7],s59 offen offset:0 lds
 v_mfma_f32_16x16x32_bf16 v[208:211],a[168:171],a[192:195],v[208:211]
 ds_read_b64_tr_b16 a[148:149],v17 offset:57344
 v_mfma_f32_16x16x32_bf16 v[224:227],a[176:179],a[192:195],v[224:227]
 ds_read_b64_tr_b16 a[150:151],v17 offset:58368
 v_mfma_f32_16x16x32_bf16 v[224:227],a[180:183],a[208:211],v[224:227]
 ds_read_b128 a[248:251],v113 offset:36864
 buffer_load_dwordx4 v117,s[4:7],s59 offen offset:1024 lds
 v_mfma_f32_16x16x32_bf16 v[228:231],a[180:183],a[212:215],v[228:231]
 ds_read_b64_tr_b16 a[152:153],v17 offset:49160
 v_mfma_f32_16x16x32_bf16 v[228:231],a[176:179],a[196:199],v[228:231]
 ds_read_b64_tr_b16 a[154:155],v17 offset:50184
 v_mfma_f32_16x16x32_bf16 v[232:235],a[176:179],a[200:203],v[232:235]
 ds_read_b128 a[236:239],v112 offset:38912
 buffer_load_dwordx4 v118,s[4:7],s59 offen offset:2048 lds
 v_mfma_f32_16x16x32_bf16 v[232:235],a[180:183],a[216:219],v[232:235]
 ds_read_b64_tr_b16 a[156:157],v17 offset:57352
 v_mfma_f32_16x16x32_bf16 v[236:239],a[180:183],a[220:223],v[236:239]
 ds_read_b64_tr_b16 a[158:159],v17 offset:58376
 v_mfma_f32_16x16x32_bf16 v[236:239],a[176:179],a[204:207],v[236:239]
 ds_read_b128 a[252:255],v113 offset:38912
 buffer_load_dwordx4 v119,s[4:7],s59 offen offset:3072 lds
 v_mfma_f32_16x16x32_bf16 v[252:255],a[184:187],a[204:207],v[252:255]
 s_add_u32 m0,s3,98304
 v_mfma_f32_16x16x32_bf16 v[252:255],a[188:191],a[220:223],v[252:255]
 s_add_u32 s41,s41,524288
 s_and_b32 s41,s41,8388607
 v_mfma_f32_16x16x32_bf16 v[248:251],a[188:191],a[216:219],v[248:251]
 buffer_load_dwordx4 v32,s[8:11],s41 offen offset:0 lds
 v_mfma_f32_16x16x32_bf16 v[248:251],a[184:187],a[200:203],v[248:251]
 v_mfma_f32_16x16x32_bf16 v[244:247],a[184:187],a[196:199],v[244:247]
 v_mfma_f32_16x16x32_bf16 v[244:247],a[188:191],a[212:215],v[244:247]
 buffer_load_dwordx4 v33,s[8:11],s41 offen offset:1024 lds
 v_mfma_f32_16x16x32_bf16 v[240:243],a[188:191],a[208:211],v[240:243]
 v_mfma_f32_16x16x32_bf16 v[240:243],a[184:187],a[192:195],v[240:243]
 s_waitcnt lgkmcnt(0)
 v_mfma_f32_16x16x32_bf16 v[128:131],a[128:131],a[224:227],v[128:131]
 ds_read_b64_tr_b16 a[160:161],v18 offset:49152
 v_mfma_f32_16x16x32_bf16 v[128:131],a[132:135],a[240:243],v[128:131]
 s_xor_b32 s50,s42,4096
 ds_read_b64_tr_b16 a[162:163],v18 offset:50176
 v_mfma_f32_16x16x32_bf16 v[132:135],a[132:135],a[244:247],v[132:135]
 buffer_load_dwordx4 a[16:19],v1,s[68:71],s50 offen offset:0 sc1
 v_mfma_f32_16x16x32_bf16 v[132:135],a[128:131],a[228:231],v[132:135]
 ds_read_b64_tr_b16 a[164:165],v18 offset:57344
 v_mfma_f32_16x16x32_bf16 v[136:139],a[128:131],a[232:235],v[136:139]
 s_xor_b32 s50,s42,4096
 ds_read_b64_tr_b16 a[166:167],v18 offset:58368
 v_mfma_f32_16x16x32_bf16 v[136:139],a[132:135],a[248:251],v[136:139]
 buffer_load_dwordx4 a[20:23],v1,s[68:71],s50 offen offset:1024 sc1
 v_mfma_f32_16x16x32_bf16 v[140:143],a[132:135],a[252:255],v[140:143]
 ds_read_b64_tr_b16 a[168:169],v18 offset:49160
 v_mfma_f32_16x16x32_bf16 v[140:143],a[128:131],a[236:239],v[140:143]
 s_xor_b32 s50,s42,6144
 ds_read_b64_tr_b16 a[170:171],v18 offset:50184
 v_mfma_f32_16x16x32_bf16 v[156:159],a[136:139],a[236:239],v[156:159]
 buffer_load_dwordx4 a[24:27],v1,s[68:71],s50 offen offset:0 sc1
 v_mfma_f32_16x16x32_bf16 v[156:159],a[140:143],a[252:255],v[156:159]
 ds_read_b64_tr_b16 a[172:173],v18 offset:57352
 v_mfma_f32_16x16x32_bf16 v[152:155],a[140:143],a[248:251],v[152:155]
 s_xor_b32 s50,s42,6144
 ds_read_b64_tr_b16 a[174:175],v18 offset:58376
 v_mfma_f32_16x16x32_bf16 v[152:155],a[136:139],a[232:235],v[152:155]
 buffer_load_dwordx4 a[28:31],v1,s[68:71],s50 offen offset:1024 sc1
 v_mfma_f32_16x16x32_bf16 v[148:151],a[136:139],a[228:231],v[148:151]
 ds_read_b64_tr_b16 a[176:177],v19 offset:49152
 v_mfma_f32_16x16x32_bf16 v[148:151],a[140:143],a[244:247],v[148:151]
 ds_read_b64_tr_b16 a[178:179],v19 offset:50176
 s_waitcnt vmcnt(35)
 v_mfma_f32_16x16x32_bf16 v[144:147],a[140:143],a[240:243],v[144:147]
 ds_read_b128 a[192:195],v112 offset:0
 buffer_load_dwordx4 v34,s[8:11],s41 offen offset:2048 lds
 v_mfma_f32_16x16x32_bf16 v[144:147],a[136:139],a[224:227],v[144:147]
 ds_read_b64_tr_b16 a[180:181],v19 offset:57344
 v_mfma_f32_16x16x32_bf16 v[160:163],a[144:147],a[224:227],v[160:163]
 ds_read_b64_tr_b16 a[182:183],v19 offset:58368
 v_mfma_f32_16x16x32_bf16 v[160:163],a[148:151],a[240:243],v[160:163]
 ds_read_b128 a[208:211],v113 offset:0
 buffer_load_dwordx4 v35,s[8:11],s41 offen offset:3072 lds
 v_mfma_f32_16x16x32_bf16 v[164:167],a[148:151],a[244:247],v[164:167]
 s_add_u32 m0,s58,36864
 ds_read_b64_tr_b16 a[184:185],v19 offset:49160
 v_mfma_f32_16x16x32_bf16 v[164:167],a[144:147],a[228:231],v[164:167]
 s_add_u32 s40,s59,65536
 ds_read_b64_tr_b16 a[186:187],v19 offset:50184
 v_mfma_f32_16x16x32_bf16 v[168:171],a[144:147],a[232:235],v[168:171]
 ds_read_b128 a[196:199],v112 offset:2048
 buffer_load_dwordx4 v116,s[4:7],s40 offen offset:0 lds
 v_mfma_f32_16x16x32_bf16 v[168:171],a[148:151],a[248:251],v[168:171]
 ds_read_b64_tr_b16 a[188:189],v19 offset:57352
 v_mfma_f32_16x16x32_bf16 v[172:175],a[148:151],a[252:255],v[172:175]
 ds_read_b64_tr_b16 a[190:191],v19 offset:58376
 v_mfma_f32_16x16x32_bf16 v[172:175],a[144:147],a[236:239],v[172:175]
 ds_read_b128 a[212:215],v113 offset:2048
 buffer_load_dwordx4 v117,s[4:7],s40 offen offset:1024 lds
 v_mfma_f32_16x16x32_bf16 v[188:191],a[152:155],a[236:239],v[188:191]
 v_mfma_f32_16x16x32_bf16 v[188:191],a[156:159],a[252:255],v[188:191]
 v_mfma_f32_16x16x32_bf16 v[184:187],a[156:159],a[248:251],v[184:187]
 buffer_load_dwordx4 v118,s[4:7],s40 offen offset:2048 lds
 v_mfma_f32_16x16x32_bf16 v[184:187],a[152:155],a[232:235],v[184:187]
 v_mfma_f32_16x16x32_bf16 v[180:183],a[152:155],a[228:231],v[180:183]
 v_mfma_f32_16x16x32_bf16 v[180:183],a[156:159],a[244:247],v[180:183]
 buffer_load_dwordx4 v119,s[4:7],s40 offen offset:3072 lds
 v_mfma_f32_16x16x32_bf16 v[176:179],a[156:159],a[240:243],v[176:179]
 v_mfma_f32_16x16x32_bf16 v[176:179],a[152:155],a[224:227],v[176:179]
 s_waitcnt vmcnt(37) lgkmcnt(0)
 s_barrier
 v_mfma_f32_16x16x32_bf16 v[192:195],a[160:163],a[224:227],v[192:195]
 ds_read_b64_tr_b16 a[128:129],v16 offset:0
 v_mfma_f32_16x16x32_bf16 v[192:195],a[164:167],a[240:243],v[192:195]
 s_lshl_b32 s50,s47,10
 ds_read_b64_tr_b16 a[130:131],v16 offset:1024
 v_mfma_f32_16x16x32_bf16 v[196:199],a[164:167],a[244:247],v[196:199]
 buffer_load_dwordx4 a[32:35],v62,s[68:71],s50 offen offset:0 sc1
 v_mfma_f32_16x16x32_bf16 v[196:199],a[160:163],a[228:231],v[196:199]
 ds_read_b64_tr_b16 a[132:133],v16 offset:8192
 v_mfma_f32_16x16x32_bf16 v[200:203],a[160:163],a[232:235],v[200:203]
 s_lshl_b32 s50,s47,10
 ds_read_b64_tr_b16 a[134:135],v16 offset:9216
 v_mfma_f32_16x16x32_bf16 v[200:203],a[164:167],a[248:251],v[200:203]
 buffer_load_dwordx4 a[36:39],v62,s[68:71],s50 offen offset:256 sc1
 v_mfma_f32_16x16x32_bf16 v[204:207],a[164:167],a[252:255],v[204:207]
 ds_read_b64_tr_b16 a[136:137],v16 offset:8
 v_mfma_f32_16x16x32_bf16 v[204:207],a[160:163],a[236:239],v[204:207]
 ds_read_b64_tr_b16 a[138:139],v16 offset:1032
 v_mfma_f32_16x16x32_bf16 v[220:223],a[168:171],a[236:239],v[220:223]
 s_lshl_b32 s50,s47,10
 v_mfma_f32_16x16x32_bf16 v[220:223],a[172:175],a[252:255],v[220:223]
 ds_read_b64_tr_b16 a[140:141],v16 offset:8200
 buffer_load_dwordx4 a[40:43],v62,s[68:71],s50 offen offset:512 sc1
 v_mfma_f32_16x16x32_bf16 v[216:219],a[172:175],a[248:251],v[216:219]
 ds_read_b64_tr_b16 a[142:143],v16 offset:9224
 v_mfma_f32_16x16x32_bf16 v[216:219],a[168:171],a[232:235],v[216:219]
 v_mfma_f32_16x16x32_bf16 v[212:215],a[168:171],a[228:231],v[212:215]
 s_lshl_b32 s50,s47,10
 ds_read_b64_tr_b16 a[144:145],v17 offset:0
 v_mfma_f32_16x16x32_bf16 v[212:215],a[172:175],a[244:247],v[212:215]
 ds_read_b64_tr_b16 a[146:147],v17 offset:1024
 s_waitcnt vmcnt(35)
 buffer_load_dwordx4 a[44:47],v62,s[68:71],s50 offen offset:768 sc1
 v_mfma_f32_16x16x32_bf16 v[208:211],a[172:175],a[240:243],v[208:211]
 ds_read_b128 a[200:203],v112 offset:4096
 v_mfma_f32_16x16x32_bf16 v[208:211],a[168:171],a[224:227],v[208:211]
 s_add_u32 m0,s3,114688
 ds_read_b64_tr_b16 a[148:149],v17 offset:8192
 v_mfma_f32_16x16x32_bf16 v[224:227],a[176:179],a[224:227],v[224:227]
 s_add_u32 s41,s41,524288
 s_and_b32 s41,s41,8388607
 ds_read_b64_tr_b16 a[150:151],v17 offset:9216
 v_mfma_f32_16x16x32_bf16 v[224:227],a[180:183],a[240:243],v[224:227]
 ds_read_b128 a[216:219],v113 offset:4096
 buffer_load_dwordx4 v32,s[8:11],s41 offen offset:0 lds
 v_mfma_f32_16x16x32_bf16 v[228:231],a[180:183],a[244:247],v[228:231]
L_stub_a_3:
 s_cbranch_execz L_stub_a_7
 ds_read_b64_tr_b16 a[152:153],v17 offset:8
 v_mfma_f32_16x16x32_bf16 v[228:231],a[176:179],a[228:231],v[228:231]
 ds_read_b64_tr_b16 a[154:155],v17 offset:1032
 v_mfma_f32_16x16x32_bf16 v[232:235],a[176:179],a[232:235],v[232:235]
 ds_read_b128 a[204:207],v112 offset:6144
 buffer_load_dwordx4 v33,s[8:11],s41 offen offset:1024 lds
 v_mfma_f32_16x16x32_bf16 v[232:235],a[180:183],a[248:251],v[232:235]
 ds_read_b64_tr_b16 a[156:157],v17 offset:8200
 v_mfma_f32_16x16x32_bf16 v[236:239],a[180:183],a[252:255],v[236:239]
 ds_read_b64_tr_b16 a[158:159],v17 offset:9224
 v_mfma_f32_16x16x32_bf16 v[236:239],a[176:179],a[236:239],v[236:239]
 ds_read_b128 a[220:223],v113 offset:6144
 v_mfma_f32_16x16x32_bf16 v[252:255],a[184:187],a[236:239],v[252:255]
 buffer_load_dwordx4 v34,s[8:11],s41 offen offset:2048 lds
 v_mfma_f32_16x16x32_bf16 v[252:255],a[188:191],a[252:255],v[252:255]
 v_mfma_f32_16x16x32_bf16 v[248:251],a[188:191],a[248:251],v[248:251]
 v_mfma_f32_16x16x32_bf16 v[248:251],a[184:187],a[232:235],v[248:251]
 v_mfma_f32_16x16x32_bf16 v[244:247],a[184:187],a[228:231],v[244:247]
 buffer_load_dwordx4 v35,s[8:11],s41 offen offset:3072 lds
 v_mfma_f32_16x16x32_bf16 v[244:247],a[188:191],a[244:247],v[244:247]
 v_mfma_f32_16x16x32_bf16 v[240:243],a[188:191],a[240:243],v[240:243]
 v_mfma_f32_16x16x32_bf16 v[240:243],a[184:187],a[224:227],v[240:243]
 s_waitcnt lgkmcnt(0)
 v_mfma_f32_16x16x32_bf16 v[128:131],a[128:131],a[192:195],v[128:131]
 ds_read_b64_tr_b16 a[160:161],v18 offset:0
 v_mfma_f32_16x16x32_bf16 v[128:131],a[132:135],a[208:211],v[128:131]
 s_lshl_b32 s50,s47,8
 s_add_u32 s50,s50,32768
 ds_read_b64_tr_b16 a[162:163],v18 offset:1024
 v_mfma_f32_16x16x32_bf16 v[132:135],a[132:135],a[212:215],v[132:135]
 buffer_load_dword v46,v63,s[68:71],s50 offen offset:0 sc1
 v_mfma_f32_16x16x32_bf16 v[132:135],a[128:131],a[196:199],v[132:135]
 ds_read_b64_tr_b16 a[164:165],v18 offset:8192
 v_mfma_f32_16x16x32_bf16 v[136:139],a[128:131],a[200:203],v[136:139]
 ds_read_b64_tr_b16 a[166:167],v18 offset:9216
 v_mfma_f32_16x16x32_bf16 v[136:139],a[132:135],a[216:219],v[136:139]
 v_mfma_f32_16x16x32_bf16 v[140:143],a[132:135],a[220:223],v[140:143]
 ds_read_b64_tr_b16 a[168:169],v18 offset:8
 v_mfma_f32_16x16x32_bf16 v[140:143],a[128:131],a[204:207],v[140:143]
 ds_read_b64_tr_b16 a[170:171],v18 offset:1032
 v_mfma_f32_16x16x32_bf16 v[156:159],a[136:139],a[204:207],v[156:159]
 s_lshl_b32 s50,s47,8
 s_add_u32 s50,s50,32768
 v_mfma_f32_16x16x32_bf16 v[156:159],a[140:143],a[220:223],v[156:159]
 ds_read_b64_tr_b16 a[172:173],v18 offset:8200
 buffer_load_dword v50,v63,s[68:71],s50 offen offset:64 sc1
 v_mfma_f32_16x16x32_bf16 v[152:155],a[140:143],a[216:219],v[152:155]
 ds_read_b64_tr_b16 a[174:175],v18 offset:9224
 v_mfma_f32_16x16x32_bf16 v[152:155],a[136:139],a[200:203],v[152:155]
 v_mfma_f32_16x16x32_bf16 v[148:151],a[136:139],a[196:199],v[148:151]
 ds_read_b64_tr_b16 a[176:177],v19 offset:0
 v_mfma_f32_16x16x32_bf16 v[148:151],a[140:143],a[212:215],v[148:151]
 ds_read_b64_tr_b16 a[178:179],v19 offset:1024
 s_waitcnt vmcnt(38)
 v_mfma_f32_16x16x32_bf16 v[144:147],a[140:143],a[208:211],v[144:147]
 ds_read_b128 a[224:227],v114 offset:0
 v_mfma_f32_16x16x32_bf16 v[144:147],a[136:139],a[192:195],v[144:147]
 ds_read_b64_tr_b16 a[180:181],v19 offset:8192
 v_mfma_f32_16x16x32_bf16 v[160:163],a[144:147],a[192:195],v[160:163]
 s_lshl_b32 s50,s47,8
 s_add_u32 s50,s50,32768
 ds_read_b64_tr_b16 a[182:183],v19 offset:9216
 v_mfma_f32_16x16x32_bf16 v[160:163],a[148:151],a[208:211],v[160:163]
 ds_read_b128 a[240:243],v115 offset:0
 buffer_load_dword v54,v63,s[68:71],s50 offen offset:128 sc1
 v_mfma_f32_16x16x32_bf16 v[164:167],a[148:151],a[212:215],v[164:167]
 ds_read_b64_tr_b16 a[184:185],v19 offset:8
 v_mfma_f32_16x16x32_bf16 v[164:167],a[144:147],a[196:199],v[164:167]
 ds_read_b64_tr_b16 a[186:187],v19 offset:1032
 v_mfma_f32_16x16x32_bf16 v[168:171],a[144:147],a[200:203],v[168:171]
 ds_read_b128 a[228:231],v114 offset:2048
 v_mfma_f32_16x16x32_bf16 v[168:171],a[148:151],a[216:219],v[168:171]
 ds_read_b64_tr_b16 a[188:189],v19 offset:8200
 v_mfma_f32_16x16x32_bf16 v[172:175],a[148:151],a[220:223],v[172:175]
 ds_read_b64_tr_b16 a[190:191],v19 offset:9224
 v_mfma_f32_16x16x32_bf16 v[172:175],a[144:147],a[204:207],v[172:175]
 s_lshl_b32 s50,s47,8
 s_add_u32 s50,s50,32768
 ds_read_b128 a[244:247],v115 offset:2048
 v_mfma_f32_16x16x32_bf16 v[188:191],a[152:155],a[204:207],v[188:191]
 buffer_load_dword v58,v63,s[68:71],s50 offen offset:192 sc1
 v_mfma_f32_16x16x32_bf16 v[188:191],a[156:159],a[220:223],v[188:191]
 v_mfma_f32_16x16x32_bf16 v[184:187],a[156:159],a[216:219],v[184:187]
 v_mfma_f32_16x16x32_bf16 v[184:187],a[152:155],a[200:203],v[184:187]
 v_mfma_f32_16x16x32_bf16 v[180:183],a[152:155],a[196:199],v[180:183]
 v_mfma_f32_16x16x32_bf16 v[180:183],a[156:159],a[212:215],v[180:183]
 v_mfma_f32_16x16x32_bf16 v[176:179],a[156:159],a[208:211],v[176:179]
 s_mov_b32 s42,0
 s_mov_b32 s43,0
 v_mfma_f32_16x16x32_bf16 v[176:179],a[152:155],a[192:195],v[176:179]
 s_waitcnt vmcnt(36) lgkmcnt(0)
 s_barrier
 v_mfma_f32_16x16x32_bf16 v[192:195],a[160:163],a[192:195],v[192:195]
 ds_read_b64_tr_b16 a[128:129],v16 offset:16384
 v_mfma_f32_16x16x32_bf16 v[192:195],a[164:167],a[208:211],v[192:195]
 s_mov_b32 s41,0
 ds_read_b64_tr_b16 a[130:131],v16 offset:17408
 v_mfma_f32_16x16x32_bf16 v[196:199],a[164:167],a[212:215],v[196:199]
 buffer_store_dwordx4 v[64:67],v85,s[68:71],s41 offen sc1
 v_mfma_f32_16x16x32_bf16 v[196:199],a[160:163],a[196:199],v[196:199]
 ds_read_b64_tr_b16 a[132:133],v16 offset:24576
 v_mfma_f32_16x16x32_bf16 v[200:203],a[160:163],a[200:203],v[200:203]
 ds_read_b64_tr_b16 a[134:135],v16 offset:25600
 v_mfma_f32_16x16x32_bf16 v[200:203],a[164:167],a[216:219],v[200:203]
 v_mfma_f32_16x16x32_bf16 v[204:207],a[164:167],a[220:223],v[204:207]
 s_add_u32 m0,s58,131072
 ds_read_b64_tr_b16 a[136:137],v16 offset:16392
 v_mfma_f32_16x16x32_bf16 v[204:207],a[160:163],a[204:207],v[204:207]
 s_add_u32 s59,s59,128
 s_and_b32 s59,s59,2047
 ds_read_b64_tr_b16 a[138:139],v16 offset:17416
 v_mfma_f32_16x16x32_bf16 v[220:223],a[168:171],a[204:207],v[220:223]
 buffer_load_dwordx4 v116,s[4:7],s59 offen offset:0 lds
 v_mfma_f32_16x16x32_bf16 v[220:223],a[172:175],a[220:223],v[220:223]
 ds_read_b64_tr_b16 a[140:141],v16 offset:24584
 v_mfma_f32_16x16x32_bf16 v[216:219],a[172:175],a[216:219],v[216:219]
 ds_read_b64_tr_b16 a[142:143],v16 offset:25608
 v_mfma_f32_16x16x32_bf16 v[216:219],a[168:171],a[200:203],v[216:219]
 v_mfma_f32_16x16x32_bf16 v[212:215],a[168:171],a[196:199],v[212:215]
 ds_read_b64_tr_b16 a[144:145],v17 offset:16384
 v_mfma_f32_16x16x32_bf16 v[212:215],a[172:175],a[212:215],v[212:215]
 ds_read_b64_tr_b16 a[146:147],v17 offset:17408
 s_waitcnt vmcnt(34)
 v_mfma_f32_16x16x32_bf16 v[208:211],a[172:175],a[208:211],v[208:211]
 ds_read_b128 a[232:235],v114 offset:4096
 buffer_load_dwordx4 v117,s[4:7],s59 offen offset:1024 lds
 v_mfma_f32_16x16x32_bf16 v[208:211],a[168:171],a[192:195],v[208:211]
 ds_read_b64_tr_b16 a[148:149],v17 offset:24576
 v_mfma_f32_16x16x32_bf16 v[224:227],a[176:179],a[192:195],v[224:227]
 ds_read_b64_tr_b16 a[150:151],v17 offset:25600
 v_mfma_f32_16x16x32_bf16 v[224:227],a[180:183],a[208:211],v[224:227]
 ds_read_b128 a[248:251],v115 offset:4096
 v_mfma_f32_16x16x32_bf16 v[228:231],a[180:183],a[212:215],v[228:231]
 ds_read_b64_tr_b16 a[152:153],v17 offset:16392
 v_mfma_f32_16x16x32_bf16 v[228:231],a[176:179],a[196:199],v[228:231]
 ds_read_b64_tr_b16 a[154:155],v17 offset:17416
 v_mfma_f32_16x16x32_bf16 v[232:235],a[176:179],a[200:203],v[232:235]
 ds_read_b128 a[236:239],v114 offset:6144
 buffer_load_dwordx4 v118,s[4:7],s59 offen offset:2048 lds
 v_mfma_f32_16x16x32_bf16 v[232:235],a[180:183],a[216:219],v[232:235]
 ds_read_b64_tr_b16 a[156:157],v17 offset:24584
 v_mfma_f32_16x16x32_bf16 v[236:239],a[180:183],a[220:223],v[236:239]
 ds_read_b64_tr_b16 a[158:159],v17 offset:25608
 v_mfma_f32_16x16x32_bf16 v[236:239],a[176:179],a[204:207],v[236:239]
 ds_read_b128 a[252:255],v115 offset:6144
 v_mfma_f32_16x16x32_bf16 v[252:255],a[184:187],a[204:207],v[252:255]
 v_mfma_f32_16x16x32_bf16 v[252:255],a[188:191],a[220:223],v[252:255]
 v_mfma_f32_16x16x32_bf16 v[248:251],a[188:191],a[216:219],v[248:251]
 buffer_load_dwordx4 v119,s[4:7],s59 offen offset:3072 lds
 v_mfma_f32_16x16x32_bf16 v[248:251],a[184:187],a[200:203],v[248:251]
 v_mfma_f32_16x16x32_bf16 v[244:247],a[184:187],a[196:199],v[244:247]
 v_mfma_f32_16x16x32_bf16 v[244:247],a[188:191],a[212:215],v[244:247]
 v_mfma_f32_16x16x32_bf16 v[240:243],a[188:191],a[208:211],v[240:243]
 v_mfma_f32_16x16x32_bf16 v[240:243],a[184:187],a[192:195],v[240:243]
 s_waitcnt lgkmcnt(0)
 v_mfma_f32_16x16x32_bf16 v[128:131],a[128:131],a[224:227],v[128:131]
 ds_read_b64_tr_b16 a[160:161],v18 offset:16384
 v_mfma_f32_16x16x32_bf16 v[128:131],a[132:135],a[240:243],v[128:131]
 s_mov_b32 s41,1048576
 ds_read_b64_tr_b16 a[162:163],v18 offset:17408
 v_mfma_f32_16x16x32_bf16 v[132:135],a[132:135],a[244:247],v[132:135]
 buffer_store_dwordx4 v[68:71],v85,s[68:71],s41 offen sc1
 v_mfma_f32_16x16x32_bf16 v[132:135],a[128:131],a[228:231],v[132:135]
 s_add_u32 m0,s58,135168
 ds_read_b64_tr_b16 a[164:165],v18 offset:24576
 v_mfma_f32_16x16x32_bf16 v[136:139],a[128:131],a[232:235],v[136:139]
 s_add_u32 s40,s59,65536
 ds_read_b64_tr_b16 a[166:167],v18 offset:25600
 v_mfma_f32_16x16x32_bf16 v[136:139],a[132:135],a[248:251],v[136:139]
 buffer_load_dwordx4 v116,s[4:7],s40 offen offset:0 lds
 v_mfma_f32_16x16x32_bf16 v[140:143],a[132:135],a[252:255],v[140:143]
 ds_read_b64_tr_b16 a[168:169],v18 offset:16392
 v_mfma_f32_16x16x32_bf16 v[140:143],a[128:131],a[236:239],v[140:143]
 ds_read_b64_tr_b16 a[170:171],v18 offset:17416
 v_mfma_f32_16x16x32_bf16 v[156:159],a[136:139],a[236:239],v[156:159]
 v_mfma_f32_16x16x32_bf16 v[156:159],a[140:143],a[252:255],v[156:159]
 ds_read_b64_tr_b16 a[172:173],v18 offset:24584
 buffer_load_dwordx4 v117,s[4:7],s40 offen offset:1024 lds
 v_mfma_f32_16x16x32_bf16 v[152:155],a[140:143],a[248:251],v[152:155]
 ds_read_b64_tr_b16 a[174:175],v18 offset:25608
 v_mfma_f32_16x16x32_bf16 v[152:155],a[136:139],a[232:235],v[152:155]
 v_mfma_f32_16x16x32_bf16 v[148:151],a[136:139],a[228:231],v[148:151]
 ds_read_b64_tr_b16 a[176:177],v19 offset:16384
 v_mfma_f32_16x16x32_bf16 v[148:151],a[140:143],a[244:247],v[148:151]
 ds_read_b64_tr_b16 a[178:179],v19 offset:17408
 s_waitcnt vmcnt(32)
 buffer_load_dwordx4 v118,s[4:7],s40 offen offset:2048 lds
 v_mfma_f32_16x16x32_bf16 v[144:147],a[140:143],a[240:243],v[144:147]
 ds_read_b128 a[192:195],v112 offset:32768
 v_mfma_f32_16x16x32_bf16 v[144:147],a[136:139],a[224:227],v[144:147]
 ds_read_b64_tr_b16 a[180:181],v19 offset:24576
 v_mfma_f32_16x16x32_bf16 v[160:163],a[144:147],a[224:227],v[160:163]
 ds_read_b64_tr_b16 a[182:183],v19 offset:25600
 v_mfma_f32_16x16x32_bf16 v[160:163],a[148:151],a[240:243],v[160:163]
 ds_read_b128 a[208:211],v113 offset:32768
 buffer_load_dwordx4 v119,s[4:7],s40 offen offset:3072 lds
 v_mfma_f32_16x16x32_bf16 v[164:167],a[148:151],a[244:247],v[164:167]
 ds_read_b64_tr_b16 a[184:185],v19 offset:16392
 v_mfma_f32_16x16x32_bf16 v[164:167],a[144:147],a[228:231],v[164:167]
 s_add_u32 m0,s3,0
 ds_read_b64_tr_b16 a[186:187],v19 offset:17416
 v_mfma_f32_16x16x32_bf16 v[168:171],a[144:147],a[232:235],v[168:171]
 ds_read_b128 a[196:199],v112 offset:34816
 buffer_load_dwordx4 v24,s[12:15],s42 offen offset:0 lds
 v_mfma_f32_16x16x32_bf16 v[168:171],a[148:151],a[248:251],v[168:171]
 ds_read_b64_tr_b16 a[188:189],v19 offset:24584
 v_mfma_f32_16x16x32_bf16 v[172:175],a[148:151],a[252:255],v[172:175]
 ds_read_b64_tr_b16 a[190:191],v19 offset:25608
 v_mfma_f32_16x16x32_bf16 v[172:175],a[144:147],a[236:239],v[172:175]
 ds_read_b128 a[212:215],v113 offset:34816
 v_mfma_f32_16x16x32_bf16 v[188:191],a[152:155],a[236:239],v[188:191]
 buffer_load_dwordx4 v25,s[12:15],s42 offen offset:1024 lds
 v_mfma_f32_16x16x32_bf16 v[188:191],a[156:159],a[252:255],v[188:191]
 v_mfma_f32_16x16x32_bf16 v[184:187],a[156:159],a[248:251],v[184:187]
 v_mfma_f32_16x16x32_bf16 v[184:187],a[152:155],a[232:235],v[184:187]
 v_mfma_f32_16x16x32_bf16 v[180:183],a[152:155],a[228:231],v[180:183]
 buffer_load_dwordx4 v26,s[12:15],s42 offen offset:2048 lds
 v_mfma_f32_16x16x32_bf16 v[180:183],a[156:159],a[244:247],v[180:183]
 v_mfma_f32_16x16x32_bf16 v[176:179],a[156:159],a[240:243],v[176:179]
 v_mfma_f32_16x16x32_bf16 v[176:179],a[152:155],a[224:227],v[176:179]
 s_waitcnt vmcnt(29) lgkmcnt(0)
 s_barrier
 v_mfma_f32_16x16x32_bf16 v[192:195],a[160:163],a[224:227],v[192:195]
 s_add_u32 s4,s30,41943040
 s_addc_u32 s5,s31,0
 ds_read_b64_tr_b16 a[128:129],v16 offset:32768
 v_mfma_f32_16x16x32_bf16 v[192:195],a[164:167],a[240:243],v[192:195]
 s_mov_b32 s41,2097152
 ds_read_b64_tr_b16 a[130:131],v16 offset:33792
 s_mov_b32 s6,16384
 v_mfma_f32_16x16x32_bf16 v[196:199],a[164:167],a[244:247],v[196:199]
 s_mov_b32 s7,0x20000
 buffer_store_dwordx4 v[72:75],v85,s[68:71],s41 offen sc1
 v_mfma_f32_16x16x32_bf16 v[196:199],a[160:163],a[228:231],v[196:199]
 s_add_u32 s8,s30,75497472
 s_addc_u32 s9,s31,0
 ds_read_b64_tr_b16 a[132:133],v16 offset:40960
 v_mfma_f32_16x16x32_bf16 v[200:203],a[160:163],a[232:235],v[200:203]
 s_mov_b32 s10,20971520
 ds_read_b64_tr_b16 a[134:135],v16 offset:41984
 s_mov_b32 s11,0x20000
 v_mfma_f32_16x16x32_bf16 v[200:203],a[164:167],a[248:251],v[200:203]
 s_lshl_b32 s48,s47,5
 buffer_load_dwordx4 v27,s[12:15],s42 offen offset:3072 lds
 s_add_u32 s48,s48,s46
 v_mfma_f32_16x16x32_bf16 v[204:207],a[164:167],a[252:255],v[204:207]
 s_add_u32 s42,s42,0x4000
 ds_read_b64_tr_b16 a[136:137],v16 offset:32776
 s_mul_i32 s40,s48,12288
 v_mfma_f32_16x16x32_bf16 v[204:207],a[160:163],a[236:239],v[204:207]
 s_add_u32 s58,s40,10240
 ds_read_b64_tr_b16 a[138:139],v16 offset:33800
 s_lshl_b32 s59,s48,13
 v_mfma_f32_16x16x32_bf16 v[220:223],a[168:171],a[236:239],v[220:223]
 s_add_u32 m0,s3,16384
 s_add_u32 s59,s59,12582912
 s_lshr_b32 s48,s3,8
 v_mfma_f32_16x16x32_bf16 v[220:223],a[172:175],a[252:255],v[220:223]
 ds_read_b64_tr_b16 a[140:141],v16 offset:40968
 buffer_load_dwordx4 v24,s[12:15],s42 offen offset:0 lds
 v_mfma_f32_16x16x32_bf16 v[216:219],a[172:175],a[248:251],v[216:219]
 ds_read_b64_tr_b16 a[142:143],v16 offset:41992
 v_add_u32 v62,s48,v3
 v_mfma_f32_16x16x32_bf16 v[216:219],a[168:171],a[232:235],v[216:219]
 v_mul_u32_u24 v62,7168,v62
 v_lshlrev_b32 v63,1,v3
 v_mfma_f32_16x16x32_bf16 v[212:215],a[168:171],a[228:231],v[212:215]
 ds_read_b64_tr_b16 a[144:145],v17 offset:32768
 v_xor_b32 v63,v63,v2
 v_mfma_f32_16x16x32_bf16 v[212:215],a[172:175],a[244:247],v[212:215]
 ds_read_b64_tr_b16 a[146:147],v17 offset:33792
 s_waitcnt vmcnt(28)
 buffer_load_dwordx4 v25,s[12:15],s42 offen offset:1024 lds
 v_mfma_f32_16x16x32_bf16 v[208:211],a[172:175],a[240:243],v[208:211]
 ds_read_b128 a[200:203],v112 offset:36864
 v_lshl_add_u32 v32,v63,4,v62
 v_mfma_f32_16x16x32_bf16 v[208:211],a[168:171],a[224:227],v[208:211]
 ds_read_b64_tr_b16 a[148:149],v17 offset:40960
 v_xor_b32 v63,8,v63
 v_mfma_f32_16x16x32_bf16 v[224:227],a[176:179],a[224:227],v[224:227]
 ds_read_b64_tr_b16 a[150:151],v17 offset:41984
 v_lshl_add_u32 v33,v63,4,v62
 v_mfma_f32_16x16x32_bf16 v[224:227],a[180:183],a[240:243],v[224:227]
 ds_read_b128 a[216:219],v113 offset:36864
 buffer_load_dwordx4 v26,s[12:15],s42 offen offset:2048 lds
 v_mfma_f32_16x16x32_bf16 v[228:231],a[180:183],a[244:247],v[228:231]
 ds_read_b64_tr_b16 a[152:153],v17 offset:32776
 v_add_u32 v33,27648,v33
 v_mfma_f32_16x16x32_bf16 v[228:231],a[176:179],a[228:231],v[228:231]
 ds_read_b64_tr_b16 a[154:155],v17 offset:33800
 v_add_u32 v34,55296,v32
 v_mfma_f32_16x16x32_bf16 v[232:235],a[176:179],a[232:235],v[232:235]
 ds_read_b128 a[204:207],v112 offset:38912
 buffer_load_dwordx4 v27,s[12:15],s42 offen offset:3072 lds
 v_mfma_f32_16x16x32_bf16 v[232:235],a[180:183],a[248:251],v[232:235]
 s_add_u32 s42,s42,0x4000
 ds_read_b64_tr_b16 a[156:157],v17 offset:40968
 v_add_u32 v35,55296,v33
 v_mfma_f32_16x16x32_bf16 v[236:239],a[180:183],a[252:255],v[236:239]
 s_getpc_b64 s[60:61]
L_pc_b:
 s_add_u32 s60,s60,L_attn_last-L_pc_b
 s_addc_u32 s61,s61,0
 ds_read_b64_tr_b16 a[158:159],v17 offset:41992
 v_mfma_f32_16x16x32_bf16 v[236:239],a[176:179],a[236:239],v[236:239]
 s_add_u32 m0,s3,65536
 ds_read_b128 a[220:223],v113 offset:38912
 s_mov_b32 s62,L_code_end-L_attn_last
 v_mfma_f32_16x16x32_bf16 v[252:255],a[184:187],a[236:239],v[252:255]
 s_mov_b32 s63,0x20000
 buffer_load_dwordx4 v28,s[16:19],s43 offen offset:0 lds
 s_bfe_u32 s77,s2,0x40003
 v_mfma_f32_16x16x32_bf16 v[252:255],a[188:191],a[252:255],v[252:255]
 s_lshl_b32 s77,s77,13
 s_lshr_b32 s48,s2,3
 s_or_b32 s48,s48,s3
 v_mfma_f32_16x16x32_bf16 v[248:251],a[188:191],a[248:251],v[248:251]
 s_or_b32 s48,s48,s45
 s_min_u32 s48,s48,1
 s_lshl_b32 s48,s48,20
 v_mfma_f32_16x16x32_bf16 v[248:251],a[184:187],a[232:235],v[248:251]
 v_lshl_add_u32 v31,v1,16,s48
 v_mov_b32 v30,1
 v_mfma_f32_16x16x32_bf16 v[244:247],a[184:187],a[228:231],v[244:247]
 buffer_load_dwordx4 v29,s[16:19],s43 offen offset:1024 lds
 v_mov_b32 v62,0
 v_mfma_f32_16x16x32_bf16 v[244:247],a[188:191],a[244:247],v[244:247]
 v_lshlrev_b32 v63,12,v95
 s_movk_i32 s50,8192
 v_mfma_f32_16x16x32_bf16 v[240:243],a[188:191],a[240:243],v[240:243]
 s_and_b32 s51,s2,7
 s_lshl_b32 s51,s51,7
 s_add_u32 s51,s51,8320
 v_mfma_f32_16x16x32_bf16 v[240:243],a[184:187],a[224:227],v[240:243]
 s_waitcnt lgkmcnt(0)
 v_mfma_f32_16x16x32_bf16 v[128:131],a[128:131],a[192:195],v[128:131]
 ds_read_b64_tr_b16 a[160:161],v18 offset:32768
 v_mfma_f32_16x16x32_bf16 v[128:131],a[132:135],a[208:211],v[128:131]
 s_mov_b32 s41,3145728
 ds_read_b64_tr_b16 a[162:163],v18 offset:33792
 v_mfma_f32_16x16x32_bf16 v[132:135],a[132:135],a[212:215],v[132:135]
 buffer_store_dwordx4 v[76:79],v85,s[68:71],s41 offen sc1
 v_mfma_f32_16x16x32_bf16 v[132:135],a[128:131],a[196:199],v[132:135]
 ds_read_b64_tr_b16 a[164:165],v18 offset:40960
 v_mfma_f32_16x16x32_bf16 v[136:139],a[128:131],a[200:203],v[136:139]
 ds_read_b64_tr_b16 a[166:167],v18 offset:41984
 v_mfma_f32_16x16x32_bf16 v[136:139],a[132:135],a[216:219],v[136:139]
 v_mfma_f32_16x16x32_bf16 v[140:143],a[132:135],a[220:223],v[140:143]
 ds_read_b64_tr_b16 a[168:169],v18 offset:32776
 v_mfma_f32_16x16x32_bf16 v[140:143],a[128:131],a[204:207],v[140:143]
 ds_read_b64_tr_b16 a[170:171],v18 offset:33800
 v_mfma_f32_16x16x32_bf16 v[156:159],a[136:139],a[204:207],v[156:159]
 v_mfma_f32_16x16x32_bf16 v[156:159],a[140:143],a[220:223],v[156:159]
 ds_read_b64_tr_b16 a[172:173],v18 offset:40968
 v_mfma_f32_16x16x32_bf16 v[152:155],a[140:143],a[216:219],v[152:155]
 ds_read_b64_tr_b16 a[174:175],v18 offset:41992
 v_mfma_f32_16x16x32_bf16 v[152:155],a[136:139],a[200:203],v[152:155]
 v_mfma_f32_16x16x32_bf16 v[148:151],a[136:139],a[196:199],v[148:151]
 ds_read_b64_tr_b16 a[176:177],v19 offset:32768
 buffer_load_dwordx4 v28,s[16:19],s43 offen offset:2048 lds
 v_mfma_f32_16x16x32_bf16 v[148:151],a[140:143],a[212:215],v[148:151]
 ds_read_b64_tr_b16 a[178:179],v19 offset:33792
 s_waitcnt vmcnt(18)
 v_mfma_f32_16x16x32_bf16 v[144:147],a[140:143],a[208:211],v[144:147]
 ds_read_b128 a[224:227],v114 offset:0
 v_mfma_f32_16x16x32_bf16 v[144:147],a[136:139],a[192:195],v[144:147]
 ds_read_b64_tr_b16 a[180:181],v19 offset:40960
 v_mfma_f32_16x16x32_bf16 v[160:163],a[144:147],a[192:195],v[160:163]
 ds_read_b64_tr_b16 a[182:183],v19 offset:41984
 v_mfma_f32_16x16x32_bf16 v[160:163],a[148:151],a[208:211],v[160:163]
 ds_read_b128 a[240:243],v115 offset:0
 v_mfma_f32_16x16x32_bf16 v[164:167],a[148:151],a[212:215],v[164:167]
 ds_read_b64_tr_b16 a[184:185],v19 offset:32776
 v_mfma_f32_16x16x32_bf16 v[164:167],a[144:147],a[196:199],v[164:167]
 ds_read_b64_tr_b16 a[186:187],v19 offset:33800
 v_mfma_f32_16x16x32_bf16 v[168:171],a[144:147],a[200:203],v[168:171]
 ds_read_b128 a[228:231],v114 offset:2048
 v_mfma_f32_16x16x32_bf16 v[168:171],a[148:151],a[216:219],v[168:171]
 ds_read_b64_tr_b16 a[188:189],v19 offset:40968
 v_mfma_f32_16x16x32_bf16 v[172:175],a[148:151],a[220:223],v[172:175]
 ds_read_b64_tr_b16 a[190:191],v19 offset:41992
 buffer_load_dwordx4 v29,s[16:19],s43 offen offset:3072 lds
 v_mfma_f32_16x16x32_bf16 v[172:175],a[144:147],a[204:207],v[172:175]
 s_add_u32 s43,s43,0x4000
 ds_read_b128 a[244:247],v115 offset:2048
 v_mfma_f32_16x16x32_bf16 v[188:191],a[152:155],a[204:207],v[188:191]
 v_mfma_f32_16x16x32_bf16 v[188:191],a[156:159],a[220:223],v[188:191]
 v_mfma_f32_16x16x32_bf16 v[184:187],a[156:159],a[216:219],v[184:187]
 v_mfma_f32_16x16x32_bf16 v[184:187],a[152:155],a[200:203],v[184:187]
 v_mfma_f32_16x16x32_bf16 v[180:183],a[152:155],a[196:199],v[180:183]
 v_mfma_f32_16x16x32_bf16 v[180:183],a[156:159],a[212:215],v[180:183]
 v_mfma_f32_16x16x32_bf16 v[176:179],a[156:159],a[208:211],v[176:179]
 v_mfma_f32_16x16x32_bf16 v[176:179],a[152:155],a[192:195],v[176:179]
 s_waitcnt vmcnt(28) lgkmcnt(0)
 s_barrier
 v_mfma_f32_16x16x32_bf16 v[192:195],a[160:163],a[192:195],v[192:195]
 s_mul_i32 s48,s2,57344
 ds_read_b64_tr_b16 a[128:129],v16 offset:49152
 v_mfma_f32_16x16x32_bf16 v[192:195],a[164:167],a[208:211],v[192:195]
 s_add_u32 m0,s3,32768
 ds_read_b64_tr_b16 a[130:131],v16 offset:50176
 v_mfma_f32_16x16x32_bf16 v[196:199],a[164:167],a[212:215],v[196:199]
 s_add_u32 s68,s38,s48
 s_addc_u32 s69,s39,0
 buffer_load_dwordx4 v24,s[12:15],s42 offen offset:0 lds
 v_mfma_f32_16x16x32_bf16 v[196:199],a[160:163],a[196:199],v[196:199]
 s_mov_b32 s70,57344
 ds_read_b64_tr_b16 a[132:133],v16 offset:57344
 s_mov_b32 s71,0x20000
 v_mfma_f32_16x16x32_bf16 v[200:203],a[160:163],a[200:203],v[200:203]
 s_lshl_b32 s48,s2,15
 ds_read_b64_tr_b16 a[134:135],v16 offset:58368
 v_mfma_f32_16x16x32_bf16 v[200:203],a[164:167],a[216:219],v[200:203]
 s_add_u32 s72,s36,s48
 s_addc_u32 s73,s37,0
 s_mov_b32 s74,32768
 v_mfma_f32_16x16x32_bf16 v[204:207],a[164:167],a[220:223],v[204:207]
 s_mov_b32 s75,0x20000
 ds_read_b64_tr_b16 a[136:137],v16 offset:49160
 buffer_load_dwordx4 v25,s[12:15],s42 offen offset:1024 lds
 v_mfma_f32_16x16x32_bf16 v[204:207],a[160:163],a[204:207],v[204:207]
 ds_read_b64_tr_b16 a[138:139],v16 offset:50184
 v_mfma_f32_16x16x32_bf16 v[220:223],a[168:171],a[204:207],v[220:223]
 v_mfma_f32_16x16x32_bf16 v[220:223],a[172:175],a[220:223],v[220:223]
 ds_read_b64_tr_b16 a[140:141],v16 offset:57352
 v_mfma_f32_16x16x32_bf16 v[216:219],a[172:175],a[216:219],v[216:219]
 ds_read_b64_tr_b16 a[142:143],v16 offset:58376
 buffer_load_dwordx4 v26,s[12:15],s42 offen offset:2048 lds
 v_mfma_f32_16x16x32_bf16 v[216:219],a[168:171],a[200:203],v[216:219]
 v_mfma_f32_16x16x32_bf16 v[212:215],a[168:171],a[196:199],v[212:215]
 ds_read_b64_tr_b16 a[144:145],v17 offset:49152
 v_mfma_f32_16x16x32_bf16 v[212:215],a[172:175],a[212:215],v[212:215]
 ds_read_b64_tr_b16 a[146:147],v17 offset:50176
 s_waitcnt vmcnt(17)
 v_mfma_f32_16x16x32_bf16 v[208:211],a[172:175],a[208:211],v[208:211]
 ds_read_b128 a[232:235],v114 offset:4096
 buffer_load_dwordx4 v27,s[12:15],s42 offen offset:3072 lds
 v_mfma_f32_16x16x32_bf16 v[208:211],a[168:171],a[192:195],v[208:211]
 s_add_u32 s42,s42,0x4000
 ds_read_b64_tr_b16 a[148:149],v17 offset:57344
 v_mfma_f32_16x16x32_bf16 v[224:227],a[176:179],a[192:195],v[224:227]
 ds_read_b64_tr_b16 a[150:151],v17 offset:58368
 v_mfma_f32_16x16x32_bf16 v[224:227],a[180:183],a[208:211],v[224:227]
 ds_read_b128 a[248:251],v115 offset:4096
 v_mfma_f32_16x16x32_bf16 v[228:231],a[180:183],a[212:215],v[228:231]
 s_add_u32 m0,s3,81920
 ds_read_b64_tr_b16 a[152:153],v17 offset:49160
 v_mfma_f32_16x16x32_bf16 v[228:231],a[176:179],a[196:199],v[228:231]
 ds_read_b64_tr_b16 a[154:155],v17 offset:50184
 buffer_load_dwordx4 v28,s[16:19],s43 offen offset:0 lds
 v_mfma_f32_16x16x32_bf16 v[232:235],a[176:179],a[200:203],v[232:235]
 ds_read_b128 a[236:239],v114 offset:6144
 v_mfma_f32_16x16x32_bf16 v[232:235],a[180:183],a[216:219],v[232:235]
 ds_read_b64_tr_b16 a[156:157],v17 offset:57352
 v_mfma_f32_16x16x32_bf16 v[236:239],a[180:183],a[220:223],v[236:239]
 ds_read_b64_tr_b16 a[158:159],v17 offset:58376
 v_mfma_f32_16x16x32_bf16 v[236:239],a[176:179],a[204:207],v[236:239]
 ds_read_b128 a[252:255],v115 offset:6144
 buffer_load_dwordx4 v29,s[16:19],s43 offen offset:1024 lds
 v_mfma_f32_16x16x32_bf16 v[252:255],a[184:187],a[204:207],v[252:255]
 v_mfma_f32_16x16x32_bf16 v[252:255],a[188:191],a[220:223],v[252:255]
 v_mfma_f32_16x16x32_bf16 v[248:251],a[188:191],a[216:219],v[248:251]
 v_mfma_f32_16x16x32_bf16 v[248:251],a[184:187],a[200:203],v[248:251]
 buffer_load_dwordx4 v28,s[16:19],s43 offen offset:2048 lds
 v_mfma_f32_16x16x32_bf16 v[244:247],a[184:187],a[196:199],v[244:247]
 v_mfma_f32_16x16x32_bf16 v[244:247],a[188:191],a[212:215],v[244:247]
 v_mfma_f32_16x16x32_bf16 v[240:243],a[188:191],a[208:211],v[240:243]
 v_mfma_f32_16x16x32_bf16 v[240:243],a[184:187],a[192:195],v[240:243]
 s_waitcnt vmcnt(31) lgkmcnt(0)
 v_mfma_f32_16x16x32_bf16 v[128:131],a[128:131],a[224:227],v[128:131]
 ds_read_b64_tr_b16 a[160:161],v18 offset:49152
 v_mfma_f32_16x16x32_bf16 v[128:131],a[132:135],a[240:243],v[128:131]
 ds_read_b64_tr_b16 a[162:163],v18 offset:50176
 v_mfma_f32_16x16x32_bf16 v[128:131],a[0:3],a[32:35],v[128:131]
 buffer_load_dwordx4 v29,s[16:19],s43 offen offset:3072 lds
 v_mfma_f32_16x16x32_bf16 v[132:135],a[128:131],a[228:231],v[132:135]
 s_add_u32 s43,s43,0x4000
 ds_read_b64_tr_b16 a[164:165],v18 offset:57344
 v_mfma_f32_16x16x32_bf16 v[132:135],a[132:135],a[244:247],v[132:135]
 ds_read_b64_tr_b16 a[166:167],v18 offset:58368
 v_mfma_f32_16x16x32_bf16 v[132:135],a[0:3],a[36:39],v[132:135]
 v_mfma_f32_16x16x32_bf16 v[136:139],a[128:131],a[232:235],v[136:139]
 ds_read_b64_tr_b16 a[168:169],v18 offset:49160
 v_mfma_f32_16x16x32_bf16 v[136:139],a[132:135],a[248:251],v[136:139]
 ds_read_b64_tr_b16 a[170:171],v18 offset:50184
 v_mul_f32 v128,v128,v46
 v_mfma_f32_16x16x32_bf16 v[136:139],a[0:3],a[40:43],v[136:139]
 v_mul_f32 v129,v129,v46
 v_mul_f32 v130,v130,v46
 v_mfma_f32_16x16x32_bf16 v[140:143],a[128:131],a[236:239],v[140:143]
 ds_read_b64_tr_b16 a[172:173],v18 offset:57352
 v_mul_f32 v131,v131,v46
 v_mfma_f32_16x16x32_bf16 v[140:143],a[132:135],a[252:255],v[140:143]
 s_add_u32 m0,s3,49152
 ds_read_b64_tr_b16 a[174:175],v18 offset:58376
 v_cvt_pk_bf16_f32 v64,v128,v129
 v_mfma_f32_16x16x32_bf16 v[140:143],a[0:3],a[44:47],v[140:143]
 buffer_load_dwordx4 v24,s[12:15],s42 offen offset:0 lds
 v_cvt_pk_bf16_f32 v65,v130,v131
 v_mfma_f32_16x16x32_bf16 v[144:147],a[136:139],a[224:227],v[144:147]
 ds_read_b64_tr_b16 a[176:177],v19 offset:49152
 v_mul_f32 v132,v132,v50
 v_mfma_f32_16x16x32_bf16 v[144:147],a[140:143],a[240:243],v[144:147]
 ds_read_b64_tr_b16 a[178:179],v19 offset:50176
 v_mul_f32 v133,v133,v50
 v_mfma_f32_16x16x32_bf16 v[144:147],a[4:7],a[32:35],v[144:147]
 v_mul_f32 v134,v134,v50
 v_mul_f32 v135,v135,v50
 v_mfma_f32_16x16x32_bf16 v[148:151],a[136:139],a[228:231],v[148:151]
 ds_read_b64_tr_b16 a[180:181],v19 offset:57344
 v_cvt_pk_bf16_f32 v80,v132,v133
 v_mfma_f32_16x16x32_bf16 v[148:151],a[140:143],a[244:247],v[148:151]
 ds_read_b64_tr_b16 a[182:183],v19 offset:58368
 v_cvt_pk_bf16_f32 v81,v134,v135
 v_mfma_f32_16x16x32_bf16 v[148:151],a[4:7],a[36:39],v[148:151]
 v_mul_f32 v136,v136,v54
 v_mul_f32 v137,v137,v54
 v_mfma_f32_16x16x32_bf16 v[152:155],a[136:139],a[232:235],v[152:155]
 ds_read_b64_tr_b16 a[184:185],v19 offset:49160
 v_mul_f32 v138,v138,v54
 v_mfma_f32_16x16x32_bf16 v[152:155],a[140:143],a[248:251],v[152:155]
 ds_read_b64_tr_b16 a[186:187],v19 offset:50184
 v_mul_f32 v139,v139,v54
 v_mfma_f32_16x16x32_bf16 v[152:155],a[4:7],a[40:43],v[152:155]
 buffer_load_dwordx4 v25,s[12:15],s42 offen offset:1024 lds
 v_cvt_pk_bf16_f32 v96,v136,v137
 v_mfma_f32_16x16x32_bf16 v[156:159],a[136:139],a[236:239],v[156:159]
 ds_read_b64_tr_b16 a[188:189],v19 offset:57352
 v_cvt_pk_bf16_f32 v97,v138,v139
 v_mfma_f32_16x16x32_bf16 v[156:159],a[140:143],a[252:255],v[156:159]
 ds_read_b64_tr_b16 a[190:191],v19 offset:58376
 v_mul_f32 v140,v140,v58
 v_mfma_f32_16x16x32_bf16 v[156:159],a[4:7],a[44:47],v[156:159]
 v_mul_f32 v141,v141,v58
 v_mul_f32 v142,v142,v58
 v_mfma_f32_16x16x32_bf16 v[160:163],a[144:147],a[224:227],v[160:163]
 v_mul_f32 v143,v143,v58
 v_cvt_pk_bf16_f32 v112,v140,v141
 v_mfma_f32_16x16x32_bf16 v[160:163],a[148:151],a[240:243],v[160:163]
 v_cvt_pk_bf16_f32 v113,v142,v143
 v_mul_f32 v144,v144,v46
 v_mfma_f32_16x16x32_bf16 v[160:163],a[8:11],a[32:35],v[160:163]
 v_mul_f32 v145,v145,v46
 v_mul_f32 v146,v146,v46
 v_mfma_f32_16x16x32_bf16 v[164:167],a[144:147],a[228:231],v[164:167]
 v_mul_f32 v147,v147,v46
 v_cvt_pk_bf16_f32 v66,v144,v145
 v_mfma_f32_16x16x32_bf16 v[164:167],a[148:151],a[244:247],v[164:167]
L_stub_a_4:
 s_cbranch_execz L_stub_a_8
 v_cvt_pk_bf16_f32 v67,v146,v147
 v_mul_f32 v148,v148,v50
 v_mfma_f32_16x16x32_bf16 v[164:167],a[8:11],a[36:39],v[164:167]
 buffer_load_dwordx4 v26,s[12:15],s42 offen offset:2048 lds
 v_mul_f32 v149,v149,v50
 v_mfma_f32_16x16x32_bf16 v[168:171],a[144:147],a[232:235],v[168:171]
 v_mul_f32 v150,v150,v50
 v_mul_f32 v151,v151,v50
 v_mfma_f32_16x16x32_bf16 v[168:171],a[148:151],a[248:251],v[168:171]
 v_cvt_pk_bf16_f32 v82,v148,v149
 v_cvt_pk_bf16_f32 v83,v150,v151
 v_mfma_f32_16x16x32_bf16 v[168:171],a[8:11],a[40:43],v[168:171]
 v_mul_f32 v152,v152,v54
 v_mul_f32 v153,v153,v54
 v_mfma_f32_16x16x32_bf16 v[172:175],a[144:147],a[236:239],v[172:175]
 v_mul_f32 v154,v154,v54
 v_mul_f32 v155,v155,v54
 v_mfma_f32_16x16x32_bf16 v[172:175],a[148:151],a[252:255],v[172:175]
 v_cvt_pk_bf16_f32 v98,v152,v153
 v_cvt_pk_bf16_f32 v99,v154,v155
 v_mfma_f32_16x16x32_bf16 v[172:175],a[8:11],a[44:47],v[172:175]
 v_mul_f32 v156,v156,v58
 v_mul_f32 v157,v157,v58
 v_mfma_f32_16x16x32_bf16 v[176:179],a[152:155],a[224:227],v[176:179]
 v_mul_f32 v158,v158,v58
 v_mul_f32 v159,v159,v58
 v_mfma_f32_16x16x32_bf16 v[176:179],a[156:159],a[240:243],v[176:179]
 v_cvt_pk_bf16_f32 v114,v156,v157
 v_cvt_pk_bf16_f32 v115,v158,v159
 v_mfma_f32_16x16x32_bf16 v[176:179],a[12:15],a[32:35],v[176:179]
 buffer_load_dwordx4 v27,s[12:15],s42 offen offset:3072 lds
 v_mul_f32 v160,v160,v46
 v_mfma_f32_16x16x32_bf16 v[180:183],a[152:155],a[228:231],v[180:183]
 s_add_u32 s42,s42,0x4000
 v_mul_f32 v161,v161,v46
 v_mul_f32 v162,v162,v46
 v_mfma_f32_16x16x32_bf16 v[180:183],a[156:159],a[244:247],v[180:183]
 v_mul_f32 v163,v163,v46
 v_cvt_pk_bf16_f32 v68,v160,v161
 v_mfma_f32_16x16x32_bf16 v[180:183],a[12:15],a[36:39],v[180:183]
 v_cvt_pk_bf16_f32 v69,v162,v163
 v_mul_f32 v164,v164,v50
 v_mfma_f32_16x16x32_bf16 v[184:187],a[152:155],a[232:235],v[184:187]
 v_mul_f32 v165,v165,v50
 v_mul_f32 v166,v166,v50
 v_mfma_f32_16x16x32_bf16 v[184:187],a[156:159],a[248:251],v[184:187]
 v_mul_f32 v167,v167,v50
 v_cvt_pk_bf16_f32 v84,v164,v165
 v_mfma_f32_16x16x32_bf16 v[184:187],a[12:15],a[40:43],v[184:187]
 v_cvt_pk_bf16_f32 v85,v166,v167
 v_mul_f32 v168,v168,v54
 v_mfma_f32_16x16x32_bf16 v[188:191],a[152:155],a[236:239],v[188:191]
 v_mul_f32 v169,v169,v54
 v_mul_f32 v170,v170,v54
 v_mfma_f32_16x16x32_bf16 v[188:191],a[156:159],a[252:255],v[188:191]
 v_mul_f32 v171,v171,v54
 v_cvt_pk_bf16_f32 v100,v168,v169
 v_mfma_f32_16x16x32_bf16 v[188:191],a[12:15],a[44:47],v[188:191]
 s_waitcnt vmcnt(21) lgkmcnt(0)
 s_barrier
 v_mfma_f32_16x16x32_bf16 v[192:195],a[160:163],a[224:227],v[192:195]
 ds_read_b128 a[128:131],v4 offset:0
 v_cvt_pk_bf16_f32 v101,v170,v171
 v_mfma_f32_16x16x32_bf16 v[192:195],a[164:167],a[240:243],v[192:195]
 s_add_u32 m0,s3,98304
 ds_read_b128 a[132:135],v5 offset:0
 v_mul_f32 v172,v172,v58
 v_mfma_f32_16x16x32_bf16 v[192:195],a[16:19],a[32:35],v[192:195]
 buffer_load_dwordx4 v28,s[16:19],s43 offen offset:0 lds
 v_mul_f32 v173,v173,v58
 v_mfma_f32_16x16x32_bf16 v[208:211],a[168:171],a[224:227],v[208:211]
 ds_read_b128 a[136:139],v6 offset:0
 v_mul_f32 v174,v174,v58
 v_mfma_f32_16x16x32_bf16 v[208:211],a[172:175],a[240:243],v[208:211]
 ds_read_b128 a[140:143],v7 offset:0
 v_mul_f32 v175,v175,v58
 v_mfma_f32_16x16x32_bf16 v[208:211],a[20:23],a[32:35],v[208:211]
 v_cvt_pk_bf16_f32 v116,v172,v173
 v_cvt_pk_bf16_f32 v117,v174,v175
 v_mfma_f32_16x16x32_bf16 v[224:227],a[176:179],a[224:227],v[224:227]
 ds_read_b128 a[144:147],v4 offset:4096
 v_mul_f32 v176,v176,v46
 v_mfma_f32_16x16x32_bf16 v[224:227],a[180:183],a[240:243],v[224:227]
 ds_read_b128 a[148:151],v5 offset:4096
 v_mul_f32 v177,v177,v46
 v_mfma_f32_16x16x32_bf16 v[224:227],a[24:27],a[32:35],v[224:227]
 v_mul_f32 v178,v178,v46
 v_mul_f32 v179,v179,v46
 v_mfma_f32_16x16x32_bf16 v[240:243],a[184:187],a[224:227],v[240:243]
 ds_read_b128 a[152:155],v6 offset:4096
 v_cvt_pk_bf16_f32 v70,v176,v177
 v_mfma_f32_16x16x32_bf16 v[240:243],a[188:191],a[240:243],v[240:243]
 ds_read_b128 a[156:159],v7 offset:4096
 v_cvt_pk_bf16_f32 v71,v178,v179
 v_mfma_f32_16x16x32_bf16 v[240:243],a[28:31],a[32:35],v[240:243]
 v_mul_f32 v180,v180,v50
 v_mul_f32 v181,v181,v50
 v_mfma_f32_16x16x32_bf16 v[196:199],a[160:163],a[228:231],v[196:199]
 v_mul_f32 v182,v182,v50
 v_mul_f32 v183,v183,v50
 v_mfma_f32_16x16x32_bf16 v[196:199],a[164:167],a[244:247],v[196:199]
 buffer_load_dwordx4 v29,s[16:19],s43 offen offset:1024 lds
 v_cvt_pk_bf16_f32 v86,v180,v181
 v_mfma_f32_16x16x32_bf16 v[196:199],a[16:19],a[36:39],v[196:199]
 v_cvt_pk_bf16_f32 v87,v182,v183
 v_mul_f32 v184,v184,v54
 v_mfma_f32_16x16x32_bf16 v[212:215],a[168:171],a[228:231],v[212:215]
 v_mul_f32 v185,v185,v54
 v_mul_f32 v186,v186,v54
 v_mfma_f32_16x16x32_bf16 v[212:215],a[172:175],a[244:247],v[212:215]
 v_mul_f32 v187,v187,v54
 v_cvt_pk_bf16_f32 v102,v184,v185
 v_mfma_f32_16x16x32_bf16 v[212:215],a[20:23],a[36:39],v[212:215]
 v_cvt_pk_bf16_f32 v103,v186,v187
 v_mul_f32 v188,v188,v58
 v_mfma_f32_16x16x32_bf16 v[228:231],a[176:179],a[228:231],v[228:231]
 v_mul_f32 v189,v189,v58
 v_mul_f32 v190,v190,v58
 v_mfma_f32_16x16x32_bf16 v[228:231],a[180:183],a[244:247],v[228:231]
 v_mul_f32 v191,v191,v58
 v_cvt_pk_bf16_f32 v118,v188,v189
 v_mfma_f32_16x16x32_bf16 v[228:231],a[24:27],a[36:39],v[228:231]
 v_cvt_pk_bf16_f32 v119,v190,v191
 v_mul_f32 v192,v192,v46
 v_mfma_f32_16x16x32_bf16 v[244:247],a[184:187],a[228:231],v[244:247]
 v_mul_f32 v193,v193,v46
 v_mul_f32 v194,v194,v46
 v_mfma_f32_16x16x32_bf16 v[244:247],a[188:191],a[244:247],v[244:247]
 v_mul_f32 v195,v195,v46
 v_cvt_pk_bf16_f32 v72,v192,v193
 v_mfma_f32_16x16x32_bf16 v[244:247],a[28:31],a[36:39],v[244:247]
 v_cvt_pk_bf16_f32 v73,v194,v195
 v_mul_f32 v208,v208,v46
 v_mfma_f32_16x16x32_bf16 v[200:203],a[160:163],a[232:235],v[200:203]
 v_mul_f32 v209,v209,v46
 v_mul_f32 v210,v210,v46
 v_mfma_f32_16x16x32_bf16 v[200:203],a[164:167],a[248:251],v[200:203]
 buffer_load_dwordx4 v28,s[16:19],s43 offen offset:2048 lds
 v_mul_f32 v211,v211,v46
 v_mfma_f32_16x16x32_bf16 v[200:203],a[16:19],a[40:43],v[200:203]
 v_cvt_pk_bf16_f32 v74,v208,v209
 v_cvt_pk_bf16_f32 v75,v210,v211
 v_mfma_f32_16x16x32_bf16 v[216:219],a[168:171],a[232:235],v[216:219]
 v_mul_f32 v224,v224,v46
 v_mul_f32 v225,v225,v46
 v_mfma_f32_16x16x32_bf16 v[216:219],a[172:175],a[248:251],v[216:219]
 v_mul_f32 v226,v226,v46
 v_mul_f32 v227,v227,v46
 v_mfma_f32_16x16x32_bf16 v[216:219],a[20:23],a[40:43],v[216:219]
 v_cvt_pk_bf16_f32 v76,v224,v225
 v_cvt_pk_bf16_f32 v77,v226,v227
 v_mfma_f32_16x16x32_bf16 v[232:235],a[176:179],a[232:235],v[232:235]
 v_mul_f32 v240,v240,v46
 v_mul_f32 v241,v241,v46
 v_mfma_f32_16x16x32_bf16 v[232:235],a[180:183],a[248:251],v[232:235]
 v_mul_f32 v242,v242,v46
 v_mul_f32 v243,v243,v46
 v_mfma_f32_16x16x32_bf16 v[232:235],a[24:27],a[40:43],v[232:235]
 v_cvt_pk_bf16_f32 v78,v240,v241
 v_cvt_pk_bf16_f32 v79,v242,v243
 v_mfma_f32_16x16x32_bf16 v[248:251],a[184:187],a[232:235],v[248:251]
 v_mul_f32 v196,v196,v50
 v_mul_f32 v197,v197,v50
 v_mfma_f32_16x16x32_bf16 v[248:251],a[188:191],a[248:251],v[248:251]
 v_mul_f32 v198,v198,v50
 v_mul_f32 v199,v199,v50
 v_mfma_f32_16x16x32_bf16 v[248:251],a[28:31],a[40:43],v[248:251]
 v_cvt_pk_bf16_f32 v88,v196,v197
 v_cvt_pk_bf16_f32 v89,v198,v199
 v_mfma_f32_16x16x32_bf16 v[204:207],a[160:163],a[236:239],v[204:207]
 buffer_load_dwordx4 v29,s[16:19],s43 offen offset:3072 lds
 v_mul_f32 v212,v212,v50
 v_mfma_f32_16x16x32_bf16 v[204:207],a[164:167],a[252:255],v[204:207]
 s_add_u32 s43,s43,0x4000
 v_mul_f32 v213,v213,v50
 v_mul_f32 v214,v214,v50
 v_mfma_f32_16x16x32_bf16 v[204:207],a[16:19],a[44:47],v[204:207]
 v_mul_f32 v215,v215,v50
 v_cvt_pk_bf16_f32 v90,v212,v213
 v_mfma_f32_16x16x32_bf16 v[220:223],a[168:171],a[236:239],v[220:223]
 v_cvt_pk_bf16_f32 v91,v214,v215
 v_mul_f32 v228,v228,v50
 v_mfma_f32_16x16x32_bf16 v[220:223],a[172:175],a[252:255],v[220:223]
 v_mul_f32 v229,v229,v50
 v_mul_f32 v230,v230,v50
 v_mfma_f32_16x16x32_bf16 v[220:223],a[20:23],a[44:47],v[220:223]
 v_mul_f32 v231,v231,v50
 v_cvt_pk_bf16_f32 v92,v228,v229
 v_mfma_f32_16x16x32_bf16 v[236:239],a[176:179],a[236:239],v[236:239]
 v_cvt_pk_bf16_f32 v93,v230,v231
 v_mul_f32 v244,v244,v50
 v_mfma_f32_16x16x32_bf16 v[236:239],a[180:183],a[252:255],v[236:239]
 v_mul_f32 v245,v245,v50
 v_mul_f32 v246,v246,v50
 v_mfma_f32_16x16x32_bf16 v[236:239],a[24:27],a[44:47],v[236:239]
 v_mul_f32 v247,v247,v50
 v_cvt_pk_bf16_f32 v94,v244,v245
 v_mfma_f32_16x16x32_bf16 v[252:255],a[184:187],a[236:239],v[252:255]
 v_cvt_pk_bf16_f32 v95,v246,v247
 v_mul_f32 v200,v200,v54
 v_mfma_f32_16x16x32_bf16 v[252:255],a[188:191],a[252:255],v[252:255]
 v_mul_f32 v201,v201,v54
 v_mul_f32 v202,v202,v54
 v_mfma_f32_16x16x32_bf16 v[252:255],a[28:31],a[44:47],v[252:255]
 s_waitcnt lgkmcnt(0)
 v_mul_f32 v203,v203,v54
 v_cvt_pk_bf16_f32 v104,v200,v201
 v_mfma_f32_16x16x32_bf16 v[128:131],a[128:131],v[64:67],0
 ds_read_b128 a[160:163],v4 offset:8192
 v_cvt_pk_bf16_f32 v105,v202,v203
 v_mul_f32 v216,v216,v54
 v_mfma_f32_16x16x32_bf16 v[128:131],a[132:135],v[68:71],v[128:131]
 ds_read_b128 a[164:167],v5 offset:8192
 v_mul_f32 v217,v217,v54
 v_mul_f32 v218,v218,v54
 v_mfma_f32_16x16x32_bf16 v[128:131],a[136:139],v[72:75],v[128:131]
 ds_read_b128 a[168:171],v6 offset:8192
 v_mul_f32 v219,v219,v54
 v_cvt_pk_bf16_f32 v106,v216,v217
 v_mfma_f32_16x16x32_bf16 v[128:131],a[140:143],v[76:79],v[128:131]
 ds_read_b128 a[172:175],v7 offset:8192
 v_cvt_pk_bf16_f32 v107,v218,v219
 v_mul_f32 v232,v232,v54
 v_mfma_f32_16x16x32_bf16 v[144:147],a[156:159],v[76:79],0
 ds_read_b128 a[176:179],v4 offset:12288
 v_mul_f32 v233,v233,v54
 v_mul_f32 v234,v234,v54
 v_mfma_f32_16x16x32_bf16 v[144:147],a[152:155],v[72:75],v[144:147]
 ds_read_b128 a[180:183],v5 offset:12288
 v_mul_f32 v235,v235,v54
 v_cvt_pk_bf16_f32 v108,v232,v233
 v_mfma_f32_16x16x32_bf16 v[144:147],a[148:151],v[68:71],v[144:147]
 ds_read_b128 a[184:187],v6 offset:12288
 v_cvt_pk_bf16_f32 v109,v234,v235
 v_mul_f32 v248,v248,v54
 v_mfma_f32_16x16x32_bf16 v[144:147],a[144:147],v[64:67],v[144:147]
 ds_read_b128 a[188:191],v7 offset:12288
 v_mfma_f32_32x32x16_bf16 a[0:15],v[36:39],v[36:39],0
 v_mul_f32 v249,v249,v54
 v_mfma_f32_16x16x32_bf16 v[148:151],a[144:147],v[80:83],0
 v_mul_f32 v250,v250,v54
 v_mul_f32 v251,v251,v54
 v_cvt_pk_bf16_f32 v110,v248,v249
 v_mfma_f32_16x16x32_bf16 v[148:151],a[148:151],v[84:87],v[148:151]
 v_cvt_pk_bf16_f32 v111,v250,v251
 v_mul_f32 v204,v204,v58
 v_mul_f32 v205,v205,v58
 v_mfma_f32_16x16x32_bf16 v[148:151],a[152:155],v[88:91],v[148:151]
 v_mul_f32 v206,v206,v58
 v_mul_f32 v207,v207,v58
 v_cvt_pk_bf16_f32 v120,v204,v205
 v_mfma_f32_16x16x32_bf16 v[148:151],a[156:159],v[92:95],v[148:151]
 v_cvt_pk_bf16_f32 v121,v206,v207
 v_mul_f32 v220,v220,v58
 v_mul_f32 v221,v221,v58
 v_mfma_f32_16x16x32_bf16 v[132:135],a[140:143],v[92:95],0
 v_mul_f32 v222,v222,v58
 v_mul_f32 v223,v223,v58
 v_mfma_f32_16x16x32_bf16 v[132:135],a[136:139],v[88:91],v[132:135]
 v_cvt_pk_bf16_f32 v122,v220,v221
 v_cvt_pk_bf16_f32 v123,v222,v223
 v_mfma_f32_16x16x32_bf16 v[132:135],a[132:135],v[84:87],v[132:135]
 v_mul_f32 v236,v236,v58
 v_mul_f32 v237,v237,v58
 v_mfma_f32_16x16x32_bf16 v[132:135],a[128:131],v[80:83],v[132:135]
 v_mfma_f32_32x32x16_bf16 a[16:31],v[36:39],v[36:39],0
 v_mul_f32 v238,v238,v58
 v_mfma_f32_16x16x32_bf16 v[136:139],a[128:131],v[96:99],0
 s_waitcnt vmcnt(16) lgkmcnt(0)
 s_barrier
 v_mfma_f32_16x16x32_bf16 v[136:139],a[132:135],v[100:103],v[136:139]
 v_mul_f32 v239,v239,v58
 v_cvt_pk_bf16_f32 v124,v236,v237
 v_mfma_f32_16x16x32_bf16 v[136:139],a[136:139],v[104:107],v[136:139]
 s_and_b32 s48,s2,63
 s_lshl_b32 s48,s48,2
 s_add_u32 s48,s48,12288
 v_mfma_f32_16x16x32_bf16 v[136:139],a[140:143],v[108:111],v[136:139]
 v_cvt_pk_bf16_f32 v125,v238,v239
 v_mul_f32 v252,v252,v58
 v_mfma_f32_16x16x32_bf16 v[152:155],a[156:159],v[108:111],0
 buffer_atomic_add v30,v63,s[4:7],s48 offen sc1
 v_mul_f32 v253,v253,v58
 v_mfma_f32_16x16x32_bf16 v[152:155],a[152:155],v[104:107],v[152:155]
 v_mul_f32 v254,v254,v58
 v_mul_f32 v255,v255,v58
 v_mfma_f32_16x16x32_bf16 v[152:155],a[148:151],v[100:103],v[152:155]
 v_cvt_pk_bf16_f32 v126,v252,v253
 v_cvt_pk_bf16_f32 v127,v254,v255
 v_mfma_f32_16x16x32_bf16 v[152:155],a[144:147],v[96:99],v[152:155]
 v_mfma_f32_32x32x16_bf16 a[32:47],v[36:39],v[36:39],0
 v_max_f32 v44,v128,v129
 v_mfma_f32_16x16x32_bf16 v[156:159],a[144:147],v[112:115],0
 v_mov_b32 v16,-1
 v_max3_f32 v44,v130,v131,v44
 v_mfma_f32_16x16x32_bf16 v[156:159],a[148:151],v[116:119],v[156:159]
 s_add_u32 m0,s3,0
 v_mov_b32 v17,-1
 v_max3_f32 v44,v144,v145,v44
 v_mfma_f32_16x16x32_bf16 v[156:159],a[152:155],v[120:123],v[156:159]
 buffer_load_dwordx4 v24,s[12:15],s42 offen offset:0 lds
 v_mov_b32 v18,-1
 v_mfma_f32_16x16x32_bf16 v[156:159],a[156:159],v[124:127],v[156:159]
 v_mov_b32 v19,-1
 v_max3_f32 v44,v146,v147,v44
 v_mfma_f32_16x16x32_bf16 v[140:143],a[140:143],v[124:127],0
 v_max_f32 v48,v132,v133
 v_max3_f32 v48,v134,v135,v48
 v_mfma_f32_16x16x32_bf16 v[140:143],a[136:139],v[120:123],v[140:143]
 v_max3_f32 v48,v148,v149,v48
 v_max3_f32 v48,v150,v151,v48
 v_mfma_f32_16x16x32_bf16 v[140:143],a[132:135],v[116:119],v[140:143]
 buffer_load_dwordx4 v25,s[12:15],s42 offen offset:1024 lds
 v_max_f32 v52,v136,v137
 v_mfma_f32_16x16x32_bf16 v[140:143],a[128:131],v[112:115],v[140:143]
 v_max3_f32 v52,v138,v139,v52
 v_max3_f32 v52,v152,v153,v52
 v_mfma_f32_16x16x32_bf16 v[160:163],a[160:163],v[64:67],0
 v_max3_f32 v52,v154,v155,v52
 v_mfma_f32_16x16x32_bf16 v[160:163],a[164:167],v[68:71],v[160:163]
 ds_read_b128 a[128:131],v4 offset:16384
 v_mfma_f32_16x16x32_bf16 v[160:163],a[168:171],v[72:75],v[160:163]
 v_mfma_f32_16x16x32_bf16 v[160:163],a[172:175],v[76:79],v[160:163]
 ds_read_b128 a[132:135],v5 offset:16384
 v_mfma_f32_16x16x32_bf16 v[176:179],a[188:191],v[76:79],0
 v_mfma_f32_16x16x32_bf16 v[176:179],a[184:187],v[72:75],v[176:179]
 ds_read_b128 a[136:139],v6 offset:16384
 v_mfma_f32_16x16x32_bf16 v[176:179],a[180:183],v[68:71],v[176:179]
 v_max_f32 v56,v140,v141
 v_max3_f32 v56,v142,v143,v56
 v_mfma_f32_16x16x32_bf16 v[176:179],a[176:179],v[64:67],v[176:179]
 ds_read_b128 a[140:143],v7 offset:16384
 v_max3_f32 v56,v156,v157,v56
 v_mfma_f32_16x16x32_bf16 v[180:183],a[176:179],v[80:83],0
 v_max3_f32 v56,v158,v159,v56
 v_mfma_f32_16x16x32_bf16 v[180:183],a[180:183],v[84:87],v[180:183]
 ds_read_b128 a[144:147],v4 offset:20480
 v_mfma_f32_16x16x32_bf16 v[180:183],a[184:187],v[88:91],v[180:183]
 v_mfma_f32_16x16x32_bf16 v[180:183],a[188:191],v[92:95],v[180:183]
 ds_read_b128 a[148:151],v5 offset:20480
 v_mfma_f32_16x16x32_bf16 v[164:167],a[172:175],v[92:95],0
 v_mfma_f32_16x16x32_bf16 v[164:167],a[168:171],v[88:91],v[164:167]
 ds_read_b128 a[152:155],v6 offset:20480
 v_mfma_f32_16x16x32_bf16 v[164:167],a[164:167],v[84:87],v[164:167]
 v_max3_f32 v44,v160,v161,v44
 v_max3_f32 v44,v162,v163,v44
 v_mfma_f32_16x16x32_bf16 v[164:167],a[160:163],v[80:83],v[164:167]
 ds_read_b128 a[156:159],v7 offset:20480
 v_max3_f32 v44,v176,v177,v44
 v_mfma_f32_16x16x32_bf16 v[168:171],a[160:163],v[96:99],0
 v_max3_f32 v44,v178,v179,v44
 v_mfma_f32_16x16x32_bf16 v[168:171],a[164:167],v[100:103],v[168:171]
 v_mfma_f32_16x16x32_bf16 v[168:171],a[168:171],v[104:107],v[168:171]
 buffer_store_dwordx4 v[16:19],v1,s[8:11],s59 offen offset:0 sc1
 v_mfma_f32_16x16x32_bf16 v[168:171],a[172:175],v[108:111],v[168:171]
 v_mfma_f32_16x16x32_bf16 v[184:187],a[188:191],v[108:111],0
 v_mfma_f32_16x16x32_bf16 v[184:187],a[184:187],v[104:107],v[184:187]
 v_mfma_f32_16x16x32_bf16 v[184:187],a[180:183],v[100:103],v[184:187]
 v_max3_f32 v48,v164,v165,v48
 v_max3_f32 v48,v166,v167,v48
 v_mfma_f32_16x16x32_bf16 v[184:187],a[176:179],v[96:99],v[184:187]
 v_max3_f32 v48,v180,v181,v48
 v_max3_f32 v48,v182,v183,v48
 v_mfma_f32_16x16x32_bf16 v[188:191],a[176:179],v[112:115],0
 v_mfma_f32_16x16x32_bf16 v[188:191],a[180:183],v[116:119],v[188:191]
 v_mfma_f32_16x16x32_bf16 v[188:191],a[184:187],v[120:123],v[188:191]
 v_mfma_f32_16x16x32_bf16 v[188:191],a[188:191],v[124:127],v[188:191]
 v_mfma_f32_16x16x32_bf16 v[172:175],a[172:175],v[124:127],0
 v_mfma_f32_16x16x32_bf16 v[172:175],a[168:171],v[120:123],v[172:175]
 v_mfma_f32_16x16x32_bf16 v[172:175],a[164:167],v[116:119],v[172:175]
 v_max3_f32 v52,v168,v169,v52
 v_max3_f32 v52,v170,v171,v52
 v_mfma_f32_16x16x32_bf16 v[172:175],a[160:163],v[112:115],v[172:175]
 v_max3_f32 v52,v184,v185,v52
 v_max3_f32 v52,v186,v187,v52
 ds_read_b64_tr_b16 a[160:161],v8 offset:0
 ds_read_b64_tr_b16 a[162:163],v8 offset:4096
 ds_read_b64_tr_b16 a[164:165],v8 offset:8192
 ds_read_b64_tr_b16 a[166:167],v8 offset:12288
 s_nop 3
 v_max3_f32 v56,v172,v173,v56
 v_max3_f32 v56,v174,v175,v56
 v_max3_f32 v56,v188,v189,v56
 v_max3_f32 v56,v190,v191,v56
 v_mov_b32 v45,v44
 v_mov_b32 v49,v48
 v_mov_b32 v53,v52
 v_mov_b32 v57,v56
 v_permlane16_swap_b32 v44,v45
 v_permlane16_swap_b32 v48,v49
 v_permlane16_swap_b32 v52,v53
 v_permlane16_swap_b32 v56,v57
 v_max_f32 v44,v44,v45
 v_max_f32 v48,v48,v49
 v_max_f32 v52,v52,v53
 v_max_f32 v56,v56,v57
 v_mov_b32 v45,v44
 v_mov_b32 v49,v48
 v_mov_b32 v53,v52
 v_mov_b32 v57,v56
 v_permlane32_swap_b32 v44,v45
 v_permlane32_swap_b32 v48,v49
 v_permlane32_swap_b32 v52,v53
 v_permlane32_swap_b32 v56,v57
 v_max_f32 v44,v44,v45
 v_max_f32 v48,v48,v49
 v_max_f32 v52,v52,v53
 v_max_f32 v56,v56,v57
 s_mov_b32 s48,0xc2cc0000
 s_cmp_lg_u32 s45,0
 s_cbranch_scc1 L_fb_hook
L_fb_ret:
 v_sub_f32 v44,s48,v44
 v_sub_f32 v48,s48,v48
 v_sub_f32 v52,s48,v52
 v_sub_f32 v56,s48,v56
 v_mov_b32 v45,v44
 v_mov_b32 v49,v48
 v_mov_b32 v53,v52
 v_mov_b32 v57,v56
 v_mov_b64 v[46:47],v[44:45]
 v_mov_b64 v[50:51],v[48:49]
 v_mov_b64 v[54:55],v[52:53]
 v_mov_b64 v[58:59],v[56:57]
 v_pk_add_f32 v[128:129],v[128:129],v[44:45]
 v_pk_add_f32 v[130:131],v[130:131],v[44:45]
 v_pk_add_f32 v[132:133],v[132:133],v[48:49]
 v_pk_add_f32 v[134:135],v[134:135],v[48:49]
 v_pk_add_f32 v[136:137],v[136:137],v[52:53]
 v_pk_add_f32 v[138:139],v[138:139],v[52:53]
 v_pk_add_f32 v[140:141],v[140:141],v[56:57]
 v_pk_add_f32 v[142:143],v[142:143],v[56:57]
 v_pk_add_f32 v[144:145],v[144:145],v[44:45]
 v_pk_add_f32 v[146:147],v[146:147],v[44:45]
 v_pk_add_f32 v[148:149],v[148:149],v[48:49]
 v_pk_add_f32 v[150:151],v[150:151],v[48:49]
 v_pk_add_f32 v[152:153],v[152:153],v[52:53]
 v_pk_add_f32 v[154:155],v[154:155],v[52:53]
 v_pk_add_f32 v[156:157],v[156:157],v[56:57]
 v_pk_add_f32 v[158:159],v[158:159],v[56:57]
 v_pk_add_f32 v[160:161],v[160:161],v[44:45]
 v_pk_add_f32 v[162:163],v[162:163],v[44:45]
 v_pk_add_f32 v[164:165],v[164:165],v[48:49]
 v_pk_add_f32 v[166:167],v[166:167],v[48:49]
 v_pk_add_f32 v[168:169],v[168:169],v[52:53]
 v_pk_add_f32 v[170:171],v[170:171],v[52:53]
 v_pk_add_f32 v[172:173],v[172:173],v[56:57]
 v_pk_add_f32 v[174:175],v[174:175],v[56:57]
 v_pk_add_f32 v[176:177],v[176:177],v[44:45]
 v_pk_add_f32 v[178:179],v[178:179],v[44:45]
 v_pk_add_f32 v[180:181],v[180:181],v[48:49]
 v_pk_add_f32 v[182:183],v[182:183],v[48:49]
 v_pk_add_f32 v[184:185],v[184:185],v[52:53]
 v_pk_add_f32 v[186:187],v[186:187],v[52:53]
 v_pk_add_f32 v[188:189],v[188:189],v[56:57]
 v_pk_add_f32 v[190:191],v[190:191],v[56:57]
 v_exp_f32 v128,v128
 v_exp_f32 v129,v129
 v_exp_f32 v130,v130
 v_exp_f32 v131,v131
 v_cvt_pk_bf16_f32 v192,v128,v129
 v_exp_f32 v144,v144
 v_exp_f32 v145,v145
 v_cvt_pk_bf16_f32 v193,v130,v131
 v_exp_f32 v146,v146
 v_exp_f32 v147,v147
 v_cvt_pk_bf16_f32 v194,v144,v145
 v_exp_f32 v132,v132
 v_exp_f32 v133,v133
 v_cvt_pk_bf16_f32 v195,v146,v147
 v_exp_f32 v134,v134
 v_exp_f32 v135,v135
 v_cvt_pk_bf16_f32 v196,v132,v133
 v_exp_f32 v148,v148
 v_exp_f32 v149,v149
 v_cvt_pk_bf16_f32 v197,v134,v135
 v_exp_f32 v150,v150
 v_exp_f32 v151,v151
 v_cvt_pk_bf16_f32 v198,v148,v149
 v_exp_f32 v136,v136
 v_exp_f32 v137,v137
 v_cvt_pk_bf16_f32 v199,v150,v151
 v_exp_f32 v138,v138
 v_exp_f32 v139,v139
 v_cvt_pk_bf16_f32 v200,v136,v137
 v_exp_f32 v152,v152
 v_exp_f32 v153,v153
 v_cvt_pk_bf16_f32 v201,v138,v139
 v_exp_f32 v154,v154
 v_exp_f32 v155,v155
 v_cvt_pk_bf16_f32 v202,v152,v153
 v_exp_f32 v140,v140
 v_exp_f32 v141,v141
 v_cvt_pk_bf16_f32 v203,v154,v155
 v_exp_f32 v142,v142
 v_exp_f32 v143,v143
 v_cvt_pk_bf16_f32 v204,v140,v141
 v_exp_f32 v156,v156
 v_exp_f32 v157,v157
 v_cvt_pk_bf16_f32 v205,v142,v143
 v_exp_f32 v158,v158
 v_exp_f32 v159,v159
 v_cvt_pk_bf16_f32 v206,v156,v157
 s_nop 0
 v_cvt_pk_bf16_f32 v207,v158,v159
 v_exp_f32 v160,v160
 v_exp_f32 v161,v161
 v_exp_f32 v162,v162
 v_exp_f32 v163,v163
 v_cvt_pk_bf16_f32 v208,v160,v161
 v_exp_f32 v176,v176
 v_exp_f32 v177,v177
 v_cvt_pk_bf16_f32 v209,v162,v163
 v_exp_f32 v178,v178
 v_exp_f32 v179,v179
 v_cvt_pk_bf16_f32 v210,v176,v177
 v_exp_f32 v164,v164
 v_exp_f32 v165,v165
 v_cvt_pk_bf16_f32 v211,v178,v179
 v_exp_f32 v166,v166
 v_exp_f32 v167,v167
 v_cvt_pk_bf16_f32 v212,v164,v165
 v_exp_f32 v180,v180
 v_exp_f32 v181,v181
 v_cvt_pk_bf16_f32 v213,v166,v167
 v_exp_f32 v182,v182
 v_exp_f32 v183,v183
 v_cvt_pk_bf16_f32 v214,v180,v181
 s_nop 0
 v_cvt_pk_bf16_f32 v215,v182,v183
 s_waitcnt lgkmcnt(4)
 s_branch L_attn_entry
L_hook:
L_stub_a_5:
 s_cbranch_execz L_stub_a_9
 s_cmp_eq_u32 s44,2
 s_cbranch_scc1 L_hook_b
 s_cmp_eq_u32 s44,1
 s_cbranch_scc1 L_hook_c
 buffer_atomic_add v30,v31,s[4:7],s50 offen sc0 sc1
 s_branch L_hook_ret
L_hook_b:
 v_add_u32 v30,1,v30
 buffer_store_dword v30,v31,s[4:7],s51 offen sc1
 s_branch L_hook_ret
L_hook_c:
 s_mov_b64 exec,0
 s_cmp_eq_u32 s3,0
 s_cbranch_scc1 L_stub_b_0
 s_cmp_eq_u32 s3,4096
 s_cbranch_scc1 L_stub_b_1
 s_cmp_eq_u32 s3,8192
 s_cbranch_scc1 L_stub_b_2
 s_branch L_warm_b_ret
L_warm_b_ret:
 s_mov_b64 exec,-1
 v_lshrrev_b32 v31,2,v1
 s_movk_i32 s50,12288
 buffer_load_dword v63,v62,s[4:7],s51 offen sc1
 buffer_load_dword v30,v31,s[4:7],s50 offen sc1
 s_branch L_hook_ret
.p2align 6
L_attn_loop:
L_stub_a_6:
 s_cbranch_execz L_warm_a_ret
 v_mfma_f32_16x16x32_bf16 a[64:67],a[160:163],v[224:227],a[64:67]
 v_exp_f32 v160,v160
 v_mfma_f32_16x16x32_bf16 a[64:67],a[164:167],v[240:243],a[64:67]
 ds_read_b128 a[128:131],v4 offset:16384
 v_mfma_f32_16x16x32_bf16 a[68:71],a[164:167],v[244:247],a[68:71]
 s_cmp_le_u32 s44,3
 v_exp_f32 v161,v161
 v_mfma_f32_16x16x32_bf16 a[68:71],a[160:163],v[228:231],a[68:71]
 ds_read_b128 a[132:135],v5 offset:16384
 v_cvt_pk_bf16_f32 v208,v160,v161
 v_mfma_f32_16x16x32_bf16 a[72:75],a[160:163],v[232:235],a[72:75]
 s_cbranch_scc1 L_hook
L_hook_ret:
 v_exp_f32 v162,v162
 v_mfma_f32_16x16x32_bf16 a[72:75],a[164:167],v[248:251],a[72:75]
 ds_read_b128 a[136:139],v6 offset:16384
 v_mfma_f32_16x16x32_bf16 a[76:79],a[164:167],v[252:255],a[76:79]
 v_exp_f32 v163,v163
 v_mfma_f32_16x16x32_bf16 a[76:79],a[160:163],v[236:239],a[76:79]
 ds_read_b128 a[140:143],v7 offset:16384
 v_cvt_pk_bf16_f32 v209,v162,v163
 v_mfma_f32_16x16x32_bf16 a[92:95],a[168:171],v[236:239],a[92:95]
 v_exp_f32 v176,v176
 v_mfma_f32_16x16x32_bf16 a[92:95],a[172:175],v[252:255],a[92:95]
 ds_read_b128 a[144:147],v4 offset:20480
 v_mfma_f32_16x16x32_bf16 a[88:91],a[172:175],v[248:251],a[88:91]
 v_exp_f32 v177,v177
 v_mfma_f32_16x16x32_bf16 a[88:91],a[168:171],v[232:235],a[88:91]
 ds_read_b128 a[148:151],v5 offset:20480
 v_cvt_pk_bf16_f32 v210,v176,v177
 v_mfma_f32_16x16x32_bf16 a[84:87],a[168:171],v[228:231],a[84:87]
 v_exp_f32 v178,v178
 v_mfma_f32_16x16x32_bf16 a[84:87],a[172:175],v[244:247],a[84:87]
 ds_read_b128 a[152:155],v6 offset:20480
 v_mfma_f32_16x16x32_bf16 a[80:83],a[172:175],v[240:243],a[80:83]
 v_exp_f32 v179,v179
 v_mfma_f32_16x16x32_bf16 a[80:83],a[168:171],v[224:227],a[80:83]
 ds_read_b128 a[156:159],v7 offset:20480
 v_cvt_pk_bf16_f32 v211,v178,v179
 v_mfma_f32_16x16x32_bf16 a[96:99],a[176:179],v[224:227],a[96:99]
 s_add_u32 m0,s3,0
 v_exp_f32 v164,v164
 v_mfma_f32_16x16x32_bf16 a[96:99],a[180:183],v[240:243],a[96:99]
 buffer_load_dwordx4 v24,s[12:15],s42 offen offset:0 lds
 v_mfma_f32_16x16x32_bf16 a[100:103],a[180:183],v[244:247],a[100:103]
 v_exp_f32 v165,v165
 v_mfma_f32_16x16x32_bf16 a[100:103],a[176:179],v[228:231],a[100:103]
 ds_read_b64_tr_b16 a[160:161],v8 offset:0
 v_cvt_pk_bf16_f32 v212,v164,v165
 v_mfma_f32_16x16x32_bf16 a[104:107],a[176:179],v[232:235],a[104:107]
 v_exp_f32 v166,v166
 v_mfma_f32_16x16x32_bf16 a[104:107],a[180:183],v[248:251],a[104:107]
 ds_read_b64_tr_b16 a[162:163],v8 offset:4096
 v_mfma_f32_16x16x32_bf16 a[108:111],a[180:183],v[252:255],a[108:111]
 v_exp_f32 v167,v167
 v_mfma_f32_16x16x32_bf16 a[108:111],a[176:179],v[236:239],a[108:111]
 buffer_load_dword a255,v61,s[60:63],s77 offen
 v_cvt_pk_bf16_f32 v213,v166,v167
 v_mfma_f32_16x16x32_bf16 a[124:127],a[184:187],v[236:239],a[124:127]
 v_exp_f32 v180,v180
 v_mfma_f32_16x16x32_bf16 a[124:127],a[188:191],v[252:255],a[124:127]
 buffer_load_dwordx4 v25,s[12:15],s42 offen offset:1024 lds
 v_mfma_f32_16x16x32_bf16 a[120:123],a[188:191],v[248:251],a[120:123]
 v_exp_f32 v181,v181
 v_mfma_f32_16x16x32_bf16 a[120:123],a[184:187],v[232:235],a[120:123]
 ds_read_b64_tr_b16 a[164:165],v8 offset:8192
 v_cvt_pk_bf16_f32 v214,v180,v181
 v_mfma_f32_16x16x32_bf16 a[116:119],a[184:187],v[228:231],a[116:119]
 v_exp_f32 v182,v182
 v_mfma_f32_16x16x32_bf16 a[116:119],a[188:191],v[244:247],a[116:119]
 ds_read_b64_tr_b16 a[166:167],v8 offset:12288
 v_mfma_f32_16x16x32_bf16 a[112:115],a[188:191],v[240:243],a[112:115]
 v_exp_f32 v183,v183
 v_mfma_f32_16x16x32_bf16 a[112:115],a[184:187],v[224:227],a[112:115]
 s_waitcnt lgkmcnt(4)
 v_cvt_pk_bf16_f32 v215,v182,v183
 v_smfmac_f32_16x16x64_bf16 v[36:39],v[20:23],v[240:247],v60
 v_smfmac_f32_16x16x64_bf16 v[40:43],v[20:23],v[248:255],v60
L_attn_entry:
L_stub_a_7:
 s_cbranch_execz L_warm_a_ret
 v_mfma_f32_16x16x32_bf16 v[128:131],a[128:131],v[64:67],v[44:47]
 v_exp_f32 v168,v168
 v_mfma_f32_16x16x32_bf16 v[128:131],a[132:135],v[68:71],v[128:131]
 ds_read_b64_tr_b16 a[168:169],v9 offset:0
 v_mfma_f32_16x16x32_bf16 v[128:131],a[136:139],v[72:75],v[128:131]
L_stub_a_8:
 s_cbranch_execz L_warm_a_ret
 v_exp_f32 v169,v169
 v_mfma_f32_16x16x32_bf16 v[128:131],a[140:143],v[76:79],v[128:131]
 ds_read_b64_tr_b16 a[170:171],v9 offset:4096
 v_cvt_pk_bf16_f32 v216,v168,v169
 v_mfma_f32_16x16x32_bf16 v[132:135],a[140:143],v[92:95],v[48:51]
 v_exp_f32 v170,v170
 v_mfma_f32_16x16x32_bf16 v[132:135],a[136:139],v[88:91],v[132:135]
 ds_read_b64_tr_b16 a[172:173],v9 offset:8192
 v_mfma_f32_16x16x32_bf16 v[132:135],a[132:135],v[84:87],v[132:135]
 v_exp_f32 v171,v171
 v_mfma_f32_16x16x32_bf16 v[132:135],a[128:131],v[80:83],v[132:135]
 ds_read_b64_tr_b16 a[174:175],v9 offset:12288
 v_cvt_pk_bf16_f32 v217,v170,v171
 v_mfma_f32_16x16x32_bf16 v[136:139],a[128:131],v[96:99],v[52:55]
 v_exp_f32 v184,v184
 v_mfma_f32_16x16x32_bf16 v[136:139],a[132:135],v[100:103],v[136:139]
 ds_read_b64_tr_b16 a[176:177],v10 offset:0
 v_mfma_f32_16x16x32_bf16 v[136:139],a[136:139],v[104:107],v[136:139]
 v_exp_f32 v185,v185
 v_mfma_f32_16x16x32_bf16 v[136:139],a[140:143],v[108:111],v[136:139]
 ds_read_b64_tr_b16 a[178:179],v10 offset:4096
 v_cvt_pk_bf16_f32 v218,v184,v185
 v_mfma_f32_16x16x32_bf16 v[140:143],a[140:143],v[124:127],v[56:59]
 v_exp_f32 v186,v186
 v_mfma_f32_16x16x32_bf16 v[140:143],a[136:139],v[120:123],v[140:143]
 ds_read_b64_tr_b16 a[180:181],v10 offset:8192
 v_mfma_f32_16x16x32_bf16 v[140:143],a[132:135],v[116:119],v[140:143]
 v_exp_f32 v187,v187
 v_mfma_f32_16x16x32_bf16 v[140:143],a[128:131],v[112:115],v[140:143]
 ds_read_b64_tr_b16 a[182:183],v10 offset:12288
 v_cvt_pk_bf16_f32 v219,v186,v187
 v_mfma_f32_16x16x32_bf16 v[156:159],a[144:147],v[112:115],v[56:59]
 v_exp_f32 v172,v172
 v_mfma_f32_16x16x32_bf16 v[156:159],a[148:151],v[116:119],v[156:159]
 ds_read_b64_tr_b16 a[184:185],v11 offset:0
 v_mfma_f32_16x16x32_bf16 v[156:159],a[152:155],v[120:123],v[156:159]
 v_exp_f32 v173,v173
 v_mfma_f32_16x16x32_bf16 v[156:159],a[156:159],v[124:127],v[156:159]
 ds_read_b64_tr_b16 a[186:187],v11 offset:4096
 v_cvt_pk_bf16_f32 v220,v172,v173
 v_mfma_f32_16x16x32_bf16 v[152:155],a[156:159],v[108:111],v[52:55]
 v_exp_f32 v174,v174
 v_mfma_f32_16x16x32_bf16 v[152:155],a[152:155],v[104:107],v[152:155]
 ds_read_b64_tr_b16 a[188:189],v11 offset:8192
 v_mfma_f32_16x16x32_bf16 v[152:155],a[148:151],v[100:103],v[152:155]
 v_exp_f32 v175,v175
 v_mfma_f32_16x16x32_bf16 v[152:155],a[144:147],v[96:99],v[152:155]
 ds_read_b64_tr_b16 a[190:191],v11 offset:12288
 v_cvt_pk_bf16_f32 v221,v174,v175
 v_mfma_f32_16x16x32_bf16 v[148:151],a[144:147],v[80:83],v[48:51]
 v_exp_f32 v188,v188
 v_mfma_f32_16x16x32_bf16 v[148:151],a[148:151],v[84:87],v[148:151]
 buffer_load_dwordx4 v26,s[12:15],s42 offen offset:2048 lds
 v_mfma_f32_16x16x32_bf16 v[148:151],a[152:155],v[88:91],v[148:151]
 v_exp_f32 v189,v189
 v_mfma_f32_16x16x32_bf16 v[148:151],a[156:159],v[92:95],v[148:151]
 v_cvt_pk_bf16_f32 v222,v188,v189
 v_mfma_f32_16x16x32_bf16 v[144:147],a[156:159],v[76:79],v[44:47]
 v_exp_f32 v190,v190
 v_mfma_f32_16x16x32_bf16 v[144:147],a[152:155],v[72:75],v[144:147]
 buffer_load_dwordx4 v27,s[12:15],s42 offen offset:3072 lds
 v_mfma_f32_16x16x32_bf16 v[144:147],a[148:151],v[68:71],v[144:147]
 s_add_u32 s42,s42,0x4000
 v_exp_f32 v191,v191
 v_mfma_f32_16x16x32_bf16 v[144:147],a[144:147],v[64:67],v[144:147]
 s_waitcnt lgkmcnt(0)
 v_cvt_pk_bf16_f32 v223,v190,v191
 v_mfma_f32_16x16x32_bf16 a[0:3],a[160:163],v[192:195],a[0:3]
 v_exp_f32 v128,v128
 v_mfma_f32_16x16x32_bf16 a[0:3],a[164:167],v[208:211],a[0:3]
 ds_read_b128 a[128:131],v4 offset:24576
 v_mfma_f32_16x16x32_bf16 a[4:7],a[164:167],v[212:215],a[4:7]
 v_exp_f32 v129,v129
 v_mfma_f32_16x16x32_bf16 a[4:7],a[160:163],v[196:199],a[4:7]
 ds_read_b128 a[132:135],v5 offset:24576
 v_cvt_pk_bf16_f32 v224,v128,v129
 v_mfma_f32_16x16x32_bf16 a[8:11],a[160:163],v[200:203],a[8:11]
 v_exp_f32 v130,v130
 v_mfma_f32_16x16x32_bf16 a[8:11],a[164:167],v[216:219],a[8:11]
 ds_read_b128 a[136:139],v6 offset:24576
 v_mfma_f32_16x16x32_bf16 a[12:15],a[164:167],v[220:223],a[12:15]
 v_exp_f32 v131,v131
 v_mfma_f32_16x16x32_bf16 a[12:15],a[160:163],v[204:207],a[12:15]
 ds_read_b128 a[140:143],v7 offset:24576
 v_cvt_pk_bf16_f32 v225,v130,v131
 v_mfma_f32_16x16x32_bf16 a[28:31],a[168:171],v[204:207],a[28:31]
 v_exp_f32 v144,v144
 v_mfma_f32_16x16x32_bf16 a[28:31],a[172:175],v[220:223],a[28:31]
 ds_read_b128 a[144:147],v4 offset:28672
 v_mfma_f32_16x16x32_bf16 a[24:27],a[172:175],v[216:219],a[24:27]
 v_exp_f32 v145,v145
 v_mfma_f32_16x16x32_bf16 a[24:27],a[168:171],v[200:203],a[24:27]
 ds_read_b128 a[148:151],v5 offset:28672
 v_cvt_pk_bf16_f32 v226,v144,v145
 v_mfma_f32_16x16x32_bf16 a[20:23],a[168:171],v[196:199],a[20:23]
 v_exp_f32 v146,v146
 v_mfma_f32_16x16x32_bf16 a[20:23],a[172:175],v[212:215],a[20:23]
 ds_read_b128 a[152:155],v6 offset:28672
 v_mfma_f32_16x16x32_bf16 a[16:19],a[172:175],v[208:211],a[16:19]
 v_exp_f32 v147,v147
 v_mfma_f32_16x16x32_bf16 a[16:19],a[168:171],v[192:195],a[16:19]
 ds_read_b128 a[156:159],v7 offset:28672
 v_cvt_pk_bf16_f32 v227,v146,v147
 v_mfma_f32_16x16x32_bf16 a[32:35],a[176:179],v[192:195],a[32:35]
 s_add_u32 m0,s3,114688
 v_exp_f32 v132,v132
 v_mfma_f32_16x16x32_bf16 a[32:35],a[180:183],v[208:211],a[32:35]
 buffer_load_dwordx4 v28,s[16:19],s43 offen offset:0 lds
 v_mfma_f32_16x16x32_bf16 a[36:39],a[180:183],v[212:215],a[36:39]
 v_exp_f32 v133,v133
 v_mfma_f32_16x16x32_bf16 a[36:39],a[176:179],v[196:199],a[36:39]
 ds_read_b64_tr_b16 a[160:161],v12 offset:0
 v_cvt_pk_bf16_f32 v228,v132,v133
 v_mfma_f32_16x16x32_bf16 a[40:43],a[176:179],v[200:203],a[40:43]
 v_exp_f32 v134,v134
 v_mfma_f32_16x16x32_bf16 a[40:43],a[180:183],v[216:219],a[40:43]
 ds_read_b64_tr_b16 a[162:163],v12 offset:4096
 v_mfma_f32_16x16x32_bf16 a[44:47],a[180:183],v[220:223],a[44:47]
 v_exp_f32 v135,v135
 v_mfma_f32_16x16x32_bf16 a[44:47],a[176:179],v[204:207],a[44:47]
 buffer_store_dwordx4 v[16:19],v1,s[8:11],s40 offen offset:0 sc1
 v_cvt_pk_bf16_f32 v229,v134,v135
 v_mfma_f32_16x16x32_bf16 a[60:63],a[184:187],v[204:207],a[60:63]
 v_exp_f32 v148,v148
 v_mfma_f32_16x16x32_bf16 a[60:63],a[188:191],v[220:223],a[60:63]
 buffer_load_dwordx4 v29,s[16:19],s43 offen offset:1024 lds
 v_mfma_f32_16x16x32_bf16 a[56:59],a[188:191],v[216:219],a[56:59]
 v_exp_f32 v149,v149
 v_mfma_f32_16x16x32_bf16 a[56:59],a[184:187],v[200:203],a[56:59]
 ds_read_b64_tr_b16 a[164:165],v12 offset:8192
 v_cvt_pk_bf16_f32 v230,v148,v149
 v_mfma_f32_16x16x32_bf16 a[52:55],a[184:187],v[196:199],a[52:55]
 v_exp_f32 v150,v150
 v_mfma_f32_16x16x32_bf16 a[52:55],a[188:191],v[212:215],a[52:55]
 ds_read_b64_tr_b16 a[166:167],v12 offset:12288
 v_mfma_f32_16x16x32_bf16 a[48:51],a[188:191],v[208:211],a[48:51]
 v_exp_f32 v151,v151
 v_mfma_f32_16x16x32_bf16 a[48:51],a[184:187],v[192:195],a[48:51]
 s_waitcnt lgkmcnt(4)
 v_cvt_pk_bf16_f32 v231,v150,v151
 v_smfmac_f32_16x16x64_bf16 v[36:39],v[20:23],v[192:199],v60
 v_smfmac_f32_16x16x64_bf16 v[40:43],v[20:23],v[200:207],v60
 v_mfma_f32_16x16x32_bf16 v[160:163],a[128:131],v[64:67],v[44:47]
 v_exp_f32 v136,v136
 v_mfma_f32_16x16x32_bf16 v[160:163],a[132:135],v[68:71],v[160:163]
 ds_read_b64_tr_b16 a[168:169],v13 offset:0
 v_mfma_f32_16x16x32_bf16 v[160:163],a[136:139],v[72:75],v[160:163]
 v_exp_f32 v137,v137
 v_mfma_f32_16x16x32_bf16 v[160:163],a[140:143],v[76:79],v[160:163]
 ds_read_b64_tr_b16 a[170:171],v13 offset:4096
 v_cvt_pk_bf16_f32 v232,v136,v137
 v_mfma_f32_16x16x32_bf16 v[164:167],a[140:143],v[92:95],v[48:51]
 v_exp_f32 v138,v138
 v_mfma_f32_16x16x32_bf16 v[164:167],a[136:139],v[88:91],v[164:167]
 ds_read_b64_tr_b16 a[172:173],v13 offset:8192
 v_mfma_f32_16x16x32_bf16 v[164:167],a[132:135],v[84:87],v[164:167]
 v_exp_f32 v139,v139
 v_mfma_f32_16x16x32_bf16 v[164:167],a[128:131],v[80:83],v[164:167]
 ds_read_b64_tr_b16 a[174:175],v13 offset:12288
 v_cvt_pk_bf16_f32 v233,v138,v139
 v_mfma_f32_16x16x32_bf16 v[168:171],a[128:131],v[96:99],v[52:55]
 v_exp_f32 v152,v152
 v_mfma_f32_16x16x32_bf16 v[168:171],a[132:135],v[100:103],v[168:171]
 ds_read_b64_tr_b16 a[176:177],v14 offset:0
 v_mfma_f32_16x16x32_bf16 v[168:171],a[136:139],v[104:107],v[168:171]
 v_exp_f32 v153,v153
 v_mfma_f32_16x16x32_bf16 v[168:171],a[140:143],v[108:111],v[168:171]
 ds_read_b64_tr_b16 a[178:179],v14 offset:4096
 v_cvt_pk_bf16_f32 v234,v152,v153
 v_mfma_f32_16x16x32_bf16 v[172:175],a[140:143],v[124:127],v[56:59]
 v_exp_f32 v154,v154
 v_mfma_f32_16x16x32_bf16 v[172:175],a[136:139],v[120:123],v[172:175]
 ds_read_b64_tr_b16 a[180:181],v14 offset:8192
 v_mfma_f32_16x16x32_bf16 v[172:175],a[132:135],v[116:119],v[172:175]
 v_exp_f32 v155,v155
 v_mfma_f32_16x16x32_bf16 v[172:175],a[128:131],v[112:115],v[172:175]
 ds_read_b64_tr_b16 a[182:183],v14 offset:12288
 v_cvt_pk_bf16_f32 v235,v154,v155
 v_mfma_f32_16x16x32_bf16 v[188:191],a[144:147],v[112:115],v[56:59]
 v_exp_f32 v140,v140
 v_mfma_f32_16x16x32_bf16 v[188:191],a[148:151],v[116:119],v[188:191]
 ds_read_b64_tr_b16 a[184:185],v15 offset:0
 v_mfma_f32_16x16x32_bf16 v[188:191],a[152:155],v[120:123],v[188:191]
 v_exp_f32 v141,v141
 v_mfma_f32_16x16x32_bf16 v[188:191],a[156:159],v[124:127],v[188:191]
 ds_read_b64_tr_b16 a[186:187],v15 offset:4096
 v_cvt_pk_bf16_f32 v236,v140,v141
 v_mfma_f32_16x16x32_bf16 v[184:187],a[156:159],v[108:111],v[52:55]
 v_exp_f32 v142,v142
 v_mfma_f32_16x16x32_bf16 v[184:187],a[152:155],v[104:107],v[184:187]
 ds_read_b64_tr_b16 a[188:189],v15 offset:8192
 v_mfma_f32_16x16x32_bf16 v[184:187],a[148:151],v[100:103],v[184:187]
 v_exp_f32 v143,v143
 v_mfma_f32_16x16x32_bf16 v[184:187],a[144:147],v[96:99],v[184:187]
 ds_read_b64_tr_b16 a[190:191],v15 offset:12288
 v_cvt_pk_bf16_f32 v237,v142,v143
 v_mfma_f32_16x16x32_bf16 v[180:183],a[144:147],v[80:83],v[48:51]
 v_exp_f32 v156,v156
 v_mfma_f32_16x16x32_bf16 v[180:183],a[148:151],v[84:87],v[180:183]
 buffer_load_dwordx4 v28,s[16:19],s43 offen offset:2048 lds
 v_mfma_f32_16x16x32_bf16 v[180:183],a[152:155],v[88:91],v[180:183]
 v_exp_f32 v157,v157
 v_mfma_f32_16x16x32_bf16 v[180:183],a[156:159],v[92:95],v[180:183]
 v_cvt_pk_bf16_f32 v238,v156,v157
 v_mfma_f32_16x16x32_bf16 v[176:179],a[156:159],v[76:79],v[44:47]
 v_exp_f32 v158,v158
 v_mfma_f32_16x16x32_bf16 v[176:179],a[152:155],v[72:75],v[176:179]
 buffer_load_dwordx4 v29,s[16:19],s43 offen offset:3072 lds
 v_mfma_f32_16x16x32_bf16 v[176:179],a[148:151],v[68:71],v[176:179]
 s_add_u32 s43,s43,0x4000
 v_exp_f32 v159,v159
 v_mfma_f32_16x16x32_bf16 v[176:179],a[144:147],v[64:67],v[176:179]
 s_waitcnt vmcnt(19) lgkmcnt(0)
 s_barrier
 v_cvt_pk_bf16_f32 v239,v158,v159
 v_mfma_f32_16x16x32_bf16 a[64:67],a[160:163],v[192:195],a[64:67]
 v_exp_f32 v160,v160
 v_mfma_f32_16x16x32_bf16 a[64:67],a[164:167],v[208:211],a[64:67]
 ds_read_b128 a[128:131],v4 offset:32768
 v_mfma_f32_16x16x32_bf16 a[68:71],a[164:167],v[212:215],a[68:71]
 v_exp_f32 v161,v161
 v_mfma_f32_16x16x32_bf16 a[68:71],a[160:163],v[196:199],a[68:71]
 ds_read_b128 a[132:135],v5 offset:32768
 v_cvt_pk_bf16_f32 v240,v160,v161
 v_mfma_f32_16x16x32_bf16 a[72:75],a[160:163],v[200:203],a[72:75]
 v_exp_f32 v162,v162
 v_mfma_f32_16x16x32_bf16 a[72:75],a[164:167],v[216:219],a[72:75]
 ds_read_b128 a[136:139],v6 offset:32768
 v_mfma_f32_16x16x32_bf16 a[76:79],a[164:167],v[220:223],a[76:79]
 v_exp_f32 v163,v163
 v_mfma_f32_16x16x32_bf16 a[76:79],a[160:163],v[204:207],a[76:79]
 ds_read_b128 a[140:143],v7 offset:32768
 v_cvt_pk_bf16_f32 v241,v162,v163
 v_mfma_f32_16x16x32_bf16 a[92:95],a[168:171],v[204:207],a[92:95]
 v_exp_f32 v176,v176
 v_mfma_f32_16x16x32_bf16 a[92:95],a[172:175],v[220:223],a[92:95]
 ds_read_b128 a[144:147],v4 offset:36864
 v_mfma_f32_16x16x32_bf16 a[88:91],a[172:175],v[216:219],a[88:91]
 v_exp_f32 v177,v177
 v_mfma_f32_16x16x32_bf16 a[88:91],a[168:171],v[200:203],a[88:91]
 ds_read_b128 a[148:151],v5 offset:36864
 v_cvt_pk_bf16_f32 v242,v176,v177
 v_mfma_f32_16x16x32_bf16 a[84:87],a[168:171],v[196:199],a[84:87]
 v_exp_f32 v178,v178
 v_mfma_f32_16x16x32_bf16 a[84:87],a[172:175],v[212:215],a[84:87]
 ds_read_b128 a[152:155],v6 offset:36864
 v_mfma_f32_16x16x32_bf16 a[80:83],a[172:175],v[208:211],a[80:83]
 v_exp_f32 v179,v179
 v_mfma_f32_16x16x32_bf16 a[80:83],a[168:171],v[192:195],a[80:83]
 ds_read_b128 a[156:159],v7 offset:36864
 v_cvt_pk_bf16_f32 v243,v178,v179
 v_mfma_f32_16x16x32_bf16 a[96:99],a[176:179],v[192:195],a[96:99]
 s_add_u32 m0,s3,16384
 v_exp_f32 v164,v164
 v_mfma_f32_16x16x32_bf16 a[96:99],a[180:183],v[208:211],a[96:99]
 buffer_load_dwordx4 v24,s[12:15],s42 offen offset:0 lds
 v_mfma_f32_16x16x32_bf16 a[100:103],a[180:183],v[212:215],a[100:103]
 v_exp_f32 v165,v165
 v_mfma_f32_16x16x32_bf16 a[100:103],a[176:179],v[196:199],a[100:103]
 ds_read_b64_tr_b16 a[160:161],v8 offset:16384
 v_cvt_pk_bf16_f32 v244,v164,v165
 v_mfma_f32_16x16x32_bf16 a[104:107],a[176:179],v[200:203],a[104:107]
 v_exp_f32 v166,v166
 v_mfma_f32_16x16x32_bf16 a[104:107],a[180:183],v[216:219],a[104:107]
 ds_read_b64_tr_b16 a[162:163],v8 offset:20480
 v_mfma_f32_16x16x32_bf16 a[108:111],a[180:183],v[220:223],a[108:111]
 v_exp_f32 v167,v167
 v_mfma_f32_16x16x32_bf16 a[108:111],a[176:179],v[204:207],a[108:111]
 buffer_load_dword a255,v61,s[64:67],s76 offen
 v_cvt_pk_bf16_f32 v245,v166,v167
 v_mfma_f32_16x16x32_bf16 a[124:127],a[184:187],v[204:207],a[124:127]
 v_exp_f32 v180,v180
 v_mfma_f32_16x16x32_bf16 a[124:127],a[188:191],v[220:223],a[124:127]
 buffer_load_dwordx4 v25,s[12:15],s42 offen offset:1024 lds
 v_mfma_f32_16x16x32_bf16 a[120:123],a[188:191],v[216:219],a[120:123]
 v_exp_f32 v181,v181
 v_mfma_f32_16x16x32_bf16 a[120:123],a[184:187],v[200:203],a[120:123]
 ds_read_b64_tr_b16 a[164:165],v8 offset:24576
 v_cvt_pk_bf16_f32 v246,v180,v181
 v_mfma_f32_16x16x32_bf16 a[116:119],a[184:187],v[196:199],a[116:119]
 v_exp_f32 v182,v182
 v_mfma_f32_16x16x32_bf16 a[116:119],a[188:191],v[212:215],a[116:119]
 ds_read_b64_tr_b16 a[166:167],v8 offset:28672
 v_mfma_f32_16x16x32_bf16 a[112:115],a[188:191],v[208:211],a[112:115]
 v_exp_f32 v183,v183
 v_mfma_f32_16x16x32_bf16 a[112:115],a[184:187],v[192:195],a[112:115]
 s_waitcnt lgkmcnt(4)
 v_cvt_pk_bf16_f32 v247,v182,v183
 v_smfmac_f32_16x16x64_bf16 v[36:39],v[20:23],v[208:215],v60
 v_smfmac_f32_16x16x64_bf16 v[40:43],v[20:23],v[216:223],v60
 v_mfma_f32_16x16x32_bf16 v[128:131],a[128:131],v[64:67],v[44:47]
 v_exp_f32 v168,v168
 v_mfma_f32_16x16x32_bf16 v[128:131],a[132:135],v[68:71],v[128:131]
 ds_read_b64_tr_b16 a[168:169],v9 offset:16384
 v_mfma_f32_16x16x32_bf16 v[128:131],a[136:139],v[72:75],v[128:131]
 v_exp_f32 v169,v169
 v_mfma_f32_16x16x32_bf16 v[128:131],a[140:143],v[76:79],v[128:131]
 ds_read_b64_tr_b16 a[170:171],v9 offset:20480
 v_cvt_pk_bf16_f32 v248,v168,v169
 v_mfma_f32_16x16x32_bf16 v[132:135],a[140:143],v[92:95],v[48:51]
 v_exp_f32 v170,v170
 v_mfma_f32_16x16x32_bf16 v[132:135],a[136:139],v[88:91],v[132:135]
 ds_read_b64_tr_b16 a[172:173],v9 offset:24576
 v_mfma_f32_16x16x32_bf16 v[132:135],a[132:135],v[84:87],v[132:135]
 v_exp_f32 v171,v171
 v_mfma_f32_16x16x32_bf16 v[132:135],a[128:131],v[80:83],v[132:135]
 ds_read_b64_tr_b16 a[174:175],v9 offset:28672
 v_cvt_pk_bf16_f32 v249,v170,v171
 v_mfma_f32_16x16x32_bf16 v[136:139],a[128:131],v[96:99],v[52:55]
 v_exp_f32 v184,v184
 v_mfma_f32_16x16x32_bf16 v[136:139],a[132:135],v[100:103],v[136:139]
 ds_read_b64_tr_b16 a[176:177],v10 offset:16384
 v_mfma_f32_16x16x32_bf16 v[136:139],a[136:139],v[104:107],v[136:139]
 v_exp_f32 v185,v185
 v_mfma_f32_16x16x32_bf16 v[136:139],a[140:143],v[108:111],v[136:139]
 ds_read_b64_tr_b16 a[178:179],v10 offset:20480
 v_cvt_pk_bf16_f32 v250,v184,v185
 v_mfma_f32_16x16x32_bf16 v[140:143],a[140:143],v[124:127],v[56:59]
 v_exp_f32 v186,v186
 v_mfma_f32_16x16x32_bf16 v[140:143],a[136:139],v[120:123],v[140:143]
 ds_read_b64_tr_b16 a[180:181],v10 offset:24576
 v_mfma_f32_16x16x32_bf16 v[140:143],a[132:135],v[116:119],v[140:143]
 v_exp_f32 v187,v187
 v_mfma_f32_16x16x32_bf16 v[140:143],a[128:131],v[112:115],v[140:143]
 ds_read_b64_tr_b16 a[182:183],v10 offset:28672
 v_cvt_pk_bf16_f32 v251,v186,v187
 v_mfma_f32_16x16x32_bf16 v[156:159],a[144:147],v[112:115],v[56:59]
 v_exp_f32 v172,v172
 v_mfma_f32_16x16x32_bf16 v[156:159],a[148:151],v[116:119],v[156:159]
 ds_read_b64_tr_b16 a[184:185],v11 offset:16384
 v_mfma_f32_16x16x32_bf16 v[156:159],a[152:155],v[120:123],v[156:159]
 v_exp_f32 v173,v173
 v_mfma_f32_16x16x32_bf16 v[156:159],a[156:159],v[124:127],v[156:159]
 ds_read_b64_tr_b16 a[186:187],v11 offset:20480
 v_cvt_pk_bf16_f32 v252,v172,v173
 v_mfma_f32_16x16x32_bf16 v[152:155],a[156:159],v[108:111],v[52:55]
 v_exp_f32 v174,v174
 v_mfma_f32_16x16x32_bf16 v[152:155],a[152:155],v[104:107],v[152:155]
 ds_read_b64_tr_b16 a[188:189],v11 offset:24576
 v_mfma_f32_16x16x32_bf16 v[152:155],a[148:151],v[100:103],v[152:155]
 v_exp_f32 v175,v175
 v_mfma_f32_16x16x32_bf16 v[152:155],a[144:147],v[96:99],v[152:155]
 ds_read_b64_tr_b16 a[190:191],v11 offset:28672
 v_cvt_pk_bf16_f32 v253,v174,v175
 v_mfma_f32_16x16x32_bf16 v[148:151],a[144:147],v[80:83],v[48:51]
 v_exp_f32 v188,v188
 v_mfma_f32_16x16x32_bf16 v[148:151],a[148:151],v[84:87],v[148:151]
 buffer_load_dwordx4 v26,s[12:15],s42 offen offset:2048 lds
 v_mfma_f32_16x16x32_bf16 v[148:151],a[152:155],v[88:91],v[148:151]
 v_exp_f32 v189,v189
 v_mfma_f32_16x16x32_bf16 v[148:151],a[156:159],v[92:95],v[148:151]
 v_cvt_pk_bf16_f32 v254,v188,v189
 v_mfma_f32_16x16x32_bf16 v[144:147],a[156:159],v[76:79],v[44:47]
 v_exp_f32 v190,v190
 v_mfma_f32_16x16x32_bf16 v[144:147],a[152:155],v[72:75],v[144:147]
 buffer_load_dwordx4 v27,s[12:15],s42 offen offset:3072 lds
 v_mfma_f32_16x16x32_bf16 v[144:147],a[148:151],v[68:71],v[144:147]
 s_add_u32 s42,s42,0x4000
 v_exp_f32 v191,v191
 v_mfma_f32_16x16x32_bf16 v[144:147],a[144:147],v[64:67],v[144:147]
 s_waitcnt lgkmcnt(0)
 v_cvt_pk_bf16_f32 v255,v190,v191
 v_mfma_f32_16x16x32_bf16 a[0:3],a[160:163],v[224:227],a[0:3]
 v_exp_f32 v128,v128
 v_mfma_f32_16x16x32_bf16 a[0:3],a[164:167],v[240:243],a[0:3]
 ds_read_b128 a[128:131],v4 offset:40960
 v_mfma_f32_16x16x32_bf16 a[4:7],a[164:167],v[244:247],a[4:7]
 v_exp_f32 v129,v129
 v_mfma_f32_16x16x32_bf16 a[4:7],a[160:163],v[228:231],a[4:7]
 ds_read_b128 a[132:135],v5 offset:40960
 v_cvt_pk_bf16_f32 v192,v128,v129
 v_mfma_f32_16x16x32_bf16 a[8:11],a[160:163],v[232:235],a[8:11]
 v_exp_f32 v130,v130
 v_mfma_f32_16x16x32_bf16 a[8:11],a[164:167],v[248:251],a[8:11]
 ds_read_b128 a[136:139],v6 offset:40960
 v_mfma_f32_16x16x32_bf16 a[12:15],a[164:167],v[252:255],a[12:15]
 v_exp_f32 v131,v131
 v_mfma_f32_16x16x32_bf16 a[12:15],a[160:163],v[236:239],a[12:15]
 ds_read_b128 a[140:143],v7 offset:40960
 v_cvt_pk_bf16_f32 v193,v130,v131
 v_mfma_f32_16x16x32_bf16 a[28:31],a[168:171],v[236:239],a[28:31]
 v_exp_f32 v144,v144
 v_mfma_f32_16x16x32_bf16 a[28:31],a[172:175],v[252:255],a[28:31]
 ds_read_b128 a[144:147],v4 offset:45056
 v_mfma_f32_16x16x32_bf16 a[24:27],a[172:175],v[248:251],a[24:27]
 v_exp_f32 v145,v145
 v_mfma_f32_16x16x32_bf16 a[24:27],a[168:171],v[232:235],a[24:27]
 ds_read_b128 a[148:151],v5 offset:45056
 v_cvt_pk_bf16_f32 v194,v144,v145
 v_mfma_f32_16x16x32_bf16 a[20:23],a[168:171],v[228:231],a[20:23]
 v_exp_f32 v146,v146
 v_mfma_f32_16x16x32_bf16 a[20:23],a[172:175],v[244:247],a[20:23]
 ds_read_b128 a[152:155],v6 offset:45056
 v_mfma_f32_16x16x32_bf16 a[16:19],a[172:175],v[240:243],a[16:19]
 v_exp_f32 v147,v147
 v_mfma_f32_16x16x32_bf16 a[16:19],a[168:171],v[224:227],a[16:19]
 ds_read_b128 a[156:159],v7 offset:45056
 v_cvt_pk_bf16_f32 v195,v146,v147
 v_mfma_f32_16x16x32_bf16 a[32:35],a[176:179],v[224:227],a[32:35]
 s_add_u32 m0,s3,65536
 v_exp_f32 v132,v132
 v_mfma_f32_16x16x32_bf16 a[32:35],a[180:183],v[240:243],a[32:35]
 buffer_load_dwordx4 v28,s[16:19],s43 offen offset:0 lds
 v_mfma_f32_16x16x32_bf16 a[36:39],a[180:183],v[244:247],a[36:39]
 v_exp_f32 v133,v133
 v_mfma_f32_16x16x32_bf16 a[36:39],a[176:179],v[228:231],a[36:39]
 ds_read_b64_tr_b16 a[160:161],v12 offset:16384
 v_cvt_pk_bf16_f32 v196,v132,v133
 v_mfma_f32_16x16x32_bf16 a[40:43],a[176:179],v[232:235],a[40:43]
 v_exp_f32 v134,v134
 v_mfma_f32_16x16x32_bf16 a[40:43],a[180:183],v[248:251],a[40:43]
 ds_read_b64_tr_b16 a[162:163],v12 offset:20480
 v_mfma_f32_16x16x32_bf16 a[44:47],a[180:183],v[252:255],a[44:47]
 v_exp_f32 v135,v135
 v_mfma_f32_16x16x32_bf16 a[44:47],a[176:179],v[236:239],a[44:47]
 buffer_store_dwordx4 v[16:19],v1,s[8:11],s59 offen offset:1024 sc1
 v_cvt_pk_bf16_f32 v197,v134,v135
 v_mfma_f32_16x16x32_bf16 a[60:63],a[184:187],v[236:239],a[60:63]
 v_exp_f32 v148,v148
 v_mfma_f32_16x16x32_bf16 a[60:63],a[188:191],v[252:255],a[60:63]
 buffer_load_dwordx4 v29,s[16:19],s43 offen offset:1024 lds
 v_mfma_f32_16x16x32_bf16 a[56:59],a[188:191],v[248:251],a[56:59]
 v_exp_f32 v149,v149
 v_mfma_f32_16x16x32_bf16 a[56:59],a[184:187],v[232:235],a[56:59]
 ds_read_b64_tr_b16 a[164:165],v12 offset:24576
 v_cvt_pk_bf16_f32 v198,v148,v149
 v_mfma_f32_16x16x32_bf16 a[52:55],a[184:187],v[228:231],a[52:55]
 s_add_u32 s59,s59,1024
 v_exp_f32 v150,v150
 v_mfma_f32_16x16x32_bf16 a[52:55],a[188:191],v[244:247],a[52:55]
 ds_read_b64_tr_b16 a[166:167],v12 offset:28672
 v_mfma_f32_16x16x32_bf16 a[48:51],a[188:191],v[240:243],a[48:51]
 v_exp_f32 v151,v151
 v_mfma_f32_16x16x32_bf16 a[48:51],a[184:187],v[224:227],a[48:51]
 s_waitcnt lgkmcnt(4)
 v_cvt_pk_bf16_f32 v199,v150,v151
 v_smfmac_f32_16x16x64_bf16 v[36:39],v[20:23],v[224:231],v60
 v_smfmac_f32_16x16x64_bf16 v[40:43],v[20:23],v[232:239],v60
 v_mfma_f32_16x16x32_bf16 v[160:163],a[128:131],v[64:67],v[44:47]
 v_exp_f32 v136,v136
 v_mfma_f32_16x16x32_bf16 v[160:163],a[132:135],v[68:71],v[160:163]
 ds_read_b64_tr_b16 a[168:169],v13 offset:16384
 v_mfma_f32_16x16x32_bf16 v[160:163],a[136:139],v[72:75],v[160:163]
 v_exp_f32 v137,v137
 v_mfma_f32_16x16x32_bf16 v[160:163],a[140:143],v[76:79],v[160:163]
 ds_read_b64_tr_b16 a[170:171],v13 offset:20480
 v_cvt_pk_bf16_f32 v200,v136,v137
 v_mfma_f32_16x16x32_bf16 v[164:167],a[140:143],v[92:95],v[48:51]
 v_exp_f32 v138,v138
 v_mfma_f32_16x16x32_bf16 v[164:167],a[136:139],v[88:91],v[164:167]
 ds_read_b64_tr_b16 a[172:173],v13 offset:24576
 v_mfma_f32_16x16x32_bf16 v[164:167],a[132:135],v[84:87],v[164:167]
 v_exp_f32 v139,v139
 v_mfma_f32_16x16x32_bf16 v[164:167],a[128:131],v[80:83],v[164:167]
 ds_read_b64_tr_b16 a[174:175],v13 offset:28672
 v_cvt_pk_bf16_f32 v201,v138,v139
 v_mfma_f32_16x16x32_bf16 v[168:171],a[128:131],v[96:99],v[52:55]
 v_exp_f32 v152,v152
 v_mfma_f32_16x16x32_bf16 v[168:171],a[132:135],v[100:103],v[168:171]
 ds_read_b64_tr_b16 a[176:177],v14 offset:16384
 v_mfma_f32_16x16x32_bf16 v[168:171],a[136:139],v[104:107],v[168:171]
 v_exp_f32 v153,v153
 v_mfma_f32_16x16x32_bf16 v[168:171],a[140:143],v[108:111],v[168:171]
 ds_read_b64_tr_b16 a[178:179],v14 offset:20480
 v_cvt_pk_bf16_f32 v202,v152,v153
 v_mfma_f32_16x16x32_bf16 v[172:175],a[140:143],v[124:127],v[56:59]
 v_exp_f32 v154,v154
 v_mfma_f32_16x16x32_bf16 v[172:175],a[136:139],v[120:123],v[172:175]
 ds_read_b64_tr_b16 a[180:181],v14 offset:24576
 v_mfma_f32_16x16x32_bf16 v[172:175],a[132:135],v[116:119],v[172:175]
 v_exp_f32 v155,v155
 v_mfma_f32_16x16x32_bf16 v[172:175],a[128:131],v[112:115],v[172:175]
 ds_read_b64_tr_b16 a[182:183],v14 offset:28672
 v_cvt_pk_bf16_f32 v203,v154,v155
 v_mfma_f32_16x16x32_bf16 v[188:191],a[144:147],v[112:115],v[56:59]
 v_exp_f32 v140,v140
 v_mfma_f32_16x16x32_bf16 v[188:191],a[148:151],v[116:119],v[188:191]
 ds_read_b64_tr_b16 a[184:185],v15 offset:16384
 v_mfma_f32_16x16x32_bf16 v[188:191],a[152:155],v[120:123],v[188:191]
 v_exp_f32 v141,v141
 v_mfma_f32_16x16x32_bf16 v[188:191],a[156:159],v[124:127],v[188:191]
 ds_read_b64_tr_b16 a[186:187],v15 offset:20480
 v_cvt_pk_bf16_f32 v204,v140,v141
 v_mfma_f32_16x16x32_bf16 v[184:187],a[156:159],v[108:111],v[52:55]
 v_exp_f32 v142,v142
 v_mfma_f32_16x16x32_bf16 v[184:187],a[152:155],v[104:107],v[184:187]
 ds_read_b64_tr_b16 a[188:189],v15 offset:24576
 v_mfma_f32_16x16x32_bf16 v[184:187],a[148:151],v[100:103],v[184:187]
 v_exp_f32 v143,v143
 v_mfma_f32_16x16x32_bf16 v[184:187],a[144:147],v[96:99],v[184:187]
 ds_read_b64_tr_b16 a[190:191],v15 offset:28672
 v_cvt_pk_bf16_f32 v205,v142,v143
 v_mfma_f32_16x16x32_bf16 v[180:183],a[144:147],v[80:83],v[48:51]
 v_exp_f32 v156,v156
 v_mfma_f32_16x16x32_bf16 v[180:183],a[148:151],v[84:87],v[180:183]
 buffer_load_dwordx4 v28,s[16:19],s43 offen offset:2048 lds
 v_mfma_f32_16x16x32_bf16 v[180:183],a[152:155],v[88:91],v[180:183]
 v_exp_f32 v157,v157
 v_mfma_f32_16x16x32_bf16 v[180:183],a[156:159],v[92:95],v[180:183]
 v_cvt_pk_bf16_f32 v206,v156,v157
 v_mfma_f32_16x16x32_bf16 v[176:179],a[156:159],v[76:79],v[44:47]
 v_exp_f32 v158,v158
 v_mfma_f32_16x16x32_bf16 v[176:179],a[152:155],v[72:75],v[176:179]
 buffer_load_dwordx4 v29,s[16:19],s43 offen offset:3072 lds
 v_mfma_f32_16x16x32_bf16 v[176:179],a[148:151],v[68:71],v[176:179]
 s_add_u32 s43,s43,0x4000
 v_exp_f32 v159,v159
 v_mfma_f32_16x16x32_bf16 v[176:179],a[144:147],v[64:67],v[176:179]
 s_waitcnt vmcnt(20) lgkmcnt(0)
 s_barrier
 v_cvt_pk_bf16_f32 v207,v158,v159
 v_mfma_f32_16x16x32_bf16 a[64:67],a[160:163],v[224:227],a[64:67]
 v_exp_f32 v160,v160
 v_mfma_f32_16x16x32_bf16 a[64:67],a[164:167],v[240:243],a[64:67]
 ds_read_b128 a[128:131],v4 offset:49152
 v_mfma_f32_16x16x32_bf16 a[68:71],a[164:167],v[244:247],a[68:71]
 v_exp_f32 v161,v161
 v_mfma_f32_16x16x32_bf16 a[68:71],a[160:163],v[228:231],a[68:71]
 ds_read_b128 a[132:135],v5 offset:49152
 v_cvt_pk_bf16_f32 v208,v160,v161
 v_mfma_f32_16x16x32_bf16 a[72:75],a[160:163],v[232:235],a[72:75]
 v_exp_f32 v162,v162
 v_mfma_f32_16x16x32_bf16 a[72:75],a[164:167],v[248:251],a[72:75]
 ds_read_b128 a[136:139],v6 offset:49152
 v_mfma_f32_16x16x32_bf16 a[76:79],a[164:167],v[252:255],a[76:79]
 v_exp_f32 v163,v163
 v_mfma_f32_16x16x32_bf16 a[76:79],a[160:163],v[236:239],a[76:79]
 ds_read_b128 a[140:143],v7 offset:49152
 v_cvt_pk_bf16_f32 v209,v162,v163
 v_mfma_f32_16x16x32_bf16 a[92:95],a[168:171],v[236:239],a[92:95]
 v_exp_f32 v176,v176
 v_mfma_f32_16x16x32_bf16 a[92:95],a[172:175],v[252:255],a[92:95]
 ds_read_b128 a[144:147],v4 offset:53248
 v_mfma_f32_16x16x32_bf16 a[88:91],a[172:175],v[248:251],a[88:91]
 v_exp_f32 v177,v177
 v_mfma_f32_16x16x32_bf16 a[88:91],a[168:171],v[232:235],a[88:91]
 ds_read_b128 a[148:151],v5 offset:53248
 v_cvt_pk_bf16_f32 v210,v176,v177
 v_mfma_f32_16x16x32_bf16 a[84:87],a[168:171],v[228:231],a[84:87]
 v_exp_f32 v178,v178
 v_mfma_f32_16x16x32_bf16 a[84:87],a[172:175],v[244:247],a[84:87]
 ds_read_b128 a[152:155],v6 offset:53248
 v_mfma_f32_16x16x32_bf16 a[80:83],a[172:175],v[240:243],a[80:83]
 v_exp_f32 v179,v179
 v_mfma_f32_16x16x32_bf16 a[80:83],a[168:171],v[224:227],a[80:83]
 ds_read_b128 a[156:159],v7 offset:53248
 v_cvt_pk_bf16_f32 v211,v178,v179
 v_mfma_f32_16x16x32_bf16 a[96:99],a[176:179],v[224:227],a[96:99]
 s_add_u32 m0,s3,32768
 v_exp_f32 v164,v164
 v_mfma_f32_16x16x32_bf16 a[96:99],a[180:183],v[240:243],a[96:99]
 buffer_load_dwordx4 v24,s[12:15],s42 offen offset:0 lds
 v_mfma_f32_16x16x32_bf16 a[100:103],a[180:183],v[244:247],a[100:103]
 v_exp_f32 v165,v165
 v_mfma_f32_16x16x32_bf16 a[100:103],a[176:179],v[228:231],a[100:103]
 ds_read_b64_tr_b16 a[160:161],v8 offset:32768
 v_cvt_pk_bf16_f32 v212,v164,v165
 v_mfma_f32_16x16x32_bf16 a[104:107],a[176:179],v[232:235],a[104:107]
 v_exp_f32 v166,v166
 v_mfma_f32_16x16x32_bf16 a[104:107],a[180:183],v[248:251],a[104:107]
 ds_read_b64_tr_b16 a[162:163],v8 offset:36864
 v_mfma_f32_16x16x32_bf16 a[108:111],a[180:183],v[252:255],a[108:111]
 v_exp_f32 v167,v167
 v_mfma_f32_16x16x32_bf16 a[108:111],a[176:179],v[236:239],a[108:111]
 buffer_load_dword a255,v61,s[68:71],s76 offen
 v_cvt_pk_bf16_f32 v213,v166,v167
 v_mfma_f32_16x16x32_bf16 a[124:127],a[184:187],v[236:239],a[124:127]
 v_exp_f32 v180,v180
 v_mfma_f32_16x16x32_bf16 a[124:127],a[188:191],v[252:255],a[124:127]
 buffer_load_dwordx4 v25,s[12:15],s42 offen offset:1024 lds
 v_mfma_f32_16x16x32_bf16 a[120:123],a[188:191],v[248:251],a[120:123]
 v_exp_f32 v181,v181
 v_mfma_f32_16x16x32_bf16 a[120:123],a[184:187],v[232:235],a[120:123]
 ds_read_b64_tr_b16 a[164:165],v8 offset:40960
 v_cvt_pk_bf16_f32 v214,v180,v181
 v_mfma_f32_16x16x32_bf16 a[116:119],a[184:187],v[228:231],a[116:119]
 v_exp_f32 v182,v182
 v_mfma_f32_16x16x32_bf16 a[116:119],a[188:191],v[244:247],a[116:119]
 ds_read_b64_tr_b16 a[166:167],v8 offset:45056
 v_mfma_f32_16x16x32_bf16 a[112:115],a[188:191],v[240:243],a[112:115]
L_stub_a_9:
 s_cbranch_execz L_warm_a_ret
 v_exp_f32 v183,v183
 v_mfma_f32_16x16x32_bf16 a[112:115],a[184:187],v[224:227],a[112:115]
 s_waitcnt lgkmcnt(4)
 v_cvt_pk_bf16_f32 v215,v182,v183
 v_smfmac_f32_16x16x64_bf16 v[36:39],v[20:23],v[240:247],v60
 v_smfmac_f32_16x16x64_bf16 v[40:43],v[20:23],v[248:255],v60
 v_mfma_f32_16x16x32_bf16 v[128:131],a[128:131],v[64:67],v[44:47]
 v_exp_f32 v168,v168
 v_mfma_f32_16x16x32_bf16 v[128:131],a[132:135],v[68:71],v[128:131]
 ds_read_b64_tr_b16 a[168:169],v9 offset:32768
 v_mfma_f32_16x16x32_bf16 v[128:131],a[136:139],v[72:75],v[128:131]
 v_exp_f32 v169,v169
 v_mfma_f32_16x16x32_bf16 v[128:131],a[140:143],v[76:79],v[128:131]
 ds_read_b64_tr_b16 a[170:171],v9 offset:36864
 v_cvt_pk_bf16_f32 v216,v168,v169
 v_mfma_f32_16x16x32_bf16 v[132:135],a[140:143],v[92:95],v[48:51]
 v_exp_f32 v170,v170
 v_mfma_f32_16x16x32_bf16 v[132:135],a[136:139],v[88:91],v[132:135]
 ds_read_b64_tr_b16 a[172:173],v9 offset:40960
 v_mfma_f32_16x16x32_bf16 v[132:135],a[132:135],v[84:87],v[132:135]
 v_exp_f32 v171,v171
 v_mfma_f32_16x16x32_bf16 v[132:135],a[128:131],v[80:83],v[132:135]
 ds_read_b64_tr_b16 a[174:175],v9 offset:45056
 v_cvt_pk_bf16_f32 v217,v170,v171
 v_mfma_f32_16x16x32_bf16 v[136:139],a[128:131],v[96:99],v[52:55]
 v_exp_f32 v184,v184
 v_mfma_f32_16x16x32_bf16 v[136:139],a[132:135],v[100:103],v[136:139]
 ds_read_b64_tr_b16 a[176:177],v10 offset:32768
 v_mfma_f32_16x16x32_bf16 v[136:139],a[136:139],v[104:107],v[136:139]
 v_exp_f32 v185,v185
 v_mfma_f32_16x16x32_bf16 v[136:139],a[140:143],v[108:111],v[136:139]
 ds_read_b64_tr_b16 a[178:179],v10 offset:36864
 v_cvt_pk_bf16_f32 v218,v184,v185
 v_mfma_f32_16x16x32_bf16 v[140:143],a[140:143],v[124:127],v[56:59]
 v_exp_f32 v186,v186
 v_mfma_f32_16x16x32_bf16 v[140:143],a[136:139],v[120:123],v[140:143]
 ds_read_b64_tr_b16 a[180:181],v10 offset:40960
 v_mfma_f32_16x16x32_bf16 v[140:143],a[132:135],v[116:119],v[140:143]
 v_exp_f32 v187,v187
 v_mfma_f32_16x16x32_bf16 v[140:143],a[128:131],v[112:115],v[140:143]
 ds_read_b64_tr_b16 a[182:183],v10 offset:45056
 v_cvt_pk_bf16_f32 v219,v186,v187
 v_mfma_f32_16x16x32_bf16 v[156:159],a[144:147],v[112:115],v[56:59]
 v_exp_f32 v172,v172
 v_mfma_f32_16x16x32_bf16 v[156:159],a[148:151],v[116:119],v[156:159]
 ds_read_b64_tr_b16 a[184:185],v11 offset:32768
 v_mfma_f32_16x16x32_bf16 v[156:159],a[152:155],v[120:123],v[156:159]
 v_exp_f32 v173,v173
 v_mfma_f32_16x16x32_bf16 v[156:159],a[156:159],v[124:127],v[156:159]
 ds_read_b64_tr_b16 a[186:187],v11 offset:36864
 v_cvt_pk_bf16_f32 v220,v172,v173
 v_mfma_f32_16x16x32_bf16 v[152:155],a[156:159],v[108:111],v[52:55]
 v_exp_f32 v174,v174
 v_mfma_f32_16x16x32_bf16 v[152:155],a[152:155],v[104:107],v[152:155]
 ds_read_b64_tr_b16 a[188:189],v11 offset:40960
 v_mfma_f32_16x16x32_bf16 v[152:155],a[148:151],v[100:103],v[152:155]
 v_exp_f32 v175,v175
 v_mfma_f32_16x16x32_bf16 v[152:155],a[144:147],v[96:99],v[152:155]
 ds_read_b64_tr_b16 a[190:191],v11 offset:45056
 v_cvt_pk_bf16_f32 v221,v174,v175
 v_mfma_f32_16x16x32_bf16 v[148:151],a[144:147],v[80:83],v[48:51]
 v_exp_f32 v188,v188
 v_mfma_f32_16x16x32_bf16 v[148:151],a[148:151],v[84:87],v[148:151]
 buffer_load_dwordx4 v26,s[12:15],s42 offen offset:2048 lds
 v_mfma_f32_16x16x32_bf16 v[148:151],a[152:155],v[88:91],v[148:151]
 v_exp_f32 v189,v189
 v_mfma_f32_16x16x32_bf16 v[148:151],a[156:159],v[92:95],v[148:151]
 v_cvt_pk_bf16_f32 v222,v188,v189
 v_mfma_f32_16x16x32_bf16 v[144:147],a[156:159],v[76:79],v[44:47]
 v_exp_f32 v190,v190
 v_mfma_f32_16x16x32_bf16 v[144:147],a[152:155],v[72:75],v[144:147]
 buffer_load_dwordx4 v27,s[12:15],s42 offen offset:3072 lds
 v_mfma_f32_16x16x32_bf16 v[144:147],a[148:151],v[68:71],v[144:147]
 s_add_u32 s42,s42,0x4000
 v_exp_f32 v191,v191
 v_mfma_f32_16x16x32_bf16 v[144:147],a[144:147],v[64:67],v[144:147]
 s_waitcnt lgkmcnt(0)
 v_cvt_pk_bf16_f32 v223,v190,v191
 v_mfma_f32_16x16x32_bf16 a[0:3],a[160:163],v[192:195],a[0:3]
 v_exp_f32 v128,v128
 v_mfma_f32_16x16x32_bf16 a[0:3],a[164:167],v[208:211],a[0:3]
 ds_read_b128 a[128:131],v4 offset:57344
 v_mfma_f32_16x16x32_bf16 a[4:7],a[164:167],v[212:215],a[4:7]
 v_exp_f32 v129,v129
 v_mfma_f32_16x16x32_bf16 a[4:7],a[160:163],v[196:199],a[4:7]
 ds_read_b128 a[132:135],v5 offset:57344
 v_cvt_pk_bf16_f32 v224,v128,v129
 v_mfma_f32_16x16x32_bf16 a[8:11],a[160:163],v[200:203],a[8:11]
 v_exp_f32 v130,v130
 v_mfma_f32_16x16x32_bf16 a[8:11],a[164:167],v[216:219],a[8:11]
 ds_read_b128 a[136:139],v6 offset:57344
 v_mfma_f32_16x16x32_bf16 a[12:15],a[164:167],v[220:223],a[12:15]
 v_exp_f32 v131,v131
 v_mfma_f32_16x16x32_bf16 a[12:15],a[160:163],v[204:207],a[12:15]
 ds_read_b128 a[140:143],v7 offset:57344
 v_cvt_pk_bf16_f32 v225,v130,v131
 v_mfma_f32_16x16x32_bf16 a[28:31],a[168:171],v[204:207],a[28:31]
 v_exp_f32 v144,v144
 v_mfma_f32_16x16x32_bf16 a[28:31],a[172:175],v[220:223],a[28:31]
 ds_read_b128 a[144:147],v4 offset:61440
 v_mfma_f32_16x16x32_bf16 a[24:27],a[172:175],v[216:219],a[24:27]
 v_exp_f32 v145,v145
 v_mfma_f32_16x16x32_bf16 a[24:27],a[168:171],v[200:203],a[24:27]
 ds_read_b128 a[148:151],v5 offset:61440
 v_cvt_pk_bf16_f32 v226,v144,v145
 v_mfma_f32_16x16x32_bf16 a[20:23],a[168:171],v[196:199],a[20:23]
 v_exp_f32 v146,v146
 v_mfma_f32_16x16x32_bf16 a[20:23],a[172:175],v[212:215],a[20:23]
 ds_read_b128 a[152:155],v6 offset:61440
 v_mfma_f32_16x16x32_bf16 a[16:19],a[172:175],v[208:211],a[16:19]
 v_exp_f32 v147,v147
 v_mfma_f32_16x16x32_bf16 a[16:19],a[168:171],v[192:195],a[16:19]
 ds_read_b128 a[156:159],v7 offset:61440
 v_cvt_pk_bf16_f32 v227,v146,v147
 v_mfma_f32_16x16x32_bf16 a[32:35],a[176:179],v[192:195],a[32:35]
 s_add_u32 m0,s3,81920
 v_exp_f32 v132,v132
 v_mfma_f32_16x16x32_bf16 a[32:35],a[180:183],v[208:211],a[32:35]
 buffer_load_dwordx4 v28,s[16:19],s43 offen offset:0 lds
 v_mfma_f32_16x16x32_bf16 a[36:39],a[180:183],v[212:215],a[36:39]
 v_exp_f32 v133,v133
 v_mfma_f32_16x16x32_bf16 a[36:39],a[176:179],v[196:199],a[36:39]
 ds_read_b64_tr_b16 a[160:161],v12 offset:32768
 v_cvt_pk_bf16_f32 v228,v132,v133
 v_mfma_f32_16x16x32_bf16 a[40:43],a[176:179],v[200:203],a[40:43]
 v_exp_f32 v134,v134
 v_mfma_f32_16x16x32_bf16 a[40:43],a[180:183],v[216:219],a[40:43]
 ds_read_b64_tr_b16 a[162:163],v12 offset:36864
 v_mfma_f32_16x16x32_bf16 a[44:47],a[180:183],v[220:223],a[44:47]
 v_exp_f32 v135,v135
 v_mfma_f32_16x16x32_bf16 a[44:47],a[176:179],v[204:207],a[44:47]
 buffer_store_dwordx4 v[16:19],v1,s[8:11],s40 offen offset:1024 sc1
 v_cvt_pk_bf16_f32 v229,v134,v135
 v_mfma_f32_16x16x32_bf16 a[60:63],a[184:187],v[204:207],a[60:63]
 v_exp_f32 v148,v148
 v_mfma_f32_16x16x32_bf16 a[60:63],a[188:191],v[220:223],a[60:63]
 buffer_load_dwordx4 v29,s[16:19],s43 offen offset:1024 lds
 v_mfma_f32_16x16x32_bf16 a[56:59],a[188:191],v[216:219],a[56:59]
 v_exp_f32 v149,v149
 v_mfma_f32_16x16x32_bf16 a[56:59],a[184:187],v[200:203],a[56:59]
 ds_read_b64_tr_b16 a[164:165],v12 offset:40960
 v_cvt_pk_bf16_f32 v230,v148,v149
 v_mfma_f32_16x16x32_bf16 a[52:55],a[184:187],v[196:199],a[52:55]
 s_add_u32 s40,s40,2048
 v_exp_f32 v150,v150
 v_mfma_f32_16x16x32_bf16 a[52:55],a[188:191],v[212:215],a[52:55]
 ds_read_b64_tr_b16 a[166:167],v12 offset:45056
 v_mfma_f32_16x16x32_bf16 a[48:51],a[188:191],v[208:211],a[48:51]
 s_min_u32 s40,s40,s58
 v_exp_f32 v151,v151
 v_mfma_f32_16x16x32_bf16 a[48:51],a[184:187],v[192:195],a[48:51]
 s_waitcnt lgkmcnt(4)
 v_cvt_pk_bf16_f32 v231,v150,v151
 v_smfmac_f32_16x16x64_bf16 v[36:39],v[20:23],v[192:199],v60
 v_smfmac_f32_16x16x64_bf16 v[40:43],v[20:23],v[200:207],v60
 v_mfma_f32_16x16x32_bf16 v[160:163],a[128:131],v[64:67],v[44:47]
 v_exp_f32 v136,v136
 v_mfma_f32_16x16x32_bf16 v[160:163],a[132:135],v[68:71],v[160:163]
 ds_read_b64_tr_b16 a[168:169],v13 offset:32768
 v_mfma_f32_16x16x32_bf16 v[160:163],a[136:139],v[72:75],v[160:163]
 v_exp_f32 v137,v137
 v_mfma_f32_16x16x32_bf16 v[160:163],a[140:143],v[76:79],v[160:163]
 ds_read_b64_tr_b16 a[170:171],v13 offset:36864
 v_cvt_pk_bf16_f32 v232,v136,v137
 v_mfma_f32_16x16x32_bf16 v[164:167],a[140:143],v[92:95],v[48:51]
 v_exp_f32 v138,v138
 v_mfma_f32_16x16x32_bf16 v[164:167],a[136:139],v[88:91],v[164:167]
 ds_read_b64_tr_b16 a[172:173],v13 offset:40960
 v_mfma_f32_16x16x32_bf16 v[164:167],a[132:135],v[84:87],v[164:167]
 v_exp_f32 v139,v139
 v_mfma_f32_16x16x32_bf16 v[164:167],a[128:131],v[80:83],v[164:167]
 ds_read_b64_tr_b16 a[174:175],v13 offset:45056
 v_cvt_pk_bf16_f32 v233,v138,v139
 v_mfma_f32_16x16x32_bf16 v[168:171],a[128:131],v[96:99],v[52:55]
 v_exp_f32 v152,v152
 v_mfma_f32_16x16x32_bf16 v[168:171],a[132:135],v[100:103],v[168:171]
 ds_read_b64_tr_b16 a[176:177],v14 offset:32768
 v_mfma_f32_16x16x32_bf16 v[168:171],a[136:139],v[104:107],v[168:171]
 v_exp_f32 v153,v153
 v_mfma_f32_16x16x32_bf16 v[168:171],a[140:143],v[108:111],v[168:171]
 ds_read_b64_tr_b16 a[178:179],v14 offset:36864
 v_cvt_pk_bf16_f32 v234,v152,v153
 v_mfma_f32_16x16x32_bf16 v[172:175],a[140:143],v[124:127],v[56:59]
 v_exp_f32 v154,v154
 v_mfma_f32_16x16x32_bf16 v[172:175],a[136:139],v[120:123],v[172:175]
 ds_read_b64_tr_b16 a[180:181],v14 offset:40960
 v_mfma_f32_16x16x32_bf16 v[172:175],a[132:135],v[116:119],v[172:175]
 v_exp_f32 v155,v155
 v_mfma_f32_16x16x32_bf16 v[172:175],a[128:131],v[112:115],v[172:175]
 ds_read_b64_tr_b16 a[182:183],v14 offset:45056
 v_cvt_pk_bf16_f32 v235,v154,v155
 v_mfma_f32_16x16x32_bf16 v[188:191],a[144:147],v[112:115],v[56:59]
 v_exp_f32 v140,v140
 v_mfma_f32_16x16x32_bf16 v[188:191],a[148:151],v[116:119],v[188:191]
 ds_read_b64_tr_b16 a[184:185],v15 offset:32768
 v_mfma_f32_16x16x32_bf16 v[188:191],a[152:155],v[120:123],v[188:191]
 v_exp_f32 v141,v141
 v_mfma_f32_16x16x32_bf16 v[188:191],a[156:159],v[124:127],v[188:191]
 ds_read_b64_tr_b16 a[186:187],v15 offset:36864
 v_cvt_pk_bf16_f32 v236,v140,v141
 v_mfma_f32_16x16x32_bf16 v[184:187],a[156:159],v[108:111],v[52:55]
 v_exp_f32 v142,v142
 v_mfma_f32_16x16x32_bf16 v[184:187],a[152:155],v[104:107],v[184:187]
 ds_read_b64_tr_b16 a[188:189],v15 offset:40960
 v_mfma_f32_16x16x32_bf16 v[184:187],a[148:151],v[100:103],v[184:187]
 v_exp_f32 v143,v143
 v_mfma_f32_16x16x32_bf16 v[184:187],a[144:147],v[96:99],v[184:187]
 ds_read_b64_tr_b16 a[190:191],v15 offset:45056
 v_cvt_pk_bf16_f32 v237,v142,v143
 v_mfma_f32_16x16x32_bf16 v[180:183],a[144:147],v[80:83],v[48:51]
 v_exp_f32 v156,v156
 v_mfma_f32_16x16x32_bf16 v[180:183],a[148:151],v[84:87],v[180:183]
 buffer_load_dwordx4 v28,s[16:19],s43 offen offset:2048 lds
 v_mfma_f32_16x16x32_bf16 v[180:183],a[152:155],v[88:91],v[180:183]
 v_exp_f32 v157,v157
 v_mfma_f32_16x16x32_bf16 v[180:183],a[156:159],v[92:95],v[180:183]
 v_cvt_pk_bf16_f32 v238,v156,v157
 v_mfma_f32_16x16x32_bf16 v[176:179],a[156:159],v[76:79],v[44:47]
 v_exp_f32 v158,v158
 v_mfma_f32_16x16x32_bf16 v[176:179],a[152:155],v[72:75],v[176:179]
 buffer_load_dwordx4 v29,s[16:19],s43 offen offset:3072 lds
 v_mfma_f32_16x16x32_bf16 v[176:179],a[148:151],v[68:71],v[176:179]
 s_add_u32 s43,s43,0x4000
 v_exp_f32 v159,v159
 v_mfma_f32_16x16x32_bf16 v[176:179],a[144:147],v[64:67],v[176:179]
 s_waitcnt vmcnt(20) lgkmcnt(0)
 s_barrier
 v_cvt_pk_bf16_f32 v239,v158,v159
 v_mfma_f32_16x16x32_bf16 a[64:67],a[160:163],v[192:195],a[64:67]
 v_exp_f32 v160,v160
 v_mfma_f32_16x16x32_bf16 a[64:67],a[164:167],v[208:211],a[64:67]
 ds_read_b128 a[128:131],v4 offset:0
 v_mfma_f32_16x16x32_bf16 a[68:71],a[164:167],v[212:215],a[68:71]
 v_exp_f32 v161,v161
 v_mfma_f32_16x16x32_bf16 a[68:71],a[160:163],v[196:199],a[68:71]
 ds_read_b128 a[132:135],v5 offset:0
 v_cvt_pk_bf16_f32 v240,v160,v161
 v_mfma_f32_16x16x32_bf16 a[72:75],a[160:163],v[200:203],a[72:75]
 v_exp_f32 v162,v162
 v_mfma_f32_16x16x32_bf16 a[72:75],a[164:167],v[216:219],a[72:75]
 ds_read_b128 a[136:139],v6 offset:0
 v_mfma_f32_16x16x32_bf16 a[76:79],a[164:167],v[220:223],a[76:79]
 v_exp_f32 v163,v163
 v_mfma_f32_16x16x32_bf16 a[76:79],a[160:163],v[204:207],a[76:79]
 ds_read_b128 a[140:143],v7 offset:0
 v_cvt_pk_bf16_f32 v241,v162,v163
 v_mfma_f32_16x16x32_bf16 a[92:95],a[168:171],v[204:207],a[92:95]
 v_exp_f32 v176,v176
 v_mfma_f32_16x16x32_bf16 a[92:95],a[172:175],v[220:223],a[92:95]
 ds_read_b128 a[144:147],v4 offset:4096
 v_mfma_f32_16x16x32_bf16 a[88:91],a[172:175],v[216:219],a[88:91]
 v_exp_f32 v177,v177
 v_mfma_f32_16x16x32_bf16 a[88:91],a[168:171],v[200:203],a[88:91]
 ds_read_b128 a[148:151],v5 offset:4096
 v_cvt_pk_bf16_f32 v242,v176,v177
 v_mfma_f32_16x16x32_bf16 a[84:87],a[168:171],v[196:199],a[84:87]
 v_exp_f32 v178,v178
 v_mfma_f32_16x16x32_bf16 a[84:87],a[172:175],v[212:215],a[84:87]
 ds_read_b128 a[152:155],v6 offset:4096
 v_mfma_f32_16x16x32_bf16 a[80:83],a[172:175],v[208:211],a[80:83]
 v_exp_f32 v179,v179
 v_mfma_f32_16x16x32_bf16 a[80:83],a[168:171],v[192:195],a[80:83]
 ds_read_b128 a[156:159],v7 offset:4096
 v_cvt_pk_bf16_f32 v243,v178,v179
 v_mfma_f32_16x16x32_bf16 a[96:99],a[176:179],v[192:195],a[96:99]
 s_add_u32 m0,s3,49152
 v_exp_f32 v164,v164
 v_mfma_f32_16x16x32_bf16 a[96:99],a[180:183],v[208:211],a[96:99]
 buffer_load_dwordx4 v24,s[12:15],s42 offen offset:0 lds
 v_mfma_f32_16x16x32_bf16 a[100:103],a[180:183],v[212:215],a[100:103]
 v_exp_f32 v165,v165
 v_mfma_f32_16x16x32_bf16 a[100:103],a[176:179],v[196:199],a[100:103]
 ds_read_b64_tr_b16 a[160:161],v8 offset:49152
 v_cvt_pk_bf16_f32 v244,v164,v165
 v_mfma_f32_16x16x32_bf16 a[104:107],a[176:179],v[200:203],a[104:107]
 v_exp_f32 v166,v166
 v_mfma_f32_16x16x32_bf16 a[104:107],a[180:183],v[216:219],a[104:107]
 ds_read_b64_tr_b16 a[162:163],v8 offset:53248
 v_mfma_f32_16x16x32_bf16 a[108:111],a[180:183],v[220:223],a[108:111]
 v_exp_f32 v167,v167
 v_mfma_f32_16x16x32_bf16 a[108:111],a[176:179],v[204:207],a[108:111]
 buffer_load_dword a255,v61,s[72:75],s76 offen
 v_cvt_pk_bf16_f32 v245,v166,v167
 v_mfma_f32_16x16x32_bf16 a[124:127],a[184:187],v[204:207],a[124:127]
 s_add_u32 s76,s76,8192
 v_exp_f32 v180,v180
 v_mfma_f32_16x16x32_bf16 a[124:127],a[188:191],v[220:223],a[124:127]
 buffer_load_dwordx4 v25,s[12:15],s42 offen offset:1024 lds
 v_mfma_f32_16x16x32_bf16 a[120:123],a[188:191],v[216:219],a[120:123]
 v_exp_f32 v181,v181
 v_mfma_f32_16x16x32_bf16 a[120:123],a[184:187],v[200:203],a[120:123]
 ds_read_b64_tr_b16 a[164:165],v8 offset:57344
 v_cvt_pk_bf16_f32 v246,v180,v181
 v_mfma_f32_16x16x32_bf16 a[116:119],a[184:187],v[196:199],a[116:119]
 v_exp_f32 v182,v182
 v_mfma_f32_16x16x32_bf16 a[116:119],a[188:191],v[212:215],a[116:119]
 ds_read_b64_tr_b16 a[166:167],v8 offset:61440
 v_mfma_f32_16x16x32_bf16 a[112:115],a[188:191],v[208:211],a[112:115]
 v_exp_f32 v183,v183
 v_mfma_f32_16x16x32_bf16 a[112:115],a[184:187],v[192:195],a[112:115]
 s_waitcnt lgkmcnt(4)
 v_cvt_pk_bf16_f32 v247,v182,v183
 v_smfmac_f32_16x16x64_bf16 v[36:39],v[20:23],v[208:215],v60
 v_smfmac_f32_16x16x64_bf16 v[40:43],v[20:23],v[216:223],v60
 v_mfma_f32_16x16x32_bf16 v[128:131],a[128:131],v[64:67],v[44:47]
 v_exp_f32 v168,v168
 v_mfma_f32_16x16x32_bf16 v[128:131],a[132:135],v[68:71],v[128:131]
 ds_read_b64_tr_b16 a[168:169],v9 offset:49152
 v_mfma_f32_16x16x32_bf16 v[128:131],a[136:139],v[72:75],v[128:131]
 v_exp_f32 v169,v169
 v_mfma_f32_16x16x32_bf16 v[128:131],a[140:143],v[76:79],v[128:131]
 ds_read_b64_tr_b16 a[170:171],v9 offset:53248
 v_cvt_pk_bf16_f32 v248,v168,v169
 v_mfma_f32_16x16x32_bf16 v[132:135],a[140:143],v[92:95],v[48:51]
 v_exp_f32 v170,v170
 v_mfma_f32_16x16x32_bf16 v[132:135],a[136:139],v[88:91],v[132:135]
 ds_read_b64_tr_b16 a[172:173],v9 offset:57344
 v_mfma_f32_16x16x32_bf16 v[132:135],a[132:135],v[84:87],v[132:135]
 v_exp_f32 v171,v171
 v_mfma_f32_16x16x32_bf16 v[132:135],a[128:131],v[80:83],v[132:135]
 ds_read_b64_tr_b16 a[174:175],v9 offset:61440
 v_cvt_pk_bf16_f32 v249,v170,v171
 v_mfma_f32_16x16x32_bf16 v[136:139],a[128:131],v[96:99],v[52:55]
 v_exp_f32 v184,v184
 v_mfma_f32_16x16x32_bf16 v[136:139],a[132:135],v[100:103],v[136:139]
 ds_read_b64_tr_b16 a[176:177],v10 offset:49152
 v_mfma_f32_16x16x32_bf16 v[136:139],a[136:139],v[104:107],v[136:139]
 v_exp_f32 v185,v185
 v_mfma_f32_16x16x32_bf16 v[136:139],a[140:143],v[108:111],v[136:139]
 ds_read_b64_tr_b16 a[178:179],v10 offset:53248
 v_cvt_pk_bf16_f32 v250,v184,v185
 v_mfma_f32_16x16x32_bf16 v[140:143],a[140:143],v[124:127],v[56:59]
 v_exp_f32 v186,v186
 v_mfma_f32_16x16x32_bf16 v[140:143],a[136:139],v[120:123],v[140:143]
 ds_read_b64_tr_b16 a[180:181],v10 offset:57344
 v_mfma_f32_16x16x32_bf16 v[140:143],a[132:135],v[116:119],v[140:143]
 v_exp_f32 v187,v187
 v_mfma_f32_16x16x32_bf16 v[140:143],a[128:131],v[112:115],v[140:143]
 ds_read_b64_tr_b16 a[182:183],v10 offset:61440
 v_cvt_pk_bf16_f32 v251,v186,v187
 v_mfma_f32_16x16x32_bf16 v[156:159],a[144:147],v[112:115],v[56:59]
 v_exp_f32 v172,v172
 v_mfma_f32_16x16x32_bf16 v[156:159],a[148:151],v[116:119],v[156:159]
 ds_read_b64_tr_b16 a[184:185],v11 offset:49152
 v_mfma_f32_16x16x32_bf16 v[156:159],a[152:155],v[120:123],v[156:159]
 v_exp_f32 v173,v173
 v_mfma_f32_16x16x32_bf16 v[156:159],a[156:159],v[124:127],v[156:159]
 ds_read_b64_tr_b16 a[186:187],v11 offset:53248
 v_cvt_pk_bf16_f32 v252,v172,v173
 v_mfma_f32_16x16x32_bf16 v[152:155],a[156:159],v[108:111],v[52:55]
 v_exp_f32 v174,v174
 v_mfma_f32_16x16x32_bf16 v[152:155],a[152:155],v[104:107],v[152:155]
 ds_read_b64_tr_b16 a[188:189],v11 offset:57344
 v_mfma_f32_16x16x32_bf16 v[152:155],a[148:151],v[100:103],v[152:155]
 v_exp_f32 v175,v175
 v_mfma_f32_16x16x32_bf16 v[152:155],a[144:147],v[96:99],v[152:155]
 ds_read_b64_tr_b16 a[190:191],v11 offset:61440
 v_cvt_pk_bf16_f32 v253,v174,v175
 v_mfma_f32_16x16x32_bf16 v[148:151],a[144:147],v[80:83],v[48:51]
 v_exp_f32 v188,v188
 v_mfma_f32_16x16x32_bf16 v[148:151],a[148:151],v[84:87],v[148:151]
 buffer_load_dwordx4 v26,s[12:15],s42 offen offset:2048 lds
 v_mfma_f32_16x16x32_bf16 v[148:151],a[152:155],v[88:91],v[148:151]
 v_exp_f32 v189,v189
 v_mfma_f32_16x16x32_bf16 v[148:151],a[156:159],v[92:95],v[148:151]
 v_cvt_pk_bf16_f32 v254,v188,v189
 v_mfma_f32_16x16x32_bf16 v[144:147],a[156:159],v[76:79],v[44:47]
 v_exp_f32 v190,v190
 v_mfma_f32_16x16x32_bf16 v[144:147],a[152:155],v[72:75],v[144:147]
 buffer_load_dwordx4 v27,s[12:15],s42 offen offset:3072 lds
 v_mfma_f32_16x16x32_bf16 v[144:147],a[148:151],v[68:71],v[144:147]
 s_add_u32 s42,s42,0x4000
 v_exp_f32 v191,v191
 v_mfma_f32_16x16x32_bf16 v[144:147],a[144:147],v[64:67],v[144:147]
 s_waitcnt lgkmcnt(0)
 v_cvt_pk_bf16_f32 v255,v190,v191
 v_mfma_f32_16x16x32_bf16 a[0:3],a[160:163],v[224:227],a[0:3]
 v_exp_f32 v128,v128
 v_mfma_f32_16x16x32_bf16 a[0:3],a[164:167],v[240:243],a[0:3]
 ds_read_b128 a[128:131],v4 offset:8192
 v_mfma_f32_16x16x32_bf16 a[4:7],a[164:167],v[244:247],a[4:7]
 v_exp_f32 v129,v129
 v_mfma_f32_16x16x32_bf16 a[4:7],a[160:163],v[228:231],a[4:7]
 ds_read_b128 a[132:135],v5 offset:8192
 v_cvt_pk_bf16_f32 v192,v128,v129
 v_mfma_f32_16x16x32_bf16 a[8:11],a[160:163],v[232:235],a[8:11]
 v_exp_f32 v130,v130
 v_mfma_f32_16x16x32_bf16 a[8:11],a[164:167],v[248:251],a[8:11]
 ds_read_b128 a[136:139],v6 offset:8192
 v_mfma_f32_16x16x32_bf16 a[12:15],a[164:167],v[252:255],a[12:15]
 v_exp_f32 v131,v131
 v_mfma_f32_16x16x32_bf16 a[12:15],a[160:163],v[236:239],a[12:15]
 ds_read_b128 a[140:143],v7 offset:8192
 v_cvt_pk_bf16_f32 v193,v130,v131
 v_mfma_f32_16x16x32_bf16 a[28:31],a[168:171],v[236:239],a[28:31]
 v_exp_f32 v144,v144
 v_mfma_f32_16x16x32_bf16 a[28:31],a[172:175],v[252:255],a[28:31]
 ds_read_b128 a[144:147],v4 offset:12288
 v_mfma_f32_16x16x32_bf16 a[24:27],a[172:175],v[248:251],a[24:27]
 v_exp_f32 v145,v145
 v_mfma_f32_16x16x32_bf16 a[24:27],a[168:171],v[232:235],a[24:27]
 ds_read_b128 a[148:151],v5 offset:12288
 v_cvt_pk_bf16_f32 v194,v144,v145
 v_mfma_f32_16x16x32_bf16 a[20:23],a[168:171],v[228:231],a[20:23]
 v_exp_f32 v146,v146
 v_mfma_f32_16x16x32_bf16 a[20:23],a[172:175],v[244:247],a[20:23]
 ds_read_b128 a[152:155],v6 offset:12288
 v_mfma_f32_16x16x32_bf16 a[16:19],a[172:175],v[240:243],a[16:19]
 v_exp_f32 v147,v147
 v_mfma_f32_16x16x32_bf16 a[16:19],a[168:171],v[224:227],a[16:19]
 ds_read_b128 a[156:159],v7 offset:12288
 v_cvt_pk_bf16_f32 v195,v146,v147
 v_mfma_f32_16x16x32_bf16 a[32:35],a[176:179],v[224:227],a[32:35]
 s_add_u32 m0,s3,98304
 v_exp_f32 v132,v132
 v_mfma_f32_16x16x32_bf16 a[32:35],a[180:183],v[240:243],a[32:35]
 buffer_load_dwordx4 v28,s[16:19],s43 offen offset:0 lds
 v_mfma_f32_16x16x32_bf16 a[36:39],a[180:183],v[244:247],a[36:39]
 v_exp_f32 v133,v133
 v_mfma_f32_16x16x32_bf16 a[36:39],a[176:179],v[228:231],a[36:39]
 ds_read_b64_tr_b16 a[160:161],v12 offset:49152
 v_cvt_pk_bf16_f32 v196,v132,v133
 v_mfma_f32_16x16x32_bf16 a[40:43],a[176:179],v[232:235],a[40:43]
 v_exp_f32 v134,v134
 v_mfma_f32_16x16x32_bf16 a[40:43],a[180:183],v[248:251],a[40:43]
 ds_read_b64_tr_b16 a[162:163],v12 offset:53248
 v_mfma_f32_16x16x32_bf16 a[44:47],a[180:183],v[252:255],a[44:47]
 v_exp_f32 v135,v135
 v_mfma_f32_16x16x32_bf16 a[44:47],a[176:179],v[236:239],a[44:47]
 v_cvt_pk_bf16_f32 v197,v134,v135
 v_mfma_f32_16x16x32_bf16 a[60:63],a[184:187],v[236:239],a[60:63]
 v_exp_f32 v148,v148
 v_mfma_f32_16x16x32_bf16 a[60:63],a[188:191],v[252:255],a[60:63]
 buffer_load_dwordx4 v29,s[16:19],s43 offen offset:1024 lds
 v_mfma_f32_16x16x32_bf16 a[56:59],a[188:191],v[248:251],a[56:59]
 v_exp_f32 v149,v149
 v_mfma_f32_16x16x32_bf16 a[56:59],a[184:187],v[232:235],a[56:59]
 ds_read_b64_tr_b16 a[164:165],v12 offset:57344
 v_cvt_pk_bf16_f32 v198,v148,v149
 v_mfma_f32_16x16x32_bf16 a[52:55],a[184:187],v[228:231],a[52:55]
 v_exp_f32 v150,v150
 v_mfma_f32_16x16x32_bf16 a[52:55],a[188:191],v[244:247],a[52:55]
 ds_read_b64_tr_b16 a[166:167],v12 offset:61440
 v_mfma_f32_16x16x32_bf16 a[48:51],a[188:191],v[240:243],a[48:51]
 v_exp_f32 v151,v151
 v_mfma_f32_16x16x32_bf16 a[48:51],a[184:187],v[224:227],a[48:51]
 s_waitcnt lgkmcnt(4)
 v_cvt_pk_bf16_f32 v199,v150,v151
 v_smfmac_f32_16x16x64_bf16 v[36:39],v[20:23],v[224:231],v60
 v_smfmac_f32_16x16x64_bf16 v[40:43],v[20:23],v[232:239],v60
 v_mfma_f32_16x16x32_bf16 v[160:163],a[128:131],v[64:67],v[44:47]
 v_exp_f32 v136,v136
 v_mfma_f32_16x16x32_bf16 v[160:163],a[132:135],v[68:71],v[160:163]
 ds_read_b64_tr_b16 a[168:169],v13 offset:49152
 v_mfma_f32_16x16x32_bf16 v[160:163],a[136:139],v[72:75],v[160:163]
 v_exp_f32 v137,v137
 v_mfma_f32_16x16x32_bf16 v[160:163],a[140:143],v[76:79],v[160:163]
 ds_read_b64_tr_b16 a[170:171],v13 offset:53248
 v_cvt_pk_bf16_f32 v200,v136,v137
 v_mfma_f32_16x16x32_bf16 v[164:167],a[140:143],v[92:95],v[48:51]
 v_exp_f32 v138,v138
 v_mfma_f32_16x16x32_bf16 v[164:167],a[136:139],v[88:91],v[164:167]
 ds_read_b64_tr_b16 a[172:173],v13 offset:57344
 v_mfma_f32_16x16x32_bf16 v[164:167],a[132:135],v[84:87],v[164:167]
 v_exp_f32 v139,v139
 v_mfma_f32_16x16x32_bf16 v[164:167],a[128:131],v[80:83],v[164:167]
 ds_read_b64_tr_b16 a[174:175],v13 offset:61440
 v_cvt_pk_bf16_f32 v201,v138,v139
 v_mfma_f32_16x16x32_bf16 v[168:171],a[128:131],v[96:99],v[52:55]
 v_exp_f32 v152,v152
 v_mfma_f32_16x16x32_bf16 v[168:171],a[132:135],v[100:103],v[168:171]
 ds_read_b64_tr_b16 a[176:177],v14 offset:49152
 v_mfma_f32_16x16x32_bf16 v[168:171],a[136:139],v[104:107],v[168:171]
 v_exp_f32 v153,v153
 v_mfma_f32_16x16x32_bf16 v[168:171],a[140:143],v[108:111],v[168:171]
 ds_read_b64_tr_b16 a[178:179],v14 offset:53248
 v_cvt_pk_bf16_f32 v202,v152,v153
 v_mfma_f32_16x16x32_bf16 v[172:175],a[140:143],v[124:127],v[56:59]
 v_exp_f32 v154,v154
 v_mfma_f32_16x16x32_bf16 v[172:175],a[136:139],v[120:123],v[172:175]
 ds_read_b64_tr_b16 a[180:181],v14 offset:57344
 v_mfma_f32_16x16x32_bf16 v[172:175],a[132:135],v[116:119],v[172:175]
 v_exp_f32 v155,v155
 v_mfma_f32_16x16x32_bf16 v[172:175],a[128:131],v[112:115],v[172:175]
 ds_read_b64_tr_b16 a[182:183],v14 offset:61440
 v_cvt_pk_bf16_f32 v203,v154,v155
 v_mfma_f32_16x16x32_bf16 v[188:191],a[144:147],v[112:115],v[56:59]
 v_exp_f32 v140,v140
 v_mfma_f32_16x16x32_bf16 v[188:191],a[148:151],v[116:119],v[188:191]
 ds_read_b64_tr_b16 a[184:185],v15 offset:49152
 v_mfma_f32_16x16x32_bf16 v[188:191],a[152:155],v[120:123],v[188:191]
 v_exp_f32 v141,v141
 v_mfma_f32_16x16x32_bf16 v[188:191],a[156:159],v[124:127],v[188:191]
 ds_read_b64_tr_b16 a[186:187],v15 offset:53248
 v_cvt_pk_bf16_f32 v204,v140,v141
 v_mfma_f32_16x16x32_bf16 v[184:187],a[156:159],v[108:111],v[52:55]
 v_exp_f32 v142,v142
 v_mfma_f32_16x16x32_bf16 v[184:187],a[152:155],v[104:107],v[184:187]
 ds_read_b64_tr_b16 a[188:189],v15 offset:57344
 v_mfma_f32_16x16x32_bf16 v[184:187],a[148:151],v[100:103],v[184:187]
 v_exp_f32 v143,v143
 v_mfma_f32_16x16x32_bf16 v[184:187],a[144:147],v[96:99],v[184:187]
 ds_read_b64_tr_b16 a[190:191],v15 offset:61440
 v_cvt_pk_bf16_f32 v205,v142,v143
 v_mfma_f32_16x16x32_bf16 v[180:183],a[144:147],v[80:83],v[48:51]
 v_exp_f32 v156,v156
 v_mfma_f32_16x16x32_bf16 v[180:183],a[148:151],v[84:87],v[180:183]
 buffer_load_dwordx4 v28,s[16:19],s43 offen offset:2048 lds
 v_mfma_f32_16x16x32_bf16 v[180:183],a[152:155],v[88:91],v[180:183]
 s_sub_u32 s44,s44,1
 v_exp_f32 v157,v157
 v_mfma_f32_16x16x32_bf16 v[180:183],a[156:159],v[92:95],v[180:183]
 v_cvt_pk_bf16_f32 v206,v156,v157
 v_mfma_f32_16x16x32_bf16 v[176:179],a[156:159],v[76:79],v[44:47]
 v_exp_f32 v158,v158
 v_mfma_f32_16x16x32_bf16 v[176:179],a[152:155],v[72:75],v[176:179]
 buffer_load_dwordx4 v29,s[16:19],s43 offen offset:3072 lds
 v_mfma_f32_16x16x32_bf16 v[176:179],a[148:151],v[68:71],v[176:179]
 s_add_u32 s43,s43,0x4000
 v_exp_f32 v159,v159
 v_mfma_f32_16x16x32_bf16 v[176:179],a[144:147],v[64:67],v[176:179]
 s_waitcnt vmcnt(19) lgkmcnt(0)
 s_barrier
 s_cmp_lg_u32 s44,0
 v_cvt_pk_bf16_f32 v207,v158,v159
 s_cbranch_scc1 L_attn_loop
L_attn_last:
 v_mfma_f32_16x16x32_bf16 a[64:67],a[160:163],v[224:227],a[64:67]
 v_exp_f32 v160,v160
 v_mfma_f32_16x16x32_bf16 a[64:67],a[164:167],v[240:243],a[64:67]
 ds_read_b128 a[128:131],v4 offset:16384
 v_readfirstlane_b32 s100,v63
 v_mfma_f32_16x16x32_bf16 a[68:71],a[164:167],v[244:247],a[68:71]
 v_exp_f32 v161,v161
 v_mfma_f32_16x16x32_bf16 a[68:71],a[160:163],v[228:231],a[68:71]
 ds_read_b128 a[132:135],v5 offset:16384
 v_cvt_pk_bf16_f32 v208,v160,v161
 v_mfma_f32_16x16x32_bf16 a[72:75],a[160:163],v[232:235],a[72:75]
 v_exp_f32 v162,v162
 v_mfma_f32_16x16x32_bf16 a[72:75],a[164:167],v[248:251],a[72:75]
 ds_read_b128 a[136:139],v6 offset:16384
 v_cmp_gt_u32 vcc,4,v30
 v_mfma_f32_16x16x32_bf16 a[76:79],a[164:167],v[252:255],a[76:79]
 s_cmp_lg_u64 vcc,0
 s_cselect_b32 s100,0,s100
 v_exp_f32 v163,v163
 v_mfma_f32_16x16x32_bf16 a[76:79],a[160:163],v[236:239],a[76:79]
 s_cmp_eq_u32 s100,0
 s_cbranch_scc1 L_spin_r
L_spin_r_ret:
 ds_read_b128 a[140:143],v7 offset:16384
 v_cvt_pk_bf16_f32 v209,v162,v163
 v_mfma_f32_16x16x32_bf16 a[92:95],a[168:171],v[236:239],a[92:95]
 s_sub_u32 s100,s100,1
 v_exp_f32 v176,v176
 v_mfma_f32_16x16x32_bf16 a[92:95],a[172:175],v[252:255],a[92:95]
 s_and_b32 s100,s100,7
 ds_read_b128 a[144:147],v4 offset:20480
 s_lshr_b32 s50,s100,1
 v_mfma_f32_16x16x32_bf16 a[88:91],a[172:175],v[248:251],a[88:91]
 s_lshl_b32 s50,s50,3
 v_exp_f32 v177,v177
 v_mfma_f32_16x16x32_bf16 a[88:91],a[168:171],v[232:235],a[88:91]
 s_lshr_b32 s51,117901063,s50
 ds_read_b128 a[148:151],v5 offset:20480
 v_cvt_pk_bf16_f32 v210,v176,v177
 v_mfma_f32_16x16x32_bf16 a[84:87],a[168:171],v[228:231],a[84:87]
 s_and_b32 s51,s51,0xff
 v_exp_f32 v178,v178
 v_mfma_f32_16x16x32_bf16 a[84:87],a[172:175],v[244:247],a[84:87]
 s_lshr_b32 s50,353240832,s50
 ds_read_b128 a[152:155],v6 offset:20480
 s_and_b32 s50,s50,0xff
 v_mfma_f32_16x16x32_bf16 a[80:83],a[172:175],v[240:243],a[80:83]
 s_lshr_b32 s48,s2,5
 v_exp_f32 v179,v179
 v_mfma_f32_16x16x32_bf16 a[80:83],a[168:171],v[224:227],a[80:83]
 s_cmp_lt_u32 s48,s51
 s_cselect_b32 s51,-1,0
 ds_read_b128 a[156:159],v7 offset:20480
 v_cvt_pk_bf16_f32 v211,v178,v179
 v_mfma_f32_16x16x32_bf16 a[96:99],a[176:179],v[224:227],a[96:99]
 s_add_u32 m0,s3,114688
 v_exp_f32 v164,v164
 v_mfma_f32_16x16x32_bf16 a[96:99],a[180:183],v[240:243],a[96:99]
 s_add_u32 s50,s50,s48
 buffer_load_dwordx4 v28,s[16:19],s43 offen offset:0 lds
 s_and_b32 s50,s50,s51
 v_mfma_f32_16x16x32_bf16 a[100:103],a[180:183],v[244:247],a[100:103]
L_stub_b_0:
 s_cbranch_execz L_warm_b_ret
 s_and_b32 s49,s100,1
 v_exp_f32 v165,v165
 v_mfma_f32_16x16x32_bf16 a[100:103],a[176:179],v[228:231],a[100:103]
 s_lshl_b32 s49,s49,1
 ds_read_b64_tr_b16 a[160:161],v8 offset:0
 v_cvt_pk_bf16_f32 v212,v164,v165
 v_mfma_f32_16x16x32_bf16 a[104:107],a[176:179],v[232:235],a[104:107]
 s_bfe_u32 s48,s2,0x10004
 v_exp_f32 v166,v166
 v_mfma_f32_16x16x32_bf16 a[104:107],a[180:183],v[248:251],a[104:107]
 s_add_u32 s49,s49,s48
 ds_read_b64_tr_b16 a[162:163],v8 offset:4096
 s_lshl_b32 s49,s49,2
 v_mfma_f32_16x16x32_bf16 a[108:111],a[180:183],v[252:255],a[108:111]
 s_lshr_b32 s48,s3,12
 v_exp_f32 v167,v167
 v_mfma_f32_16x16x32_bf16 a[108:111],a[176:179],v[236:239],a[108:111]
 s_add_u32 s49,s49,s48
 buffer_load_dword a255,v61,s[60:63],s77 offen
 v_cvt_pk_bf16_f32 v213,v166,v167
 v_mfma_f32_16x16x32_bf16 a[124:127],a[184:187],v[236:239],a[124:127]
 s_bfe_u32 s44,s2,0x10003
 v_exp_f32 v180,v180
 v_mfma_f32_16x16x32_bf16 a[124:127],a[188:191],v[252:255],a[124:127]
 s_lshl_b32 s48,s49,18
 buffer_load_dwordx4 v29,s[16:19],s43 offen offset:1024 lds
 s_lshl_b32 s49,s44,12
 v_mfma_f32_16x16x32_bf16 a[120:123],a[188:191],v[248:251],a[120:123]
 s_add_u32 s48,s48,s49
 v_exp_f32 v181,v181
 v_mfma_f32_16x16x32_bf16 a[120:123],a[184:187],v[232:235],a[120:123]
 s_add_u32 s48,s48,4194304
 ds_read_b64_tr_b16 a[164:165],v8 offset:8192
 v_cvt_pk_bf16_f32 v214,v180,v181
 v_mfma_f32_16x16x32_bf16 a[116:119],a[184:187],v[228:231],a[116:119]
 s_and_b32 s49,s51,258048
 v_exp_f32 v182,v182
 v_mfma_f32_16x16x32_bf16 a[116:119],a[188:191],v[244:247],a[116:119]
 s_add_u32 s4,s30,s48
 s_addc_u32 s5,s31,0
 ds_read_b64_tr_b16 a[166:167],v8 offset:12288
 v_mfma_f32_16x16x32_bf16 a[112:115],a[188:191],v[240:243],a[112:115]
 s_mov_b32 s6,s49
 v_exp_f32 v183,v183
 v_mfma_f32_16x16x32_bf16 a[112:115],a[184:187],v[224:227],a[112:115]
 s_waitcnt lgkmcnt(4)
 v_cvt_pk_bf16_f32 v215,v182,v183
 v_smfmac_f32_16x16x64_bf16 v[36:39],v[20:23],v[240:247],v60
 v_smfmac_f32_16x16x64_bf16 v[40:43],v[20:23],v[248:255],v60
 v_mfma_f32_16x16x32_bf16 v[128:131],a[128:131],v[64:67],v[44:47]
 s_mov_b32 s7,0x20000
 v_exp_f32 v168,v168
 v_mfma_f32_16x16x32_bf16 v[128:131],a[132:135],v[68:71],v[128:131]
 s_lshl_b32 s50,s50,8
 ds_read_b64_tr_b16 a[168:169],v9 offset:0
 s_mul_i32 s48,s44,458752
 v_mfma_f32_16x16x32_bf16 v[128:131],a[136:139],v[72:75],v[128:131]
 s_add_u32 s48,s48,s50
 v_exp_f32 v169,v169
 v_mfma_f32_16x16x32_bf16 v[128:131],a[140:143],v[76:79],v[128:131]
 s_sub_u32 s49,14680064,s48
 ds_read_b64_tr_b16 a[170:171],v9 offset:4096
 v_cvt_pk_bf16_f32 v216,v168,v169
 v_mfma_f32_16x16x32_bf16 v[132:135],a[140:143],v[92:95],v[48:51]
 s_and_b32 s49,s49,s51
 v_exp_f32 v170,v170
 v_mfma_f32_16x16x32_bf16 v[132:135],a[136:139],v[88:91],v[132:135]
 s_add_u32 s12,s32,s48
 s_addc_u32 s13,s33,0
 ds_read_b64_tr_b16 a[172:173],v9 offset:8192
 v_mfma_f32_16x16x32_bf16 v[132:135],a[132:135],v[84:87],v[132:135]
 s_mov_b32 s14,s49
 v_exp_f32 v171,v171
 v_mfma_f32_16x16x32_bf16 v[132:135],a[128:131],v[80:83],v[132:135]
 s_mov_b32 s15,0x20000
 ds_read_b64_tr_b16 a[174:175],v9 offset:12288
 v_cvt_pk_bf16_f32 v217,v170,v171
 v_mfma_f32_16x16x32_bf16 v[136:139],a[128:131],v[96:99],v[52:55]
 s_lshl_b32 s44,s44,7
 v_exp_f32 v184,v184
 v_mfma_f32_16x16x32_bf16 v[136:139],a[132:135],v[100:103],v[136:139]
 s_add_u32 s48,s50,s44
 ds_read_b64_tr_b16 a[176:177],v10 offset:0
 s_and_b32 s49,s51,128
 v_mfma_f32_16x16x32_bf16 v[136:139],a[136:139],v[104:107],v[136:139]
 s_add_u32 s8,s34,s48
 s_addc_u32 s9,s35,0
 v_exp_f32 v185,v185
 v_mfma_f32_16x16x32_bf16 v[136:139],a[140:143],v[108:111],v[136:139]
 s_mov_b32 s10,s49
 ds_read_b64_tr_b16 a[178:179],v10 offset:4096
 v_cvt_pk_bf16_f32 v218,v184,v185
 v_mfma_f32_16x16x32_bf16 v[140:143],a[140:143],v[124:127],v[56:59]
 s_mov_b32 s11,0x20000
 v_exp_f32 v186,v186
 v_mfma_f32_16x16x32_bf16 v[140:143],a[136:139],v[120:123],v[140:143]
 ds_read_b64_tr_b16 a[180:181],v10 offset:8192
 v_mov_b32 v24,v32
 v_mfma_f32_16x16x32_bf16 v[140:143],a[132:135],v[116:119],v[140:143]
 v_exp_f32 v187,v187
 v_mfma_f32_16x16x32_bf16 v[140:143],a[128:131],v[112:115],v[140:143]
 ds_read_b64_tr_b16 a[182:183],v10 offset:12288
 v_cvt_pk_bf16_f32 v219,v186,v187
 v_mfma_f32_16x16x32_bf16 v[156:159],a[144:147],v[112:115],v[56:59]
 v_exp_f32 v172,v172
 v_mfma_f32_16x16x32_bf16 v[156:159],a[148:151],v[116:119],v[156:159]
 ds_read_b64_tr_b16 a[184:185],v11 offset:0
 v_mov_b32 v25,v33
 v_mfma_f32_16x16x32_bf16 v[156:159],a[152:155],v[120:123],v[156:159]
 v_exp_f32 v173,v173
 v_mfma_f32_16x16x32_bf16 v[156:159],a[156:159],v[124:127],v[156:159]
 ds_read_b64_tr_b16 a[186:187],v11 offset:4096
 v_cvt_pk_bf16_f32 v220,v172,v173
 v_mfma_f32_16x16x32_bf16 v[152:155],a[156:159],v[108:111],v[52:55]
 v_exp_f32 v174,v174
 v_mfma_f32_16x16x32_bf16 v[152:155],a[152:155],v[104:107],v[152:155]
 ds_read_b64_tr_b16 a[188:189],v11 offset:8192
 v_mov_b32 v26,v34
 v_mfma_f32_16x16x32_bf16 v[152:155],a[148:151],v[100:103],v[152:155]
 v_exp_f32 v175,v175
 v_mfma_f32_16x16x32_bf16 v[152:155],a[144:147],v[96:99],v[152:155]
 ds_read_b64_tr_b16 a[190:191],v11 offset:12288
 v_cvt_pk_bf16_f32 v221,v174,v175
 v_mfma_f32_16x16x32_bf16 v[148:151],a[144:147],v[80:83],v[48:51]
 v_exp_f32 v188,v188
 v_mfma_f32_16x16x32_bf16 v[148:151],a[148:151],v[84:87],v[148:151]
 buffer_load_dwordx4 v28,s[16:19],s43 offen offset:2048 lds
 v_mov_b32 v27,v35
 v_mfma_f32_16x16x32_bf16 v[148:151],a[152:155],v[88:91],v[148:151]
 s_mov_b32 s41,0
 v_exp_f32 v189,v189
 v_mfma_f32_16x16x32_bf16 v[148:151],a[156:159],v[92:95],v[148:151]
 v_cvt_pk_bf16_f32 v222,v188,v189
 v_lshlrev_b32 v62,3,v3
 v_mfma_f32_16x16x32_bf16 v[144:147],a[156:159],v[76:79],v[44:47]
 s_xor_b32 s44,s44,128
 v_exp_f32 v190,v190
 v_mfma_f32_16x16x32_bf16 v[144:147],a[152:155],v[72:75],v[144:147]
 buffer_load_dwordx4 v29,s[16:19],s43 offen offset:3072 lds
 v_mfma_f32_16x16x32_bf16 v[144:147],a[148:151],v[68:71],v[144:147]
 s_add_u32 s43,s43,0x4000
 v_exp_f32 v191,v191
 v_mfma_f32_16x16x32_bf16 v[144:147],a[144:147],v[64:67],v[144:147]
 s_waitcnt lgkmcnt(0)
 v_cvt_pk_bf16_f32 v223,v190,v191
 v_mfma_f32_16x16x32_bf16 a[0:3],a[160:163],v[192:195],a[0:3]
 v_exp_f32 v128,v128
 v_mfma_f32_16x16x32_bf16 a[0:3],a[164:167],v[208:211],a[0:3]
 ds_read_b128 a[128:131],v4 offset:24576
 buffer_load_dword a255,v1,s[8:11],0 offen
 v_mfma_f32_16x16x32_bf16 a[4:7],a[164:167],v[212:215],a[4:7]
 v_exp_f32 v129,v129
 v_mfma_f32_16x16x32_bf16 a[4:7],a[160:163],v[196:199],a[4:7]
 ds_read_b128 a[132:135],v5 offset:24576
 v_cvt_pk_bf16_f32 v224,v128,v129
 v_mfma_f32_16x16x32_bf16 a[8:11],a[160:163],v[200:203],a[8:11]
 v_exp_f32 v130,v130
 v_mfma_f32_16x16x32_bf16 a[8:11],a[164:167],v[216:219],a[8:11]
 ds_read_b128 a[136:139],v6 offset:24576
 v_mfma_f32_16x16x32_bf16 a[12:15],a[164:167],v[220:223],a[12:15]
 v_exp_f32 v131,v131
 v_mfma_f32_16x16x32_bf16 a[12:15],a[160:163],v[204:207],a[12:15]
 ds_read_b128 a[140:143],v7 offset:24576
 v_cvt_pk_bf16_f32 v225,v130,v131
 v_mfma_f32_16x16x32_bf16 a[28:31],a[168:171],v[204:207],a[28:31]
 v_exp_f32 v144,v144
 v_mfma_f32_16x16x32_bf16 a[28:31],a[172:175],v[220:223],a[28:31]
 ds_read_b128 a[144:147],v4 offset:28672
 v_mfma_f32_16x16x32_bf16 a[24:27],a[172:175],v[216:219],a[24:27]
 v_exp_f32 v145,v145
 v_mfma_f32_16x16x32_bf16 a[24:27],a[168:171],v[200:203],a[24:27]
 ds_read_b128 a[148:151],v5 offset:28672
 v_cvt_pk_bf16_f32 v226,v144,v145
 v_mfma_f32_16x16x32_bf16 a[20:23],a[168:171],v[196:199],a[20:23]
 v_exp_f32 v146,v146
 v_mfma_f32_16x16x32_bf16 a[20:23],a[172:175],v[212:215],a[20:23]
 ds_read_b128 a[152:155],v6 offset:28672
 v_mfma_f32_16x16x32_bf16 a[16:19],a[172:175],v[208:211],a[16:19]
 v_exp_f32 v147,v147
 v_mfma_f32_16x16x32_bf16 a[16:19],a[168:171],v[192:195],a[16:19]
 ds_read_b128 a[156:159],v7 offset:28672
 v_cvt_pk_bf16_f32 v227,v146,v147
 v_mfma_f32_16x16x32_bf16 a[32:35],a[176:179],v[192:195],a[32:35]
 s_add_u32 m0,s3,0
 v_exp_f32 v132,v132
 v_mfma_f32_16x16x32_bf16 a[32:35],a[180:183],v[208:211],a[32:35]
 buffer_load_dwordx4 v24,s[12:15],s41 offen offset:0 lds
 v_mfma_f32_16x16x32_bf16 a[36:39],a[180:183],v[212:215],a[36:39]
 v_exp_f32 v133,v133
 v_mfma_f32_16x16x32_bf16 a[36:39],a[176:179],v[196:199],a[36:39]
 ds_read_b64_tr_b16 a[160:161],v12 offset:0
 v_cvt_pk_bf16_f32 v228,v132,v133
 v_mfma_f32_16x16x32_bf16 a[40:43],a[176:179],v[200:203],a[40:43]
 v_exp_f32 v134,v134
 v_mfma_f32_16x16x32_bf16 a[40:43],a[180:183],v[216:219],a[40:43]
 ds_read_b64_tr_b16 a[162:163],v12 offset:4096
 v_mfma_f32_16x16x32_bf16 a[44:47],a[180:183],v[220:223],a[44:47]
 v_exp_f32 v135,v135
 v_mfma_f32_16x16x32_bf16 a[44:47],a[176:179],v[204:207],a[44:47]
 v_cvt_pk_bf16_f32 v229,v134,v135
 v_mfma_f32_16x16x32_bf16 a[60:63],a[184:187],v[204:207],a[60:63]
 v_exp_f32 v148,v148
 v_mfma_f32_16x16x32_bf16 a[60:63],a[188:191],v[220:223],a[60:63]
 buffer_load_dwordx4 v25,s[12:15],s41 offen offset:1024 lds
 v_mfma_f32_16x16x32_bf16 a[56:59],a[188:191],v[216:219],a[56:59]
 v_exp_f32 v149,v149
 v_mfma_f32_16x16x32_bf16 a[56:59],a[184:187],v[200:203],a[56:59]
 ds_read_b64_tr_b16 a[164:165],v12 offset:8192
 v_cvt_pk_bf16_f32 v230,v148,v149
 v_mfma_f32_16x16x32_bf16 a[52:55],a[184:187],v[196:199],a[52:55]
 v_exp_f32 v150,v150
 v_mfma_f32_16x16x32_bf16 a[52:55],a[188:191],v[212:215],a[52:55]
 ds_read_b64_tr_b16 a[166:167],v12 offset:12288
 v_mfma_f32_16x16x32_bf16 a[48:51],a[188:191],v[208:211],a[48:51]
 v_exp_f32 v151,v151
 v_mfma_f32_16x16x32_bf16 a[48:51],a[184:187],v[192:195],a[48:51]
 s_waitcnt lgkmcnt(4)
 v_cvt_pk_bf16_f32 v231,v150,v151
 v_smfmac_f32_16x16x64_bf16 v[36:39],v[20:23],v[192:199],v60
 v_smfmac_f32_16x16x64_bf16 v[40:43],v[20:23],v[200:207],v60
 v_mfma_f32_16x16x32_bf16 v[160:163],a[128:131],v[64:67],v[44:47]
 s_mov_b32 s40,0
 v_exp_f32 v136,v136
 v_mfma_f32_16x16x32_bf16 v[160:163],a[132:135],v[68:71],v[160:163]
 ds_read_b64_tr_b16 a[168:169],v13 offset:0
 buffer_load_dwordx4 a[192:195],v1,s[4:7],s40 offen offset:0 sc1
 v_mfma_f32_16x16x32_bf16 v[160:163],a[136:139],v[72:75],v[160:163]
 v_exp_f32 v137,v137
 v_mfma_f32_16x16x32_bf16 v[160:163],a[140:143],v[76:79],v[160:163]
 ds_read_b64_tr_b16 a[170:171],v13 offset:4096
 v_cvt_pk_bf16_f32 v232,v136,v137
 v_mfma_f32_16x16x32_bf16 v[164:167],a[140:143],v[92:95],v[48:51]
 v_exp_f32 v138,v138
 v_mfma_f32_16x16x32_bf16 v[164:167],a[136:139],v[88:91],v[164:167]
 ds_read_b64_tr_b16 a[172:173],v13 offset:8192
 buffer_load_dwordx4 a[196:199],v1,s[4:7],s40 offen offset:1024 sc1
 v_mfma_f32_16x16x32_bf16 v[164:167],a[132:135],v[84:87],v[164:167]
 v_exp_f32 v139,v139
 v_mfma_f32_16x16x32_bf16 v[164:167],a[128:131],v[80:83],v[164:167]
 ds_read_b64_tr_b16 a[174:175],v13 offset:12288
 v_cvt_pk_bf16_f32 v233,v138,v139
 v_mfma_f32_16x16x32_bf16 v[168:171],a[128:131],v[96:99],v[52:55]
 v_exp_f32 v152,v152
 v_mfma_f32_16x16x32_bf16 v[168:171],a[132:135],v[100:103],v[168:171]
 ds_read_b64_tr_b16 a[176:177],v14 offset:0
 v_mfma_f32_16x16x32_bf16 v[168:171],a[136:139],v[104:107],v[168:171]
 v_exp_f32 v153,v153
 v_mfma_f32_16x16x32_bf16 v[168:171],a[140:143],v[108:111],v[168:171]
 ds_read_b64_tr_b16 a[178:179],v14 offset:4096
 v_cvt_pk_bf16_f32 v234,v152,v153
 v_mfma_f32_16x16x32_bf16 v[172:175],a[140:143],v[124:127],v[56:59]
 v_exp_f32 v154,v154
 v_mfma_f32_16x16x32_bf16 v[172:175],a[136:139],v[120:123],v[172:175]
 ds_read_b64_tr_b16 a[180:181],v14 offset:8192
 buffer_load_dwordx4 a[208:211],v1,s[4:7],s40 offen offset:2048 sc1
 v_mfma_f32_16x16x32_bf16 v[172:175],a[132:135],v[116:119],v[172:175]
 v_exp_f32 v155,v155
 v_mfma_f32_16x16x32_bf16 v[172:175],a[128:131],v[112:115],v[172:175]
 ds_read_b64_tr_b16 a[182:183],v14 offset:12288
 v_cvt_pk_bf16_f32 v235,v154,v155
 v_mfma_f32_16x16x32_bf16 v[188:191],a[144:147],v[112:115],v[56:59]
 v_exp_f32 v140,v140
 v_mfma_f32_16x16x32_bf16 v[188:191],a[148:151],v[116:119],v[188:191]
 ds_read_b64_tr_b16 a[184:185],v15 offset:0
 buffer_load_dwordx4 a[212:215],v1,s[4:7],s40 offen offset:3072 sc1
 v_mfma_f32_16x16x32_bf16 v[188:191],a[152:155],v[120:123],v[188:191]
 v_exp_f32 v141,v141
 v_mfma_f32_16x16x32_bf16 v[188:191],a[156:159],v[124:127],v[188:191]
 ds_read_b64_tr_b16 a[186:187],v15 offset:4096
 v_cvt_pk_bf16_f32 v236,v140,v141
 v_mfma_f32_16x16x32_bf16 v[184:187],a[156:159],v[108:111],v[52:55]
 v_exp_f32 v142,v142
 v_mfma_f32_16x16x32_bf16 v[184:187],a[152:155],v[104:107],v[184:187]
 ds_read_b64_tr_b16 a[188:189],v15 offset:8192
 v_mfma_f32_16x16x32_bf16 v[184:187],a[148:151],v[100:103],v[184:187]
 v_exp_f32 v143,v143
 v_mfma_f32_16x16x32_bf16 v[184:187],a[144:147],v[96:99],v[184:187]
 ds_read_b64_tr_b16 a[190:191],v15 offset:12288
 v_cvt_pk_bf16_f32 v237,v142,v143
 v_mfma_f32_16x16x32_bf16 v[180:183],a[144:147],v[80:83],v[48:51]
 v_exp_f32 v156,v156
 v_mfma_f32_16x16x32_bf16 v[180:183],a[148:151],v[84:87],v[180:183]
 buffer_load_dwordx4 v26,s[12:15],s41 offen offset:2048 lds
 v_mfma_f32_16x16x32_bf16 v[180:183],a[152:155],v[88:91],v[180:183]
 v_exp_f32 v157,v157
 v_mfma_f32_16x16x32_bf16 v[180:183],a[156:159],v[92:95],v[180:183]
 v_cvt_pk_bf16_f32 v238,v156,v157
 v_mfma_f32_16x16x32_bf16 v[176:179],a[156:159],v[76:79],v[44:47]
 v_exp_f32 v158,v158
 v_mfma_f32_16x16x32_bf16 v[176:179],a[152:155],v[72:75],v[176:179]
 buffer_load_dwordx4 v27,s[12:15],s41 offen offset:3072 lds
 v_mfma_f32_16x16x32_bf16 v[176:179],a[148:151],v[68:71],v[176:179]
 s_mov_b32 s41,917504
 v_exp_f32 v159,v159
 v_mfma_f32_16x16x32_bf16 v[176:179],a[144:147],v[64:67],v[176:179]
 s_waitcnt vmcnt(23) lgkmcnt(0)
 s_barrier
 v_cvt_pk_bf16_f32 v239,v158,v159
 v_mfma_f32_16x16x32_bf16 a[64:67],a[160:163],v[192:195],a[64:67]
 v_exp_f32 v160,v160
 v_mfma_f32_16x16x32_bf16 a[64:67],a[164:167],v[208:211],a[64:67]
 ds_read_b128 a[128:131],v4 offset:32768
 v_mfma_f32_16x16x32_bf16 a[68:71],a[164:167],v[212:215],a[68:71]
 v_exp_f32 v161,v161
 v_mfma_f32_16x16x32_bf16 a[68:71],a[160:163],v[196:199],a[68:71]
 ds_read_b128 a[132:135],v5 offset:32768
 v_cvt_pk_bf16_f32 v240,v160,v161
 v_mfma_f32_16x16x32_bf16 a[72:75],a[160:163],v[200:203],a[72:75]
 v_exp_f32 v162,v162
 v_mfma_f32_16x16x32_bf16 a[72:75],a[164:167],v[216:219],a[72:75]
 ds_read_b128 a[136:139],v6 offset:32768
 v_mfma_f32_16x16x32_bf16 a[76:79],a[164:167],v[220:223],a[76:79]
 v_exp_f32 v163,v163
 v_mfma_f32_16x16x32_bf16 a[76:79],a[160:163],v[204:207],a[76:79]
 ds_read_b128 a[140:143],v7 offset:32768
 v_cvt_pk_bf16_f32 v241,v162,v163
 v_mfma_f32_16x16x32_bf16 a[92:95],a[168:171],v[204:207],a[92:95]
 v_exp_f32 v176,v176
 v_mfma_f32_16x16x32_bf16 a[92:95],a[172:175],v[220:223],a[92:95]
 ds_read_b128 a[144:147],v4 offset:36864
 v_mfma_f32_16x16x32_bf16 a[88:91],a[172:175],v[216:219],a[88:91]
 v_exp_f32 v177,v177
 v_mfma_f32_16x16x32_bf16 a[88:91],a[168:171],v[200:203],a[88:91]
 ds_read_b128 a[148:151],v5 offset:36864
 v_cvt_pk_bf16_f32 v242,v176,v177
 v_mfma_f32_16x16x32_bf16 a[84:87],a[168:171],v[196:199],a[84:87]
 v_exp_f32 v178,v178
 v_mfma_f32_16x16x32_bf16 a[84:87],a[172:175],v[212:215],a[84:87]
 ds_read_b128 a[152:155],v6 offset:36864
 v_mfma_f32_16x16x32_bf16 a[80:83],a[172:175],v[208:211],a[80:83]
 v_exp_f32 v179,v179
 v_mfma_f32_16x16x32_bf16 a[80:83],a[168:171],v[192:195],a[80:83]
 ds_read_b128 a[156:159],v7 offset:36864
 v_cvt_pk_bf16_f32 v243,v178,v179
 v_mfma_f32_16x16x32_bf16 a[96:99],a[176:179],v[192:195],a[96:99]
 s_add_u32 m0,s3,65536
 v_exp_f32 v164,v164
 v_mfma_f32_16x16x32_bf16 a[96:99],a[180:183],v[208:211],a[96:99]
 buffer_load_dwordx4 v24,s[12:15],s41 offen offset:0 lds
 v_mfma_f32_16x16x32_bf16 a[100:103],a[180:183],v[212:215],a[100:103]
 v_exp_f32 v165,v165
 v_mfma_f32_16x16x32_bf16 a[100:103],a[176:179],v[196:199],a[100:103]
 ds_read_b64_tr_b16 a[160:161],v8 offset:16384
 v_cvt_pk_bf16_f32 v244,v164,v165
 v_mfma_f32_16x16x32_bf16 a[104:107],a[176:179],v[200:203],a[104:107]
 v_exp_f32 v166,v166
 v_mfma_f32_16x16x32_bf16 a[104:107],a[180:183],v[216:219],a[104:107]
 ds_read_b64_tr_b16 a[162:163],v8 offset:20480
 v_mfma_f32_16x16x32_bf16 a[108:111],a[180:183],v[220:223],a[108:111]
 v_exp_f32 v167,v167
 v_mfma_f32_16x16x32_bf16 a[108:111],a[176:179],v[204:207],a[108:111]
 v_cvt_pk_bf16_f32 v245,v166,v167
 v_mfma_f32_16x16x32_bf16 a[124:127],a[184:187],v[204:207],a[124:127]
 v_exp_f32 v180,v180
 v_mfma_f32_16x16x32_bf16 a[124:127],a[188:191],v[220:223],a[124:127]
 buffer_load_dwordx4 v25,s[12:15],s41 offen offset:1024 lds
 v_mfma_f32_16x16x32_bf16 a[120:123],a[188:191],v[216:219],a[120:123]
 v_exp_f32 v181,v181
 v_mfma_f32_16x16x32_bf16 a[120:123],a[184:187],v[200:203],a[120:123]
 ds_read_b64_tr_b16 a[164:165],v8 offset:24576
 v_cvt_pk_bf16_f32 v246,v180,v181
 v_mfma_f32_16x16x32_bf16 a[116:119],a[184:187],v[196:199],a[116:119]
 v_exp_f32 v182,v182
 v_mfma_f32_16x16x32_bf16 a[116:119],a[188:191],v[212:215],a[116:119]
 ds_read_b64_tr_b16 a[166:167],v8 offset:28672
 v_mfma_f32_16x16x32_bf16 a[112:115],a[188:191],v[208:211],a[112:115]
 v_exp_f32 v183,v183
 v_mfma_f32_16x16x32_bf16 a[112:115],a[184:187],v[192:195],a[112:115]
 s_waitcnt lgkmcnt(4)
 v_cvt_pk_bf16_f32 v247,v182,v183
 v_smfmac_f32_16x16x64_bf16 v[36:39],v[20:23],v[208:215],v60
 v_smfmac_f32_16x16x64_bf16 v[40:43],v[20:23],v[216:223],v60
 v_mfma_f32_16x16x32_bf16 v[128:131],a[128:131],v[64:67],v[44:47]
 s_mov_b32 s40,131072
 v_exp_f32 v168,v168
 v_mfma_f32_16x16x32_bf16 v[128:131],a[132:135],v[68:71],v[128:131]
 ds_read_b64_tr_b16 a[168:169],v9 offset:16384
 buffer_load_dwordx4 a[200:203],v1,s[4:7],s40 offen offset:0 sc1
 v_mfma_f32_16x16x32_bf16 v[128:131],a[136:139],v[72:75],v[128:131]
 v_exp_f32 v169,v169
 v_mfma_f32_16x16x32_bf16 v[128:131],a[140:143],v[76:79],v[128:131]
 ds_read_b64_tr_b16 a[170:171],v9 offset:20480
 v_cvt_pk_bf16_f32 v248,v168,v169
 v_mfma_f32_16x16x32_bf16 v[132:135],a[140:143],v[92:95],v[48:51]
 v_exp_f32 v170,v170
 v_mfma_f32_16x16x32_bf16 v[132:135],a[136:139],v[88:91],v[132:135]
 ds_read_b64_tr_b16 a[172:173],v9 offset:24576
 buffer_load_dwordx4 a[204:207],v1,s[4:7],s40 offen offset:1024 sc1
 v_mfma_f32_16x16x32_bf16 v[132:135],a[132:135],v[84:87],v[132:135]
 v_exp_f32 v171,v171
 v_mfma_f32_16x16x32_bf16 v[132:135],a[128:131],v[80:83],v[132:135]
 ds_read_b64_tr_b16 a[174:175],v9 offset:28672
 v_cvt_pk_bf16_f32 v249,v170,v171
 v_mfma_f32_16x16x32_bf16 v[136:139],a[128:131],v[96:99],v[52:55]
 v_exp_f32 v184,v184
 v_mfma_f32_16x16x32_bf16 v[136:139],a[132:135],v[100:103],v[136:139]
 ds_read_b64_tr_b16 a[176:177],v10 offset:16384
 v_mfma_f32_16x16x32_bf16 v[136:139],a[136:139],v[104:107],v[136:139]
 v_exp_f32 v185,v185
 v_mfma_f32_16x16x32_bf16 v[136:139],a[140:143],v[108:111],v[136:139]
 ds_read_b64_tr_b16 a[178:179],v10 offset:20480
 v_cvt_pk_bf16_f32 v250,v184,v185
 v_mfma_f32_16x16x32_bf16 v[140:143],a[140:143],v[124:127],v[56:59]
 v_exp_f32 v186,v186
 v_mfma_f32_16x16x32_bf16 v[140:143],a[136:139],v[120:123],v[140:143]
 ds_read_b64_tr_b16 a[180:181],v10 offset:24576
 buffer_load_dwordx4 a[216:219],v1,s[4:7],s40 offen offset:2048 sc1
 v_mfma_f32_16x16x32_bf16 v[140:143],a[132:135],v[116:119],v[140:143]
 v_exp_f32 v187,v187
 v_mfma_f32_16x16x32_bf16 v[140:143],a[128:131],v[112:115],v[140:143]
 ds_read_b64_tr_b16 a[182:183],v10 offset:28672
 v_cvt_pk_bf16_f32 v251,v186,v187
 v_mfma_f32_16x16x32_bf16 v[156:159],a[144:147],v[112:115],v[56:59]
 v_exp_f32 v172,v172
 v_mfma_f32_16x16x32_bf16 v[156:159],a[148:151],v[116:119],v[156:159]
 ds_read_b64_tr_b16 a[184:185],v11 offset:16384
 buffer_load_dwordx4 a[220:223],v1,s[4:7],s40 offen offset:3072 sc1
 v_mfma_f32_16x16x32_bf16 v[156:159],a[152:155],v[120:123],v[156:159]
 v_exp_f32 v173,v173
 v_mfma_f32_16x16x32_bf16 v[156:159],a[156:159],v[124:127],v[156:159]
 ds_read_b64_tr_b16 a[186:187],v11 offset:20480
 v_cvt_pk_bf16_f32 v252,v172,v173
 v_mfma_f32_16x16x32_bf16 v[152:155],a[156:159],v[108:111],v[52:55]
 v_exp_f32 v174,v174
 v_mfma_f32_16x16x32_bf16 v[152:155],a[152:155],v[104:107],v[152:155]
 ds_read_b64_tr_b16 a[188:189],v11 offset:24576
 v_mfma_f32_16x16x32_bf16 v[152:155],a[148:151],v[100:103],v[152:155]
 v_exp_f32 v175,v175
 v_mfma_f32_16x16x32_bf16 v[152:155],a[144:147],v[96:99],v[152:155]
 ds_read_b64_tr_b16 a[190:191],v11 offset:28672
 v_cvt_pk_bf16_f32 v253,v174,v175
 v_mfma_f32_16x16x32_bf16 v[148:151],a[144:147],v[80:83],v[48:51]
 v_exp_f32 v188,v188
 v_mfma_f32_16x16x32_bf16 v[148:151],a[148:151],v[84:87],v[148:151]
 buffer_load_dwordx4 v26,s[12:15],s41 offen offset:2048 lds
 v_mfma_f32_16x16x32_bf16 v[148:151],a[152:155],v[88:91],v[148:151]
 v_exp_f32 v189,v189
 v_mfma_f32_16x16x32_bf16 v[148:151],a[156:159],v[92:95],v[148:151]
 v_cvt_pk_bf16_f32 v254,v188,v189
 v_mfma_f32_16x16x32_bf16 v[144:147],a[156:159],v[76:79],v[44:47]
 v_exp_f32 v190,v190
 v_mfma_f32_16x16x32_bf16 v[144:147],a[152:155],v[72:75],v[144:147]
 buffer_load_dwordx4 v27,s[12:15],s41 offen offset:3072 lds
 v_mfma_f32_16x16x32_bf16 v[144:147],a[148:151],v[68:71],v[144:147]
 s_mov_b32 s41,1835008
 v_exp_f32 v191,v191
 v_mfma_f32_16x16x32_bf16 v[144:147],a[144:147],v[64:67],v[144:147]
 s_waitcnt lgkmcnt(0)
 v_cvt_pk_bf16_f32 v255,v190,v191
 v_mfma_f32_16x16x32_bf16 a[0:3],a[160:163],v[224:227],a[0:3]
 v_exp_f32 v128,v128
 v_mfma_f32_16x16x32_bf16 a[0:3],a[164:167],v[240:243],a[0:3]
 ds_read_b128 a[128:131],v4 offset:40960
 v_mfma_f32_16x16x32_bf16 a[4:7],a[164:167],v[244:247],a[4:7]
 v_exp_f32 v129,v129
 v_mfma_f32_16x16x32_bf16 a[4:7],a[160:163],v[228:231],a[4:7]
 ds_read_b128 a[132:135],v5 offset:40960
 v_cvt_pk_bf16_f32 v192,v128,v129
 v_mfma_f32_16x16x32_bf16 a[8:11],a[160:163],v[232:235],a[8:11]
 v_exp_f32 v130,v130
 v_mfma_f32_16x16x32_bf16 a[8:11],a[164:167],v[248:251],a[8:11]
 ds_read_b128 a[136:139],v6 offset:40960
 v_mfma_f32_16x16x32_bf16 a[12:15],a[164:167],v[252:255],a[12:15]
 v_exp_f32 v131,v131
 v_mfma_f32_16x16x32_bf16 a[12:15],a[160:163],v[236:239],a[12:15]
 ds_read_b128 a[140:143],v7 offset:40960
 v_cvt_pk_bf16_f32 v193,v130,v131
 v_mfma_f32_16x16x32_bf16 a[28:31],a[168:171],v[236:239],a[28:31]
 v_exp_f32 v144,v144
 v_mfma_f32_16x16x32_bf16 a[28:31],a[172:175],v[252:255],a[28:31]
 ds_read_b128 a[144:147],v4 offset:45056
 v_mfma_f32_16x16x32_bf16 a[24:27],a[172:175],v[248:251],a[24:27]
 v_exp_f32 v145,v145
 v_mfma_f32_16x16x32_bf16 a[24:27],a[168:171],v[232:235],a[24:27]
 ds_read_b128 a[148:151],v5 offset:45056
 v_cvt_pk_bf16_f32 v194,v144,v145
 v_mfma_f32_16x16x32_bf16 a[20:23],a[168:171],v[228:231],a[20:23]
 v_exp_f32 v146,v146
 v_mfma_f32_16x16x32_bf16 a[20:23],a[172:175],v[244:247],a[20:23]
 ds_read_b128 a[152:155],v6 offset:45056
 v_mfma_f32_16x16x32_bf16 a[16:19],a[172:175],v[240:243],a[16:19]
 v_exp_f32 v147,v147
 v_mfma_f32_16x16x32_bf16 a[16:19],a[168:171],v[224:227],a[16:19]
 ds_read_b128 a[156:159],v7 offset:45056
 v_cvt_pk_bf16_f32 v195,v146,v147
 v_mfma_f32_16x16x32_bf16 a[32:35],a[176:179],v[224:227],a[32:35]
 s_add_u32 m0,s3,16384
 v_exp_f32 v132,v132
 v_mfma_f32_16x16x32_bf16 a[32:35],a[180:183],v[240:243],a[32:35]
 buffer_load_dwordx4 v24,s[12:15],s41 offen offset:0 lds
 v_mfma_f32_16x16x32_bf16 a[36:39],a[180:183],v[244:247],a[36:39]
 v_exp_f32 v133,v133
 v_mfma_f32_16x16x32_bf16 a[36:39],a[176:179],v[228:231],a[36:39]
 ds_read_b64_tr_b16 a[160:161],v12 offset:16384
 v_cvt_pk_bf16_f32 v196,v132,v133
 v_mfma_f32_16x16x32_bf16 a[40:43],a[176:179],v[232:235],a[40:43]
 v_exp_f32 v134,v134
 v_mfma_f32_16x16x32_bf16 a[40:43],a[180:183],v[248:251],a[40:43]
 ds_read_b64_tr_b16 a[162:163],v12 offset:20480
 v_mfma_f32_16x16x32_bf16 a[44:47],a[180:183],v[252:255],a[44:47]
 v_exp_f32 v135,v135
 v_mfma_f32_16x16x32_bf16 a[44:47],a[176:179],v[236:239],a[44:47]
 v_cvt_pk_bf16_f32 v197,v134,v135
 v_mfma_f32_16x16x32_bf16 a[60:63],a[184:187],v[236:239],a[60:63]
 v_exp_f32 v148,v148
 v_mfma_f32_16x16x32_bf16 a[60:63],a[188:191],v[252:255],a[60:63]
 buffer_load_dwordx4 v25,s[12:15],s41 offen offset:1024 lds
 v_mfma_f32_16x16x32_bf16 a[56:59],a[188:191],v[248:251],a[56:59]
 v_exp_f32 v149,v149
 v_mfma_f32_16x16x32_bf16 a[56:59],a[184:187],v[232:235],a[56:59]
 ds_read_b64_tr_b16 a[164:165],v12 offset:24576
 v_cvt_pk_bf16_f32 v198,v148,v149
 v_mfma_f32_16x16x32_bf16 a[52:55],a[184:187],v[228:231],a[52:55]
 v_exp_f32 v150,v150
 v_mfma_f32_16x16x32_bf16 a[52:55],a[188:191],v[244:247],a[52:55]
 ds_read_b64_tr_b16 a[166:167],v12 offset:28672
 v_mfma_f32_16x16x32_bf16 a[48:51],a[188:191],v[240:243],a[48:51]
 v_exp_f32 v151,v151
 v_mfma_f32_16x16x32_bf16 a[48:51],a[184:187],v[224:227],a[48:51]
 s_waitcnt lgkmcnt(4)
 v_cvt_pk_bf16_f32 v199,v150,v151
 v_smfmac_f32_16x16x64_bf16 v[36:39],v[20:23],v[224:231],v60
 v_smfmac_f32_16x16x64_bf16 v[40:43],v[20:23],v[232:239],v60
 v_mfma_f32_16x16x32_bf16 v[160:163],a[128:131],v[64:67],v[44:47]
 s_mov_b32 s40,8192
 v_exp_f32 v136,v136
 v_mfma_f32_16x16x32_bf16 v[160:163],a[132:135],v[68:71],v[160:163]
 ds_read_b64_tr_b16 a[168:169],v13 offset:16384
 buffer_load_dwordx4 a[224:227],v1,s[4:7],s40 offen offset:0 sc1
 v_mfma_f32_16x16x32_bf16 v[160:163],a[136:139],v[72:75],v[160:163]
 v_exp_f32 v137,v137
 v_mfma_f32_16x16x32_bf16 v[160:163],a[140:143],v[76:79],v[160:163]
 ds_read_b64_tr_b16 a[170:171],v13 offset:20480
 v_cvt_pk_bf16_f32 v200,v136,v137
 v_mfma_f32_16x16x32_bf16 v[164:167],a[140:143],v[92:95],v[48:51]
 v_exp_f32 v138,v138
 v_mfma_f32_16x16x32_bf16 v[164:167],a[136:139],v[88:91],v[164:167]
 ds_read_b64_tr_b16 a[172:173],v13 offset:24576
 buffer_load_dwordx4 a[228:231],v1,s[4:7],s40 offen offset:1024 sc1
 v_mfma_f32_16x16x32_bf16 v[164:167],a[132:135],v[84:87],v[164:167]
 v_exp_f32 v139,v139
 v_mfma_f32_16x16x32_bf16 v[164:167],a[128:131],v[80:83],v[164:167]
 ds_read_b64_tr_b16 a[174:175],v13 offset:28672
 v_cvt_pk_bf16_f32 v201,v138,v139
 v_mfma_f32_16x16x32_bf16 v[168:171],a[128:131],v[96:99],v[52:55]
 v_exp_f32 v152,v152
 v_mfma_f32_16x16x32_bf16 v[168:171],a[132:135],v[100:103],v[168:171]
 ds_read_b64_tr_b16 a[176:177],v14 offset:16384
 v_mfma_f32_16x16x32_bf16 v[168:171],a[136:139],v[104:107],v[168:171]
 v_exp_f32 v153,v153
 v_mfma_f32_16x16x32_bf16 v[168:171],a[140:143],v[108:111],v[168:171]
 ds_read_b64_tr_b16 a[178:179],v14 offset:20480
 v_cvt_pk_bf16_f32 v202,v152,v153
 v_mfma_f32_16x16x32_bf16 v[172:175],a[140:143],v[124:127],v[56:59]
 v_exp_f32 v154,v154
 v_mfma_f32_16x16x32_bf16 v[172:175],a[136:139],v[120:123],v[172:175]
 ds_read_b64_tr_b16 a[180:181],v14 offset:24576
 buffer_load_dwordx4 a[240:243],v1,s[4:7],s40 offen offset:2048 sc1
 v_mfma_f32_16x16x32_bf16 v[172:175],a[132:135],v[116:119],v[172:175]
 v_exp_f32 v155,v155
 v_mfma_f32_16x16x32_bf16 v[172:175],a[128:131],v[112:115],v[172:175]
 ds_read_b64_tr_b16 a[182:183],v14 offset:28672
 v_cvt_pk_bf16_f32 v203,v154,v155
 v_mfma_f32_16x16x32_bf16 v[188:191],a[144:147],v[112:115],v[56:59]
 v_exp_f32 v140,v140
 v_mfma_f32_16x16x32_bf16 v[188:191],a[148:151],v[116:119],v[188:191]
 ds_read_b64_tr_b16 a[184:185],v15 offset:16384
 buffer_load_dwordx4 a[244:247],v1,s[4:7],s40 offen offset:3072 sc1
 v_mfma_f32_16x16x32_bf16 v[188:191],a[152:155],v[120:123],v[188:191]
 v_exp_f32 v141,v141
 v_mfma_f32_16x16x32_bf16 v[188:191],a[156:159],v[124:127],v[188:191]
 ds_read_b64_tr_b16 a[186:187],v15 offset:20480
 v_cvt_pk_bf16_f32 v204,v140,v141
 v_mfma_f32_16x16x32_bf16 v[184:187],a[156:159],v[108:111],v[52:55]
 v_exp_f32 v142,v142
 v_mfma_f32_16x16x32_bf16 v[184:187],a[152:155],v[104:107],v[184:187]
 ds_read_b64_tr_b16 a[188:189],v15 offset:24576
 v_mfma_f32_16x16x32_bf16 v[184:187],a[148:151],v[100:103],v[184:187]
 v_exp_f32 v143,v143
 v_mfma_f32_16x16x32_bf16 v[184:187],a[144:147],v[96:99],v[184:187]
 ds_read_b64_tr_b16 a[190:191],v15 offset:28672
 v_cvt_pk_bf16_f32 v205,v142,v143
 v_mfma_f32_16x16x32_bf16 v[180:183],a[144:147],v[80:83],v[48:51]
 v_exp_f32 v156,v156
 v_mfma_f32_16x16x32_bf16 v[180:183],a[148:151],v[84:87],v[180:183]
 buffer_load_dwordx4 v26,s[12:15],s41 offen offset:2048 lds
 v_mfma_f32_16x16x32_bf16 v[180:183],a[152:155],v[88:91],v[180:183]
 v_exp_f32 v157,v157
 v_mfma_f32_16x16x32_bf16 v[180:183],a[156:159],v[92:95],v[180:183]
L_stub_b_1:
 s_cbranch_execz L_warm_b_ret
 v_cvt_pk_bf16_f32 v206,v156,v157
 v_mfma_f32_16x16x32_bf16 v[176:179],a[156:159],v[76:79],v[44:47]
 v_exp_f32 v158,v158
 v_mfma_f32_16x16x32_bf16 v[176:179],a[152:155],v[72:75],v[176:179]
 buffer_load_dwordx4 v27,s[12:15],s41 offen offset:3072 lds
 v_mfma_f32_16x16x32_bf16 v[176:179],a[148:151],v[68:71],v[176:179]
 s_mov_b32 s41,2752512
 v_exp_f32 v159,v159
 v_mfma_f32_16x16x32_bf16 v[176:179],a[144:147],v[64:67],v[176:179]
 s_waitcnt vmcnt(30) lgkmcnt(0)
 s_barrier
 v_cvt_pk_bf16_f32 v207,v158,v159
 v_mfma_f32_16x16x32_bf16 a[64:67],a[160:163],v[224:227],a[64:67]
 s_add_u32 m0,s3,131072
 s_mov_b32 s42,7340032
 v_exp_f32 v160,v160
 v_mfma_f32_16x16x32_bf16 a[64:67],a[164:167],v[240:243],a[64:67]
 ds_read_b128 a[128:131],v4 offset:49152
 buffer_load_dwordx4 v24,s[12:15],s42 offen offset:0 lds
 v_mfma_f32_16x16x32_bf16 a[68:71],a[164:167],v[244:247],a[68:71]
 v_exp_f32 v161,v161
 v_mfma_f32_16x16x32_bf16 a[68:71],a[160:163],v[228:231],a[68:71]
 ds_read_b128 a[132:135],v5 offset:49152
 v_cvt_pk_bf16_f32 v208,v160,v161
 v_mfma_f32_16x16x32_bf16 a[72:75],a[160:163],v[232:235],a[72:75]
 v_exp_f32 v162,v162
 v_mfma_f32_16x16x32_bf16 a[72:75],a[164:167],v[248:251],a[72:75]
 ds_read_b128 a[136:139],v6 offset:49152
 buffer_load_dwordx4 v25,s[12:15],s42 offen offset:1024 lds
 v_mfma_f32_16x16x32_bf16 a[76:79],a[164:167],v[252:255],a[76:79]
 v_exp_f32 v163,v163
 v_mfma_f32_16x16x32_bf16 a[76:79],a[160:163],v[236:239],a[76:79]
 ds_read_b128 a[140:143],v7 offset:49152
 v_cvt_pk_bf16_f32 v209,v162,v163
 v_mfma_f32_16x16x32_bf16 a[92:95],a[168:171],v[236:239],a[92:95]
 v_exp_f32 v176,v176
 v_mfma_f32_16x16x32_bf16 a[92:95],a[172:175],v[252:255],a[92:95]
 ds_read_b128 a[144:147],v4 offset:53248
 buffer_load_dwordx4 v26,s[12:15],s42 offen offset:2048 lds
 v_mfma_f32_16x16x32_bf16 a[88:91],a[172:175],v[248:251],a[88:91]
 v_exp_f32 v177,v177
 v_mfma_f32_16x16x32_bf16 a[88:91],a[168:171],v[232:235],a[88:91]
 ds_read_b128 a[148:151],v5 offset:53248
 v_cvt_pk_bf16_f32 v210,v176,v177
 v_mfma_f32_16x16x32_bf16 a[84:87],a[168:171],v[228:231],a[84:87]
 v_exp_f32 v178,v178
 v_mfma_f32_16x16x32_bf16 a[84:87],a[172:175],v[244:247],a[84:87]
 ds_read_b128 a[152:155],v6 offset:53248
 buffer_load_dwordx4 v27,s[12:15],s42 offen offset:3072 lds
 v_mfma_f32_16x16x32_bf16 a[80:83],a[172:175],v[240:243],a[80:83]
 v_exp_f32 v179,v179
 v_mfma_f32_16x16x32_bf16 a[80:83],a[168:171],v[224:227],a[80:83]
 ds_read_b128 a[156:159],v7 offset:53248
 v_cvt_pk_bf16_f32 v211,v178,v179
 v_mfma_f32_16x16x32_bf16 a[96:99],a[176:179],v[224:227],a[96:99]
 s_add_u32 m0,s3,81920
 v_exp_f32 v164,v164
 v_mfma_f32_16x16x32_bf16 a[96:99],a[180:183],v[240:243],a[96:99]
 buffer_load_dwordx4 v24,s[12:15],s41 offen offset:0 lds
 v_mfma_f32_16x16x32_bf16 a[100:103],a[180:183],v[244:247],a[100:103]
 v_exp_f32 v165,v165
 v_mfma_f32_16x16x32_bf16 a[100:103],a[176:179],v[228:231],a[100:103]
 ds_read_b64_tr_b16 a[160:161],v8 offset:32768
 v_cvt_pk_bf16_f32 v212,v164,v165
 v_mfma_f32_16x16x32_bf16 a[104:107],a[176:179],v[232:235],a[104:107]
 v_exp_f32 v166,v166
 v_mfma_f32_16x16x32_bf16 a[104:107],a[180:183],v[248:251],a[104:107]
 ds_read_b64_tr_b16 a[162:163],v8 offset:36864
 v_mfma_f32_16x16x32_bf16 a[108:111],a[180:183],v[252:255],a[108:111]
 v_exp_f32 v167,v167
 v_mfma_f32_16x16x32_bf16 a[108:111],a[176:179],v[236:239],a[108:111]
 v_cvt_pk_bf16_f32 v213,v166,v167
 v_mfma_f32_16x16x32_bf16 a[124:127],a[184:187],v[236:239],a[124:127]
 v_exp_f32 v180,v180
 v_mfma_f32_16x16x32_bf16 a[124:127],a[188:191],v[252:255],a[124:127]
 buffer_load_dwordx4 v25,s[12:15],s41 offen offset:1024 lds
 v_mfma_f32_16x16x32_bf16 a[120:123],a[188:191],v[248:251],a[120:123]
 v_exp_f32 v181,v181
 v_mfma_f32_16x16x32_bf16 a[120:123],a[184:187],v[232:235],a[120:123]
 ds_read_b64_tr_b16 a[164:165],v8 offset:40960
 v_cvt_pk_bf16_f32 v214,v180,v181
 v_mfma_f32_16x16x32_bf16 a[116:119],a[184:187],v[228:231],a[116:119]
 v_exp_f32 v182,v182
 v_mfma_f32_16x16x32_bf16 a[116:119],a[188:191],v[244:247],a[116:119]
 ds_read_b64_tr_b16 a[166:167],v8 offset:45056
 v_mfma_f32_16x16x32_bf16 a[112:115],a[188:191],v[240:243],a[112:115]
 v_exp_f32 v183,v183
 v_mfma_f32_16x16x32_bf16 a[112:115],a[184:187],v[224:227],a[112:115]
 s_waitcnt lgkmcnt(4)
 v_cvt_pk_bf16_f32 v215,v182,v183
 v_smfmac_f32_16x16x64_bf16 v[36:39],v[20:23],v[240:247],v60
 v_smfmac_f32_16x16x64_bf16 v[40:43],v[20:23],v[248:255],v60
 v_mfma_f32_16x16x32_bf16 v[128:131],a[128:131],v[64:67],v[44:47]
 s_mov_b32 s40,139264
 v_exp_f32 v168,v168
 v_mfma_f32_16x16x32_bf16 v[128:131],a[132:135],v[68:71],v[128:131]
 ds_read_b64_tr_b16 a[168:169],v9 offset:32768
 buffer_load_dwordx4 a[232:235],v1,s[4:7],s40 offen offset:0 sc1
 v_mfma_f32_16x16x32_bf16 v[128:131],a[136:139],v[72:75],v[128:131]
 v_exp_f32 v169,v169
 v_mfma_f32_16x16x32_bf16 v[128:131],a[140:143],v[76:79],v[128:131]
 ds_read_b64_tr_b16 a[170:171],v9 offset:36864
 v_cvt_pk_bf16_f32 v216,v168,v169
 v_mfma_f32_16x16x32_bf16 v[132:135],a[140:143],v[92:95],v[48:51]
 v_exp_f32 v170,v170
 v_mfma_f32_16x16x32_bf16 v[132:135],a[136:139],v[88:91],v[132:135]
 ds_read_b64_tr_b16 a[172:173],v9 offset:40960
 buffer_load_dwordx4 a[236:239],v1,s[4:7],s40 offen offset:1024 sc1
 v_mfma_f32_16x16x32_bf16 v[132:135],a[132:135],v[84:87],v[132:135]
 v_exp_f32 v171,v171
 v_mfma_f32_16x16x32_bf16 v[132:135],a[128:131],v[80:83],v[132:135]
 ds_read_b64_tr_b16 a[174:175],v9 offset:45056
 v_cvt_pk_bf16_f32 v217,v170,v171
 v_mfma_f32_16x16x32_bf16 v[136:139],a[128:131],v[96:99],v[52:55]
 v_exp_f32 v184,v184
 v_mfma_f32_16x16x32_bf16 v[136:139],a[132:135],v[100:103],v[136:139]
 ds_read_b64_tr_b16 a[176:177],v10 offset:32768
 v_mfma_f32_16x16x32_bf16 v[136:139],a[136:139],v[104:107],v[136:139]
 v_exp_f32 v185,v185
 v_mfma_f32_16x16x32_bf16 v[136:139],a[140:143],v[108:111],v[136:139]
 ds_read_b64_tr_b16 a[178:179],v10 offset:36864
 v_cvt_pk_bf16_f32 v218,v184,v185
 v_mfma_f32_16x16x32_bf16 v[140:143],a[140:143],v[124:127],v[56:59]
 v_exp_f32 v186,v186
 v_mfma_f32_16x16x32_bf16 v[140:143],a[136:139],v[120:123],v[140:143]
 ds_read_b64_tr_b16 a[180:181],v10 offset:40960
 buffer_load_dwordx4 a[248:251],v1,s[4:7],s40 offen offset:2048 sc1
 v_mfma_f32_16x16x32_bf16 v[140:143],a[132:135],v[116:119],v[140:143]
 v_exp_f32 v187,v187
 v_mfma_f32_16x16x32_bf16 v[140:143],a[128:131],v[112:115],v[140:143]
 ds_read_b64_tr_b16 a[182:183],v10 offset:45056
 v_cvt_pk_bf16_f32 v219,v186,v187
 v_mfma_f32_16x16x32_bf16 v[156:159],a[144:147],v[112:115],v[56:59]
 v_exp_f32 v172,v172
 v_mfma_f32_16x16x32_bf16 v[156:159],a[148:151],v[116:119],v[156:159]
 ds_read_b64_tr_b16 a[184:185],v11 offset:32768
 buffer_load_dwordx4 a[252:255],v1,s[4:7],s40 offen offset:3072 sc1
 v_mfma_f32_16x16x32_bf16 v[156:159],a[152:155],v[120:123],v[156:159]
 v_exp_f32 v173,v173
 v_mfma_f32_16x16x32_bf16 v[156:159],a[156:159],v[124:127],v[156:159]
 ds_read_b64_tr_b16 a[186:187],v11 offset:36864
 v_cvt_pk_bf16_f32 v220,v172,v173
 v_mfma_f32_16x16x32_bf16 v[152:155],a[156:159],v[108:111],v[52:55]
 v_exp_f32 v174,v174
 v_mfma_f32_16x16x32_bf16 v[152:155],a[152:155],v[104:107],v[152:155]
 ds_read_b64_tr_b16 a[188:189],v11 offset:40960
 v_mfma_f32_16x16x32_bf16 v[152:155],a[148:151],v[100:103],v[152:155]
 v_exp_f32 v175,v175
 v_mfma_f32_16x16x32_bf16 v[152:155],a[144:147],v[96:99],v[152:155]
 ds_read_b64_tr_b16 a[190:191],v11 offset:45056
 v_cvt_pk_bf16_f32 v221,v174,v175
 v_mfma_f32_16x16x32_bf16 v[148:151],a[144:147],v[80:83],v[48:51]
 v_exp_f32 v188,v188
 v_mfma_f32_16x16x32_bf16 v[148:151],a[148:151],v[84:87],v[148:151]
 buffer_load_dwordx4 v26,s[12:15],s41 offen offset:2048 lds
 v_mfma_f32_16x16x32_bf16 v[148:151],a[152:155],v[88:91],v[148:151]
 v_exp_f32 v189,v189
 v_mfma_f32_16x16x32_bf16 v[148:151],a[156:159],v[92:95],v[148:151]
 v_cvt_pk_bf16_f32 v222,v188,v189
 v_mfma_f32_16x16x32_bf16 v[144:147],a[156:159],v[76:79],v[44:47]
 v_exp_f32 v190,v190
 v_mfma_f32_16x16x32_bf16 v[144:147],a[152:155],v[72:75],v[144:147]
 buffer_load_dwordx4 v27,s[12:15],s41 offen offset:3072 lds
 v_mfma_f32_16x16x32_bf16 v[144:147],a[148:151],v[68:71],v[144:147]
 s_mov_b32 s41,3670016
 v_exp_f32 v191,v191
 v_mfma_f32_16x16x32_bf16 v[144:147],a[144:147],v[64:67],v[144:147]
 s_waitcnt lgkmcnt(0)
 v_cvt_pk_bf16_f32 v223,v190,v191
 v_mfma_f32_16x16x32_bf16 a[0:3],a[160:163],v[192:195],a[0:3]
 s_add_u32 m0,s3,147456
 s_mov_b32 s42,8257536
 v_exp_f32 v128,v128
 v_mfma_f32_16x16x32_bf16 a[0:3],a[164:167],v[208:211],a[0:3]
 ds_read_b128 a[128:131],v4 offset:57344
 buffer_load_dwordx4 v24,s[12:15],s42 offen offset:0 lds
 v_mfma_f32_16x16x32_bf16 a[4:7],a[164:167],v[212:215],a[4:7]
 v_exp_f32 v129,v129
 v_mfma_f32_16x16x32_bf16 a[4:7],a[160:163],v[196:199],a[4:7]
 ds_read_b128 a[132:135],v5 offset:57344
 v_cvt_pk_bf16_f32 v224,v128,v129
 v_mfma_f32_16x16x32_bf16 a[8:11],a[160:163],v[200:203],a[8:11]
 v_exp_f32 v130,v130
 v_mfma_f32_16x16x32_bf16 a[8:11],a[164:167],v[216:219],a[8:11]
 ds_read_b128 a[136:139],v6 offset:57344
 buffer_load_dwordx4 v25,s[12:15],s42 offen offset:1024 lds
 v_mfma_f32_16x16x32_bf16 a[12:15],a[164:167],v[220:223],a[12:15]
 v_exp_f32 v131,v131
 v_mfma_f32_16x16x32_bf16 a[12:15],a[160:163],v[204:207],a[12:15]
 ds_read_b128 a[140:143],v7 offset:57344
 v_cvt_pk_bf16_f32 v225,v130,v131
 v_mfma_f32_16x16x32_bf16 a[28:31],a[168:171],v[204:207],a[28:31]
 v_exp_f32 v144,v144
 v_mfma_f32_16x16x32_bf16 a[28:31],a[172:175],v[220:223],a[28:31]
 ds_read_b128 a[144:147],v4 offset:61440
 buffer_load_dwordx4 v26,s[12:15],s42 offen offset:2048 lds
 v_mfma_f32_16x16x32_bf16 a[24:27],a[172:175],v[216:219],a[24:27]
 v_exp_f32 v145,v145
 v_mfma_f32_16x16x32_bf16 a[24:27],a[168:171],v[200:203],a[24:27]
 ds_read_b128 a[148:151],v5 offset:61440
 v_cvt_pk_bf16_f32 v226,v144,v145
 v_mfma_f32_16x16x32_bf16 a[20:23],a[168:171],v[196:199],a[20:23]
 v_exp_f32 v146,v146
 v_mfma_f32_16x16x32_bf16 a[20:23],a[172:175],v[212:215],a[20:23]
 ds_read_b128 a[152:155],v6 offset:61440
 buffer_load_dwordx4 v27,s[12:15],s42 offen offset:3072 lds
 v_mfma_f32_16x16x32_bf16 a[16:19],a[172:175],v[208:211],a[16:19]
 v_exp_f32 v147,v147
 v_mfma_f32_16x16x32_bf16 a[16:19],a[168:171],v[192:195],a[16:19]
 ds_read_b128 a[156:159],v7 offset:61440
 v_cvt_pk_bf16_f32 v227,v146,v147
 v_mfma_f32_16x16x32_bf16 a[32:35],a[176:179],v[192:195],a[32:35]
 s_add_u32 m0,s3,32768
 v_exp_f32 v132,v132
 v_mfma_f32_16x16x32_bf16 a[32:35],a[180:183],v[208:211],a[32:35]
 buffer_load_dwordx4 v24,s[12:15],s41 offen offset:0 lds
 v_mfma_f32_16x16x32_bf16 a[36:39],a[180:183],v[212:215],a[36:39]
 v_exp_f32 v133,v133
 v_mfma_f32_16x16x32_bf16 a[36:39],a[176:179],v[196:199],a[36:39]
 ds_read_b64_tr_b16 a[160:161],v12 offset:32768
 v_cvt_pk_bf16_f32 v228,v132,v133
 v_mfma_f32_16x16x32_bf16 a[40:43],a[176:179],v[200:203],a[40:43]
 v_exp_f32 v134,v134
 v_mfma_f32_16x16x32_bf16 a[40:43],a[180:183],v[216:219],a[40:43]
 ds_read_b64_tr_b16 a[162:163],v12 offset:36864
 v_mfma_f32_16x16x32_bf16 a[44:47],a[180:183],v[220:223],a[44:47]
 v_exp_f32 v135,v135
 v_mfma_f32_16x16x32_bf16 a[44:47],a[176:179],v[204:207],a[44:47]
 v_cvt_pk_bf16_f32 v229,v134,v135
 v_mfma_f32_16x16x32_bf16 a[60:63],a[184:187],v[204:207],a[60:63]
 v_exp_f32 v148,v148
 v_mfma_f32_16x16x32_bf16 a[60:63],a[188:191],v[220:223],a[60:63]
 buffer_load_dwordx4 v25,s[12:15],s41 offen offset:1024 lds
 v_mfma_f32_16x16x32_bf16 a[56:59],a[188:191],v[216:219],a[56:59]
 v_exp_f32 v149,v149
 v_mfma_f32_16x16x32_bf16 a[56:59],a[184:187],v[200:203],a[56:59]
 ds_read_b64_tr_b16 a[164:165],v12 offset:40960
 v_cvt_pk_bf16_f32 v230,v148,v149
 v_mfma_f32_16x16x32_bf16 a[52:55],a[184:187],v[196:199],a[52:55]
 v_exp_f32 v150,v150
 v_mfma_f32_16x16x32_bf16 a[52:55],a[188:191],v[212:215],a[52:55]
 ds_read_b64_tr_b16 a[166:167],v12 offset:45056
 v_mfma_f32_16x16x32_bf16 a[48:51],a[188:191],v[208:211],a[48:51]
 v_exp_f32 v151,v151
 v_mfma_f32_16x16x32_bf16 a[48:51],a[184:187],v[192:195],a[48:51]
 s_waitcnt lgkmcnt(4)
 v_cvt_pk_bf16_f32 v231,v150,v151
 v_smfmac_f32_16x16x64_bf16 v[36:39],v[20:23],v[192:199],v60
 v_smfmac_f32_16x16x64_bf16 v[40:43],v[20:23],v[200:207],v60
 v_mfma_f32_16x16x32_bf16 v[160:163],a[128:131],v[64:67],v[44:47]
 v_exp_f32 v136,v136
 v_mfma_f32_16x16x32_bf16 v[160:163],a[132:135],v[68:71],v[160:163]
 ds_read_b64_tr_b16 a[168:169],v13 offset:32768
 v_mfma_f32_16x16x32_bf16 v[160:163],a[136:139],v[72:75],v[160:163]
 v_exp_f32 v137,v137
 v_mfma_f32_16x16x32_bf16 v[160:163],a[140:143],v[76:79],v[160:163]
 ds_read_b64_tr_b16 a[170:171],v13 offset:36864
 v_cvt_pk_bf16_f32 v232,v136,v137
 v_mfma_f32_16x16x32_bf16 v[164:167],a[140:143],v[92:95],v[48:51]
 v_exp_f32 v138,v138
 v_mfma_f32_16x16x32_bf16 v[164:167],a[136:139],v[88:91],v[164:167]
 ds_read_b64_tr_b16 a[172:173],v13 offset:40960
 v_mfma_f32_16x16x32_bf16 v[164:167],a[132:135],v[84:87],v[164:167]
 v_exp_f32 v139,v139
 v_mfma_f32_16x16x32_bf16 v[164:167],a[128:131],v[80:83],v[164:167]
 ds_read_b64_tr_b16 a[174:175],v13 offset:45056
 v_cvt_pk_bf16_f32 v233,v138,v139
 v_mfma_f32_16x16x32_bf16 v[168:171],a[128:131],v[96:99],v[52:55]
 v_exp_f32 v152,v152
 v_mfma_f32_16x16x32_bf16 v[168:171],a[132:135],v[100:103],v[168:171]
 ds_read_b64_tr_b16 a[176:177],v14 offset:32768
 v_mfma_f32_16x16x32_bf16 v[168:171],a[136:139],v[104:107],v[168:171]
 v_exp_f32 v153,v153
 v_mfma_f32_16x16x32_bf16 v[168:171],a[140:143],v[108:111],v[168:171]
 ds_read_b64_tr_b16 a[178:179],v14 offset:36864
 v_cvt_pk_bf16_f32 v234,v152,v153
 v_mfma_f32_16x16x32_bf16 v[172:175],a[140:143],v[124:127],v[56:59]
 v_exp_f32 v154,v154
 v_mfma_f32_16x16x32_bf16 v[172:175],a[136:139],v[120:123],v[172:175]
 ds_read_b64_tr_b16 a[180:181],v14 offset:40960
 v_mfma_f32_16x16x32_bf16 v[172:175],a[132:135],v[116:119],v[172:175]
 v_exp_f32 v155,v155
 v_mfma_f32_16x16x32_bf16 v[172:175],a[128:131],v[112:115],v[172:175]
 ds_read_b64_tr_b16 a[182:183],v14 offset:45056
 v_cvt_pk_bf16_f32 v235,v154,v155
 v_mfma_f32_16x16x32_bf16 v[188:191],a[144:147],v[112:115],v[56:59]
 v_exp_f32 v140,v140
 v_mfma_f32_16x16x32_bf16 v[188:191],a[148:151],v[116:119],v[188:191]
 ds_read_b64_tr_b16 a[184:185],v15 offset:32768
 v_mfma_f32_16x16x32_bf16 v[188:191],a[152:155],v[120:123],v[188:191]
 v_exp_f32 v141,v141
 v_mfma_f32_16x16x32_bf16 v[188:191],a[156:159],v[124:127],v[188:191]
 ds_read_b64_tr_b16 a[186:187],v15 offset:36864
 v_cvt_pk_bf16_f32 v236,v140,v141
 v_mfma_f32_16x16x32_bf16 v[184:187],a[156:159],v[108:111],v[52:55]
 v_exp_f32 v142,v142
 v_mfma_f32_16x16x32_bf16 v[184:187],a[152:155],v[104:107],v[184:187]
 ds_read_b64_tr_b16 a[188:189],v15 offset:40960
 v_mfma_f32_16x16x32_bf16 v[184:187],a[148:151],v[100:103],v[184:187]
 v_exp_f32 v143,v143
 v_mfma_f32_16x16x32_bf16 v[184:187],a[144:147],v[96:99],v[184:187]
 ds_read_b64_tr_b16 a[190:191],v15 offset:45056
 v_cvt_pk_bf16_f32 v237,v142,v143
 v_mfma_f32_16x16x32_bf16 v[180:183],a[144:147],v[80:83],v[48:51]
 v_exp_f32 v156,v156
 v_mfma_f32_16x16x32_bf16 v[180:183],a[148:151],v[84:87],v[180:183]
 buffer_load_dwordx4 v26,s[12:15],s41 offen offset:2048 lds
 v_mfma_f32_16x16x32_bf16 v[180:183],a[152:155],v[88:91],v[180:183]
 v_exp_f32 v157,v157
 v_mfma_f32_16x16x32_bf16 v[180:183],a[156:159],v[92:95],v[180:183]
 v_cvt_pk_bf16_f32 v238,v156,v157
 v_mfma_f32_16x16x32_bf16 v[176:179],a[156:159],v[76:79],v[44:47]
 v_exp_f32 v158,v158
 v_mfma_f32_16x16x32_bf16 v[176:179],a[152:155],v[72:75],v[176:179]
 buffer_load_dwordx4 v27,s[12:15],s41 offen offset:3072 lds
 v_mfma_f32_16x16x32_bf16 v[176:179],a[148:151],v[68:71],v[176:179]
 s_mov_b32 s41,4587520
 v_exp_f32 v159,v159
 v_mfma_f32_16x16x32_bf16 v[176:179],a[144:147],v[64:67],v[176:179]
 s_waitcnt vmcnt(45) lgkmcnt(0)
 s_barrier
 v_cvt_pk_bf16_f32 v239,v158,v159
 v_mfma_f32_16x16x32_bf16 a[64:67],a[160:163],v[192:195],a[64:67]
 v_exp_f32 v160,v160
 v_mfma_f32_16x16x32_bf16 a[64:67],a[164:167],v[208:211],a[64:67]
 ds_read_b64_tr_b16 a[128:129],v8 offset:49152
 buffer_load_dwordx2 v[120:121],v62,s[8:11],0 offen offset:0
 v_mfma_f32_16x16x32_bf16 a[68:71],a[164:167],v[212:215],a[68:71]
 v_exp_f32 v161,v161
 v_mfma_f32_16x16x32_bf16 a[68:71],a[160:163],v[196:199],a[68:71]
 ds_read_b64_tr_b16 a[130:131],v8 offset:53248
 buffer_load_dwordx2 v[122:123],v62,s[8:11],0 offen offset:32
 v_mfma_f32_16x16x32_bf16 a[72:75],a[160:163],v[200:203],a[72:75]
 v_exp_f32 v162,v162
 v_mfma_f32_16x16x32_bf16 a[72:75],a[164:167],v[216:219],a[72:75]
 ds_read_b64_tr_b16 a[132:133],v8 offset:57344
 buffer_load_dwordx2 v[124:125],v62,s[8:11],0 offen offset:64
 v_mfma_f32_16x16x32_bf16 a[76:79],a[164:167],v[220:223],a[76:79]
 v_exp_f32 v163,v163
 v_cvt_pk_bf16_f32 v240,v160,v161
 v_mfma_f32_16x16x32_bf16 a[76:79],a[160:163],v[204:207],a[76:79]
 ds_read_b64_tr_b16 a[134:135],v8 offset:61440
 buffer_load_dwordx2 v[126:127],v62,s[8:11],0 offen offset:96
 v_smfmac_f32_16x16x64_bf16 v[36:39],v[20:23],v[208:215],v60
 v_exp_f32 v176,v176
 v_mfma_f32_16x16x32_bf16 a[92:95],a[168:171],v[204:207],a[92:95]
 ds_read_b64_tr_b16 a[136:137],v9 offset:49152
 v_exp_f32 v177,v177
 v_mfma_f32_16x16x32_bf16 a[92:95],a[172:175],v[220:223],a[92:95]
 s_mov_b32 s40,16384
 v_cvt_pk_bf16_f32 v241,v162,v163
 v_exp_f32 v178,v178
 v_mfma_f32_16x16x32_bf16 a[88:91],a[172:175],v[216:219],a[88:91]
 ds_read_b64_tr_b16 a[138:139],v9 offset:53248
 buffer_load_dwordx4 v[64:67],v1,s[4:7],s40 offen offset:0 sc1
 v_mfma_f32_16x16x32_bf16 a[88:91],a[168:171],v[200:203],a[88:91]
 v_exp_f32 v179,v179
 v_cvt_pk_bf16_f32 v242,v176,v177
 v_mfma_f32_16x16x32_bf16 a[84:87],a[168:171],v[196:199],a[84:87]
 ds_read_b64_tr_b16 a[140:141],v9 offset:57344
 v_exp_f32 v164,v164
 v_mfma_f32_16x16x32_bf16 a[84:87],a[172:175],v[212:215],a[84:87]
 v_exp_f32 v165,v165
 v_cvt_pk_bf16_f32 v243,v178,v179
 v_mfma_f32_16x16x32_bf16 a[80:83],a[172:175],v[208:211],a[80:83]
 ds_read_b64_tr_b16 a[142:143],v9 offset:61440
 v_exp_f32 v166,v166
 v_mfma_f32_16x16x32_bf16 a[80:83],a[168:171],v[192:195],a[80:83]
 v_exp_f32 v167,v167
 v_cvt_pk_bf16_f32 v244,v164,v165
 v_mfma_f32_16x16x32_bf16 a[96:99],a[176:179],v[192:195],a[96:99]
 ds_read_b64_tr_b16 a[144:145],v10 offset:49152
 buffer_load_dwordx4 v[68:71],v1,s[4:7],s40 offen offset:1024 sc1
 v_mfma_f32_16x16x32_bf16 a[96:99],a[180:183],v[208:211],a[96:99]
 v_exp_f32 v180,v180
 v_mfma_f32_16x16x32_bf16 a[100:103],a[180:183],v[212:215],a[100:103]
 ds_read_b64_tr_b16 a[146:147],v10 offset:53248
 v_exp_f32 v181,v181
 v_mfma_f32_16x16x32_bf16 a[100:103],a[176:179],v[196:199],a[100:103]
 v_cvt_pk_bf16_f32 v245,v166,v167
 v_exp_f32 v182,v182
 v_mfma_f32_16x16x32_bf16 a[104:107],a[176:179],v[200:203],a[104:107]
 ds_read_b64_tr_b16 a[148:149],v10 offset:57344
 v_exp_f32 v183,v183
 v_mfma_f32_16x16x32_bf16 a[104:107],a[180:183],v[216:219],a[104:107]
 v_cvt_pk_bf16_f32 v246,v180,v181
 v_exp_f32 v168,v168
 v_mfma_f32_16x16x32_bf16 a[108:111],a[180:183],v[220:223],a[108:111]
 ds_read_b64_tr_b16 a[150:151],v10 offset:61440
 buffer_load_dwordx4 v[80:83],v1,s[4:7],s40 offen offset:2048 sc1
 v_mfma_f32_16x16x32_bf16 a[108:111],a[176:179],v[204:207],a[108:111]
 ds_read_b64_tr_b16 a[152:153],v11 offset:49152
 v_exp_f32 v169,v169
 v_smfmac_f32_16x16x64_bf16 v[40:43],v[20:23],v[216:223],v60
 ds_read_b64_tr_b16 a[154:155],v11 offset:53248
 v_cvt_pk_bf16_f32 v247,v182,v183
 v_mfma_f32_16x16x32_bf16 a[124:127],a[184:187],v[204:207],a[124:127]
 ds_read_b64_tr_b16 a[156:157],v11 offset:57344
 v_exp_f32 v170,v170
 v_mfma_f32_16x16x32_bf16 a[124:127],a[188:191],v[220:223],a[124:127]
 ds_read_b64_tr_b16 a[158:159],v11 offset:61440
 v_exp_f32 v171,v171
 v_mfma_f32_16x16x32_bf16 a[120:123],a[188:191],v[216:219],a[120:123]
 v_cvt_pk_bf16_f32 v248,v168,v169
 v_exp_f32 v184,v184
 v_mfma_f32_16x16x32_bf16 a[120:123],a[184:187],v[200:203],a[120:123]
 buffer_load_dwordx4 v[84:87],v1,s[4:7],s40 offen offset:3072 sc1
 v_exp_f32 v185,v185
 v_mfma_f32_16x16x32_bf16 a[116:119],a[184:187],v[196:199],a[116:119]
 v_cvt_pk_bf16_f32 v249,v170,v171
 v_exp_f32 v186,v186
 v_mfma_f32_16x16x32_bf16 a[116:119],a[188:191],v[212:215],a[116:119]
 v_exp_f32 v187,v187
 v_cvt_pk_bf16_f32 v250,v184,v185
 v_mfma_f32_16x16x32_bf16 a[112:115],a[188:191],v[208:211],a[112:115]
 v_exp_f32 v172,v172
 v_mfma_f32_16x16x32_bf16 a[112:115],a[184:187],v[192:195],a[112:115]
 s_waitcnt lgkmcnt(0)
 v_exp_f32 v173,v173
 v_cvt_pk_bf16_f32 v251,v186,v187
 v_mfma_f32_16x16x32_bf16 a[0:3],a[128:131],v[224:227],a[0:3]
 s_mov_b32 s40,147456
 v_exp_f32 v174,v174
 v_mfma_f32_16x16x32_bf16 a[0:3],a[132:135],v[240:243],a[0:3]
 ds_read_b64_tr_b16 a[160:161],v12 offset:49152
 buffer_load_dwordx4 v[72:75],v1,s[4:7],s40 offen offset:0 sc1
 v_mfma_f32_16x16x32_bf16 a[16:19],a[140:143],v[240:243],a[16:19]
 v_exp_f32 v175,v175
 v_cvt_pk_bf16_f32 v252,v172,v173
 v_mfma_f32_16x16x32_bf16 a[16:19],a[136:139],v[224:227],a[16:19]
 ds_read_b64_tr_b16 a[162:163],v12 offset:53248
 v_exp_f32 v188,v188
 v_mfma_f32_16x16x32_bf16 a[32:35],a[144:147],v[224:227],a[32:35]
 v_exp_f32 v189,v189
 v_cvt_pk_bf16_f32 v253,v174,v175
 v_mfma_f32_16x16x32_bf16 a[32:35],a[148:151],v[240:243],a[32:35]
 ds_read_b64_tr_b16 a[164:165],v12 offset:57344
 v_exp_f32 v190,v190
 v_mfma_f32_16x16x32_bf16 a[48:51],a[156:159],v[240:243],a[48:51]
 v_exp_f32 v191,v191
 v_mfma_f32_16x16x32_bf16 a[48:51],a[152:155],v[224:227],a[48:51]
 ds_read_b64_tr_b16 a[166:167],v12 offset:61440
 buffer_load_dwordx4 v[76:79],v1,s[4:7],s40 offen offset:1024 sc1
 v_smfmac_f32_16x16x64_bf16 v[36:39],v[20:23],v[224:231],v60
 v_cvt_pk_bf16_f32 v254,v188,v189
 v_mfma_f32_16x16x32_bf16 a[4:7],a[128:131],v[228:231],a[4:7]
 ds_read_b64_tr_b16 a[168:169],v13 offset:49152
 v_cvt_pk_bf16_f32 v255,v190,v191
 v_mfma_f32_16x16x32_bf16 a[4:7],a[132:135],v[244:247],a[4:7]
 v_mfma_f32_16x16x32_bf16 a[20:23],a[140:143],v[244:247],a[20:23]
 ds_read_b64_tr_b16 a[170:171],v13 offset:53248
 v_mfma_f32_16x16x32_bf16 a[20:23],a[136:139],v[228:231],a[20:23]
 v_mfma_f32_16x16x32_bf16 a[36:39],a[144:147],v[228:231],a[36:39]
 ds_read_b64_tr_b16 a[172:173],v13 offset:57344
 buffer_load_dwordx4 v[88:91],v1,s[4:7],s40 offen offset:2048 sc1
 v_mfma_f32_16x16x32_bf16 a[36:39],a[148:151],v[244:247],a[36:39]
 v_mfma_f32_16x16x32_bf16 a[52:55],a[156:159],v[244:247],a[52:55]
 ds_read_b64_tr_b16 a[174:175],v13 offset:61440
 v_mfma_f32_16x16x32_bf16 a[52:55],a[152:155],v[228:231],a[52:55]
 v_smfmac_f32_16x16x64_bf16 v[40:43],v[20:23],v[232:239],v60
 ds_read_b64_tr_b16 a[176:177],v14 offset:49152
 v_mfma_f32_16x16x32_bf16 a[8:11],a[128:131],v[232:235],a[8:11]
 v_mfma_f32_16x16x32_bf16 a[8:11],a[132:135],v[248:251],a[8:11]
 ds_read_b64_tr_b16 a[178:179],v14 offset:53248
 buffer_load_dwordx4 v[92:95],v1,s[4:7],s40 offen offset:3072 sc1
 v_mfma_f32_16x16x32_bf16 a[24:27],a[140:143],v[248:251],a[24:27]
 v_mfma_f32_16x16x32_bf16 a[24:27],a[136:139],v[232:235],a[24:27]
 ds_read_b64_tr_b16 a[180:181],v14 offset:57344
 v_mfma_f32_16x16x32_bf16 a[40:43],a[144:147],v[232:235],a[40:43]
 ds_read_b64_tr_b16 a[182:183],v14 offset:61440
 v_mfma_f32_16x16x32_bf16 a[40:43],a[148:151],v[248:251],a[40:43]
 s_add_u32 m0,s3,98304
 ds_read_b64_tr_b16 a[184:185],v15 offset:49152
 v_mfma_f32_16x16x32_bf16 a[56:59],a[156:159],v[248:251],a[56:59]
 s_mov_b32 s41,4587520
 ds_read_b64_tr_b16 a[186:187],v15 offset:53248
 v_mfma_f32_16x16x32_bf16 a[56:59],a[152:155],v[232:235],a[56:59]
 ds_read_b64_tr_b16 a[188:189],v15 offset:57344
 buffer_load_dwordx4 v24,s[12:15],s41 offen offset:0 lds
 v_mfma_f32_16x16x32_bf16 a[12:15],a[128:131],v[236:239],a[12:15]
 ds_read_b64_tr_b16 a[190:191],v15 offset:61440
 v_mfma_f32_16x16x32_bf16 a[12:15],a[132:135],v[252:255],a[12:15]
 v_xor_b32 v8,s44,v8
 v_subrev_u32 v44,65536,v8
 v_mfma_f32_16x16x32_bf16 a[28:31],a[140:143],v[252:255],a[28:31]
 v_xor_b32 v9,s44,v9
 v_subrev_u32 v45,65536,v9
 v_mfma_f32_16x16x32_bf16 a[28:31],a[136:139],v[236:239],a[28:31]
 v_xor_b32 v10,s44,v10
 v_subrev_u32 v46,65536,v10
 v_mfma_f32_16x16x32_bf16 a[44:47],a[144:147],v[236:239],a[44:47]
 v_xor_b32 v11,s44,v11
 v_subrev_u32 v47,65536,v11
 v_mfma_f32_16x16x32_bf16 a[44:47],a[148:151],v[252:255],a[44:47]
 buffer_load_dwordx4 v25,s[12:15],s41 offen offset:1024 lds
 v_xor_b32 v12,s44,v12
 v_mfma_f32_16x16x32_bf16 a[60:63],a[156:159],v[252:255],a[60:63]
 v_subrev_u32 v48,65536,v12
 v_xor_b32 v13,s44,v13
 v_mfma_f32_16x16x32_bf16 a[60:63],a[152:155],v[236:239],a[60:63]
 s_waitcnt vmcnt(10) lgkmcnt(0)
 s_barrier
 v_mfma_f32_16x16x32_bf16 a[64:67],a[160:163],v[224:227],a[64:67]
 v_subrev_u32 v49,65536,v13
 v_xor_b32 v14,s44,v14
 v_mfma_f32_16x16x32_bf16 a[64:67],a[164:167],v[240:243],a[64:67]
 v_subrev_u32 v50,65536,v14
 v_xor_b32 v15,s44,v15
 v_smfmac_f32_16x16x64_bf16 v[36:39],v[20:23],v[240:247],v60
 v_subrev_u32 v51,65536,v15
 v_lshlrev_b32 v152,16,v120
 v_mfma_f32_16x16x32_bf16 a[68:71],a[164:167],v[244:247],a[68:71]
 buffer_load_dwordx4 v26,s[12:15],s41 offen offset:2048 lds
 v_and_b32 v153,0xffff0000,v120
 v_mfma_f32_16x16x32_bf16 a[68:71],a[160:163],v[228:231],a[68:71]
 v_lshlrev_b32 v154,16,v121
 v_and_b32 v155,0xffff0000,v121
 v_smfmac_f32_16x16x64_bf16 v[40:43],v[20:23],v[248:255],v60
 v_mul_f32 v152,0xbeeff558,v152
 v_mul_f32 v153,0xbeeff558,v153
 v_mfma_f32_16x16x32_bf16 a[72:75],a[160:163],v[232:235],a[72:75]
 v_mul_f32 v154,0xbeeff558,v154
 v_mul_f32 v155,0xbeeff558,v155
 v_mfma_f32_16x16x32_bf16 a[72:75],a[164:167],v[248:251],a[72:75]
 v_lshlrev_b32 v156,16,v122
 v_and_b32 v157,0xffff0000,v122
 v_mfma_f32_16x16x32_bf16 a[76:79],a[164:167],v[252:255],a[76:79]
 v_lshlrev_b32 v158,16,v123
 v_and_b32 v159,0xffff0000,v123
 v_mfma_f32_16x16x32_bf16 a[76:79],a[160:163],v[236:239],a[76:79]
 buffer_load_dwordx4 v27,s[12:15],s41 offen offset:3072 lds
 v_mul_f32 v156,0xbeeff558,v156
 v_mfma_f32_16x16x32_bf16 a[92:95],a[168:171],v[236:239],a[92:95]
 v_mul_f32 v157,0xbeeff558,v157
 v_mul_f32 v158,0xbeeff558,v158
 v_mfma_f32_16x16x32_bf16 a[92:95],a[172:175],v[252:255],a[92:95]
 v_mul_f32 v159,0xbeeff558,v159
 v_lshlrev_b32 v184,16,v124
 v_mfma_f32_16x16x32_bf16 a[88:91],a[172:175],v[248:251],a[88:91]
 ds_read_b64_tr_b16 a[128:129],v44 offset:0
 v_and_b32 v185,0xffff0000,v124
 v_mfma_f32_16x16x32_bf16 a[88:91],a[168:171],v[232:235],a[88:91]
 ds_read_b64_tr_b16 a[130:131],v44 offset:4096
 v_lshlrev_b32 v186,16,v125
 v_mfma_f32_16x16x32_bf16 a[84:87],a[168:171],v[228:231],a[84:87]
 ds_read_b64_tr_b16 a[132:133],v44 offset:8192
 v_and_b32 v187,0xffff0000,v125
 v_mfma_f32_16x16x32_bf16 a[84:87],a[172:175],v[244:247],a[84:87]
 ds_read_b64_tr_b16 a[134:135],v44 offset:12288
 v_mul_f32 v184,0xbeeff558,v184
 v_mfma_f32_16x16x32_bf16 a[80:83],a[172:175],v[240:243],a[80:83]
 ds_read_b64_tr_b16 a[136:137],v45 offset:0
 v_mul_f32 v185,0xbeeff558,v185
 v_mfma_f32_16x16x32_bf16 a[80:83],a[168:171],v[224:227],a[80:83]
 ds_read_b64_tr_b16 a[138:139],v45 offset:4096
 v_mul_f32 v186,0xbeeff558,v186
 v_mfma_f32_16x16x32_bf16 a[96:99],a[176:179],v[224:227],a[96:99]
 ds_read_b64_tr_b16 a[140:141],v45 offset:8192
 v_mul_f32 v187,0xbeeff558,v187
 v_mfma_f32_16x16x32_bf16 a[96:99],a[180:183],v[240:243],a[96:99]
 ds_read_b64_tr_b16 a[142:143],v45 offset:12288
 v_lshlrev_b32 v188,16,v126
 v_mfma_f32_16x16x32_bf16 a[100:103],a[180:183],v[244:247],a[100:103]
 ds_read_b64_tr_b16 a[144:145],v46 offset:0
 v_and_b32 v189,0xffff0000,v126
 v_mfma_f32_16x16x32_bf16 a[100:103],a[176:179],v[228:231],a[100:103]
 ds_read_b64_tr_b16 a[146:147],v46 offset:4096
 v_lshlrev_b32 v190,16,v127
 v_mfma_f32_16x16x32_bf16 a[104:107],a[176:179],v[232:235],a[104:107]
 ds_read_b64_tr_b16 a[148:149],v46 offset:8192
 v_and_b32 v191,0xffff0000,v127
 v_mfma_f32_16x16x32_bf16 a[104:107],a[180:183],v[248:251],a[104:107]
 ds_read_b64_tr_b16 a[150:151],v46 offset:12288
 v_mul_f32 v188,0xbeeff558,v188
 v_mfma_f32_16x16x32_bf16 a[108:111],a[180:183],v[252:255],a[108:111]
L_stub_b_2:
 s_cbranch_execz L_warm_b_ret
 ds_read_b64_tr_b16 a[152:153],v47 offset:0
 v_mul_f32 v189,0xbeeff558,v189
 v_mfma_f32_16x16x32_bf16 a[108:111],a[176:179],v[236:239],a[108:111]
 ds_read_b64_tr_b16 a[154:155],v47 offset:4096
 v_mul_f32 v190,0xbeeff558,v190
 v_mfma_f32_16x16x32_bf16 a[124:127],a[184:187],v[236:239],a[124:127]
 ds_read_b64_tr_b16 a[156:157],v47 offset:8192
 v_mul_f32 v191,0xbeeff558,v191
 v_mfma_f32_16x16x32_bf16 a[124:127],a[188:191],v[252:255],a[124:127]
 ds_read_b64_tr_b16 a[158:159],v47 offset:12288
 v_mfma_f32_16x16x32_bf16 a[120:123],a[188:191],v[248:251],a[120:123]
 v_mfma_f32_16x16x32_bf16 a[120:123],a[184:187],v[232:235],a[120:123]
 v_mfma_f32_16x16x32_bf16 a[116:119],a[184:187],v[228:231],a[116:119]
 v_mfma_f32_16x16x32_bf16 a[116:119],a[188:191],v[244:247],a[116:119]
 v_mfma_f32_16x16x32_bf16 a[112:115],a[188:191],v[240:243],a[112:115]
 v_mfma_f32_16x16x32_bf16 a[112:115],a[184:187],v[224:227],a[112:115]
 s_waitcnt lgkmcnt(0)
 v_mfma_f32_16x16x32_bf16 v[192:195],a[128:131],a[192:195],0
 ds_read_b64_tr_b16 a[160:161],v48 offset:0
 v_mfma_f32_16x16x32_bf16 v[192:195],a[132:135],a[208:211],v[192:195]
 s_mov_b32 s40,24576
 ds_read_b64_tr_b16 a[162:163],v48 offset:4096
 v_mfma_f32_16x16x32_bf16 v[200:203],a[128:131],a[196:199],0
 buffer_load_dwordx4 v[96:99],v1,s[4:7],s40 offen offset:0 sc1
 v_add_f32 v36,v36,v37
 v_mfma_f32_16x16x32_bf16 v[200:203],a[132:135],a[212:215],v[200:203]
 ds_read_b64_tr_b16 a[164:165],v48 offset:8192
 v_add_f32 v38,v38,v39
 v_mfma_f32_16x16x32_bf16 v[208:211],a[128:131],a[200:203],0
 ds_read_b64_tr_b16 a[166:167],v48 offset:12288
 v_add_f32 v40,v40,v41
 v_mfma_f32_16x16x32_bf16 v[208:211],a[132:135],a[216:219],v[208:211]
 buffer_load_dwordx4 v[100:103],v1,s[4:7],s40 offen offset:1024 sc1
 v_add_f32 v42,v42,v43
 v_mfma_f32_16x16x32_bf16 v[216:219],a[128:131],a[204:207],0
 ds_read_b64_tr_b16 a[168:169],v49 offset:0
 v_mov_b32 v37,v36
 v_mfma_f32_16x16x32_bf16 v[216:219],a[132:135],a[220:223],v[216:219]
 ds_read_b64_tr_b16 a[170:171],v49 offset:4096
 v_mov_b32 v39,v38
 v_mfma_f32_16x16x32_bf16 v[196:199],a[136:139],a[192:195],0
 v_mov_b32 v41,v40
 v_mov_b32 v43,v42
 v_mfma_f32_16x16x32_bf16 v[196:199],a[140:143],a[208:211],v[196:199]
 ds_read_b64_tr_b16 a[172:173],v49 offset:8192
 buffer_load_dwordx4 v[112:115],v1,s[4:7],s40 offen offset:2048 sc1
 v_mfma_f32_16x16x32_bf16 v[204:207],a[136:139],a[196:199],0
 ds_read_b64_tr_b16 a[174:175],v49 offset:12288
 v_mfma_f32_16x16x32_bf16 v[204:207],a[140:143],a[212:215],v[204:207]
 v_permlane16_swap_b32 v36,v37
 v_mfma_f32_16x16x32_bf16 v[212:215],a[136:139],a[200:203],0
 ds_read_b64_tr_b16 a[176:177],v50 offset:0
 v_mfma_f32_16x16x32_bf16 v[212:215],a[140:143],a[216:219],v[212:215]
 ds_read_b64_tr_b16 a[178:179],v50 offset:4096
 buffer_load_dwordx4 v[116:119],v1,s[4:7],s40 offen offset:3072 sc1
 v_mfma_f32_16x16x32_bf16 v[220:223],a[136:139],a[204:207],0
 v_permlane16_swap_b32 v38,v39
 v_mfma_f32_16x16x32_bf16 v[220:223],a[140:143],a[220:223],v[220:223]
 ds_read_b64_tr_b16 a[180:181],v50 offset:8192
 v_mfma_f32_16x16x32_bf16 v[224:227],a[144:147],a[192:195],0
 s_mov_b32 s40,155648
 ds_read_b64_tr_b16 a[182:183],v50 offset:12288
 v_mfma_f32_16x16x32_bf16 v[224:227],a[148:151],a[208:211],v[224:227]
 buffer_load_dwordx4 v[104:107],v1,s[4:7],s40 offen offset:0 sc1
 v_mfma_f32_16x16x32_bf16 v[232:235],a[144:147],a[196:199],0
 ds_read_b64_tr_b16 a[184:185],v51 offset:0
 v_mfma_f32_16x16x32_bf16 v[232:235],a[148:151],a[212:215],v[232:235]
 ds_read_b64_tr_b16 a[186:187],v51 offset:4096
 v_mfma_f32_16x16x32_bf16 v[240:243],a[144:147],a[200:203],0
 buffer_load_dwordx4 v[108:111],v1,s[4:7],s40 offen offset:1024 sc1
 v_mfma_f32_16x16x32_bf16 v[240:243],a[148:151],a[216:219],v[240:243]
 ds_read_b64_tr_b16 a[188:189],v51 offset:8192
 v_mfma_f32_16x16x32_bf16 v[248:251],a[144:147],a[204:207],0
 ds_read_b64_tr_b16 a[190:191],v51 offset:12288
 v_mfma_f32_16x16x32_bf16 v[248:251],a[148:151],a[220:223],v[248:251]
 v_permlane16_swap_b32 v40,v41
 v_mfma_f32_16x16x32_bf16 v[228:231],a[152:155],a[192:195],0
 buffer_load_dwordx4 v[120:123],v1,s[4:7],s40 offen offset:2048 sc1
 v_mfma_f32_16x16x32_bf16 v[228:231],a[156:159],a[208:211],v[228:231]
 v_permlane16_swap_b32 v42,v43
 v_mfma_f32_16x16x32_bf16 v[236:239],a[152:155],a[196:199],0
 v_add_f32 v36,v36,v37
 v_add_f32 v38,v38,v39
 v_mfma_f32_16x16x32_bf16 v[236:239],a[156:159],a[212:215],v[236:239]
 v_add_f32 v40,v40,v41
 v_add_f32 v42,v42,v43
 v_mfma_f32_16x16x32_bf16 v[244:247],a[152:155],a[200:203],0
 buffer_load_dwordx4 v[124:127],v1,s[4:7],s40 offen offset:3072 sc1
 v_mov_b32 v37,v36
 v_mfma_f32_16x16x32_bf16 v[244:247],a[156:159],a[216:219],v[244:247]
 v_mov_b32 v39,v38
 v_mov_b32 v41,v40
 v_mfma_f32_16x16x32_bf16 v[252:255],a[152:155],a[204:207],0
 v_mov_b32 v43,v42
 v_mfma_f32_16x16x32_bf16 v[252:255],a[156:159],a[220:223],v[252:255]
 s_waitcnt vmcnt(52) lgkmcnt(0)
 s_barrier
 v_mfma_f32_16x16x32_bf16 v[128:131],a[160:163],a[192:195],v[152:155]
 s_add_u32 m0,s3,114688
 ds_read_b64_tr_b16 a[128:129],v8 offset:0
 v_mfma_f32_16x16x32_bf16 v[128:131],a[164:167],a[208:211],v[128:131]
 s_mov_b32 s41,5505024
 ds_read_b64_tr_b16 a[130:131],v8 offset:4096
 v_mfma_f32_16x16x32_bf16 v[136:139],a[160:163],a[196:199],v[152:155]
 buffer_load_dwordx4 v24,s[12:15],s41 offen offset:0 lds
 v_mfma_f32_16x16x32_bf16 v[136:139],a[164:167],a[212:215],v[136:139]
 ds_read_b64_tr_b16 a[132:133],v8 offset:8192
 v_mfma_f32_16x16x32_bf16 v[144:147],a[160:163],a[200:203],v[152:155]
 ds_read_b64_tr_b16 a[134:135],v8 offset:12288
 v_mfma_f32_16x16x32_bf16 v[144:147],a[164:167],a[216:219],v[144:147]
 v_permlane32_swap_b32 v36,v37
 v_mfma_f32_16x16x32_bf16 v[152:155],a[160:163],a[204:207],v[152:155]
 ds_read_b64_tr_b16 a[136:137],v9 offset:0
 v_mfma_f32_16x16x32_bf16 v[152:155],a[164:167],a[220:223],v[152:155]
 ds_read_b64_tr_b16 a[138:139],v9 offset:4096
 v_mfma_f32_16x16x32_bf16 v[132:135],a[168:171],a[192:195],v[156:159]
 v_permlane32_swap_b32 v38,v39
 v_mfma_f32_16x16x32_bf16 v[132:135],a[172:175],a[208:211],v[132:135]
 ds_read_b64_tr_b16 a[140:141],v9 offset:8192
 buffer_load_dwordx4 v25,s[12:15],s41 offen offset:1024 lds
 v_mfma_f32_16x16x32_bf16 v[140:143],a[168:171],a[196:199],v[156:159]
 ds_read_b64_tr_b16 a[142:143],v9 offset:12288
 v_mfma_f32_16x16x32_bf16 v[140:143],a[172:175],a[212:215],v[140:143]
 v_permlane32_swap_b32 v40,v41
 v_mfma_f32_16x16x32_bf16 v[148:151],a[168:171],a[200:203],v[156:159]
 ds_read_b64_tr_b16 a[144:145],v10 offset:0
 v_mfma_f32_16x16x32_bf16 v[148:151],a[172:175],a[216:219],v[148:151]
 ds_read_b64_tr_b16 a[146:147],v10 offset:4096
 v_mfma_f32_16x16x32_bf16 v[156:159],a[168:171],a[204:207],v[156:159]
 v_permlane32_swap_b32 v42,v43
 v_mfma_f32_16x16x32_bf16 v[156:159],a[172:175],a[220:223],v[156:159]
 ds_read_b64_tr_b16 a[148:149],v10 offset:8192
 v_add_f32 v36,v36,v37
 v_mfma_f32_16x16x32_bf16 v[160:163],a[176:179],a[192:195],v[184:187]
 ds_read_b64_tr_b16 a[150:151],v10 offset:12288
 v_add_f32 v38,v38,v39
 v_mfma_f32_16x16x32_bf16 v[160:163],a[180:183],a[208:211],v[160:163]
 buffer_load_dwordx4 v26,s[12:15],s41 offen offset:2048 lds
 v_add_f32 v40,v40,v41
 v_mfma_f32_16x16x32_bf16 v[168:171],a[176:179],a[196:199],v[184:187]
 ds_read_b64_tr_b16 a[152:153],v11 offset:0
 v_add_f32 v42,v42,v43
 v_mfma_f32_16x16x32_bf16 v[168:171],a[180:183],a[212:215],v[168:171]
 ds_read_b64_tr_b16 a[154:155],v11 offset:4096
 v_mfma_f32_16x16x32_bf16 v[176:179],a[176:179],a[200:203],v[184:187]
 v_rcp_f32 v37,v36
 v_mfma_f32_16x16x32_bf16 v[176:179],a[180:183],a[216:219],v[176:179]
 ds_read_b64_tr_b16 a[156:157],v11 offset:8192
 v_mfma_f32_16x16x32_bf16 v[184:187],a[176:179],a[204:207],v[184:187]
 ds_read_b64_tr_b16 a[158:159],v11 offset:12288
 v_mfma_f32_16x16x32_bf16 v[184:187],a[180:183],a[220:223],v[184:187]
 v_rcp_f32 v39,v38
 v_mfma_f32_16x16x32_bf16 v[164:167],a[184:187],a[192:195],v[188:191]
 buffer_load_dwordx4 v27,s[12:15],s41 offen offset:3072 lds
 v_mfma_f32_16x16x32_bf16 v[164:167],a[188:191],a[208:211],v[164:167]
 v_rcp_f32 v41,v40
 v_mfma_f32_16x16x32_bf16 v[172:175],a[184:187],a[196:199],v[188:191]
 v_rcp_f32 v43,v42
 v_mfma_f32_16x16x32_bf16 v[172:175],a[188:191],a[212:215],v[172:175]
 v_accvgpr_read_b32 v4,a0
 v_accvgpr_read_b32 v5,a1
 v_mfma_f32_16x16x32_bf16 v[180:183],a[184:187],a[200:203],v[188:191]
 v_accvgpr_read_b32 v6,a2
 v_accvgpr_read_b32 v7,a3
 v_mfma_f32_16x16x32_bf16 v[180:183],a[188:191],a[216:219],v[180:183]
 v_mul_f32 v4,v4,v37
 v_mul_f32 v5,v5,v37
 v_mfma_f32_16x16x32_bf16 v[188:191],a[184:187],a[204:207],v[188:191]
 v_mul_f32 v6,v6,v37
 v_mul_f32 v7,v7,v37
 v_mfma_f32_16x16x32_bf16 v[188:191],a[188:191],a[220:223],v[188:191]
 s_waitcnt vmcnt(38) lgkmcnt(0)
 v_cvt_pk_bf16_f32 v20,v4,v5
 v_cvt_pk_bf16_f32 v21,v6,v7
 v_mfma_f32_16x16x32_bf16 v[192:195],a[128:131],a[224:227],v[192:195]
 ds_read_b64_tr_b16 a[160:161],v12 offset:0
 v_accvgpr_read_b32 v16,a16
 v_mfma_f32_16x16x32_bf16 v[192:195],a[132:135],a[240:243],v[192:195]
 s_mov_b32 s40,32768
 ds_read_b64_tr_b16 a[162:163],v12 offset:4096
 v_accvgpr_read_b32 v17,a17
 v_mfma_f32_16x16x32_bf16 v[200:203],a[132:135],a[244:247],v[200:203]
 buffer_load_dwordx4 a[192:195],v1,s[4:7],s40 offen offset:0 sc1
 v_accvgpr_read_b32 v18,a18
 v_mfma_f32_16x16x32_bf16 v[200:203],a[128:131],a[228:231],v[200:203]
 ds_read_b64_tr_b16 a[164:165],v12 offset:8192
 v_accvgpr_read_b32 v19,a19
 v_mfma_f32_16x16x32_bf16 v[208:211],a[128:131],a[232:235],v[208:211]
 ds_read_b64_tr_b16 a[166:167],v12 offset:12288
 v_mul_f32 v16,v16,v37
 v_mfma_f32_16x16x32_bf16 v[208:211],a[132:135],a[248:251],v[208:211]
 v_mul_f32 v17,v17,v37
 v_mul_f32 v18,v18,v37
 v_mfma_f32_16x16x32_bf16 v[216:219],a[132:135],a[252:255],v[216:219]
 ds_read_b64_tr_b16 a[168:169],v13 offset:0
 v_mul_f32 v19,v19,v37
 v_mfma_f32_16x16x32_bf16 v[216:219],a[128:131],a[236:239],v[216:219]
 ds_read_b64_tr_b16 a[170:171],v13 offset:4096
 v_cvt_pk_bf16_f32 v22,v16,v17
 v_mfma_f32_16x16x32_bf16 v[220:223],a[136:139],a[236:239],v[220:223]
 v_cvt_pk_bf16_f32 v23,v18,v19
 s_mov_b32 s49,0
 v_mfma_f32_16x16x32_bf16 v[220:223],a[140:143],a[252:255],v[220:223]
 ds_read_b64_tr_b16 a[172:173],v13 offset:8192
 buffer_load_dwordx4 a[196:199],v1,s[4:7],s40 offen offset:1024 sc1
 v_mfma_f32_16x16x32_bf16 v[212:215],a[140:143],a[248:251],v[212:215]
 ds_read_b64_tr_b16 a[174:175],v13 offset:12288
 buffer_store_dwordx4 v[20:23],v1,s[20:23],s49 offen offset:0 sc1
 v_mfma_f32_16x16x32_bf16 v[212:215],a[136:139],a[232:235],v[212:215]
 v_accvgpr_read_b32 v4,a32
 v_accvgpr_read_b32 v5,a33
 v_mfma_f32_16x16x32_bf16 v[204:207],a[136:139],a[228:231],v[204:207]
 ds_read_b64_tr_b16 a[176:177],v14 offset:0
 v_accvgpr_read_b32 v6,a34
 v_mfma_f32_16x16x32_bf16 v[204:207],a[140:143],a[244:247],v[204:207]
 ds_read_b64_tr_b16 a[178:179],v14 offset:4096
 v_accvgpr_read_b32 v7,a35
 v_mfma_f32_16x16x32_bf16 v[196:199],a[140:143],a[240:243],v[196:199]
 v_mul_f32 v4,v4,v37
 v_mul_f32 v5,v5,v37
 v_mfma_f32_16x16x32_bf16 v[196:199],a[136:139],a[224:227],v[196:199]
 ds_read_b64_tr_b16 a[180:181],v14 offset:8192
 v_mul_f32 v6,v6,v37
 v_mfma_f32_16x16x32_bf16 v[224:227],a[144:147],a[224:227],v[224:227]
 ds_read_b64_tr_b16 a[182:183],v14 offset:12288
 v_mul_f32 v7,v7,v37
 v_mfma_f32_16x16x32_bf16 v[224:227],a[148:151],a[240:243],v[224:227]
 buffer_load_dwordx4 a[208:211],v1,s[4:7],s40 offen offset:2048 sc1
 v_cvt_pk_bf16_f32 v28,v4,v5
 v_mfma_f32_16x16x32_bf16 v[232:235],a[148:151],a[244:247],v[232:235]
 ds_read_b64_tr_b16 a[184:185],v15 offset:0
 v_cvt_pk_bf16_f32 v29,v6,v7
 v_mfma_f32_16x16x32_bf16 v[232:235],a[144:147],a[228:231],v[232:235]
 ds_read_b64_tr_b16 a[186:187],v15 offset:4096
 v_accvgpr_read_b32 v16,a48
 v_mfma_f32_16x16x32_bf16 v[240:243],a[144:147],a[232:235],v[240:243]
 v_accvgpr_read_b32 v17,a49
 v_accvgpr_read_b32 v18,a50
 v_mfma_f32_16x16x32_bf16 v[240:243],a[148:151],a[248:251],v[240:243]
 ds_read_b64_tr_b16 a[188:189],v15 offset:8192
 v_accvgpr_read_b32 v19,a51
 v_mfma_f32_16x16x32_bf16 v[248:251],a[148:151],a[252:255],v[248:251]
 ds_read_b64_tr_b16 a[190:191],v15 offset:12288
 v_mul_f32 v16,v16,v37
 v_mfma_f32_16x16x32_bf16 v[248:251],a[144:147],a[236:239],v[248:251]
 v_mul_f32 v17,v17,v37
 v_mul_f32 v18,v18,v37
 v_mfma_f32_16x16x32_bf16 v[252:255],a[152:155],a[236:239],v[252:255]
 buffer_load_dwordx4 a[212:215],v1,s[4:7],s40 offen offset:3072 sc1
 v_mul_f32 v19,v19,v37
 v_mfma_f32_16x16x32_bf16 v[252:255],a[156:159],a[252:255],v[252:255]
 v_cvt_pk_bf16_f32 v30,v16,v17
 v_cvt_pk_bf16_f32 v31,v18,v19
 v_mfma_f32_16x16x32_bf16 v[244:247],a[156:159],a[248:251],v[244:247]
 s_mov_b32 s49,0
 buffer_store_dwordx4 v[28:31],v1,s[20:23],s49 offen offset:2048 sc1
 v_accvgpr_read_b32 v16,a0
 v_mfma_f32_16x16x32_bf16 v[244:247],a[152:155],a[232:235],v[244:247]
 v_accvgpr_read_b32 v17,a17
 v_accvgpr_read_b32 v18,a4
 v_mfma_f32_16x16x32_bf16 v[236:239],a[152:155],a[228:231],v[236:239]
 v_accvgpr_read_b32 v19,a21
 v_accvgpr_read_b32 v20,a8
 v_mfma_f32_16x16x32_bf16 v[236:239],a[156:159],a[244:247],v[236:239]
 v_accvgpr_read_b32 v21,a25
 v_accvgpr_read_b32 v22,a12
 v_mfma_f32_16x16x32_bf16 v[228:231],a[156:159],a[240:243],v[228:231]
 v_accvgpr_read_b32 v23,a29
 v_max_f32_e64 v16,abs(v16),abs(v17)
 v_mfma_f32_16x16x32_bf16 v[228:231],a[152:155],a[224:227],v[228:231]
 s_waitcnt vmcnt(54) lgkmcnt(0)
 s_barrier
 v_mfma_f32_16x16x32_bf16 v[128:131],a[160:163],a[224:227],v[128:131]
 ds_read_b64_tr_b16 a[128:129],v44 offset:16384
 v_max_f32_e64 v18,abs(v18),abs(v19)
 v_mfma_f32_16x16x32_bf16 v[128:131],a[164:167],a[240:243],v[128:131]
 s_mov_b32 s40,163840
 ds_read_b64_tr_b16 a[130:131],v44 offset:20480
 v_max_f32_e64 v20,abs(v20),abs(v21)
 v_mfma_f32_16x16x32_bf16 v[136:139],a[164:167],a[244:247],v[136:139]
 buffer_load_dwordx4 a[200:203],v1,s[4:7],s40 offen offset:0 sc1
 v_max_f32_e64 v22,abs(v22),abs(v23)
 v_mfma_f32_16x16x32_bf16 v[136:139],a[160:163],a[228:231],v[136:139]
 s_mov_b32 s48,0x5d800000
 ds_read_b64_tr_b16 a[132:133],v44 offset:24576
 s_mov_b32 s49,524288
 v_mfma_f32_16x16x32_bf16 v[144:147],a[160:163],a[232:235],v[144:147]
 ds_read_b64_tr_b16 a[134:135],v44 offset:28672
 v_min3_u32 v16,v16,v18,v20
 v_mfma_f32_16x16x32_bf16 v[144:147],a[164:167],a[248:251],v[144:147]
 v_min_u32 v16,v16,v22
 v_add_f32 v63,v36,v38
 v_mfma_f32_16x16x32_bf16 v[152:155],a[164:167],a[252:255],v[152:155]
 ds_read_b64_tr_b16 a[136:137],v45 offset:16384
 v_add_f32 v62,v40,v42
 v_mfma_f32_16x16x32_bf16 v[152:155],a[160:163],a[236:239],v[152:155]
 ds_read_b64_tr_b16 a[138:139],v45 offset:20480
 v_cmp_gt_u32 s[50:51],s49,v16
 v_mfma_f32_16x16x32_bf16 v[156:159],a[168:171],a[236:239],v[156:159]
 v_add_f32 v62,v62,v63
 v_cmp_nge_f32 vcc,s48,v62
 v_mfma_f32_16x16x32_bf16 v[156:159],a[172:175],a[252:255],v[156:159]
 ds_read_b64_tr_b16 a[140:141],v45 offset:24576
 buffer_load_dwordx4 a[204:207],v1,s[4:7],s40 offen offset:1024 sc1
 v_mfma_f32_16x16x32_bf16 v[148:151],a[172:175],a[248:251],v[148:151]
 ds_read_b64_tr_b16 a[142:143],v45 offset:28672
 v_mov_b32 v63,s3
 v_mfma_f32_16x16x32_bf16 v[148:151],a[168:171],a[232:235],v[148:151]
 v_lshrrev_b32 v63,10,v63
 v_add_u32 v63,49152,v63
 v_mfma_f32_16x16x32_bf16 v[140:143],a[168:171],a[228:231],v[140:143]
 s_or_b64 vcc,vcc,s[50:51]
 s_cselect_b32 s48,1,0
 ds_read_b64_tr_b16 a[144:145],v46 offset:16384
 v_mfma_f32_16x16x32_bf16 v[140:143],a[172:175],a[244:247],v[140:143]
 ds_read_b64_tr_b16 a[146:147],v46 offset:20480
 v_mov_b32 v62,s48
 v_mfma_f32_16x16x32_bf16 v[132:135],a[172:175],a[240:243],v[132:135]
 ds_write_b32 v63,v62
 v_mov_b32 v63,49152
 v_mfma_f32_16x16x32_bf16 v[132:135],a[168:171],a[224:227],v[132:135]
 ds_read_b64_tr_b16 a[148:149],v46 offset:24576
 v_accvgpr_read_b32 v4,a64
 v_mfma_f32_16x16x32_bf16 v[160:163],a[176:179],a[224:227],v[160:163]
 ds_read_b64_tr_b16 a[150:151],v46 offset:28672
 v_accvgpr_read_b32 v5,a65
 v_mfma_f32_16x16x32_bf16 v[160:163],a[180:183],a[240:243],v[160:163]
 buffer_load_dwordx4 a[216:219],v1,s[4:7],s40 offen offset:2048 sc1
 v_accvgpr_read_b32 v6,a66
 v_mfma_f32_16x16x32_bf16 v[168:171],a[180:183],a[244:247],v[168:171]
 ds_read_b64_tr_b16 a[152:153],v47 offset:16384
 v_accvgpr_read_b32 v7,a67
 v_mfma_f32_16x16x32_bf16 v[168:171],a[176:179],a[228:231],v[168:171]
 ds_read_b64_tr_b16 a[154:155],v47 offset:20480
 v_mul_f32 v4,v4,v37
 v_mfma_f32_16x16x32_bf16 v[176:179],a[176:179],a[232:235],v[176:179]
 v_mul_f32 v5,v5,v37
 v_mul_f32 v6,v6,v37
 v_mfma_f32_16x16x32_bf16 v[176:179],a[180:183],a[248:251],v[176:179]
 ds_read_b64_tr_b16 a[156:157],v47 offset:24576
 v_mul_f32 v7,v7,v37
 v_mfma_f32_16x16x32_bf16 v[184:187],a[180:183],a[252:255],v[184:187]
 ds_read_b64_tr_b16 a[158:159],v47 offset:28672
 v_cvt_pk_bf16_f32 v20,v4,v5
 v_mfma_f32_16x16x32_bf16 v[184:187],a[176:179],a[236:239],v[184:187]
 v_cvt_pk_bf16_f32 v21,v6,v7
 v_accvgpr_read_b32 v16,a80
 v_mfma_f32_16x16x32_bf16 v[188:191],a[184:187],a[236:239],v[188:191]
 buffer_load_dwordx4 a[220:223],v1,s[4:7],s40 offen offset:3072 sc1
 v_accvgpr_read_b32 v17,a81
 v_mfma_f32_16x16x32_bf16 v[188:191],a[188:191],a[252:255],v[188:191]
 v_accvgpr_read_b32 v18,a82
 v_accvgpr_read_b32 v19,a83
 v_mfma_f32_16x16x32_bf16 v[180:183],a[188:191],a[248:251],v[180:183]
 v_mul_f32 v16,v16,v37
 v_mul_f32 v17,v17,v37
 v_mfma_f32_16x16x32_bf16 v[180:183],a[184:187],a[232:235],v[180:183]
 v_mul_f32 v18,v18,v37
 v_mul_f32 v19,v19,v37
 v_mfma_f32_16x16x32_bf16 v[172:175],a[184:187],a[228:231],v[172:175]
 v_cvt_pk_bf16_f32 v22,v16,v17
 v_cvt_pk_bf16_f32 v23,v18,v19
 v_mfma_f32_16x16x32_bf16 v[172:175],a[188:191],a[244:247],v[172:175]
 s_mov_b32 s49,4096
 buffer_store_dwordx4 v[20:23],v1,s[20:23],s49 offen offset:0 sc1
 v_accvgpr_read_b32 v4,a96
 v_mfma_f32_16x16x32_bf16 v[164:167],a[188:191],a[240:243],v[164:167]
 v_accvgpr_read_b32 v5,a97
 v_accvgpr_read_b32 v6,a98
 v_mfma_f32_16x16x32_bf16 v[164:167],a[184:187],a[224:227],v[164:167]
 s_waitcnt vmcnt(27) lgkmcnt(0)
 v_accvgpr_read_b32 v7,a99
 v_mul_f32 v4,v4,v37
 v_mfma_f32_16x16x32_bf16 v[192:195],a[128:131],v[64:67],v[192:195]
 ds_read_b64_tr_b16 a[160:161],v48 offset:16384
 v_mul_f32 v5,v5,v37
 v_mfma_f32_16x16x32_bf16 v[192:195],a[132:135],v[80:83],v[192:195]
 s_mov_b32 s40,40960
 ds_read_b64_tr_b16 a[162:163],v48 offset:20480
 v_mul_f32 v6,v6,v37
 v_mfma_f32_16x16x32_bf16 v[200:203],a[132:135],v[84:87],v[200:203]
 buffer_load_dwordx4 a[224:227],v1,s[4:7],s40 offen offset:0 sc1
 v_mul_f32 v7,v7,v37
 v_mfma_f32_16x16x32_bf16 v[200:203],a[128:131],v[68:71],v[200:203]
 ds_read_b64_tr_b16 a[164:165],v48 offset:24576
 v_cvt_pk_bf16_f32 v28,v4,v5
 v_mfma_f32_16x16x32_bf16 v[208:211],a[128:131],v[72:75],v[208:211]
 ds_read_b64_tr_b16 a[166:167],v48 offset:28672
 v_cvt_pk_bf16_f32 v29,v6,v7
 v_mfma_f32_16x16x32_bf16 v[208:211],a[132:135],v[88:91],v[208:211]
 v_accvgpr_read_b32 v16,a112
 v_accvgpr_read_b32 v17,a113
 v_mfma_f32_16x16x32_bf16 v[216:219],a[132:135],v[92:95],v[216:219]
 ds_read_b64_tr_b16 a[168:169],v49 offset:16384
 v_accvgpr_read_b32 v18,a114
 v_mfma_f32_16x16x32_bf16 v[216:219],a[128:131],v[76:79],v[216:219]
 ds_read_b64_tr_b16 a[170:171],v49 offset:20480
 v_accvgpr_read_b32 v19,a115
 v_mfma_f32_16x16x32_bf16 v[220:223],a[136:139],v[76:79],v[220:223]
 v_mul_f32 v16,v16,v37
 v_mul_f32 v17,v17,v37
 v_mfma_f32_16x16x32_bf16 v[220:223],a[140:143],v[92:95],v[220:223]
 ds_read_b64_tr_b16 a[172:173],v49 offset:24576
 buffer_load_dwordx4 a[228:231],v1,s[4:7],s40 offen offset:1024 sc1
 v_mfma_f32_16x16x32_bf16 v[212:215],a[140:143],v[88:91],v[212:215]
 ds_read_b64_tr_b16 a[174:175],v49 offset:28672
 v_mul_f32 v18,v18,v37
 v_mfma_f32_16x16x32_bf16 v[212:215],a[136:139],v[72:75],v[212:215]
 v_mul_f32 v19,v19,v37
 v_cvt_pk_bf16_f32 v30,v16,v17
 v_mfma_f32_16x16x32_bf16 v[204:207],a[136:139],v[68:71],v[204:207]
 ds_read_b64_tr_b16 a[176:177],v50 offset:16384
 v_cvt_pk_bf16_f32 v31,v18,v19
 v_mfma_f32_16x16x32_bf16 v[204:207],a[140:143],v[84:87],v[204:207]
 s_mov_b32 s49,4096
 ds_read_b64_tr_b16 a[178:179],v50 offset:20480
 buffer_store_dwordx4 v[28:31],v1,s[20:23],s49 offen offset:2048 sc1
 v_mfma_f32_16x16x32_bf16 v[196:199],a[140:143],v[80:83],v[196:199]
 v_accvgpr_read_b32 v4,a4
 v_accvgpr_read_b32 v5,a5
 v_mfma_f32_16x16x32_bf16 v[196:199],a[136:139],v[64:67],v[196:199]
 ds_read_b64_tr_b16 a[180:181],v50 offset:24576
 v_accvgpr_read_b32 v6,a6
 v_mfma_f32_16x16x32_bf16 v[224:227],a[144:147],v[64:67],v[224:227]
 ds_read_b64_tr_b16 a[182:183],v50 offset:28672
 v_accvgpr_read_b32 v7,a7
 v_mfma_f32_16x16x32_bf16 v[224:227],a[148:151],v[80:83],v[224:227]
 buffer_load_dwordx4 a[240:243],v1,s[4:7],s40 offen offset:2048 sc1
 v_mul_f32 v4,v4,v39
 v_mfma_f32_16x16x32_bf16 v[232:235],a[148:151],v[84:87],v[232:235]
 ds_read_b64_tr_b16 a[184:185],v51 offset:16384
 v_mul_f32 v5,v5,v39
 v_mfma_f32_16x16x32_bf16 v[232:235],a[144:147],v[68:71],v[232:235]
 ds_read_b64_tr_b16 a[186:187],v51 offset:20480
 v_mul_f32 v6,v6,v39
 v_mfma_f32_16x16x32_bf16 v[240:243],a[144:147],v[72:75],v[240:243]
 v_mul_f32 v7,v7,v39
 v_cvt_pk_bf16_f32 v20,v4,v5
 v_mfma_f32_16x16x32_bf16 v[240:243],a[148:151],v[88:91],v[240:243]
 ds_read_b64_tr_b16 a[188:189],v51 offset:24576
 v_cvt_pk_bf16_f32 v21,v6,v7
 v_mfma_f32_16x16x32_bf16 v[248:251],a[148:151],v[92:95],v[248:251]
 ds_read_b64_tr_b16 a[190:191],v51 offset:28672
 v_accvgpr_read_b32 v16,a20
 v_mfma_f32_16x16x32_bf16 v[248:251],a[144:147],v[76:79],v[248:251]
 v_accvgpr_read_b32 v17,a21
 v_accvgpr_read_b32 v18,a22
 v_mfma_f32_16x16x32_bf16 v[252:255],a[152:155],v[76:79],v[252:255]
 buffer_load_dwordx4 a[244:247],v1,s[4:7],s40 offen offset:3072 sc1
 v_accvgpr_read_b32 v19,a23
 v_mfma_f32_16x16x32_bf16 v[252:255],a[156:159],v[92:95],v[252:255]
 v_mul_f32 v16,v16,v39
 v_mul_f32 v17,v17,v39
 v_mfma_f32_16x16x32_bf16 v[244:247],a[156:159],v[88:91],v[244:247]
 v_mul_f32 v18,v18,v39
 v_mul_f32 v19,v19,v39
 v_mfma_f32_16x16x32_bf16 v[244:247],a[152:155],v[72:75],v[244:247]
 v_cvt_pk_bf16_f32 v22,v16,v17
 v_cvt_pk_bf16_f32 v23,v18,v19
 v_mfma_f32_16x16x32_bf16 v[236:239],a[152:155],v[68:71],v[236:239]
 s_mov_b32 s49,0
 buffer_store_dwordx4 v[20:23],v1,s[20:23],s49 offen offset:1024 sc1
 v_accvgpr_read_b32 v4,a36
 v_mfma_f32_16x16x32_bf16 v[236:239],a[156:159],v[84:87],v[236:239]
 v_accvgpr_read_b32 v5,a37
 v_accvgpr_read_b32 v6,a38
 v_mfma_f32_16x16x32_bf16 v[228:231],a[156:159],v[80:83],v[228:231]
 v_accvgpr_read_b32 v7,a39
 v_mul_f32 v4,v4,v39
 v_mfma_f32_16x16x32_bf16 v[228:231],a[152:155],v[64:67],v[228:231]
 s_waitcnt vmcnt(53) lgkmcnt(0)
 s_barrier
 v_mfma_f32_16x16x32_bf16 v[128:131],a[160:163],v[64:67],v[128:131]
 ds_read_b64_tr_b16 a[128:129],v8 offset:16384
 v_mul_f32 v5,v5,v39
 v_mfma_f32_16x16x32_bf16 v[128:131],a[164:167],v[80:83],v[128:131]
 s_mov_b32 s40,172032
 ds_read_b64_tr_b16 a[130:131],v8 offset:20480
 v_mul_f32 v6,v6,v39
 v_mfma_f32_16x16x32_bf16 v[136:139],a[164:167],v[84:87],v[136:139]
 buffer_load_dwordx4 a[232:235],v1,s[4:7],s40 offen offset:0 sc1
 ds_read_b128 v[32:35],v63
 v_mfma_f32_16x16x32_bf16 v[136:139],a[160:163],v[68:71],v[136:139]
 ds_read_b64_tr_b16 a[132:133],v8 offset:24576
 v_mul_f32 v7,v7,v39
 v_mfma_f32_16x16x32_bf16 v[144:147],a[160:163],v[72:75],v[144:147]
 ds_read_b64_tr_b16 a[134:135],v8 offset:28672
 v_cvt_pk_bf16_f32 v28,v4,v5
 v_mfma_f32_16x16x32_bf16 v[144:147],a[164:167],v[88:91],v[144:147]
 v_cvt_pk_bf16_f32 v29,v6,v7
 v_accvgpr_read_b32 v16,a52
 v_mfma_f32_16x16x32_bf16 v[152:155],a[164:167],v[92:95],v[152:155]
 ds_read_b64_tr_b16 a[136:137],v9 offset:16384
 v_accvgpr_read_b32 v17,a53
 v_mfma_f32_16x16x32_bf16 v[152:155],a[160:163],v[76:79],v[152:155]
 ds_read_b64_tr_b16 a[138:139],v9 offset:20480
 v_accvgpr_read_b32 v18,a54
 v_mfma_f32_16x16x32_bf16 v[156:159],a[168:171],v[76:79],v[156:159]
 v_accvgpr_read_b32 v19,a55
 v_mul_f32 v16,v16,v39
 v_mfma_f32_16x16x32_bf16 v[156:159],a[172:175],v[92:95],v[156:159]
 ds_read_b64_tr_b16 a[140:141],v9 offset:24576
 buffer_load_dwordx4 a[236:239],v1,s[4:7],s40 offen offset:1024 sc1
 v_mfma_f32_16x16x32_bf16 v[148:151],a[172:175],v[88:91],v[148:151]
 ds_read_b64_tr_b16 a[142:143],v9 offset:28672
 v_mul_f32 v17,v17,v39
 v_mfma_f32_16x16x32_bf16 v[148:151],a[168:171],v[72:75],v[148:151]
 v_mul_f32 v18,v18,v39
 v_mul_f32 v19,v19,v39
 v_mfma_f32_16x16x32_bf16 v[140:143],a[168:171],v[68:71],v[140:143]
 ds_read_b64_tr_b16 a[144:145],v10 offset:16384
 v_cvt_pk_bf16_f32 v30,v16,v17
 v_mfma_f32_16x16x32_bf16 v[140:143],a[172:175],v[84:87],v[140:143]
 ds_read_b64_tr_b16 a[146:147],v10 offset:20480
 v_cvt_pk_bf16_f32 v31,v18,v19
 v_mfma_f32_16x16x32_bf16 v[132:135],a[172:175],v[80:83],v[132:135]
 s_mov_b32 s49,0
 buffer_store_dwordx4 v[28:31],v1,s[20:23],s49 offen offset:3072 sc1
 v_accvgpr_read_b32 v4,a68
 v_mfma_f32_16x16x32_bf16 v[132:135],a[168:171],v[64:67],v[132:135]
 ds_read_b64_tr_b16 a[148:149],v10 offset:24576
 v_accvgpr_read_b32 v5,a69
 v_mfma_f32_16x16x32_bf16 v[160:163],a[176:179],v[64:67],v[160:163]
 ds_read_b64_tr_b16 a[150:151],v10 offset:28672
 v_accvgpr_read_b32 v6,a70
 v_mfma_f32_16x16x32_bf16 v[160:163],a[180:183],v[80:83],v[160:163]
 buffer_load_dwordx4 a[248:251],v1,s[4:7],s40 offen offset:2048 sc1
 v_accvgpr_read_b32 v7,a71
 v_mfma_f32_16x16x32_bf16 v[168:171],a[180:183],v[84:87],v[168:171]
 ds_read_b64_tr_b16 a[152:153],v11 offset:16384
 v_mul_f32 v4,v4,v39
 v_mfma_f32_16x16x32_bf16 v[168:171],a[176:179],v[68:71],v[168:171]
 ds_read_b64_tr_b16 a[154:155],v11 offset:20480
 v_mul_f32 v5,v5,v39
 v_mfma_f32_16x16x32_bf16 v[176:179],a[176:179],v[72:75],v[176:179]
 v_mul_f32 v6,v6,v39
 v_mul_f32 v7,v7,v39
 v_mfma_f32_16x16x32_bf16 v[176:179],a[180:183],v[88:91],v[176:179]
 ds_read_b64_tr_b16 a[156:157],v11 offset:24576
 v_cvt_pk_bf16_f32 v20,v4,v5
 v_mfma_f32_16x16x32_bf16 v[184:187],a[180:183],v[92:95],v[184:187]
 ds_read_b64_tr_b16 a[158:159],v11 offset:28672
 v_cvt_pk_bf16_f32 v21,v6,v7
 v_mfma_f32_16x16x32_bf16 v[184:187],a[176:179],v[76:79],v[184:187]
 v_accvgpr_read_b32 v16,a84
 v_accvgpr_read_b32 v17,a85
 v_mfma_f32_16x16x32_bf16 v[188:191],a[184:187],v[76:79],v[188:191]
 buffer_load_dwordx4 a[252:255],v1,s[4:7],s40 offen offset:3072 sc1
 v_accvgpr_read_b32 v18,a86
 v_mfma_f32_16x16x32_bf16 v[188:191],a[188:191],v[92:95],v[188:191]
 v_accvgpr_read_b32 v19,a87
 v_mul_f32 v16,v16,v39
 v_mfma_f32_16x16x32_bf16 v[180:183],a[188:191],v[88:91],v[180:183]
 v_mul_f32 v17,v17,v39
 v_mul_f32 v18,v18,v39
 v_mfma_f32_16x16x32_bf16 v[180:183],a[184:187],v[72:75],v[180:183]
 v_mul_f32 v19,v19,v39
 v_cvt_pk_bf16_f32 v22,v16,v17
 v_mfma_f32_16x16x32_bf16 v[172:175],a[184:187],v[68:71],v[172:175]
 v_cvt_pk_bf16_f32 v23,v18,v19
 s_mov_b32 s49,4096
 v_mfma_f32_16x16x32_bf16 v[172:175],a[188:191],v[84:87],v[172:175]
 buffer_store_dwordx4 v[20:23],v1,s[20:23],s49 offen offset:1024 sc1
 v_accvgpr_read_b32 v4,a100
 v_mfma_f32_16x16x32_bf16 v[164:167],a[188:191],v[80:83],v[164:167]
 v_accvgpr_read_b32 v5,a101
 v_accvgpr_read_b32 v6,a102
 v_mfma_f32_16x16x32_bf16 v[164:167],a[184:187],v[64:67],v[164:167]
 s_waitcnt vmcnt(27) lgkmcnt(0)
 v_accvgpr_read_b32 v7,a103
 v_mul_f32 v4,v4,v39
 v_mfma_f32_16x16x32_bf16 v[192:195],a[128:131],v[96:99],v[192:195]
 ds_read_b64_tr_b16 a[160:161],v12 offset:16384
 v_mul_f32 v5,v5,v39
 v_mfma_f32_16x16x32_bf16 v[192:195],a[132:135],v[112:115],v[192:195]
 s_mov_b32 s40,49152
 ds_read_b64_tr_b16 a[162:163],v12 offset:20480
 v_mul_f32 v6,v6,v39
 v_mfma_f32_16x16x32_bf16 v[200:203],a[132:135],v[116:119],v[200:203]
 buffer_load_dwordx4 v[64:67],v1,s[4:7],s40 offen offset:0 sc1
 v_mul_f32 v7,v7,v39
 v_mfma_f32_16x16x32_bf16 v[200:203],a[128:131],v[100:103],v[200:203]
 ds_read_b64_tr_b16 a[164:165],v12 offset:24576
 v_or3_b32 v32,v32,v33,v34
 v_mfma_f32_16x16x32_bf16 v[208:211],a[128:131],v[104:107],v[208:211]
 ds_read_b64_tr_b16 a[166:167],v12 offset:28672
 v_or_b32 v32,v32,v35
 v_mfma_f32_16x16x32_bf16 v[208:211],a[132:135],v[120:123],v[208:211]
 v_cvt_pk_bf16_f32 v28,v4,v5
 v_cvt_pk_bf16_f32 v29,v6,v7
 v_mfma_f32_16x16x32_bf16 v[216:219],a[132:135],v[124:127],v[216:219]
 ds_read_b64_tr_b16 a[168:169],v13 offset:16384
 v_readfirstlane_b32 s48,v32
 v_mfma_f32_16x16x32_bf16 v[216:219],a[128:131],v[108:111],v[216:219]
 ds_read_b64_tr_b16 a[170:171],v13 offset:20480
 v_accvgpr_read_b32 v16,a116
 v_mfma_f32_16x16x32_bf16 v[220:223],a[136:139],v[108:111],v[220:223]
 s_andn2_b32 s48,s48,s45
 s_cbranch_scc1 L_fallback
 v_accvgpr_read_b32 v17,a117
 v_mfma_f32_16x16x32_bf16 v[220:223],a[140:143],v[124:127],v[220:223]
 ds_read_b64_tr_b16 a[172:173],v13 offset:24576
 buffer_load_dwordx4 v[68:71],v1,s[4:7],s40 offen offset:1024 sc1
 v_mfma_f32_16x16x32_bf16 v[212:215],a[140:143],v[120:123],v[212:215]
 ds_read_b64_tr_b16 a[174:175],v13 offset:28672
 v_accvgpr_read_b32 v18,a118
 v_mfma_f32_16x16x32_bf16 v[212:215],a[136:139],v[104:107],v[212:215]
 v_accvgpr_read_b32 v19,a119
 v_mul_f32 v16,v16,v39
 v_mfma_f32_16x16x32_bf16 v[204:207],a[136:139],v[100:103],v[204:207]
 ds_read_b64_tr_b16 a[176:177],v14 offset:16384
 v_mul_f32 v17,v17,v39
 v_mfma_f32_16x16x32_bf16 v[204:207],a[140:143],v[116:119],v[204:207]
 ds_read_b64_tr_b16 a[178:179],v14 offset:20480
 v_mul_f32 v18,v18,v39
 v_mfma_f32_16x16x32_bf16 v[196:199],a[140:143],v[112:115],v[196:199]
 v_mul_f32 v19,v19,v39
 v_cvt_pk_bf16_f32 v30,v16,v17
 v_mfma_f32_16x16x32_bf16 v[196:199],a[136:139],v[96:99],v[196:199]
 ds_read_b64_tr_b16 a[180:181],v14 offset:24576
 v_cvt_pk_bf16_f32 v31,v18,v19
 v_mfma_f32_16x16x32_bf16 v[224:227],a[144:147],v[96:99],v[224:227]
 s_mov_b32 s49,4096
 ds_read_b64_tr_b16 a[182:183],v14 offset:28672
 buffer_store_dwordx4 v[28:31],v1,s[20:23],s49 offen offset:3072 sc1
 v_mfma_f32_16x16x32_bf16 v[224:227],a[148:151],v[112:115],v[224:227]
 buffer_load_dwordx4 v[80:83],v1,s[4:7],s40 offen offset:2048 sc1
 v_accvgpr_read_b32 v4,a8
 v_mfma_f32_16x16x32_bf16 v[232:235],a[148:151],v[116:119],v[232:235]
 ds_read_b64_tr_b16 a[184:185],v15 offset:16384
 v_accvgpr_read_b32 v5,a9
 v_mfma_f32_16x16x32_bf16 v[232:235],a[144:147],v[100:103],v[232:235]
 ds_read_b64_tr_b16 a[186:187],v15 offset:20480
 v_accvgpr_read_b32 v6,a10
 v_mfma_f32_16x16x32_bf16 v[240:243],a[144:147],v[104:107],v[240:243]
 v_accvgpr_read_b32 v7,a11
 v_mul_f32 v4,v4,v41
 v_mfma_f32_16x16x32_bf16 v[240:243],a[148:151],v[120:123],v[240:243]
 ds_read_b64_tr_b16 a[188:189],v15 offset:24576
 v_mul_f32 v5,v5,v41
 v_mfma_f32_16x16x32_bf16 v[248:251],a[148:151],v[124:127],v[248:251]
 ds_read_b64_tr_b16 a[190:191],v15 offset:28672
 v_mul_f32 v6,v6,v41
 v_mfma_f32_16x16x32_bf16 v[248:251],a[144:147],v[108:111],v[248:251]
 v_mul_f32 v7,v7,v41
 v_cvt_pk_bf16_f32 v20,v4,v5
 v_mfma_f32_16x16x32_bf16 v[252:255],a[152:155],v[108:111],v[252:255]
 buffer_load_dwordx4 v[84:87],v1,s[4:7],s40 offen offset:3072 sc1
 v_cvt_pk_bf16_f32 v21,v6,v7
 v_mfma_f32_16x16x32_bf16 v[252:255],a[156:159],v[124:127],v[252:255]
 v_accvgpr_read_b32 v16,a24
 v_accvgpr_read_b32 v17,a25
 v_mfma_f32_16x16x32_bf16 v[244:247],a[156:159],v[120:123],v[244:247]
 v_accvgpr_read_b32 v18,a26
 v_accvgpr_read_b32 v19,a27
 v_mfma_f32_16x16x32_bf16 v[244:247],a[152:155],v[104:107],v[244:247]
 v_mul_f32 v16,v16,v41
 v_mul_f32 v17,v17,v41
 v_mfma_f32_16x16x32_bf16 v[236:239],a[152:155],v[100:103],v[236:239]
 v_mul_f32 v18,v18,v41
 v_mul_f32 v19,v19,v41
 v_mfma_f32_16x16x32_bf16 v[236:239],a[156:159],v[116:119],v[236:239]
 v_cvt_pk_bf16_f32 v22,v16,v17
 v_cvt_pk_bf16_f32 v23,v18,v19
 v_mfma_f32_16x16x32_bf16 v[228:231],a[156:159],v[112:115],v[228:231]
 s_mov_b32 s49,262144
 buffer_store_dwordx4 v[20:23],v1,s[20:23],s49 offen offset:0 sc1
 v_accvgpr_read_b32 v4,a40
 v_mfma_f32_16x16x32_bf16 v[228:231],a[152:155],v[96:99],v[228:231]
 s_waitcnt vmcnt(57) lgkmcnt(0)
 s_barrier
 v_mfma_f32_16x16x32_bf16 v[128:131],a[160:163],v[96:99],v[128:131]
 ds_read_b64_tr_b16 a[128:129],v44 offset:32768
 v_accvgpr_read_b32 v5,a41
 v_mfma_f32_16x16x32_bf16 v[128:131],a[164:167],v[112:115],v[128:131]
 s_mov_b32 s40,180224
 ds_read_b64_tr_b16 a[130:131],v44 offset:36864
 v_accvgpr_read_b32 v6,a42
 v_mfma_f32_16x16x32_bf16 v[136:139],a[164:167],v[116:119],v[136:139]
 buffer_load_dwordx4 v[72:75],v1,s[4:7],s40 offen offset:0 sc1
 v_accvgpr_read_b32 v7,a43
 v_mfma_f32_16x16x32_bf16 v[136:139],a[160:163],v[100:103],v[136:139]
 ds_read_b64_tr_b16 a[132:133],v44 offset:40960
 v_mul_f32 v4,v4,v41
 v_mfma_f32_16x16x32_bf16 v[144:147],a[160:163],v[104:107],v[144:147]
 ds_read_b64_tr_b16 a[134:135],v44 offset:45056
 v_mul_f32 v5,v5,v41
 v_mfma_f32_16x16x32_bf16 v[144:147],a[164:167],v[120:123],v[144:147]
 v_mul_f32 v6,v6,v41
 v_mul_f32 v7,v7,v41
 v_mfma_f32_16x16x32_bf16 v[152:155],a[164:167],v[124:127],v[152:155]
 ds_read_b64_tr_b16 a[136:137],v45 offset:32768
 v_cvt_pk_bf16_f32 v28,v4,v5
 v_mfma_f32_16x16x32_bf16 v[152:155],a[160:163],v[108:111],v[152:155]
 ds_read_b64_tr_b16 a[138:139],v45 offset:36864
 v_cvt_pk_bf16_f32 v29,v6,v7
 v_mfma_f32_16x16x32_bf16 v[156:159],a[168:171],v[108:111],v[156:159]
 v_accvgpr_read_b32 v16,a56
 v_accvgpr_read_b32 v17,a57
 v_mfma_f32_16x16x32_bf16 v[156:159],a[172:175],v[124:127],v[156:159]
 ds_read_b64_tr_b16 a[140:141],v45 offset:40960
 buffer_load_dwordx4 v[76:79],v1,s[4:7],s40 offen offset:1024 sc1
 v_mfma_f32_16x16x32_bf16 v[148:151],a[172:175],v[120:123],v[148:151]
 ds_read_b64_tr_b16 a[142:143],v45 offset:45056
 v_accvgpr_read_b32 v18,a58
 v_mfma_f32_16x16x32_bf16 v[148:151],a[168:171],v[104:107],v[148:151]
 v_accvgpr_read_b32 v19,a59
 v_mul_f32 v16,v16,v41
 v_mfma_f32_16x16x32_bf16 v[140:143],a[168:171],v[100:103],v[140:143]
 ds_read_b64_tr_b16 a[144:145],v46 offset:32768
 v_mul_f32 v17,v17,v41
 v_mfma_f32_16x16x32_bf16 v[140:143],a[172:175],v[116:119],v[140:143]
 ds_read_b64_tr_b16 a[146:147],v46 offset:36864
 v_mul_f32 v18,v18,v41
 v_mfma_f32_16x16x32_bf16 v[132:135],a[172:175],v[112:115],v[132:135]
 v_mul_f32 v19,v19,v41
 v_cvt_pk_bf16_f32 v30,v16,v17
 v_mfma_f32_16x16x32_bf16 v[132:135],a[168:171],v[96:99],v[132:135]
 ds_read_b64_tr_b16 a[148:149],v46 offset:40960
 v_cvt_pk_bf16_f32 v31,v18,v19
 v_mfma_f32_16x16x32_bf16 v[160:163],a[176:179],v[96:99],v[160:163]
 s_mov_b32 s49,262144
 ds_read_b64_tr_b16 a[150:151],v46 offset:45056
 buffer_store_dwordx4 v[28:31],v1,s[20:23],s49 offen offset:2048 sc1
 v_mfma_f32_16x16x32_bf16 v[160:163],a[180:183],v[112:115],v[160:163]
 buffer_load_dwordx4 v[88:91],v1,s[4:7],s40 offen offset:2048 sc1
 v_accvgpr_read_b32 v4,a72
 v_mfma_f32_16x16x32_bf16 v[168:171],a[180:183],v[116:119],v[168:171]
 ds_read_b64_tr_b16 a[152:153],v47 offset:32768
 v_accvgpr_read_b32 v5,a73
 v_mfma_f32_16x16x32_bf16 v[168:171],a[176:179],v[100:103],v[168:171]
 ds_read_b64_tr_b16 a[154:155],v47 offset:36864
 v_accvgpr_read_b32 v6,a74
 v_mfma_f32_16x16x32_bf16 v[176:179],a[176:179],v[104:107],v[176:179]
 v_accvgpr_read_b32 v7,a75
 v_mul_f32 v4,v4,v41
 v_mfma_f32_16x16x32_bf16 v[176:179],a[180:183],v[120:123],v[176:179]
 ds_read_b64_tr_b16 a[156:157],v47 offset:40960
 v_mul_f32 v5,v5,v41
 v_mfma_f32_16x16x32_bf16 v[184:187],a[180:183],v[124:127],v[184:187]
 ds_read_b64_tr_b16 a[158:159],v47 offset:45056
 v_mul_f32 v6,v6,v41
 v_mfma_f32_16x16x32_bf16 v[184:187],a[176:179],v[108:111],v[184:187]
 v_mul_f32 v7,v7,v41
 v_cvt_pk_bf16_f32 v20,v4,v5
 v_mfma_f32_16x16x32_bf16 v[188:191],a[184:187],v[108:111],v[188:191]
 buffer_load_dwordx4 v[92:95],v1,s[4:7],s40 offen offset:3072 sc1
 v_cvt_pk_bf16_f32 v21,v6,v7
 v_mfma_f32_16x16x32_bf16 v[188:191],a[188:191],v[124:127],v[188:191]
 v_accvgpr_read_b32 v16,a88
 v_accvgpr_read_b32 v17,a89
 v_mfma_f32_16x16x32_bf16 v[180:183],a[188:191],v[120:123],v[180:183]
 v_accvgpr_read_b32 v18,a90
 v_accvgpr_read_b32 v19,a91
 v_mfma_f32_16x16x32_bf16 v[180:183],a[184:187],v[104:107],v[180:183]
 v_mul_f32 v16,v16,v41
 v_mul_f32 v17,v17,v41
 v_mfma_f32_16x16x32_bf16 v[172:175],a[184:187],v[100:103],v[172:175]
 v_mul_f32 v18,v18,v41
 v_mul_f32 v19,v19,v41
 v_mfma_f32_16x16x32_bf16 v[172:175],a[188:191],v[116:119],v[172:175]
 v_cvt_pk_bf16_f32 v22,v16,v17
 v_cvt_pk_bf16_f32 v23,v18,v19
 v_mfma_f32_16x16x32_bf16 v[164:167],a[188:191],v[112:115],v[164:167]
 s_mov_b32 s49,266240
 buffer_store_dwordx4 v[20:23],v1,s[20:23],s49 offen offset:0 sc1
 v_accvgpr_read_b32 v4,a104
 v_mfma_f32_16x16x32_bf16 v[164:167],a[184:187],v[96:99],v[164:167]
 s_waitcnt vmcnt(25) lgkmcnt(0)
 v_accvgpr_read_b32 v5,a105
 v_accvgpr_read_b32 v6,a106
 v_mfma_f32_16x16x32_bf16 v[192:195],a[128:131],a[192:195],v[192:195]
 s_add_u32 m0,s3,49152
 ds_read_b64_tr_b16 a[160:161],v48 offset:32768
 v_accvgpr_read_b32 v7,a107
 v_mfma_f32_16x16x32_bf16 v[192:195],a[132:135],a[208:211],v[192:195]
 s_mov_b32 s41,6422528
 ds_read_b64_tr_b16 a[162:163],v48 offset:36864
 v_mul_f32 v4,v4,v41
 v_mfma_f32_16x16x32_bf16 v[200:203],a[132:135],a[212:215],v[200:203]
 buffer_load_dwordx4 v24,s[12:15],s41 offen offset:0 lds
 v_mul_f32 v5,v5,v41
 v_mfma_f32_16x16x32_bf16 v[200:203],a[128:131],a[196:199],v[200:203]
 ds_read_b64_tr_b16 a[164:165],v48 offset:40960
 v_mul_f32 v6,v6,v41
 v_mfma_f32_16x16x32_bf16 v[208:211],a[128:131],a[200:203],v[208:211]
 ds_read_b64_tr_b16 a[166:167],v48 offset:45056
 v_mul_f32 v7,v7,v41
 v_mfma_f32_16x16x32_bf16 v[208:211],a[132:135],a[216:219],v[208:211]
 v_cvt_pk_bf16_f32 v28,v4,v5
 v_cvt_pk_bf16_f32 v29,v6,v7
 v_mfma_f32_16x16x32_bf16 v[216:219],a[132:135],a[220:223],v[216:219]
 ds_read_b64_tr_b16 a[168:169],v49 offset:32768
 v_accvgpr_read_b32 v16,a120
 v_mfma_f32_16x16x32_bf16 v[216:219],a[128:131],a[204:207],v[216:219]
 ds_read_b64_tr_b16 a[170:171],v49 offset:36864
 v_accvgpr_read_b32 v17,a121
 v_mfma_f32_16x16x32_bf16 v[220:223],a[136:139],a[204:207],v[220:223]
 v_accvgpr_read_b32 v18,a122
 v_accvgpr_read_b32 v19,a123
 v_mfma_f32_16x16x32_bf16 v[220:223],a[140:143],a[220:223],v[220:223]
 ds_read_b64_tr_b16 a[172:173],v49 offset:40960
 buffer_load_dwordx4 v25,s[12:15],s41 offen offset:1024 lds
 v_mfma_f32_16x16x32_bf16 v[212:215],a[140:143],a[216:219],v[212:215]
 ds_read_b64_tr_b16 a[174:175],v49 offset:45056
 v_mul_f32 v16,v16,v41
 v_mfma_f32_16x16x32_bf16 v[212:215],a[136:139],a[200:203],v[212:215]
 v_mul_f32 v17,v17,v41
 v_mul_f32 v18,v18,v41
 v_mfma_f32_16x16x32_bf16 v[204:207],a[136:139],a[196:199],v[204:207]
 ds_read_b64_tr_b16 a[176:177],v50 offset:32768
 v_mul_f32 v19,v19,v41
 v_mfma_f32_16x16x32_bf16 v[204:207],a[140:143],a[212:215],v[204:207]
 ds_read_b64_tr_b16 a[178:179],v50 offset:36864
 v_cvt_pk_bf16_f32 v30,v16,v17
 v_mfma_f32_16x16x32_bf16 v[196:199],a[140:143],a[208:211],v[196:199]
 v_cvt_pk_bf16_f32 v31,v18,v19
 s_mov_b32 s49,266240
 v_mfma_f32_16x16x32_bf16 v[196:199],a[136:139],a[192:195],v[196:199]
 ds_read_b64_tr_b16 a[180:181],v50 offset:40960
 buffer_store_dwordx4 v[28:31],v1,s[20:23],s49 offen offset:2048 sc1
 v_mfma_f32_16x16x32_bf16 v[224:227],a[144:147],a[192:195],v[224:227]
 ds_read_b64_tr_b16 a[182:183],v50 offset:45056
 v_accvgpr_read_b32 v4,a12
 v_mfma_f32_16x16x32_bf16 v[224:227],a[148:151],a[208:211],v[224:227]
 buffer_load_dwordx4 v26,s[12:15],s41 offen offset:2048 lds
 v_accvgpr_read_b32 v5,a13
 v_mfma_f32_16x16x32_bf16 v[232:235],a[148:151],a[212:215],v[232:235]
 ds_read_b64_tr_b16 a[184:185],v51 offset:32768
 v_accvgpr_read_b32 v6,a14
 v_mfma_f32_16x16x32_bf16 v[232:235],a[144:147],a[196:199],v[232:235]
 ds_read_b64_tr_b16 a[186:187],v51 offset:36864
 v_accvgpr_read_b32 v7,a15
 v_mfma_f32_16x16x32_bf16 v[240:243],a[144:147],a[200:203],v[240:243]
 v_mul_f32 v4,v4,v43
 v_mul_f32 v5,v5,v43
 v_mfma_f32_16x16x32_bf16 v[240:243],a[148:151],a[216:219],v[240:243]
 ds_read_b64_tr_b16 a[188:189],v51 offset:40960
 v_mul_f32 v6,v6,v43
 v_mfma_f32_16x16x32_bf16 v[248:251],a[148:151],a[220:223],v[248:251]
 ds_read_b64_tr_b16 a[190:191],v51 offset:45056
 v_mul_f32 v7,v7,v43
 v_mfma_f32_16x16x32_bf16 v[248:251],a[144:147],a[204:207],v[248:251]
 v_cvt_pk_bf16_f32 v20,v4,v5
 v_cvt_pk_bf16_f32 v21,v6,v7
 v_mfma_f32_16x16x32_bf16 v[252:255],a[152:155],a[204:207],v[252:255]
 buffer_load_dwordx4 v27,s[12:15],s41 offen offset:3072 lds
 v_accvgpr_read_b32 v16,a28
 v_mfma_f32_16x16x32_bf16 v[252:255],a[156:159],a[220:223],v[252:255]
 v_accvgpr_read_b32 v17,a29
 v_accvgpr_read_b32 v18,a30
 v_mfma_f32_16x16x32_bf16 v[244:247],a[156:159],a[216:219],v[244:247]
 v_accvgpr_read_b32 v19,a31
 v_mul_f32 v16,v16,v43
 v_mfma_f32_16x16x32_bf16 v[244:247],a[152:155],a[200:203],v[244:247]
 v_mul_f32 v17,v17,v43
 v_mul_f32 v18,v18,v43
 v_mfma_f32_16x16x32_bf16 v[236:239],a[152:155],a[196:199],v[236:239]
 v_mul_f32 v19,v19,v43
 v_cvt_pk_bf16_f32 v22,v16,v17
 v_mfma_f32_16x16x32_bf16 v[236:239],a[156:159],a[212:215],v[236:239]
 v_cvt_pk_bf16_f32 v23,v18,v19
 s_mov_b32 s49,262144
 v_mfma_f32_16x16x32_bf16 v[228:231],a[156:159],a[208:211],v[228:231]
 buffer_store_dwordx4 v[20:23],v1,s[20:23],s49 offen offset:1024 sc1
 v_mfma_f32_16x16x32_bf16 v[228:231],a[152:155],a[192:195],v[228:231]
 s_waitcnt vmcnt(53) lgkmcnt(0)
 s_barrier
 v_mfma_f32_16x16x32_bf16 v[128:131],a[160:163],a[192:195],v[128:131]
 ds_read_b64_tr_b16 a[128:129],v8 offset:32768
 v_accvgpr_read_b32 v4,a44
 v_mfma_f32_16x16x32_bf16 v[128:131],a[164:167],a[208:211],v[128:131]
 s_mov_b32 s40,57344
 ds_read_b64_tr_b16 a[130:131],v8 offset:36864
 v_accvgpr_read_b32 v5,a45
 v_mfma_f32_16x16x32_bf16 v[136:139],a[164:167],a[212:215],v[136:139]
 buffer_load_dwordx4 v[96:99],v1,s[4:7],s40 offen offset:0 sc1
 v_accvgpr_read_b32 v6,a46
 v_mfma_f32_16x16x32_bf16 v[136:139],a[160:163],a[196:199],v[136:139]
 ds_read_b64_tr_b16 a[132:133],v8 offset:40960
 v_accvgpr_read_b32 v7,a47
 v_mfma_f32_16x16x32_bf16 v[144:147],a[160:163],a[200:203],v[144:147]
 ds_read_b64_tr_b16 a[134:135],v8 offset:45056
 v_mul_f32 v4,v4,v43
 v_mfma_f32_16x16x32_bf16 v[144:147],a[164:167],a[216:219],v[144:147]
 v_mul_f32 v5,v5,v43
 v_mul_f32 v6,v6,v43
 v_mfma_f32_16x16x32_bf16 v[152:155],a[164:167],a[220:223],v[152:155]
 ds_read_b64_tr_b16 a[136:137],v9 offset:32768
 v_mul_f32 v7,v7,v43
 v_mfma_f32_16x16x32_bf16 v[152:155],a[160:163],a[204:207],v[152:155]
 ds_read_b64_tr_b16 a[138:139],v9 offset:36864
 v_cvt_pk_bf16_f32 v28,v4,v5
 v_mfma_f32_16x16x32_bf16 v[156:159],a[168:171],a[204:207],v[156:159]
 v_cvt_pk_bf16_f32 v29,v6,v7
 v_accvgpr_read_b32 v16,a60
 v_mfma_f32_16x16x32_bf16 v[156:159],a[172:175],a[220:223],v[156:159]
 ds_read_b64_tr_b16 a[140:141],v9 offset:40960
 buffer_load_dwordx4 v[100:103],v1,s[4:7],s40 offen offset:1024 sc1
 v_mfma_f32_16x16x32_bf16 v[148:151],a[172:175],a[216:219],v[148:151]
 ds_read_b64_tr_b16 a[142:143],v9 offset:45056
 v_accvgpr_read_b32 v17,a61
 v_mfma_f32_16x16x32_bf16 v[148:151],a[168:171],a[200:203],v[148:151]
 v_accvgpr_read_b32 v18,a62
 v_accvgpr_read_b32 v19,a63
 v_mfma_f32_16x16x32_bf16 v[140:143],a[168:171],a[196:199],v[140:143]
 ds_read_b64_tr_b16 a[144:145],v10 offset:32768
 v_mul_f32 v16,v16,v43
 v_mfma_f32_16x16x32_bf16 v[140:143],a[172:175],a[212:215],v[140:143]
 ds_read_b64_tr_b16 a[146:147],v10 offset:36864
 v_mul_f32 v17,v17,v43
 v_mfma_f32_16x16x32_bf16 v[132:135],a[172:175],a[208:211],v[132:135]
 v_mul_f32 v18,v18,v43
 v_mul_f32 v19,v19,v43
 v_mfma_f32_16x16x32_bf16 v[132:135],a[168:171],a[192:195],v[132:135]
 ds_read_b64_tr_b16 a[148:149],v10 offset:40960
 v_cvt_pk_bf16_f32 v30,v16,v17
 v_mfma_f32_16x16x32_bf16 v[160:163],a[176:179],a[192:195],v[160:163]
 ds_read_b64_tr_b16 a[150:151],v10 offset:45056
 v_cvt_pk_bf16_f32 v31,v18,v19
 v_mfma_f32_16x16x32_bf16 v[160:163],a[180:183],a[208:211],v[160:163]
 s_mov_b32 s49,262144
 buffer_load_dwordx4 v[112:115],v1,s[4:7],s40 offen offset:2048 sc1
 v_mfma_f32_16x16x32_bf16 v[168:171],a[180:183],a[212:215],v[168:171]
 ds_read_b64_tr_b16 a[152:153],v11 offset:32768
 buffer_store_dwordx4 v[28:31],v1,s[20:23],s49 offen offset:3072 sc1
 v_mfma_f32_16x16x32_bf16 v[168:171],a[176:179],a[196:199],v[168:171]
 ds_read_b64_tr_b16 a[154:155],v11 offset:36864
 v_accvgpr_read_b32 v4,a76
 v_mfma_f32_16x16x32_bf16 v[176:179],a[176:179],a[200:203],v[176:179]
 v_accvgpr_read_b32 v5,a77
 v_accvgpr_read_b32 v6,a78
 v_mfma_f32_16x16x32_bf16 v[176:179],a[180:183],a[216:219],v[176:179]
 ds_read_b64_tr_b16 a[156:157],v11 offset:40960
 v_accvgpr_read_b32 v7,a79
 v_mfma_f32_16x16x32_bf16 v[184:187],a[180:183],a[220:223],v[184:187]
 ds_read_b64_tr_b16 a[158:159],v11 offset:45056
 v_mul_f32 v4,v4,v43
 v_mfma_f32_16x16x32_bf16 v[184:187],a[176:179],a[204:207],v[184:187]
 v_mul_f32 v5,v5,v43
 v_mul_f32 v6,v6,v43
 v_mfma_f32_16x16x32_bf16 v[188:191],a[184:187],a[204:207],v[188:191]
 buffer_load_dwordx4 v[116:119],v1,s[4:7],s40 offen offset:3072 sc1
 v_mul_f32 v7,v7,v43
 v_mfma_f32_16x16x32_bf16 v[188:191],a[188:191],a[220:223],v[188:191]
 v_cvt_pk_bf16_f32 v20,v4,v5
 v_cvt_pk_bf16_f32 v21,v6,v7
 v_mfma_f32_16x16x32_bf16 v[180:183],a[188:191],a[216:219],v[180:183]
 v_accvgpr_read_b32 v16,a92
 v_accvgpr_read_b32 v17,a93
 v_mfma_f32_16x16x32_bf16 v[180:183],a[184:187],a[200:203],v[180:183]
 v_accvgpr_read_b32 v18,a94
 v_accvgpr_read_b32 v19,a95
 v_mfma_f32_16x16x32_bf16 v[172:175],a[184:187],a[196:199],v[172:175]
 v_mul_f32 v16,v16,v43
 v_mul_f32 v17,v17,v43
 v_mfma_f32_16x16x32_bf16 v[172:175],a[188:191],a[212:215],v[172:175]
 v_mul_f32 v18,v18,v43
 v_mul_f32 v19,v19,v43
 v_mfma_f32_16x16x32_bf16 v[164:167],a[188:191],a[208:211],v[164:167]
 v_cvt_pk_bf16_f32 v22,v16,v17
 v_cvt_pk_bf16_f32 v23,v18,v19
 v_mfma_f32_16x16x32_bf16 v[164:167],a[184:187],a[192:195],v[164:167]
 s_waitcnt vmcnt(24) lgkmcnt(0)
 s_mov_b32 s49,266240
 v_mfma_f32_16x16x32_bf16 v[192:195],a[128:131],a[224:227],v[192:195]
 ds_read_b64_tr_b16 a[160:161],v12 offset:32768
 buffer_store_dwordx4 v[20:23],v1,s[20:23],s49 offen offset:1024 sc1
 v_mfma_f32_16x16x32_bf16 v[192:195],a[132:135],a[240:243],v[192:195]
 s_mov_b32 s40,188416
 ds_read_b64_tr_b16 a[162:163],v12 offset:36864
 v_accvgpr_read_b32 v4,a108
 v_mfma_f32_16x16x32_bf16 v[200:203],a[132:135],a[244:247],v[200:203]
 buffer_load_dwordx4 v[104:107],v1,s[4:7],s40 offen offset:0 sc1
 v_accvgpr_read_b32 v5,a109
 v_mfma_f32_16x16x32_bf16 v[200:203],a[128:131],a[228:231],v[200:203]
 ds_read_b64_tr_b16 a[164:165],v12 offset:40960
 v_accvgpr_read_b32 v6,a110
 v_mfma_f32_16x16x32_bf16 v[208:211],a[128:131],a[232:235],v[208:211]
 ds_read_b64_tr_b16 a[166:167],v12 offset:45056
 v_accvgpr_read_b32 v7,a111
 v_mfma_f32_16x16x32_bf16 v[208:211],a[132:135],a[248:251],v[208:211]
 v_mul_f32 v4,v4,v43
 v_mul_f32 v5,v5,v43
 v_mfma_f32_16x16x32_bf16 v[216:219],a[132:135],a[252:255],v[216:219]
 ds_read_b64_tr_b16 a[168:169],v13 offset:32768
 v_mul_f32 v6,v6,v43
 v_mfma_f32_16x16x32_bf16 v[216:219],a[128:131],a[236:239],v[216:219]
 ds_read_b64_tr_b16 a[170:171],v13 offset:36864
 buffer_load_dwordx4 v[108:111],v1,s[4:7],s40 offen offset:1024 sc1
 v_mfma_f32_16x16x32_bf16 v[220:223],a[136:139],a[236:239],v[220:223]
 v_mul_f32 v7,v7,v43
 v_cvt_pk_bf16_f32 v28,v4,v5
 v_mfma_f32_16x16x32_bf16 v[220:223],a[140:143],a[252:255],v[220:223]
 ds_read_b64_tr_b16 a[172:173],v13 offset:40960
 v_cvt_pk_bf16_f32 v29,v6,v7
 v_mfma_f32_16x16x32_bf16 v[212:215],a[140:143],a[248:251],v[212:215]
 ds_read_b64_tr_b16 a[174:175],v13 offset:45056
 v_accvgpr_read_b32 v16,a124
 v_mfma_f32_16x16x32_bf16 v[212:215],a[136:139],a[232:235],v[212:215]
 v_accvgpr_read_b32 v17,a125
 v_accvgpr_read_b32 v18,a126
 v_mfma_f32_16x16x32_bf16 v[204:207],a[136:139],a[228:231],v[204:207]
 ds_read_b64_tr_b16 a[176:177],v14 offset:32768
 buffer_load_dwordx4 v[120:123],v1,s[4:7],s40 offen offset:2048 sc1
 v_mfma_f32_16x16x32_bf16 v[204:207],a[140:143],a[244:247],v[204:207]
 ds_read_b64_tr_b16 a[178:179],v14 offset:36864
 v_accvgpr_read_b32 v19,a127
 v_mfma_f32_16x16x32_bf16 v[196:199],a[140:143],a[240:243],v[196:199]
 v_mul_f32 v16,v16,v43
 v_mul_f32 v17,v17,v43
 v_mfma_f32_16x16x32_bf16 v[196:199],a[136:139],a[224:227],v[196:199]
 ds_read_b64_tr_b16 a[180:181],v14 offset:40960
 v_mul_f32 v18,v18,v43
 v_mfma_f32_16x16x32_bf16 v[224:227],a[144:147],a[224:227],v[224:227]
 ds_read_b64_tr_b16 a[182:183],v14 offset:45056
 v_mul_f32 v19,v19,v43
 v_mfma_f32_16x16x32_bf16 v[224:227],a[148:151],a[240:243],v[224:227]
 buffer_load_dwordx4 v[124:127],v1,s[4:7],s40 offen offset:3072 sc1
 v_cvt_pk_bf16_f32 v30,v16,v17
 v_mfma_f32_16x16x32_bf16 v[232:235],a[148:151],a[244:247],v[232:235]
 ds_read_b64_tr_b16 a[184:185],v15 offset:32768
 v_cvt_pk_bf16_f32 v31,v18,v19
 v_mfma_f32_16x16x32_bf16 v[232:235],a[144:147],a[228:231],v[232:235]
 s_mov_b32 s49,266240
 ds_read_b64_tr_b16 a[186:187],v15 offset:36864
 buffer_store_dwordx4 v[28:31],v1,s[20:23],s49 offen offset:3072 sc1
 v_mfma_f32_16x16x32_bf16 v[240:243],a[144:147],a[232:235],v[240:243]
 s_add_u32 s68,s30,41943040
 s_addc_u32 s69,s31,0
 s_mov_b32 s70,16384
 v_mfma_f32_16x16x32_bf16 v[240:243],a[148:151],a[248:251],v[240:243]
 s_mov_b32 s40,65536
 ds_read_b64_tr_b16 a[188:189],v15 offset:40960
 s_mov_b32 s71,0x20000
 v_mfma_f32_16x16x32_bf16 v[248:251],a[148:151],a[252:255],v[248:251]
 ds_read_b64_tr_b16 a[190:191],v15 offset:45056
 buffer_load_dwordx4 a[192:195],v1,s[4:7],s40 offen offset:0 sc1
 v_mfma_f32_16x16x32_bf16 v[248:251],a[144:147],a[236:239],v[248:251]
 v_lshlrev_b32 v52,16,v1
 v_mov_b32 v55,1
 v_mfma_f32_16x16x32_bf16 v[252:255],a[152:155],a[236:239],v[252:255]
 s_lshl_b32 s76,s47,5
 s_add_u32 s76,s76,s46
 s_lshl_b32 s76,s76,2
 v_mfma_f32_16x16x32_bf16 v[252:255],a[156:159],a[252:255],v[252:255]
 s_xor_b32 s16,s76,32
 s_lshl_b32 s17,s76,11
 s_add_u32 s17,s17,12582912
 v_mfma_f32_16x16x32_bf16 v[244:247],a[156:159],a[248:251],v[244:247]
 s_xor_b32 s18,s17,65536
 v_add_u32 v36,65536,v8
 v_add_u32 v37,65536,v9
 v_mfma_f32_16x16x32_bf16 v[244:247],a[152:155],a[232:235],v[244:247]
 buffer_load_dwordx4 a[196:199],v1,s[4:7],s40 offen offset:1024 sc1
 v_add_u32 v38,65536,v10
 v_mfma_f32_16x16x32_bf16 v[236:239],a[152:155],a[228:231],v[236:239]
 v_add_u32 v39,65536,v11
 v_add_u32 v40,65536,v12
 v_mfma_f32_16x16x32_bf16 v[236:239],a[156:159],a[244:247],v[236:239]
 v_add_u32 v41,65536,v13
 v_add_u32 v42,65536,v14
 v_mfma_f32_16x16x32_bf16 v[228:231],a[156:159],a[240:243],v[228:231]
 v_add_u32 v43,65536,v15
 v_mfma_f32_16x16x32_bf16 v[228:231],a[152:155],a[224:227],v[228:231]
 s_waitcnt vmcnt(54) lgkmcnt(0)
 s_barrier
 v_mfma_f32_16x16x32_bf16 v[128:131],a[160:163],a[224:227],v[128:131]
 ds_read_b64_tr_b16 a[128:129],v8 offset:49152
 v_mfma_f32_16x16x32_bf16 v[128:131],a[164:167],a[240:243],v[128:131]
 ds_read_b64_tr_b16 a[130:131],v8 offset:53248
 v_mfma_f32_16x16x32_bf16 v[136:139],a[164:167],a[244:247],v[136:139]
 buffer_load_dwordx4 a[208:211],v1,s[4:7],s40 offen offset:2048 sc1
 v_mfma_f32_16x16x32_bf16 v[136:139],a[160:163],a[228:231],v[136:139]
 ds_read_b64_tr_b16 a[132:133],v8 offset:57344
 v_mfma_f32_16x16x32_bf16 v[144:147],a[160:163],a[232:235],v[144:147]
 ds_read_b64_tr_b16 a[134:135],v8 offset:61440
 v_mfma_f32_16x16x32_bf16 v[144:147],a[164:167],a[248:251],v[144:147]
 buffer_load_dwordx4 a[212:215],v1,s[4:7],s40 offen offset:3072 sc1
 v_mfma_f32_16x16x32_bf16 v[152:155],a[164:167],a[252:255],v[152:155]
 ds_read_b64_tr_b16 a[136:137],v9 offset:49152
 v_mfma_f32_16x16x32_bf16 v[152:155],a[160:163],a[236:239],v[152:155]
 ds_read_b64_tr_b16 a[138:139],v9 offset:53248
 v_mfma_f32_16x16x32_bf16 v[156:159],a[168:171],a[236:239],v[156:159]
 s_mov_b32 s40,196608
 v_mfma_f32_16x16x32_bf16 v[156:159],a[172:175],a[252:255],v[156:159]
 ds_read_b64_tr_b16 a[140:141],v9 offset:57344
 buffer_load_dwordx4 a[200:203],v1,s[4:7],s40 offen offset:0 sc1
 v_mfma_f32_16x16x32_bf16 v[148:151],a[172:175],a[248:251],v[148:151]
 ds_read_b64_tr_b16 a[142:143],v9 offset:61440
 v_mfma_f32_16x16x32_bf16 v[148:151],a[168:171],a[232:235],v[148:151]
 v_mfma_f32_16x16x32_bf16 v[140:143],a[168:171],a[228:231],v[140:143]
 ds_read_b64_tr_b16 a[144:145],v10 offset:49152
 v_mfma_f32_16x16x32_bf16 v[140:143],a[172:175],a[244:247],v[140:143]
 ds_read_b64_tr_b16 a[146:147],v10 offset:53248
 buffer_load_dwordx4 a[204:207],v1,s[4:7],s40 offen offset:1024 sc1
 v_mfma_f32_16x16x32_bf16 v[132:135],a[172:175],a[240:243],v[132:135]
 v_mfma_f32_16x16x32_bf16 v[132:135],a[168:171],a[224:227],v[132:135]
 ds_read_b64_tr_b16 a[148:149],v10 offset:57344
 v_mfma_f32_16x16x32_bf16 v[160:163],a[176:179],a[224:227],v[160:163]
 ds_read_b64_tr_b16 a[150:151],v10 offset:61440
 v_mfma_f32_16x16x32_bf16 v[160:163],a[180:183],a[240:243],v[160:163]
 buffer_load_dwordx4 a[216:219],v1,s[4:7],s40 offen offset:2048 sc1
 v_mfma_f32_16x16x32_bf16 v[168:171],a[180:183],a[244:247],v[168:171]
 ds_read_b64_tr_b16 a[152:153],v11 offset:49152
 v_mfma_f32_16x16x32_bf16 v[168:171],a[176:179],a[228:231],v[168:171]
 ds_read_b64_tr_b16 a[154:155],v11 offset:53248
 v_mfma_f32_16x16x32_bf16 v[176:179],a[176:179],a[232:235],v[176:179]
 buffer_load_dwordx4 a[220:223],v1,s[4:7],s40 offen offset:3072 sc1
 v_mfma_f32_16x16x32_bf16 v[176:179],a[180:183],a[248:251],v[176:179]
 ds_read_b64_tr_b16 a[156:157],v11 offset:57344
 v_mfma_f32_16x16x32_bf16 v[184:187],a[180:183],a[252:255],v[184:187]
 s_add_u32 m0,s3,16384
 ds_read_b64_tr_b16 a[158:159],v11 offset:61440
 v_mfma_f32_16x16x32_bf16 v[184:187],a[176:179],a[236:239],v[184:187]
 s_mov_b32 s41,9175040
 v_mfma_f32_16x16x32_bf16 v[188:191],a[184:187],a[236:239],v[188:191]
 buffer_load_dwordx4 v24,s[12:15],s41 offen offset:0 lds
 v_mfma_f32_16x16x32_bf16 v[188:191],a[188:191],a[252:255],v[188:191]
 v_mfma_f32_16x16x32_bf16 v[180:183],a[188:191],a[248:251],v[180:183]
 v_mfma_f32_16x16x32_bf16 v[180:183],a[184:187],a[232:235],v[180:183]
 v_mfma_f32_16x16x32_bf16 v[172:175],a[184:187],a[228:231],v[172:175]
 buffer_load_dwordx4 v25,s[12:15],s41 offen offset:1024 lds
 v_mfma_f32_16x16x32_bf16 v[172:175],a[188:191],a[244:247],v[172:175]
 v_mfma_f32_16x16x32_bf16 v[164:167],a[188:191],a[240:243],v[164:167]
 v_mfma_f32_16x16x32_bf16 v[164:167],a[184:187],a[224:227],v[164:167]
 s_waitcnt vmcnt(28) lgkmcnt(0)
 v_mfma_f32_16x16x32_bf16 v[192:195],a[128:131],v[64:67],v[192:195]
 ds_read_b64_tr_b16 a[160:161],v12 offset:49152
 s_waitcnt vmcnt(10)
 v_mfma_f32_16x16x32_bf16 v[192:195],a[132:135],v[80:83],v[192:195]
 ds_read_b64_tr_b16 a[162:163],v12 offset:53248
 buffer_store_dword v55,v52,s[68:71],s76 offen sc1
 v_mfma_f32_16x16x32_bf16 v[200:203],a[132:135],v[84:87],v[200:203]
 s_lshl_b32 s48,s100,2
 buffer_load_dwordx4 v26,s[12:15],s41 offen offset:2048 lds
 s_lshr_b32 s43,1164390928,s48
 v_mfma_f32_16x16x32_bf16 v[200:203],a[128:131],v[68:71],v[200:203]
 s_bitcmp1_b32 s43,2
 s_cselect_b32 s42,-1,0
 ds_read_b64_tr_b16 a[164:165],v12 offset:57344
 v_mfma_f32_16x16x32_bf16 v[208:211],a[128:131],v[72:75],v[208:211]
 s_lshr_b32 s50,s100,1
 ds_read_b64_tr_b16 a[166:167],v12 offset:61440
 s_lshl_b32 s50,s50,3
 v_mfma_f32_16x16x32_bf16 v[208:211],a[132:135],v[88:91],v[208:211]
 s_lshr_b32 s51,117901063,s50
 buffer_load_dwordx4 v27,s[12:15],s41 offen offset:3072 lds
 s_and_b32 s51,s51,0xff
 v_mfma_f32_16x16x32_bf16 v[216:219],a[132:135],v[92:95],v[216:219]
 s_lshr_b32 s50,353240832,s50
 ds_read_b64_tr_b16 a[168:169],v13 offset:49152
 s_and_b32 s50,s50,0xff
 v_mfma_f32_16x16x32_bf16 v[216:219],a[128:131],v[76:79],v[216:219]
 s_lshr_b32 s48,s2,5
 ds_read_b64_tr_b16 a[170:171],v13 offset:53248
 v_mfma_f32_16x16x32_bf16 v[220:223],a[136:139],v[76:79],v[220:223]
 s_mov_b32 s40,73728
 s_cmp_lt_u32 s48,s51
 s_cselect_b32 s51,-1,0
 v_mfma_f32_16x16x32_bf16 v[220:223],a[140:143],v[92:95],v[220:223]
 s_add_u32 s50,s50,s48
 ds_read_b64_tr_b16 a[172:173],v13 offset:57344
 buffer_load_dwordx4 a[224:227],v1,s[4:7],s40 offen offset:0 sc1
 v_mfma_f32_16x16x32_bf16 v[212:215],a[140:143],v[88:91],v[212:215]
 s_and_b32 s50,s50,s51
 ds_read_b64_tr_b16 a[174:175],v13 offset:61440
 s_and_b32 s49,s100,1
 v_mfma_f32_16x16x32_bf16 v[212:215],a[136:139],v[72:75],v[212:215]
 s_lshl_b32 s49,s49,1
 s_bfe_u32 s48,s2,0x10004
 s_add_u32 s49,s49,s48
 v_mfma_f32_16x16x32_bf16 v[204:207],a[136:139],v[68:71],v[204:207]
 s_lshl_b32 s49,s49,2
 ds_read_b64_tr_b16 a[176:177],v14 offset:49152
 s_lshr_b32 s48,s3,12
 v_mfma_f32_16x16x32_bf16 v[204:207],a[140:143],v[84:87],v[204:207]
 s_add_u32 s49,s49,s48
 ds_read_b64_tr_b16 a[178:179],v14 offset:53248
 buffer_load_dwordx4 a[228:231],v1,s[4:7],s40 offen offset:1024 sc1
 v_mfma_f32_16x16x32_bf16 v[196:199],a[140:143],v[80:83],v[196:199]
 s_mul_i32 s48,s49,458752
 s_lshl_b32 s46,s50,13
 s_add_u32 s48,s48,s46
 v_mfma_f32_16x16x32_bf16 v[196:199],a[136:139],v[64:67],v[196:199]
 s_bfe_u32 s47,s2,0x10003
 ds_read_b64_tr_b16 a[180:181],v14 offset:57344
 s_lshl_b32 s46,s47,12
 v_mfma_f32_16x16x32_bf16 v[224:227],a[144:147],v[64:67],v[224:227]
 s_add_u32 s48,s48,s46
 ds_read_b64_tr_b16 a[182:183],v14 offset:61440
 s_add_u32 s48,s48,25165824
 v_mfma_f32_16x16x32_bf16 v[224:227],a[148:151],v[80:83],v[224:227]
 s_and_b32 s46,s51,233472
 buffer_load_dwordx4 a[240:243],v1,s[4:7],s40 offen offset:2048 sc1
 v_mfma_f32_16x16x32_bf16 v[232:235],a[148:151],v[84:87],v[232:235]
 s_add_u32 s64,s30,s48
 s_addc_u32 s65,s31,0
 ds_read_b64_tr_b16 a[184:185],v15 offset:49152
 v_mfma_f32_16x16x32_bf16 v[232:235],a[144:147],v[68:71],v[232:235]
 s_mov_b32 s66,s46
 ds_read_b64_tr_b16 a[186:187],v15 offset:53248
 s_mov_b32 s67,0x20000
 v_mfma_f32_16x16x32_bf16 v[240:243],a[144:147],v[72:75],v[240:243]
 s_lshl_b32 s77,s49,1
 buffer_load_dwordx4 a[244:247],v1,s[4:7],s40 offen offset:3072 sc1
 s_add_u32 s77,s77,s47
 v_mfma_f32_16x16x32_bf16 v[240:243],a[148:151],v[88:91],v[240:243]
 s_lshl_b32 s77,s77,5
 ds_read_b64_tr_b16 a[188:189],v15 offset:57344
 s_add_u32 s77,s77,s50
 v_mfma_f32_16x16x32_bf16 v[248:251],a[148:151],v[92:95],v[248:251]
 s_lshl_b32 s77,s77,2
 ds_read_b64_tr_b16 a[190:191],v15 offset:61440
 s_add_u32 s77,s77,4096
 v_mfma_f32_16x16x32_bf16 v[248:251],a[144:147],v[76:79],v[248:251]
 s_mov_b32 s40,204800
 s_andn2_b32 s48,0x100000,s51
 s_or_b32 s77,s77,s48
 v_mfma_f32_16x16x32_bf16 v[252:255],a[152:155],v[76:79],v[252:255]
 buffer_load_dwordx4 a[232:235],v1,s[4:7],s40 offen offset:0 sc1
 v_xor_b32 v58,s44,v44
 v_mfma_f32_16x16x32_bf16 v[252:255],a[156:159],v[92:95],v[252:255]
 s_and_b32 s100,s43,1
 s_bfe_u32 s51,s43,0x10001
 s_lshl_b32 s48,s51,3
 v_mfma_f32_16x16x32_bf16 v[244:247],a[156:159],v[88:91],v[244:247]
 s_lshr_b32 s49,s2,5
 s_add_u32 s48,s48,s49
 s_bfe_u32 s49,s2,0x30003
 v_mfma_f32_16x16x32_bf16 v[244:247],a[152:155],v[72:75],v[244:247]
 s_bitcmp1_b32 s43,2
 s_cselect_b32 s46,s48,s49
 s_lshl_b32 s48,s51,2
 v_mfma_f32_16x16x32_bf16 v[236:239],a[152:155],v[68:71],v[236:239]
 s_lshr_b32 s49,s2,6
 buffer_load_dwordx4 a[236:239],v1,s[4:7],s40 offen offset:1024 sc1
 s_add_u32 s48,s48,s49
 v_mfma_f32_16x16x32_bf16 v[236:239],a[156:159],v[84:87],v[236:239]
 s_bfe_u32 s49,s2,0x20003
 s_bitcmp1_b32 s43,2
 s_cselect_b32 s47,s49,s48
 v_mfma_f32_16x16x32_bf16 v[228:231],a[156:159],v[80:83],v[228:231]
 s_lshl_b32 s47,s47,2
 s_lshr_b32 s48,s3,12
 s_add_u32 s47,s47,s48
 v_mfma_f32_16x16x32_bf16 v[228:231],a[152:155],v[64:67],v[228:231]
 s_waitcnt vmcnt(31) lgkmcnt(0)
 s_barrier
 v_mfma_f32_16x16x32_bf16 v[128:131],a[160:163],v[64:67],v[128:131]
 s_movk_i32 s50,0x800
 ds_read_b64_tr_b16 a[128:129],v44 offset:49152
 v_mfma_f32_16x16x32_bf16 v[128:131],a[164:167],v[80:83],v[128:131]
 s_bitcmp1_b32 s43,2
 s_cselect_b32 s50,4096,s50
 ds_read_b64_tr_b16 a[130:131],v44 offset:53248
 v_mfma_f32_16x16x32_bf16 v[136:139],a[164:167],v[84:87],v[136:139]
 s_mov_b32 s58,131072
 buffer_load_dwordx4 a[248:251],v1,s[4:7],s40 offen offset:2048 sc1
 v_mfma_f32_16x16x32_bf16 v[136:139],a[160:163],v[68:71],v[136:139]
 s_bitcmp1_b32 s43,2
 s_cmov_b32 s58,524288
 ds_read_b64_tr_b16 a[132:133],v44 offset:57344
 v_mfma_f32_16x16x32_bf16 v[144:147],a[160:163],v[72:75],v[144:147]
 s_bitcmp1_b32 s43,2
 s_cselect_b32 s44,1,32
 ds_read_b64_tr_b16 a[134:135],v44 offset:61440
 v_mfma_f32_16x16x32_bf16 v[144:147],a[164:167],v[88:91],v[144:147]
 s_mul_i32 s44,s44,s100
 buffer_load_dwordx4 a[252:255],v1,s[4:7],s40 offen offset:3072 sc1
 v_mfma_f32_16x16x32_bf16 v[152:155],a[164:167],v[92:95],v[152:155]
 s_bitcmp1_b32 s43,2
 s_cselect_b64 s[8:9],s[38:39],s[36:37]
 ds_read_b64_tr_b16 a[136:137],v45 offset:49152
 v_mfma_f32_16x16x32_bf16 v[152:155],a[160:163],v[76:79],v[152:155]
 s_add_u32 m0,s3,81920
 ds_read_b64_tr_b16 a[138:139],v45 offset:53248
 s_mul_i32 s48,s50,s44
 v_mfma_f32_16x16x32_bf16 v[156:159],a[168:171],v[76:79],v[156:159]
 s_mov_b32 s41,10092544
 s_lshl_b32 s48,s48,6
 s_lshl_b32 s49,s46,8
 v_mfma_f32_16x16x32_bf16 v[156:159],a[172:175],v[92:95],v[156:159]
 s_add_u32 s48,s48,s49
 ds_read_b64_tr_b16 a[140:141],v45 offset:57344
 buffer_load_dwordx4 v24,s[12:15],s41 offen offset:0 lds
 v_mfma_f32_16x16x32_bf16 v[148:151],a[172:175],v[88:91],v[148:151]
 s_mov_b32 s51,8388608
 ds_read_b64_tr_b16 a[142:143],v45 offset:61440
 v_mfma_f32_16x16x32_bf16 v[148:151],a[168:171],v[72:75],v[148:151]
 s_bitcmp1_b32 s43,2
 s_cselect_b32 s49,14680064,s51
 s_sub_u32 s49,s49,s48
 v_mfma_f32_16x16x32_bf16 v[140:143],a[168:171],v[68:71],v[140:143]
 s_add_u32 s8,s8,s48
 s_addc_u32 s9,s9,0
 ds_read_b64_tr_b16 a[144:145],v46 offset:49152
 v_mfma_f32_16x16x32_bf16 v[140:143],a[172:175],v[84:87],v[140:143]
 s_mov_b32 s10,s49
 ds_read_b64_tr_b16 a[146:147],v46 offset:53248
 buffer_load_dwordx4 v25,s[12:15],s41 offen offset:1024 lds
 v_mfma_f32_16x16x32_bf16 v[132:135],a[172:175],v[80:83],v[132:135]
 s_mov_b32 s11,0x20000
 s_lshr_b32 s48,s3,8
 v_add_u32 v62,s48,v3
 v_mfma_f32_16x16x32_bf16 v[132:135],a[168:171],v[64:67],v[132:135]
 ds_read_b64_tr_b16 a[148:149],v46 offset:57344
 v_mul_u32_u24 v62,s50,v62
 v_mfma_f32_16x16x32_bf16 v[160:163],a[176:179],v[64:67],v[160:163]
 ds_read_b64_tr_b16 a[150:151],v46 offset:61440
 v_lshlrev_b32 v63,1,v3
 v_mfma_f32_16x16x32_bf16 v[160:163],a[180:183],v[80:83],v[160:163]
 buffer_load_dwordx4 v26,s[12:15],s41 offen offset:2048 lds
 v_xor_b32 v63,v63,v2
 v_mfma_f32_16x16x32_bf16 v[168:171],a[180:183],v[84:87],v[168:171]
 ds_read_b64_tr_b16 a[152:153],v47 offset:49152
 v_lshl_add_u32 v32,v63,4,v62
 v_mfma_f32_16x16x32_bf16 v[168:171],a[176:179],v[68:71],v[168:171]
 ds_read_b64_tr_b16 a[154:155],v47 offset:53248
 v_xor_b32 v63,8,v63
 v_mfma_f32_16x16x32_bf16 v[176:179],a[176:179],v[72:75],v[176:179]
 buffer_load_dwordx4 v27,s[12:15],s41 offen offset:3072 lds
 v_lshl_add_u32 v33,v63,4,v62
 v_mfma_f32_16x16x32_bf16 v[176:179],a[180:183],v[88:91],v[176:179]
 s_lshl_b32 s48,s50,2
 ds_read_b64_tr_b16 a[156:157],v47 offset:57344
 s_sub_u32 s48,s48,1024
 v_mfma_f32_16x16x32_bf16 v[184:187],a[180:183],v[92:95],v[184:187]
 s_add_u32 m0,s3,32768
 ds_read_b64_tr_b16 a[158:159],v47 offset:61440
 s_lshl_b32 s49,s48,1
 v_mfma_f32_16x16x32_bf16 v[184:187],a[176:179],v[76:79],v[184:187]
 s_mov_b32 s41,11010048
 v_add_u32 v33,s48,v33
 v_add_u32 v34,s49,v32
 v_mfma_f32_16x16x32_bf16 v[188:191],a[184:187],v[76:79],v[188:191]
 buffer_load_dwordx4 v24,s[12:15],s41 offen offset:0 lds
 v_add_u32 v35,s49,v33
 v_mfma_f32_16x16x32_bf16 v[188:191],a[188:191],v[92:95],v[188:191]
 s_lshl_b32 s50,s47,19
 s_add_u32 s50,s50,8388608
 s_mul_i32 s48,s47,458752
 v_mfma_f32_16x16x32_bf16 v[180:183],a[188:191],v[88:91],v[180:183]
 s_add_u32 s48,s48,25165824
 s_bitcmp1_b32 s43,2
 s_cselect_b32 s48,s48,s50
 v_mfma_f32_16x16x32_bf16 v[180:183],a[184:187],v[72:75],v[180:183]
 s_lshl_b32 s49,s44,12
 s_add_u32 s48,s48,s49
 s_sub_u32 s49,524288,s49
 v_mfma_f32_16x16x32_bf16 v[172:175],a[184:187],v[68:71],v[172:175]
 s_andn2_b32 s49,s49,s42
 buffer_load_dwordx4 v25,s[12:15],s41 offen offset:1024 lds
 v_mfma_f32_16x16x32_bf16 v[172:175],a[188:191],v[84:87],v[172:175]
 s_add_u32 s60,s30,s48
 s_addc_u32 s61,s31,0
 s_mov_b32 s62,s49
 v_mfma_f32_16x16x32_bf16 v[164:167],a[188:191],v[80:83],v[164:167]
 s_mov_b32 s63,0x20000
 s_lshl_b32 s51,s46,1
 s_add_u32 s51,s51,s100
 v_mfma_f32_16x16x32_bf16 v[164:167],a[184:187],v[64:67],v[164:167]
 s_waitcnt vmcnt(28) lgkmcnt(0)
 s_lshr_b32 s48,s47,1
 v_mfma_f32_16x16x32_bf16 v[192:195],a[128:131],v[96:99],v[192:195]
 s_bitcmp1_b32 s43,2
 s_cselect_b32 s48,s46,s48
 ds_read_b64_tr_b16 a[160:161],v48 offset:49152
 v_mfma_f32_16x16x32_bf16 v[192:195],a[132:135],v[112:115],v[192:195]
 s_lshl_b32 s76,s48,8
 ds_read_b64_tr_b16 a[162:163],v48 offset:53248
 v_lshrrev_b32 v54,2,v1
 v_mfma_f32_16x16x32_bf16 v[200:203],a[132:135],v[116:119],v[200:203]
 s_add_u32 s20,s30,75497472
 s_addc_u32 s21,s31,0
 buffer_load_dwordx4 v26,s[12:15],s41 offen offset:2048 lds
 v_mfma_f32_16x16x32_bf16 v[200:203],a[128:131],v[100:103],v[200:203]
 s_mov_b32 s22,20971520
 ds_read_b64_tr_b16 a[164:165],v48 offset:57344
 s_mov_b32 s23,0x20000
 v_mfma_f32_16x16x32_bf16 v[208:211],a[128:131],v[104:107],v[208:211]
 ds_read_b64_tr_b16 a[166:167],v48 offset:61440
 v_lshlrev_b32 v56,11,v2
 v_mfma_f32_16x16x32_bf16 v[208:211],a[132:135],v[120:123],v[208:211]
 buffer_load_dwordx4 v27,s[12:15],s41 offen offset:3072 lds
 v_lshl_add_u32 v56,v3,4,v56
 v_mfma_f32_16x16x32_bf16 v[216:219],a[132:135],v[124:127],v[216:219]
 ds_read_b64_tr_b16 a[168:169],v49 offset:49152
 v_lshrrev_b32 v57,2,v2
 v_mfma_f32_16x16x32_bf16 v[216:219],a[128:131],v[108:111],v[216:219]
 ds_read_b64_tr_b16 a[170:171],v49 offset:53248
 v_and_b32 v62,1,v3
 v_mfma_f32_16x16x32_bf16 v[220:223],a[136:139],v[108:111],v[220:223]
 s_mov_b32 s40,81920
 v_lshl_add_u32 v62,v62,2,v57
 v_lshl_add_u32 v57,v3,2,v57
 v_mfma_f32_16x16x32_bf16 v[220:223],a[140:143],v[124:127],v[220:223]
 ds_read_b64_tr_b16 a[172:173],v49 offset:57344
 buffer_load_dwordx4 v[64:67],v1,s[4:7],s40 offen offset:0 sc1
 v_mfma_f32_16x16x32_bf16 v[212:215],a[140:143],v[120:123],v[212:215]
 ds_read_b64_tr_b16 a[174:175],v49 offset:61440
 v_lshlrev_b32 v57,8,v57
 v_mfma_f32_16x16x32_bf16 v[212:215],a[136:139],v[104:107],v[212:215]
 v_lshlrev_b32 v62,1,v62
 v_and_b32 v63,3,v2
 v_mfma_f32_16x16x32_bf16 v[204:207],a[136:139],v[100:103],v[204:207]
 ds_read_b64_tr_b16 a[176:177],v50 offset:49152
 v_xor_b32 v62,v62,v63
 v_mfma_f32_16x16x32_bf16 v[204:207],a[140:143],v[116:119],v[204:207]
 ds_read_b64_tr_b16 a[178:179],v50 offset:53248
 buffer_load_dwordx4 v[68:71],v1,s[4:7],s40 offen offset:1024 sc1
 v_mfma_f32_16x16x32_bf16 v[196:199],a[140:143],v[112:115],v[196:199]
 v_lshl_add_u32 v57,v62,4,v57
 v_bfi_b32 v57,s42,v58,v57
 v_mfma_f32_16x16x32_bf16 v[196:199],a[136:139],v[96:99],v[196:199]
 s_xor_b32 s48,s100,s42
 ds_read_b64_tr_b16 a[180:181],v50 offset:57344
 s_and_b32 s48,s48,1
 v_mfma_f32_16x16x32_bf16 v[224:227],a[144:147],v[96:99],v[224:227]
 s_lshl_b32 s48,s48,7
 ds_read_b64_tr_b16 a[182:183],v50 offset:61440
 v_xor_b32 v57,s48,v57
 v_mfma_f32_16x16x32_bf16 v[224:227],a[148:151],v[112:115],v[224:227]
 buffer_load_dwordx4 v[80:83],v1,s[4:7],s40 offen offset:2048 sc1
 v_lshlrev_b32 v62,1,v2
 v_mfma_f32_16x16x32_bf16 v[232:235],a[148:151],v[116:119],v[232:235]
 ds_read_b64_tr_b16 a[184:185],v51 offset:49152
 v_mfma_f32_16x16x32_bf16 v[232:235],a[144:147],v[100:103],v[232:235]
 ds_read_b64_tr_b16 a[186:187],v51 offset:53248
 v_mfma_f32_16x16x32_bf16 v[240:243],a[144:147],v[104:107],v[240:243]
 buffer_load_dwordx4 v[84:87],v1,s[4:7],s40 offen offset:3072 sc1
 v_mfma_f32_16x16x32_bf16 v[240:243],a[148:151],v[120:123],v[240:243]
 ds_read_b64_tr_b16 a[188:189],v51 offset:57344
 v_mfma_f32_16x16x32_bf16 v[248:251],a[148:151],v[124:127],v[248:251]
 ds_read_b64_tr_b16 a[190:191],v51 offset:61440
 v_mfma_f32_16x16x32_bf16 v[248:251],a[144:147],v[108:111],v[248:251]
 s_mov_b32 s40,212992
 v_mfma_f32_16x16x32_bf16 v[252:255],a[152:155],v[108:111],v[252:255]
 buffer_load_dwordx4 v[72:75],v1,s[4:7],s40 offen offset:0 sc1
 v_mfma_f32_16x16x32_bf16 v[252:255],a[156:159],v[124:127],v[252:255]
 v_mfma_f32_16x16x32_bf16 v[244:247],a[156:159],v[120:123],v[244:247]
 v_mfma_f32_16x16x32_bf16 v[244:247],a[152:155],v[104:107],v[244:247]
 v_mfma_f32_16x16x32_bf16 v[236:239],a[152:155],v[100:103],v[236:239]
 buffer_load_dwordx4 v[76:79],v1,s[4:7],s40 offen offset:1024 sc1
 v_mfma_f32_16x16x32_bf16 v[236:239],a[156:159],v[116:119],v[236:239]
 v_mfma_f32_16x16x32_bf16 v[228:231],a[156:159],v[112:115],v[228:231]
 v_mfma_f32_16x16x32_bf16 v[228:231],a[152:155],v[96:99],v[228:231]
 s_waitcnt vmcnt(62) lgkmcnt(0)
 s_barrier
 v_mfma_f32_16x16x32_bf16 v[128:131],a[160:163],v[96:99],v[128:131]
 ds_read_b64_tr_b16 a[128:129],v36 offset:0
 v_mfma_f32_16x16x32_bf16 v[128:131],a[164:167],v[112:115],v[128:131]
 ds_read_b64_tr_b16 a[130:131],v36 offset:4096
 v_mfma_f32_16x16x32_bf16 v[136:139],a[164:167],v[116:119],v[136:139]
 buffer_load_dwordx4 v[88:91],v1,s[4:7],s40 offen offset:2048 sc1
 v_mfma_f32_16x16x32_bf16 v[136:139],a[160:163],v[100:103],v[136:139]
 ds_read_b64_tr_b16 a[132:133],v36 offset:8192
 v_mfma_f32_16x16x32_bf16 v[144:147],a[160:163],v[104:107],v[144:147]
 ds_read_b64_tr_b16 a[134:135],v36 offset:12288
 v_mfma_f32_16x16x32_bf16 v[144:147],a[164:167],v[120:123],v[144:147]
 buffer_load_dwordx4 v[92:95],v1,s[4:7],s40 offen offset:3072 sc1
 v_mfma_f32_16x16x32_bf16 v[152:155],a[164:167],v[124:127],v[152:155]
 ds_read_b64_tr_b16 a[136:137],v37 offset:0
 v_mfma_f32_16x16x32_bf16 v[152:155],a[160:163],v[108:111],v[152:155]
 s_add_u32 m0,s3,98304
 ds_read_b64_tr_b16 a[138:139],v37 offset:4096
 v_mfma_f32_16x16x32_bf16 v[156:159],a[168:171],v[108:111],v[156:159]
 s_mov_b32 s41,11927552
 v_mfma_f32_16x16x32_bf16 v[156:159],a[172:175],v[124:127],v[156:159]
 ds_read_b64_tr_b16 a[140:141],v37 offset:8192
 buffer_load_dwordx4 v24,s[12:15],s41 offen offset:0 lds
 v_mfma_f32_16x16x32_bf16 v[148:151],a[172:175],v[120:123],v[148:151]
 ds_read_b64_tr_b16 a[142:143],v37 offset:12288
 v_mfma_f32_16x16x32_bf16 v[148:151],a[168:171],v[104:107],v[148:151]
 v_mfma_f32_16x16x32_bf16 v[140:143],a[168:171],v[100:103],v[140:143]
 ds_read_b64_tr_b16 a[144:145],v38 offset:0
 v_mfma_f32_16x16x32_bf16 v[140:143],a[172:175],v[116:119],v[140:143]
 ds_read_b64_tr_b16 a[146:147],v38 offset:4096
 buffer_load_dwordx4 v25,s[12:15],s41 offen offset:1024 lds
 v_mfma_f32_16x16x32_bf16 v[132:135],a[172:175],v[112:115],v[132:135]
 v_mfma_f32_16x16x32_bf16 v[132:135],a[168:171],v[96:99],v[132:135]
 ds_read_b64_tr_b16 a[148:149],v38 offset:8192
 v_mfma_f32_16x16x32_bf16 v[160:163],a[176:179],v[96:99],v[160:163]
 ds_read_b64_tr_b16 a[150:151],v38 offset:12288
 v_mfma_f32_16x16x32_bf16 v[160:163],a[180:183],v[112:115],v[160:163]
 buffer_load_dwordx4 v26,s[12:15],s41 offen offset:2048 lds
 v_mfma_f32_16x16x32_bf16 v[168:171],a[180:183],v[116:119],v[168:171]
 ds_read_b64_tr_b16 a[152:153],v39 offset:0
 v_mfma_f32_16x16x32_bf16 v[168:171],a[176:179],v[100:103],v[168:171]
 ds_read_b64_tr_b16 a[154:155],v39 offset:4096
 v_mfma_f32_16x16x32_bf16 v[176:179],a[176:179],v[104:107],v[176:179]
 buffer_load_dwordx4 v27,s[12:15],s41 offen offset:3072 lds
 v_mfma_f32_16x16x32_bf16 v[176:179],a[180:183],v[120:123],v[176:179]
 ds_read_b64_tr_b16 a[156:157],v39 offset:8192
 v_mfma_f32_16x16x32_bf16 v[184:187],a[180:183],v[124:127],v[184:187]
 s_add_u32 m0,s3,114688
 ds_read_b64_tr_b16 a[158:159],v39 offset:12288
 v_mfma_f32_16x16x32_bf16 v[184:187],a[176:179],v[108:111],v[184:187]
 s_mov_b32 s41,12845056
 v_mfma_f32_16x16x32_bf16 v[188:191],a[184:187],v[108:111],v[188:191]
 buffer_load_dwordx4 v24,s[12:15],s41 offen offset:0 lds
 v_mfma_f32_16x16x32_bf16 v[188:191],a[188:191],v[124:127],v[188:191]
 v_mfma_f32_16x16x32_bf16 v[180:183],a[188:191],v[120:123],v[180:183]
 v_mfma_f32_16x16x32_bf16 v[180:183],a[184:187],v[104:107],v[180:183]
 v_mfma_f32_16x16x32_bf16 v[172:175],a[184:187],v[100:103],v[172:175]
 buffer_load_dwordx4 v25,s[12:15],s41 offen offset:1024 lds
 v_mfma_f32_16x16x32_bf16 v[172:175],a[188:191],v[116:119],v[172:175]
 v_mfma_f32_16x16x32_bf16 v[164:167],a[188:191],v[112:115],v[164:167]
 v_mfma_f32_16x16x32_bf16 v[164:167],a[184:187],v[96:99],v[164:167]
 s_waitcnt vmcnt(35) lgkmcnt(0)
 v_mfma_f32_16x16x32_bf16 v[192:195],a[128:131],a[192:195],v[192:195]
 ds_read_b64_tr_b16 a[160:161],v40 offset:0
 v_mfma_f32_16x16x32_bf16 v[192:195],a[132:135],a[208:211],v[192:195]
 ds_read_b64_tr_b16 a[162:163],v40 offset:4096
 v_mfma_f32_16x16x32_bf16 v[200:203],a[132:135],a[212:215],v[200:203]
 buffer_load_dwordx4 v26,s[12:15],s41 offen offset:2048 lds
 v_mfma_f32_16x16x32_bf16 v[200:203],a[128:131],a[196:199],v[200:203]
 ds_read_b64_tr_b16 a[164:165],v40 offset:8192
 v_mfma_f32_16x16x32_bf16 v[208:211],a[128:131],a[200:203],v[208:211]
 ds_read_b64_tr_b16 a[166:167],v40 offset:12288
 v_mfma_f32_16x16x32_bf16 v[208:211],a[132:135],a[216:219],v[208:211]
 buffer_load_dwordx4 v27,s[12:15],s41 offen offset:3072 lds
 v_mfma_f32_16x16x32_bf16 v[216:219],a[132:135],a[220:223],v[216:219]
 ds_read_b64_tr_b16 a[168:169],v41 offset:0
 v_mfma_f32_16x16x32_bf16 v[216:219],a[128:131],a[204:207],v[216:219]
 ds_read_b64_tr_b16 a[170:171],v41 offset:4096
 v_mfma_f32_16x16x32_bf16 v[220:223],a[136:139],a[204:207],v[220:223]
 s_mov_b32 s40,90112
 v_mfma_f32_16x16x32_bf16 v[220:223],a[140:143],a[220:223],v[220:223]
 ds_read_b64_tr_b16 a[172:173],v41 offset:8192
 buffer_load_dwordx4 v[96:99],v1,s[4:7],s40 offen offset:0 sc1
 v_mfma_f32_16x16x32_bf16 v[212:215],a[140:143],a[216:219],v[212:215]
 ds_read_b64_tr_b16 a[174:175],v41 offset:12288
 v_mfma_f32_16x16x32_bf16 v[212:215],a[136:139],a[200:203],v[212:215]
 v_mfma_f32_16x16x32_bf16 v[204:207],a[136:139],a[196:199],v[204:207]
 ds_read_b64_tr_b16 a[176:177],v42 offset:0
 v_mfma_f32_16x16x32_bf16 v[204:207],a[140:143],a[212:215],v[204:207]
 ds_read_b64_tr_b16 a[178:179],v42 offset:4096
 buffer_load_dwordx4 v[100:103],v1,s[4:7],s40 offen offset:1024 sc1
 v_mfma_f32_16x16x32_bf16 v[196:199],a[140:143],a[208:211],v[196:199]
 v_mfma_f32_16x16x32_bf16 v[196:199],a[136:139],a[192:195],v[196:199]
 ds_read_b64_tr_b16 a[180:181],v42 offset:8192
 v_mfma_f32_16x16x32_bf16 v[224:227],a[144:147],a[192:195],v[224:227]
 ds_read_b64_tr_b16 a[182:183],v42 offset:12288
 v_mfma_f32_16x16x32_bf16 v[224:227],a[148:151],a[208:211],v[224:227]
 buffer_load_dwordx4 v[112:115],v1,s[4:7],s40 offen offset:2048 sc1
 v_mfma_f32_16x16x32_bf16 v[232:235],a[148:151],a[212:215],v[232:235]
 ds_read_b64_tr_b16 a[184:185],v43 offset:0
 v_mfma_f32_16x16x32_bf16 v[232:235],a[144:147],a[196:199],v[232:235]
 ds_read_b64_tr_b16 a[186:187],v43 offset:4096
 v_mfma_f32_16x16x32_bf16 v[240:243],a[144:147],a[200:203],v[240:243]
 buffer_load_dwordx4 v[116:119],v1,s[4:7],s40 offen offset:3072 sc1
 v_mfma_f32_16x16x32_bf16 v[240:243],a[148:151],a[216:219],v[240:243]
 ds_read_b64_tr_b16 a[188:189],v43 offset:8192
 v_mfma_f32_16x16x32_bf16 v[248:251],a[148:151],a[220:223],v[248:251]
 ds_read_b64_tr_b16 a[190:191],v43 offset:12288
 v_mfma_f32_16x16x32_bf16 v[248:251],a[144:147],a[204:207],v[248:251]
 s_mov_b32 s40,221184
 v_mfma_f32_16x16x32_bf16 v[252:255],a[152:155],a[204:207],v[252:255]
 buffer_load_dwordx4 v[104:107],v1,s[4:7],s40 offen offset:0 sc1
 v_mfma_f32_16x16x32_bf16 v[252:255],a[156:159],a[220:223],v[252:255]
 v_mfma_f32_16x16x32_bf16 v[244:247],a[156:159],a[216:219],v[244:247]
 v_mfma_f32_16x16x32_bf16 v[244:247],a[152:155],a[200:203],v[244:247]
 v_mfma_f32_16x16x32_bf16 v[236:239],a[152:155],a[196:199],v[236:239]
 buffer_load_dwordx4 v[108:111],v1,s[4:7],s40 offen offset:1024 sc1
 v_mfma_f32_16x16x32_bf16 v[236:239],a[156:159],a[212:215],v[236:239]
 v_mfma_f32_16x16x32_bf16 v[228:231],a[156:159],a[208:211],v[228:231]
 v_mfma_f32_16x16x32_bf16 v[228:231],a[152:155],a[192:195],v[228:231]
 s_waitcnt vmcnt(62) lgkmcnt(0)
 s_barrier
 v_mfma_f32_16x16x32_bf16 v[128:131],a[160:163],a[192:195],v[128:131]
 ds_read_b64_tr_b16 a[128:129],v36 offset:16384
 buffer_load_dword v53,v52,s[68:71],s16 offen sc1
 v_mfma_f32_16x16x32_bf16 v[128:131],a[164:167],a[208:211],v[128:131]
 ds_read_b64_tr_b16 a[130:131],v36 offset:20480
 v_mfma_f32_16x16x32_bf16 v[136:139],a[164:167],a[212:215],v[136:139]
 buffer_load_dwordx4 v[120:123],v1,s[4:7],s40 offen offset:2048 sc1
 v_mfma_f32_16x16x32_bf16 v[136:139],a[160:163],a[196:199],v[136:139]
 ds_read_b64_tr_b16 a[132:133],v36 offset:24576
 v_mfma_f32_16x16x32_bf16 v[144:147],a[160:163],a[200:203],v[144:147]
 ds_read_b64_tr_b16 a[134:135],v36 offset:28672
 v_mfma_f32_16x16x32_bf16 v[144:147],a[164:167],a[216:219],v[144:147]
 buffer_load_dwordx4 v[124:127],v1,s[4:7],s40 offen offset:3072 sc1
 v_mfma_f32_16x16x32_bf16 v[152:155],a[164:167],a[220:223],v[152:155]
 ds_read_b64_tr_b16 a[136:137],v37 offset:16384
 v_mfma_f32_16x16x32_bf16 v[152:155],a[160:163],a[204:207],v[152:155]
 s_add_u32 m0,s3,49152
 ds_read_b64_tr_b16 a[138:139],v37 offset:20480
 v_mfma_f32_16x16x32_bf16 v[156:159],a[168:171],a[204:207],v[156:159]
 s_mov_b32 s41,13762560
 v_mfma_f32_16x16x32_bf16 v[156:159],a[172:175],a[220:223],v[156:159]
 ds_read_b64_tr_b16 a[140:141],v37 offset:24576
 buffer_load_dwordx4 v24,s[12:15],s41 offen offset:0 lds
 v_mfma_f32_16x16x32_bf16 v[148:151],a[172:175],a[216:219],v[148:151]
 ds_read_b64_tr_b16 a[142:143],v37 offset:28672
 v_mfma_f32_16x16x32_bf16 v[148:151],a[168:171],a[200:203],v[148:151]
 v_mfma_f32_16x16x32_bf16 v[140:143],a[168:171],a[196:199],v[140:143]
 ds_read_b64_tr_b16 a[144:145],v38 offset:16384
 v_mfma_f32_16x16x32_bf16 v[140:143],a[172:175],a[212:215],v[140:143]
 ds_read_b64_tr_b16 a[146:147],v38 offset:20480
 buffer_load_dwordx4 v25,s[12:15],s41 offen offset:1024 lds
 v_mfma_f32_16x16x32_bf16 v[132:135],a[172:175],a[208:211],v[132:135]
 v_mfma_f32_16x16x32_bf16 v[132:135],a[168:171],a[192:195],v[132:135]
 ds_read_b64_tr_b16 a[148:149],v38 offset:24576
 v_mfma_f32_16x16x32_bf16 v[160:163],a[176:179],a[192:195],v[160:163]
 ds_read_b64_tr_b16 a[150:151],v38 offset:28672
 v_mfma_f32_16x16x32_bf16 v[160:163],a[180:183],a[208:211],v[160:163]
 buffer_load_dwordx4 v26,s[12:15],s41 offen offset:2048 lds
 v_mfma_f32_16x16x32_bf16 v[168:171],a[180:183],a[212:215],v[168:171]
 ds_read_b64_tr_b16 a[152:153],v39 offset:16384
 v_mfma_f32_16x16x32_bf16 v[168:171],a[176:179],a[196:199],v[168:171]
 ds_read_b64_tr_b16 a[154:155],v39 offset:20480
 v_mfma_f32_16x16x32_bf16 v[176:179],a[176:179],a[200:203],v[176:179]
 buffer_load_dwordx4 v27,s[12:15],s41 offen offset:3072 lds
 v_mfma_f32_16x16x32_bf16 v[176:179],a[180:183],a[216:219],v[176:179]
 ds_read_b64_tr_b16 a[156:157],v39 offset:24576
 v_mfma_f32_16x16x32_bf16 v[184:187],a[180:183],a[220:223],v[184:187]
 ds_read_b64_tr_b16 a[158:159],v39 offset:28672
 v_mfma_f32_16x16x32_bf16 v[184:187],a[176:179],a[204:207],v[184:187]
 s_mov_b32 s40,114688
 v_mfma_f32_16x16x32_bf16 v[188:191],a[184:187],a[204:207],v[188:191]
 buffer_load_dwordx4 a[64:67],v1,s[4:7],s40 offen offset:0 sc1
 v_mfma_f32_16x16x32_bf16 v[188:191],a[188:191],a[220:223],v[188:191]
 v_mfma_f32_16x16x32_bf16 v[180:183],a[188:191],a[216:219],v[180:183]
 v_mfma_f32_16x16x32_bf16 v[180:183],a[184:187],a[200:203],v[180:183]
 v_mfma_f32_16x16x32_bf16 v[172:175],a[184:187],a[196:199],v[172:175]
 buffer_load_dwordx4 a[68:71],v1,s[4:7],s40 offen offset:1024 sc1
 v_mfma_f32_16x16x32_bf16 v[172:175],a[188:191],a[212:215],v[172:175]
 v_mfma_f32_16x16x32_bf16 v[164:167],a[188:191],a[208:211],v[164:167]
 v_mfma_f32_16x16x32_bf16 v[164:167],a[184:187],a[192:195],v[164:167]
 s_waitcnt vmcnt(39) lgkmcnt(0)
 v_mfma_f32_16x16x32_bf16 v[192:195],a[128:131],a[224:227],v[192:195]
 ds_read_b64_tr_b16 a[160:161],v40 offset:16384
 v_mfma_f32_16x16x32_bf16 v[192:195],a[132:135],a[240:243],v[192:195]
 ds_read_b64_tr_b16 a[162:163],v40 offset:20480
 v_mfma_f32_16x16x32_bf16 v[200:203],a[132:135],a[244:247],v[200:203]
 buffer_load_dwordx4 a[80:83],v1,s[4:7],s40 offen offset:2048 sc1
 v_mfma_f32_16x16x32_bf16 v[200:203],a[128:131],a[228:231],v[200:203]
 ds_read_b64_tr_b16 a[164:165],v40 offset:24576
 v_mfma_f32_16x16x32_bf16 v[208:211],a[128:131],a[232:235],v[208:211]
 ds_read_b64_tr_b16 a[166:167],v40 offset:28672
 v_mfma_f32_16x16x32_bf16 v[208:211],a[132:135],a[248:251],v[208:211]
 buffer_load_dwordx4 a[84:87],v1,s[4:7],s40 offen offset:3072 sc1
 v_mfma_f32_16x16x32_bf16 v[216:219],a[132:135],a[252:255],v[216:219]
 ds_read_b64_tr_b16 a[168:169],v41 offset:16384
 v_mfma_f32_16x16x32_bf16 v[216:219],a[128:131],a[236:239],v[216:219]
 ds_read_b64_tr_b16 a[170:171],v41 offset:20480
 v_mfma_f32_16x16x32_bf16 v[220:223],a[136:139],a[236:239],v[220:223]
 s_mov_b32 s40,98304
 v_mfma_f32_16x16x32_bf16 v[220:223],a[140:143],a[252:255],v[220:223]
 ds_read_b64_tr_b16 a[172:173],v41 offset:24576
 buffer_load_dwordx4 a[192:195],v1,s[4:7],s40 offen offset:0 sc1
 v_mfma_f32_16x16x32_bf16 v[212:215],a[140:143],a[248:251],v[212:215]
 ds_read_b64_tr_b16 a[174:175],v41 offset:28672
 v_mfma_f32_16x16x32_bf16 v[212:215],a[136:139],a[232:235],v[212:215]
 v_mfma_f32_16x16x32_bf16 v[204:207],a[136:139],a[228:231],v[204:207]
 ds_read_b64_tr_b16 a[176:177],v42 offset:16384
 v_mfma_f32_16x16x32_bf16 v[204:207],a[140:143],a[244:247],v[204:207]
 ds_read_b64_tr_b16 a[178:179],v42 offset:20480
 buffer_load_dwordx4 a[196:199],v1,s[4:7],s40 offen offset:1024 sc1
 v_mfma_f32_16x16x32_bf16 v[196:199],a[140:143],a[240:243],v[196:199]
 v_mfma_f32_16x16x32_bf16 v[196:199],a[136:139],a[224:227],v[196:199]
 ds_read_b64_tr_b16 a[180:181],v42 offset:24576
 v_mfma_f32_16x16x32_bf16 v[224:227],a[144:147],a[224:227],v[224:227]
 ds_read_b64_tr_b16 a[182:183],v42 offset:28672
 v_mfma_f32_16x16x32_bf16 v[224:227],a[148:151],a[240:243],v[224:227]
 buffer_load_dwordx4 a[208:211],v1,s[4:7],s40 offen offset:2048 sc1
 v_mfma_f32_16x16x32_bf16 v[232:235],a[148:151],a[244:247],v[232:235]
 ds_read_b64_tr_b16 a[184:185],v43 offset:16384
 v_mfma_f32_16x16x32_bf16 v[232:235],a[144:147],a[228:231],v[232:235]
 ds_read_b64_tr_b16 a[186:187],v43 offset:20480
 v_mfma_f32_16x16x32_bf16 v[240:243],a[144:147],a[232:235],v[240:243]
 buffer_load_dwordx4 a[212:215],v1,s[4:7],s40 offen offset:3072 sc1
 v_mfma_f32_16x16x32_bf16 v[240:243],a[148:151],a[248:251],v[240:243]
 ds_read_b64_tr_b16 a[188:189],v43 offset:24576
 v_mfma_f32_16x16x32_bf16 v[248:251],a[148:151],a[252:255],v[248:251]
 ds_read_b64_tr_b16 a[190:191],v43 offset:28672
 v_mfma_f32_16x16x32_bf16 v[248:251],a[144:147],a[236:239],v[248:251]
 s_mov_b32 s40,229376
 v_mfma_f32_16x16x32_bf16 v[252:255],a[152:155],a[236:239],v[252:255]
 buffer_load_dwordx4 a[200:203],v1,s[4:7],s40 offen offset:0 sc1
 v_mfma_f32_16x16x32_bf16 v[252:255],a[156:159],a[252:255],v[252:255]
 v_mfma_f32_16x16x32_bf16 v[244:247],a[156:159],a[248:251],v[244:247]
 v_mfma_f32_16x16x32_bf16 v[244:247],a[152:155],a[232:235],v[244:247]
 v_mfma_f32_16x16x32_bf16 v[236:239],a[152:155],a[228:231],v[236:239]
 buffer_load_dwordx4 a[204:207],v1,s[4:7],s40 offen offset:1024 sc1
 v_mfma_f32_16x16x32_bf16 v[236:239],a[156:159],a[244:247],v[236:239]
 v_mfma_f32_16x16x32_bf16 v[228:231],a[156:159],a[240:243],v[228:231]
 v_mfma_f32_16x16x32_bf16 v[228:231],a[152:155],a[224:227],v[228:231]
 s_waitcnt vmcnt(55) lgkmcnt(0)
 s_barrier
 v_mfma_f32_16x16x32_bf16 v[128:131],a[160:163],a[224:227],v[128:131]
 ds_read_b64_tr_b16 a[128:129],v44 offset:16384
 v_and_b32 v4,1,v2
 v_mfma_f32_16x16x32_bf16 v[128:131],a[164:167],a[240:243],v[128:131]
 ds_read_b64_tr_b16 a[130:131],v44 offset:20480
 v_lshlrev_b32 v4,4,v4
 v_mfma_f32_16x16x32_bf16 v[136:139],a[164:167],a[244:247],v[136:139]
 buffer_load_dwordx4 a[216:219],v1,s[4:7],s40 offen offset:2048 sc1
 v_mov_b32 v5,0x3f80
 v_mfma_f32_16x16x32_bf16 v[136:139],a[160:163],a[228:231],v[136:139]
 ds_read_b64_tr_b16 a[132:133],v44 offset:24576
 v_lshlrev_b32 v4,v4,v5
 v_mfma_f32_16x16x32_bf16 v[144:147],a[160:163],a[232:235],v[144:147]
 ds_read_b64_tr_b16 a[134:135],v44 offset:28672
 v_bfe_u32 v5,v2,1,1
 v_mfma_f32_16x16x32_bf16 v[144:147],a[164:167],a[248:251],v[144:147]
 buffer_load_dwordx4 a[220:223],v1,s[4:7],s40 offen offset:3072 sc1
 v_lshrrev_b32 v6,2,v2
 v_mfma_f32_16x16x32_bf16 v[152:155],a[164:167],a[252:255],v[152:155]
 ds_read_b64_tr_b16 a[136:137],v45 offset:16384
 v_xor_b32 v6,v6,v3
 v_mfma_f32_16x16x32_bf16 v[152:155],a[160:163],a[236:239],v[152:155]
 ds_read_b64_tr_b16 a[138:139],v45 offset:20480
 v_lshl_add_u32 v6,v6,2,v5
 v_mfma_f32_16x16x32_bf16 v[156:159],a[168:171],a[236:239],v[156:159]
 s_mov_b32 s40,245760
 v_cmp_eq_u32 vcc,0,v6
 v_mov_b32 v38,0
 v_mfma_f32_16x16x32_bf16 v[156:159],a[172:175],a[252:255],v[156:159]
 ds_read_b64_tr_b16 a[140:141],v45 offset:24576
 buffer_load_dwordx4 a[72:75],v1,s[4:7],s40 offen offset:0 sc1
 v_mfma_f32_16x16x32_bf16 v[148:151],a[172:175],a[248:251],v[148:151]
 ds_read_b64_tr_b16 a[142:143],v45 offset:28672
 v_mov_b32 v40,0
 v_mfma_f32_16x16x32_bf16 v[148:151],a[168:171],a[232:235],v[148:151]
 v_cndmask_b32 v36,0,v4,vcc
 v_cndmask_b32 v42,0,v4,vcc
 v_mfma_f32_16x16x32_bf16 v[140:143],a[168:171],a[228:231],v[140:143]
 ds_read_b64_tr_b16 a[144:145],v46 offset:16384
 v_cmp_eq_u32 vcc,1,v6
 v_mfma_f32_16x16x32_bf16 v[140:143],a[172:175],a[244:247],v[140:143]
 ds_read_b64_tr_b16 a[146:147],v46 offset:20480
 buffer_load_dwordx4 a[76:79],v1,s[4:7],s40 offen offset:1024 sc1
 v_mfma_f32_16x16x32_bf16 v[132:135],a[172:175],a[240:243],v[132:135]
 v_mov_b32 v39,0
 v_mov_b32 v41,0
 v_mfma_f32_16x16x32_bf16 v[132:135],a[168:171],a[224:227],v[132:135]
 ds_read_b64_tr_b16 a[148:149],v46 offset:24576
 v_cndmask_b32 v37,0,v4,vcc
 v_mfma_f32_16x16x32_bf16 v[160:163],a[176:179],a[224:227],v[160:163]
 ds_read_b64_tr_b16 a[150:151],v46 offset:28672
 v_cndmask_b32 v43,0,v4,vcc
 v_mfma_f32_16x16x32_bf16 v[160:163],a[180:183],a[240:243],v[160:163]
 buffer_load_dwordx4 a[88:91],v1,s[4:7],s40 offen offset:2048 sc1
 v_mfma_f32_16x16x32_bf16 v[168:171],a[180:183],a[244:247],v[168:171]
 ds_read_b64_tr_b16 a[152:153],v47 offset:16384
 v_mfma_f32_16x16x32_bf16 v[168:171],a[176:179],a[228:231],v[168:171]
 ds_read_b64_tr_b16 a[154:155],v47 offset:20480
 v_mfma_f32_16x16x32_bf16 v[176:179],a[176:179],a[232:235],v[176:179]
 buffer_load_dwordx4 a[92:95],v1,s[4:7],s40 offen offset:3072 sc1
 v_mfma_f32_16x16x32_bf16 v[176:179],a[180:183],a[248:251],v[176:179]
 ds_read_b64_tr_b16 a[156:157],v47 offset:24576
 v_mfma_f32_16x16x32_bf16 v[184:187],a[180:183],a[252:255],v[184:187]
 ds_read_b64_tr_b16 a[158:159],v47 offset:28672
 v_mfma_f32_16x16x32_bf16 v[184:187],a[176:179],a[236:239],v[184:187]
 s_mov_b32 s40,122880
 v_mfma_f32_16x16x32_bf16 v[188:191],a[184:187],a[236:239],v[188:191]
 buffer_load_dwordx4 a[96:99],v1,s[4:7],s40 offen offset:0 sc1
 v_mfma_f32_16x16x32_bf16 v[188:191],a[188:191],a[252:255],v[188:191]
 v_mfma_f32_16x16x32_bf16 v[180:183],a[188:191],a[248:251],v[180:183]
 v_mfma_f32_16x16x32_bf16 v[180:183],a[184:187],a[232:235],v[180:183]
 v_mfma_f32_16x16x32_bf16 v[172:175],a[184:187],a[228:231],v[172:175]
 buffer_load_dwordx4 a[100:103],v1,s[4:7],s40 offen offset:1024 sc1
 v_mfma_f32_16x16x32_bf16 v[172:175],a[188:191],a[244:247],v[172:175]
 v_mfma_f32_16x16x32_bf16 v[164:167],a[188:191],a[240:243],v[164:167]
 v_mfma_f32_16x16x32_bf16 v[164:167],a[184:187],a[224:227],v[164:167]
 s_waitcnt vmcnt(39) lgkmcnt(0)
 v_mfma_f32_16x16x32_bf16 v[192:195],a[128:131],v[64:67],v[192:195]
 ds_read_b64_tr_b16 a[160:161],v48 offset:16384
 v_mfma_f32_16x16x32_bf16 v[192:195],a[132:135],v[80:83],v[192:195]
 ds_read_b64_tr_b16 a[162:163],v48 offset:20480
 v_mfma_f32_16x16x32_bf16 v[200:203],a[132:135],v[84:87],v[200:203]
 buffer_load_dwordx4 a[112:115],v1,s[4:7],s40 offen offset:2048 sc1
 v_mfma_f32_16x16x32_bf16 v[200:203],a[128:131],v[68:71],v[200:203]
 ds_read_b64_tr_b16 a[164:165],v48 offset:24576
 v_mfma_f32_16x16x32_bf16 v[208:211],a[128:131],v[72:75],v[208:211]
 ds_read_b64_tr_b16 a[166:167],v48 offset:28672
 v_mfma_f32_16x16x32_bf16 v[208:211],a[132:135],v[88:91],v[208:211]
 buffer_load_dwordx4 a[116:119],v1,s[4:7],s40 offen offset:3072 sc1
 v_mfma_f32_16x16x32_bf16 v[216:219],a[132:135],v[92:95],v[216:219]
 ds_read_b64_tr_b16 a[168:169],v49 offset:16384
 v_mfma_f32_16x16x32_bf16 v[216:219],a[128:131],v[76:79],v[216:219]
 ds_read_b64_tr_b16 a[170:171],v49 offset:20480
 v_mfma_f32_16x16x32_bf16 v[220:223],a[136:139],v[76:79],v[220:223]
 s_mov_b32 s40,106496
 v_mfma_f32_16x16x32_bf16 v[220:223],a[140:143],v[92:95],v[220:223]
 ds_read_b64_tr_b16 a[172:173],v49 offset:24576
 buffer_load_dwordx4 a[224:227],v1,s[4:7],s40 offen offset:0 sc1
 v_mfma_f32_16x16x32_bf16 v[212:215],a[140:143],v[88:91],v[212:215]
 ds_read_b64_tr_b16 a[174:175],v49 offset:28672
 v_mfma_f32_16x16x32_bf16 v[212:215],a[136:139],v[72:75],v[212:215]
 v_mfma_f32_16x16x32_bf16 v[204:207],a[136:139],v[68:71],v[204:207]
 ds_read_b64_tr_b16 a[176:177],v50 offset:16384
 v_mfma_f32_16x16x32_bf16 v[204:207],a[140:143],v[84:87],v[204:207]
 ds_read_b64_tr_b16 a[178:179],v50 offset:20480
 buffer_load_dwordx4 a[228:231],v1,s[4:7],s40 offen offset:1024 sc1
 v_mfma_f32_16x16x32_bf16 v[196:199],a[140:143],v[80:83],v[196:199]
 v_mfma_f32_16x16x32_bf16 v[196:199],a[136:139],v[64:67],v[196:199]
 ds_read_b64_tr_b16 a[180:181],v50 offset:24576
 v_mfma_f32_16x16x32_bf16 v[224:227],a[144:147],v[64:67],v[224:227]
 ds_read_b64_tr_b16 a[182:183],v50 offset:28672
 v_mfma_f32_16x16x32_bf16 v[224:227],a[148:151],v[80:83],v[224:227]
 buffer_load_dwordx4 a[240:243],v1,s[4:7],s40 offen offset:2048 sc1
 v_mfma_f32_16x16x32_bf16 v[232:235],a[148:151],v[84:87],v[232:235]
 ds_read_b64_tr_b16 a[184:185],v51 offset:16384
 v_mfma_f32_16x16x32_bf16 v[232:235],a[144:147],v[68:71],v[232:235]
 ds_read_b64_tr_b16 a[186:187],v51 offset:20480
 v_mfma_f32_16x16x32_bf16 v[240:243],a[144:147],v[72:75],v[240:243]
 buffer_load_dwordx4 a[244:247],v1,s[4:7],s40 offen offset:3072 sc1
 v_mfma_f32_16x16x32_bf16 v[240:243],a[148:151],v[88:91],v[240:243]
 ds_read_b64_tr_b16 a[188:189],v51 offset:24576
 v_mfma_f32_16x16x32_bf16 v[248:251],a[148:151],v[92:95],v[248:251]
 ds_read_b64_tr_b16 a[190:191],v51 offset:28672
 v_mfma_f32_16x16x32_bf16 v[248:251],a[144:147],v[76:79],v[248:251]
 s_mov_b32 s40,237568
 v_mfma_f32_16x16x32_bf16 v[252:255],a[152:155],v[76:79],v[252:255]
 buffer_load_dwordx4 a[232:235],v1,s[4:7],s40 offen offset:0 sc1
 s_waitcnt vmcnt(31)
 v_mfma_f32_16x16x32_bf16 v[252:255],a[156:159],v[92:95],v[252:255]
 v_readfirstlane_b32 s48,v53
 v_mfma_f32_16x16x32_bf16 v[244:247],a[156:159],v[88:91],v[244:247]
 v_mfma_f32_16x16x32_bf16 v[244:247],a[152:155],v[72:75],v[244:247]
 v_mfma_f32_16x16x32_bf16 v[236:239],a[152:155],v[68:71],v[236:239]
 buffer_load_dwordx4 a[236:239],v1,s[4:7],s40 offen offset:1024 sc1
 s_cmp_eq_u32 s48,0
 s_cbranch_scc1 L_spin_p
L_spin_p_ret:
 v_mfma_f32_16x16x32_bf16 v[236:239],a[156:159],v[84:87],v[236:239]
 v_mfma_f32_16x16x32_bf16 v[228:231],a[156:159],v[80:83],v[228:231]
 v_mfma_f32_16x16x32_bf16 v[228:231],a[152:155],v[64:67],v[228:231]
 s_waitcnt vmcnt(59) lgkmcnt(0)
 s_barrier
 v_mfma_f32_16x16x32_bf16 v[128:131],a[160:163],v[64:67],v[128:131]
 ds_read_b64_tr_b16 a[128:129],v8 offset:16384
 v_mfma_f32_16x16x32_bf16 v[128:131],a[164:167],v[80:83],v[128:131]
 ds_read_b64_tr_b16 a[130:131],v8 offset:20480
 v_mfma_f32_16x16x32_bf16 v[136:139],a[164:167],v[84:87],v[136:139]
 buffer_load_dwordx4 a[248:251],v1,s[4:7],s40 offen offset:2048 sc1
 v_mfma_f32_16x16x32_bf16 v[136:139],a[160:163],v[68:71],v[136:139]
 ds_read_b64_tr_b16 a[132:133],v8 offset:24576
 v_mfma_f32_16x16x32_bf16 v[144:147],a[160:163],v[72:75],v[144:147]
 ds_read_b64_tr_b16 a[134:135],v8 offset:28672
 v_mfma_f32_16x16x32_bf16 v[144:147],a[164:167],v[88:91],v[144:147]
 v_mfma_f32_16x16x32_bf16 v[152:155],a[164:167],v[92:95],v[152:155]
 ds_read_b64_tr_b16 a[136:137],v9 offset:16384
 v_mfma_f32_16x16x32_bf16 v[152:155],a[160:163],v[76:79],v[152:155]
 ds_read_b64_tr_b16 a[138:139],v9 offset:20480
 buffer_load_dwordx4 a[252:255],v1,s[4:7],s40 offen offset:3072 sc1
 v_mfma_f32_16x16x32_bf16 v[156:159],a[168:171],v[76:79],v[156:159]
 v_mfma_f32_16x16x32_bf16 v[156:159],a[172:175],v[92:95],v[156:159]
 ds_read_b64_tr_b16 a[140:141],v9 offset:24576
 v_mfma_f32_16x16x32_bf16 v[148:151],a[172:175],v[88:91],v[148:151]
 ds_read_b64_tr_b16 a[142:143],v9 offset:28672
 v_mfma_f32_16x16x32_bf16 v[148:151],a[168:171],v[72:75],v[148:151]
 s_mov_b32 s40,253952
 v_mfma_f32_16x16x32_bf16 v[140:143],a[168:171],v[68:71],v[140:143]
 ds_read_b64_tr_b16 a[144:145],v10 offset:16384
 buffer_load_dwordx4 a[104:107],v1,s[4:7],s40 offen offset:0 sc1
 v_mfma_f32_16x16x32_bf16 v[140:143],a[172:175],v[84:87],v[140:143]
 ds_read_b64_tr_b16 a[146:147],v10 offset:20480
 v_mfma_f32_16x16x32_bf16 v[132:135],a[172:175],v[80:83],v[132:135]
 v_mfma_f32_16x16x32_bf16 v[132:135],a[168:171],v[64:67],v[132:135]
 ds_read_b64_tr_b16 a[148:149],v10 offset:24576
 v_mfma_f32_16x16x32_bf16 v[160:163],a[176:179],v[64:67],v[160:163]
 ds_read_b64_tr_b16 a[150:151],v10 offset:28672
 v_mfma_f32_16x16x32_bf16 v[160:163],a[180:183],v[80:83],v[160:163]
 buffer_load_dwordx4 a[108:111],v1,s[4:7],s40 offen offset:1024 sc1
 v_mfma_f32_16x16x32_bf16 v[168:171],a[180:183],v[84:87],v[168:171]
 ds_read_b64_tr_b16 a[152:153],v11 offset:16384
 v_mfma_f32_16x16x32_bf16 v[168:171],a[176:179],v[68:71],v[168:171]
 ds_read_b64_tr_b16 a[154:155],v11 offset:20480
 v_mfma_f32_16x16x32_bf16 v[176:179],a[176:179],v[72:75],v[176:179]
 v_mfma_f32_16x16x32_bf16 v[176:179],a[180:183],v[88:91],v[176:179]
 ds_read_b64_tr_b16 a[156:157],v11 offset:24576
 v_mfma_f32_16x16x32_bf16 v[184:187],a[180:183],v[92:95],v[184:187]
 ds_read_b64_tr_b16 a[158:159],v11 offset:28672
 buffer_load_dwordx4 a[120:123],v1,s[4:7],s40 offen offset:2048 sc1
 v_mfma_f32_16x16x32_bf16 v[184:187],a[176:179],v[76:79],v[184:187]
 v_mfma_f32_16x16x32_bf16 v[188:191],a[184:187],v[76:79],v[188:191]
 v_mfma_f32_16x16x32_bf16 v[188:191],a[188:191],v[92:95],v[188:191]
 v_mfma_f32_16x16x32_bf16 v[180:183],a[188:191],v[88:91],v[180:183]
 v_mfma_f32_16x16x32_bf16 v[180:183],a[184:187],v[72:75],v[180:183]
 buffer_load_dwordx4 a[124:127],v1,s[4:7],s40 offen offset:3072 sc1
 v_mfma_f32_16x16x32_bf16 v[172:175],a[184:187],v[68:71],v[172:175]
 v_mfma_f32_16x16x32_bf16 v[172:175],a[188:191],v[84:87],v[172:175]
 v_mfma_f32_16x16x32_bf16 v[164:167],a[188:191],v[80:83],v[164:167]
 buffer_load_dword v53,v54,s[68:71],s76 offen sc1
 v_mfma_f32_16x16x32_bf16 v[164:167],a[184:187],v[64:67],v[164:167]
 s_waitcnt vmcnt(37) lgkmcnt(0)
 v_mfma_f32_16x16x32_bf16 v[192:195],a[128:131],v[96:99],v[192:195]
 ds_read_b64_tr_b16 a[160:161],v12 offset:16384
 v_mfma_f32_16x16x32_bf16 v[192:195],a[132:135],v[112:115],v[192:195]
 ds_read_b64_tr_b16 a[162:163],v12 offset:20480
 v_mfma_f32_16x16x32_bf16 v[200:203],a[132:135],v[116:119],v[200:203]
 v_mfma_f32_16x16x32_bf16 v[200:203],a[128:131],v[100:103],v[200:203]
 ds_read_b64_tr_b16 a[164:165],v12 offset:24576
 v_mfma_f32_16x16x32_bf16 v[208:211],a[128:131],v[104:107],v[208:211]
 ds_read_b64_tr_b16 a[166:167],v12 offset:28672
 v_mfma_f32_16x16x32_bf16 v[208:211],a[132:135],v[120:123],v[208:211]
 v_mfma_f32_16x16x32_bf16 v[216:219],a[132:135],v[124:127],v[216:219]
 ds_read_b64_tr_b16 a[168:169],v13 offset:16384
 v_mfma_f32_16x16x32_bf16 v[216:219],a[128:131],v[108:111],v[216:219]
 ds_read_b64_tr_b16 a[170:171],v13 offset:20480
 v_mfma_f32_16x16x32_bf16 v[220:223],a[136:139],v[108:111],v[220:223]
 v_mfma_f32_16x16x32_bf16 v[220:223],a[140:143],v[124:127],v[220:223]
 ds_read_b64_tr_b16 a[172:173],v13 offset:24576
 v_mfma_f32_16x16x32_bf16 v[212:215],a[140:143],v[120:123],v[212:215]
 ds_read_b64_tr_b16 a[174:175],v13 offset:28672
 v_mfma_f32_16x16x32_bf16 v[212:215],a[136:139],v[104:107],v[212:215]
 v_mfma_f32_16x16x32_bf16 v[204:207],a[136:139],v[100:103],v[204:207]
 ds_read_b64_tr_b16 a[176:177],v14 offset:16384
 v_mfma_f32_16x16x32_bf16 v[204:207],a[140:143],v[116:119],v[204:207]
 ds_read_b64_tr_b16 a[178:179],v14 offset:20480
 v_mfma_f32_16x16x32_bf16 v[196:199],a[140:143],v[112:115],v[196:199]
 v_mfma_f32_16x16x32_bf16 v[196:199],a[136:139],v[96:99],v[196:199]
 ds_read_b64_tr_b16 a[180:181],v14 offset:24576
 v_mfma_f32_16x16x32_bf16 v[224:227],a[144:147],v[96:99],v[224:227]
 ds_read_b64_tr_b16 a[182:183],v14 offset:28672
 v_mfma_f32_16x16x32_bf16 v[224:227],a[148:151],v[112:115],v[224:227]
 v_mfma_f32_16x16x32_bf16 v[232:235],a[148:151],v[116:119],v[232:235]
 ds_read_b64_tr_b16 a[184:185],v15 offset:16384
 v_mfma_f32_16x16x32_bf16 v[232:235],a[144:147],v[100:103],v[232:235]
 ds_read_b64_tr_b16 a[186:187],v15 offset:20480
 v_mfma_f32_16x16x32_bf16 v[240:243],a[144:147],v[104:107],v[240:243]
 v_mfma_f32_16x16x32_bf16 v[240:243],a[148:151],v[120:123],v[240:243]
 ds_read_b64_tr_b16 a[188:189],v15 offset:24576
 v_mfma_f32_16x16x32_bf16 v[248:251],a[148:151],v[124:127],v[248:251]
 ds_read_b64_tr_b16 a[190:191],v15 offset:28672
 v_mfma_f32_16x16x32_bf16 v[248:251],a[144:147],v[108:111],v[248:251]
 v_mfma_f32_16x16x32_bf16 v[252:255],a[152:155],v[108:111],v[252:255]
 v_mfma_f32_16x16x32_bf16 v[252:255],a[156:159],v[124:127],v[252:255]
 v_mfma_f32_16x16x32_bf16 v[244:247],a[156:159],v[120:123],v[244:247]
 s_mov_b64 exec,0
 s_bitcmp1_b32 s43,2
 s_cbranch_scc1 L_warm_m_go
 s_cmp_eq_u32 s3,0
 s_cbranch_scc1 L_stub_o_0
 s_cmp_eq_u32 s3,4096
 s_cbranch_scc1 L_stub_o_1
 s_cmp_eq_u32 s3,8192
 s_cbranch_scc1 L_stub_o_2
 s_branch L_stub_o_3
L_warm_m_go:
 s_cmp_eq_u32 s3,0
 s_cbranch_scc1 L_stub_m_0
 s_cmp_eq_u32 s3,4096
 s_cbranch_scc1 L_stub_m_1
 s_cmp_eq_u32 s3,8192
 s_cbranch_scc1 L_stub_m_2
 s_branch L_stub_m_3
L_warm_o_ret:
L_warm_m_ret:
 s_mov_b64 exec,-1
 v_mfma_f32_16x16x32_bf16 v[244:247],a[152:155],v[104:107],v[244:247]
 v_mfma_f32_16x16x32_bf16 v[236:239],a[152:155],v[100:103],v[236:239]
 v_mfma_f32_16x16x32_bf16 v[236:239],a[156:159],v[116:119],v[236:239]
 v_mfma_f32_16x16x32_bf16 v[228:231],a[156:159],v[112:115],v[228:231]
 v_mfma_f32_16x16x32_bf16 v[228:231],a[152:155],v[96:99],v[228:231]
 s_waitcnt vmcnt(33) lgkmcnt(0)
 s_barrier
 v_mfma_f32_16x16x32_bf16 v[128:131],a[160:163],v[96:99],v[128:131]
 s_add_u32 m0,s3,0
 ds_read_b64_tr_b16 a[128:129],v44 offset:32768
 s_lshl_b32 s48,s51,7
 v_mfma_f32_16x16x32_bf16 v[128:131],a[164:167],v[112:115],v[128:131]
 s_mov_b32 s41,0
 ds_read_b64_tr_b16 a[130:131],v44 offset:36864
 s_and_b32 s48,s48,s42
 v_mfma_f32_16x16x32_bf16 v[136:139],a[164:167],v[116:119],v[136:139]
 s_and_b32 s49,128,s42
 buffer_load_dwordx4 v32,s[8:11],s41 offen offset:0 lds
 v_mfma_f32_16x16x32_bf16 v[136:139],a[160:163],v[100:103],v[136:139]
 s_add_u32 s4,s54,s48
 s_addc_u32 s5,s55,0
 ds_read_b64_tr_b16 a[132:133],v44 offset:40960
 v_mfma_f32_16x16x32_bf16 v[144:147],a[160:163],v[104:107],v[144:147]
 s_mov_b32 s6,s49
 ds_read_b64_tr_b16 a[134:135],v44 offset:45056
 s_mov_b32 s7,0x20000
 v_mfma_f32_16x16x32_bf16 v[144:147],a[164:167],v[120:123],v[144:147]
 buffer_load_ushort v58,v62,s[4:7],0 offen offset:0
 v_mfma_f32_16x16x32_bf16 v[152:155],a[164:167],v[124:127],v[152:155]
 ds_read_b64_tr_b16 a[136:137],v8 offset:32768
 buffer_load_ushort v59,v62,s[4:7],0 offen offset:32
 v_mfma_f32_16x16x32_bf16 v[152:155],a[160:163],v[108:111],v[152:155]
 ds_read_b64_tr_b16 a[138:139],v8 offset:36864
 buffer_load_ushort v60,v62,s[4:7],0 offen offset:64
 v_mfma_f32_16x16x32_bf16 v[156:159],a[168:171],v[108:111],v[156:159]
 buffer_load_ushort v61,v62,s[4:7],0 offen offset:96
 v_mfma_f32_16x16x32_bf16 v[156:159],a[172:175],v[124:127],v[156:159]
 s_movk_i32 s48,128
 s_bitcmp1_b32 s43,2
 s_cmovk_i32 s48,0
 ds_read_b64_tr_b16 a[140:141],v8 offset:40960
 buffer_load_dwordx4 v33,s[8:11],s41 offen offset:1024 lds
 v_mfma_f32_16x16x32_bf16 v[148:151],a[172:175],v[120:123],v[148:151]
 ds_read_b64_tr_b16 a[142:143],v8 offset:45056
 v_xor_b32 v16,s48,v57
 v_mfma_f32_16x16x32_bf16 v[148:151],a[168:171],v[104:107],v[148:151]
 v_add_u32 v24,65536,v16
 v_mfma_f32_16x16x32_bf16 v[140:143],a[168:171],v[100:103],v[140:143]
 s_movk_i32 s48,136
 s_bitcmp1_b32 s43,2
 s_cmovk_i32 s48,32
 ds_read_b64_tr_b16 a[144:145],v8 offset:49152
 v_mfma_f32_16x16x32_bf16 v[140:143],a[172:175],v[116:119],v[140:143]
 ds_read_b64_tr_b16 a[146:147],v8 offset:53248
 v_xor_b32 v17,s48,v57
 v_mfma_f32_16x16x32_bf16 v[132:135],a[172:175],v[112:115],v[132:135]
 v_add_u32 v25,65536,v17
 v_mfma_f32_16x16x32_bf16 v[132:135],a[168:171],v[96:99],v[132:135]
 s_movk_i32 s48,64
 s_bitcmp1_b32 s43,2
 s_cmovk_i32 s48,64
 ds_read_b64_tr_b16 a[148:149],v8 offset:57344
 v_mfma_f32_16x16x32_bf16 v[160:163],a[176:179],v[96:99],v[160:163]
 ds_read_b64_tr_b16 a[150:151],v8 offset:61440
 v_xor_b32 v18,s48,v57
 v_mfma_f32_16x16x32_bf16 v[160:163],a[180:183],v[112:115],v[160:163]
 buffer_load_dwordx4 v34,s[8:11],s41 offen offset:2048 lds
 v_add_u32 v26,65536,v18
 v_mfma_f32_16x16x32_bf16 v[168:171],a[180:183],v[116:119],v[168:171]
 s_movk_i32 s48,72
 s_bitcmp1_b32 s43,2
 s_cmovk_i32 s48,96
 ds_read_b64_tr_b16 a[152:153],v44 offset:49152
 v_mfma_f32_16x16x32_bf16 v[168:171],a[176:179],v[100:103],v[168:171]
 ds_read_b64_tr_b16 a[154:155],v44 offset:53248
 v_xor_b32 v19,s48,v57
 v_mfma_f32_16x16x32_bf16 v[176:179],a[176:179],v[104:107],v[176:179]
 v_add_u32 v27,65536,v19
 v_mfma_f32_16x16x32_bf16 v[176:179],a[180:183],v[120:123],v[176:179]
 s_movk_i32 s48,192
 s_bitcmp1_b32 s43,2
 s_cmovk_i32 s48,128
 ds_read_b64_tr_b16 a[156:157],v44 offset:57344
 v_mfma_f32_16x16x32_bf16 v[184:187],a[180:183],v[124:127],v[184:187]
 ds_read_b64_tr_b16 a[158:159],v44 offset:61440
 v_xor_b32 v20,s48,v57
 v_mfma_f32_16x16x32_bf16 v[184:187],a[176:179],v[108:111],v[184:187]
 v_add_u32 v28,65536,v20
 v_mfma_f32_16x16x32_bf16 v[188:191],a[184:187],v[108:111],v[188:191]
 s_movk_i32 s48,200
 s_bitcmp1_b32 s43,2
 s_cmovk_i32 s48,160
 buffer_load_dwordx4 v35,s[8:11],s41 offen offset:3072 lds
 v_mfma_f32_16x16x32_bf16 v[188:191],a[188:191],v[124:127],v[188:191]
 v_xor_b32 v21,s48,v57
 v_add_u32 v29,65536,v21
 v_mfma_f32_16x16x32_bf16 v[180:183],a[188:191],v[120:123],v[180:183]
 s_movk_i32 s48,0
 s_bitcmp1_b32 s43,2
 s_cmovk_i32 s48,192
 v_mfma_f32_16x16x32_bf16 v[180:183],a[184:187],v[104:107],v[180:183]
 v_xor_b32 v22,s48,v57
 v_add_u32 v30,65536,v22
 v_mfma_f32_16x16x32_bf16 v[172:175],a[184:187],v[100:103],v[172:175]
 s_movk_i32 s48,8
 s_bitcmp1_b32 s43,2
 s_cmovk_i32 s48,224
 v_mfma_f32_16x16x32_bf16 v[172:175],a[188:191],v[116:119],v[172:175]
 v_xor_b32 v23,s48,v57
 v_add_u32 v31,65536,v23
 v_mfma_f32_16x16x32_bf16 v[164:167],a[188:191],v[112:115],v[164:167]
 v_mfma_f32_16x16x32_bf16 v[164:167],a[184:187],v[96:99],v[164:167]
 s_waitcnt vmcnt(9) lgkmcnt(0)
 v_mfma_f32_16x16x32_bf16 v[192:195],a[128:131],a[192:195],v[192:195]
 s_add_u32 m0,s3,65536
 ds_read_b64_tr_b16 a[160:161],v45 offset:32768
 v_mfma_f32_16x16x32_bf16 v[192:195],a[132:135],a[208:211],v[192:195]
 s_add_u32 s41,s41,s58
 ds_read_b64_tr_b16 a[162:163],v45 offset:36864
 v_mfma_f32_16x16x32_bf16 v[192:195],a[136:139],a[224:227],v[192:195]
 buffer_load_dwordx4 v32,s[8:11],s41 offen offset:0 lds
 v_mfma_f32_16x16x32_bf16 v[192:195],a[140:143],a[240:243],v[192:195]
 ds_read_b64_tr_b16 a[164:165],v45 offset:40960
 v_mfma_f32_16x16x32_bf16 v[192:195],a[144:147],a[64:67],v[192:195]
 ds_read_b64_tr_b16 a[166:167],v45 offset:45056
 v_mfma_f32_16x16x32_bf16 v[192:195],a[148:151],a[80:83],v[192:195]
 v_mfma_f32_16x16x32_bf16 v[192:195],a[152:155],a[96:99],v[192:195]
 ds_read_b64_tr_b16 a[168:169],v9 offset:32768
 v_mfma_f32_16x16x32_bf16 v[192:195],a[156:159],a[112:115],v[192:195]
 ds_read_b64_tr_b16 a[170:171],v9 offset:36864
 v_mfma_f32_16x16x32_bf16 v[200:203],a[156:159],a[116:119],v[200:203]
 v_mfma_f32_16x16x32_bf16 v[200:203],a[152:155],a[100:103],v[200:203]
 ds_read_b64_tr_b16 a[172:173],v9 offset:40960
 buffer_load_dwordx4 v33,s[8:11],s41 offen offset:1024 lds
 v_mfma_f32_16x16x32_bf16 v[200:203],a[148:151],a[84:87],v[200:203]
 ds_read_b64_tr_b16 a[174:175],v9 offset:45056
 v_mfma_f32_16x16x32_bf16 v[200:203],a[144:147],a[68:71],v[200:203]
 v_mfma_f32_16x16x32_bf16 v[200:203],a[140:143],a[244:247],v[200:203]
 ds_read_b64_tr_b16 a[176:177],v9 offset:49152
 v_mfma_f32_16x16x32_bf16 v[200:203],a[136:139],a[228:231],v[200:203]
 ds_read_b64_tr_b16 a[178:179],v9 offset:53248
 v_mfma_f32_16x16x32_bf16 v[200:203],a[132:135],a[212:215],v[200:203]
 v_mfma_f32_16x16x32_bf16 v[200:203],a[128:131],a[196:199],v[200:203]
 ds_read_b64_tr_b16 a[180:181],v9 offset:57344
 v_mfma_f32_16x16x32_bf16 v[208:211],a[128:131],a[200:203],v[208:211]
 ds_read_b64_tr_b16 a[182:183],v9 offset:61440
 v_mfma_f32_16x16x32_bf16 v[208:211],a[132:135],a[216:219],v[208:211]
 buffer_load_dwordx4 v34,s[8:11],s41 offen offset:2048 lds
 v_mfma_f32_16x16x32_bf16 v[208:211],a[136:139],a[232:235],v[208:211]
 ds_read_b64_tr_b16 a[184:185],v45 offset:49152
 v_mfma_f32_16x16x32_bf16 v[208:211],a[140:143],a[248:251],v[208:211]
 ds_read_b64_tr_b16 a[186:187],v45 offset:53248
 v_mfma_f32_16x16x32_bf16 v[208:211],a[144:147],a[72:75],v[208:211]
 v_mfma_f32_16x16x32_bf16 v[208:211],a[148:151],a[88:91],v[208:211]
 ds_read_b64_tr_b16 a[188:189],v45 offset:57344
 v_mfma_f32_16x16x32_bf16 v[208:211],a[152:155],a[104:107],v[208:211]
 ds_read_b64_tr_b16 a[190:191],v45 offset:61440
 v_mfma_f32_16x16x32_bf16 v[208:211],a[156:159],a[120:123],v[208:211]
 v_mfma_f32_16x16x32_bf16 v[216:219],a[156:159],a[124:127],v[216:219]
 buffer_load_dwordx4 v35,s[8:11],s41 offen offset:3072 lds
 v_mfma_f32_16x16x32_bf16 v[216:219],a[152:155],a[108:111],v[216:219]
 v_mfma_f32_16x16x32_bf16 v[216:219],a[148:151],a[92:95],v[216:219]
 v_mfma_f32_16x16x32_bf16 v[216:219],a[144:147],a[76:79],v[216:219]
 v_mfma_f32_16x16x32_bf16 v[216:219],a[140:143],a[252:255],v[216:219]
 v_mfma_f32_16x16x32_bf16 v[216:219],a[136:139],a[236:239],v[216:219]
 v_mfma_f32_16x16x32_bf16 v[216:219],a[132:135],a[220:223],v[216:219]
 v_mfma_f32_16x16x32_bf16 v[216:219],a[128:131],a[204:207],v[216:219]
 s_waitcnt lgkmcnt(0)
 v_mfma_f32_16x16x32_bf16 v[196:199],a[160:163],a[192:195],v[196:199]
 s_add_u32 m0,s3,16384
 ds_read_b64_tr_b16 a[128:129],v46 offset:32768
 v_mfma_f32_16x16x32_bf16 v[196:199],a[164:167],a[208:211],v[196:199]
 s_add_u32 s41,s41,s58
 ds_read_b64_tr_b16 a[130:131],v46 offset:36864
 v_mfma_f32_16x16x32_bf16 v[196:199],a[168:171],a[224:227],v[196:199]
 buffer_load_dwordx4 v32,s[8:11],s41 offen offset:0 lds
 v_mfma_f32_16x16x32_bf16 v[196:199],a[172:175],a[240:243],v[196:199]
 ds_read_b64_tr_b16 a[132:133],v46 offset:40960
 v_mfma_f32_16x16x32_bf16 v[196:199],a[176:179],a[64:67],v[196:199]
 ds_read_b64_tr_b16 a[134:135],v46 offset:45056
 v_mfma_f32_16x16x32_bf16 v[196:199],a[180:183],a[80:83],v[196:199]
 buffer_load_dwordx4 v33,s[8:11],s41 offen offset:1024 lds
 v_mfma_f32_16x16x32_bf16 v[196:199],a[184:187],a[96:99],v[196:199]
 ds_read_b64_tr_b16 a[136:137],v10 offset:32768
 v_mfma_f32_16x16x32_bf16 v[196:199],a[188:191],a[112:115],v[196:199]
 ds_read_b64_tr_b16 a[138:139],v10 offset:36864
 v_mfma_f32_16x16x32_bf16 v[204:207],a[188:191],a[116:119],v[204:207]
 v_mfma_f32_16x16x32_bf16 v[204:207],a[184:187],a[100:103],v[204:207]
 ds_read_b64_tr_b16 a[140:141],v10 offset:40960
 buffer_load_dwordx4 v34,s[8:11],s41 offen offset:2048 lds
 v_mfma_f32_16x16x32_bf16 v[204:207],a[180:183],a[84:87],v[204:207]
 ds_read_b64_tr_b16 a[142:143],v10 offset:45056
 v_mfma_f32_16x16x32_bf16 v[204:207],a[176:179],a[68:71],v[204:207]
 v_mfma_f32_16x16x32_bf16 v[204:207],a[172:175],a[244:247],v[204:207]
 ds_read_b64_tr_b16 a[144:145],v10 offset:49152
 v_mfma_f32_16x16x32_bf16 v[204:207],a[168:171],a[228:231],v[204:207]
 ds_read_b64_tr_b16 a[146:147],v10 offset:53248
 buffer_load_dwordx4 v35,s[8:11],s41 offen offset:3072 lds
 v_mfma_f32_16x16x32_bf16 v[204:207],a[164:167],a[212:215],v[204:207]
 v_mfma_f32_16x16x32_bf16 v[204:207],a[160:163],a[196:199],v[204:207]
 s_add_u32 m0,s3,81920
 ds_read_b64_tr_b16 a[148:149],v10 offset:57344
 v_mfma_f32_16x16x32_bf16 v[212:215],a[160:163],a[200:203],v[212:215]
 s_add_u32 s41,s41,s58
 ds_read_b64_tr_b16 a[150:151],v10 offset:61440
 v_mfma_f32_16x16x32_bf16 v[212:215],a[164:167],a[216:219],v[212:215]
 buffer_load_dwordx4 v32,s[8:11],s41 offen offset:0 lds
 v_mfma_f32_16x16x32_bf16 v[212:215],a[168:171],a[232:235],v[212:215]
 ds_read_b64_tr_b16 a[152:153],v46 offset:49152
 v_mfma_f32_16x16x32_bf16 v[212:215],a[172:175],a[248:251],v[212:215]
 ds_read_b64_tr_b16 a[154:155],v46 offset:53248
 v_mfma_f32_16x16x32_bf16 v[212:215],a[176:179],a[72:75],v[212:215]
 buffer_load_dwordx4 v33,s[8:11],s41 offen offset:1024 lds
 v_mfma_f32_16x16x32_bf16 v[212:215],a[180:183],a[88:91],v[212:215]
 ds_read_b64_tr_b16 a[156:157],v46 offset:57344
 v_mfma_f32_16x16x32_bf16 v[212:215],a[184:187],a[104:107],v[212:215]
 ds_read_b64_tr_b16 a[158:159],v46 offset:61440
 v_mfma_f32_16x16x32_bf16 v[212:215],a[188:191],a[120:123],v[212:215]
 v_mfma_f32_16x16x32_bf16 v[220:223],a[188:191],a[124:127],v[220:223]
 buffer_load_dwordx4 v34,s[8:11],s41 offen offset:2048 lds
 s_waitcnt vmcnt(19)
 v_mfma_f32_16x16x32_bf16 v[220:223],a[184:187],a[108:111],v[220:223]
 v_cmp_eq_u32 vcc,0,v53
 v_mfma_f32_16x16x32_bf16 v[220:223],a[180:183],a[92:95],v[220:223]
 v_mfma_f32_16x16x32_bf16 v[220:223],a[176:179],a[76:79],v[220:223]
 v_mfma_f32_16x16x32_bf16 v[220:223],a[172:175],a[252:255],v[220:223]
 buffer_load_dwordx4 v35,s[8:11],s41 offen offset:3072 lds
 v_mfma_f32_16x16x32_bf16 v[220:223],a[168:171],a[236:239],v[220:223]
 s_cmp_lg_u64 vcc,0
 s_cbranch_scc1 L_spin_o
L_spin_o_ret:
 v_mfma_f32_16x16x32_bf16 v[220:223],a[164:167],a[220:223],v[220:223]
 v_mfma_f32_16x16x32_bf16 v[220:223],a[160:163],a[204:207],v[220:223]
 s_waitcnt lgkmcnt(0)
 v_mfma_f32_16x16x32_bf16 v[224:227],a[128:131],a[192:195],v[224:227]
 ds_read_b64_tr_b16 a[160:161],v47 offset:32768
 v_cvt_pk_bf16_f32 v96,v192,v193
 v_mfma_f32_16x16x32_bf16 v[224:227],a[132:135],a[208:211],v[224:227]
 s_mov_b32 s40,0
 ds_read_b64_tr_b16 a[162:163],v47 offset:36864
 v_cvt_pk_bf16_f32 v97,v194,v195
 v_mfma_f32_16x16x32_bf16 v[224:227],a[136:139],a[224:227],v[224:227]
 buffer_load_dwordx4 a[0:3],v1,s[60:63],s40 offen offset:0 sc1
 v_cvt_pk_bf16_f32 v98,v196,v197
 v_mfma_f32_16x16x32_bf16 v[224:227],a[140:143],a[240:243],v[224:227]
 ds_read_b64_tr_b16 a[164:165],v47 offset:40960
 v_cvt_pk_bf16_f32 v99,v198,v199
 v_mfma_f32_16x16x32_bf16 v[224:227],a[144:147],a[64:67],v[224:227]
 ds_read_b64_tr_b16 a[166:167],v47 offset:45056
 v_min_u32 v96,-2,v96
 v_mfma_f32_16x16x32_bf16 v[224:227],a[148:151],a[80:83],v[224:227]
 v_min_u32 v97,-2,v97
 v_min_u32 v98,-2,v98
 v_mfma_f32_16x16x32_bf16 v[224:227],a[152:155],a[96:99],v[224:227]
 ds_read_b64_tr_b16 a[168:169],v11 offset:32768
 v_min_u32 v99,-2,v99
 v_mfma_f32_16x16x32_bf16 v[224:227],a[156:159],a[112:115],v[224:227]
 s_add_u32 s19,s18,0
 ds_read_b64_tr_b16 a[170:171],v11 offset:36864
 buffer_store_dwordx4 v[96:99],v1,s[20:23],s19 offen offset:0 sc1
 v_mfma_f32_16x16x32_bf16 v[232:235],a[156:159],a[116:119],v[232:235]
 v_mfma_f32_16x16x32_bf16 v[232:235],a[152:155],a[100:103],v[232:235]
 ds_read_b64_tr_b16 a[172:173],v11 offset:40960
 buffer_load_dwordx4 a[4:7],v1,s[60:63],s40 offen offset:1024 sc1
 v_mfma_f32_16x16x32_bf16 v[232:235],a[148:151],a[84:87],v[232:235]
 ds_read_b64_tr_b16 a[174:175],v11 offset:45056
 v_mfma_f32_16x16x32_bf16 v[232:235],a[144:147],a[68:71],v[232:235]
 v_mfma_f32_16x16x32_bf16 v[232:235],a[140:143],a[244:247],v[232:235]
 ds_read_b64_tr_b16 a[176:177],v11 offset:49152
 v_mfma_f32_16x16x32_bf16 v[232:235],a[136:139],a[228:231],v[232:235]
 ds_read_b64_tr_b16 a[178:179],v11 offset:53248
 v_mfma_f32_16x16x32_bf16 v[232:235],a[132:135],a[212:215],v[232:235]
 v_mfma_f32_16x16x32_bf16 v[232:235],a[128:131],a[196:199],v[232:235]
 ds_read_b64_tr_b16 a[180:181],v11 offset:57344
 v_mfma_f32_16x16x32_bf16 v[240:243],a[128:131],a[200:203],v[240:243]
 ds_read_b64_tr_b16 a[182:183],v11 offset:61440
 v_cvt_pk_bf16_f32 v100,v200,v201
 v_mfma_f32_16x16x32_bf16 v[240:243],a[132:135],a[216:219],v[240:243]
 buffer_load_dwordx4 a[16:19],v1,s[60:63],s40 offen offset:2048 sc1
 v_cvt_pk_bf16_f32 v101,v202,v203
 v_mfma_f32_16x16x32_bf16 v[240:243],a[136:139],a[232:235],v[240:243]
 ds_read_b64_tr_b16 a[184:185],v47 offset:49152
 v_cvt_pk_bf16_f32 v102,v204,v205
 v_mfma_f32_16x16x32_bf16 v[240:243],a[140:143],a[248:251],v[240:243]
 ds_read_b64_tr_b16 a[186:187],v47 offset:53248
 v_cvt_pk_bf16_f32 v103,v206,v207
 v_mfma_f32_16x16x32_bf16 v[240:243],a[144:147],a[72:75],v[240:243]
 v_min_u32 v100,-2,v100
 v_min_u32 v101,-2,v101
 v_mfma_f32_16x16x32_bf16 v[240:243],a[148:151],a[88:91],v[240:243]
 ds_read_b64_tr_b16 a[188:189],v47 offset:57344
 v_min_u32 v102,-2,v102
 v_mfma_f32_16x16x32_bf16 v[240:243],a[152:155],a[104:107],v[240:243]
 ds_read_b64_tr_b16 a[190:191],v47 offset:61440
 v_min_u32 v103,-2,v103
 v_mfma_f32_16x16x32_bf16 v[240:243],a[156:159],a[120:123],v[240:243]
 s_add_u32 s19,s18,0
 buffer_store_dwordx4 v[100:103],v1,s[20:23],s19 offen offset:1024 sc1
 v_mfma_f32_16x16x32_bf16 v[248:251],a[156:159],a[124:127],v[248:251]
 buffer_load_dwordx4 a[20:23],v1,s[60:63],s40 offen offset:3072 sc1
 v_mfma_f32_16x16x32_bf16 v[248:251],a[152:155],a[108:111],v[248:251]
 v_mfma_f32_16x16x32_bf16 v[248:251],a[148:151],a[92:95],v[248:251]
 v_mfma_f32_16x16x32_bf16 v[248:251],a[144:147],a[76:79],v[248:251]
 v_mfma_f32_16x16x32_bf16 v[248:251],a[140:143],a[252:255],v[248:251]
 v_mfma_f32_16x16x32_bf16 v[248:251],a[136:139],a[236:239],v[248:251]
 v_mfma_f32_16x16x32_bf16 v[248:251],a[132:135],a[220:223],v[248:251]
 v_mfma_f32_16x16x32_bf16 v[248:251],a[128:131],a[204:207],v[248:251]
 s_waitcnt lgkmcnt(0)
 v_mfma_f32_16x16x32_bf16 v[228:231],a[160:163],a[192:195],v[228:231]
 ds_read_b64_tr_b16 a[128:129],v48 offset:32768
 v_cvt_pk_bf16_f32 v96,v208,v209
 v_mfma_f32_16x16x32_bf16 v[228:231],a[164:167],a[208:211],v[228:231]
 s_mov_b32 s59,262144
 ds_read_b64_tr_b16 a[130:131],v48 offset:36864
 v_cvt_pk_bf16_f32 v97,v210,v211
 v_mfma_f32_16x16x32_bf16 v[228:231],a[168:171],a[224:227],v[228:231]
 buffer_load_dwordx4 a[8:11],v1,s[60:63],s59 offen offset:0 sc1
 v_cvt_pk_bf16_f32 v98,v212,v213
 v_mfma_f32_16x16x32_bf16 v[228:231],a[172:175],a[240:243],v[228:231]
 ds_read_b64_tr_b16 a[132:133],v48 offset:40960
 v_cvt_pk_bf16_f32 v99,v214,v215
 v_mfma_f32_16x16x32_bf16 v[228:231],a[176:179],a[64:67],v[228:231]
 ds_read_b64_tr_b16 a[134:135],v48 offset:45056
 v_min_u32 v96,-2,v96
 v_mfma_f32_16x16x32_bf16 v[228:231],a[180:183],a[80:83],v[228:231]
 v_min_u32 v97,-2,v97
 v_min_u32 v98,-2,v98
 v_mfma_f32_16x16x32_bf16 v[228:231],a[184:187],a[96:99],v[228:231]
 ds_read_b64_tr_b16 a[136:137],v12 offset:32768
 v_min_u32 v99,-2,v99
 v_mfma_f32_16x16x32_bf16 v[228:231],a[188:191],a[112:115],v[228:231]
 s_add_u32 s19,s18,0
 ds_read_b64_tr_b16 a[138:139],v12 offset:36864
 buffer_store_dwordx4 v[96:99],v1,s[20:23],s19 offen offset:2048 sc1
 v_mfma_f32_16x16x32_bf16 v[236:239],a[188:191],a[116:119],v[236:239]
 v_mfma_f32_16x16x32_bf16 v[236:239],a[184:187],a[100:103],v[236:239]
 ds_read_b64_tr_b16 a[140:141],v12 offset:40960
 buffer_load_dwordx4 a[12:15],v1,s[60:63],s59 offen offset:1024 sc1
 v_mfma_f32_16x16x32_bf16 v[236:239],a[180:183],a[84:87],v[236:239]
 ds_read_b64_tr_b16 a[142:143],v12 offset:45056
 v_mfma_f32_16x16x32_bf16 v[236:239],a[176:179],a[68:71],v[236:239]
 v_mfma_f32_16x16x32_bf16 v[236:239],a[172:175],a[244:247],v[236:239]
 ds_read_b64_tr_b16 a[144:145],v12 offset:49152
 v_mfma_f32_16x16x32_bf16 v[236:239],a[168:171],a[228:231],v[236:239]
 ds_read_b64_tr_b16 a[146:147],v12 offset:53248
 v_mfma_f32_16x16x32_bf16 v[236:239],a[164:167],a[212:215],v[236:239]
 v_mfma_f32_16x16x32_bf16 v[236:239],a[160:163],a[196:199],v[236:239]
 ds_read_b64_tr_b16 a[148:149],v12 offset:57344
 v_mfma_f32_16x16x32_bf16 v[244:247],a[160:163],a[200:203],v[244:247]
 ds_read_b64_tr_b16 a[150:151],v12 offset:61440
 v_cvt_pk_bf16_f32 v100,v216,v217
 v_mfma_f32_16x16x32_bf16 v[244:247],a[164:167],a[216:219],v[244:247]
 buffer_load_dwordx4 a[24:27],v1,s[60:63],s59 offen offset:2048 sc1
 v_cvt_pk_bf16_f32 v101,v218,v219
 v_mfma_f32_16x16x32_bf16 v[244:247],a[168:171],a[232:235],v[244:247]
 ds_read_b64_tr_b16 a[152:153],v48 offset:49152
 v_cvt_pk_bf16_f32 v102,v220,v221
 v_mfma_f32_16x16x32_bf16 v[244:247],a[172:175],a[248:251],v[244:247]
 ds_read_b64_tr_b16 a[154:155],v48 offset:53248
 v_cvt_pk_bf16_f32 v103,v222,v223
 v_mfma_f32_16x16x32_bf16 v[244:247],a[176:179],a[72:75],v[244:247]
 v_min_u32 v100,-2,v100
 v_min_u32 v101,-2,v101
 v_mfma_f32_16x16x32_bf16 v[244:247],a[180:183],a[88:91],v[244:247]
 ds_read_b64_tr_b16 a[156:157],v48 offset:57344
 v_min_u32 v102,-2,v102
 v_mfma_f32_16x16x32_bf16 v[244:247],a[184:187],a[104:107],v[244:247]
 ds_read_b64_tr_b16 a[158:159],v48 offset:61440
 v_min_u32 v103,-2,v103
 v_mfma_f32_16x16x32_bf16 v[244:247],a[188:191],a[120:123],v[244:247]
 s_add_u32 s19,s18,0
 buffer_store_dwordx4 v[100:103],v1,s[20:23],s19 offen offset:3072 sc1
 v_mfma_f32_16x16x32_bf16 v[252:255],a[188:191],a[124:127],v[252:255]
 buffer_load_dwordx4 a[28:31],v1,s[60:63],s59 offen offset:3072 sc1
 v_mfma_f32_16x16x32_bf16 v[252:255],a[184:187],a[108:111],v[252:255]
 v_mfma_f32_16x16x32_bf16 v[252:255],a[180:183],a[92:95],v[252:255]
 v_mfma_f32_16x16x32_bf16 v[252:255],a[176:179],a[76:79],v[252:255]
 v_mfma_f32_16x16x32_bf16 v[252:255],a[172:175],a[252:255],v[252:255]
 v_mfma_f32_16x16x32_bf16 v[252:255],a[168:171],a[236:239],v[252:255]
 v_mfma_f32_16x16x32_bf16 v[252:255],a[164:167],a[220:223],v[252:255]
 v_mfma_f32_16x16x32_bf16 v[252:255],a[160:163],a[204:207],v[252:255]
 s_waitcnt lgkmcnt(0)
 v_mfma_f32_16x16x32_bf16 v[128:131],a[128:131],a[192:195],v[128:131]
 ds_read_b64_tr_b16 a[160:161],v49 offset:32768
 v_cvt_pk_bf16_f32 v96,v224,v225
 v_mfma_f32_16x16x32_bf16 v[128:131],a[132:135],a[208:211],v[128:131]
 s_mov_b32 s40,4096
 ds_read_b64_tr_b16 a[162:163],v49 offset:36864
 v_cvt_pk_bf16_f32 v97,v226,v227
 v_mfma_f32_16x16x32_bf16 v[128:131],a[136:139],a[224:227],v[128:131]
 buffer_load_dwordx4 a[32:35],v1,s[60:63],s40 offen offset:0 sc1
 v_cvt_pk_bf16_f32 v98,v228,v229
 v_mfma_f32_16x16x32_bf16 v[128:131],a[140:143],a[240:243],v[128:131]
 ds_read_b64_tr_b16 a[164:165],v49 offset:40960
 v_cvt_pk_bf16_f32 v99,v230,v231
 v_mfma_f32_16x16x32_bf16 v[128:131],a[144:147],a[64:67],v[128:131]
 ds_read_b64_tr_b16 a[166:167],v49 offset:45056
 v_min_u32 v96,-2,v96
 v_mfma_f32_16x16x32_bf16 v[128:131],a[148:151],a[80:83],v[128:131]
 v_min_u32 v97,-2,v97
 v_min_u32 v98,-2,v98
 v_mfma_f32_16x16x32_bf16 v[128:131],a[152:155],a[96:99],v[128:131]
 ds_read_b64_tr_b16 a[168:169],v13 offset:32768
 v_min_u32 v99,-2,v99
 v_mfma_f32_16x16x32_bf16 v[128:131],a[156:159],a[112:115],v[128:131]
 s_add_u32 s19,s18,4096
 ds_read_b64_tr_b16 a[170:171],v13 offset:36864
 buffer_store_dwordx4 v[96:99],v1,s[20:23],s19 offen offset:0 sc1
 v_mfma_f32_16x16x32_bf16 v[136:139],a[156:159],a[116:119],v[136:139]
 v_mfma_f32_16x16x32_bf16 v[136:139],a[152:155],a[100:103],v[136:139]
 ds_read_b64_tr_b16 a[172:173],v13 offset:40960
 buffer_load_dwordx4 a[36:39],v1,s[60:63],s40 offen offset:1024 sc1
 v_mfma_f32_16x16x32_bf16 v[136:139],a[148:151],a[84:87],v[136:139]
 ds_read_b64_tr_b16 a[174:175],v13 offset:45056
 v_mfma_f32_16x16x32_bf16 v[136:139],a[144:147],a[68:71],v[136:139]
 v_mfma_f32_16x16x32_bf16 v[136:139],a[140:143],a[244:247],v[136:139]
 ds_read_b64_tr_b16 a[176:177],v13 offset:49152
 v_mfma_f32_16x16x32_bf16 v[136:139],a[136:139],a[228:231],v[136:139]
 ds_read_b64_tr_b16 a[178:179],v13 offset:53248
 v_mfma_f32_16x16x32_bf16 v[136:139],a[132:135],a[212:215],v[136:139]
 v_mfma_f32_16x16x32_bf16 v[136:139],a[128:131],a[196:199],v[136:139]
 ds_read_b64_tr_b16 a[180:181],v13 offset:57344
 v_mfma_f32_16x16x32_bf16 v[144:147],a[128:131],a[200:203],v[144:147]
 ds_read_b64_tr_b16 a[182:183],v13 offset:61440
 v_cvt_pk_bf16_f32 v100,v232,v233
 v_mfma_f32_16x16x32_bf16 v[144:147],a[132:135],a[216:219],v[144:147]
 buffer_load_dwordx4 a[48:51],v1,s[60:63],s40 offen offset:2048 sc1
 v_cvt_pk_bf16_f32 v101,v234,v235
 v_mfma_f32_16x16x32_bf16 v[144:147],a[136:139],a[232:235],v[144:147]
 ds_read_b64_tr_b16 a[184:185],v49 offset:49152
 v_cvt_pk_bf16_f32 v102,v236,v237
 v_mfma_f32_16x16x32_bf16 v[144:147],a[140:143],a[248:251],v[144:147]
 ds_read_b64_tr_b16 a[186:187],v49 offset:53248
 v_cvt_pk_bf16_f32 v103,v238,v239
 v_mfma_f32_16x16x32_bf16 v[144:147],a[144:147],a[72:75],v[144:147]
 v_min_u32 v100,-2,v100
 v_min_u32 v101,-2,v101
 v_mfma_f32_16x16x32_bf16 v[144:147],a[148:151],a[88:91],v[144:147]
 ds_read_b64_tr_b16 a[188:189],v49 offset:57344
 v_min_u32 v102,-2,v102
 v_mfma_f32_16x16x32_bf16 v[144:147],a[152:155],a[104:107],v[144:147]
 ds_read_b64_tr_b16 a[190:191],v49 offset:61440
 v_min_u32 v103,-2,v103
 v_mfma_f32_16x16x32_bf16 v[144:147],a[156:159],a[120:123],v[144:147]
 s_add_u32 s19,s18,4096
 buffer_store_dwordx4 v[100:103],v1,s[20:23],s19 offen offset:1024 sc1
 v_mfma_f32_16x16x32_bf16 v[152:155],a[156:159],a[124:127],v[152:155]
 buffer_load_dwordx4 a[52:55],v1,s[60:63],s40 offen offset:3072 sc1
 v_mfma_f32_16x16x32_bf16 v[152:155],a[152:155],a[108:111],v[152:155]
 v_mfma_f32_16x16x32_bf16 v[152:155],a[148:151],a[92:95],v[152:155]
 v_mfma_f32_16x16x32_bf16 v[152:155],a[144:147],a[76:79],v[152:155]
 v_mfma_f32_16x16x32_bf16 v[152:155],a[140:143],a[252:255],v[152:155]
 v_mfma_f32_16x16x32_bf16 v[152:155],a[136:139],a[236:239],v[152:155]
 v_mfma_f32_16x16x32_bf16 v[152:155],a[132:135],a[220:223],v[152:155]
 v_mfma_f32_16x16x32_bf16 v[152:155],a[128:131],a[204:207],v[152:155]
 s_waitcnt lgkmcnt(0)
 v_mfma_f32_16x16x32_bf16 v[132:135],a[160:163],a[192:195],v[132:135]
 ds_read_b64_tr_b16 a[128:129],v50 offset:32768
 v_cvt_pk_bf16_f32 v96,v240,v241
 v_mfma_f32_16x16x32_bf16 v[132:135],a[164:167],a[208:211],v[132:135]
 s_mov_b32 s59,266240
 ds_read_b64_tr_b16 a[130:131],v50 offset:36864
 v_cvt_pk_bf16_f32 v97,v242,v243
 v_mfma_f32_16x16x32_bf16 v[132:135],a[168:171],a[224:227],v[132:135]
 buffer_load_dwordx4 a[40:43],v1,s[60:63],s59 offen offset:0 sc1
 v_cvt_pk_bf16_f32 v98,v244,v245
 v_mfma_f32_16x16x32_bf16 v[132:135],a[172:175],a[240:243],v[132:135]
 ds_read_b64_tr_b16 a[132:133],v50 offset:40960
 v_cvt_pk_bf16_f32 v99,v246,v247
 v_mfma_f32_16x16x32_bf16 v[132:135],a[176:179],a[64:67],v[132:135]
 ds_read_b64_tr_b16 a[134:135],v50 offset:45056
 v_min_u32 v96,-2,v96
 v_mfma_f32_16x16x32_bf16 v[132:135],a[180:183],a[80:83],v[132:135]
 v_min_u32 v97,-2,v97
 v_min_u32 v98,-2,v98
 v_mfma_f32_16x16x32_bf16 v[132:135],a[184:187],a[96:99],v[132:135]
 ds_read_b64_tr_b16 a[136:137],v14 offset:32768
 v_min_u32 v99,-2,v99
 v_mfma_f32_16x16x32_bf16 v[132:135],a[188:191],a[112:115],v[132:135]
 s_add_u32 s19,s18,4096
 ds_read_b64_tr_b16 a[138:139],v14 offset:36864
 buffer_store_dwordx4 v[96:99],v1,s[20:23],s19 offen offset:2048 sc1
 v_mfma_f32_16x16x32_bf16 v[140:143],a[188:191],a[116:119],v[140:143]
 v_mfma_f32_16x16x32_bf16 v[140:143],a[184:187],a[100:103],v[140:143]
 ds_read_b64_tr_b16 a[140:141],v14 offset:40960
 buffer_load_dwordx4 a[44:47],v1,s[60:63],s59 offen offset:1024 sc1
 v_mfma_f32_16x16x32_bf16 v[140:143],a[180:183],a[84:87],v[140:143]
 ds_read_b64_tr_b16 a[142:143],v14 offset:45056
 v_mfma_f32_16x16x32_bf16 v[140:143],a[176:179],a[68:71],v[140:143]
 v_mfma_f32_16x16x32_bf16 v[140:143],a[172:175],a[244:247],v[140:143]
 ds_read_b64_tr_b16 a[144:145],v14 offset:49152
 v_mfma_f32_16x16x32_bf16 v[140:143],a[168:171],a[228:231],v[140:143]
 ds_read_b64_tr_b16 a[146:147],v14 offset:53248
 v_mfma_f32_16x16x32_bf16 v[140:143],a[164:167],a[212:215],v[140:143]
 v_mfma_f32_16x16x32_bf16 v[140:143],a[160:163],a[196:199],v[140:143]
 ds_read_b64_tr_b16 a[148:149],v14 offset:57344
 v_mfma_f32_16x16x32_bf16 v[148:151],a[160:163],a[200:203],v[148:151]
 ds_read_b64_tr_b16 a[150:151],v14 offset:61440
 v_cvt_pk_bf16_f32 v100,v248,v249
 v_mfma_f32_16x16x32_bf16 v[148:151],a[164:167],a[216:219],v[148:151]
 buffer_load_dwordx4 a[56:59],v1,s[60:63],s59 offen offset:2048 sc1
 v_cvt_pk_bf16_f32 v101,v250,v251
 v_mfma_f32_16x16x32_bf16 v[148:151],a[168:171],a[232:235],v[148:151]
 ds_read_b64_tr_b16 a[152:153],v50 offset:49152
 v_cvt_pk_bf16_f32 v102,v252,v253
 v_mfma_f32_16x16x32_bf16 v[148:151],a[172:175],a[248:251],v[148:151]
 ds_read_b64_tr_b16 a[154:155],v50 offset:53248
 v_cvt_pk_bf16_f32 v103,v254,v255
 v_mfma_f32_16x16x32_bf16 v[148:151],a[176:179],a[72:75],v[148:151]
 v_min_u32 v100,-2,v100
 v_min_u32 v101,-2,v101
 v_mfma_f32_16x16x32_bf16 v[148:151],a[180:183],a[88:91],v[148:151]
 ds_read_b64_tr_b16 a[156:157],v50 offset:57344
 v_min_u32 v102,-2,v102
 v_mfma_f32_16x16x32_bf16 v[148:151],a[184:187],a[104:107],v[148:151]
 ds_read_b64_tr_b16 a[158:159],v50 offset:61440
 v_min_u32 v103,-2,v103
 v_mfma_f32_16x16x32_bf16 v[148:151],a[188:191],a[120:123],v[148:151]
 s_add_u32 s19,s18,4096
 buffer_store_dwordx4 v[100:103],v1,s[20:23],s19 offen offset:3072 sc1
 v_mfma_f32_16x16x32_bf16 v[156:159],a[188:191],a[124:127],v[156:159]
 buffer_load_dwordx4 a[60:63],v1,s[60:63],s59 offen offset:3072 sc1
 v_mfma_f32_16x16x32_bf16 v[156:159],a[184:187],a[108:111],v[156:159]
 v_mfma_f32_16x16x32_bf16 v[156:159],a[180:183],a[92:95],v[156:159]
 v_mfma_f32_16x16x32_bf16 v[156:159],a[176:179],a[76:79],v[156:159]
 v_mfma_f32_16x16x32_bf16 v[156:159],a[172:175],a[252:255],v[156:159]
 v_mfma_f32_16x16x32_bf16 v[156:159],a[168:171],a[236:239],v[156:159]
 v_mfma_f32_16x16x32_bf16 v[156:159],a[164:167],a[220:223],v[156:159]
 v_mfma_f32_16x16x32_bf16 v[156:159],a[160:163],a[204:207],v[156:159]
 s_waitcnt lgkmcnt(0)
 v_mfma_f32_16x16x32_bf16 v[160:163],a[128:131],a[192:195],v[160:163]
 s_lshl_b32 s76,s47,1
 ds_read_b64_tr_b16 a[160:161],v51 offset:32768
 s_add_u32 s76,s76,s100
 v_mfma_f32_16x16x32_bf16 v[160:163],a[132:135],a[208:211],v[160:163]
 s_add_u32 s19,s17,0
 ds_read_b64_tr_b16 a[162:163],v51 offset:36864
 s_lshl_b32 s76,s76,7
 v_mfma_f32_16x16x32_bf16 v[160:163],a[136:139],a[224:227],v[160:163]
 s_add_u32 s76,s76,4096
 buffer_load_dwordx4 v[64:67],v1,s[20:23],s19 offen offset:0 sc1
 v_and_b32 v54,0x7c,v54
 v_mfma_f32_16x16x32_bf16 v[160:163],a[140:143],a[240:243],v[160:163]
 ds_read_b64_tr_b16 a[164:165],v51 offset:40960
 v_min_u32 v63,24,v54
 v_mfma_f32_16x16x32_bf16 v[160:163],a[144:147],a[64:67],v[160:163]
 ds_read_b64_tr_b16 a[166:167],v51 offset:45056
 v_min_u32 v54,108,v54
 v_mfma_f32_16x16x32_bf16 v[160:163],a[148:151],a[80:83],v[160:163]
 s_mov_b32 s48,0xbfb8aa3b
 s_waitcnt vmcnt(40)
 v_lshlrev_b32 v58,16,v58
 v_mfma_f32_16x16x32_bf16 v[160:163],a[152:155],a[96:99],v[160:163]
 ds_read_b64_tr_b16 a[168:169],v15 offset:32768
 v_mul_f32 v228,s48,v58
 v_mfma_f32_16x16x32_bf16 v[160:163],a[156:159],a[112:115],v[160:163]
 ds_read_b64_tr_b16 a[170:171],v15 offset:36864
 v_mul_f32 v229,s48,v58
 v_mfma_f32_16x16x32_bf16 v[168:171],a[156:159],a[116:119],v[168:171]
 v_mul_f32 v230,s48,v58
 v_mul_f32 v231,s48,v58
 v_mfma_f32_16x16x32_bf16 v[168:171],a[152:155],a[100:103],v[168:171]
 ds_read_b64_tr_b16 a[172:173],v15 offset:40960
 buffer_load_dwordx4 v[68:71],v1,s[20:23],s19 offen offset:1024 sc1
 v_mfma_f32_16x16x32_bf16 v[168:171],a[148:151],a[84:87],v[168:171]
 ds_read_b64_tr_b16 a[174:175],v15 offset:45056
 v_lshlrev_b32 v59,16,v59
 v_mfma_f32_16x16x32_bf16 v[168:171],a[144:147],a[68:71],v[168:171]
 v_mul_f32 v236,s48,v59
 v_mul_f32 v237,s48,v59
 v_mfma_f32_16x16x32_bf16 v[168:171],a[140:143],a[244:247],v[168:171]
 ds_read_b64_tr_b16 a[176:177],v15 offset:49152
 v_mul_f32 v238,s48,v59
 v_mfma_f32_16x16x32_bf16 v[168:171],a[136:139],a[228:231],v[168:171]
 ds_read_b64_tr_b16 a[178:179],v15 offset:53248
 v_mul_f32 v239,s48,v59
 v_mfma_f32_16x16x32_bf16 v[168:171],a[132:135],a[212:215],v[168:171]
 v_lshlrev_b32 v60,16,v60
 v_mul_f32 v244,s48,v60
 v_mfma_f32_16x16x32_bf16 v[168:171],a[128:131],a[196:199],v[168:171]
 ds_read_b64_tr_b16 a[180:181],v15 offset:57344
 v_mul_f32 v245,s48,v60
 v_mfma_f32_16x16x32_bf16 v[176:179],a[128:131],a[200:203],v[176:179]
 ds_read_b64_tr_b16 a[182:183],v15 offset:61440
 v_mul_f32 v246,s48,v60
 v_mfma_f32_16x16x32_bf16 v[176:179],a[132:135],a[216:219],v[176:179]
 buffer_load_dwordx4 v[72:75],v1,s[20:23],s19 offen offset:2048 sc1
 v_mul_f32 v247,s48,v60
 v_mfma_f32_16x16x32_bf16 v[176:179],a[136:139],a[232:235],v[176:179]
 ds_read_b64_tr_b16 a[184:185],v51 offset:49152
 v_lshlrev_b32 v61,16,v61
 v_mfma_f32_16x16x32_bf16 v[176:179],a[140:143],a[248:251],v[176:179]
 ds_read_b64_tr_b16 a[186:187],v51 offset:53248
 v_mul_f32 v252,s48,v61
 v_mfma_f32_16x16x32_bf16 v[176:179],a[144:147],a[72:75],v[176:179]
 v_mul_f32 v253,s48,v61
 v_mul_f32 v254,s48,v61
 v_mfma_f32_16x16x32_bf16 v[176:179],a[148:151],a[88:91],v[176:179]
 ds_read_b64_tr_b16 a[188:189],v51 offset:57344
 v_mul_f32 v255,s48,v61
 v_mfma_f32_16x16x32_bf16 v[176:179],a[152:155],a[104:107],v[176:179]
 ds_read_b64_tr_b16 a[190:191],v51 offset:61440
 v_mfma_f32_16x16x32_bf16 v[176:179],a[156:159],a[120:123],v[176:179]
 v_mfma_f32_16x16x32_bf16 v[184:187],a[156:159],a[124:127],v[184:187]
 buffer_load_dwordx4 v[76:79],v1,s[20:23],s19 offen offset:3072 sc1
 v_mfma_f32_16x16x32_bf16 v[184:187],a[152:155],a[108:111],v[184:187]
 v_mfma_f32_16x16x32_bf16 v[184:187],a[148:151],a[92:95],v[184:187]
 v_mfma_f32_16x16x32_bf16 v[184:187],a[144:147],a[76:79],v[184:187]
 v_mfma_f32_16x16x32_bf16 v[184:187],a[140:143],a[252:255],v[184:187]
 v_mfma_f32_16x16x32_bf16 v[184:187],a[136:139],a[236:239],v[184:187]
 v_mfma_f32_16x16x32_bf16 v[184:187],a[132:135],a[220:223],v[184:187]
 v_mfma_f32_16x16x32_bf16 v[184:187],a[128:131],a[204:207],v[184:187]
 s_waitcnt vmcnt(40) lgkmcnt(0)
 s_barrier
 v_mfma_f32_16x16x32_bf16 v[164:167],a[160:163],a[192:195],v[164:167]
 ds_read_b64_tr_b16 a[128:129],v16 offset:0
 v_mfma_f32_16x16x32_bf16 v[164:167],a[164:167],a[208:211],v[164:167]
 ds_read_b64_tr_b16 a[130:131],v16 offset:4096
 v_mfma_f32_16x16x32_bf16 v[164:167],a[168:171],a[224:227],v[164:167]
 v_mfma_f32_16x16x32_bf16 v[164:167],a[172:175],a[240:243],v[164:167]
 ds_read_b64_tr_b16 a[132:133],v16 offset:8192
 v_mfma_f32_16x16x32_bf16 v[164:167],a[176:179],a[64:67],v[164:167]
 ds_read_b64_tr_b16 a[134:135],v16 offset:12288
 v_mfma_f32_16x16x32_bf16 v[164:167],a[180:183],a[80:83],v[164:167]
 v_mfma_f32_16x16x32_bf16 v[164:167],a[184:187],a[96:99],v[164:167]
 ds_read_b64_tr_b16 a[136:137],v17 offset:0
 v_mfma_f32_16x16x32_bf16 v[164:167],a[188:191],a[112:115],v[164:167]
 ds_read_b64_tr_b16 a[138:139],v17 offset:4096
 v_mfma_f32_16x16x32_bf16 v[172:175],a[188:191],a[116:119],v[172:175]
 v_mfma_f32_16x16x32_bf16 v[172:175],a[184:187],a[100:103],v[172:175]
 ds_read_b64_tr_b16 a[140:141],v17 offset:8192
 v_mfma_f32_16x16x32_bf16 v[172:175],a[180:183],a[84:87],v[172:175]
 ds_read_b64_tr_b16 a[142:143],v17 offset:12288
 v_mfma_f32_16x16x32_bf16 v[172:175],a[176:179],a[68:71],v[172:175]
 v_mfma_f32_16x16x32_bf16 v[172:175],a[172:175],a[244:247],v[172:175]
 ds_read_b64_tr_b16 a[144:145],v18 offset:0
 v_mfma_f32_16x16x32_bf16 v[172:175],a[168:171],a[228:231],v[172:175]
 ds_read_b64_tr_b16 a[146:147],v18 offset:4096
 v_mfma_f32_16x16x32_bf16 v[172:175],a[164:167],a[212:215],v[172:175]
 v_mfma_f32_16x16x32_bf16 v[172:175],a[160:163],a[196:199],v[172:175]
 ds_read_b64_tr_b16 a[148:149],v18 offset:8192
 v_mfma_f32_16x16x32_bf16 v[180:183],a[160:163],a[200:203],v[180:183]
 ds_read_b64_tr_b16 a[150:151],v18 offset:12288
 v_mfma_f32_16x16x32_bf16 v[180:183],a[164:167],a[216:219],v[180:183]
 v_mfma_f32_16x16x32_bf16 v[180:183],a[168:171],a[232:235],v[180:183]
 ds_read_b64_tr_b16 a[152:153],v19 offset:0
 v_mfma_f32_16x16x32_bf16 v[180:183],a[172:175],a[248:251],v[180:183]
 ds_read_b64_tr_b16 a[154:155],v19 offset:4096
 v_mfma_f32_16x16x32_bf16 v[180:183],a[176:179],a[72:75],v[180:183]
 v_mfma_f32_16x16x32_bf16 v[180:183],a[180:183],a[88:91],v[180:183]
 ds_read_b64_tr_b16 a[156:157],v19 offset:8192
 v_mfma_f32_16x16x32_bf16 v[180:183],a[184:187],a[104:107],v[180:183]
 ds_read_b64_tr_b16 a[158:159],v19 offset:12288
 v_mfma_f32_16x16x32_bf16 v[180:183],a[188:191],a[120:123],v[180:183]
 v_mfma_f32_16x16x32_bf16 v[188:191],a[188:191],a[124:127],v[188:191]
 v_mfma_f32_16x16x32_bf16 v[188:191],a[184:187],a[108:111],v[188:191]
 v_mfma_f32_16x16x32_bf16 v[188:191],a[180:183],a[92:95],v[188:191]
 v_mfma_f32_16x16x32_bf16 v[188:191],a[176:179],a[76:79],v[188:191]
 v_mfma_f32_16x16x32_bf16 v[188:191],a[172:175],a[252:255],v[188:191]
 v_mfma_f32_16x16x32_bf16 v[188:191],a[168:171],a[236:239],v[188:191]
 v_mfma_f32_16x16x32_bf16 v[188:191],a[164:167],a[220:223],v[188:191]
 v_mfma_f32_16x16x32_bf16 v[188:191],a[160:163],a[204:207],v[188:191]
 s_mov_b32 s48,0x409d30fc
 s_mov_b32 s49,s48
 s_mov_b32 s50,0x3ea65393
 s_mov_b32 s51,s50
 s_mov_b32 s44,229376
 s_mov_b32 s101,524288
 s_add_u32 s19,s17,4096
 buffer_load_dwordx4 v[80:83],v1,s[20:23],s19 offen offset:0 sc1
 buffer_load_dwordx4 v[84:87],v1,s[20:23],s19 offen offset:1024 sc1
 buffer_load_dwordx4 v[88:91],v1,s[20:23],s19 offen offset:2048 sc1
 buffer_load_dwordx4 v[92:95],v1,s[20:23],s19 offen offset:3072 sc1
 buffer_load_dword v53,v63,s[68:71],s76 offen sc1
 s_waitcnt vmcnt(5)
L_ina_check:
 v_max_u32 v6,v64,v65
 v_max3_u32 v6,v66,v67,v6
 v_max3_u32 v6,v68,v69,v6
 v_max3_u32 v6,v70,v71,v6
 v_max3_u32 v6,v72,v73,v6
 v_max3_u32 v6,v74,v75,v6
 v_max3_u32 v6,v76,v77,v6
 v_max3_u32 v6,v78,v79,v6
 v_cmp_eq_u32 vcc,-1,v6
 s_nop 1
 s_cmp_lg_u64 vcc,0
 s_cbranch_scc1 L_ina_late
L_ina_ok:
 v_mfma_f32_16x16x32_bf16 v[128:131],v[36:39],v[64:67],v[128:131]
 v_mfma_f32_16x16x32_bf16 v[132:135],v[40:43],v[64:67],v[132:135]
 v_mfma_f32_16x16x32_bf16 v[136:139],v[36:39],v[68:71],v[136:139]
 v_mfma_f32_16x16x32_bf16 v[140:143],v[40:43],v[68:71],v[140:143]
 v_mfma_f32_16x16x32_bf16 v[144:147],v[36:39],v[72:75],v[144:147]
 v_mfma_f32_16x16x32_bf16 v[148:151],v[40:43],v[72:75],v[148:151]
 v_mfma_f32_16x16x32_bf16 v[152:155],v[36:39],v[76:79],v[152:155]
 v_mfma_f32_16x16x32_bf16 v[156:159],v[40:43],v[76:79],v[156:159]
 s_nop 1
 v_pk_fma_f32 v[96:97],v[128:129],v[128:129],s[48:49]
 v_pk_fma_f32 v[98:99],v[130:131],v[130:131],s[48:49]
 v_pk_fma_f32 v[100:101],v[132:133],v[132:133],s[48:49]
 v_pk_fma_f32 v[102:103],v[134:135],v[134:135],s[48:49]
 v_pk_mul_f32 v[96:97],v[96:97],v[128:129]
 v_pk_mul_f32 v[98:99],v[98:99],v[130:131]
 v_pk_mul_f32 v[100:101],v[100:101],v[132:133]
 v_pk_mul_f32 v[102:103],v[102:103],v[134:135]
 v_exp_f32 v96,v96
 v_exp_f32 v97,v97
 v_exp_f32 v98,v98
 v_exp_f32 v99,v99
 v_exp_f32 v100,v100
 v_exp_f32 v101,v101
 v_exp_f32 v102,v102
 v_exp_f32 v103,v103
 v_pk_fma_f32 v[96:97],v[96:97],s[50:51],s[50:51]
 v_pk_fma_f32 v[98:99],v[98:99],s[50:51],s[50:51]
 v_pk_fma_f32 v[100:101],v[100:101],s[50:51],s[50:51]
 v_pk_fma_f32 v[102:103],v[102:103],s[50:51],s[50:51]
 v_rcp_f32 v96,v96
 v_rcp_f32 v97,v97
 v_rcp_f32 v98,v98
 v_rcp_f32 v99,v99
 v_rcp_f32 v100,v100
 v_rcp_f32 v101,v101
 v_rcp_f32 v102,v102
 v_rcp_f32 v103,v103
 v_pk_mul_f32 v[96:97],v[96:97],v[128:129]
 v_pk_mul_f32 v[98:99],v[98:99],v[130:131]
 v_pk_mul_f32 v[100:101],v[100:101],v[132:133]
 v_pk_mul_f32 v[102:103],v[102:103],v[134:135]
 v_cvt_pk_bf16_f32 v104,v96,v97
 v_cvt_pk_bf16_f32 v105,v98,v99
 v_cvt_pk_bf16_f32 v106,v100,v101
 v_cvt_pk_bf16_f32 v107,v102,v103
 buffer_store_dwordx4 v[104:107],v1,s[64:67],0 offen offset:0 sc1
 v_pk_fma_f32 v[108:109],v[136:137],v[136:137],s[48:49]
 v_pk_fma_f32 v[110:111],v[138:139],v[138:139],s[48:49]
 v_pk_fma_f32 v[112:113],v[140:141],v[140:141],s[48:49]
 v_pk_fma_f32 v[114:115],v[142:143],v[142:143],s[48:49]
 v_pk_mul_f32 v[108:109],v[108:109],v[136:137]
 v_pk_mul_f32 v[110:111],v[110:111],v[138:139]
 v_pk_mul_f32 v[112:113],v[112:113],v[140:141]
 v_pk_mul_f32 v[114:115],v[114:115],v[142:143]
 v_exp_f32 v108,v108
 v_exp_f32 v109,v109
 v_exp_f32 v110,v110
 v_exp_f32 v111,v111
 v_exp_f32 v112,v112
 v_exp_f32 v113,v113
 v_exp_f32 v114,v114
 v_exp_f32 v115,v115
 v_pk_fma_f32 v[108:109],v[108:109],s[50:51],s[50:51]
 v_pk_fma_f32 v[110:111],v[110:111],s[50:51],s[50:51]
 v_pk_fma_f32 v[112:113],v[112:113],s[50:51],s[50:51]
 v_pk_fma_f32 v[114:115],v[114:115],s[50:51],s[50:51]
 v_rcp_f32 v108,v108
 v_rcp_f32 v109,v109
 v_rcp_f32 v110,v110
 v_rcp_f32 v111,v111
 v_rcp_f32 v112,v112
 v_rcp_f32 v113,v113
 v_rcp_f32 v114,v114
 v_rcp_f32 v115,v115
 v_pk_mul_f32 v[108:109],v[108:109],v[136:137]
 v_pk_mul_f32 v[110:111],v[110:111],v[138:139]
 v_pk_mul_f32 v[112:113],v[112:113],v[140:141]
 v_pk_mul_f32 v[114:115],v[114:115],v[142:143]
 v_cvt_pk_bf16_f32 v116,v108,v109
 v_cvt_pk_bf16_f32 v117,v110,v111
 v_cvt_pk_bf16_f32 v118,v112,v113
 v_cvt_pk_bf16_f32 v119,v114,v115
 buffer_store_dwordx4 v[116:119],v1,s[64:67],0 offen offset:1024 sc1
 v_pk_fma_f32 v[96:97],v[144:145],v[144:145],s[48:49]
 v_pk_fma_f32 v[98:99],v[146:147],v[146:147],s[48:49]
 v_pk_fma_f32 v[100:101],v[148:149],v[148:149],s[48:49]
 v_pk_fma_f32 v[102:103],v[150:151],v[150:151],s[48:49]
 v_pk_mul_f32 v[96:97],v[96:97],v[144:145]
 v_pk_mul_f32 v[98:99],v[98:99],v[146:147]
 v_pk_mul_f32 v[100:101],v[100:101],v[148:149]
 v_pk_mul_f32 v[102:103],v[102:103],v[150:151]
 v_exp_f32 v96,v96
 v_exp_f32 v97,v97
 v_exp_f32 v98,v98
 v_exp_f32 v99,v99
 v_exp_f32 v100,v100
 v_exp_f32 v101,v101
 v_exp_f32 v102,v102
 v_exp_f32 v103,v103
 v_pk_fma_f32 v[96:97],v[96:97],s[50:51],s[50:51]
 v_pk_fma_f32 v[98:99],v[98:99],s[50:51],s[50:51]
 v_pk_fma_f32 v[100:101],v[100:101],s[50:51],s[50:51]
 v_pk_fma_f32 v[102:103],v[102:103],s[50:51],s[50:51]
 v_rcp_f32 v96,v96
 v_rcp_f32 v97,v97
 v_rcp_f32 v98,v98
 v_rcp_f32 v99,v99
 v_rcp_f32 v100,v100
 v_rcp_f32 v101,v101
 v_rcp_f32 v102,v102
 v_rcp_f32 v103,v103
 v_pk_mul_f32 v[96:97],v[96:97],v[144:145]
 v_pk_mul_f32 v[98:99],v[98:99],v[146:147]
 v_pk_mul_f32 v[100:101],v[100:101],v[148:149]
 v_pk_mul_f32 v[102:103],v[102:103],v[150:151]
 v_cvt_pk_bf16_f32 v104,v96,v97
 v_cvt_pk_bf16_f32 v105,v98,v99
 v_cvt_pk_bf16_f32 v106,v100,v101
 v_cvt_pk_bf16_f32 v107,v102,v103
 buffer_store_dwordx4 v[104:107],v1,s[64:67],s44 offen offset:0 sc1
 v_pk_fma_f32 v[108:109],v[152:153],v[152:153],s[48:49]
 v_pk_fma_f32 v[110:111],v[154:155],v[154:155],s[48:49]
 v_pk_fma_f32 v[112:113],v[156:157],v[156:157],s[48:49]
 v_pk_fma_f32 v[114:115],v[158:159],v[158:159],s[48:49]
 v_pk_mul_f32 v[108:109],v[108:109],v[152:153]
 v_pk_mul_f32 v[110:111],v[110:111],v[154:155]
 v_pk_mul_f32 v[112:113],v[112:113],v[156:157]
 v_pk_mul_f32 v[114:115],v[114:115],v[158:159]
 v_exp_f32 v108,v108
 v_exp_f32 v109,v109
 v_exp_f32 v110,v110
 v_exp_f32 v111,v111
 v_exp_f32 v112,v112
 v_exp_f32 v113,v113
 v_exp_f32 v114,v114
 v_exp_f32 v115,v115
 v_pk_fma_f32 v[108:109],v[108:109],s[50:51],s[50:51]
 v_pk_fma_f32 v[110:111],v[110:111],s[50:51],s[50:51]
 v_pk_fma_f32 v[112:113],v[112:113],s[50:51],s[50:51]
 v_pk_fma_f32 v[114:115],v[114:115],s[50:51],s[50:51]
 v_rcp_f32 v108,v108
 v_rcp_f32 v109,v109
 v_rcp_f32 v110,v110
 v_rcp_f32 v111,v111
 v_rcp_f32 v112,v112
 v_rcp_f32 v113,v113
 v_rcp_f32 v114,v114
 v_rcp_f32 v115,v115
 v_pk_mul_f32 v[108:109],v[108:109],v[152:153]
 v_pk_mul_f32 v[110:111],v[110:111],v[154:155]
 v_pk_mul_f32 v[112:113],v[112:113],v[156:157]
 v_pk_mul_f32 v[114:115],v[114:115],v[158:159]
 v_cvt_pk_bf16_f32 v116,v108,v109
 v_cvt_pk_bf16_f32 v117,v110,v111
 v_cvt_pk_bf16_f32 v118,v112,v113
 v_cvt_pk_bf16_f32 v119,v114,v115
 buffer_store_dwordx4 v[116:119],v1,s[64:67],s44 offen offset:1024 sc1
 s_waitcnt vmcnt(5)
L_inb_check:
 v_max_u32 v6,v80,v81
 v_max3_u32 v6,v82,v83,v6
 v_max3_u32 v6,v84,v85,v6
 v_max3_u32 v6,v86,v87,v6
 v_max3_u32 v6,v88,v89,v6
 v_max3_u32 v6,v90,v91,v6
 v_max3_u32 v6,v92,v93,v6
 v_max3_u32 v6,v94,v95,v6
 v_cmp_eq_u32 vcc,-1,v6
 s_nop 1
 s_cmp_lg_u64 vcc,0
 s_cbranch_scc1 L_inb_late
L_inb_ok:
 v_mfma_f32_16x16x32_bf16 v[160:163],v[36:39],v[80:83],v[160:163]
 v_mfma_f32_16x16x32_bf16 v[164:167],v[40:43],v[80:83],v[164:167]
 v_mfma_f32_16x16x32_bf16 v[168:171],v[36:39],v[84:87],v[168:171]
 v_mfma_f32_16x16x32_bf16 v[172:175],v[40:43],v[84:87],v[172:175]
 v_mfma_f32_16x16x32_bf16 v[176:179],v[36:39],v[88:91],v[176:179]
 v_mfma_f32_16x16x32_bf16 v[180:183],v[40:43],v[88:91],v[180:183]
 v_mfma_f32_16x16x32_bf16 v[184:187],v[36:39],v[92:95],v[184:187]
 v_mfma_f32_16x16x32_bf16 v[188:191],v[40:43],v[92:95],v[188:191]
 s_nop 1
 s_bitcmp1_b32 s43,2
 s_cbranch_scc1 L_mlp2
 v_pk_fma_f32 v[96:97],v[160:161],v[160:161],s[48:49]
 v_pk_fma_f32 v[98:99],v[162:163],v[162:163],s[48:49]
 v_pk_fma_f32 v[100:101],v[164:165],v[164:165],s[48:49]
 v_pk_fma_f32 v[102:103],v[166:167],v[166:167],s[48:49]
 v_pk_mul_f32 v[96:97],v[96:97],v[160:161]
 v_pk_mul_f32 v[98:99],v[98:99],v[162:163]
 v_pk_mul_f32 v[100:101],v[100:101],v[164:165]
 v_pk_mul_f32 v[102:103],v[102:103],v[166:167]
 v_exp_f32 v96,v96
 v_exp_f32 v97,v97
 v_exp_f32 v98,v98
 v_exp_f32 v99,v99
 v_exp_f32 v100,v100
 v_exp_f32 v101,v101
 v_exp_f32 v102,v102
 v_exp_f32 v103,v103
 v_pk_fma_f32 v[96:97],v[96:97],s[50:51],s[50:51]
 v_pk_fma_f32 v[98:99],v[98:99],s[50:51],s[50:51]
 v_pk_fma_f32 v[100:101],v[100:101],s[50:51],s[50:51]
 v_pk_fma_f32 v[102:103],v[102:103],s[50:51],s[50:51]
 v_rcp_f32 v96,v96
 v_rcp_f32 v97,v97
 v_rcp_f32 v98,v98
 v_rcp_f32 v99,v99
 v_rcp_f32 v100,v100
 v_rcp_f32 v101,v101
 v_rcp_f32 v102,v102
 v_rcp_f32 v103,v103
 v_pk_mul_f32 v[96:97],v[96:97],v[160:161]
 v_pk_mul_f32 v[98:99],v[98:99],v[162:163]
 v_pk_mul_f32 v[100:101],v[100:101],v[164:165]
 v_pk_mul_f32 v[102:103],v[102:103],v[166:167]
L_stub_o_0:
 s_cbranch_execz L_stub_o_4
 v_cvt_pk_bf16_f32 v104,v96,v97
 v_cvt_pk_bf16_f32 v105,v98,v99
 v_cvt_pk_bf16_f32 v106,v100,v101
 v_cvt_pk_bf16_f32 v107,v102,v103
 buffer_store_dwordx4 v[104:107],v1,s[64:67],0 offen offset:2048 sc1
 v_pk_fma_f32 v[108:109],v[168:169],v[168:169],s[48:49]
 v_pk_fma_f32 v[110:111],v[170:171],v[170:171],s[48:49]
 v_pk_fma_f32 v[112:113],v[172:173],v[172:173],s[48:49]
 v_pk_fma_f32 v[114:115],v[174:175],v[174:175],s[48:49]
 v_pk_mul_f32 v[108:109],v[108:109],v[168:169]
 v_pk_mul_f32 v[110:111],v[110:111],v[170:171]
 v_pk_mul_f32 v[112:113],v[112:113],v[172:173]
 v_pk_mul_f32 v[114:115],v[114:115],v[174:175]
 v_exp_f32 v108,v108
 v_exp_f32 v109,v109
 v_exp_f32 v110,v110
 v_exp_f32 v111,v111
 v_exp_f32 v112,v112
 v_exp_f32 v113,v113
 v_exp_f32 v114,v114
 v_exp_f32 v115,v115
 v_pk_fma_f32 v[108:109],v[108:109],s[50:51],s[50:51]
 v_pk_fma_f32 v[110:111],v[110:111],s[50:51],s[50:51]
 v_pk_fma_f32 v[112:113],v[112:113],s[50:51],s[50:51]
 v_pk_fma_f32 v[114:115],v[114:115],s[50:51],s[50:51]
 v_rcp_f32 v108,v108
 v_rcp_f32 v109,v109
 v_rcp_f32 v110,v110
 v_rcp_f32 v111,v111
 v_rcp_f32 v112,v112
 v_rcp_f32 v113,v113
 v_rcp_f32 v114,v114
 v_rcp_f32 v115,v115
 v_pk_mul_f32 v[108:109],v[108:109],v[168:169]
 v_pk_mul_f32 v[110:111],v[110:111],v[170:171]
 v_pk_mul_f32 v[112:113],v[112:113],v[172:173]
 v_pk_mul_f32 v[114:115],v[114:115],v[174:175]
 v_cvt_pk_bf16_f32 v116,v108,v109
 v_cvt_pk_bf16_f32 v117,v110,v111
 v_cvt_pk_bf16_f32 v118,v112,v113
 v_cvt_pk_bf16_f32 v119,v114,v115
 buffer_store_dwordx4 v[116:119],v1,s[64:67],0 offen offset:3072 sc1
 v_pk_fma_f32 v[96:97],v[176:177],v[176:177],s[48:49]
 v_pk_fma_f32 v[98:99],v[178:179],v[178:179],s[48:49]
 v_pk_fma_f32 v[100:101],v[180:181],v[180:181],s[48:49]
 v_pk_fma_f32 v[102:103],v[182:183],v[182:183],s[48:49]
 v_pk_mul_f32 v[96:97],v[96:97],v[176:177]
 v_pk_mul_f32 v[98:99],v[98:99],v[178:179]
 v_pk_mul_f32 v[100:101],v[100:101],v[180:181]
 v_pk_mul_f32 v[102:103],v[102:103],v[182:183]
 v_exp_f32 v96,v96
 v_exp_f32 v97,v97
 v_exp_f32 v98,v98
 v_exp_f32 v99,v99
 v_exp_f32 v100,v100
 v_exp_f32 v101,v101
 v_exp_f32 v102,v102
 v_exp_f32 v103,v103
 v_pk_fma_f32 v[96:97],v[96:97],s[50:51],s[50:51]
 v_pk_fma_f32 v[98:99],v[98:99],s[50:51],s[50:51]
 v_pk_fma_f32 v[100:101],v[100:101],s[50:51],s[50:51]
 v_pk_fma_f32 v[102:103],v[102:103],s[50:51],s[50:51]
 v_rcp_f32 v96,v96
 v_rcp_f32 v97,v97
 v_rcp_f32 v98,v98
 v_rcp_f32 v99,v99
 v_rcp_f32 v100,v100
 v_rcp_f32 v101,v101
 v_rcp_f32 v102,v102
 v_rcp_f32 v103,v103
 v_pk_mul_f32 v[96:97],v[96:97],v[176:177]
 v_pk_mul_f32 v[98:99],v[98:99],v[178:179]
 v_pk_mul_f32 v[100:101],v[100:101],v[180:181]
 v_pk_mul_f32 v[102:103],v[102:103],v[182:183]
 v_cvt_pk_bf16_f32 v104,v96,v97
 v_cvt_pk_bf16_f32 v105,v98,v99
 v_cvt_pk_bf16_f32 v106,v100,v101
 v_cvt_pk_bf16_f32 v107,v102,v103
 buffer_store_dwordx4 v[104:107],v1,s[64:67],s44 offen offset:2048 sc1
 v_pk_fma_f32 v[108:109],v[184:185],v[184:185],s[48:49]
 v_pk_fma_f32 v[110:111],v[186:187],v[186:187],s[48:49]
 v_pk_fma_f32 v[112:113],v[188:189],v[188:189],s[48:49]
 v_pk_fma_f32 v[114:115],v[190:191],v[190:191],s[48:49]
 v_pk_mul_f32 v[108:109],v[108:109],v[184:185]
 v_pk_mul_f32 v[110:111],v[110:111],v[186:187]
 v_pk_mul_f32 v[112:113],v[112:113],v[188:189]
 v_pk_mul_f32 v[114:115],v[114:115],v[190:191]
 v_exp_f32 v108,v108
 v_exp_f32 v109,v109
 v_exp_f32 v110,v110
 v_exp_f32 v111,v111
 v_exp_f32 v112,v112
 v_exp_f32 v113,v113
 v_exp_f32 v114,v114
 v_exp_f32 v115,v115
 v_pk_fma_f32 v[108:109],v[108:109],s[50:51],s[50:51]
 v_pk_fma_f32 v[110:111],v[110:111],s[50:51],s[50:51]
 v_pk_fma_f32 v[112:113],v[112:113],s[50:51],s[50:51]
 v_pk_fma_f32 v[114:115],v[114:115],s[50:51],s[50:51]
 v_rcp_f32 v108,v108
 v_rcp_f32 v109,v109
 v_rcp_f32 v110,v110
 v_rcp_f32 v111,v111
 v_rcp_f32 v112,v112
 v_rcp_f32 v113,v113
 v_rcp_f32 v114,v114
 v_rcp_f32 v115,v115
 v_pk_mul_f32 v[108:109],v[108:109],v[184:185]
 v_pk_mul_f32 v[110:111],v[110:111],v[186:187]
 v_pk_mul_f32 v[112:113],v[112:113],v[188:189]
 v_pk_mul_f32 v[114:115],v[114:115],v[190:191]
 v_cvt_pk_bf16_f32 v116,v108,v109
 v_cvt_pk_bf16_f32 v117,v110,v111
 v_cvt_pk_bf16_f32 v118,v112,v113
 v_cvt_pk_bf16_f32 v119,v114,v115
 buffer_store_dwordx4 v[116:119],v1,s[64:67],s44 offen offset:3072 sc1
 s_waitcnt vmcnt(29) lgkmcnt(0)
 v_mfma_f32_16x16x32_bf16 v[128:131],a[128:131],a[0:3],0
 s_mul_i32 s48,s47,393216
 ds_read_b64_tr_b16 a[160:161],v20 offset:0
 s_lshl_b32 s49,s46,12
 v_mfma_f32_16x16x32_bf16 v[128:131],a[132:135],a[16:19],v[128:131]
 s_mov_b32 s40,8192
 ds_read_b64_tr_b16 a[162:163],v20 offset:4096
 s_add_u32 s48,s48,s49
 v_mfma_f32_16x16x32_bf16 v[136:139],a[128:131],a[4:7],0
 s_lshl_b32 s49,s100,11
 buffer_load_dwordx4 a[64:67],v1,s[60:63],s40 offen offset:0 sc1
 s_lshl_b32 s50,s100,17
 v_mfma_f32_16x16x32_bf16 v[136:139],a[132:135],a[20:23],v[136:139]
 s_xor_b32 s51,s49,2048
 ds_read_b64_tr_b16 a[164:165],v20 offset:8192
 s_add_u32 s51,s51,s48
 v_mfma_f32_16x16x32_bf16 v[144:147],a[128:131],a[8:11],0
 s_add_u32 s12,s51,262144
 ds_read_b64_tr_b16 a[166:167],v20 offset:12288
 s_xor_b32 s51,s49,1024
 v_mfma_f32_16x16x32_bf16 v[144:147],a[132:135],a[24:27],v[144:147]
 s_add_u32 s51,s51,s48
 buffer_load_dwordx4 a[68:71],v1,s[60:63],s40 offen offset:1024 sc1
 s_add_u32 s13,s51,s50
 v_mfma_f32_16x16x32_bf16 v[152:155],a[128:131],a[12:15],0
 s_xor_b32 s51,s49,3072
 ds_read_b64_tr_b16 a[168:169],v21 offset:0
 s_add_u32 s51,s51,s48
 v_mfma_f32_16x16x32_bf16 v[152:155],a[132:135],a[28:31],v[152:155]
 s_add_u32 s14,s51,s50
 ds_read_b64_tr_b16 a[170:171],v21 offset:4096
 s_mov_b32 s48,s47
 v_mfma_f32_16x16x32_bf16 v[132:135],a[136:139],a[0:3],0
 s_lshl_b32 s49,s46,1
 s_add_u32 s49,s49,s100
 s_lshl_b32 s49,s49,1
 v_mfma_f32_16x16x32_bf16 v[132:135],a[140:143],a[16:19],v[132:135]
 s_mul_i32 s15,s48,393216
 ds_read_b64_tr_b16 a[172:173],v21 offset:8192
 buffer_load_dwordx4 a[80:83],v1,s[60:63],s40 offen offset:2048 sc1
 v_mfma_f32_16x16x32_bf16 v[140:143],a[136:139],a[4:7],0
 s_lshl_b32 s50,s49,10
 ds_read_b64_tr_b16 a[174:175],v21 offset:12288
 s_add_u32 s15,s15,s50
 v_mfma_f32_16x16x32_bf16 v[140:143],a[140:143],a[20:23],v[140:143]
 s_lshl_b32 s48,s48,17
 s_lshl_b32 s49,s49,6
 s_add_u32 s48,s48,s49
 v_mfma_f32_16x16x32_bf16 v[148:151],a[136:139],a[8:11],0
 s_sub_u32 s49,4194304,s48
 ds_read_b64_tr_b16 a[176:177],v22 offset:0
 v_mfma_f32_16x16x32_bf16 v[148:151],a[140:143],a[24:27],v[148:151]
 s_add_u32 s72,s52,s48
 s_addc_u32 s73,s53,0
 ds_read_b64_tr_b16 a[178:179],v22 offset:4096
 buffer_load_dwordx4 a[84:87],v1,s[60:63],s40 offen offset:3072 sc1
 v_mfma_f32_16x16x32_bf16 v[156:159],a[136:139],a[12:15],0
 s_mov_b32 s74,s49
 s_mov_b32 s75,0x20000
 v_mfma_f32_16x16x32_bf16 v[156:159],a[140:143],a[28:31],v[156:159]
 s_add_u32 s16,s56,s48
 s_addc_u32 s17,s57,0
 ds_read_b64_tr_b16 a[180:181],v22 offset:8192
 v_mfma_f32_16x16x32_bf16 v[160:163],a[144:147],a[0:3],0
 s_mov_b32 s59,270336
 ds_read_b64_tr_b16 a[182:183],v22 offset:12288
 s_mov_b32 s18,s49
 v_mfma_f32_16x16x32_bf16 v[160:163],a[148:151],a[16:19],v[160:163]
 s_mov_b32 s19,0x20000
 buffer_load_dwordx4 a[72:75],v1,s[60:63],s59 offen offset:0 sc1
 v_mfma_f32_16x16x32_bf16 v[168:171],a[144:147],a[4:7],0
 ds_read_b64_tr_b16 a[184:185],v23 offset:0
 v_mfma_f32_16x16x32_bf16 v[168:171],a[148:151],a[20:23],v[168:171]
 ds_read_b64_tr_b16 a[186:187],v23 offset:4096
 v_mfma_f32_16x16x32_bf16 v[176:179],a[144:147],a[8:11],0
 buffer_load_dwordx4 a[76:79],v1,s[60:63],s59 offen offset:1024 sc1
 v_mfma_f32_16x16x32_bf16 v[176:179],a[148:151],a[24:27],v[176:179]
 ds_read_b64_tr_b16 a[188:189],v23 offset:8192
 v_mfma_f32_16x16x32_bf16 v[184:187],a[144:147],a[12:15],0
 ds_read_b64_tr_b16 a[190:191],v23 offset:12288
 v_mfma_f32_16x16x32_bf16 v[184:187],a[148:151],a[28:31],v[184:187]
 v_mfma_f32_16x16x32_bf16 v[164:167],a[152:155],a[0:3],0
 buffer_load_dwordx4 a[88:91],v1,s[60:63],s59 offen offset:2048 sc1
 v_mfma_f32_16x16x32_bf16 v[164:167],a[156:159],a[16:19],v[164:167]
 v_mfma_f32_16x16x32_bf16 v[172:175],a[152:155],a[4:7],0
 v_mfma_f32_16x16x32_bf16 v[172:175],a[156:159],a[20:23],v[172:175]
 v_mfma_f32_16x16x32_bf16 v[180:183],a[152:155],a[8:11],0
 buffer_load_dwordx4 a[92:95],v1,s[60:63],s59 offen offset:3072 sc1
 v_mfma_f32_16x16x32_bf16 v[180:183],a[156:159],a[24:27],v[180:183]
 v_mfma_f32_16x16x32_bf16 v[188:191],a[152:155],a[12:15],0
 v_mfma_f32_16x16x32_bf16 v[188:191],a[156:159],a[28:31],v[188:191]
 s_waitcnt vmcnt(57) lgkmcnt(0)
 s_barrier
 v_mfma_f32_16x16x32_bf16 v[192:195],a[160:163],a[0:3],0
 s_add_u32 m0,s3,0
 ds_read_b64_tr_b16 a[128:129],v24 offset:0
 s_waitcnt vmcnt(8)
 v_mfma_f32_16x16x32_bf16 v[192:195],a[164:167],a[16:19],v[192:195]
 s_mov_b32 s41,524288
 ds_read_b64_tr_b16 a[130:131],v24 offset:4096
 buffer_store_dword v55,v52,s[68:71],s77 offen sc1
 v_mfma_f32_16x16x32_bf16 v[200:203],a[160:163],a[4:7],0
 buffer_load_dwordx4 v32,s[8:11],s41 offen offset:0 lds
 v_mfma_f32_16x16x32_bf16 v[200:203],a[164:167],a[20:23],v[200:203]
 ds_read_b64_tr_b16 a[132:133],v24 offset:8192
 v_mfma_f32_16x16x32_bf16 v[208:211],a[160:163],a[8:11],0
 ds_read_b64_tr_b16 a[134:135],v24 offset:12288
 v_mfma_f32_16x16x32_bf16 v[208:211],a[164:167],a[24:27],v[208:211]
 buffer_load_dwordx4 v33,s[8:11],s41 offen offset:1024 lds
 v_mfma_f32_16x16x32_bf16 v[216:219],a[160:163],a[12:15],0
 ds_read_b64_tr_b16 a[136:137],v25 offset:0
 v_mfma_f32_16x16x32_bf16 v[216:219],a[164:167],a[28:31],v[216:219]
 ds_read_b64_tr_b16 a[138:139],v25 offset:4096
 v_mfma_f32_16x16x32_bf16 v[196:199],a[168:171],a[0:3],0
 s_mov_b32 s40,12288
 v_mfma_f32_16x16x32_bf16 v[196:199],a[172:175],a[16:19],v[196:199]
 ds_read_b64_tr_b16 a[140:141],v25 offset:8192
 buffer_load_dwordx4 a[96:99],v1,s[60:63],s40 offen offset:0 sc1
 v_mfma_f32_16x16x32_bf16 v[204:207],a[168:171],a[4:7],0
 ds_read_b64_tr_b16 a[142:143],v25 offset:12288
 v_mfma_f32_16x16x32_bf16 v[204:207],a[172:175],a[20:23],v[204:207]
 v_mfma_f32_16x16x32_bf16 v[212:215],a[168:171],a[8:11],0
 ds_read_b64_tr_b16 a[144:145],v26 offset:0
 v_mfma_f32_16x16x32_bf16 v[212:215],a[172:175],a[24:27],v[212:215]
 ds_read_b64_tr_b16 a[146:147],v26 offset:4096
 buffer_load_dwordx4 a[100:103],v1,s[60:63],s40 offen offset:1024 sc1
 v_mfma_f32_16x16x32_bf16 v[220:223],a[168:171],a[12:15],0
 v_mfma_f32_16x16x32_bf16 v[220:223],a[172:175],a[28:31],v[220:223]
 ds_read_b64_tr_b16 a[148:149],v26 offset:8192
 v_mfma_f32_16x16x32_bf16 v[224:227],a[176:179],a[0:3],0
 ds_read_b64_tr_b16 a[150:151],v26 offset:12288
 v_mfma_f32_16x16x32_bf16 v[224:227],a[180:183],a[16:19],v[224:227]
 buffer_load_dwordx4 a[112:115],v1,s[60:63],s40 offen offset:2048 sc1
 v_mfma_f32_16x16x32_bf16 v[232:235],a[176:179],a[4:7],0
 ds_read_b64_tr_b16 a[152:153],v27 offset:0
 v_mfma_f32_16x16x32_bf16 v[232:235],a[180:183],a[20:23],v[232:235]
 ds_read_b64_tr_b16 a[154:155],v27 offset:4096
 v_mfma_f32_16x16x32_bf16 v[240:243],a[176:179],a[8:11],0
 buffer_load_dwordx4 a[116:119],v1,s[60:63],s40 offen offset:3072 sc1
 v_mfma_f32_16x16x32_bf16 v[240:243],a[180:183],a[24:27],v[240:243]
 ds_read_b64_tr_b16 a[156:157],v27 offset:8192
 v_mfma_f32_16x16x32_bf16 v[248:251],a[176:179],a[12:15],0
 ds_read_b64_tr_b16 a[158:159],v27 offset:12288
 v_mfma_f32_16x16x32_bf16 v[248:251],a[180:183],a[28:31],v[248:251]
 s_mov_b32 s59,274432
 v_mfma_f32_16x16x32_bf16 v[228:231],a[184:187],a[0:3],0
 buffer_load_dwordx4 a[104:107],v1,s[60:63],s59 offen offset:0 sc1
 v_mfma_f32_16x16x32_bf16 v[228:231],a[188:191],a[16:19],v[228:231]
 v_mfma_f32_16x16x32_bf16 v[236:239],a[184:187],a[4:7],0
 v_mfma_f32_16x16x32_bf16 v[236:239],a[188:191],a[20:23],v[236:239]
 v_mfma_f32_16x16x32_bf16 v[244:247],a[184:187],a[8:11],0
 buffer_load_dwordx4 a[108:111],v1,s[60:63],s59 offen offset:1024 sc1
 v_mfma_f32_16x16x32_bf16 v[244:247],a[188:191],a[24:27],v[244:247]
 v_mfma_f32_16x16x32_bf16 v[252:255],a[184:187],a[12:15],0
 v_mfma_f32_16x16x32_bf16 v[252:255],a[188:191],a[28:31],v[252:255]
 s_waitcnt vmcnt(34) lgkmcnt(0)
 v_mfma_f32_16x16x32_bf16 v[128:131],a[128:131],a[32:35],v[128:131]
 ds_read_b64_tr_b16 a[160:161],v28 offset:0
 v_mfma_f32_16x16x32_bf16 v[128:131],a[132:135],a[48:51],v[128:131]
 ds_read_b64_tr_b16 a[162:163],v28 offset:4096
 v_mfma_f32_16x16x32_bf16 v[136:139],a[132:135],a[52:55],v[136:139]
 buffer_load_dwordx4 a[120:123],v1,s[60:63],s59 offen offset:2048 sc1
 v_mfma_f32_16x16x32_bf16 v[136:139],a[128:131],a[36:39],v[136:139]
 ds_read_b64_tr_b16 a[164:165],v28 offset:8192
 v_mfma_f32_16x16x32_bf16 v[144:147],a[128:131],a[40:43],v[144:147]
 ds_read_b64_tr_b16 a[166:167],v28 offset:12288
 v_mfma_f32_16x16x32_bf16 v[144:147],a[132:135],a[56:59],v[144:147]
 buffer_load_dwordx4 a[124:127],v1,s[60:63],s59 offen offset:3072 sc1
 v_mfma_f32_16x16x32_bf16 v[152:155],a[132:135],a[60:63],v[152:155]
 ds_read_b64_tr_b16 a[168:169],v29 offset:0
 v_mfma_f32_16x16x32_bf16 v[152:155],a[128:131],a[44:47],v[152:155]
 ds_read_b64_tr_b16 a[170:171],v29 offset:4096
 v_mfma_f32_16x16x32_bf16 v[156:159],a[136:139],a[44:47],v[156:159]
 v_mfma_f32_16x16x32_bf16 v[156:159],a[140:143],a[60:63],v[156:159]
 ds_read_b64_tr_b16 a[172:173],v29 offset:8192
 buffer_load_dwordx4 v34,s[8:11],s41 offen offset:2048 lds
 v_mfma_f32_16x16x32_bf16 v[148:151],a[140:143],a[56:59],v[148:151]
 ds_read_b64_tr_b16 a[174:175],v29 offset:12288
 v_mfma_f32_16x16x32_bf16 v[148:151],a[136:139],a[40:43],v[148:151]
 v_mfma_f32_16x16x32_bf16 v[140:143],a[136:139],a[36:39],v[140:143]
 ds_read_b64_tr_b16 a[176:177],v30 offset:0
 v_mfma_f32_16x16x32_bf16 v[140:143],a[140:143],a[52:55],v[140:143]
 ds_read_b64_tr_b16 a[178:179],v30 offset:4096
 buffer_load_dwordx4 v35,s[8:11],s41 offen offset:3072 lds
 v_mfma_f32_16x16x32_bf16 v[132:135],a[140:143],a[48:51],v[132:135]
 v_mfma_f32_16x16x32_bf16 v[132:135],a[136:139],a[32:35],v[132:135]
 ds_read_b64_tr_b16 a[180:181],v30 offset:8192
 v_mfma_f32_16x16x32_bf16 v[160:163],a[144:147],a[32:35],v[160:163]
 s_mov_b32 s40,16384
 ds_read_b64_tr_b16 a[182:183],v30 offset:12288
 v_mfma_f32_16x16x32_bf16 v[160:163],a[148:151],a[48:51],v[160:163]
 buffer_load_dwordx4 a[0:3],v1,s[60:63],s40 offen offset:0 sc1
 v_mfma_f32_16x16x32_bf16 v[168:171],a[148:151],a[52:55],v[168:171]
 ds_read_b64_tr_b16 a[184:185],v31 offset:0
 v_mfma_f32_16x16x32_bf16 v[168:171],a[144:147],a[36:39],v[168:171]
 ds_read_b64_tr_b16 a[186:187],v31 offset:4096
 v_mfma_f32_16x16x32_bf16 v[176:179],a[144:147],a[40:43],v[176:179]
 buffer_load_dwordx4 a[4:7],v1,s[60:63],s40 offen offset:1024 sc1
 v_mfma_f32_16x16x32_bf16 v[176:179],a[148:151],a[56:59],v[176:179]
 ds_read_b64_tr_b16 a[188:189],v31 offset:8192
 v_mfma_f32_16x16x32_bf16 v[184:187],a[148:151],a[60:63],v[184:187]
 ds_read_b64_tr_b16 a[190:191],v31 offset:12288
 v_mfma_f32_16x16x32_bf16 v[184:187],a[144:147],a[44:47],v[184:187]
 v_mfma_f32_16x16x32_bf16 v[188:191],a[152:155],a[44:47],v[188:191]
 buffer_load_dwordx4 a[16:19],v1,s[60:63],s40 offen offset:2048 sc1
 v_mfma_f32_16x16x32_bf16 v[188:191],a[156:159],a[60:63],v[188:191]
 v_mfma_f32_16x16x32_bf16 v[180:183],a[156:159],a[56:59],v[180:183]
 v_mfma_f32_16x16x32_bf16 v[180:183],a[152:155],a[40:43],v[180:183]
 v_mfma_f32_16x16x32_bf16 v[172:175],a[152:155],a[36:39],v[172:175]
 buffer_load_dwordx4 a[20:23],v1,s[60:63],s40 offen offset:3072 sc1
 v_mfma_f32_16x16x32_bf16 v[172:175],a[156:159],a[52:55],v[172:175]
 v_mfma_f32_16x16x32_bf16 v[164:167],a[156:159],a[48:51],v[164:167]
 v_mfma_f32_16x16x32_bf16 v[164:167],a[152:155],a[32:35],v[164:167]
 s_waitcnt vmcnt(62) lgkmcnt(0)
 s_barrier
 v_mfma_f32_16x16x32_bf16 v[192:195],a[160:163],a[32:35],v[192:195]
 ds_read_b64_tr_b16 a[128:129],v16 offset:16384
 v_mfma_f32_16x16x32_bf16 v[192:195],a[164:167],a[48:51],v[192:195]
 s_mov_b32 s59,278528
 ds_read_b64_tr_b16 a[130:131],v16 offset:20480
 v_mfma_f32_16x16x32_bf16 v[200:203],a[164:167],a[52:55],v[200:203]
 buffer_load_dwordx4 a[8:11],v1,s[60:63],s59 offen offset:0 sc1
 v_mfma_f32_16x16x32_bf16 v[200:203],a[160:163],a[36:39],v[200:203]
 ds_read_b64_tr_b16 a[132:133],v16 offset:24576
 v_mfma_f32_16x16x32_bf16 v[208:211],a[160:163],a[40:43],v[208:211]
 ds_read_b64_tr_b16 a[134:135],v16 offset:28672
 v_mfma_f32_16x16x32_bf16 v[208:211],a[164:167],a[56:59],v[208:211]
 v_mfma_f32_16x16x32_bf16 v[216:219],a[164:167],a[60:63],v[216:219]
 ds_read_b64_tr_b16 a[136:137],v17 offset:16384
 v_mfma_f32_16x16x32_bf16 v[216:219],a[160:163],a[44:47],v[216:219]
 ds_read_b64_tr_b16 a[138:139],v17 offset:20480
 buffer_load_dwordx4 a[12:15],v1,s[60:63],s59 offen offset:1024 sc1
 v_mfma_f32_16x16x32_bf16 v[220:223],a[168:171],a[44:47],v[220:223]
 v_mfma_f32_16x16x32_bf16 v[220:223],a[172:175],a[60:63],v[220:223]
 ds_read_b64_tr_b16 a[140:141],v17 offset:24576
 v_mfma_f32_16x16x32_bf16 v[212:215],a[172:175],a[56:59],v[212:215]
 ds_read_b64_tr_b16 a[142:143],v17 offset:28672
 v_mfma_f32_16x16x32_bf16 v[212:215],a[168:171],a[40:43],v[212:215]
 v_mfma_f32_16x16x32_bf16 v[204:207],a[168:171],a[36:39],v[204:207]
 ds_read_b64_tr_b16 a[144:145],v18 offset:16384
 buffer_load_dwordx4 a[24:27],v1,s[60:63],s59 offen offset:2048 sc1
 v_mfma_f32_16x16x32_bf16 v[204:207],a[172:175],a[52:55],v[204:207]
 ds_read_b64_tr_b16 a[146:147],v18 offset:20480
 v_mfma_f32_16x16x32_bf16 v[196:199],a[172:175],a[48:51],v[196:199]
 v_mfma_f32_16x16x32_bf16 v[196:199],a[168:171],a[32:35],v[196:199]
 ds_read_b64_tr_b16 a[148:149],v18 offset:24576
 v_mfma_f32_16x16x32_bf16 v[224:227],a[176:179],a[32:35],v[224:227]
 ds_read_b64_tr_b16 a[150:151],v18 offset:28672
 v_mfma_f32_16x16x32_bf16 v[224:227],a[180:183],a[48:51],v[224:227]
 buffer_load_dwordx4 a[28:31],v1,s[60:63],s59 offen offset:3072 sc1
 v_mfma_f32_16x16x32_bf16 v[232:235],a[180:183],a[52:55],v[232:235]
 ds_read_b64_tr_b16 a[152:153],v19 offset:16384
 v_mfma_f32_16x16x32_bf16 v[232:235],a[176:179],a[36:39],v[232:235]
 ds_read_b64_tr_b16 a[154:155],v19 offset:20480
 v_mfma_f32_16x16x32_bf16 v[240:243],a[176:179],a[40:43],v[240:243]
 s_add_u32 m0,s3,65536
 v_mfma_f32_16x16x32_bf16 v[240:243],a[180:183],a[56:59],v[240:243]
 s_mov_b32 s41,655360
 ds_read_b64_tr_b16 a[156:157],v19 offset:24576
 v_mfma_f32_16x16x32_bf16 v[248:251],a[180:183],a[60:63],v[248:251]
 ds_read_b64_tr_b16 a[158:159],v19 offset:28672
 buffer_load_dwordx4 v32,s[8:11],s41 offen offset:0 lds
 v_mfma_f32_16x16x32_bf16 v[248:251],a[176:179],a[44:47],v[248:251]
 v_mfma_f32_16x16x32_bf16 v[252:255],a[184:187],a[44:47],v[252:255]
 v_mfma_f32_16x16x32_bf16 v[252:255],a[188:191],a[60:63],v[252:255]
 v_mfma_f32_16x16x32_bf16 v[244:247],a[188:191],a[56:59],v[244:247]
 v_mfma_f32_16x16x32_bf16 v[244:247],a[184:187],a[40:43],v[244:247]
 buffer_load_dwordx4 v33,s[8:11],s41 offen offset:1024 lds
 v_mfma_f32_16x16x32_bf16 v[236:239],a[184:187],a[36:39],v[236:239]
 v_mfma_f32_16x16x32_bf16 v[236:239],a[188:191],a[52:55],v[236:239]
 v_mfma_f32_16x16x32_bf16 v[228:231],a[188:191],a[48:51],v[228:231]
 v_mfma_f32_16x16x32_bf16 v[228:231],a[184:187],a[32:35],v[228:231]
 s_waitcnt vmcnt(23) lgkmcnt(0)
 s_cmp_eq_u32 s100,0
 s_cselect_b32 s44,4,4
L_oproj_loop:
 v_mfma_f32_16x16x32_bf16 v[128:131],a[128:131],a[64:67],v[128:131]
 ds_read_b64_tr_b16 a[160:161],v20 offset:16384
 v_mfma_f32_16x16x32_bf16 v[128:131],a[132:135],a[80:83],v[128:131]
 s_add_u32 s40,s40,4096
 ds_read_b64_tr_b16 a[162:163],v20 offset:20480
 v_mfma_f32_16x16x32_bf16 v[136:139],a[132:135],a[84:87],v[136:139]
 buffer_load_dwordx4 a[32:35],v1,s[60:63],s40 offen offset:0 sc1
 v_mfma_f32_16x16x32_bf16 v[136:139],a[128:131],a[68:71],v[136:139]
 ds_read_b64_tr_b16 a[164:165],v20 offset:24576
 v_mfma_f32_16x16x32_bf16 v[144:147],a[128:131],a[72:75],v[144:147]
 ds_read_b64_tr_b16 a[166:167],v20 offset:28672
 v_mfma_f32_16x16x32_bf16 v[144:147],a[132:135],a[88:91],v[144:147]
 v_mfma_f32_16x16x32_bf16 v[152:155],a[132:135],a[92:95],v[152:155]
 ds_read_b64_tr_b16 a[168:169],v21 offset:16384
 v_mfma_f32_16x16x32_bf16 v[152:155],a[128:131],a[76:79],v[152:155]
 ds_read_b64_tr_b16 a[170:171],v21 offset:20480
 buffer_load_dwordx4 v34,s[8:11],s41 offen offset:2048 lds
 v_mfma_f32_16x16x32_bf16 v[156:159],a[136:139],a[76:79],v[156:159]
 v_mfma_f32_16x16x32_bf16 v[156:159],a[140:143],a[92:95],v[156:159]
 ds_read_b64_tr_b16 a[172:173],v21 offset:24576
 v_mfma_f32_16x16x32_bf16 v[148:151],a[140:143],a[88:91],v[148:151]
 ds_read_b64_tr_b16 a[174:175],v21 offset:28672
 v_mfma_f32_16x16x32_bf16 v[148:151],a[136:139],a[72:75],v[148:151]
 v_mfma_f32_16x16x32_bf16 v[140:143],a[136:139],a[68:71],v[140:143]
 ds_read_b64_tr_b16 a[176:177],v22 offset:16384
 buffer_load_dwordx4 a[36:39],v1,s[60:63],s40 offen offset:1024 sc1
 v_mfma_f32_16x16x32_bf16 v[140:143],a[140:143],a[84:87],v[140:143]
 ds_read_b64_tr_b16 a[178:179],v22 offset:20480
 v_mfma_f32_16x16x32_bf16 v[132:135],a[140:143],a[80:83],v[132:135]
 v_mfma_f32_16x16x32_bf16 v[132:135],a[136:139],a[64:67],v[132:135]
 ds_read_b64_tr_b16 a[180:181],v22 offset:24576
 v_mfma_f32_16x16x32_bf16 v[160:163],a[144:147],a[64:67],v[160:163]
 ds_read_b64_tr_b16 a[182:183],v22 offset:28672
 v_mfma_f32_16x16x32_bf16 v[160:163],a[148:151],a[80:83],v[160:163]
 buffer_load_dwordx4 a[48:51],v1,s[60:63],s40 offen offset:2048 sc1
 v_mfma_f32_16x16x32_bf16 v[168:171],a[148:151],a[84:87],v[168:171]
 ds_read_b64_tr_b16 a[184:185],v23 offset:16384
 v_mfma_f32_16x16x32_bf16 v[168:171],a[144:147],a[68:71],v[168:171]
 ds_read_b64_tr_b16 a[186:187],v23 offset:20480
 v_mfma_f32_16x16x32_bf16 v[176:179],a[144:147],a[72:75],v[176:179]
 v_mfma_f32_16x16x32_bf16 v[176:179],a[148:151],a[88:91],v[176:179]
 ds_read_b64_tr_b16 a[188:189],v23 offset:24576
 v_mfma_f32_16x16x32_bf16 v[184:187],a[148:151],a[92:95],v[184:187]
 ds_read_b64_tr_b16 a[190:191],v23 offset:28672
 buffer_load_dwordx4 v35,s[8:11],s41 offen offset:3072 lds
 v_mfma_f32_16x16x32_bf16 v[184:187],a[144:147],a[76:79],v[184:187]
 v_mfma_f32_16x16x32_bf16 v[188:191],a[152:155],a[76:79],v[188:191]
 v_mfma_f32_16x16x32_bf16 v[188:191],a[156:159],a[92:95],v[188:191]
 v_mfma_f32_16x16x32_bf16 v[180:183],a[156:159],a[88:91],v[180:183]
 v_mfma_f32_16x16x32_bf16 v[180:183],a[152:155],a[72:75],v[180:183]
 buffer_load_dwordx4 a[52:55],v1,s[60:63],s40 offen offset:3072 sc1
 v_mfma_f32_16x16x32_bf16 v[172:175],a[152:155],a[68:71],v[172:175]
 v_mfma_f32_16x16x32_bf16 v[172:175],a[156:159],a[84:87],v[172:175]
 v_mfma_f32_16x16x32_bf16 v[164:167],a[156:159],a[80:83],v[164:167]
 v_mfma_f32_16x16x32_bf16 v[164:167],a[152:155],a[64:67],v[164:167]
 s_waitcnt vmcnt(25) lgkmcnt(0)
 s_barrier
 v_mfma_f32_16x16x32_bf16 v[192:195],a[160:163],a[64:67],v[192:195]
 ds_read_b64_tr_b16 a[128:129],v24 offset:16384
 v_mfma_f32_16x16x32_bf16 v[192:195],a[164:167],a[80:83],v[192:195]
 s_add_u32 s59,s40,262144
 ds_read_b64_tr_b16 a[130:131],v24 offset:20480
 v_mfma_f32_16x16x32_bf16 v[200:203],a[164:167],a[84:87],v[200:203]
 buffer_load_dwordx4 a[40:43],v1,s[60:63],s59 offen offset:0 sc1
 v_mfma_f32_16x16x32_bf16 v[200:203],a[160:163],a[68:71],v[200:203]
 ds_read_b64_tr_b16 a[132:133],v24 offset:24576
 v_mfma_f32_16x16x32_bf16 v[208:211],a[160:163],a[72:75],v[208:211]
 ds_read_b64_tr_b16 a[134:135],v24 offset:28672
 v_mfma_f32_16x16x32_bf16 v[208:211],a[164:167],a[88:91],v[208:211]
 s_add_u32 m0,s3,16384
 v_mfma_f32_16x16x32_bf16 v[216:219],a[164:167],a[92:95],v[216:219]
 s_add_u32 s41,s41,131072
 ds_read_b64_tr_b16 a[136:137],v25 offset:16384
 v_mfma_f32_16x16x32_bf16 v[216:219],a[160:163],a[76:79],v[216:219]
 ds_read_b64_tr_b16 a[138:139],v25 offset:20480
 buffer_load_dwordx4 v32,s[8:11],s41 offen offset:0 lds
 v_mfma_f32_16x16x32_bf16 v[220:223],a[168:171],a[76:79],v[220:223]
 v_mfma_f32_16x16x32_bf16 v[220:223],a[172:175],a[92:95],v[220:223]
 ds_read_b64_tr_b16 a[140:141],v25 offset:24576
 v_mfma_f32_16x16x32_bf16 v[212:215],a[172:175],a[88:91],v[212:215]
 ds_read_b64_tr_b16 a[142:143],v25 offset:28672
 v_mfma_f32_16x16x32_bf16 v[212:215],a[168:171],a[72:75],v[212:215]
 v_mfma_f32_16x16x32_bf16 v[204:207],a[168:171],a[68:71],v[204:207]
 ds_read_b64_tr_b16 a[144:145],v26 offset:16384
 buffer_load_dwordx4 a[44:47],v1,s[60:63],s59 offen offset:1024 sc1
 v_mfma_f32_16x16x32_bf16 v[204:207],a[172:175],a[84:87],v[204:207]
 ds_read_b64_tr_b16 a[146:147],v26 offset:20480
 v_mfma_f32_16x16x32_bf16 v[196:199],a[172:175],a[80:83],v[196:199]
 v_mfma_f32_16x16x32_bf16 v[196:199],a[168:171],a[64:67],v[196:199]
 ds_read_b64_tr_b16 a[148:149],v26 offset:24576
 v_mfma_f32_16x16x32_bf16 v[224:227],a[176:179],a[64:67],v[224:227]
 ds_read_b64_tr_b16 a[150:151],v26 offset:28672
 v_mfma_f32_16x16x32_bf16 v[224:227],a[180:183],a[80:83],v[224:227]
 buffer_load_dwordx4 a[56:59],v1,s[60:63],s59 offen offset:2048 sc1
 v_mfma_f32_16x16x32_bf16 v[232:235],a[180:183],a[84:87],v[232:235]
 ds_read_b64_tr_b16 a[152:153],v27 offset:16384
 v_mfma_f32_16x16x32_bf16 v[232:235],a[176:179],a[68:71],v[232:235]
 ds_read_b64_tr_b16 a[154:155],v27 offset:20480
 v_mfma_f32_16x16x32_bf16 v[240:243],a[176:179],a[72:75],v[240:243]
 v_mfma_f32_16x16x32_bf16 v[240:243],a[180:183],a[88:91],v[240:243]
 ds_read_b64_tr_b16 a[156:157],v27 offset:24576
 v_mfma_f32_16x16x32_bf16 v[248:251],a[180:183],a[92:95],v[248:251]
 ds_read_b64_tr_b16 a[158:159],v27 offset:28672
 buffer_load_dwordx4 v33,s[8:11],s41 offen offset:1024 lds
 v_mfma_f32_16x16x32_bf16 v[248:251],a[176:179],a[76:79],v[248:251]
 v_mfma_f32_16x16x32_bf16 v[252:255],a[184:187],a[76:79],v[252:255]
 v_mfma_f32_16x16x32_bf16 v[252:255],a[188:191],a[92:95],v[252:255]
 v_mfma_f32_16x16x32_bf16 v[244:247],a[188:191],a[88:91],v[244:247]
 v_mfma_f32_16x16x32_bf16 v[244:247],a[184:187],a[72:75],v[244:247]
 buffer_load_dwordx4 a[60:63],v1,s[60:63],s59 offen offset:3072 sc1
 v_mfma_f32_16x16x32_bf16 v[236:239],a[184:187],a[68:71],v[236:239]
 v_mfma_f32_16x16x32_bf16 v[236:239],a[188:191],a[84:87],v[236:239]
 v_mfma_f32_16x16x32_bf16 v[228:231],a[188:191],a[80:83],v[228:231]
 v_mfma_f32_16x16x32_bf16 v[228:231],a[184:187],a[64:67],v[228:231]
 s_waitcnt vmcnt(24) lgkmcnt(0)
 v_mfma_f32_16x16x32_bf16 v[128:131],a[128:131],a[96:99],v[128:131]
 ds_read_b64_tr_b16 a[160:161],v28 offset:16384
 v_mfma_f32_16x16x32_bf16 v[128:131],a[132:135],a[112:115],v[128:131]
 s_add_u32 s40,s40,4096
 ds_read_b64_tr_b16 a[162:163],v28 offset:20480
 v_mfma_f32_16x16x32_bf16 v[136:139],a[132:135],a[116:119],v[136:139]
 buffer_load_dwordx4 a[64:67],v1,s[60:63],s40 offen offset:0 sc1
 v_mfma_f32_16x16x32_bf16 v[136:139],a[128:131],a[100:103],v[136:139]
 ds_read_b64_tr_b16 a[164:165],v28 offset:24576
 v_mfma_f32_16x16x32_bf16 v[144:147],a[128:131],a[104:107],v[144:147]
 ds_read_b64_tr_b16 a[166:167],v28 offset:28672
 v_mfma_f32_16x16x32_bf16 v[144:147],a[132:135],a[120:123],v[144:147]
 v_mfma_f32_16x16x32_bf16 v[152:155],a[132:135],a[124:127],v[152:155]
 ds_read_b64_tr_b16 a[168:169],v29 offset:16384
 v_mfma_f32_16x16x32_bf16 v[152:155],a[128:131],a[108:111],v[152:155]
 ds_read_b64_tr_b16 a[170:171],v29 offset:20480
 buffer_load_dwordx4 v34,s[8:11],s41 offen offset:2048 lds
 v_mfma_f32_16x16x32_bf16 v[156:159],a[136:139],a[108:111],v[156:159]
 v_mfma_f32_16x16x32_bf16 v[156:159],a[140:143],a[124:127],v[156:159]
 ds_read_b64_tr_b16 a[172:173],v29 offset:24576
 v_mfma_f32_16x16x32_bf16 v[148:151],a[140:143],a[120:123],v[148:151]
 ds_read_b64_tr_b16 a[174:175],v29 offset:28672
 v_mfma_f32_16x16x32_bf16 v[148:151],a[136:139],a[104:107],v[148:151]
 v_mfma_f32_16x16x32_bf16 v[140:143],a[136:139],a[100:103],v[140:143]
 ds_read_b64_tr_b16 a[176:177],v30 offset:16384
 buffer_load_dwordx4 a[68:71],v1,s[60:63],s40 offen offset:1024 sc1
 v_mfma_f32_16x16x32_bf16 v[140:143],a[140:143],a[116:119],v[140:143]
 ds_read_b64_tr_b16 a[178:179],v30 offset:20480
 v_mfma_f32_16x16x32_bf16 v[132:135],a[140:143],a[112:115],v[132:135]
 v_mfma_f32_16x16x32_bf16 v[132:135],a[136:139],a[96:99],v[132:135]
 ds_read_b64_tr_b16 a[180:181],v30 offset:24576
 v_mfma_f32_16x16x32_bf16 v[160:163],a[144:147],a[96:99],v[160:163]
 ds_read_b64_tr_b16 a[182:183],v30 offset:28672
 v_mfma_f32_16x16x32_bf16 v[160:163],a[148:151],a[112:115],v[160:163]
 buffer_load_dwordx4 a[80:83],v1,s[60:63],s40 offen offset:2048 sc1
 v_mfma_f32_16x16x32_bf16 v[168:171],a[148:151],a[116:119],v[168:171]
 ds_read_b64_tr_b16 a[184:185],v31 offset:16384
 v_mfma_f32_16x16x32_bf16 v[168:171],a[144:147],a[100:103],v[168:171]
 ds_read_b64_tr_b16 a[186:187],v31 offset:20480
 v_mfma_f32_16x16x32_bf16 v[176:179],a[144:147],a[104:107],v[176:179]
 v_mfma_f32_16x16x32_bf16 v[176:179],a[148:151],a[120:123],v[176:179]
 ds_read_b64_tr_b16 a[188:189],v31 offset:24576
 v_mfma_f32_16x16x32_bf16 v[184:187],a[148:151],a[124:127],v[184:187]
L_stub_o_1:
 s_cbranch_execz L_stub_o_5
 ds_read_b64_tr_b16 a[190:191],v31 offset:28672
 buffer_load_dwordx4 v35,s[8:11],s41 offen offset:3072 lds
 v_mfma_f32_16x16x32_bf16 v[184:187],a[144:147],a[108:111],v[184:187]
 v_mfma_f32_16x16x32_bf16 v[188:191],a[152:155],a[108:111],v[188:191]
 v_mfma_f32_16x16x32_bf16 v[188:191],a[156:159],a[124:127],v[188:191]
 v_mfma_f32_16x16x32_bf16 v[180:183],a[156:159],a[120:123],v[180:183]
 v_mfma_f32_16x16x32_bf16 v[180:183],a[152:155],a[104:107],v[180:183]
 buffer_load_dwordx4 a[84:87],v1,s[60:63],s40 offen offset:3072 sc1
 v_mfma_f32_16x16x32_bf16 v[172:175],a[152:155],a[100:103],v[172:175]
 v_mfma_f32_16x16x32_bf16 v[172:175],a[156:159],a[116:119],v[172:175]
 v_mfma_f32_16x16x32_bf16 v[164:167],a[156:159],a[112:115],v[164:167]
 v_mfma_f32_16x16x32_bf16 v[164:167],a[152:155],a[96:99],v[164:167]
 s_waitcnt vmcnt(25) lgkmcnt(0)
 s_barrier
 v_mfma_f32_16x16x32_bf16 v[192:195],a[160:163],a[96:99],v[192:195]
 ds_read_b64_tr_b16 a[128:129],v16 offset:0
 v_mfma_f32_16x16x32_bf16 v[192:195],a[164:167],a[112:115],v[192:195]
 s_add_u32 s59,s40,262144
 ds_read_b64_tr_b16 a[130:131],v16 offset:4096
 v_mfma_f32_16x16x32_bf16 v[200:203],a[164:167],a[116:119],v[200:203]
 buffer_load_dwordx4 a[72:75],v1,s[60:63],s59 offen offset:0 sc1
 v_mfma_f32_16x16x32_bf16 v[200:203],a[160:163],a[100:103],v[200:203]
 ds_read_b64_tr_b16 a[132:133],v16 offset:8192
 v_mfma_f32_16x16x32_bf16 v[208:211],a[160:163],a[104:107],v[208:211]
 ds_read_b64_tr_b16 a[134:135],v16 offset:12288
 v_mfma_f32_16x16x32_bf16 v[208:211],a[164:167],a[120:123],v[208:211]
 s_add_u32 m0,s3,81920
 v_mfma_f32_16x16x32_bf16 v[216:219],a[164:167],a[124:127],v[216:219]
 s_add_u32 s41,s41,131072
 ds_read_b64_tr_b16 a[136:137],v17 offset:0
 v_mfma_f32_16x16x32_bf16 v[216:219],a[160:163],a[108:111],v[216:219]
 ds_read_b64_tr_b16 a[138:139],v17 offset:4096
 buffer_load_dwordx4 v32,s[8:11],s41 offen offset:0 lds
 v_mfma_f32_16x16x32_bf16 v[220:223],a[168:171],a[108:111],v[220:223]
 v_mfma_f32_16x16x32_bf16 v[220:223],a[172:175],a[124:127],v[220:223]
 ds_read_b64_tr_b16 a[140:141],v17 offset:8192
 v_mfma_f32_16x16x32_bf16 v[212:215],a[172:175],a[120:123],v[212:215]
 ds_read_b64_tr_b16 a[142:143],v17 offset:12288
 v_mfma_f32_16x16x32_bf16 v[212:215],a[168:171],a[104:107],v[212:215]
 v_mfma_f32_16x16x32_bf16 v[204:207],a[168:171],a[100:103],v[204:207]
 ds_read_b64_tr_b16 a[144:145],v18 offset:0
 buffer_load_dwordx4 a[76:79],v1,s[60:63],s59 offen offset:1024 sc1
 v_mfma_f32_16x16x32_bf16 v[204:207],a[172:175],a[116:119],v[204:207]
 ds_read_b64_tr_b16 a[146:147],v18 offset:4096
 v_mfma_f32_16x16x32_bf16 v[196:199],a[172:175],a[112:115],v[196:199]
 v_mfma_f32_16x16x32_bf16 v[196:199],a[168:171],a[96:99],v[196:199]
 ds_read_b64_tr_b16 a[148:149],v18 offset:8192
 v_mfma_f32_16x16x32_bf16 v[224:227],a[176:179],a[96:99],v[224:227]
 ds_read_b64_tr_b16 a[150:151],v18 offset:12288
 v_mfma_f32_16x16x32_bf16 v[224:227],a[180:183],a[112:115],v[224:227]
 buffer_load_dwordx4 a[88:91],v1,s[60:63],s59 offen offset:2048 sc1
 v_mfma_f32_16x16x32_bf16 v[232:235],a[180:183],a[116:119],v[232:235]
 ds_read_b64_tr_b16 a[152:153],v19 offset:0
 v_mfma_f32_16x16x32_bf16 v[232:235],a[176:179],a[100:103],v[232:235]
 ds_read_b64_tr_b16 a[154:155],v19 offset:4096
 v_mfma_f32_16x16x32_bf16 v[240:243],a[176:179],a[104:107],v[240:243]
 v_mfma_f32_16x16x32_bf16 v[240:243],a[180:183],a[120:123],v[240:243]
 ds_read_b64_tr_b16 a[156:157],v19 offset:8192
 v_mfma_f32_16x16x32_bf16 v[248:251],a[180:183],a[124:127],v[248:251]
 ds_read_b64_tr_b16 a[158:159],v19 offset:12288
 buffer_load_dwordx4 v33,s[8:11],s41 offen offset:1024 lds
 v_mfma_f32_16x16x32_bf16 v[248:251],a[176:179],a[108:111],v[248:251]
 v_mfma_f32_16x16x32_bf16 v[252:255],a[184:187],a[108:111],v[252:255]
 v_mfma_f32_16x16x32_bf16 v[252:255],a[188:191],a[124:127],v[252:255]
 v_mfma_f32_16x16x32_bf16 v[244:247],a[188:191],a[120:123],v[244:247]
 v_mfma_f32_16x16x32_bf16 v[244:247],a[184:187],a[104:107],v[244:247]
 buffer_load_dwordx4 a[92:95],v1,s[60:63],s59 offen offset:3072 sc1
 v_mfma_f32_16x16x32_bf16 v[236:239],a[184:187],a[100:103],v[236:239]
 v_mfma_f32_16x16x32_bf16 v[236:239],a[188:191],a[116:119],v[236:239]
 v_mfma_f32_16x16x32_bf16 v[228:231],a[188:191],a[112:115],v[228:231]
 v_mfma_f32_16x16x32_bf16 v[228:231],a[184:187],a[96:99],v[228:231]
 s_waitcnt vmcnt(24) lgkmcnt(0)
 v_mfma_f32_16x16x32_bf16 v[128:131],a[128:131],a[0:3],v[128:131]
 ds_read_b64_tr_b16 a[160:161],v20 offset:0
 v_mfma_f32_16x16x32_bf16 v[128:131],a[132:135],a[16:19],v[128:131]
 s_add_u32 s40,s40,4096
 ds_read_b64_tr_b16 a[162:163],v20 offset:4096
 v_mfma_f32_16x16x32_bf16 v[136:139],a[132:135],a[20:23],v[136:139]
 buffer_load_dwordx4 a[96:99],v1,s[60:63],s40 offen offset:0 sc1
 v_mfma_f32_16x16x32_bf16 v[136:139],a[128:131],a[4:7],v[136:139]
 ds_read_b64_tr_b16 a[164:165],v20 offset:8192
 v_mfma_f32_16x16x32_bf16 v[144:147],a[128:131],a[8:11],v[144:147]
 ds_read_b64_tr_b16 a[166:167],v20 offset:12288
 v_mfma_f32_16x16x32_bf16 v[144:147],a[132:135],a[24:27],v[144:147]
 v_mfma_f32_16x16x32_bf16 v[152:155],a[132:135],a[28:31],v[152:155]
 ds_read_b64_tr_b16 a[168:169],v21 offset:0
 v_mfma_f32_16x16x32_bf16 v[152:155],a[128:131],a[12:15],v[152:155]
 ds_read_b64_tr_b16 a[170:171],v21 offset:4096
 buffer_load_dwordx4 v34,s[8:11],s41 offen offset:2048 lds
 v_mfma_f32_16x16x32_bf16 v[156:159],a[136:139],a[12:15],v[156:159]
 v_mfma_f32_16x16x32_bf16 v[156:159],a[140:143],a[28:31],v[156:159]
 ds_read_b64_tr_b16 a[172:173],v21 offset:8192
 v_mfma_f32_16x16x32_bf16 v[148:151],a[140:143],a[24:27],v[148:151]
 ds_read_b64_tr_b16 a[174:175],v21 offset:12288
 v_mfma_f32_16x16x32_bf16 v[148:151],a[136:139],a[8:11],v[148:151]
 v_mfma_f32_16x16x32_bf16 v[140:143],a[136:139],a[4:7],v[140:143]
 ds_read_b64_tr_b16 a[176:177],v22 offset:0
 buffer_load_dwordx4 a[100:103],v1,s[60:63],s40 offen offset:1024 sc1
 v_mfma_f32_16x16x32_bf16 v[140:143],a[140:143],a[20:23],v[140:143]
 ds_read_b64_tr_b16 a[178:179],v22 offset:4096
 v_mfma_f32_16x16x32_bf16 v[132:135],a[140:143],a[16:19],v[132:135]
 v_mfma_f32_16x16x32_bf16 v[132:135],a[136:139],a[0:3],v[132:135]
 ds_read_b64_tr_b16 a[180:181],v22 offset:8192
 v_mfma_f32_16x16x32_bf16 v[160:163],a[144:147],a[0:3],v[160:163]
 ds_read_b64_tr_b16 a[182:183],v22 offset:12288
 v_mfma_f32_16x16x32_bf16 v[160:163],a[148:151],a[16:19],v[160:163]
 buffer_load_dwordx4 a[112:115],v1,s[60:63],s40 offen offset:2048 sc1
 v_mfma_f32_16x16x32_bf16 v[168:171],a[148:151],a[20:23],v[168:171]
 ds_read_b64_tr_b16 a[184:185],v23 offset:0
 v_mfma_f32_16x16x32_bf16 v[168:171],a[144:147],a[4:7],v[168:171]
 ds_read_b64_tr_b16 a[186:187],v23 offset:4096
 v_mfma_f32_16x16x32_bf16 v[176:179],a[144:147],a[8:11],v[176:179]
 v_mfma_f32_16x16x32_bf16 v[176:179],a[148:151],a[24:27],v[176:179]
 ds_read_b64_tr_b16 a[188:189],v23 offset:8192
 v_mfma_f32_16x16x32_bf16 v[184:187],a[148:151],a[28:31],v[184:187]
 ds_read_b64_tr_b16 a[190:191],v23 offset:12288
 buffer_load_dwordx4 v35,s[8:11],s41 offen offset:3072 lds
 v_mfma_f32_16x16x32_bf16 v[184:187],a[144:147],a[12:15],v[184:187]
 v_mfma_f32_16x16x32_bf16 v[188:191],a[152:155],a[12:15],v[188:191]
 v_mfma_f32_16x16x32_bf16 v[188:191],a[156:159],a[28:31],v[188:191]
 v_mfma_f32_16x16x32_bf16 v[180:183],a[156:159],a[24:27],v[180:183]
 v_mfma_f32_16x16x32_bf16 v[180:183],a[152:155],a[8:11],v[180:183]
 buffer_load_dwordx4 a[116:119],v1,s[60:63],s40 offen offset:3072 sc1
 v_mfma_f32_16x16x32_bf16 v[172:175],a[152:155],a[4:7],v[172:175]
 v_mfma_f32_16x16x32_bf16 v[172:175],a[156:159],a[20:23],v[172:175]
 v_mfma_f32_16x16x32_bf16 v[164:167],a[156:159],a[16:19],v[164:167]
 v_mfma_f32_16x16x32_bf16 v[164:167],a[152:155],a[0:3],v[164:167]
 s_waitcnt vmcnt(25) lgkmcnt(0)
 s_barrier
 v_mfma_f32_16x16x32_bf16 v[192:195],a[160:163],a[0:3],v[192:195]
 ds_read_b64_tr_b16 a[128:129],v24 offset:0
 v_mfma_f32_16x16x32_bf16 v[192:195],a[164:167],a[16:19],v[192:195]
 s_add_u32 s59,s40,262144
 ds_read_b64_tr_b16 a[130:131],v24 offset:4096
 v_mfma_f32_16x16x32_bf16 v[200:203],a[164:167],a[20:23],v[200:203]
 buffer_load_dwordx4 a[104:107],v1,s[60:63],s59 offen offset:0 sc1
 v_mfma_f32_16x16x32_bf16 v[200:203],a[160:163],a[4:7],v[200:203]
 ds_read_b64_tr_b16 a[132:133],v24 offset:8192
 v_mfma_f32_16x16x32_bf16 v[208:211],a[160:163],a[8:11],v[208:211]
 ds_read_b64_tr_b16 a[134:135],v24 offset:12288
 v_mfma_f32_16x16x32_bf16 v[208:211],a[164:167],a[24:27],v[208:211]
 s_add_u32 m0,s3,0
 v_mfma_f32_16x16x32_bf16 v[216:219],a[164:167],a[28:31],v[216:219]
 s_add_u32 s41,s41,131072
 ds_read_b64_tr_b16 a[136:137],v25 offset:0
 v_mfma_f32_16x16x32_bf16 v[216:219],a[160:163],a[12:15],v[216:219]
 ds_read_b64_tr_b16 a[138:139],v25 offset:4096
 buffer_load_dwordx4 v32,s[8:11],s41 offen offset:0 lds
 v_mfma_f32_16x16x32_bf16 v[220:223],a[168:171],a[12:15],v[220:223]
 v_mfma_f32_16x16x32_bf16 v[220:223],a[172:175],a[28:31],v[220:223]
 ds_read_b64_tr_b16 a[140:141],v25 offset:8192
 v_mfma_f32_16x16x32_bf16 v[212:215],a[172:175],a[24:27],v[212:215]
 ds_read_b64_tr_b16 a[142:143],v25 offset:12288
 v_mfma_f32_16x16x32_bf16 v[212:215],a[168:171],a[8:11],v[212:215]
 v_mfma_f32_16x16x32_bf16 v[204:207],a[168:171],a[4:7],v[204:207]
 ds_read_b64_tr_b16 a[144:145],v26 offset:0
 buffer_load_dwordx4 a[108:111],v1,s[60:63],s59 offen offset:1024 sc1
 v_mfma_f32_16x16x32_bf16 v[204:207],a[172:175],a[20:23],v[204:207]
 ds_read_b64_tr_b16 a[146:147],v26 offset:4096
 v_mfma_f32_16x16x32_bf16 v[196:199],a[172:175],a[16:19],v[196:199]
 v_mfma_f32_16x16x32_bf16 v[196:199],a[168:171],a[0:3],v[196:199]
 ds_read_b64_tr_b16 a[148:149],v26 offset:8192
 v_mfma_f32_16x16x32_bf16 v[224:227],a[176:179],a[0:3],v[224:227]
 ds_read_b64_tr_b16 a[150:151],v26 offset:12288
 v_mfma_f32_16x16x32_bf16 v[224:227],a[180:183],a[16:19],v[224:227]
 buffer_load_dwordx4 a[120:123],v1,s[60:63],s59 offen offset:2048 sc1
 v_mfma_f32_16x16x32_bf16 v[232:235],a[180:183],a[20:23],v[232:235]
 ds_read_b64_tr_b16 a[152:153],v27 offset:0
 v_mfma_f32_16x16x32_bf16 v[232:235],a[176:179],a[4:7],v[232:235]
 ds_read_b64_tr_b16 a[154:155],v27 offset:4096
 v_mfma_f32_16x16x32_bf16 v[240:243],a[176:179],a[8:11],v[240:243]
 v_mfma_f32_16x16x32_bf16 v[240:243],a[180:183],a[24:27],v[240:243]
 ds_read_b64_tr_b16 a[156:157],v27 offset:8192
 v_mfma_f32_16x16x32_bf16 v[248:251],a[180:183],a[28:31],v[248:251]
 ds_read_b64_tr_b16 a[158:159],v27 offset:12288
 buffer_load_dwordx4 v33,s[8:11],s41 offen offset:1024 lds
 v_mfma_f32_16x16x32_bf16 v[248:251],a[176:179],a[12:15],v[248:251]
 v_mfma_f32_16x16x32_bf16 v[252:255],a[184:187],a[12:15],v[252:255]
 v_mfma_f32_16x16x32_bf16 v[252:255],a[188:191],a[28:31],v[252:255]
 v_mfma_f32_16x16x32_bf16 v[244:247],a[188:191],a[24:27],v[244:247]
 v_mfma_f32_16x16x32_bf16 v[244:247],a[184:187],a[8:11],v[244:247]
 buffer_load_dwordx4 a[124:127],v1,s[60:63],s59 offen offset:3072 sc1
 v_mfma_f32_16x16x32_bf16 v[236:239],a[184:187],a[4:7],v[236:239]
 v_mfma_f32_16x16x32_bf16 v[236:239],a[188:191],a[20:23],v[236:239]
 v_mfma_f32_16x16x32_bf16 v[228:231],a[188:191],a[16:19],v[228:231]
 v_mfma_f32_16x16x32_bf16 v[228:231],a[184:187],a[0:3],v[228:231]
 s_waitcnt vmcnt(24) lgkmcnt(0)
 v_mfma_f32_16x16x32_bf16 v[128:131],a[128:131],a[32:35],v[128:131]
 ds_read_b64_tr_b16 a[160:161],v28 offset:0
 v_mfma_f32_16x16x32_bf16 v[128:131],a[132:135],a[48:51],v[128:131]
 s_add_u32 s40,s40,4096
 ds_read_b64_tr_b16 a[162:163],v28 offset:4096
 v_mfma_f32_16x16x32_bf16 v[136:139],a[132:135],a[52:55],v[136:139]
 buffer_load_dwordx4 a[0:3],v1,s[60:63],s40 offen offset:0 sc1
 v_mfma_f32_16x16x32_bf16 v[136:139],a[128:131],a[36:39],v[136:139]
 ds_read_b64_tr_b16 a[164:165],v28 offset:8192
 v_mfma_f32_16x16x32_bf16 v[144:147],a[128:131],a[40:43],v[144:147]
 ds_read_b64_tr_b16 a[166:167],v28 offset:12288
 v_mfma_f32_16x16x32_bf16 v[144:147],a[132:135],a[56:59],v[144:147]
 v_mfma_f32_16x16x32_bf16 v[152:155],a[132:135],a[60:63],v[152:155]
 ds_read_b64_tr_b16 a[168:169],v29 offset:0
 v_mfma_f32_16x16x32_bf16 v[152:155],a[128:131],a[44:47],v[152:155]
 ds_read_b64_tr_b16 a[170:171],v29 offset:4096
 buffer_load_dwordx4 v34,s[8:11],s41 offen offset:2048 lds
 v_mfma_f32_16x16x32_bf16 v[156:159],a[136:139],a[44:47],v[156:159]
 v_mfma_f32_16x16x32_bf16 v[156:159],a[140:143],a[60:63],v[156:159]
 ds_read_b64_tr_b16 a[172:173],v29 offset:8192
 v_mfma_f32_16x16x32_bf16 v[148:151],a[140:143],a[56:59],v[148:151]
 ds_read_b64_tr_b16 a[174:175],v29 offset:12288
 v_mfma_f32_16x16x32_bf16 v[148:151],a[136:139],a[40:43],v[148:151]
 v_mfma_f32_16x16x32_bf16 v[140:143],a[136:139],a[36:39],v[140:143]
 ds_read_b64_tr_b16 a[176:177],v30 offset:0
 buffer_load_dwordx4 a[4:7],v1,s[60:63],s40 offen offset:1024 sc1
 v_mfma_f32_16x16x32_bf16 v[140:143],a[140:143],a[52:55],v[140:143]
 ds_read_b64_tr_b16 a[178:179],v30 offset:4096
 v_mfma_f32_16x16x32_bf16 v[132:135],a[140:143],a[48:51],v[132:135]
 v_mfma_f32_16x16x32_bf16 v[132:135],a[136:139],a[32:35],v[132:135]
 ds_read_b64_tr_b16 a[180:181],v30 offset:8192
 v_mfma_f32_16x16x32_bf16 v[160:163],a[144:147],a[32:35],v[160:163]
 ds_read_b64_tr_b16 a[182:183],v30 offset:12288
 v_mfma_f32_16x16x32_bf16 v[160:163],a[148:151],a[48:51],v[160:163]
 buffer_load_dwordx4 a[16:19],v1,s[60:63],s40 offen offset:2048 sc1
 v_mfma_f32_16x16x32_bf16 v[168:171],a[148:151],a[52:55],v[168:171]
 ds_read_b64_tr_b16 a[184:185],v31 offset:0
 v_mfma_f32_16x16x32_bf16 v[168:171],a[144:147],a[36:39],v[168:171]
 ds_read_b64_tr_b16 a[186:187],v31 offset:4096
 v_mfma_f32_16x16x32_bf16 v[176:179],a[144:147],a[40:43],v[176:179]
 v_mfma_f32_16x16x32_bf16 v[176:179],a[148:151],a[56:59],v[176:179]
 ds_read_b64_tr_b16 a[188:189],v31 offset:8192
 v_mfma_f32_16x16x32_bf16 v[184:187],a[148:151],a[60:63],v[184:187]
 ds_read_b64_tr_b16 a[190:191],v31 offset:12288
 buffer_load_dwordx4 v35,s[8:11],s41 offen offset:3072 lds
 v_mfma_f32_16x16x32_bf16 v[184:187],a[144:147],a[44:47],v[184:187]
 v_mfma_f32_16x16x32_bf16 v[188:191],a[152:155],a[44:47],v[188:191]
 v_mfma_f32_16x16x32_bf16 v[188:191],a[156:159],a[60:63],v[188:191]
 v_mfma_f32_16x16x32_bf16 v[180:183],a[156:159],a[56:59],v[180:183]
 v_mfma_f32_16x16x32_bf16 v[180:183],a[152:155],a[40:43],v[180:183]
 buffer_load_dwordx4 a[20:23],v1,s[60:63],s40 offen offset:3072 sc1
 v_mfma_f32_16x16x32_bf16 v[172:175],a[152:155],a[36:39],v[172:175]
 v_mfma_f32_16x16x32_bf16 v[172:175],a[156:159],a[52:55],v[172:175]
 v_mfma_f32_16x16x32_bf16 v[164:167],a[156:159],a[48:51],v[164:167]
 v_mfma_f32_16x16x32_bf16 v[164:167],a[152:155],a[32:35],v[164:167]
 s_waitcnt vmcnt(25) lgkmcnt(0)
 s_barrier
 v_mfma_f32_16x16x32_bf16 v[192:195],a[160:163],a[32:35],v[192:195]
 ds_read_b64_tr_b16 a[128:129],v16 offset:16384
 v_mfma_f32_16x16x32_bf16 v[192:195],a[164:167],a[48:51],v[192:195]
 s_add_u32 s59,s40,262144
 ds_read_b64_tr_b16 a[130:131],v16 offset:20480
 v_mfma_f32_16x16x32_bf16 v[200:203],a[164:167],a[52:55],v[200:203]
 buffer_load_dwordx4 a[8:11],v1,s[60:63],s59 offen offset:0 sc1
 v_mfma_f32_16x16x32_bf16 v[200:203],a[160:163],a[36:39],v[200:203]
 ds_read_b64_tr_b16 a[132:133],v16 offset:24576
 v_mfma_f32_16x16x32_bf16 v[208:211],a[160:163],a[40:43],v[208:211]
 ds_read_b64_tr_b16 a[134:135],v16 offset:28672
 v_mfma_f32_16x16x32_bf16 v[208:211],a[164:167],a[56:59],v[208:211]
 s_add_u32 m0,s3,65536
 v_mfma_f32_16x16x32_bf16 v[216:219],a[164:167],a[60:63],v[216:219]
 s_add_u32 s41,s41,131072
 ds_read_b64_tr_b16 a[136:137],v17 offset:16384
 v_mfma_f32_16x16x32_bf16 v[216:219],a[160:163],a[44:47],v[216:219]
 ds_read_b64_tr_b16 a[138:139],v17 offset:20480
 buffer_load_dwordx4 v32,s[8:11],s41 offen offset:0 lds
 v_mfma_f32_16x16x32_bf16 v[220:223],a[168:171],a[44:47],v[220:223]
 v_mfma_f32_16x16x32_bf16 v[220:223],a[172:175],a[60:63],v[220:223]
 ds_read_b64_tr_b16 a[140:141],v17 offset:24576
 v_mfma_f32_16x16x32_bf16 v[212:215],a[172:175],a[56:59],v[212:215]
 ds_read_b64_tr_b16 a[142:143],v17 offset:28672
 v_mfma_f32_16x16x32_bf16 v[212:215],a[168:171],a[40:43],v[212:215]
 v_mfma_f32_16x16x32_bf16 v[204:207],a[168:171],a[36:39],v[204:207]
 ds_read_b64_tr_b16 a[144:145],v18 offset:16384
 buffer_load_dwordx4 a[12:15],v1,s[60:63],s59 offen offset:1024 sc1
 v_mfma_f32_16x16x32_bf16 v[204:207],a[172:175],a[52:55],v[204:207]
 ds_read_b64_tr_b16 a[146:147],v18 offset:20480
 v_mfma_f32_16x16x32_bf16 v[196:199],a[172:175],a[48:51],v[196:199]
 v_mfma_f32_16x16x32_bf16 v[196:199],a[168:171],a[32:35],v[196:199]
 ds_read_b64_tr_b16 a[148:149],v18 offset:24576
 v_mfma_f32_16x16x32_bf16 v[224:227],a[176:179],a[32:35],v[224:227]
 ds_read_b64_tr_b16 a[150:151],v18 offset:28672
 v_mfma_f32_16x16x32_bf16 v[224:227],a[180:183],a[48:51],v[224:227]
 buffer_load_dwordx4 a[24:27],v1,s[60:63],s59 offen offset:2048 sc1
 v_mfma_f32_16x16x32_bf16 v[232:235],a[180:183],a[52:55],v[232:235]
 ds_read_b64_tr_b16 a[152:153],v19 offset:16384
 v_mfma_f32_16x16x32_bf16 v[232:235],a[176:179],a[36:39],v[232:235]
 ds_read_b64_tr_b16 a[154:155],v19 offset:20480
 v_mfma_f32_16x16x32_bf16 v[240:243],a[176:179],a[40:43],v[240:243]
 v_mfma_f32_16x16x32_bf16 v[240:243],a[180:183],a[56:59],v[240:243]
 ds_read_b64_tr_b16 a[156:157],v19 offset:24576
 v_mfma_f32_16x16x32_bf16 v[248:251],a[180:183],a[60:63],v[248:251]
 ds_read_b64_tr_b16 a[158:159],v19 offset:28672
 buffer_load_dwordx4 v33,s[8:11],s41 offen offset:1024 lds
 v_mfma_f32_16x16x32_bf16 v[248:251],a[176:179],a[44:47],v[248:251]
 v_mfma_f32_16x16x32_bf16 v[252:255],a[184:187],a[44:47],v[252:255]
 v_mfma_f32_16x16x32_bf16 v[252:255],a[188:191],a[60:63],v[252:255]
 v_mfma_f32_16x16x32_bf16 v[244:247],a[188:191],a[56:59],v[244:247]
 v_mfma_f32_16x16x32_bf16 v[244:247],a[184:187],a[40:43],v[244:247]
 buffer_load_dwordx4 a[28:31],v1,s[60:63],s59 offen offset:3072 sc1
 v_mfma_f32_16x16x32_bf16 v[236:239],a[184:187],a[36:39],v[236:239]
 s_sub_u32 s44,s44,1
 v_mfma_f32_16x16x32_bf16 v[236:239],a[188:191],a[52:55],v[236:239]
 s_cmp_lg_u32 s44,0
 v_mfma_f32_16x16x32_bf16 v[228:231],a[188:191],a[48:51],v[228:231]
 v_mfma_f32_16x16x32_bf16 v[228:231],a[184:187],a[32:35],v[228:231]
 s_waitcnt vmcnt(24) lgkmcnt(0)
 s_cbranch_scc1 L_oproj_loop
 s_mov_b32 s77,s40
 s_mov_b32 s58,s41
 v_mfma_f32_16x16x32_bf16 v[128:131],a[128:131],a[64:67],v[128:131]
 ds_read_b64_tr_b16 a[160:161],v20 offset:16384
 v_mfma_f32_16x16x32_bf16 v[128:131],a[132:135],a[80:83],v[128:131]
 ds_read_b64_tr_b16 a[162:163],v20 offset:20480
 v_mfma_f32_16x16x32_bf16 v[136:139],a[132:135],a[84:87],v[136:139]
 buffer_load_dwordx4 v34,s[8:11],s41 offen offset:2048 lds
 v_mfma_f32_16x16x32_bf16 v[136:139],a[128:131],a[68:71],v[136:139]
 ds_read_b64_tr_b16 a[164:165],v20 offset:24576
 v_mfma_f32_16x16x32_bf16 v[144:147],a[128:131],a[72:75],v[144:147]
 ds_read_b64_tr_b16 a[166:167],v20 offset:28672
 v_mfma_f32_16x16x32_bf16 v[144:147],a[132:135],a[88:91],v[144:147]
 v_mfma_f32_16x16x32_bf16 v[152:155],a[132:135],a[92:95],v[152:155]
 ds_read_b64_tr_b16 a[168:169],v21 offset:16384
 buffer_load_dwordx4 v35,s[8:11],s41 offen offset:3072 lds
 v_mfma_f32_16x16x32_bf16 v[152:155],a[128:131],a[76:79],v[152:155]
 ds_read_b64_tr_b16 a[170:171],v21 offset:20480
 v_mfma_f32_16x16x32_bf16 v[156:159],a[136:139],a[76:79],v[156:159]
 v_mfma_f32_16x16x32_bf16 v[156:159],a[140:143],a[92:95],v[156:159]
 s_add_u32 s40,s77,4096
 ds_read_b64_tr_b16 a[172:173],v21 offset:24576
 v_mfma_f32_16x16x32_bf16 v[148:151],a[140:143],a[88:91],v[148:151]
 ds_read_b64_tr_b16 a[174:175],v21 offset:28672
 buffer_load_dwordx4 a[32:35],v1,s[60:63],s40 offen offset:0 sc1
 v_mfma_f32_16x16x32_bf16 v[148:151],a[136:139],a[72:75],v[148:151]
 v_mfma_f32_16x16x32_bf16 v[140:143],a[136:139],a[68:71],v[140:143]
 ds_read_b64_tr_b16 a[176:177],v22 offset:16384
 v_mfma_f32_16x16x32_bf16 v[140:143],a[140:143],a[84:87],v[140:143]
 ds_read_b64_tr_b16 a[178:179],v22 offset:20480
 v_mfma_f32_16x16x32_bf16 v[132:135],a[140:143],a[80:83],v[132:135]
 buffer_load_dwordx4 a[36:39],v1,s[60:63],s40 offen offset:1024 sc1
 v_mfma_f32_16x16x32_bf16 v[132:135],a[136:139],a[64:67],v[132:135]
 ds_read_b64_tr_b16 a[180:181],v22 offset:24576
 v_mfma_f32_16x16x32_bf16 v[160:163],a[144:147],a[64:67],v[160:163]
 ds_read_b64_tr_b16 a[182:183],v22 offset:28672
 v_mfma_f32_16x16x32_bf16 v[160:163],a[148:151],a[80:83],v[160:163]
 v_mfma_f32_16x16x32_bf16 v[168:171],a[148:151],a[84:87],v[168:171]
 ds_read_b64_tr_b16 a[184:185],v23 offset:16384
 v_mfma_f32_16x16x32_bf16 v[168:171],a[144:147],a[68:71],v[168:171]
 ds_read_b64_tr_b16 a[186:187],v23 offset:20480
 buffer_load_dwordx4 a[48:51],v1,s[60:63],s40 offen offset:2048 sc1
 v_mfma_f32_16x16x32_bf16 v[176:179],a[144:147],a[72:75],v[176:179]
 v_mfma_f32_16x16x32_bf16 v[176:179],a[148:151],a[88:91],v[176:179]
 ds_read_b64_tr_b16 a[188:189],v23 offset:24576
 v_mfma_f32_16x16x32_bf16 v[184:187],a[148:151],a[92:95],v[184:187]
 ds_read_b64_tr_b16 a[190:191],v23 offset:28672
 v_mfma_f32_16x16x32_bf16 v[184:187],a[144:147],a[76:79],v[184:187]
 buffer_load_dwordx4 a[52:55],v1,s[60:63],s40 offen offset:3072 sc1
 v_mfma_f32_16x16x32_bf16 v[188:191],a[152:155],a[76:79],v[188:191]
 v_mfma_f32_16x16x32_bf16 v[188:191],a[156:159],a[92:95],v[188:191]
 v_mfma_f32_16x16x32_bf16 v[180:183],a[156:159],a[88:91],v[180:183]
 s_add_u32 s59,s77,266240
 v_mfma_f32_16x16x32_bf16 v[180:183],a[152:155],a[72:75],v[180:183]
 buffer_load_dwordx4 a[40:43],v1,s[60:63],s59 offen offset:0 sc1
 v_mfma_f32_16x16x32_bf16 v[172:175],a[152:155],a[68:71],v[172:175]
 v_mfma_f32_16x16x32_bf16 v[172:175],a[156:159],a[84:87],v[172:175]
 v_mfma_f32_16x16x32_bf16 v[164:167],a[156:159],a[80:83],v[164:167]
 v_mfma_f32_16x16x32_bf16 v[164:167],a[152:155],a[64:67],v[164:167]
 s_waitcnt vmcnt(26) lgkmcnt(0)
 s_barrier
 v_mfma_f32_16x16x32_bf16 v[192:195],a[160:163],a[64:67],v[192:195]
 ds_read_b64_tr_b16 a[128:129],v24 offset:16384
 v_mfma_f32_16x16x32_bf16 v[192:195],a[164:167],a[80:83],v[192:195]
 ds_read_b64_tr_b16 a[130:131],v24 offset:20480
 v_mfma_f32_16x16x32_bf16 v[200:203],a[164:167],a[84:87],v[200:203]
 buffer_load_dwordx4 a[44:47],v1,s[60:63],s59 offen offset:1024 sc1
 v_mfma_f32_16x16x32_bf16 v[200:203],a[160:163],a[68:71],v[200:203]
 ds_read_b64_tr_b16 a[132:133],v24 offset:24576
 v_mfma_f32_16x16x32_bf16 v[208:211],a[160:163],a[72:75],v[208:211]
 ds_read_b64_tr_b16 a[134:135],v24 offset:28672
 v_mfma_f32_16x16x32_bf16 v[208:211],a[164:167],a[88:91],v[208:211]
 v_mfma_f32_16x16x32_bf16 v[216:219],a[164:167],a[92:95],v[216:219]
 ds_read_b64_tr_b16 a[136:137],v25 offset:16384
 buffer_load_dwordx4 a[56:59],v1,s[60:63],s59 offen offset:2048 sc1
 v_mfma_f32_16x16x32_bf16 v[216:219],a[160:163],a[76:79],v[216:219]
 ds_read_b64_tr_b16 a[138:139],v25 offset:20480
 v_mfma_f32_16x16x32_bf16 v[220:223],a[168:171],a[76:79],v[220:223]
 v_mfma_f32_16x16x32_bf16 v[220:223],a[172:175],a[92:95],v[220:223]
 ds_read_b64_tr_b16 a[140:141],v25 offset:24576
 v_mfma_f32_16x16x32_bf16 v[212:215],a[172:175],a[88:91],v[212:215]
 ds_read_b64_tr_b16 a[142:143],v25 offset:28672
 buffer_load_dwordx4 a[60:63],v1,s[60:63],s59 offen offset:3072 sc1
 v_mfma_f32_16x16x32_bf16 v[212:215],a[168:171],a[72:75],v[212:215]
 v_mfma_f32_16x16x32_bf16 v[204:207],a[168:171],a[68:71],v[204:207]
 s_add_u32 m0,s3,16384
 ds_read_b64_tr_b16 a[144:145],v26 offset:16384
 v_mfma_f32_16x16x32_bf16 v[204:207],a[172:175],a[84:87],v[204:207]
 s_add_u32 s41,s58,131072
 ds_read_b64_tr_b16 a[146:147],v26 offset:20480
 v_mfma_f32_16x16x32_bf16 v[196:199],a[172:175],a[80:83],v[196:199]
 buffer_load_dwordx4 v32,s[8:11],s41 offen offset:0 lds
 v_mfma_f32_16x16x32_bf16 v[196:199],a[168:171],a[64:67],v[196:199]
 ds_read_b64_tr_b16 a[148:149],v26 offset:24576
 v_mfma_f32_16x16x32_bf16 v[224:227],a[176:179],a[64:67],v[224:227]
 ds_read_b64_tr_b16 a[150:151],v26 offset:28672
 v_mfma_f32_16x16x32_bf16 v[224:227],a[180:183],a[80:83],v[224:227]
 v_mfma_f32_16x16x32_bf16 v[232:235],a[180:183],a[84:87],v[232:235]
 ds_read_b64_tr_b16 a[152:153],v27 offset:16384
 v_mfma_f32_16x16x32_bf16 v[232:235],a[176:179],a[68:71],v[232:235]
 ds_read_b64_tr_b16 a[154:155],v27 offset:20480
 buffer_load_dwordx4 v33,s[8:11],s41 offen offset:1024 lds
 v_mfma_f32_16x16x32_bf16 v[240:243],a[176:179],a[72:75],v[240:243]
 v_mfma_f32_16x16x32_bf16 v[240:243],a[180:183],a[88:91],v[240:243]
 ds_read_b64_tr_b16 a[156:157],v27 offset:24576
 v_mfma_f32_16x16x32_bf16 v[248:251],a[180:183],a[92:95],v[248:251]
 ds_read_b64_tr_b16 a[158:159],v27 offset:28672
 v_mfma_f32_16x16x32_bf16 v[248:251],a[176:179],a[76:79],v[248:251]
 buffer_load_dwordx4 v34,s[8:11],s41 offen offset:2048 lds
 v_mfma_f32_16x16x32_bf16 v[252:255],a[184:187],a[76:79],v[252:255]
 v_mfma_f32_16x16x32_bf16 v[252:255],a[188:191],a[92:95],v[252:255]
 v_mfma_f32_16x16x32_bf16 v[244:247],a[188:191],a[88:91],v[244:247]
 v_mfma_f32_16x16x32_bf16 v[244:247],a[184:187],a[72:75],v[244:247]
 buffer_load_dwordx4 v35,s[8:11],s41 offen offset:3072 lds
 v_mfma_f32_16x16x32_bf16 v[236:239],a[184:187],a[68:71],v[236:239]
 v_mfma_f32_16x16x32_bf16 v[236:239],a[188:191],a[84:87],v[236:239]
 v_mfma_f32_16x16x32_bf16 v[228:231],a[188:191],a[80:83],v[228:231]
 v_mfma_f32_16x16x32_bf16 v[228:231],a[184:187],a[64:67],v[228:231]
 s_waitcnt vmcnt(26) lgkmcnt(0)
 v_mfma_f32_16x16x32_bf16 v[128:131],a[128:131],a[96:99],v[128:131]
 ds_read_b64_tr_b16 a[160:161],v28 offset:16384
 v_mfma_f32_16x16x32_bf16 v[128:131],a[132:135],a[112:115],v[128:131]
 s_add_u32 s40,s77,8192
 ds_read_b64_tr_b16 a[162:163],v28 offset:20480
 v_mfma_f32_16x16x32_bf16 v[136:139],a[132:135],a[116:119],v[136:139]
 buffer_load_dwordx4 a[64:67],v1,s[60:63],s40 offen offset:0 sc1
 v_mfma_f32_16x16x32_bf16 v[136:139],a[128:131],a[100:103],v[136:139]
 ds_read_b64_tr_b16 a[164:165],v28 offset:24576
 v_mfma_f32_16x16x32_bf16 v[144:147],a[128:131],a[104:107],v[144:147]
 ds_read_b64_tr_b16 a[166:167],v28 offset:28672
 v_mfma_f32_16x16x32_bf16 v[144:147],a[132:135],a[120:123],v[144:147]
 v_mfma_f32_16x16x32_bf16 v[152:155],a[132:135],a[124:127],v[152:155]
 ds_read_b64_tr_b16 a[168:169],v29 offset:16384
 buffer_load_dwordx4 a[68:71],v1,s[60:63],s40 offen offset:1024 sc1
 v_mfma_f32_16x16x32_bf16 v[152:155],a[128:131],a[108:111],v[152:155]
 ds_read_b64_tr_b16 a[170:171],v29 offset:20480
 v_mfma_f32_16x16x32_bf16 v[156:159],a[136:139],a[108:111],v[156:159]
 v_mfma_f32_16x16x32_bf16 v[156:159],a[140:143],a[124:127],v[156:159]
 ds_read_b64_tr_b16 a[172:173],v29 offset:24576
 v_mfma_f32_16x16x32_bf16 v[148:151],a[140:143],a[120:123],v[148:151]
 ds_read_b64_tr_b16 a[174:175],v29 offset:28672
 buffer_load_dwordx4 a[80:83],v1,s[60:63],s40 offen offset:2048 sc1
 v_mfma_f32_16x16x32_bf16 v[148:151],a[136:139],a[104:107],v[148:151]
 v_mfma_f32_16x16x32_bf16 v[140:143],a[136:139],a[100:103],v[140:143]
 ds_read_b64_tr_b16 a[176:177],v30 offset:16384
 v_mfma_f32_16x16x32_bf16 v[140:143],a[140:143],a[116:119],v[140:143]
 ds_read_b64_tr_b16 a[178:179],v30 offset:20480
 v_mfma_f32_16x16x32_bf16 v[132:135],a[140:143],a[112:115],v[132:135]
 buffer_load_dwordx4 a[84:87],v1,s[60:63],s40 offen offset:3072 sc1
 v_mfma_f32_16x16x32_bf16 v[132:135],a[136:139],a[96:99],v[132:135]
 ds_read_b64_tr_b16 a[180:181],v30 offset:24576
 v_mfma_f32_16x16x32_bf16 v[160:163],a[144:147],a[96:99],v[160:163]
 ds_read_b64_tr_b16 a[182:183],v30 offset:28672
 v_mfma_f32_16x16x32_bf16 v[160:163],a[148:151],a[112:115],v[160:163]
 v_mfma_f32_16x16x32_bf16 v[168:171],a[148:151],a[116:119],v[168:171]
 s_add_u32 s59,s77,270336
 ds_read_b64_tr_b16 a[184:185],v31 offset:16384
 v_mfma_f32_16x16x32_bf16 v[168:171],a[144:147],a[100:103],v[168:171]
 ds_read_b64_tr_b16 a[186:187],v31 offset:20480
 buffer_load_dwordx4 a[72:75],v1,s[60:63],s59 offen offset:0 sc1
 v_mfma_f32_16x16x32_bf16 v[176:179],a[144:147],a[104:107],v[176:179]
 v_mfma_f32_16x16x32_bf16 v[176:179],a[148:151],a[120:123],v[176:179]
 ds_read_b64_tr_b16 a[188:189],v31 offset:24576
 v_mfma_f32_16x16x32_bf16 v[184:187],a[148:151],a[124:127],v[184:187]
 ds_read_b64_tr_b16 a[190:191],v31 offset:28672
 v_mfma_f32_16x16x32_bf16 v[184:187],a[144:147],a[108:111],v[184:187]
 buffer_load_dwordx4 a[76:79],v1,s[60:63],s59 offen offset:1024 sc1
 v_mfma_f32_16x16x32_bf16 v[188:191],a[152:155],a[108:111],v[188:191]
 v_mfma_f32_16x16x32_bf16 v[188:191],a[156:159],a[124:127],v[188:191]
 v_mfma_f32_16x16x32_bf16 v[180:183],a[156:159],a[120:123],v[180:183]
 v_mfma_f32_16x16x32_bf16 v[180:183],a[152:155],a[104:107],v[180:183]
 buffer_load_dwordx4 a[88:91],v1,s[60:63],s59 offen offset:2048 sc1
 v_mfma_f32_16x16x32_bf16 v[172:175],a[152:155],a[100:103],v[172:175]
 v_mfma_f32_16x16x32_bf16 v[172:175],a[156:159],a[116:119],v[172:175]
 v_mfma_f32_16x16x32_bf16 v[164:167],a[156:159],a[112:115],v[164:167]
 v_mfma_f32_16x16x32_bf16 v[164:167],a[152:155],a[96:99],v[164:167]
 s_waitcnt vmcnt(28) lgkmcnt(0)
 s_barrier
 v_mfma_f32_16x16x32_bf16 v[192:195],a[160:163],a[96:99],v[192:195]
 ds_read_b64_tr_b16 a[128:129],v16 offset:0
 v_mfma_f32_16x16x32_bf16 v[192:195],a[164:167],a[112:115],v[192:195]
 ds_read_b64_tr_b16 a[130:131],v16 offset:4096
 v_mfma_f32_16x16x32_bf16 v[200:203],a[164:167],a[116:119],v[200:203]
 buffer_load_dwordx4 a[92:95],v1,s[60:63],s59 offen offset:3072 sc1
 v_mfma_f32_16x16x32_bf16 v[200:203],a[160:163],a[100:103],v[200:203]
 ds_read_b64_tr_b16 a[132:133],v16 offset:8192
 v_mfma_f32_16x16x32_bf16 v[208:211],a[160:163],a[104:107],v[208:211]
 s_add_u32 m0,s3,81920
 ds_read_b64_tr_b16 a[134:135],v16 offset:12288
 v_mfma_f32_16x16x32_bf16 v[208:211],a[164:167],a[120:123],v[208:211]
 s_add_u32 s41,s58,262144
 v_mfma_f32_16x16x32_bf16 v[216:219],a[164:167],a[124:127],v[216:219]
 ds_read_b64_tr_b16 a[136:137],v17 offset:0
 buffer_load_dwordx4 v32,s[8:11],s41 offen offset:0 lds
 v_mfma_f32_16x16x32_bf16 v[216:219],a[160:163],a[108:111],v[216:219]
 ds_read_b64_tr_b16 a[138:139],v17 offset:4096
 v_mfma_f32_16x16x32_bf16 v[220:223],a[168:171],a[108:111],v[220:223]
 v_mfma_f32_16x16x32_bf16 v[220:223],a[172:175],a[124:127],v[220:223]
 ds_read_b64_tr_b16 a[140:141],v17 offset:8192
 v_mfma_f32_16x16x32_bf16 v[212:215],a[172:175],a[120:123],v[212:215]
 ds_read_b64_tr_b16 a[142:143],v17 offset:12288
 buffer_load_dwordx4 v33,s[8:11],s41 offen offset:1024 lds
 v_mfma_f32_16x16x32_bf16 v[212:215],a[168:171],a[104:107],v[212:215]
 v_mfma_f32_16x16x32_bf16 v[204:207],a[168:171],a[100:103],v[204:207]
 ds_read_b64_tr_b16 a[144:145],v18 offset:0
 v_mfma_f32_16x16x32_bf16 v[204:207],a[172:175],a[116:119],v[204:207]
 ds_read_b64_tr_b16 a[146:147],v18 offset:4096
 v_mfma_f32_16x16x32_bf16 v[196:199],a[172:175],a[112:115],v[196:199]
 buffer_load_dwordx4 v34,s[8:11],s41 offen offset:2048 lds
 v_mfma_f32_16x16x32_bf16 v[196:199],a[168:171],a[96:99],v[196:199]
 ds_read_b64_tr_b16 a[148:149],v18 offset:8192
 v_mfma_f32_16x16x32_bf16 v[224:227],a[176:179],a[96:99],v[224:227]
 ds_read_b64_tr_b16 a[150:151],v18 offset:12288
 v_mfma_f32_16x16x32_bf16 v[224:227],a[180:183],a[112:115],v[224:227]
 v_mfma_f32_16x16x32_bf16 v[232:235],a[180:183],a[116:119],v[232:235]
 ds_read_b64_tr_b16 a[152:153],v19 offset:0
 v_mfma_f32_16x16x32_bf16 v[232:235],a[176:179],a[100:103],v[232:235]
L_stub_o_2:
 s_cbranch_execz L_warm_o_ret
 ds_read_b64_tr_b16 a[154:155],v19 offset:4096
 buffer_load_dwordx4 v35,s[8:11],s41 offen offset:3072 lds
 v_mfma_f32_16x16x32_bf16 v[240:243],a[176:179],a[104:107],v[240:243]
 v_mfma_f32_16x16x32_bf16 v[240:243],a[180:183],a[120:123],v[240:243]
 s_add_u32 m0,s3,32768
 ds_read_b64_tr_b16 a[156:157],v19 offset:8192
 v_mfma_f32_16x16x32_bf16 v[248:251],a[180:183],a[124:127],v[248:251]
 s_add_u32 s41,s58,917504
 ds_read_b64_tr_b16 a[158:159],v19 offset:12288
 v_mfma_f32_16x16x32_bf16 v[248:251],a[176:179],a[108:111],v[248:251]
 buffer_load_dwordx4 v32,s[8:11],s41 offen offset:0 lds
 v_mfma_f32_16x16x32_bf16 v[252:255],a[184:187],a[108:111],v[252:255]
 v_mfma_f32_16x16x32_bf16 v[252:255],a[188:191],a[124:127],v[252:255]
 v_mfma_f32_16x16x32_bf16 v[244:247],a[188:191],a[120:123],v[244:247]
 v_mfma_f32_16x16x32_bf16 v[244:247],a[184:187],a[104:107],v[244:247]
 buffer_load_dwordx4 v33,s[8:11],s41 offen offset:1024 lds
 v_mfma_f32_16x16x32_bf16 v[236:239],a[184:187],a[100:103],v[236:239]
 v_mfma_f32_16x16x32_bf16 v[236:239],a[188:191],a[116:119],v[236:239]
 v_mfma_f32_16x16x32_bf16 v[228:231],a[188:191],a[112:115],v[228:231]
 v_mfma_f32_16x16x32_bf16 v[228:231],a[184:187],a[96:99],v[228:231]
 s_waitcnt vmcnt(28) lgkmcnt(0)
 v_mfma_f32_16x16x32_bf16 v[128:131],a[128:131],a[0:3],v[128:131]
 ds_read_b64_tr_b16 a[160:161],v20 offset:0
 v_mfma_f32_16x16x32_bf16 v[128:131],a[132:135],a[16:19],v[128:131]
 ds_read_b64_tr_b16 a[162:163],v20 offset:4096
 v_mfma_f32_16x16x32_bf16 v[136:139],a[132:135],a[20:23],v[136:139]
 buffer_load_dwordx4 v34,s[8:11],s41 offen offset:2048 lds
 v_mfma_f32_16x16x32_bf16 v[136:139],a[128:131],a[4:7],v[136:139]
 ds_read_b64_tr_b16 a[164:165],v20 offset:8192
 v_mfma_f32_16x16x32_bf16 v[144:147],a[128:131],a[8:11],v[144:147]
 ds_read_b64_tr_b16 a[166:167],v20 offset:12288
 v_mfma_f32_16x16x32_bf16 v[144:147],a[132:135],a[24:27],v[144:147]
 v_mfma_f32_16x16x32_bf16 v[152:155],a[132:135],a[28:31],v[152:155]
 ds_read_b64_tr_b16 a[168:169],v21 offset:0
 buffer_load_dwordx4 v35,s[8:11],s41 offen offset:3072 lds
 v_mfma_f32_16x16x32_bf16 v[152:155],a[128:131],a[12:15],v[152:155]
 ds_read_b64_tr_b16 a[170:171],v21 offset:4096
 v_mfma_f32_16x16x32_bf16 v[156:159],a[136:139],a[12:15],v[156:159]
 v_mfma_f32_16x16x32_bf16 v[156:159],a[140:143],a[28:31],v[156:159]
 s_add_u32 s40,s77,12288
 ds_read_b64_tr_b16 a[172:173],v21 offset:8192
 v_mfma_f32_16x16x32_bf16 v[148:151],a[140:143],a[24:27],v[148:151]
 ds_read_b64_tr_b16 a[174:175],v21 offset:12288
 buffer_load_dwordx4 a[96:99],v1,s[60:63],s40 offen offset:0 sc1
 v_mfma_f32_16x16x32_bf16 v[148:151],a[136:139],a[8:11],v[148:151]
 v_mfma_f32_16x16x32_bf16 v[140:143],a[136:139],a[4:7],v[140:143]
 ds_read_b64_tr_b16 a[176:177],v22 offset:0
 v_mfma_f32_16x16x32_bf16 v[140:143],a[140:143],a[20:23],v[140:143]
 ds_read_b64_tr_b16 a[178:179],v22 offset:4096
 v_mfma_f32_16x16x32_bf16 v[132:135],a[140:143],a[16:19],v[132:135]
 buffer_load_dwordx4 a[100:103],v1,s[60:63],s40 offen offset:1024 sc1
 v_mfma_f32_16x16x32_bf16 v[132:135],a[136:139],a[0:3],v[132:135]
 ds_read_b64_tr_b16 a[180:181],v22 offset:8192
 v_mfma_f32_16x16x32_bf16 v[160:163],a[144:147],a[0:3],v[160:163]
 ds_read_b64_tr_b16 a[182:183],v22 offset:12288
 v_mfma_f32_16x16x32_bf16 v[160:163],a[148:151],a[16:19],v[160:163]
 v_mfma_f32_16x16x32_bf16 v[168:171],a[148:151],a[20:23],v[168:171]
 ds_read_b64_tr_b16 a[184:185],v23 offset:0
 v_mfma_f32_16x16x32_bf16 v[168:171],a[144:147],a[4:7],v[168:171]
 ds_read_b64_tr_b16 a[186:187],v23 offset:4096
 buffer_load_dwordx4 a[112:115],v1,s[60:63],s40 offen offset:2048 sc1
 v_mfma_f32_16x16x32_bf16 v[176:179],a[144:147],a[8:11],v[176:179]
 v_mfma_f32_16x16x32_bf16 v[176:179],a[148:151],a[24:27],v[176:179]
 ds_read_b64_tr_b16 a[188:189],v23 offset:8192
 v_mfma_f32_16x16x32_bf16 v[184:187],a[148:151],a[28:31],v[184:187]
 ds_read_b64_tr_b16 a[190:191],v23 offset:12288
 v_mfma_f32_16x16x32_bf16 v[184:187],a[144:147],a[12:15],v[184:187]
 buffer_load_dwordx4 a[116:119],v1,s[60:63],s40 offen offset:3072 sc1
 v_mfma_f32_16x16x32_bf16 v[188:191],a[152:155],a[12:15],v[188:191]
 v_mfma_f32_16x16x32_bf16 v[188:191],a[156:159],a[28:31],v[188:191]
 v_mfma_f32_16x16x32_bf16 v[180:183],a[156:159],a[24:27],v[180:183]
 s_add_u32 s59,s77,274432
 v_mfma_f32_16x16x32_bf16 v[180:183],a[152:155],a[8:11],v[180:183]
 buffer_load_dwordx4 a[104:107],v1,s[60:63],s59 offen offset:0 sc1
 v_mfma_f32_16x16x32_bf16 v[172:175],a[152:155],a[4:7],v[172:175]
 v_mfma_f32_16x16x32_bf16 v[172:175],a[156:159],a[20:23],v[172:175]
 v_mfma_f32_16x16x32_bf16 v[164:167],a[156:159],a[16:19],v[164:167]
 v_mfma_f32_16x16x32_bf16 v[164:167],a[152:155],a[0:3],v[164:167]
 s_waitcnt vmcnt(33) lgkmcnt(0)
 s_barrier
 v_mfma_f32_16x16x32_bf16 v[192:195],a[160:163],a[0:3],v[192:195]
 ds_read_b64_tr_b16 a[128:129],v24 offset:0
 v_mfma_f32_16x16x32_bf16 v[192:195],a[164:167],a[16:19],v[192:195]
 ds_read_b64_tr_b16 a[130:131],v24 offset:4096
 v_mfma_f32_16x16x32_bf16 v[200:203],a[164:167],a[20:23],v[200:203]
 buffer_load_dwordx4 a[108:111],v1,s[60:63],s59 offen offset:1024 sc1
 v_mfma_f32_16x16x32_bf16 v[200:203],a[160:163],a[4:7],v[200:203]
 ds_read_b64_tr_b16 a[132:133],v24 offset:8192
 v_mfma_f32_16x16x32_bf16 v[208:211],a[160:163],a[8:11],v[208:211]
 ds_read_b64_tr_b16 a[134:135],v24 offset:12288
 v_mfma_f32_16x16x32_bf16 v[208:211],a[164:167],a[24:27],v[208:211]
 v_mfma_f32_16x16x32_bf16 v[216:219],a[164:167],a[28:31],v[216:219]
 ds_read_b64_tr_b16 a[136:137],v25 offset:0
 buffer_load_dwordx4 a[120:123],v1,s[60:63],s59 offen offset:2048 sc1
 v_mfma_f32_16x16x32_bf16 v[216:219],a[160:163],a[12:15],v[216:219]
 ds_read_b64_tr_b16 a[138:139],v25 offset:4096
 v_mfma_f32_16x16x32_bf16 v[220:223],a[168:171],a[12:15],v[220:223]
 v_mfma_f32_16x16x32_bf16 v[220:223],a[172:175],a[28:31],v[220:223]
 ds_read_b64_tr_b16 a[140:141],v25 offset:8192
 v_mfma_f32_16x16x32_bf16 v[212:215],a[172:175],a[24:27],v[212:215]
 ds_read_b64_tr_b16 a[142:143],v25 offset:12288
 buffer_load_dwordx4 a[124:127],v1,s[60:63],s59 offen offset:3072 sc1
 v_mfma_f32_16x16x32_bf16 v[212:215],a[168:171],a[8:11],v[212:215]
 v_mfma_f32_16x16x32_bf16 v[204:207],a[168:171],a[4:7],v[204:207]
 s_add_u32 m0,s3,0
 ds_read_b64_tr_b16 a[144:145],v26 offset:0
 v_mfma_f32_16x16x32_bf16 v[204:207],a[172:175],a[20:23],v[204:207]
 s_add_u32 s41,s58,393216
 ds_read_b64_tr_b16 a[146:147],v26 offset:4096
 v_mfma_f32_16x16x32_bf16 v[196:199],a[172:175],a[16:19],v[196:199]
 buffer_load_dwordx4 v32,s[8:11],s41 offen offset:0 lds
 v_mfma_f32_16x16x32_bf16 v[196:199],a[168:171],a[0:3],v[196:199]
 ds_read_b64_tr_b16 a[148:149],v26 offset:8192
 v_mfma_f32_16x16x32_bf16 v[224:227],a[176:179],a[0:3],v[224:227]
 ds_read_b64_tr_b16 a[150:151],v26 offset:12288
 v_mfma_f32_16x16x32_bf16 v[224:227],a[180:183],a[16:19],v[224:227]
 v_mfma_f32_16x16x32_bf16 v[232:235],a[180:183],a[20:23],v[232:235]
 ds_read_b64_tr_b16 a[152:153],v27 offset:0
 v_mfma_f32_16x16x32_bf16 v[232:235],a[176:179],a[4:7],v[232:235]
 ds_read_b64_tr_b16 a[154:155],v27 offset:4096
 buffer_load_dwordx4 v33,s[8:11],s41 offen offset:1024 lds
 v_mfma_f32_16x16x32_bf16 v[240:243],a[176:179],a[8:11],v[240:243]
 v_mfma_f32_16x16x32_bf16 v[240:243],a[180:183],a[24:27],v[240:243]
 ds_read_b64_tr_b16 a[156:157],v27 offset:8192
 v_mfma_f32_16x16x32_bf16 v[248:251],a[180:183],a[28:31],v[248:251]
 ds_read_b64_tr_b16 a[158:159],v27 offset:12288
 v_mfma_f32_16x16x32_bf16 v[248:251],a[176:179],a[12:15],v[248:251]
 buffer_load_dwordx4 v34,s[8:11],s41 offen offset:2048 lds
 v_mfma_f32_16x16x32_bf16 v[252:255],a[184:187],a[12:15],v[252:255]
 v_mfma_f32_16x16x32_bf16 v[252:255],a[188:191],a[28:31],v[252:255]
 v_mfma_f32_16x16x32_bf16 v[244:247],a[188:191],a[24:27],v[244:247]
 v_mfma_f32_16x16x32_bf16 v[244:247],a[184:187],a[8:11],v[244:247]
 buffer_load_dwordx4 v35,s[8:11],s41 offen offset:3072 lds
 v_mfma_f32_16x16x32_bf16 v[236:239],a[184:187],a[4:7],v[236:239]
 v_mfma_f32_16x16x32_bf16 v[236:239],a[188:191],a[20:23],v[236:239]
 v_mfma_f32_16x16x32_bf16 v[228:231],a[188:191],a[16:19],v[228:231]
 v_mfma_f32_16x16x32_bf16 v[228:231],a[184:187],a[0:3],v[228:231]
 s_waitcnt vmcnt(32) lgkmcnt(0)
 v_mfma_f32_16x16x32_bf16 v[128:131],a[128:131],a[32:35],v[128:131]
 ds_read_b64_tr_b16 a[160:161],v28 offset:0
 v_mfma_f32_16x16x32_bf16 v[128:131],a[132:135],a[48:51],v[128:131]
 s_add_u32 s40,s77,16384
 ds_read_b64_tr_b16 a[162:163],v28 offset:4096
 v_mfma_f32_16x16x32_bf16 v[136:139],a[132:135],a[52:55],v[136:139]
 buffer_load_dwordx4 a[0:3],v1,s[60:63],s40 offen offset:0 sc1
 v_mfma_f32_16x16x32_bf16 v[136:139],a[128:131],a[36:39],v[136:139]
 ds_read_b64_tr_b16 a[164:165],v28 offset:8192
 v_mfma_f32_16x16x32_bf16 v[144:147],a[128:131],a[40:43],v[144:147]
 ds_read_b64_tr_b16 a[166:167],v28 offset:12288
 v_mfma_f32_16x16x32_bf16 v[144:147],a[132:135],a[56:59],v[144:147]
 v_mfma_f32_16x16x32_bf16 v[152:155],a[132:135],a[60:63],v[152:155]
 ds_read_b64_tr_b16 a[168:169],v29 offset:0
 buffer_load_dwordx4 a[4:7],v1,s[60:63],s40 offen offset:1024 sc1
 v_mfma_f32_16x16x32_bf16 v[152:155],a[128:131],a[44:47],v[152:155]
 ds_read_b64_tr_b16 a[170:171],v29 offset:4096
 v_mfma_f32_16x16x32_bf16 v[156:159],a[136:139],a[44:47],v[156:159]
 v_mfma_f32_16x16x32_bf16 v[156:159],a[140:143],a[60:63],v[156:159]
 ds_read_b64_tr_b16 a[172:173],v29 offset:8192
 v_mfma_f32_16x16x32_bf16 v[148:151],a[140:143],a[56:59],v[148:151]
 ds_read_b64_tr_b16 a[174:175],v29 offset:12288
 buffer_load_dwordx4 a[16:19],v1,s[60:63],s40 offen offset:2048 sc1
 v_mfma_f32_16x16x32_bf16 v[148:151],a[136:139],a[40:43],v[148:151]
 v_mfma_f32_16x16x32_bf16 v[140:143],a[136:139],a[36:39],v[140:143]
 ds_read_b64_tr_b16 a[176:177],v30 offset:0
 v_mfma_f32_16x16x32_bf16 v[140:143],a[140:143],a[52:55],v[140:143]
 ds_read_b64_tr_b16 a[178:179],v30 offset:4096
 v_mfma_f32_16x16x32_bf16 v[132:135],a[140:143],a[48:51],v[132:135]
 buffer_load_dwordx4 a[20:23],v1,s[60:63],s40 offen offset:3072 sc1
 v_mfma_f32_16x16x32_bf16 v[132:135],a[136:139],a[32:35],v[132:135]
 ds_read_b64_tr_b16 a[180:181],v30 offset:8192
 v_mfma_f32_16x16x32_bf16 v[160:163],a[144:147],a[32:35],v[160:163]
 ds_read_b64_tr_b16 a[182:183],v30 offset:12288
 v_mfma_f32_16x16x32_bf16 v[160:163],a[148:151],a[48:51],v[160:163]
 v_mfma_f32_16x16x32_bf16 v[168:171],a[148:151],a[52:55],v[168:171]
 s_add_u32 s59,s77,278528
 ds_read_b64_tr_b16 a[184:185],v31 offset:0
 v_mfma_f32_16x16x32_bf16 v[168:171],a[144:147],a[36:39],v[168:171]
 ds_read_b64_tr_b16 a[186:187],v31 offset:4096
 buffer_load_dwordx4 a[8:11],v1,s[60:63],s59 offen offset:0 sc1
 v_mfma_f32_16x16x32_bf16 v[176:179],a[144:147],a[40:43],v[176:179]
 v_mfma_f32_16x16x32_bf16 v[176:179],a[148:151],a[56:59],v[176:179]
 ds_read_b64_tr_b16 a[188:189],v31 offset:8192
 v_mfma_f32_16x16x32_bf16 v[184:187],a[148:151],a[60:63],v[184:187]
 ds_read_b64_tr_b16 a[190:191],v31 offset:12288
 v_mfma_f32_16x16x32_bf16 v[184:187],a[144:147],a[44:47],v[184:187]
 buffer_load_dwordx4 a[12:15],v1,s[60:63],s59 offen offset:1024 sc1
 v_mfma_f32_16x16x32_bf16 v[188:191],a[152:155],a[44:47],v[188:191]
 v_mfma_f32_16x16x32_bf16 v[188:191],a[156:159],a[60:63],v[188:191]
 v_mfma_f32_16x16x32_bf16 v[180:183],a[156:159],a[56:59],v[180:183]
 v_mfma_f32_16x16x32_bf16 v[180:183],a[152:155],a[40:43],v[180:183]
 buffer_load_dwordx4 a[24:27],v1,s[60:63],s59 offen offset:2048 sc1
 v_mfma_f32_16x16x32_bf16 v[172:175],a[152:155],a[36:39],v[172:175]
 v_mfma_f32_16x16x32_bf16 v[172:175],a[156:159],a[52:55],v[172:175]
 v_mfma_f32_16x16x32_bf16 v[164:167],a[156:159],a[48:51],v[164:167]
 v_mfma_f32_16x16x32_bf16 v[164:167],a[152:155],a[32:35],v[164:167]
 s_waitcnt vmcnt(35) lgkmcnt(0)
 s_barrier
 v_mfma_f32_16x16x32_bf16 v[192:195],a[160:163],a[32:35],v[192:195]
 ds_read_b64_tr_b16 a[128:129],v16 offset:16384
 v_mfma_f32_16x16x32_bf16 v[192:195],a[164:167],a[48:51],v[192:195]
 ds_read_b64_tr_b16 a[130:131],v16 offset:20480
 v_mfma_f32_16x16x32_bf16 v[200:203],a[164:167],a[52:55],v[200:203]
 buffer_load_dwordx4 a[28:31],v1,s[60:63],s59 offen offset:3072 sc1
 v_mfma_f32_16x16x32_bf16 v[200:203],a[160:163],a[36:39],v[200:203]
 ds_read_b64_tr_b16 a[132:133],v16 offset:24576
 v_mfma_f32_16x16x32_bf16 v[208:211],a[160:163],a[40:43],v[208:211]
 s_add_u32 m0,s3,65536
 ds_read_b64_tr_b16 a[134:135],v16 offset:28672
 v_mfma_f32_16x16x32_bf16 v[208:211],a[164:167],a[56:59],v[208:211]
 s_add_u32 s41,s58,524288
 v_mfma_f32_16x16x32_bf16 v[216:219],a[164:167],a[60:63],v[216:219]
 ds_read_b64_tr_b16 a[136:137],v17 offset:16384
 buffer_load_dwordx4 v32,s[8:11],s41 offen offset:0 lds
 v_mfma_f32_16x16x32_bf16 v[216:219],a[160:163],a[44:47],v[216:219]
 ds_read_b64_tr_b16 a[138:139],v17 offset:20480
 v_mfma_f32_16x16x32_bf16 v[220:223],a[168:171],a[44:47],v[220:223]
 v_mfma_f32_16x16x32_bf16 v[220:223],a[172:175],a[60:63],v[220:223]
 ds_read_b64_tr_b16 a[140:141],v17 offset:24576
 v_mfma_f32_16x16x32_bf16 v[212:215],a[172:175],a[56:59],v[212:215]
 ds_read_b64_tr_b16 a[142:143],v17 offset:28672
 buffer_load_dwordx4 v33,s[8:11],s41 offen offset:1024 lds
 v_mfma_f32_16x16x32_bf16 v[212:215],a[168:171],a[40:43],v[212:215]
 v_mfma_f32_16x16x32_bf16 v[204:207],a[168:171],a[36:39],v[204:207]
 ds_read_b64_tr_b16 a[144:145],v18 offset:16384
 v_mfma_f32_16x16x32_bf16 v[204:207],a[172:175],a[52:55],v[204:207]
 ds_read_b64_tr_b16 a[146:147],v18 offset:20480
 v_mfma_f32_16x16x32_bf16 v[196:199],a[172:175],a[48:51],v[196:199]
 buffer_load_dwordx4 v34,s[8:11],s41 offen offset:2048 lds
 v_mfma_f32_16x16x32_bf16 v[196:199],a[168:171],a[32:35],v[196:199]
 ds_read_b64_tr_b16 a[148:149],v18 offset:24576
 v_mfma_f32_16x16x32_bf16 v[224:227],a[176:179],a[32:35],v[224:227]
 ds_read_b64_tr_b16 a[150:151],v18 offset:28672
 v_mfma_f32_16x16x32_bf16 v[224:227],a[180:183],a[48:51],v[224:227]
 v_mfma_f32_16x16x32_bf16 v[232:235],a[180:183],a[52:55],v[232:235]
 ds_read_b64_tr_b16 a[152:153],v19 offset:16384
 v_mfma_f32_16x16x32_bf16 v[232:235],a[176:179],a[36:39],v[232:235]
 ds_read_b64_tr_b16 a[154:155],v19 offset:20480
 buffer_load_dwordx4 v35,s[8:11],s41 offen offset:3072 lds
 v_mfma_f32_16x16x32_bf16 v[240:243],a[176:179],a[40:43],v[240:243]
 v_mfma_f32_16x16x32_bf16 v[240:243],a[180:183],a[56:59],v[240:243]
 s_add_u32 m0,s3,98304
 ds_read_b64_tr_b16 a[156:157],v19 offset:24576
 v_mfma_f32_16x16x32_bf16 v[248:251],a[180:183],a[60:63],v[248:251]
 s_add_u32 s41,s58,1048576
 ds_read_b64_tr_b16 a[158:159],v19 offset:28672
 v_mfma_f32_16x16x32_bf16 v[248:251],a[176:179],a[44:47],v[248:251]
 buffer_load_dwordx4 v32,s[8:11],s41 offen offset:0 lds
 v_mfma_f32_16x16x32_bf16 v[252:255],a[184:187],a[44:47],v[252:255]
 v_mfma_f32_16x16x32_bf16 v[252:255],a[188:191],a[60:63],v[252:255]
 v_mfma_f32_16x16x32_bf16 v[244:247],a[188:191],a[56:59],v[244:247]
 v_mfma_f32_16x16x32_bf16 v[244:247],a[184:187],a[40:43],v[244:247]
 buffer_load_dwordx4 v33,s[8:11],s41 offen offset:1024 lds
 v_mfma_f32_16x16x32_bf16 v[236:239],a[184:187],a[36:39],v[236:239]
 v_mfma_f32_16x16x32_bf16 v[236:239],a[188:191],a[52:55],v[236:239]
 v_mfma_f32_16x16x32_bf16 v[228:231],a[188:191],a[48:51],v[228:231]
 v_mfma_f32_16x16x32_bf16 v[228:231],a[184:187],a[32:35],v[228:231]
 s_waitcnt vmcnt(34) lgkmcnt(0)
 v_mfma_f32_16x16x32_bf16 v[128:131],a[128:131],a[64:67],v[128:131]
 ds_read_b64_tr_b16 a[160:161],v20 offset:16384
 v_mfma_f32_16x16x32_bf16 v[128:131],a[132:135],a[80:83],v[128:131]
 ds_read_b64_tr_b16 a[162:163],v20 offset:20480
 v_mfma_f32_16x16x32_bf16 v[136:139],a[132:135],a[84:87],v[136:139]
 buffer_load_dwordx4 v34,s[8:11],s41 offen offset:2048 lds
 v_mfma_f32_16x16x32_bf16 v[136:139],a[128:131],a[68:71],v[136:139]
 ds_read_b64_tr_b16 a[164:165],v20 offset:24576
 v_mfma_f32_16x16x32_bf16 v[144:147],a[128:131],a[72:75],v[144:147]
 ds_read_b64_tr_b16 a[166:167],v20 offset:28672
 v_mfma_f32_16x16x32_bf16 v[144:147],a[132:135],a[88:91],v[144:147]
 v_mfma_f32_16x16x32_bf16 v[152:155],a[132:135],a[92:95],v[152:155]
 ds_read_b64_tr_b16 a[168:169],v21 offset:16384
 buffer_load_dwordx4 v35,s[8:11],s41 offen offset:3072 lds
 v_mfma_f32_16x16x32_bf16 v[152:155],a[128:131],a[76:79],v[152:155]
 ds_read_b64_tr_b16 a[170:171],v21 offset:20480
 v_mfma_f32_16x16x32_bf16 v[156:159],a[136:139],a[76:79],v[156:159]
 v_mfma_f32_16x16x32_bf16 v[156:159],a[140:143],a[92:95],v[156:159]
 s_add_u32 s40,s77,20480
 ds_read_b64_tr_b16 a[172:173],v21 offset:24576
 v_mfma_f32_16x16x32_bf16 v[148:151],a[140:143],a[88:91],v[148:151]
 ds_read_b64_tr_b16 a[174:175],v21 offset:28672
 buffer_load_dwordx4 a[32:35],v1,s[60:63],s40 offen offset:0 sc1
 v_mfma_f32_16x16x32_bf16 v[148:151],a[136:139],a[72:75],v[148:151]
 v_mfma_f32_16x16x32_bf16 v[140:143],a[136:139],a[68:71],v[140:143]
 ds_read_b64_tr_b16 a[176:177],v22 offset:16384
 v_mfma_f32_16x16x32_bf16 v[140:143],a[140:143],a[84:87],v[140:143]
 ds_read_b64_tr_b16 a[178:179],v22 offset:20480
 v_mfma_f32_16x16x32_bf16 v[132:135],a[140:143],a[80:83],v[132:135]
 buffer_load_dwordx4 a[36:39],v1,s[60:63],s40 offen offset:1024 sc1
 v_mfma_f32_16x16x32_bf16 v[132:135],a[136:139],a[64:67],v[132:135]
 ds_read_b64_tr_b16 a[180:181],v22 offset:24576
 v_mfma_f32_16x16x32_bf16 v[160:163],a[144:147],a[64:67],v[160:163]
 ds_read_b64_tr_b16 a[182:183],v22 offset:28672
 v_mfma_f32_16x16x32_bf16 v[160:163],a[148:151],a[80:83],v[160:163]
 v_mfma_f32_16x16x32_bf16 v[168:171],a[148:151],a[84:87],v[168:171]
 ds_read_b64_tr_b16 a[184:185],v23 offset:16384
 v_mfma_f32_16x16x32_bf16 v[168:171],a[144:147],a[68:71],v[168:171]
 ds_read_b64_tr_b16 a[186:187],v23 offset:20480
 buffer_load_dwordx4 a[48:51],v1,s[60:63],s40 offen offset:2048 sc1
 v_mfma_f32_16x16x32_bf16 v[176:179],a[144:147],a[72:75],v[176:179]
 v_mfma_f32_16x16x32_bf16 v[176:179],a[148:151],a[88:91],v[176:179]
 ds_read_b64_tr_b16 a[188:189],v23 offset:24576
 v_mfma_f32_16x16x32_bf16 v[184:187],a[148:151],a[92:95],v[184:187]
 ds_read_b64_tr_b16 a[190:191],v23 offset:28672
 v_mfma_f32_16x16x32_bf16 v[184:187],a[144:147],a[76:79],v[184:187]
 buffer_load_dwordx4 a[52:55],v1,s[60:63],s40 offen offset:3072 sc1
 v_mfma_f32_16x16x32_bf16 v[188:191],a[152:155],a[76:79],v[188:191]
 v_mfma_f32_16x16x32_bf16 v[188:191],a[156:159],a[92:95],v[188:191]
 v_mfma_f32_16x16x32_bf16 v[180:183],a[156:159],a[88:91],v[180:183]
 s_add_u32 s59,s77,282624
 v_mfma_f32_16x16x32_bf16 v[180:183],a[152:155],a[72:75],v[180:183]
 buffer_load_dwordx4 a[40:43],v1,s[60:63],s59 offen offset:0 sc1
 v_mfma_f32_16x16x32_bf16 v[172:175],a[152:155],a[68:71],v[172:175]
 v_mfma_f32_16x16x32_bf16 v[172:175],a[156:159],a[84:87],v[172:175]
 v_mfma_f32_16x16x32_bf16 v[164:167],a[156:159],a[80:83],v[164:167]
 v_mfma_f32_16x16x32_bf16 v[164:167],a[152:155],a[64:67],v[164:167]
 s_waitcnt vmcnt(37) lgkmcnt(0)
 s_barrier
 v_mfma_f32_16x16x32_bf16 v[192:195],a[160:163],a[64:67],v[192:195]
 ds_read_b64_tr_b16 a[128:129],v24 offset:16384
 v_mfma_f32_16x16x32_bf16 v[192:195],a[164:167],a[80:83],v[192:195]
 ds_read_b64_tr_b16 a[130:131],v24 offset:20480
 v_mfma_f32_16x16x32_bf16 v[200:203],a[164:167],a[84:87],v[200:203]
 buffer_load_dwordx4 a[44:47],v1,s[60:63],s59 offen offset:1024 sc1
 v_mfma_f32_16x16x32_bf16 v[200:203],a[160:163],a[68:71],v[200:203]
 ds_read_b64_tr_b16 a[132:133],v24 offset:24576
 v_mfma_f32_16x16x32_bf16 v[208:211],a[160:163],a[72:75],v[208:211]
 ds_read_b64_tr_b16 a[134:135],v24 offset:28672
 v_mfma_f32_16x16x32_bf16 v[208:211],a[164:167],a[88:91],v[208:211]
 v_mfma_f32_16x16x32_bf16 v[216:219],a[164:167],a[92:95],v[216:219]
 ds_read_b64_tr_b16 a[136:137],v25 offset:16384
 buffer_load_dwordx4 a[56:59],v1,s[60:63],s59 offen offset:2048 sc1
 v_mfma_f32_16x16x32_bf16 v[216:219],a[160:163],a[76:79],v[216:219]
 ds_read_b64_tr_b16 a[138:139],v25 offset:20480
 v_mfma_f32_16x16x32_bf16 v[220:223],a[168:171],a[76:79],v[220:223]
 v_mfma_f32_16x16x32_bf16 v[220:223],a[172:175],a[92:95],v[220:223]
 ds_read_b64_tr_b16 a[140:141],v25 offset:24576
 v_mfma_f32_16x16x32_bf16 v[212:215],a[172:175],a[88:91],v[212:215]
 ds_read_b64_tr_b16 a[142:143],v25 offset:28672
 buffer_load_dwordx4 a[60:63],v1,s[60:63],s59 offen offset:3072 sc1
 v_mfma_f32_16x16x32_bf16 v[212:215],a[168:171],a[72:75],v[212:215]
 v_mfma_f32_16x16x32_bf16 v[204:207],a[168:171],a[68:71],v[204:207]
 s_add_u32 m0,s3,16384
 ds_read_b64_tr_b16 a[144:145],v26 offset:16384
 v_mfma_f32_16x16x32_bf16 v[204:207],a[172:175],a[84:87],v[204:207]
 s_add_u32 s41,s58,655360
 ds_read_b64_tr_b16 a[146:147],v26 offset:20480
 v_mfma_f32_16x16x32_bf16 v[196:199],a[172:175],a[80:83],v[196:199]
 buffer_load_dwordx4 v32,s[8:11],s41 offen offset:0 lds
 v_mfma_f32_16x16x32_bf16 v[196:199],a[168:171],a[64:67],v[196:199]
 ds_read_b64_tr_b16 a[148:149],v26 offset:24576
 v_mfma_f32_16x16x32_bf16 v[224:227],a[176:179],a[64:67],v[224:227]
 ds_read_b64_tr_b16 a[150:151],v26 offset:28672
 v_mfma_f32_16x16x32_bf16 v[224:227],a[180:183],a[80:83],v[224:227]
 v_mfma_f32_16x16x32_bf16 v[232:235],a[180:183],a[84:87],v[232:235]
 ds_read_b64_tr_b16 a[152:153],v27 offset:16384
 v_mfma_f32_16x16x32_bf16 v[232:235],a[176:179],a[68:71],v[232:235]
 ds_read_b64_tr_b16 a[154:155],v27 offset:20480
 buffer_load_dwordx4 v33,s[8:11],s41 offen offset:1024 lds
 v_mfma_f32_16x16x32_bf16 v[240:243],a[176:179],a[72:75],v[240:243]
 v_mfma_f32_16x16x32_bf16 v[240:243],a[180:183],a[88:91],v[240:243]
 ds_read_b64_tr_b16 a[156:157],v27 offset:24576
 v_mfma_f32_16x16x32_bf16 v[248:251],a[180:183],a[92:95],v[248:251]
 ds_read_b64_tr_b16 a[158:159],v27 offset:28672
 v_mfma_f32_16x16x32_bf16 v[248:251],a[176:179],a[76:79],v[248:251]
 buffer_load_dwordx4 v34,s[8:11],s41 offen offset:2048 lds
 v_mfma_f32_16x16x32_bf16 v[252:255],a[184:187],a[76:79],v[252:255]
 v_mfma_f32_16x16x32_bf16 v[252:255],a[188:191],a[92:95],v[252:255]
 v_mfma_f32_16x16x32_bf16 v[244:247],a[188:191],a[88:91],v[244:247]
 v_mfma_f32_16x16x32_bf16 v[244:247],a[184:187],a[72:75],v[244:247]
 buffer_load_dwordx4 v35,s[8:11],s41 offen offset:3072 lds
 v_mfma_f32_16x16x32_bf16 v[236:239],a[184:187],a[68:71],v[236:239]
 v_mfma_f32_16x16x32_bf16 v[236:239],a[188:191],a[84:87],v[236:239]
 v_mfma_f32_16x16x32_bf16 v[228:231],a[188:191],a[80:83],v[228:231]
 v_mfma_f32_16x16x32_bf16 v[228:231],a[184:187],a[64:67],v[228:231]
 s_waitcnt vmcnt(32) lgkmcnt(0)
 v_mfma_f32_16x16x32_bf16 v[128:131],a[128:131],a[96:99],v[128:131]
 ds_read_b64_tr_b16 a[160:161],v28 offset:16384
 v_mfma_f32_16x16x32_bf16 v[128:131],a[132:135],a[112:115],v[128:131]
 s_add_u32 s40,s77,24576
 ds_read_b64_tr_b16 a[162:163],v28 offset:20480
 v_mfma_f32_16x16x32_bf16 v[136:139],a[132:135],a[116:119],v[136:139]
 buffer_load_dwordx4 a[64:67],v1,s[60:63],s40 offen offset:0 sc1
 v_mfma_f32_16x16x32_bf16 v[136:139],a[128:131],a[100:103],v[136:139]
 ds_read_b64_tr_b16 a[164:165],v28 offset:24576
 v_mfma_f32_16x16x32_bf16 v[144:147],a[128:131],a[104:107],v[144:147]
 ds_read_b64_tr_b16 a[166:167],v28 offset:28672
 v_mfma_f32_16x16x32_bf16 v[144:147],a[132:135],a[120:123],v[144:147]
 v_mfma_f32_16x16x32_bf16 v[152:155],a[132:135],a[124:127],v[152:155]
 ds_read_b64_tr_b16 a[168:169],v29 offset:16384
 buffer_load_dwordx4 a[68:71],v1,s[60:63],s40 offen offset:1024 sc1
 v_mfma_f32_16x16x32_bf16 v[152:155],a[128:131],a[108:111],v[152:155]
 ds_read_b64_tr_b16 a[170:171],v29 offset:20480
 v_mfma_f32_16x16x32_bf16 v[156:159],a[136:139],a[108:111],v[156:159]
 v_mfma_f32_16x16x32_bf16 v[156:159],a[140:143],a[124:127],v[156:159]
 ds_read_b64_tr_b16 a[172:173],v29 offset:24576
 v_mfma_f32_16x16x32_bf16 v[148:151],a[140:143],a[120:123],v[148:151]
 ds_read_b64_tr_b16 a[174:175],v29 offset:28672
 buffer_load_dwordx4 a[80:83],v1,s[60:63],s40 offen offset:2048 sc1
 v_mfma_f32_16x16x32_bf16 v[148:151],a[136:139],a[104:107],v[148:151]
 v_mfma_f32_16x16x32_bf16 v[140:143],a[136:139],a[100:103],v[140:143]
 ds_read_b64_tr_b16 a[176:177],v30 offset:16384
 v_mfma_f32_16x16x32_bf16 v[140:143],a[140:143],a[116:119],v[140:143]
 ds_read_b64_tr_b16 a[178:179],v30 offset:20480
 v_mfma_f32_16x16x32_bf16 v[132:135],a[140:143],a[112:115],v[132:135]
 buffer_load_dwordx4 a[84:87],v1,s[60:63],s40 offen offset:3072 sc1
 v_mfma_f32_16x16x32_bf16 v[132:135],a[136:139],a[96:99],v[132:135]
 ds_read_b64_tr_b16 a[180:181],v30 offset:24576
 v_mfma_f32_16x16x32_bf16 v[160:163],a[144:147],a[96:99],v[160:163]
 ds_read_b64_tr_b16 a[182:183],v30 offset:28672
 v_mfma_f32_16x16x32_bf16 v[160:163],a[148:151],a[112:115],v[160:163]
 v_mfma_f32_16x16x32_bf16 v[168:171],a[148:151],a[116:119],v[168:171]
 s_add_u32 s59,s77,286720
 ds_read_b64_tr_b16 a[184:185],v31 offset:16384
 v_mfma_f32_16x16x32_bf16 v[168:171],a[144:147],a[100:103],v[168:171]
 ds_read_b64_tr_b16 a[186:187],v31 offset:20480
 buffer_load_dwordx4 a[72:75],v1,s[60:63],s59 offen offset:0 sc1
 v_mfma_f32_16x16x32_bf16 v[176:179],a[144:147],a[104:107],v[176:179]
 v_mfma_f32_16x16x32_bf16 v[176:179],a[148:151],a[120:123],v[176:179]
 ds_read_b64_tr_b16 a[188:189],v31 offset:24576
 v_mfma_f32_16x16x32_bf16 v[184:187],a[148:151],a[124:127],v[184:187]
 ds_read_b64_tr_b16 a[190:191],v31 offset:28672
 v_mfma_f32_16x16x32_bf16 v[184:187],a[144:147],a[108:111],v[184:187]
 buffer_load_dwordx4 a[76:79],v1,s[60:63],s59 offen offset:1024 sc1
 v_mfma_f32_16x16x32_bf16 v[188:191],a[152:155],a[108:111],v[188:191]
 v_mfma_f32_16x16x32_bf16 v[188:191],a[156:159],a[124:127],v[188:191]
 v_mfma_f32_16x16x32_bf16 v[180:183],a[156:159],a[120:123],v[180:183]
 v_mfma_f32_16x16x32_bf16 v[180:183],a[152:155],a[104:107],v[180:183]
 buffer_load_dwordx4 a[88:91],v1,s[60:63],s59 offen offset:2048 sc1
 v_mfma_f32_16x16x32_bf16 v[172:175],a[152:155],a[100:103],v[172:175]
 v_mfma_f32_16x16x32_bf16 v[172:175],a[156:159],a[116:119],v[172:175]
 v_mfma_f32_16x16x32_bf16 v[164:167],a[156:159],a[112:115],v[164:167]
 v_mfma_f32_16x16x32_bf16 v[164:167],a[152:155],a[96:99],v[164:167]
 s_waitcnt vmcnt(35) lgkmcnt(0)
 s_barrier
 v_mfma_f32_16x16x32_bf16 v[192:195],a[160:163],a[96:99],v[192:195]
 ds_read_b64_tr_b16 a[128:129],v16 offset:0
 v_mfma_f32_16x16x32_bf16 v[192:195],a[164:167],a[112:115],v[192:195]
 ds_read_b64_tr_b16 a[130:131],v16 offset:4096
 v_mfma_f32_16x16x32_bf16 v[200:203],a[164:167],a[116:119],v[200:203]
 buffer_load_dwordx4 a[92:95],v1,s[60:63],s59 offen offset:3072 sc1
 v_mfma_f32_16x16x32_bf16 v[200:203],a[160:163],a[100:103],v[200:203]
 ds_read_b64_tr_b16 a[132:133],v16 offset:8192
 v_mfma_f32_16x16x32_bf16 v[208:211],a[160:163],a[104:107],v[208:211]
 s_add_u32 m0,s3,81920
 ds_read_b64_tr_b16 a[134:135],v16 offset:12288
 v_mfma_f32_16x16x32_bf16 v[208:211],a[164:167],a[120:123],v[208:211]
 s_add_u32 s41,s58,786432
 v_mfma_f32_16x16x32_bf16 v[216:219],a[164:167],a[124:127],v[216:219]
 ds_read_b64_tr_b16 a[136:137],v17 offset:0
 buffer_load_dwordx4 v32,s[8:11],s41 offen offset:0 lds
 v_mfma_f32_16x16x32_bf16 v[216:219],a[160:163],a[108:111],v[216:219]
 ds_read_b64_tr_b16 a[138:139],v17 offset:4096
 v_mfma_f32_16x16x32_bf16 v[220:223],a[168:171],a[108:111],v[220:223]
 v_mfma_f32_16x16x32_bf16 v[220:223],a[172:175],a[124:127],v[220:223]
 ds_read_b64_tr_b16 a[140:141],v17 offset:8192
 v_mfma_f32_16x16x32_bf16 v[212:215],a[172:175],a[120:123],v[212:215]
 ds_read_b64_tr_b16 a[142:143],v17 offset:12288
 buffer_load_dwordx4 v33,s[8:11],s41 offen offset:1024 lds
 v_mfma_f32_16x16x32_bf16 v[212:215],a[168:171],a[104:107],v[212:215]
 v_mfma_f32_16x16x32_bf16 v[204:207],a[168:171],a[100:103],v[204:207]
 ds_read_b64_tr_b16 a[144:145],v18 offset:0
 v_mfma_f32_16x16x32_bf16 v[204:207],a[172:175],a[116:119],v[204:207]
 ds_read_b64_tr_b16 a[146:147],v18 offset:4096
 v_mfma_f32_16x16x32_bf16 v[196:199],a[172:175],a[112:115],v[196:199]
 buffer_load_dwordx4 v34,s[8:11],s41 offen offset:2048 lds
 v_mfma_f32_16x16x32_bf16 v[196:199],a[168:171],a[96:99],v[196:199]
 ds_read_b64_tr_b16 a[148:149],v18 offset:8192
 v_mfma_f32_16x16x32_bf16 v[224:227],a[176:179],a[96:99],v[224:227]
 ds_read_b64_tr_b16 a[150:151],v18 offset:12288
 v_mfma_f32_16x16x32_bf16 v[224:227],a[180:183],a[112:115],v[224:227]
 v_mfma_f32_16x16x32_bf16 v[232:235],a[180:183],a[116:119],v[232:235]
 ds_read_b64_tr_b16 a[152:153],v19 offset:0
 v_mfma_f32_16x16x32_bf16 v[232:235],a[176:179],a[100:103],v[232:235]
 ds_read_b64_tr_b16 a[154:155],v19 offset:4096
 buffer_load_dwordx4 v35,s[8:11],s41 offen offset:3072 lds
 v_mfma_f32_16x16x32_bf16 v[240:243],a[176:179],a[104:107],v[240:243]
 v_mfma_f32_16x16x32_bf16 v[240:243],a[180:183],a[120:123],v[240:243]
 s_add_u32 m0,s3,49152
 ds_read_b64_tr_b16 a[156:157],v19 offset:8192
 v_mfma_f32_16x16x32_bf16 v[248:251],a[180:183],a[124:127],v[248:251]
 s_add_u32 s41,s58,1179648
 ds_read_b64_tr_b16 a[158:159],v19 offset:12288
 v_mfma_f32_16x16x32_bf16 v[248:251],a[176:179],a[108:111],v[248:251]
 buffer_load_dwordx4 v32,s[8:11],s41 offen offset:0 lds
 v_mfma_f32_16x16x32_bf16 v[252:255],a[184:187],a[108:111],v[252:255]
 v_mfma_f32_16x16x32_bf16 v[252:255],a[188:191],a[124:127],v[252:255]
 v_mfma_f32_16x16x32_bf16 v[244:247],a[188:191],a[120:123],v[244:247]
 v_mfma_f32_16x16x32_bf16 v[244:247],a[184:187],a[104:107],v[244:247]
 buffer_load_dwordx4 v33,s[8:11],s41 offen offset:1024 lds
 v_mfma_f32_16x16x32_bf16 v[236:239],a[184:187],a[100:103],v[236:239]
 v_mfma_f32_16x16x32_bf16 v[236:239],a[188:191],a[116:119],v[236:239]
 v_mfma_f32_16x16x32_bf16 v[228:231],a[188:191],a[112:115],v[228:231]
 v_mfma_f32_16x16x32_bf16 v[228:231],a[184:187],a[96:99],v[228:231]
 s_waitcnt vmcnt(34) lgkmcnt(0)
 v_mfma_f32_16x16x32_bf16 v[128:131],a[128:131],a[0:3],v[128:131]
 ds_read_b64_tr_b16 a[160:161],v20 offset:0
 v_mfma_f32_16x16x32_bf16 v[128:131],a[132:135],a[16:19],v[128:131]
 ds_read_b64_tr_b16 a[162:163],v20 offset:4096
 v_mfma_f32_16x16x32_bf16 v[136:139],a[132:135],a[20:23],v[136:139]
 buffer_load_dwordx4 v34,s[8:11],s41 offen offset:2048 lds
 v_mfma_f32_16x16x32_bf16 v[136:139],a[128:131],a[4:7],v[136:139]
 ds_read_b64_tr_b16 a[164:165],v20 offset:8192
 v_mfma_f32_16x16x32_bf16 v[144:147],a[128:131],a[8:11],v[144:147]
 ds_read_b64_tr_b16 a[166:167],v20 offset:12288
 v_mfma_f32_16x16x32_bf16 v[144:147],a[132:135],a[24:27],v[144:147]
 v_mfma_f32_16x16x32_bf16 v[152:155],a[132:135],a[28:31],v[152:155]
 ds_read_b64_tr_b16 a[168:169],v21 offset:0
 buffer_load_dwordx4 v35,s[8:11],s41 offen offset:3072 lds
 v_mfma_f32_16x16x32_bf16 v[152:155],a[128:131],a[12:15],v[152:155]
 ds_read_b64_tr_b16 a[170:171],v21 offset:4096
 v_mfma_f32_16x16x32_bf16 v[156:159],a[136:139],a[12:15],v[156:159]
 v_mfma_f32_16x16x32_bf16 v[156:159],a[140:143],a[28:31],v[156:159]
 s_add_u32 s40,s77,28672
 ds_read_b64_tr_b16 a[172:173],v21 offset:8192
 v_mfma_f32_16x16x32_bf16 v[148:151],a[140:143],a[24:27],v[148:151]
 ds_read_b64_tr_b16 a[174:175],v21 offset:12288
 buffer_load_dwordx4 a[96:99],v1,s[60:63],s40 offen offset:0 sc1
 v_mfma_f32_16x16x32_bf16 v[148:151],a[136:139],a[8:11],v[148:151]
L_stub_o_3:
 s_cbranch_execz L_warm_o_ret
 v_mfma_f32_16x16x32_bf16 v[140:143],a[136:139],a[4:7],v[140:143]
 ds_read_b64_tr_b16 a[176:177],v22 offset:0
 v_mfma_f32_16x16x32_bf16 v[140:143],a[140:143],a[20:23],v[140:143]
 ds_read_b64_tr_b16 a[178:179],v22 offset:4096
 v_mfma_f32_16x16x32_bf16 v[132:135],a[140:143],a[16:19],v[132:135]
 buffer_load_dwordx4 a[100:103],v1,s[60:63],s40 offen offset:1024 sc1
 v_mfma_f32_16x16x32_bf16 v[132:135],a[136:139],a[0:3],v[132:135]
 ds_read_b64_tr_b16 a[180:181],v22 offset:8192
 v_mfma_f32_16x16x32_bf16 v[160:163],a[144:147],a[0:3],v[160:163]
 ds_read_b64_tr_b16 a[182:183],v22 offset:12288
 v_mfma_f32_16x16x32_bf16 v[160:163],a[148:151],a[16:19],v[160:163]
 v_mfma_f32_16x16x32_bf16 v[168:171],a[148:151],a[20:23],v[168:171]
 ds_read_b64_tr_b16 a[184:185],v23 offset:0
 v_mfma_f32_16x16x32_bf16 v[168:171],a[144:147],a[4:7],v[168:171]
 ds_read_b64_tr_b16 a[186:187],v23 offset:4096
 buffer_load_dwordx4 a[112:115],v1,s[60:63],s40 offen offset:2048 sc1
 v_mfma_f32_16x16x32_bf16 v[176:179],a[144:147],a[8:11],v[176:179]
 v_mfma_f32_16x16x32_bf16 v[176:179],a[148:151],a[24:27],v[176:179]
 ds_read_b64_tr_b16 a[188:189],v23 offset:8192
 v_mfma_f32_16x16x32_bf16 v[184:187],a[148:151],a[28:31],v[184:187]
 ds_read_b64_tr_b16 a[190:191],v23 offset:12288
 v_mfma_f32_16x16x32_bf16 v[184:187],a[144:147],a[12:15],v[184:187]
 buffer_load_dwordx4 a[116:119],v1,s[60:63],s40 offen offset:3072 sc1
 v_mfma_f32_16x16x32_bf16 v[188:191],a[152:155],a[12:15],v[188:191]
 v_mfma_f32_16x16x32_bf16 v[188:191],a[156:159],a[28:31],v[188:191]
 v_mfma_f32_16x16x32_bf16 v[180:183],a[156:159],a[24:27],v[180:183]
 s_add_u32 s59,s77,290816
 v_mfma_f32_16x16x32_bf16 v[180:183],a[152:155],a[8:11],v[180:183]
 buffer_load_dwordx4 a[104:107],v1,s[60:63],s59 offen offset:0 sc1
 v_mfma_f32_16x16x32_bf16 v[172:175],a[152:155],a[4:7],v[172:175]
 v_mfma_f32_16x16x32_bf16 v[172:175],a[156:159],a[20:23],v[172:175]
 v_mfma_f32_16x16x32_bf16 v[164:167],a[156:159],a[16:19],v[164:167]
 v_mfma_f32_16x16x32_bf16 v[164:167],a[152:155],a[0:3],v[164:167]
 s_waitcnt vmcnt(37) lgkmcnt(0)
 s_barrier
 v_mfma_f32_16x16x32_bf16 v[192:195],a[160:163],a[0:3],v[192:195]
 ds_read_b64_tr_b16 a[128:129],v24 offset:0
 v_mfma_f32_16x16x32_bf16 v[192:195],a[164:167],a[16:19],v[192:195]
 ds_read_b64_tr_b16 a[130:131],v24 offset:4096
 v_mfma_f32_16x16x32_bf16 v[200:203],a[164:167],a[20:23],v[200:203]
 buffer_load_dwordx4 a[108:111],v1,s[60:63],s59 offen offset:1024 sc1
 v_mfma_f32_16x16x32_bf16 v[200:203],a[160:163],a[4:7],v[200:203]
 ds_read_b64_tr_b16 a[132:133],v24 offset:8192
 v_mfma_f32_16x16x32_bf16 v[208:211],a[160:163],a[8:11],v[208:211]
 ds_read_b64_tr_b16 a[134:135],v24 offset:12288
 v_mfma_f32_16x16x32_bf16 v[208:211],a[164:167],a[24:27],v[208:211]
 v_mfma_f32_16x16x32_bf16 v[216:219],a[164:167],a[28:31],v[216:219]
 ds_read_b64_tr_b16 a[136:137],v25 offset:0
 buffer_load_dwordx4 a[120:123],v1,s[60:63],s59 offen offset:2048 sc1
 v_mfma_f32_16x16x32_bf16 v[216:219],a[160:163],a[12:15],v[216:219]
 ds_read_b64_tr_b16 a[138:139],v25 offset:4096
 v_mfma_f32_16x16x32_bf16 v[220:223],a[168:171],a[12:15],v[220:223]
 v_mfma_f32_16x16x32_bf16 v[220:223],a[172:175],a[28:31],v[220:223]
 ds_read_b64_tr_b16 a[140:141],v25 offset:8192
 v_mfma_f32_16x16x32_bf16 v[212:215],a[172:175],a[24:27],v[212:215]
 ds_read_b64_tr_b16 a[142:143],v25 offset:12288
 buffer_load_dwordx4 a[124:127],v1,s[60:63],s59 offen offset:3072 sc1
 v_mfma_f32_16x16x32_bf16 v[212:215],a[168:171],a[8:11],v[212:215]
 v_mfma_f32_16x16x32_bf16 v[204:207],a[168:171],a[4:7],v[204:207]
 s_add_u32 m0,s3,114688
 ds_read_b64_tr_b16 a[144:145],v26 offset:0
 v_mfma_f32_16x16x32_bf16 v[204:207],a[172:175],a[20:23],v[204:207]
 s_add_u32 s41,s58,1310720
 ds_read_b64_tr_b16 a[146:147],v26 offset:4096
 v_mfma_f32_16x16x32_bf16 v[196:199],a[172:175],a[16:19],v[196:199]
 buffer_load_dwordx4 v32,s[8:11],s41 offen offset:0 lds
 v_mfma_f32_16x16x32_bf16 v[196:199],a[168:171],a[0:3],v[196:199]
 ds_read_b64_tr_b16 a[148:149],v26 offset:8192
 v_mfma_f32_16x16x32_bf16 v[224:227],a[176:179],a[0:3],v[224:227]
 ds_read_b64_tr_b16 a[150:151],v26 offset:12288
 v_mfma_f32_16x16x32_bf16 v[224:227],a[180:183],a[16:19],v[224:227]
 v_mfma_f32_16x16x32_bf16 v[232:235],a[180:183],a[20:23],v[232:235]
 ds_read_b64_tr_b16 a[152:153],v27 offset:0
 v_mfma_f32_16x16x32_bf16 v[232:235],a[176:179],a[4:7],v[232:235]
 ds_read_b64_tr_b16 a[154:155],v27 offset:4096
 buffer_load_dwordx4 v33,s[8:11],s41 offen offset:1024 lds
 v_mfma_f32_16x16x32_bf16 v[240:243],a[176:179],a[8:11],v[240:243]
 v_mfma_f32_16x16x32_bf16 v[240:243],a[180:183],a[24:27],v[240:243]
 ds_read_b64_tr_b16 a[156:157],v27 offset:8192
 v_mfma_f32_16x16x32_bf16 v[248:251],a[180:183],a[28:31],v[248:251]
 ds_read_b64_tr_b16 a[158:159],v27 offset:12288
 v_mfma_f32_16x16x32_bf16 v[248:251],a[176:179],a[12:15],v[248:251]
 buffer_load_dwordx4 v34,s[8:11],s41 offen offset:2048 lds
 v_mfma_f32_16x16x32_bf16 v[252:255],a[184:187],a[12:15],v[252:255]
 v_mfma_f32_16x16x32_bf16 v[252:255],a[188:191],a[28:31],v[252:255]
 v_mfma_f32_16x16x32_bf16 v[244:247],a[188:191],a[24:27],v[244:247]
 v_mfma_f32_16x16x32_bf16 v[244:247],a[184:187],a[8:11],v[244:247]
 buffer_load_dwordx4 v35,s[8:11],s41 offen offset:3072 lds
 v_mfma_f32_16x16x32_bf16 v[236:239],a[184:187],a[4:7],v[236:239]
 v_mfma_f32_16x16x32_bf16 v[236:239],a[188:191],a[20:23],v[236:239]
 v_mfma_f32_16x16x32_bf16 v[228:231],a[188:191],a[16:19],v[228:231]
 v_mfma_f32_16x16x32_bf16 v[228:231],a[184:187],a[0:3],v[228:231]
 s_waitcnt vmcnt(32) lgkmcnt(0)
 v_mfma_f32_16x16x32_bf16 v[128:131],a[128:131],a[32:35],v[128:131]
 ds_read_b64_tr_b16 a[160:161],v28 offset:0
 v_mfma_f32_16x16x32_bf16 v[128:131],a[132:135],a[48:51],v[128:131]
 s_add_u32 s40,s77,32768
 ds_read_b64_tr_b16 a[162:163],v28 offset:4096
 v_mfma_f32_16x16x32_bf16 v[136:139],a[132:135],a[52:55],v[136:139]
 buffer_load_dwordx4 a[0:3],v1,s[60:63],s40 offen offset:0 sc1
 v_mfma_f32_16x16x32_bf16 v[136:139],a[128:131],a[36:39],v[136:139]
 ds_read_b64_tr_b16 a[164:165],v28 offset:8192
 v_mfma_f32_16x16x32_bf16 v[144:147],a[128:131],a[40:43],v[144:147]
 ds_read_b64_tr_b16 a[166:167],v28 offset:12288
 v_mfma_f32_16x16x32_bf16 v[144:147],a[132:135],a[56:59],v[144:147]
 v_mfma_f32_16x16x32_bf16 v[152:155],a[132:135],a[60:63],v[152:155]
 ds_read_b64_tr_b16 a[168:169],v29 offset:0
 buffer_load_dwordx4 a[4:7],v1,s[60:63],s40 offen offset:1024 sc1
 v_mfma_f32_16x16x32_bf16 v[152:155],a[128:131],a[44:47],v[152:155]
 ds_read_b64_tr_b16 a[170:171],v29 offset:4096
 v_mfma_f32_16x16x32_bf16 v[156:159],a[136:139],a[44:47],v[156:159]
 v_mfma_f32_16x16x32_bf16 v[156:159],a[140:143],a[60:63],v[156:159]
 ds_read_b64_tr_b16 a[172:173],v29 offset:8192
 v_mfma_f32_16x16x32_bf16 v[148:151],a[140:143],a[56:59],v[148:151]
 ds_read_b64_tr_b16 a[174:175],v29 offset:12288
 buffer_load_dwordx4 a[16:19],v1,s[60:63],s40 offen offset:2048 sc1
 v_mfma_f32_16x16x32_bf16 v[148:151],a[136:139],a[40:43],v[148:151]
 v_mfma_f32_16x16x32_bf16 v[140:143],a[136:139],a[36:39],v[140:143]
 ds_read_b64_tr_b16 a[176:177],v30 offset:0
 v_mfma_f32_16x16x32_bf16 v[140:143],a[140:143],a[52:55],v[140:143]
 ds_read_b64_tr_b16 a[178:179],v30 offset:4096
 v_mfma_f32_16x16x32_bf16 v[132:135],a[140:143],a[48:51],v[132:135]
 buffer_load_dwordx4 a[20:23],v1,s[60:63],s40 offen offset:3072 sc1
 v_mfma_f32_16x16x32_bf16 v[132:135],a[136:139],a[32:35],v[132:135]
 ds_read_b64_tr_b16 a[180:181],v30 offset:8192
 v_mfma_f32_16x16x32_bf16 v[160:163],a[144:147],a[32:35],v[160:163]
 ds_read_b64_tr_b16 a[182:183],v30 offset:12288
 v_mfma_f32_16x16x32_bf16 v[160:163],a[148:151],a[48:51],v[160:163]
 v_mfma_f32_16x16x32_bf16 v[168:171],a[148:151],a[52:55],v[168:171]
 s_add_u32 s59,s77,294912
 ds_read_b64_tr_b16 a[184:185],v31 offset:0
 v_mfma_f32_16x16x32_bf16 v[168:171],a[144:147],a[36:39],v[168:171]
 ds_read_b64_tr_b16 a[186:187],v31 offset:4096
 buffer_load_dwordx4 a[8:11],v1,s[60:63],s59 offen offset:0 sc1
 v_mfma_f32_16x16x32_bf16 v[176:179],a[144:147],a[40:43],v[176:179]
 v_mfma_f32_16x16x32_bf16 v[176:179],a[148:151],a[56:59],v[176:179]
 ds_read_b64_tr_b16 a[188:189],v31 offset:8192
 v_mfma_f32_16x16x32_bf16 v[184:187],a[148:151],a[60:63],v[184:187]
 ds_read_b64_tr_b16 a[190:191],v31 offset:12288
 v_mfma_f32_16x16x32_bf16 v[184:187],a[144:147],a[44:47],v[184:187]
 buffer_load_dwordx4 a[12:15],v1,s[60:63],s59 offen offset:1024 sc1
 v_mfma_f32_16x16x32_bf16 v[188:191],a[152:155],a[44:47],v[188:191]
 v_mfma_f32_16x16x32_bf16 v[188:191],a[156:159],a[60:63],v[188:191]
 v_mfma_f32_16x16x32_bf16 v[180:183],a[156:159],a[56:59],v[180:183]
 v_mfma_f32_16x16x32_bf16 v[180:183],a[152:155],a[40:43],v[180:183]
 buffer_load_dwordx4 a[24:27],v1,s[60:63],s59 offen offset:2048 sc1
 v_mfma_f32_16x16x32_bf16 v[172:175],a[152:155],a[36:39],v[172:175]
 v_mfma_f32_16x16x32_bf16 v[172:175],a[156:159],a[52:55],v[172:175]
 v_mfma_f32_16x16x32_bf16 v[164:167],a[156:159],a[48:51],v[164:167]
 v_mfma_f32_16x16x32_bf16 v[164:167],a[152:155],a[32:35],v[164:167]
 s_waitcnt vmcnt(35) lgkmcnt(0)
 s_barrier
 v_mfma_f32_16x16x32_bf16 v[192:195],a[160:163],a[32:35],v[192:195]
 ds_read_b64_tr_b16 a[128:129],v16 offset:16384
 v_mfma_f32_16x16x32_bf16 v[192:195],a[164:167],a[48:51],v[192:195]
 ds_read_b64_tr_b16 a[130:131],v16 offset:20480
 v_mfma_f32_16x16x32_bf16 v[200:203],a[164:167],a[52:55],v[200:203]
 buffer_load_dwordx4 a[28:31],v1,s[60:63],s59 offen offset:3072 sc1
 v_mfma_f32_16x16x32_bf16 v[200:203],a[160:163],a[36:39],v[200:203]
 ds_read_b64_tr_b16 a[132:133],v16 offset:24576
 v_mfma_f32_16x16x32_bf16 v[208:211],a[160:163],a[40:43],v[208:211]
 ds_read_b64_tr_b16 a[134:135],v16 offset:28672
 v_mfma_f32_16x16x32_bf16 v[208:211],a[164:167],a[56:59],v[208:211]
 s_add_u32 s40,s77,40960
 v_mfma_f32_16x16x32_bf16 v[216:219],a[164:167],a[60:63],v[216:219]
 ds_read_b64_tr_b16 a[136:137],v17 offset:16384
 buffer_load_dwordx4 a[192:195],v1,s[60:63],s40 offen offset:0 sc1
 v_mfma_f32_16x16x32_bf16 v[216:219],a[160:163],a[44:47],v[216:219]
 ds_read_b64_tr_b16 a[138:139],v17 offset:20480
 v_mfma_f32_16x16x32_bf16 v[220:223],a[168:171],a[44:47],v[220:223]
 v_mfma_f32_16x16x32_bf16 v[220:223],a[172:175],a[60:63],v[220:223]
 ds_read_b64_tr_b16 a[140:141],v17 offset:24576
 v_mfma_f32_16x16x32_bf16 v[212:215],a[172:175],a[56:59],v[212:215]
 ds_read_b64_tr_b16 a[142:143],v17 offset:28672
 buffer_load_dwordx4 a[196:199],v1,s[60:63],s40 offen offset:1024 sc1
 v_mfma_f32_16x16x32_bf16 v[212:215],a[168:171],a[40:43],v[212:215]
 v_mfma_f32_16x16x32_bf16 v[204:207],a[168:171],a[36:39],v[204:207]
 ds_read_b64_tr_b16 a[144:145],v18 offset:16384
 v_mfma_f32_16x16x32_bf16 v[204:207],a[172:175],a[52:55],v[204:207]
 ds_read_b64_tr_b16 a[146:147],v18 offset:20480
 v_mfma_f32_16x16x32_bf16 v[196:199],a[172:175],a[48:51],v[196:199]
 buffer_load_dwordx4 a[208:211],v1,s[60:63],s40 offen offset:2048 sc1
 v_mfma_f32_16x16x32_bf16 v[196:199],a[168:171],a[32:35],v[196:199]
 ds_read_b64_tr_b16 a[148:149],v18 offset:24576
 v_mfma_f32_16x16x32_bf16 v[224:227],a[176:179],a[32:35],v[224:227]
 ds_read_b64_tr_b16 a[150:151],v18 offset:28672
 v_mfma_f32_16x16x32_bf16 v[224:227],a[180:183],a[48:51],v[224:227]
 v_mfma_f32_16x16x32_bf16 v[232:235],a[180:183],a[52:55],v[232:235]
 ds_read_b64_tr_b16 a[152:153],v19 offset:16384
 v_mfma_f32_16x16x32_bf16 v[232:235],a[176:179],a[36:39],v[232:235]
 ds_read_b64_tr_b16 a[154:155],v19 offset:20480
 buffer_load_dwordx4 a[212:215],v1,s[60:63],s40 offen offset:3072 sc1
 v_mfma_f32_16x16x32_bf16 v[240:243],a[176:179],a[40:43],v[240:243]
 v_mfma_f32_16x16x32_bf16 v[240:243],a[180:183],a[56:59],v[240:243]
 ds_read_b64_tr_b16 a[156:157],v19 offset:24576
 v_mfma_f32_16x16x32_bf16 v[248:251],a[180:183],a[60:63],v[248:251]
 s_add_u32 s59,s77,303104
 ds_read_b64_tr_b16 a[158:159],v19 offset:28672
 v_mfma_f32_16x16x32_bf16 v[248:251],a[176:179],a[44:47],v[248:251]
 buffer_load_dwordx4 a[200:203],v1,s[60:63],s59 offen offset:0 sc1
 v_mfma_f32_16x16x32_bf16 v[252:255],a[184:187],a[44:47],v[252:255]
 v_mfma_f32_16x16x32_bf16 v[252:255],a[188:191],a[60:63],v[252:255]
 v_mfma_f32_16x16x32_bf16 v[244:247],a[188:191],a[56:59],v[244:247]
 v_mfma_f32_16x16x32_bf16 v[244:247],a[184:187],a[40:43],v[244:247]
 buffer_load_dwordx4 a[204:207],v1,s[60:63],s59 offen offset:1024 sc1
 v_mfma_f32_16x16x32_bf16 v[236:239],a[184:187],a[36:39],v[236:239]
 v_mfma_f32_16x16x32_bf16 v[236:239],a[188:191],a[52:55],v[236:239]
 v_mfma_f32_16x16x32_bf16 v[228:231],a[188:191],a[48:51],v[228:231]
 v_mfma_f32_16x16x32_bf16 v[228:231],a[184:187],a[32:35],v[228:231]
 s_waitcnt vmcnt(34) lgkmcnt(0)
 v_mfma_f32_16x16x32_bf16 v[128:131],a[128:131],a[64:67],v[128:131]
 ds_read_b64_tr_b16 a[160:161],v20 offset:16384
 v_mfma_f32_16x16x32_bf16 v[128:131],a[132:135],a[80:83],v[128:131]
 ds_read_b64_tr_b16 a[162:163],v20 offset:20480
 v_mfma_f32_16x16x32_bf16 v[136:139],a[132:135],a[84:87],v[136:139]
 buffer_load_dwordx4 a[216:219],v1,s[60:63],s59 offen offset:2048 sc1
 v_mfma_f32_16x16x32_bf16 v[136:139],a[128:131],a[68:71],v[136:139]
 ds_read_b64_tr_b16 a[164:165],v20 offset:24576
 v_mfma_f32_16x16x32_bf16 v[144:147],a[128:131],a[72:75],v[144:147]
 ds_read_b64_tr_b16 a[166:167],v20 offset:28672
 v_mfma_f32_16x16x32_bf16 v[144:147],a[132:135],a[88:91],v[144:147]
 v_mfma_f32_16x16x32_bf16 v[152:155],a[132:135],a[92:95],v[152:155]
 ds_read_b64_tr_b16 a[168:169],v21 offset:16384
 buffer_load_dwordx4 a[220:223],v1,s[60:63],s59 offen offset:3072 sc1
 v_mfma_f32_16x16x32_bf16 v[152:155],a[128:131],a[76:79],v[152:155]
 ds_read_b64_tr_b16 a[170:171],v21 offset:20480
 v_mfma_f32_16x16x32_bf16 v[156:159],a[136:139],a[76:79],v[156:159]
 v_mfma_f32_16x16x32_bf16 v[156:159],a[140:143],a[92:95],v[156:159]
 s_add_u32 s40,s77,36864
 ds_read_b64_tr_b16 a[172:173],v21 offset:24576
 v_mfma_f32_16x16x32_bf16 v[148:151],a[140:143],a[88:91],v[148:151]
 ds_read_b64_tr_b16 a[174:175],v21 offset:28672
 buffer_load_dwordx4 a[32:35],v1,s[60:63],s40 offen offset:0 sc1
 v_mfma_f32_16x16x32_bf16 v[148:151],a[136:139],a[72:75],v[148:151]
 v_mfma_f32_16x16x32_bf16 v[140:143],a[136:139],a[68:71],v[140:143]
 ds_read_b64_tr_b16 a[176:177],v22 offset:16384
 v_mfma_f32_16x16x32_bf16 v[140:143],a[140:143],a[84:87],v[140:143]
 ds_read_b64_tr_b16 a[178:179],v22 offset:20480
 v_mfma_f32_16x16x32_bf16 v[132:135],a[140:143],a[80:83],v[132:135]
 buffer_load_dwordx4 a[36:39],v1,s[60:63],s40 offen offset:1024 sc1
 v_mfma_f32_16x16x32_bf16 v[132:135],a[136:139],a[64:67],v[132:135]
 ds_read_b64_tr_b16 a[180:181],v22 offset:24576
 v_mfma_f32_16x16x32_bf16 v[160:163],a[144:147],a[64:67],v[160:163]
 ds_read_b64_tr_b16 a[182:183],v22 offset:28672
 v_mfma_f32_16x16x32_bf16 v[160:163],a[148:151],a[80:83],v[160:163]
 v_mfma_f32_16x16x32_bf16 v[168:171],a[148:151],a[84:87],v[168:171]
 ds_read_b64_tr_b16 a[184:185],v23 offset:16384
 v_mfma_f32_16x16x32_bf16 v[168:171],a[144:147],a[68:71],v[168:171]
 ds_read_b64_tr_b16 a[186:187],v23 offset:20480
 buffer_load_dwordx4 a[48:51],v1,s[60:63],s40 offen offset:2048 sc1
 v_mfma_f32_16x16x32_bf16 v[176:179],a[144:147],a[72:75],v[176:179]
 v_mfma_f32_16x16x32_bf16 v[176:179],a[148:151],a[88:91],v[176:179]
 ds_read_b64_tr_b16 a[188:189],v23 offset:24576
 v_mfma_f32_16x16x32_bf16 v[184:187],a[148:151],a[92:95],v[184:187]
 ds_read_b64_tr_b16 a[190:191],v23 offset:28672
 v_mfma_f32_16x16x32_bf16 v[184:187],a[144:147],a[76:79],v[184:187]
 buffer_load_dwordx4 a[52:55],v1,s[60:63],s40 offen offset:3072 sc1
 v_mfma_f32_16x16x32_bf16 v[188:191],a[152:155],a[76:79],v[188:191]
 v_mfma_f32_16x16x32_bf16 v[188:191],a[156:159],a[92:95],v[188:191]
 v_mfma_f32_16x16x32_bf16 v[180:183],a[156:159],a[88:91],v[180:183]
 s_add_u32 s59,s77,299008
 v_mfma_f32_16x16x32_bf16 v[180:183],a[152:155],a[72:75],v[180:183]
 buffer_load_dwordx4 a[40:43],v1,s[60:63],s59 offen offset:0 sc1
 v_mfma_f32_16x16x32_bf16 v[172:175],a[152:155],a[68:71],v[172:175]
 v_mfma_f32_16x16x32_bf16 v[172:175],a[156:159],a[84:87],v[172:175]
 v_mfma_f32_16x16x32_bf16 v[164:167],a[156:159],a[80:83],v[164:167]
 v_mfma_f32_16x16x32_bf16 v[164:167],a[152:155],a[64:67],v[164:167]
 s_waitcnt vmcnt(37) lgkmcnt(0)
 s_barrier
 v_mfma_f32_16x16x32_bf16 v[192:195],a[160:163],a[64:67],v[192:195]
 ds_read_b64_tr_b16 a[128:129],v24 offset:16384
 v_mfma_f32_16x16x32_bf16 v[192:195],a[164:167],a[80:83],v[192:195]
 ds_read_b64_tr_b16 a[130:131],v24 offset:20480
 v_mfma_f32_16x16x32_bf16 v[200:203],a[164:167],a[84:87],v[200:203]
 buffer_load_dwordx4 a[44:47],v1,s[60:63],s59 offen offset:1024 sc1
 v_mfma_f32_16x16x32_bf16 v[200:203],a[160:163],a[68:71],v[200:203]
 ds_read_b64_tr_b16 a[132:133],v24 offset:24576
 v_mfma_f32_16x16x32_bf16 v[208:211],a[160:163],a[72:75],v[208:211]
 ds_read_b64_tr_b16 a[134:135],v24 offset:28672
 v_mfma_f32_16x16x32_bf16 v[208:211],a[164:167],a[88:91],v[208:211]
 v_mfma_f32_16x16x32_bf16 v[216:219],a[164:167],a[92:95],v[216:219]
 ds_read_b64_tr_b16 a[136:137],v25 offset:16384
 buffer_load_dwordx4 a[56:59],v1,s[60:63],s59 offen offset:2048 sc1
 v_mfma_f32_16x16x32_bf16 v[216:219],a[160:163],a[76:79],v[216:219]
 ds_read_b64_tr_b16 a[138:139],v25 offset:20480
 v_mfma_f32_16x16x32_bf16 v[220:223],a[168:171],a[76:79],v[220:223]
 v_mfma_f32_16x16x32_bf16 v[220:223],a[172:175],a[92:95],v[220:223]
 ds_read_b64_tr_b16 a[140:141],v25 offset:24576
 v_mfma_f32_16x16x32_bf16 v[212:215],a[172:175],a[88:91],v[212:215]
 ds_read_b64_tr_b16 a[142:143],v25 offset:28672
 buffer_load_dwordx4 a[60:63],v1,s[60:63],s59 offen offset:3072 sc1
 v_mfma_f32_16x16x32_bf16 v[212:215],a[168:171],a[72:75],v[212:215]
 v_mfma_f32_16x16x32_bf16 v[204:207],a[168:171],a[68:71],v[204:207]
 ds_read_b64_tr_b16 a[144:145],v26 offset:16384
 v_mfma_f32_16x16x32_bf16 v[204:207],a[172:175],a[84:87],v[204:207]
 s_add_u32 s40,s77,45056
 ds_read_b64_tr_b16 a[146:147],v26 offset:20480
 v_mfma_f32_16x16x32_bf16 v[196:199],a[172:175],a[80:83],v[196:199]
 buffer_load_dwordx4 a[224:227],v1,s[60:63],s40 offen offset:0 sc1
 v_mfma_f32_16x16x32_bf16 v[196:199],a[168:171],a[64:67],v[196:199]
 ds_read_b64_tr_b16 a[148:149],v26 offset:24576
 v_mfma_f32_16x16x32_bf16 v[224:227],a[176:179],a[64:67],v[224:227]
 ds_read_b64_tr_b16 a[150:151],v26 offset:28672
 v_mfma_f32_16x16x32_bf16 v[224:227],a[180:183],a[80:83],v[224:227]
 v_mfma_f32_16x16x32_bf16 v[232:235],a[180:183],a[84:87],v[232:235]
 ds_read_b64_tr_b16 a[152:153],v27 offset:16384
 v_mfma_f32_16x16x32_bf16 v[232:235],a[176:179],a[68:71],v[232:235]
 ds_read_b64_tr_b16 a[154:155],v27 offset:20480
 buffer_load_dwordx4 a[228:231],v1,s[60:63],s40 offen offset:1024 sc1
 v_mfma_f32_16x16x32_bf16 v[240:243],a[176:179],a[72:75],v[240:243]
 v_mfma_f32_16x16x32_bf16 v[240:243],a[180:183],a[88:91],v[240:243]
 ds_read_b64_tr_b16 a[156:157],v27 offset:24576
 v_mfma_f32_16x16x32_bf16 v[248:251],a[180:183],a[92:95],v[248:251]
 ds_read_b64_tr_b16 a[158:159],v27 offset:28672
 v_mfma_f32_16x16x32_bf16 v[248:251],a[176:179],a[76:79],v[248:251]
 buffer_load_dwordx4 a[240:243],v1,s[60:63],s40 offen offset:2048 sc1
 v_mfma_f32_16x16x32_bf16 v[252:255],a[184:187],a[76:79],v[252:255]
 v_mfma_f32_16x16x32_bf16 v[252:255],a[188:191],a[92:95],v[252:255]
 v_mfma_f32_16x16x32_bf16 v[244:247],a[188:191],a[88:91],v[244:247]
 v_mfma_f32_16x16x32_bf16 v[244:247],a[184:187],a[72:75],v[244:247]
 buffer_load_dwordx4 a[244:247],v1,s[60:63],s40 offen offset:3072 sc1
 v_mfma_f32_16x16x32_bf16 v[236:239],a[184:187],a[68:71],v[236:239]
 v_mfma_f32_16x16x32_bf16 v[236:239],a[188:191],a[84:87],v[236:239]
 v_mfma_f32_16x16x32_bf16 v[228:231],a[188:191],a[80:83],v[228:231]
 v_mfma_f32_16x16x32_bf16 v[228:231],a[184:187],a[64:67],v[228:231]
 s_waitcnt vmcnt(32) lgkmcnt(0)
 v_mfma_f32_16x16x32_bf16 v[128:131],a[128:131],a[96:99],v[128:131]
 ds_read_b64_tr_b16 a[160:161],v28 offset:16384
 v_mfma_f32_16x16x32_bf16 v[128:131],a[132:135],a[112:115],v[128:131]
 s_add_u32 s59,s77,307200
 ds_read_b64_tr_b16 a[162:163],v28 offset:20480
 v_mfma_f32_16x16x32_bf16 v[136:139],a[132:135],a[116:119],v[136:139]
 buffer_load_dwordx4 a[232:235],v1,s[60:63],s59 offen offset:0 sc1
 v_mfma_f32_16x16x32_bf16 v[136:139],a[128:131],a[100:103],v[136:139]
 ds_read_b64_tr_b16 a[164:165],v28 offset:24576
 v_mfma_f32_16x16x32_bf16 v[144:147],a[128:131],a[104:107],v[144:147]
 ds_read_b64_tr_b16 a[166:167],v28 offset:28672
 v_mfma_f32_16x16x32_bf16 v[144:147],a[132:135],a[120:123],v[144:147]
 v_mfma_f32_16x16x32_bf16 v[152:155],a[132:135],a[124:127],v[152:155]
 ds_read_b64_tr_b16 a[168:169],v29 offset:16384
 v_mfma_f32_16x16x32_bf16 v[152:155],a[128:131],a[108:111],v[152:155]
 ds_read_b64_tr_b16 a[170:171],v29 offset:20480
 v_mfma_f32_16x16x32_bf16 v[156:159],a[136:139],a[108:111],v[156:159]
 v_mfma_f32_16x16x32_bf16 v[156:159],a[140:143],a[124:127],v[156:159]
 ds_read_b64_tr_b16 a[172:173],v29 offset:24576
 buffer_load_dwordx4 a[236:239],v1,s[60:63],s59 offen offset:1024 sc1
 v_mfma_f32_16x16x32_bf16 v[148:151],a[140:143],a[120:123],v[148:151]
 ds_read_b64_tr_b16 a[174:175],v29 offset:28672
 v_mfma_f32_16x16x32_bf16 v[148:151],a[136:139],a[104:107],v[148:151]
 v_mfma_f32_16x16x32_bf16 v[140:143],a[136:139],a[100:103],v[140:143]
 ds_read_b64_tr_b16 a[176:177],v30 offset:16384
 v_mfma_f32_16x16x32_bf16 v[140:143],a[140:143],a[116:119],v[140:143]
 ds_read_b64_tr_b16 a[178:179],v30 offset:20480
 v_mfma_f32_16x16x32_bf16 v[132:135],a[140:143],a[112:115],v[132:135]
 v_mfma_f32_16x16x32_bf16 v[132:135],a[136:139],a[96:99],v[132:135]
 ds_read_b64_tr_b16 a[180:181],v30 offset:24576
 v_mfma_f32_16x16x32_bf16 v[160:163],a[144:147],a[96:99],v[160:163]
 ds_read_b64_tr_b16 a[182:183],v30 offset:28672
 v_mfma_f32_16x16x32_bf16 v[160:163],a[148:151],a[112:115],v[160:163]
 buffer_load_dwordx4 a[248:251],v1,s[60:63],s59 offen offset:2048 sc1
 v_mfma_f32_16x16x32_bf16 v[168:171],a[148:151],a[116:119],v[168:171]
 ds_read_b64_tr_b16 a[184:185],v31 offset:16384
 v_mfma_f32_16x16x32_bf16 v[168:171],a[144:147],a[100:103],v[168:171]
 ds_read_b64_tr_b16 a[186:187],v31 offset:20480
 v_mfma_f32_16x16x32_bf16 v[176:179],a[144:147],a[104:107],v[176:179]
 v_mfma_f32_16x16x32_bf16 v[176:179],a[148:151],a[120:123],v[176:179]
 ds_read_b64_tr_b16 a[188:189],v31 offset:24576
 v_mfma_f32_16x16x32_bf16 v[184:187],a[148:151],a[124:127],v[184:187]
 ds_read_b64_tr_b16 a[190:191],v31 offset:28672
 v_mfma_f32_16x16x32_bf16 v[184:187],a[144:147],a[108:111],v[184:187]
 v_mfma_f32_16x16x32_bf16 v[188:191],a[152:155],a[108:111],v[188:191]
 buffer_load_dwordx4 a[252:255],v1,s[60:63],s59 offen offset:3072 sc1
 v_mfma_f32_16x16x32_bf16 v[188:191],a[156:159],a[124:127],v[188:191]
 v_mfma_f32_16x16x32_bf16 v[180:183],a[156:159],a[120:123],v[180:183]
 v_mfma_f32_16x16x32_bf16 v[180:183],a[152:155],a[104:107],v[180:183]
 v_mfma_f32_16x16x32_bf16 v[172:175],a[152:155],a[100:103],v[172:175]
 v_mfma_f32_16x16x32_bf16 v[172:175],a[156:159],a[116:119],v[172:175]
 v_mfma_f32_16x16x32_bf16 v[164:167],a[156:159],a[112:115],v[164:167]
 v_mfma_f32_16x16x32_bf16 v[164:167],a[152:155],a[96:99],v[164:167]
 s_waitcnt vmcnt(32) lgkmcnt(0)
 s_barrier
 v_mfma_f32_16x16x32_bf16 v[192:195],a[160:163],a[96:99],v[192:195]
 ds_read_b64_tr_b16 a[128:129],v16 offset:32768
 v_mfma_f32_16x16x32_bf16 v[192:195],a[164:167],a[112:115],v[192:195]
 s_mov_b32 s47,0
 ds_read_b64_tr_b16 a[130:131],v16 offset:36864
 v_mfma_f32_16x16x32_bf16 v[200:203],a[164:167],a[116:119],v[200:203]
 buffer_load_dwordx4 v[64:67],v56,s[72:75],s47 offen
 v_mfma_f32_16x16x32_bf16 v[200:203],a[160:163],a[100:103],v[200:203]
 ds_read_b64_tr_b16 a[132:133],v16 offset:40960
 v_mfma_f32_16x16x32_bf16 v[208:211],a[160:163],a[104:107],v[208:211]
 ds_read_b64_tr_b16 a[134:135],v16 offset:45056
 v_mfma_f32_16x16x32_bf16 v[208:211],a[164:167],a[120:123],v[208:211]
 v_mfma_f32_16x16x32_bf16 v[216:219],a[164:167],a[124:127],v[216:219]
 ds_read_b64_tr_b16 a[136:137],v24 offset:32768
 v_mfma_f32_16x16x32_bf16 v[216:219],a[160:163],a[108:111],v[216:219]
 ds_read_b64_tr_b16 a[138:139],v24 offset:36864
 v_mfma_f32_16x16x32_bf16 v[220:223],a[168:171],a[108:111],v[220:223]
 v_mfma_f32_16x16x32_bf16 v[220:223],a[172:175],a[124:127],v[220:223]
 ds_read_b64_tr_b16 a[140:141],v24 offset:40960
 v_mfma_f32_16x16x32_bf16 v[212:215],a[172:175],a[120:123],v[212:215]
 ds_read_b64_tr_b16 a[142:143],v24 offset:45056
 v_mfma_f32_16x16x32_bf16 v[212:215],a[168:171],a[104:107],v[212:215]
 v_mfma_f32_16x16x32_bf16 v[204:207],a[168:171],a[100:103],v[204:207]
 ds_read_b64_tr_b16 a[144:145],v16 offset:49152
 v_mfma_f32_16x16x32_bf16 v[204:207],a[172:175],a[116:119],v[204:207]
 ds_read_b64_tr_b16 a[146:147],v16 offset:53248
 v_mfma_f32_16x16x32_bf16 v[196:199],a[172:175],a[112:115],v[196:199]
 v_mfma_f32_16x16x32_bf16 v[196:199],a[168:171],a[96:99],v[196:199]
 ds_read_b64_tr_b16 a[148:149],v16 offset:57344
 v_mfma_f32_16x16x32_bf16 v[224:227],a[176:179],a[96:99],v[224:227]
 s_mov_b32 s47,32768
 ds_read_b64_tr_b16 a[150:151],v16 offset:61440
 v_mfma_f32_16x16x32_bf16 v[224:227],a[180:183],a[112:115],v[224:227]
 buffer_load_dwordx4 v[68:71],v56,s[72:75],s47 offen
 v_mfma_f32_16x16x32_bf16 v[232:235],a[180:183],a[116:119],v[232:235]
 ds_read_b64_tr_b16 a[152:153],v24 offset:49152
 v_mfma_f32_16x16x32_bf16 v[232:235],a[176:179],a[100:103],v[232:235]
 ds_read_b64_tr_b16 a[154:155],v24 offset:53248
 v_mfma_f32_16x16x32_bf16 v[240:243],a[176:179],a[104:107],v[240:243]
 v_mfma_f32_16x16x32_bf16 v[240:243],a[180:183],a[120:123],v[240:243]
 ds_read_b64_tr_b16 a[156:157],v24 offset:57344
 v_mfma_f32_16x16x32_bf16 v[248:251],a[180:183],a[124:127],v[248:251]
 ds_read_b64_tr_b16 a[158:159],v24 offset:61440
 v_mfma_f32_16x16x32_bf16 v[248:251],a[176:179],a[108:111],v[248:251]
 v_mfma_f32_16x16x32_bf16 v[252:255],a[184:187],a[108:111],v[252:255]
 v_mfma_f32_16x16x32_bf16 v[252:255],a[188:191],a[124:127],v[252:255]
 v_mfma_f32_16x16x32_bf16 v[244:247],a[188:191],a[120:123],v[244:247]
 v_mfma_f32_16x16x32_bf16 v[244:247],a[184:187],a[104:107],v[244:247]
 v_mfma_f32_16x16x32_bf16 v[236:239],a[184:187],a[100:103],v[236:239]
 v_mfma_f32_16x16x32_bf16 v[236:239],a[188:191],a[116:119],v[236:239]
 v_mfma_f32_16x16x32_bf16 v[228:231],a[188:191],a[112:115],v[228:231]
 v_mfma_f32_16x16x32_bf16 v[228:231],a[184:187],a[96:99],v[228:231]
 s_waitcnt vmcnt(2) lgkmcnt(0)
 v_mfma_f32_16x16x32_bf16 v[128:131],a[128:131],a[0:3],v[128:131]
 ds_read_b64_tr_b16 a[160:161],v17 offset:32768
 v_mfma_f32_16x16x32_bf16 v[128:131],a[132:135],a[16:19],v[128:131]
 s_mov_b32 s47,65536
 ds_read_b64_tr_b16 a[162:163],v17 offset:36864
 v_mfma_f32_16x16x32_bf16 v[128:131],a[136:139],a[32:35],v[128:131]
 buffer_load_dwordx4 v[72:75],v56,s[72:75],s47 offen
 v_mfma_f32_16x16x32_bf16 v[128:131],a[140:143],a[48:51],v[128:131]
 ds_read_b64_tr_b16 a[164:165],v17 offset:40960
 v_mfma_f32_16x16x32_bf16 v[128:131],a[144:147],a[192:195],v[128:131]
 ds_read_b64_tr_b16 a[166:167],v17 offset:45056
 v_mfma_f32_16x16x32_bf16 v[128:131],a[148:151],a[208:211],v[128:131]
 v_mfma_f32_16x16x32_bf16 v[128:131],a[152:155],a[224:227],v[128:131]
 ds_read_b64_tr_b16 a[168:169],v25 offset:32768
 v_mfma_f32_16x16x32_bf16 v[128:131],a[156:159],a[240:243],v[128:131]
 ds_read_b64_tr_b16 a[170:171],v25 offset:36864
 v_mfma_f32_16x16x32_bf16 v[136:139],a[156:159],a[244:247],v[136:139]
 v_mfma_f32_16x16x32_bf16 v[136:139],a[152:155],a[228:231],v[136:139]
 ds_read_b64_tr_b16 a[172:173],v25 offset:40960
 v_mfma_f32_16x16x32_bf16 v[136:139],a[148:151],a[212:215],v[136:139]
 ds_read_b64_tr_b16 a[174:175],v25 offset:45056
 v_mfma_f32_16x16x32_bf16 v[136:139],a[144:147],a[196:199],v[136:139]
 v_mfma_f32_16x16x32_bf16 v[136:139],a[140:143],a[52:55],v[136:139]
 ds_read_b64_tr_b16 a[176:177],v17 offset:49152
 v_mfma_f32_16x16x32_bf16 v[136:139],a[136:139],a[36:39],v[136:139]
 ds_read_b64_tr_b16 a[178:179],v17 offset:53248
 v_mfma_f32_16x16x32_bf16 v[136:139],a[132:135],a[20:23],v[136:139]
 v_mfma_f32_16x16x32_bf16 v[136:139],a[128:131],a[4:7],v[136:139]
 ds_read_b64_tr_b16 a[180:181],v17 offset:57344
 v_mfma_f32_16x16x32_bf16 v[144:147],a[128:131],a[8:11],v[144:147]
 s_mov_b32 s47,98304
 ds_read_b64_tr_b16 a[182:183],v17 offset:61440
 v_mfma_f32_16x16x32_bf16 v[144:147],a[132:135],a[24:27],v[144:147]
 buffer_load_dwordx4 v[76:79],v56,s[72:75],s47 offen
 v_mfma_f32_16x16x32_bf16 v[144:147],a[136:139],a[40:43],v[144:147]
 ds_read_b64_tr_b16 a[184:185],v25 offset:49152
 v_mfma_f32_16x16x32_bf16 v[144:147],a[140:143],a[56:59],v[144:147]
 ds_read_b64_tr_b16 a[186:187],v25 offset:53248
 v_mfma_f32_16x16x32_bf16 v[144:147],a[144:147],a[200:203],v[144:147]
 v_mfma_f32_16x16x32_bf16 v[144:147],a[148:151],a[216:219],v[144:147]
 ds_read_b64_tr_b16 a[188:189],v25 offset:57344
 v_mfma_f32_16x16x32_bf16 v[144:147],a[152:155],a[232:235],v[144:147]
 ds_read_b64_tr_b16 a[190:191],v25 offset:61440
 v_mfma_f32_16x16x32_bf16 v[144:147],a[156:159],a[248:251],v[144:147]
 v_mfma_f32_16x16x32_bf16 v[152:155],a[156:159],a[252:255],v[152:155]
 v_mfma_f32_16x16x32_bf16 v[152:155],a[152:155],a[236:239],v[152:155]
 v_mfma_f32_16x16x32_bf16 v[152:155],a[148:151],a[220:223],v[152:155]
 v_mfma_f32_16x16x32_bf16 v[152:155],a[144:147],a[204:207],v[152:155]
 v_mfma_f32_16x16x32_bf16 v[152:155],a[140:143],a[60:63],v[152:155]
 v_mfma_f32_16x16x32_bf16 v[152:155],a[136:139],a[44:47],v[152:155]
 v_mfma_f32_16x16x32_bf16 v[152:155],a[132:135],a[28:31],v[152:155]
 v_mfma_f32_16x16x32_bf16 v[152:155],a[128:131],a[12:15],v[152:155]
 s_waitcnt lgkmcnt(0)
 v_mfma_f32_16x16x32_bf16 v[132:135],a[160:163],a[0:3],v[132:135]
 ds_read_b64_tr_b16 a[128:129],v18 offset:32768
 v_mfma_f32_16x16x32_bf16 v[132:135],a[164:167],a[16:19],v[132:135]
 ds_read_b64_tr_b16 a[130:131],v18 offset:36864
 v_mfma_f32_16x16x32_bf16 v[132:135],a[168:171],a[32:35],v[132:135]
 v_mfma_f32_16x16x32_bf16 v[132:135],a[172:175],a[48:51],v[132:135]
 ds_read_b64_tr_b16 a[132:133],v18 offset:40960
 v_mfma_f32_16x16x32_bf16 v[132:135],a[176:179],a[192:195],v[132:135]
 ds_read_b64_tr_b16 a[134:135],v18 offset:45056
 v_mfma_f32_16x16x32_bf16 v[132:135],a[180:183],a[208:211],v[132:135]
 v_mfma_f32_16x16x32_bf16 v[132:135],a[184:187],a[224:227],v[132:135]
 ds_read_b64_tr_b16 a[136:137],v26 offset:32768
 v_mfma_f32_16x16x32_bf16 v[132:135],a[188:191],a[240:243],v[132:135]
 ds_read_b64_tr_b16 a[138:139],v26 offset:36864
 v_mfma_f32_16x16x32_bf16 v[140:143],a[188:191],a[244:247],v[140:143]
 v_mfma_f32_16x16x32_bf16 v[140:143],a[184:187],a[228:231],v[140:143]
 ds_read_b64_tr_b16 a[140:141],v26 offset:40960
 v_mfma_f32_16x16x32_bf16 v[140:143],a[180:183],a[212:215],v[140:143]
 ds_read_b64_tr_b16 a[142:143],v26 offset:45056
 v_mfma_f32_16x16x32_bf16 v[140:143],a[176:179],a[196:199],v[140:143]
 v_mfma_f32_16x16x32_bf16 v[140:143],a[172:175],a[52:55],v[140:143]
 ds_read_b64_tr_b16 a[144:145],v18 offset:49152
 v_mfma_f32_16x16x32_bf16 v[140:143],a[168:171],a[36:39],v[140:143]
 ds_read_b64_tr_b16 a[146:147],v18 offset:53248
 v_mfma_f32_16x16x32_bf16 v[140:143],a[164:167],a[20:23],v[140:143]
 v_mfma_f32_16x16x32_bf16 v[140:143],a[160:163],a[4:7],v[140:143]
 ds_read_b64_tr_b16 a[148:149],v18 offset:57344
 v_mfma_f32_16x16x32_bf16 v[148:151],a[160:163],a[8:11],v[148:151]
 ds_read_b64_tr_b16 a[150:151],v18 offset:61440
 v_mfma_f32_16x16x32_bf16 v[148:151],a[164:167],a[24:27],v[148:151]
 v_mfma_f32_16x16x32_bf16 v[148:151],a[168:171],a[40:43],v[148:151]
 ds_read_b64_tr_b16 a[152:153],v26 offset:49152
 v_mfma_f32_16x16x32_bf16 v[148:151],a[172:175],a[56:59],v[148:151]
L_stub_o_4:
 s_cbranch_execz L_warm_o_ret
 ds_read_b64_tr_b16 a[154:155],v26 offset:53248
 v_mfma_f32_16x16x32_bf16 v[148:151],a[176:179],a[200:203],v[148:151]
 v_mfma_f32_16x16x32_bf16 v[148:151],a[180:183],a[216:219],v[148:151]
 ds_read_b64_tr_b16 a[156:157],v26 offset:57344
 v_mfma_f32_16x16x32_bf16 v[148:151],a[184:187],a[232:235],v[148:151]
 ds_read_b64_tr_b16 a[158:159],v26 offset:61440
 v_mfma_f32_16x16x32_bf16 v[148:151],a[188:191],a[248:251],v[148:151]
 v_mfma_f32_16x16x32_bf16 v[156:159],a[188:191],a[252:255],v[156:159]
 v_mfma_f32_16x16x32_bf16 v[156:159],a[184:187],a[236:239],v[156:159]
 v_mfma_f32_16x16x32_bf16 v[156:159],a[180:183],a[220:223],v[156:159]
 v_mfma_f32_16x16x32_bf16 v[156:159],a[176:179],a[204:207],v[156:159]
 v_mfma_f32_16x16x32_bf16 v[156:159],a[172:175],a[60:63],v[156:159]
 v_mfma_f32_16x16x32_bf16 v[156:159],a[168:171],a[44:47],v[156:159]
 v_mfma_f32_16x16x32_bf16 v[156:159],a[164:167],a[28:31],v[156:159]
 v_mfma_f32_16x16x32_bf16 v[156:159],a[160:163],a[12:15],v[156:159]
 s_waitcnt lgkmcnt(0)
 v_mfma_f32_16x16x32_bf16 v[160:163],a[128:131],a[0:3],v[160:163]
 ds_read_b64_tr_b16 a[160:161],v19 offset:32768
 v_cvt_pk_bf16_f32 v8,v128,v129
 v_mfma_f32_16x16x32_bf16 v[160:163],a[132:135],a[16:19],v[160:163]
 ds_read_b64_tr_b16 a[162:163],v19 offset:36864
 v_cvt_pk_bf16_f32 v9,v130,v131
 v_mfma_f32_16x16x32_bf16 v[160:163],a[136:139],a[32:35],v[160:163]
 v_cvt_pk_bf16_f32 v10,v132,v133
 v_cvt_pk_bf16_f32 v11,v134,v135
 v_mfma_f32_16x16x32_bf16 v[160:163],a[140:143],a[48:51],v[160:163]
 ds_read_b64_tr_b16 a[164:165],v19 offset:40960
 v_min_u32 v8,-2,v8
 v_mfma_f32_16x16x32_bf16 v[160:163],a[144:147],a[192:195],v[160:163]
 ds_read_b64_tr_b16 a[166:167],v19 offset:45056
 v_min_u32 v9,-2,v9
 v_mfma_f32_16x16x32_bf16 v[160:163],a[148:151],a[208:211],v[160:163]
 v_min_u32 v10,-2,v10
 v_min_u32 v11,-2,v11
 v_mfma_f32_16x16x32_bf16 v[160:163],a[152:155],a[224:227],v[160:163]
 s_add_u32 s46,s12,0
 ds_read_b64_tr_b16 a[168:169],v27 offset:32768
 buffer_store_dwordx4 v[8:11],v1,s[20:23],s46 offen sc1
 v_mfma_f32_16x16x32_bf16 v[160:163],a[156:159],a[240:243],v[160:163]
 ds_read_b64_tr_b16 a[170:171],v27 offset:36864
 v_mfma_f32_16x16x32_bf16 v[168:171],a[156:159],a[244:247],v[168:171]
 v_mfma_f32_16x16x32_bf16 v[168:171],a[152:155],a[228:231],v[168:171]
 ds_read_b64_tr_b16 a[172:173],v27 offset:40960
 v_mfma_f32_16x16x32_bf16 v[168:171],a[148:151],a[212:215],v[168:171]
 ds_read_b64_tr_b16 a[174:175],v27 offset:45056
 v_mfma_f32_16x16x32_bf16 v[168:171],a[144:147],a[196:199],v[168:171]
 v_mfma_f32_16x16x32_bf16 v[168:171],a[140:143],a[52:55],v[168:171]
 ds_read_b64_tr_b16 a[176:177],v19 offset:49152
 v_mfma_f32_16x16x32_bf16 v[168:171],a[136:139],a[36:39],v[168:171]
 ds_read_b64_tr_b16 a[178:179],v19 offset:53248
 v_mfma_f32_16x16x32_bf16 v[168:171],a[132:135],a[20:23],v[168:171]
 v_mfma_f32_16x16x32_bf16 v[168:171],a[128:131],a[4:7],v[168:171]
 ds_read_b64_tr_b16 a[180:181],v19 offset:57344
 v_mfma_f32_16x16x32_bf16 v[176:179],a[128:131],a[8:11],v[176:179]
 ds_read_b64_tr_b16 a[182:183],v19 offset:61440
 v_cvt_pk_bf16_f32 v12,v136,v137
 v_mfma_f32_16x16x32_bf16 v[176:179],a[132:135],a[24:27],v[176:179]
 v_cvt_pk_bf16_f32 v13,v138,v139
 v_cvt_pk_bf16_f32 v14,v140,v141
 v_mfma_f32_16x16x32_bf16 v[176:179],a[136:139],a[40:43],v[176:179]
 ds_read_b64_tr_b16 a[184:185],v27 offset:49152
 v_cvt_pk_bf16_f32 v15,v142,v143
 v_mfma_f32_16x16x32_bf16 v[176:179],a[140:143],a[56:59],v[176:179]
 ds_read_b64_tr_b16 a[186:187],v27 offset:53248
 v_min_u32 v12,-2,v12
 v_mfma_f32_16x16x32_bf16 v[176:179],a[144:147],a[200:203],v[176:179]
 v_min_u32 v13,-2,v13
 v_min_u32 v14,-2,v14
 v_mfma_f32_16x16x32_bf16 v[176:179],a[148:151],a[216:219],v[176:179]
 ds_read_b64_tr_b16 a[188:189],v27 offset:57344
 v_min_u32 v15,-2,v15
 v_mfma_f32_16x16x32_bf16 v[176:179],a[152:155],a[232:235],v[176:179]
 s_add_u32 s46,s12,32768
 ds_read_b64_tr_b16 a[190:191],v27 offset:61440
 buffer_store_dwordx4 v[12:15],v1,s[20:23],s46 offen sc1
 v_mfma_f32_16x16x32_bf16 v[176:179],a[156:159],a[248:251],v[176:179]
 v_mfma_f32_16x16x32_bf16 v[184:187],a[156:159],a[252:255],v[184:187]
 v_mfma_f32_16x16x32_bf16 v[184:187],a[152:155],a[236:239],v[184:187]
 v_mfma_f32_16x16x32_bf16 v[184:187],a[148:151],a[220:223],v[184:187]
 v_mfma_f32_16x16x32_bf16 v[184:187],a[144:147],a[204:207],v[184:187]
 v_mfma_f32_16x16x32_bf16 v[184:187],a[140:143],a[60:63],v[184:187]
 v_mfma_f32_16x16x32_bf16 v[184:187],a[136:139],a[44:47],v[184:187]
 v_mfma_f32_16x16x32_bf16 v[184:187],a[132:135],a[28:31],v[184:187]
 v_mfma_f32_16x16x32_bf16 v[184:187],a[128:131],a[12:15],v[184:187]
 s_waitcnt lgkmcnt(0)
 v_mfma_f32_16x16x32_bf16 v[164:167],a[160:163],a[0:3],v[164:167]
 ds_read_b64_tr_b16 a[128:129],v20 offset:32768
 v_cvt_pk_bf16_f32 v44,v144,v145
 v_mfma_f32_16x16x32_bf16 v[164:167],a[164:167],a[16:19],v[164:167]
 ds_read_b64_tr_b16 a[130:131],v20 offset:36864
 v_cvt_pk_bf16_f32 v45,v146,v147
 v_mfma_f32_16x16x32_bf16 v[164:167],a[168:171],a[32:35],v[164:167]
 v_cvt_pk_bf16_f32 v46,v148,v149
 v_cvt_pk_bf16_f32 v47,v150,v151
 v_mfma_f32_16x16x32_bf16 v[164:167],a[172:175],a[48:51],v[164:167]
 ds_read_b64_tr_b16 a[132:133],v20 offset:40960
 v_min_u32 v44,-2,v44
 v_mfma_f32_16x16x32_bf16 v[164:167],a[176:179],a[192:195],v[164:167]
 ds_read_b64_tr_b16 a[134:135],v20 offset:45056
 v_min_u32 v45,-2,v45
 v_mfma_f32_16x16x32_bf16 v[164:167],a[180:183],a[208:211],v[164:167]
 v_min_u32 v46,-2,v46
 v_min_u32 v47,-2,v47
 v_mfma_f32_16x16x32_bf16 v[164:167],a[184:187],a[224:227],v[164:167]
 s_add_u32 s46,s12,65536
 ds_read_b64_tr_b16 a[136:137],v28 offset:32768
 buffer_store_dwordx4 v[44:47],v1,s[20:23],s46 offen sc1
 v_mfma_f32_16x16x32_bf16 v[164:167],a[188:191],a[240:243],v[164:167]
 ds_read_b64_tr_b16 a[138:139],v28 offset:36864
 v_mfma_f32_16x16x32_bf16 v[172:175],a[188:191],a[244:247],v[172:175]
 v_mfma_f32_16x16x32_bf16 v[172:175],a[184:187],a[228:231],v[172:175]
 ds_read_b64_tr_b16 a[140:141],v28 offset:40960
 v_mfma_f32_16x16x32_bf16 v[172:175],a[180:183],a[212:215],v[172:175]
 ds_read_b64_tr_b16 a[142:143],v28 offset:45056
 v_mfma_f32_16x16x32_bf16 v[172:175],a[176:179],a[196:199],v[172:175]
 v_mfma_f32_16x16x32_bf16 v[172:175],a[172:175],a[52:55],v[172:175]
 ds_read_b64_tr_b16 a[144:145],v20 offset:49152
 v_mfma_f32_16x16x32_bf16 v[172:175],a[168:171],a[36:39],v[172:175]
 ds_read_b64_tr_b16 a[146:147],v20 offset:53248
 v_mfma_f32_16x16x32_bf16 v[172:175],a[164:167],a[20:23],v[172:175]
 v_mfma_f32_16x16x32_bf16 v[172:175],a[160:163],a[4:7],v[172:175]
 ds_read_b64_tr_b16 a[148:149],v20 offset:57344
 v_mfma_f32_16x16x32_bf16 v[180:183],a[160:163],a[8:11],v[180:183]
 ds_read_b64_tr_b16 a[150:151],v20 offset:61440
 v_cvt_pk_bf16_f32 v48,v152,v153
 v_mfma_f32_16x16x32_bf16 v[180:183],a[164:167],a[24:27],v[180:183]
 v_cvt_pk_bf16_f32 v49,v154,v155
 v_cvt_pk_bf16_f32 v50,v156,v157
 v_mfma_f32_16x16x32_bf16 v[180:183],a[168:171],a[40:43],v[180:183]
 ds_read_b64_tr_b16 a[152:153],v28 offset:49152
 v_cvt_pk_bf16_f32 v51,v158,v159
 v_mfma_f32_16x16x32_bf16 v[180:183],a[172:175],a[56:59],v[180:183]
 ds_read_b64_tr_b16 a[154:155],v28 offset:53248
 v_min_u32 v48,-2,v48
 v_mfma_f32_16x16x32_bf16 v[180:183],a[176:179],a[200:203],v[180:183]
 v_min_u32 v49,-2,v49
 v_min_u32 v50,-2,v50
 v_mfma_f32_16x16x32_bf16 v[180:183],a[180:183],a[216:219],v[180:183]
 ds_read_b64_tr_b16 a[156:157],v28 offset:57344
 v_min_u32 v51,-2,v51
 v_mfma_f32_16x16x32_bf16 v[180:183],a[184:187],a[232:235],v[180:183]
 s_add_u32 s46,s12,98304
 ds_read_b64_tr_b16 a[158:159],v28 offset:61440
 buffer_store_dwordx4 v[48:51],v1,s[20:23],s46 offen sc1
 v_mfma_f32_16x16x32_bf16 v[180:183],a[188:191],a[248:251],v[180:183]
 v_mfma_f32_16x16x32_bf16 v[188:191],a[188:191],a[252:255],v[188:191]
 v_mfma_f32_16x16x32_bf16 v[188:191],a[184:187],a[236:239],v[188:191]
 v_mfma_f32_16x16x32_bf16 v[188:191],a[180:183],a[220:223],v[188:191]
 v_mfma_f32_16x16x32_bf16 v[188:191],a[176:179],a[204:207],v[188:191]
 v_mfma_f32_16x16x32_bf16 v[188:191],a[172:175],a[60:63],v[188:191]
 v_mfma_f32_16x16x32_bf16 v[188:191],a[168:171],a[44:47],v[188:191]
 v_mfma_f32_16x16x32_bf16 v[188:191],a[164:167],a[28:31],v[188:191]
 v_mfma_f32_16x16x32_bf16 v[188:191],a[160:163],a[12:15],v[188:191]
 s_waitcnt lgkmcnt(0)
 v_mfma_f32_16x16x32_bf16 v[192:195],a[128:131],a[0:3],v[192:195]
 ds_read_b64_tr_b16 a[160:161],v21 offset:32768
 v_cvt_pk_bf16_f32 v8,v160,v161
 v_mfma_f32_16x16x32_bf16 v[192:195],a[132:135],a[16:19],v[192:195]
 ds_read_b64_tr_b16 a[162:163],v21 offset:36864
 v_cvt_pk_bf16_f32 v9,v162,v163
 v_mfma_f32_16x16x32_bf16 v[192:195],a[136:139],a[32:35],v[192:195]
 v_cvt_pk_bf16_f32 v10,v164,v165
 v_cvt_pk_bf16_f32 v11,v166,v167
 v_mfma_f32_16x16x32_bf16 v[192:195],a[140:143],a[48:51],v[192:195]
 ds_read_b64_tr_b16 a[164:165],v21 offset:40960
 v_min_u32 v8,-2,v8
 v_mfma_f32_16x16x32_bf16 v[192:195],a[144:147],a[192:195],v[192:195]
 ds_read_b64_tr_b16 a[166:167],v21 offset:45056
 v_min_u32 v9,-2,v9
 v_mfma_f32_16x16x32_bf16 v[192:195],a[148:151],a[208:211],v[192:195]
 v_min_u32 v10,-2,v10
 v_min_u32 v11,-2,v11
 v_mfma_f32_16x16x32_bf16 v[192:195],a[152:155],a[224:227],v[192:195]
 s_add_u32 s46,s13,0
 ds_read_b64_tr_b16 a[168:169],v29 offset:32768
 buffer_store_dwordx4 v[8:11],v1,s[20:23],s46 offen sc1
 v_mfma_f32_16x16x32_bf16 v[192:195],a[156:159],a[240:243],v[192:195]
 ds_read_b64_tr_b16 a[170:171],v29 offset:36864
 v_mfma_f32_16x16x32_bf16 v[200:203],a[156:159],a[244:247],v[200:203]
 v_mfma_f32_16x16x32_bf16 v[200:203],a[152:155],a[228:231],v[200:203]
 ds_read_b64_tr_b16 a[172:173],v29 offset:40960
 v_mfma_f32_16x16x32_bf16 v[200:203],a[148:151],a[212:215],v[200:203]
 ds_read_b64_tr_b16 a[174:175],v29 offset:45056
 v_mfma_f32_16x16x32_bf16 v[200:203],a[144:147],a[196:199],v[200:203]
 v_mfma_f32_16x16x32_bf16 v[200:203],a[140:143],a[52:55],v[200:203]
 ds_read_b64_tr_b16 a[176:177],v21 offset:49152
 v_mfma_f32_16x16x32_bf16 v[200:203],a[136:139],a[36:39],v[200:203]
 ds_read_b64_tr_b16 a[178:179],v21 offset:53248
 v_mfma_f32_16x16x32_bf16 v[200:203],a[132:135],a[20:23],v[200:203]
 v_mfma_f32_16x16x32_bf16 v[200:203],a[128:131],a[4:7],v[200:203]
 ds_read_b64_tr_b16 a[180:181],v21 offset:57344
 v_mfma_f32_16x16x32_bf16 v[208:211],a[128:131],a[8:11],v[208:211]
 ds_read_b64_tr_b16 a[182:183],v21 offset:61440
 v_cvt_pk_bf16_f32 v12,v168,v169
 v_mfma_f32_16x16x32_bf16 v[208:211],a[132:135],a[24:27],v[208:211]
 v_cvt_pk_bf16_f32 v13,v170,v171
 v_cvt_pk_bf16_f32 v14,v172,v173
 v_mfma_f32_16x16x32_bf16 v[208:211],a[136:139],a[40:43],v[208:211]
 ds_read_b64_tr_b16 a[184:185],v29 offset:49152
 v_cvt_pk_bf16_f32 v15,v174,v175
 v_mfma_f32_16x16x32_bf16 v[208:211],a[140:143],a[56:59],v[208:211]
 ds_read_b64_tr_b16 a[186:187],v29 offset:53248
 v_min_u32 v12,-2,v12
 v_mfma_f32_16x16x32_bf16 v[208:211],a[144:147],a[200:203],v[208:211]
 v_min_u32 v13,-2,v13
 v_min_u32 v14,-2,v14
 v_mfma_f32_16x16x32_bf16 v[208:211],a[148:151],a[216:219],v[208:211]
 ds_read_b64_tr_b16 a[188:189],v29 offset:57344
 v_min_u32 v15,-2,v15
 v_mfma_f32_16x16x32_bf16 v[208:211],a[152:155],a[232:235],v[208:211]
 s_add_u32 s46,s13,32768
 ds_read_b64_tr_b16 a[190:191],v29 offset:61440
 buffer_store_dwordx4 v[12:15],v1,s[20:23],s46 offen sc1
 v_mfma_f32_16x16x32_bf16 v[208:211],a[156:159],a[248:251],v[208:211]
 v_mfma_f32_16x16x32_bf16 v[216:219],a[156:159],a[252:255],v[216:219]
 v_mfma_f32_16x16x32_bf16 v[216:219],a[152:155],a[236:239],v[216:219]
 v_mfma_f32_16x16x32_bf16 v[216:219],a[148:151],a[220:223],v[216:219]
 v_mfma_f32_16x16x32_bf16 v[216:219],a[144:147],a[204:207],v[216:219]
 v_mfma_f32_16x16x32_bf16 v[216:219],a[140:143],a[60:63],v[216:219]
 v_mfma_f32_16x16x32_bf16 v[216:219],a[136:139],a[44:47],v[216:219]
 v_mfma_f32_16x16x32_bf16 v[216:219],a[132:135],a[28:31],v[216:219]
 v_mfma_f32_16x16x32_bf16 v[216:219],a[128:131],a[12:15],v[216:219]
 s_waitcnt lgkmcnt(0)
 v_mfma_f32_16x16x32_bf16 v[196:199],a[160:163],a[0:3],v[196:199]
 ds_read_b64_tr_b16 a[128:129],v22 offset:32768
 v_cvt_pk_bf16_f32 v44,v176,v177
 v_mfma_f32_16x16x32_bf16 v[196:199],a[164:167],a[16:19],v[196:199]
 s_add_u32 s47,s15,262144
 ds_read_b64_tr_b16 a[130:131],v22 offset:36864
 v_cvt_pk_bf16_f32 v45,v178,v179
 v_mfma_f32_16x16x32_bf16 v[196:199],a[168:171],a[32:35],v[196:199]
 buffer_load_dwordx4 v[112:115],v1,s[20:23],s47 offen sc1
 v_cvt_pk_bf16_f32 v46,v180,v181
 v_mfma_f32_16x16x32_bf16 v[196:199],a[172:175],a[48:51],v[196:199]
 ds_read_b64_tr_b16 a[132:133],v22 offset:40960
 v_cvt_pk_bf16_f32 v47,v182,v183
 v_mfma_f32_16x16x32_bf16 v[196:199],a[176:179],a[192:195],v[196:199]
 ds_read_b64_tr_b16 a[134:135],v22 offset:45056
 v_min_u32 v44,-2,v44
 v_mfma_f32_16x16x32_bf16 v[196:199],a[180:183],a[208:211],v[196:199]
 v_min_u32 v45,-2,v45
 v_min_u32 v46,-2,v46
 v_mfma_f32_16x16x32_bf16 v[196:199],a[184:187],a[224:227],v[196:199]
 ds_read_b64_tr_b16 a[136:137],v30 offset:32768
 v_min_u32 v47,-2,v47
 v_mfma_f32_16x16x32_bf16 v[196:199],a[188:191],a[240:243],v[196:199]
 s_add_u32 s46,s13,65536
 ds_read_b64_tr_b16 a[138:139],v30 offset:36864
 buffer_store_dwordx4 v[44:47],v1,s[20:23],s46 offen sc1
 v_mfma_f32_16x16x32_bf16 v[204:207],a[188:191],a[244:247],v[204:207]
 s_add_u32 s47,s15,294912
 v_mfma_f32_16x16x32_bf16 v[204:207],a[184:187],a[228:231],v[204:207]
 ds_read_b64_tr_b16 a[140:141],v30 offset:40960
 buffer_load_dwordx4 v[116:119],v1,s[20:23],s47 offen sc1
 v_mfma_f32_16x16x32_bf16 v[204:207],a[180:183],a[212:215],v[204:207]
 ds_read_b64_tr_b16 a[142:143],v30 offset:45056
 v_mfma_f32_16x16x32_bf16 v[204:207],a[176:179],a[196:199],v[204:207]
 v_mfma_f32_16x16x32_bf16 v[204:207],a[172:175],a[52:55],v[204:207]
 ds_read_b64_tr_b16 a[144:145],v22 offset:49152
 v_mfma_f32_16x16x32_bf16 v[204:207],a[168:171],a[36:39],v[204:207]
 ds_read_b64_tr_b16 a[146:147],v22 offset:53248
 v_mfma_f32_16x16x32_bf16 v[204:207],a[164:167],a[20:23],v[204:207]
 v_mfma_f32_16x16x32_bf16 v[204:207],a[160:163],a[4:7],v[204:207]
 ds_read_b64_tr_b16 a[148:149],v22 offset:57344
 v_mfma_f32_16x16x32_bf16 v[212:215],a[160:163],a[8:11],v[212:215]
 s_add_u32 s47,s15,327680
 ds_read_b64_tr_b16 a[150:151],v22 offset:61440
 v_cvt_pk_bf16_f32 v48,v184,v185
 v_mfma_f32_16x16x32_bf16 v[212:215],a[164:167],a[24:27],v[212:215]
 buffer_load_dwordx4 v[120:123],v1,s[20:23],s47 offen sc1
 v_cvt_pk_bf16_f32 v49,v186,v187
 v_mfma_f32_16x16x32_bf16 v[212:215],a[168:171],a[40:43],v[212:215]
 ds_read_b64_tr_b16 a[152:153],v30 offset:49152
 v_cvt_pk_bf16_f32 v50,v188,v189
 v_mfma_f32_16x16x32_bf16 v[212:215],a[172:175],a[56:59],v[212:215]
 ds_read_b64_tr_b16 a[154:155],v30 offset:53248
 v_cvt_pk_bf16_f32 v51,v190,v191
 v_mfma_f32_16x16x32_bf16 v[212:215],a[176:179],a[200:203],v[212:215]
 v_min_u32 v48,-2,v48
 v_min_u32 v49,-2,v49
 v_mfma_f32_16x16x32_bf16 v[212:215],a[180:183],a[216:219],v[212:215]
 ds_read_b64_tr_b16 a[156:157],v30 offset:57344
 v_min_u32 v50,-2,v50
 v_mfma_f32_16x16x32_bf16 v[212:215],a[184:187],a[232:235],v[212:215]
 ds_read_b64_tr_b16 a[158:159],v30 offset:61440
 v_min_u32 v51,-2,v51
 v_mfma_f32_16x16x32_bf16 v[212:215],a[188:191],a[248:251],v[212:215]
 s_add_u32 s47,s15,360448
 s_add_u32 s46,s13,98304
 v_mfma_f32_16x16x32_bf16 v[220:223],a[188:191],a[252:255],v[220:223]
 buffer_load_dwordx4 v[124:127],v1,s[20:23],s47 offen sc1
 v_mfma_f32_16x16x32_bf16 v[220:223],a[184:187],a[236:239],v[220:223]
 buffer_store_dwordx4 v[48:51],v1,s[20:23],s46 offen sc1
 v_mfma_f32_16x16x32_bf16 v[220:223],a[180:183],a[220:223],v[220:223]
 v_mfma_f32_16x16x32_bf16 v[220:223],a[176:179],a[204:207],v[220:223]
 v_mfma_f32_16x16x32_bf16 v[220:223],a[172:175],a[60:63],v[220:223]
 v_mfma_f32_16x16x32_bf16 v[220:223],a[168:171],a[44:47],v[220:223]
 v_mfma_f32_16x16x32_bf16 v[220:223],a[164:167],a[28:31],v[220:223]
 v_mfma_f32_16x16x32_bf16 v[220:223],a[160:163],a[12:15],v[220:223]
 s_waitcnt lgkmcnt(0)
 v_mfma_f32_16x16x32_bf16 v[224:227],a[128:131],a[0:3],v[224:227]
 ds_read_b64_tr_b16 a[160:161],v23 offset:32768
 v_cvt_pk_bf16_f32 v8,v192,v193
 v_mfma_f32_16x16x32_bf16 v[224:227],a[132:135],a[16:19],v[224:227]
 s_add_u32 s47,s15,0
 ds_read_b64_tr_b16 a[162:163],v23 offset:36864
 v_cvt_pk_bf16_f32 v9,v194,v195
 v_mfma_f32_16x16x32_bf16 v[224:227],a[136:139],a[32:35],v[224:227]
 buffer_load_dwordx4 v[80:83],v1,s[20:23],s47 offen sc1
 v_cvt_pk_bf16_f32 v10,v196,v197
 v_mfma_f32_16x16x32_bf16 v[224:227],a[140:143],a[48:51],v[224:227]
 ds_read_b64_tr_b16 a[164:165],v23 offset:40960
 v_cvt_pk_bf16_f32 v11,v198,v199
 v_mfma_f32_16x16x32_bf16 v[224:227],a[144:147],a[192:195],v[224:227]
 ds_read_b64_tr_b16 a[166:167],v23 offset:45056
 v_min_u32 v8,-2,v8
 v_mfma_f32_16x16x32_bf16 v[224:227],a[148:151],a[208:211],v[224:227]
 v_min_u32 v9,-2,v9
 v_min_u32 v10,-2,v10
 v_mfma_f32_16x16x32_bf16 v[224:227],a[152:155],a[224:227],v[224:227]
 ds_read_b64_tr_b16 a[168:169],v31 offset:32768
 v_min_u32 v11,-2,v11
 v_mfma_f32_16x16x32_bf16 v[224:227],a[156:159],a[240:243],v[224:227]
 s_add_u32 s46,s14,0
 ds_read_b64_tr_b16 a[170:171],v31 offset:36864
 buffer_store_dwordx4 v[8:11],v1,s[20:23],s46 offen sc1
 v_mfma_f32_16x16x32_bf16 v[232:235],a[156:159],a[244:247],v[232:235]
 s_add_u32 s47,s15,32768
 v_mfma_f32_16x16x32_bf16 v[232:235],a[152:155],a[228:231],v[232:235]
 ds_read_b64_tr_b16 a[172:173],v31 offset:40960
 buffer_load_dwordx4 v[84:87],v1,s[20:23],s47 offen sc1
 v_mfma_f32_16x16x32_bf16 v[232:235],a[148:151],a[212:215],v[232:235]
 ds_read_b64_tr_b16 a[174:175],v31 offset:45056
 v_mfma_f32_16x16x32_bf16 v[232:235],a[144:147],a[196:199],v[232:235]
 v_mfma_f32_16x16x32_bf16 v[232:235],a[140:143],a[52:55],v[232:235]
 ds_read_b64_tr_b16 a[176:177],v23 offset:49152
 v_mfma_f32_16x16x32_bf16 v[232:235],a[136:139],a[36:39],v[232:235]
 ds_read_b64_tr_b16 a[178:179],v23 offset:53248
 v_mfma_f32_16x16x32_bf16 v[232:235],a[132:135],a[20:23],v[232:235]
 v_mfma_f32_16x16x32_bf16 v[232:235],a[128:131],a[4:7],v[232:235]
 ds_read_b64_tr_b16 a[180:181],v23 offset:57344
 v_mfma_f32_16x16x32_bf16 v[240:243],a[128:131],a[8:11],v[240:243]
 s_add_u32 s47,s15,65536
 ds_read_b64_tr_b16 a[182:183],v23 offset:61440
 v_cvt_pk_bf16_f32 v12,v200,v201
 v_mfma_f32_16x16x32_bf16 v[240:243],a[132:135],a[24:27],v[240:243]
 buffer_load_dwordx4 v[88:91],v1,s[20:23],s47 offen sc1
 v_cvt_pk_bf16_f32 v13,v202,v203
 v_mfma_f32_16x16x32_bf16 v[240:243],a[136:139],a[40:43],v[240:243]
 ds_read_b64_tr_b16 a[184:185],v31 offset:49152
 v_cvt_pk_bf16_f32 v14,v204,v205
 v_mfma_f32_16x16x32_bf16 v[240:243],a[140:143],a[56:59],v[240:243]
 ds_read_b64_tr_b16 a[186:187],v31 offset:53248
 v_cvt_pk_bf16_f32 v15,v206,v207
 v_mfma_f32_16x16x32_bf16 v[240:243],a[144:147],a[200:203],v[240:243]
 v_min_u32 v12,-2,v12
 v_min_u32 v13,-2,v13
 v_mfma_f32_16x16x32_bf16 v[240:243],a[148:151],a[216:219],v[240:243]
 ds_read_b64_tr_b16 a[188:189],v31 offset:57344
 v_min_u32 v14,-2,v14
 v_mfma_f32_16x16x32_bf16 v[240:243],a[152:155],a[232:235],v[240:243]
 ds_read_b64_tr_b16 a[190:191],v31 offset:61440
 v_min_u32 v15,-2,v15
 v_mfma_f32_16x16x32_bf16 v[240:243],a[156:159],a[248:251],v[240:243]
 s_add_u32 s47,s15,98304
 s_add_u32 s46,s14,32768
 v_mfma_f32_16x16x32_bf16 v[248:251],a[156:159],a[252:255],v[248:251]
 buffer_load_dwordx4 v[92:95],v1,s[20:23],s47 offen sc1
 v_mfma_f32_16x16x32_bf16 v[248:251],a[152:155],a[236:239],v[248:251]
 buffer_store_dwordx4 v[12:15],v1,s[20:23],s46 offen sc1
 v_mfma_f32_16x16x32_bf16 v[248:251],a[148:151],a[220:223],v[248:251]
 v_mfma_f32_16x16x32_bf16 v[248:251],a[144:147],a[204:207],v[248:251]
 v_mfma_f32_16x16x32_bf16 v[248:251],a[140:143],a[60:63],v[248:251]
 v_mfma_f32_16x16x32_bf16 v[248:251],a[136:139],a[44:47],v[248:251]
 v_mfma_f32_16x16x32_bf16 v[248:251],a[132:135],a[28:31],v[248:251]
 v_mfma_f32_16x16x32_bf16 v[248:251],a[128:131],a[12:15],v[248:251]
 s_waitcnt lgkmcnt(0)
 v_mfma_f32_16x16x32_bf16 v[228:231],a[160:163],a[0:3],v[228:231]
 v_cvt_pk_bf16_f32 v44,v208,v209
 v_cvt_pk_bf16_f32 v45,v210,v211
 v_mfma_f32_16x16x32_bf16 v[228:231],a[164:167],a[16:19],v[228:231]
 s_add_u32 s47,s15,131072
 v_cvt_pk_bf16_f32 v46,v212,v213
 v_cvt_pk_bf16_f32 v47,v214,v215
 v_mfma_f32_16x16x32_bf16 v[228:231],a[168:171],a[32:35],v[228:231]
 buffer_load_dwordx4 v[96:99],v1,s[20:23],s47 offen sc1
 v_min_u32 v44,-2,v44
 v_mfma_f32_16x16x32_bf16 v[228:231],a[172:175],a[48:51],v[228:231]
 v_min_u32 v45,-2,v45
 v_min_u32 v46,-2,v46
 v_mfma_f32_16x16x32_bf16 v[228:231],a[176:179],a[192:195],v[228:231]
 v_min_u32 v47,-2,v47
 s_add_u32 s46,s14,65536
 v_mfma_f32_16x16x32_bf16 v[228:231],a[180:183],a[208:211],v[228:231]
 buffer_store_dwordx4 v[44:47],v1,s[20:23],s46 offen sc1
 v_mfma_f32_16x16x32_bf16 v[228:231],a[184:187],a[224:227],v[228:231]
 v_mfma_f32_16x16x32_bf16 v[228:231],a[188:191],a[240:243],v[228:231]
 v_mfma_f32_16x16x32_bf16 v[236:239],a[188:191],a[244:247],v[236:239]
 s_add_u32 s47,s15,163840
 v_mfma_f32_16x16x32_bf16 v[236:239],a[184:187],a[228:231],v[236:239]
 buffer_load_dwordx4 v[100:103],v1,s[20:23],s47 offen sc1
 v_mfma_f32_16x16x32_bf16 v[236:239],a[180:183],a[212:215],v[236:239]
 v_mfma_f32_16x16x32_bf16 v[236:239],a[176:179],a[196:199],v[236:239]
 v_mfma_f32_16x16x32_bf16 v[236:239],a[172:175],a[52:55],v[236:239]
 v_mfma_f32_16x16x32_bf16 v[236:239],a[168:171],a[36:39],v[236:239]
 v_mfma_f32_16x16x32_bf16 v[236:239],a[164:167],a[20:23],v[236:239]
 v_mfma_f32_16x16x32_bf16 v[236:239],a[160:163],a[4:7],v[236:239]
 v_mfma_f32_16x16x32_bf16 v[244:247],a[160:163],a[8:11],v[244:247]
 s_add_u32 s47,s15,196608
 v_cvt_pk_bf16_f32 v48,v216,v217
 v_cvt_pk_bf16_f32 v49,v218,v219
 v_mfma_f32_16x16x32_bf16 v[244:247],a[164:167],a[24:27],v[244:247]
 buffer_load_dwordx4 v[104:107],v1,s[20:23],s47 offen sc1
 v_cvt_pk_bf16_f32 v50,v220,v221
 v_mfma_f32_16x16x32_bf16 v[244:247],a[168:171],a[40:43],v[244:247]
 v_cvt_pk_bf16_f32 v51,v222,v223
 v_min_u32 v48,-2,v48
 v_mfma_f32_16x16x32_bf16 v[244:247],a[172:175],a[56:59],v[244:247]
 v_min_u32 v49,-2,v49
 v_min_u32 v50,-2,v50
 v_mfma_f32_16x16x32_bf16 v[244:247],a[176:179],a[200:203],v[244:247]
 v_min_u32 v51,-2,v51
 s_add_u32 s46,s14,98304
 v_mfma_f32_16x16x32_bf16 v[244:247],a[180:183],a[216:219],v[244:247]
 buffer_store_dwordx4 v[48:51],v1,s[20:23],s46 offen sc1
 v_mfma_f32_16x16x32_bf16 v[244:247],a[184:187],a[232:235],v[244:247]
 v_mfma_f32_16x16x32_bf16 v[244:247],a[188:191],a[248:251],v[244:247]
 s_add_u32 s47,s15,229376
 v_mfma_f32_16x16x32_bf16 v[252:255],a[188:191],a[252:255],v[252:255]
 buffer_load_dwordx4 v[108:111],v1,s[20:23],s47 offen sc1
 v_mfma_f32_16x16x32_bf16 v[252:255],a[184:187],a[236:239],v[252:255]
 v_mfma_f32_16x16x32_bf16 v[252:255],a[180:183],a[220:223],v[252:255]
 v_mfma_f32_16x16x32_bf16 v[252:255],a[176:179],a[204:207],v[252:255]
 v_mfma_f32_16x16x32_bf16 v[252:255],a[172:175],a[60:63],v[252:255]
 v_mfma_f32_16x16x32_bf16 v[252:255],a[168:171],a[44:47],v[252:255]
 v_mfma_f32_16x16x32_bf16 v[252:255],a[164:167],a[28:31],v[252:255]
 v_mfma_f32_16x16x32_bf16 v[252:255],a[160:163],a[12:15],v[252:255]
 s_mov_b32 s48,0xbfb8aa3b
 s_mov_b32 s101,524288
L_o_check:
 s_waitcnt vmcnt(0)
 v_max_u32 v4,v80,v81
 v_max3_u32 v4,v82,v83,v4
 v_max3_u32 v4,v84,v85,v4
 v_max3_u32 v4,v86,v87,v4
 v_max3_u32 v4,v88,v89,v4
 v_max3_u32 v4,v90,v91,v4
 v_max3_u32 v4,v92,v93,v4
 v_max3_u32 v4,v94,v95,v4
 v_max_u32 v5,v96,v97
 v_max3_u32 v5,v98,v99,v5
 v_max3_u32 v5,v100,v101,v5
 v_max3_u32 v5,v102,v103,v5
 v_max3_u32 v5,v104,v105,v5
 v_max3_u32 v5,v106,v107,v5
 v_max3_u32 v5,v108,v109,v5
 v_max3_u32 v5,v110,v111,v5
 v_max_u32 v6,v112,v113
 v_max3_u32 v6,v114,v115,v6
 v_max3_u32 v6,v116,v117,v6
 v_max3_u32 v6,v118,v119,v6
 v_max3_u32 v6,v120,v121,v6
 v_max3_u32 v6,v122,v123,v6
 v_max3_u32 v6,v124,v125,v6
 v_max3_u32 v6,v126,v127,v6
 v_max3_u32 v7,v4,v5,v6
 v_cmp_eq_u32 vcc,-1,v7
 s_nop 1
 s_cmp_lg_u64 vcc,0
 s_cbranch_scc1 L_o_late
L_o_ok:
 v_mfma_f32_16x16x32_bf16 v[128:131],v[36:39],v[80:83],0
 v_mfma_f32_16x16x32_bf16 v[128:131],v[36:39],v[96:99],v[128:131]
 v_mfma_f32_16x16x32_bf16 v[132:135],v[40:43],v[80:83],0
 v_mfma_f32_16x16x32_bf16 v[132:135],v[40:43],v[96:99],v[132:135]
 v_mfma_f32_16x16x32_bf16 v[136:139],v[36:39],v[84:87],0
 v_mfma_f32_16x16x32_bf16 v[136:139],v[36:39],v[100:103],v[136:139]
 v_mfma_f32_16x16x32_bf16 v[140:143],v[40:43],v[84:87],0
 v_mfma_f32_16x16x32_bf16 v[140:143],v[40:43],v[100:103],v[140:143]
 v_mfma_f32_16x16x32_bf16 v[224:227],v[36:39],v[112:115],v[224:227]
 v_mfma_f32_16x16x32_bf16 v[228:231],v[40:43],v[112:115],v[228:231]
 v_mfma_f32_16x16x32_bf16 v[160:163],v[36:39],v[64:67],0
 v_mfma_f32_16x16x32_bf16 v[164:167],v[40:43],v[64:67],0
 v_exp_f32 v192,v128
 v_exp_f32 v193,v129
 v_exp_f32 v194,v130
 v_mfma_f32_16x16x32_bf16 v[144:147],v[36:39],v[88:91],0
 v_exp_f32 v195,v131
 v_exp_f32 v196,v132
 v_exp_f32 v197,v133
 v_mfma_f32_16x16x32_bf16 v[144:147],v[36:39],v[104:107],v[144:147]
 v_exp_f32 v198,v134
 v_exp_f32 v199,v135
 v_fma_f32 v192,v192,s48,s48
 v_fma_f32 v193,v193,s48,s48
 v_mfma_f32_16x16x32_bf16 v[148:151],v[40:43],v[88:91],0
 v_fma_f32 v194,v194,s48,s48
 v_fma_f32 v195,v195,s48,s48
 v_fma_f32 v196,v196,s48,s48
 v_fma_f32 v197,v197,s48,s48
 v_fma_f32 v198,v198,s48,s48
 v_fma_f32 v199,v199,s48,s48
 v_mfma_f32_16x16x32_bf16 v[148:151],v[40:43],v[104:107],v[148:151]
 v_rcp_f32 v192,v192
 v_rcp_f32 v193,v193
 v_rcp_f32 v194,v194
 v_mfma_f32_16x16x32_bf16 v[232:235],v[36:39],v[116:119],v[232:235]
 v_rcp_f32 v195,v195
 v_rcp_f32 v196,v196
 v_rcp_f32 v197,v197
 v_mfma_f32_16x16x32_bf16 v[236:239],v[40:43],v[116:119],v[236:239]
 v_rcp_f32 v198,v198
 v_rcp_f32 v199,v199
 v_mul_f32 v128,v192,v128
 v_mul_f32 v129,v193,v129
 v_mfma_f32_16x16x32_bf16 v[168:171],v[36:39],v[68:71],0
 v_mul_f32 v130,v194,v130
 v_mul_f32 v131,v195,v131
 v_mul_f32 v132,v196,v132
 v_mul_f32 v133,v197,v133
 v_mul_f32 v134,v198,v134
 v_mul_f32 v135,v199,v135
 v_mfma_f32_16x16x32_bf16 v[172:175],v[40:43],v[68:71],0
 v_fma_f32 v128,v224,v128,v160
 v_fma_f32 v129,v225,v129,v161
 v_fma_f32 v130,v226,v130,v162
 v_fma_f32 v131,v227,v131,v163
 v_fma_f32 v132,v228,v132,v164
 v_fma_f32 v133,v229,v133,v165
 v_mfma_f32_16x16x32_bf16 v[152:155],v[36:39],v[92:95],0
 v_fma_f32 v134,v230,v134,v166
 v_fma_f32 v135,v231,v135,v167
 v_cvt_pk_bf16_f32 v200,v128,v129
 v_cvt_pk_bf16_f32 v201,v130,v131
 v_cvt_pk_bf16_f32 v202,v132,v133
 v_cvt_pk_bf16_f32 v203,v134,v135
 v_mfma_f32_16x16x32_bf16 v[152:155],v[36:39],v[108:111],v[152:155]
 s_mov_b32 s46,0
 buffer_store_dwordx4 v[200:203],v56,s[16:19],s46 offen sc1
 v_exp_f32 v192,v136
 v_exp_f32 v193,v137
 v_mfma_f32_16x16x32_bf16 v[156:159],v[40:43],v[92:95],0
 v_exp_f32 v194,v138
 v_exp_f32 v195,v139
 v_exp_f32 v196,v140
 v_mfma_f32_16x16x32_bf16 v[156:159],v[40:43],v[108:111],v[156:159]
 v_exp_f32 v197,v141
 v_exp_f32 v198,v142
 v_exp_f32 v199,v143
 v_mfma_f32_16x16x32_bf16 v[240:243],v[36:39],v[120:123],v[240:243]
 v_fma_f32 v192,v192,s48,s48
 v_fma_f32 v193,v193,s48,s48
 v_fma_f32 v194,v194,s48,s48
 v_fma_f32 v195,v195,s48,s48
 v_fma_f32 v196,v196,s48,s48
 v_fma_f32 v197,v197,s48,s48
 v_mfma_f32_16x16x32_bf16 v[244:247],v[40:43],v[120:123],v[244:247]
 v_fma_f32 v198,v198,s48,s48
 v_fma_f32 v199,v199,s48,s48
 v_rcp_f32 v192,v192
 v_rcp_f32 v193,v193
 v_mfma_f32_16x16x32_bf16 v[176:179],v[36:39],v[72:75],0
 v_rcp_f32 v194,v194
 v_rcp_f32 v195,v195
 v_rcp_f32 v196,v196
 v_mfma_f32_16x16x32_bf16 v[180:183],v[40:43],v[72:75],0
L_stub_o_5:
 s_cbranch_execz L_warm_o_ret
 v_rcp_f32 v197,v197
 v_rcp_f32 v198,v198
 v_rcp_f32 v199,v199
 v_mfma_f32_16x16x32_bf16 v[248:251],v[36:39],v[124:127],v[248:251]
 v_mul_f32 v136,v192,v136
 v_mul_f32 v137,v193,v137
 v_mul_f32 v138,v194,v138
 v_mul_f32 v139,v195,v139
 v_mul_f32 v140,v196,v140
 v_mul_f32 v141,v197,v141
 v_mfma_f32_16x16x32_bf16 v[252:255],v[40:43],v[124:127],v[252:255]
 v_mul_f32 v142,v198,v142
 v_mul_f32 v143,v199,v143
 v_fma_f32 v136,v232,v136,v168
 v_fma_f32 v137,v233,v137,v169
 v_fma_f32 v138,v234,v138,v170
 v_fma_f32 v139,v235,v139,v171
 v_mfma_f32_16x16x32_bf16 v[184:187],v[36:39],v[76:79],0
 v_fma_f32 v140,v236,v140,v172
 v_fma_f32 v141,v237,v141,v173
 v_fma_f32 v142,v238,v142,v174
 v_fma_f32 v143,v239,v143,v175
 v_cvt_pk_bf16_f32 v204,v136,v137
 v_cvt_pk_bf16_f32 v205,v138,v139
 v_mfma_f32_16x16x32_bf16 v[188:191],v[40:43],v[76:79],0
 v_cvt_pk_bf16_f32 v206,v140,v141
 v_cvt_pk_bf16_f32 v207,v142,v143
 s_mov_b32 s46,32768
 buffer_store_dwordx4 v[204:207],v56,s[16:19],s46 offen sc1
 v_exp_f32 v192,v144
 v_exp_f32 v193,v145
 v_exp_f32 v194,v146
 v_exp_f32 v195,v147
 v_exp_f32 v196,v148
 v_exp_f32 v197,v149
 v_exp_f32 v198,v150
 v_exp_f32 v199,v151
 v_fma_f32 v192,v192,s48,s48
 v_fma_f32 v193,v193,s48,s48
 v_fma_f32 v194,v194,s48,s48
 v_fma_f32 v195,v195,s48,s48
 v_fma_f32 v196,v196,s48,s48
 v_fma_f32 v197,v197,s48,s48
 v_fma_f32 v198,v198,s48,s48
 v_fma_f32 v199,v199,s48,s48
 v_rcp_f32 v192,v192
 v_rcp_f32 v193,v193
 v_rcp_f32 v194,v194
 v_rcp_f32 v195,v195
 v_rcp_f32 v196,v196
 v_rcp_f32 v197,v197
 v_rcp_f32 v198,v198
 v_rcp_f32 v199,v199
 v_mul_f32 v144,v192,v144
 v_mul_f32 v145,v193,v145
 v_mul_f32 v146,v194,v146
 v_mul_f32 v147,v195,v147
 v_mul_f32 v148,v196,v148
 v_mul_f32 v149,v197,v149
 v_mul_f32 v150,v198,v150
 v_mul_f32 v151,v199,v151
 v_fma_f32 v144,v240,v144,v176
 v_fma_f32 v145,v241,v145,v177
 v_fma_f32 v146,v242,v146,v178
 v_fma_f32 v147,v243,v147,v179
 v_fma_f32 v148,v244,v148,v180
 v_fma_f32 v149,v245,v149,v181
 v_fma_f32 v150,v246,v150,v182
 v_fma_f32 v151,v247,v151,v183
 v_cvt_pk_bf16_f32 v208,v144,v145
 v_cvt_pk_bf16_f32 v209,v146,v147
 v_cvt_pk_bf16_f32 v210,v148,v149
 v_cvt_pk_bf16_f32 v211,v150,v151
 s_mov_b32 s46,65536
 buffer_store_dwordx4 v[208:211],v56,s[16:19],s46 offen sc1
 v_exp_f32 v192,v152
 v_exp_f32 v193,v153
 v_exp_f32 v194,v154
 v_exp_f32 v195,v155
 v_exp_f32 v196,v156
 v_exp_f32 v197,v157
 v_exp_f32 v198,v158
 v_exp_f32 v199,v159
 v_fma_f32 v192,v192,s48,s48
 v_fma_f32 v193,v193,s48,s48
 v_fma_f32 v194,v194,s48,s48
 v_fma_f32 v195,v195,s48,s48
 v_fma_f32 v196,v196,s48,s48
 v_fma_f32 v197,v197,s48,s48
 v_fma_f32 v198,v198,s48,s48
 v_fma_f32 v199,v199,s48,s48
 v_rcp_f32 v192,v192
 v_rcp_f32 v193,v193
 v_rcp_f32 v194,v194
 v_rcp_f32 v195,v195
 v_rcp_f32 v196,v196
 v_rcp_f32 v197,v197
 v_rcp_f32 v198,v198
 v_rcp_f32 v199,v199
 v_mul_f32 v152,v192,v152
 v_mul_f32 v153,v193,v153
 v_mul_f32 v154,v194,v154
 v_mul_f32 v155,v195,v155
 v_mul_f32 v156,v196,v156
 v_mul_f32 v157,v197,v157
 v_mul_f32 v158,v198,v158
 v_mul_f32 v159,v199,v159
 v_fma_f32 v152,v248,v152,v184
 v_fma_f32 v153,v249,v153,v185
 v_fma_f32 v154,v250,v154,v186
 v_fma_f32 v155,v251,v155,v187
 v_fma_f32 v156,v252,v156,v188
 v_fma_f32 v157,v253,v157,v189
 v_fma_f32 v158,v254,v158,v190
 v_fma_f32 v159,v255,v159,v191
 v_cvt_pk_bf16_f32 v212,v152,v153
 v_cvt_pk_bf16_f32 v213,v154,v155
 v_cvt_pk_bf16_f32 v214,v156,v157
 v_cvt_pk_bf16_f32 v215,v158,v159
 s_mov_b32 s46,98304
 buffer_store_dwordx4 v[212:215],v56,s[16:19],s46 offen sc1
 s_waitcnt vmcnt(0) lgkmcnt(0)
 s_endpgm
L_o_late:
 s_sub_u32 s101,s101,1
 s_cbranch_scc1 L_o_ok
 v_cmp_eq_u32 vcc,-1,v4
 s_nop 1
 s_cmp_lg_u64 vcc,0
 s_cbranch_scc0 L_o_has0
 s_add_u32 s47,s15,0
 buffer_load_dwordx4 v[80:83],v1,s[20:23],s47 offen sc1
 s_add_u32 s47,s15,32768
 buffer_load_dwordx4 v[84:87],v1,s[20:23],s47 offen sc1
 s_add_u32 s47,s15,65536
 buffer_load_dwordx4 v[88:91],v1,s[20:23],s47 offen sc1
 s_add_u32 s47,s15,98304
 buffer_load_dwordx4 v[92:95],v1,s[20:23],s47 offen sc1
L_o_has0:
 v_cmp_eq_u32 vcc,-1,v5
 s_nop 1
 s_cmp_lg_u64 vcc,0
 s_cbranch_scc0 L_o_has1
 s_add_u32 s47,s15,131072
 buffer_load_dwordx4 v[96:99],v1,s[20:23],s47 offen sc1
 s_add_u32 s47,s15,163840
 buffer_load_dwordx4 v[100:103],v1,s[20:23],s47 offen sc1
 s_add_u32 s47,s15,196608
 buffer_load_dwordx4 v[104:107],v1,s[20:23],s47 offen sc1
 s_add_u32 s47,s15,229376
 buffer_load_dwordx4 v[108:111],v1,s[20:23],s47 offen sc1
L_o_has1:
 v_cmp_eq_u32 vcc,-1,v6
 s_nop 1
 s_cmp_lg_u64 vcc,0
 s_cbranch_scc0 L_o_has2
 s_add_u32 s47,s15,262144
 buffer_load_dwordx4 v[112:115],v1,s[20:23],s47 offen sc1
 s_add_u32 s47,s15,294912
 buffer_load_dwordx4 v[116:119],v1,s[20:23],s47 offen sc1
 s_add_u32 s47,s15,327680
 buffer_load_dwordx4 v[120:123],v1,s[20:23],s47 offen sc1
 s_add_u32 s47,s15,360448
 buffer_load_dwordx4 v[124:127],v1,s[20:23],s47 offen sc1
L_o_has2:
 s_branch L_o_check
.p2align 12
L_hook_mlp2:
L_stub_m_0:
 s_cbranch_execz L_stub_m_4
 s_waitcnt vmcnt(24)
 v_cmp_eq_u32 vcc,0,v53
 s_cmp_eq_u32 s44,3
 s_cselect_b32 s48,0x7ff,-1
 s_cmp_eq_u32 s44,2
 s_cmov_b32 s48,0x7fff
 s_or_b32 s49,vcc_lo,vcc_hi
 s_and_b32 s49,s48,s49
 s_cbranch_scc0 L_hook_mlp2_ret
 s_branch L_poll_more
L_mlp2:
 s_waitcnt vmcnt(4)
 v_cmp_eq_u32 vcc,0,v53
 s_nop 1
 s_cmp_lg_u64 vcc,0
 s_cselect_b32 s62,0,454656
 v_pk_fma_f32 v[96:97],v[160:161],v[160:161],s[48:49]
 v_pk_fma_f32 v[98:99],v[162:163],v[162:163],s[48:49]
 v_pk_fma_f32 v[100:101],v[164:165],v[164:165],s[48:49]
 v_pk_fma_f32 v[102:103],v[166:167],v[166:167],s[48:49]
 s_mov_b32 s40,0
 buffer_load_dwordx4 a[0:3],v1,s[60:63],s40 offen offset:0 sc1
 v_pk_mul_f32 v[96:97],v[96:97],v[160:161]
 v_pk_mul_f32 v[98:99],v[98:99],v[162:163]
 v_pk_mul_f32 v[100:101],v[100:101],v[164:165]
 v_pk_mul_f32 v[102:103],v[102:103],v[166:167]
 v_exp_f32 v96,v96
 v_exp_f32 v97,v97
 v_exp_f32 v98,v98
 v_exp_f32 v99,v99
 v_exp_f32 v100,v100
 v_exp_f32 v101,v101
 v_exp_f32 v102,v102
 v_exp_f32 v103,v103
 buffer_load_dwordx4 a[4:7],v1,s[60:63],s40 offen offset:1024 sc1
 v_pk_fma_f32 v[96:97],v[96:97],s[50:51],s[50:51]
 v_pk_fma_f32 v[98:99],v[98:99],s[50:51],s[50:51]
 v_pk_fma_f32 v[100:101],v[100:101],s[50:51],s[50:51]
 v_pk_fma_f32 v[102:103],v[102:103],s[50:51],s[50:51]
 buffer_load_dwordx4 a[16:19],v1,s[60:63],s40 offen offset:2048 sc1
 v_rcp_f32 v96,v96
 v_rcp_f32 v97,v97
 v_rcp_f32 v98,v98
 v_rcp_f32 v99,v99
 v_rcp_f32 v100,v100
 v_rcp_f32 v101,v101
 v_rcp_f32 v102,v102
 v_rcp_f32 v103,v103
 buffer_load_dwordx4 a[20:23],v1,s[60:63],s40 offen offset:3072 sc1
 v_pk_mul_f32 v[96:97],v[96:97],v[160:161]
 v_pk_mul_f32 v[98:99],v[98:99],v[162:163]
 v_pk_mul_f32 v[100:101],v[100:101],v[164:165]
 v_pk_mul_f32 v[102:103],v[102:103],v[166:167]
 v_cvt_pk_bf16_f32 v104,v96,v97
 v_cvt_pk_bf16_f32 v105,v98,v99
 v_cvt_pk_bf16_f32 v106,v100,v101
 v_cvt_pk_bf16_f32 v107,v102,v103
 buffer_store_dwordx4 v[104:107],v1,s[64:67],0 offen offset:2048 sc1
 v_pk_fma_f32 v[108:109],v[168:169],v[168:169],s[48:49]
 v_pk_fma_f32 v[110:111],v[170:171],v[170:171],s[48:49]
 v_pk_fma_f32 v[112:113],v[172:173],v[172:173],s[48:49]
 v_pk_fma_f32 v[114:115],v[174:175],v[174:175],s[48:49]
 s_mov_b32 s59,229376
 buffer_load_dwordx4 a[8:11],v1,s[60:63],s59 offen offset:0 sc1
 v_pk_mul_f32 v[108:109],v[108:109],v[168:169]
 v_pk_mul_f32 v[110:111],v[110:111],v[170:171]
 v_pk_mul_f32 v[112:113],v[112:113],v[172:173]
 v_pk_mul_f32 v[114:115],v[114:115],v[174:175]
 v_exp_f32 v108,v108
 v_exp_f32 v109,v109
 v_exp_f32 v110,v110
 v_exp_f32 v111,v111
 v_exp_f32 v112,v112
 v_exp_f32 v113,v113
 v_exp_f32 v114,v114
 v_exp_f32 v115,v115
 buffer_load_dwordx4 a[12:15],v1,s[60:63],s59 offen offset:1024 sc1
 v_pk_fma_f32 v[108:109],v[108:109],s[50:51],s[50:51]
 v_pk_fma_f32 v[110:111],v[110:111],s[50:51],s[50:51]
 v_pk_fma_f32 v[112:113],v[112:113],s[50:51],s[50:51]
 v_pk_fma_f32 v[114:115],v[114:115],s[50:51],s[50:51]
 buffer_load_dwordx4 a[24:27],v1,s[60:63],s59 offen offset:2048 sc1
 v_rcp_f32 v108,v108
 v_rcp_f32 v109,v109
 v_rcp_f32 v110,v110
 v_rcp_f32 v111,v111
 v_rcp_f32 v112,v112
 v_rcp_f32 v113,v113
 v_rcp_f32 v114,v114
 v_rcp_f32 v115,v115
 buffer_load_dwordx4 a[28:31],v1,s[60:63],s59 offen offset:3072 sc1
 v_pk_mul_f32 v[108:109],v[108:109],v[168:169]
 v_pk_mul_f32 v[110:111],v[110:111],v[170:171]
 v_pk_mul_f32 v[112:113],v[112:113],v[172:173]
 v_pk_mul_f32 v[114:115],v[114:115],v[174:175]
 v_cvt_pk_bf16_f32 v116,v108,v109
 v_cvt_pk_bf16_f32 v117,v110,v111
 v_cvt_pk_bf16_f32 v118,v112,v113
 v_cvt_pk_bf16_f32 v119,v114,v115
 buffer_store_dwordx4 v[116:119],v1,s[64:67],0 offen offset:3072 sc1
 buffer_load_dword v53,v63,s[68:71],s76 offen sc1
 v_pk_fma_f32 v[96:97],v[176:177],v[176:177],s[48:49]
 v_pk_fma_f32 v[98:99],v[178:179],v[178:179],s[48:49]
 v_pk_fma_f32 v[100:101],v[180:181],v[180:181],s[48:49]
 v_pk_fma_f32 v[102:103],v[182:183],v[182:183],s[48:49]
 s_mov_b32 s40,8192
 buffer_load_dwordx4 a[32:35],v1,s[60:63],s40 offen offset:0 sc1
 v_pk_mul_f32 v[96:97],v[96:97],v[176:177]
 v_pk_mul_f32 v[98:99],v[98:99],v[178:179]
 v_pk_mul_f32 v[100:101],v[100:101],v[180:181]
 v_pk_mul_f32 v[102:103],v[102:103],v[182:183]
 v_exp_f32 v96,v96
 v_exp_f32 v97,v97
 v_exp_f32 v98,v98
 v_exp_f32 v99,v99
 v_exp_f32 v100,v100
 v_exp_f32 v101,v101
 v_exp_f32 v102,v102
 v_exp_f32 v103,v103
 buffer_load_dwordx4 a[36:39],v1,s[60:63],s40 offen offset:1024 sc1
 v_pk_fma_f32 v[96:97],v[96:97],s[50:51],s[50:51]
 v_pk_fma_f32 v[98:99],v[98:99],s[50:51],s[50:51]
 v_pk_fma_f32 v[100:101],v[100:101],s[50:51],s[50:51]
 v_pk_fma_f32 v[102:103],v[102:103],s[50:51],s[50:51]
 buffer_load_dwordx4 a[48:51],v1,s[60:63],s40 offen offset:2048 sc1
 v_rcp_f32 v96,v96
 v_rcp_f32 v97,v97
 v_rcp_f32 v98,v98
 v_rcp_f32 v99,v99
 v_rcp_f32 v100,v100
 v_rcp_f32 v101,v101
 v_rcp_f32 v102,v102
 v_rcp_f32 v103,v103
 buffer_load_dwordx4 a[52:55],v1,s[60:63],s40 offen offset:3072 sc1
 v_pk_mul_f32 v[96:97],v[96:97],v[176:177]
 v_pk_mul_f32 v[98:99],v[98:99],v[178:179]
 v_pk_mul_f32 v[100:101],v[100:101],v[180:181]
 v_pk_mul_f32 v[102:103],v[102:103],v[182:183]
 v_cvt_pk_bf16_f32 v104,v96,v97
 v_cvt_pk_bf16_f32 v105,v98,v99
 v_cvt_pk_bf16_f32 v106,v100,v101
 v_cvt_pk_bf16_f32 v107,v102,v103
 buffer_store_dwordx4 v[104:107],v1,s[64:67],s44 offen offset:2048 sc1
 v_pk_fma_f32 v[108:109],v[184:185],v[184:185],s[48:49]
 v_pk_fma_f32 v[110:111],v[186:187],v[186:187],s[48:49]
 v_pk_fma_f32 v[112:113],v[188:189],v[188:189],s[48:49]
 v_pk_fma_f32 v[114:115],v[190:191],v[190:191],s[48:49]
 s_mov_b32 s59,237568
 buffer_load_dwordx4 a[40:43],v1,s[60:63],s59 offen offset:0 sc1
 v_pk_mul_f32 v[108:109],v[108:109],v[184:185]
 v_pk_mul_f32 v[110:111],v[110:111],v[186:187]
 v_pk_mul_f32 v[112:113],v[112:113],v[188:189]
 v_pk_mul_f32 v[114:115],v[114:115],v[190:191]
 v_exp_f32 v108,v108
 v_exp_f32 v109,v109
 v_exp_f32 v110,v110
 v_exp_f32 v111,v111
 v_exp_f32 v112,v112
 v_exp_f32 v113,v113
 v_exp_f32 v114,v114
 v_exp_f32 v115,v115
 buffer_load_dwordx4 a[44:47],v1,s[60:63],s59 offen offset:1024 sc1
 v_pk_fma_f32 v[108:109],v[108:109],s[50:51],s[50:51]
 v_pk_fma_f32 v[110:111],v[110:111],s[50:51],s[50:51]
 v_pk_fma_f32 v[112:113],v[112:113],s[50:51],s[50:51]
 v_pk_fma_f32 v[114:115],v[114:115],s[50:51],s[50:51]
 buffer_load_dwordx4 a[56:59],v1,s[60:63],s59 offen offset:2048 sc1
 v_rcp_f32 v108,v108
 v_rcp_f32 v109,v109
 v_rcp_f32 v110,v110
 v_rcp_f32 v111,v111
 v_rcp_f32 v112,v112
 v_rcp_f32 v113,v113
 v_rcp_f32 v114,v114
 v_rcp_f32 v115,v115
 buffer_load_dwordx4 a[60:63],v1,s[60:63],s59 offen offset:3072 sc1
 v_pk_mul_f32 v[108:109],v[108:109],v[184:185]
 v_pk_mul_f32 v[110:111],v[110:111],v[186:187]
 v_pk_mul_f32 v[112:113],v[112:113],v[188:189]
 v_pk_mul_f32 v[114:115],v[114:115],v[190:191]
 v_cvt_pk_bf16_f32 v116,v108,v109
 v_cvt_pk_bf16_f32 v117,v110,v111
 v_cvt_pk_bf16_f32 v118,v112,v113
 v_cvt_pk_bf16_f32 v119,v114,v115
 buffer_store_dwordx4 v[116:119],v1,s[64:67],s44 offen offset:3072 sc1
 s_cmp_eq_u32 s62,0
 s_cbranch_scc1 L_u_late
L_u_late_ret:
 s_waitcnt vmcnt(12) lgkmcnt(0)
 v_mfma_f32_16x16x32_bf16 v[128:131],a[0:3],a[128:131],0
 s_lshl_b32 s48,s46,1
 ds_read_b64_tr_b16 a[160:161],v20 offset:0
 s_add_u32 s48,s48,s100
 v_mfma_f32_16x16x32_bf16 v[128:131],a[16:19],a[132:135],v[128:131]
 s_mov_b32 s40,16384
 ds_read_b64_tr_b16 a[162:163],v20 offset:4096
 s_lshl_b32 s49,s47,11
 v_mfma_f32_16x16x32_bf16 v[132:135],a[4:7],a[128:131],0
 s_lshl_b32 s50,s100,17
 buffer_load_dwordx4 a[64:67],v1,s[60:63],s40 offen offset:0 sc1
 s_xor_b32 s51,s48,1
 v_mfma_f32_16x16x32_bf16 v[132:135],a[20:23],a[132:135],v[132:135]
 s_mul_i32 s51,s51,393216
 ds_read_b64_tr_b16 a[164:165],v20 offset:8192
 s_add_u32 s51,s51,s49
 v_mfma_f32_16x16x32_bf16 v[136:139],a[8:11],a[128:131],0
 s_add_u32 s12,s51,s50
 ds_read_b64_tr_b16 a[166:167],v20 offset:12288
 s_add_u32 s14,s51,263168
 v_mfma_f32_16x16x32_bf16 v[136:139],a[24:27],a[132:135],v[136:139]
 s_mul_i32 s51,s48,393216
 buffer_load_dwordx4 a[68:71],v1,s[60:63],s40 offen offset:1024 sc1
 s_add_u32 s51,s51,s49
 v_mfma_f32_16x16x32_bf16 v[140:143],a[12:15],a[128:131],0
 s_add_u32 s13,s51,s50
 ds_read_b64_tr_b16 a[168:169],v21 offset:0
 s_lshl_b32 s49,s47,1
 v_mfma_f32_16x16x32_bf16 v[140:143],a[28:31],a[132:135],v[140:143]
 s_add_u32 s49,s49,1
 ds_read_b64_tr_b16 a[170:171],v21 offset:4096
 s_mul_i32 s15,s48,393216
 v_mfma_f32_16x16x32_bf16 v[144:147],a[0:3],a[136:139],0
 s_lshl_b32 s50,s49,10
 s_add_u32 s15,s15,s50
 s_lshl_b32 s48,s48,17
 v_mfma_f32_16x16x32_bf16 v[144:147],a[16:19],a[140:143],v[144:147]
 s_lshl_b32 s49,s49,6
 ds_read_b64_tr_b16 a[172:173],v21 offset:8192
 buffer_load_dwordx4 a[80:83],v1,s[60:63],s40 offen offset:2048 sc1
 v_mfma_f32_16x16x32_bf16 v[148:151],a[4:7],a[136:139],0
 s_add_u32 s48,s48,s49
 ds_read_b64_tr_b16 a[174:175],v21 offset:12288
 s_sub_u32 s49,4194304,s48
 v_mfma_f32_16x16x32_bf16 v[148:151],a[20:23],a[140:143],v[148:151]
 s_add_u32 s72,s52,s48
 s_addc_u32 s73,s53,0
 s_mov_b32 s74,s49
 v_mfma_f32_16x16x32_bf16 v[152:155],a[8:11],a[136:139],0
 s_mov_b32 s75,0x20000
 ds_read_b64_tr_b16 a[176:177],v22 offset:0
 v_mfma_f32_16x16x32_bf16 v[152:155],a[24:27],a[140:143],v[152:155]
 s_add_u32 s16,s56,s48
 s_addc_u32 s17,s57,0
 ds_read_b64_tr_b16 a[178:179],v22 offset:4096
 buffer_load_dwordx4 a[84:87],v1,s[60:63],s40 offen offset:3072 sc1
 v_mfma_f32_16x16x32_bf16 v[156:159],a[12:15],a[136:139],0
 s_mov_b32 s18,s49
 s_mov_b32 s19,0x20000
 v_mfma_f32_16x16x32_bf16 v[156:159],a[28:31],a[140:143],v[156:159]
 ds_read_b64_tr_b16 a[180:181],v22 offset:8192
 v_mfma_f32_16x16x32_bf16 v[160:163],a[0:3],a[144:147],0
 s_mov_b32 s59,245760
 ds_read_b64_tr_b16 a[182:183],v22 offset:12288
 v_mfma_f32_16x16x32_bf16 v[160:163],a[16:19],a[148:151],v[160:163]
 buffer_load_dwordx4 a[72:75],v1,s[60:63],s59 offen offset:0 sc1
 v_mfma_f32_16x16x32_bf16 v[164:167],a[4:7],a[144:147],0
 ds_read_b64_tr_b16 a[184:185],v23 offset:0
 v_mfma_f32_16x16x32_bf16 v[164:167],a[20:23],a[148:151],v[164:167]
 ds_read_b64_tr_b16 a[186:187],v23 offset:4096
 v_mfma_f32_16x16x32_bf16 v[168:171],a[8:11],a[144:147],0
 buffer_load_dwordx4 a[76:79],v1,s[60:63],s59 offen offset:1024 sc1
 v_mfma_f32_16x16x32_bf16 v[168:171],a[24:27],a[148:151],v[168:171]
 ds_read_b64_tr_b16 a[188:189],v23 offset:8192
 v_mfma_f32_16x16x32_bf16 v[172:175],a[12:15],a[144:147],0
 ds_read_b64_tr_b16 a[190:191],v23 offset:12288
 v_mfma_f32_16x16x32_bf16 v[172:175],a[28:31],a[148:151],v[172:175]
 v_mfma_f32_16x16x32_bf16 v[176:179],a[0:3],a[152:155],0
 buffer_load_dwordx4 a[88:91],v1,s[60:63],s59 offen offset:2048 sc1
 v_mfma_f32_16x16x32_bf16 v[176:179],a[16:19],a[156:159],v[176:179]
 v_mfma_f32_16x16x32_bf16 v[180:183],a[4:7],a[152:155],0
 v_mfma_f32_16x16x32_bf16 v[180:183],a[20:23],a[156:159],v[180:183]
 v_mfma_f32_16x16x32_bf16 v[184:187],a[8:11],a[152:155],0
 buffer_load_dwordx4 a[92:95],v1,s[60:63],s59 offen offset:3072 sc1
 v_mfma_f32_16x16x32_bf16 v[184:187],a[24:27],a[156:159],v[184:187]
 v_mfma_f32_16x16x32_bf16 v[188:191],a[12:15],a[152:155],0
 v_mfma_f32_16x16x32_bf16 v[188:191],a[28:31],a[156:159],v[188:191]
 s_waitcnt vmcnt(62) lgkmcnt(0)
 s_barrier
 v_mfma_f32_16x16x32_bf16 v[192:195],a[0:3],a[160:163],v[228:231]
 s_add_u32 m0,s3,0
 ds_read_b64_tr_b16 a[128:129],v24 offset:0
 s_waitcnt vmcnt(8)
 v_mfma_f32_16x16x32_bf16 v[192:195],a[16:19],a[164:167],v[192:195]
 s_mov_b32 s41,2097152
 ds_read_b64_tr_b16 a[130:131],v24 offset:4096
 buffer_store_dword v55,v52,s[68:71],s77 offen sc1
 v_mfma_f32_16x16x32_bf16 v[196:199],a[4:7],a[160:163],v[228:231]
 buffer_load_dwordx4 v32,s[8:11],s41 offen offset:0 lds
 v_mfma_f32_16x16x32_bf16 v[196:199],a[20:23],a[164:167],v[196:199]
 ds_read_b64_tr_b16 a[132:133],v24 offset:8192
 v_mfma_f32_16x16x32_bf16 v[224:227],a[8:11],a[160:163],v[228:231]
 ds_read_b64_tr_b16 a[134:135],v24 offset:12288
 v_mfma_f32_16x16x32_bf16 v[224:227],a[24:27],a[164:167],v[224:227]
 buffer_load_dwordx4 v33,s[8:11],s41 offen offset:1024 lds
 v_mfma_f32_16x16x32_bf16 v[228:231],a[12:15],a[160:163],v[228:231]
 ds_read_b64_tr_b16 a[136:137],v25 offset:0
 v_mfma_f32_16x16x32_bf16 v[228:231],a[28:31],a[164:167],v[228:231]
 ds_read_b64_tr_b16 a[138:139],v25 offset:4096
 v_mfma_f32_16x16x32_bf16 v[200:203],a[0:3],a[168:171],v[236:239]
 s_mov_b32 s40,24576
 v_mfma_f32_16x16x32_bf16 v[200:203],a[16:19],a[172:175],v[200:203]
 ds_read_b64_tr_b16 a[140:141],v25 offset:8192
 buffer_load_dwordx4 a[96:99],v1,s[60:63],s40 offen offset:0 sc1
 v_mfma_f32_16x16x32_bf16 v[204:207],a[4:7],a[168:171],v[236:239]
 ds_read_b64_tr_b16 a[142:143],v25 offset:12288
 v_mfma_f32_16x16x32_bf16 v[204:207],a[20:23],a[172:175],v[204:207]
 v_mfma_f32_16x16x32_bf16 v[232:235],a[8:11],a[168:171],v[236:239]
 ds_read_b64_tr_b16 a[144:145],v26 offset:0
 v_mfma_f32_16x16x32_bf16 v[232:235],a[24:27],a[172:175],v[232:235]
 ds_read_b64_tr_b16 a[146:147],v26 offset:4096
 buffer_load_dwordx4 a[100:103],v1,s[60:63],s40 offen offset:1024 sc1
 v_mfma_f32_16x16x32_bf16 v[236:239],a[12:15],a[168:171],v[236:239]
 v_mfma_f32_16x16x32_bf16 v[236:239],a[28:31],a[172:175],v[236:239]
 ds_read_b64_tr_b16 a[148:149],v26 offset:8192
 v_mfma_f32_16x16x32_bf16 v[208:211],a[0:3],a[176:179],v[244:247]
 ds_read_b64_tr_b16 a[150:151],v26 offset:12288
 v_mfma_f32_16x16x32_bf16 v[208:211],a[16:19],a[180:183],v[208:211]
 buffer_load_dwordx4 a[112:115],v1,s[60:63],s40 offen offset:2048 sc1
 v_mfma_f32_16x16x32_bf16 v[212:215],a[4:7],a[176:179],v[244:247]
 ds_read_b64_tr_b16 a[152:153],v27 offset:0
 v_mfma_f32_16x16x32_bf16 v[212:215],a[20:23],a[180:183],v[212:215]
 ds_read_b64_tr_b16 a[154:155],v27 offset:4096
 v_mfma_f32_16x16x32_bf16 v[240:243],a[8:11],a[176:179],v[244:247]
 buffer_load_dwordx4 a[116:119],v1,s[60:63],s40 offen offset:3072 sc1
 v_mfma_f32_16x16x32_bf16 v[240:243],a[24:27],a[180:183],v[240:243]
 ds_read_b64_tr_b16 a[156:157],v27 offset:8192
 v_mfma_f32_16x16x32_bf16 v[244:247],a[12:15],a[176:179],v[244:247]
 ds_read_b64_tr_b16 a[158:159],v27 offset:12288
 v_mfma_f32_16x16x32_bf16 v[244:247],a[28:31],a[180:183],v[244:247]
 s_mov_b32 s59,253952
 v_mfma_f32_16x16x32_bf16 v[216:219],a[0:3],a[184:187],v[252:255]
 buffer_load_dwordx4 a[104:107],v1,s[60:63],s59 offen offset:0 sc1
 v_mfma_f32_16x16x32_bf16 v[216:219],a[16:19],a[188:191],v[216:219]
 v_mfma_f32_16x16x32_bf16 v[220:223],a[4:7],a[184:187],v[252:255]
 v_mfma_f32_16x16x32_bf16 v[220:223],a[20:23],a[188:191],v[220:223]
 v_mfma_f32_16x16x32_bf16 v[248:251],a[8:11],a[184:187],v[252:255]
 buffer_load_dwordx4 a[108:111],v1,s[60:63],s59 offen offset:1024 sc1
 v_mfma_f32_16x16x32_bf16 v[248:251],a[24:27],a[188:191],v[248:251]
 v_mfma_f32_16x16x32_bf16 v[252:255],a[12:15],a[184:187],v[252:255]
 v_mfma_f32_16x16x32_bf16 v[252:255],a[28:31],a[188:191],v[252:255]
 s_waitcnt vmcnt(18) lgkmcnt(0)
 v_mfma_f32_16x16x32_bf16 v[128:131],a[32:35],a[128:131],v[128:131]
 ds_read_b64_tr_b16 a[160:161],v28 offset:0
 v_mfma_f32_16x16x32_bf16 v[128:131],a[48:51],a[132:135],v[128:131]
 ds_read_b64_tr_b16 a[162:163],v28 offset:4096
 v_mfma_f32_16x16x32_bf16 v[132:135],a[52:55],a[132:135],v[132:135]
 buffer_load_dwordx4 a[120:123],v1,s[60:63],s59 offen offset:2048 sc1
 v_mfma_f32_16x16x32_bf16 v[132:135],a[36:39],a[128:131],v[132:135]
 ds_read_b64_tr_b16 a[164:165],v28 offset:8192
 v_mfma_f32_16x16x32_bf16 v[136:139],a[40:43],a[128:131],v[136:139]
 ds_read_b64_tr_b16 a[166:167],v28 offset:12288
 v_mfma_f32_16x16x32_bf16 v[136:139],a[56:59],a[132:135],v[136:139]
 buffer_load_dwordx4 a[124:127],v1,s[60:63],s59 offen offset:3072 sc1
 v_mfma_f32_16x16x32_bf16 v[140:143],a[60:63],a[132:135],v[140:143]
 ds_read_b64_tr_b16 a[168:169],v29 offset:0
 v_mfma_f32_16x16x32_bf16 v[140:143],a[44:47],a[128:131],v[140:143]
 ds_read_b64_tr_b16 a[170:171],v29 offset:4096
 v_mfma_f32_16x16x32_bf16 v[156:159],a[44:47],a[136:139],v[156:159]
 v_mfma_f32_16x16x32_bf16 v[156:159],a[60:63],a[140:143],v[156:159]
 ds_read_b64_tr_b16 a[172:173],v29 offset:8192
 buffer_load_dwordx4 v34,s[8:11],s41 offen offset:2048 lds
 v_mfma_f32_16x16x32_bf16 v[152:155],a[56:59],a[140:143],v[152:155]
 ds_read_b64_tr_b16 a[174:175],v29 offset:12288
 v_mfma_f32_16x16x32_bf16 v[152:155],a[40:43],a[136:139],v[152:155]
 v_mfma_f32_16x16x32_bf16 v[148:151],a[36:39],a[136:139],v[148:151]
 ds_read_b64_tr_b16 a[176:177],v30 offset:0
 v_mfma_f32_16x16x32_bf16 v[148:151],a[52:55],a[140:143],v[148:151]
 ds_read_b64_tr_b16 a[178:179],v30 offset:4096
 buffer_load_dwordx4 v35,s[8:11],s41 offen offset:3072 lds
 v_mfma_f32_16x16x32_bf16 v[144:147],a[48:51],a[140:143],v[144:147]
 v_mfma_f32_16x16x32_bf16 v[144:147],a[32:35],a[136:139],v[144:147]
 ds_read_b64_tr_b16 a[180:181],v30 offset:8192
 v_mfma_f32_16x16x32_bf16 v[160:163],a[32:35],a[144:147],v[160:163]
 s_mov_b32 s40,32768
 ds_read_b64_tr_b16 a[182:183],v30 offset:12288
 v_mfma_f32_16x16x32_bf16 v[160:163],a[48:51],a[148:151],v[160:163]
 buffer_load_dwordx4 a[0:3],v1,s[60:63],s40 offen offset:0 sc1
 v_mfma_f32_16x16x32_bf16 v[164:167],a[52:55],a[148:151],v[164:167]
 ds_read_b64_tr_b16 a[184:185],v31 offset:0
 v_mfma_f32_16x16x32_bf16 v[164:167],a[36:39],a[144:147],v[164:167]
 ds_read_b64_tr_b16 a[186:187],v31 offset:4096
 v_mfma_f32_16x16x32_bf16 v[168:171],a[40:43],a[144:147],v[168:171]
 buffer_load_dwordx4 a[4:7],v1,s[60:63],s40 offen offset:1024 sc1
 v_mfma_f32_16x16x32_bf16 v[168:171],a[56:59],a[148:151],v[168:171]
 ds_read_b64_tr_b16 a[188:189],v31 offset:8192
 v_mfma_f32_16x16x32_bf16 v[172:175],a[60:63],a[148:151],v[172:175]
 ds_read_b64_tr_b16 a[190:191],v31 offset:12288
 v_mfma_f32_16x16x32_bf16 v[172:175],a[44:47],a[144:147],v[172:175]
 v_mfma_f32_16x16x32_bf16 v[188:191],a[44:47],a[152:155],v[188:191]
 buffer_load_dwordx4 a[16:19],v1,s[60:63],s40 offen offset:2048 sc1
 v_mfma_f32_16x16x32_bf16 v[188:191],a[60:63],a[156:159],v[188:191]
 v_mfma_f32_16x16x32_bf16 v[184:187],a[56:59],a[156:159],v[184:187]
 v_mfma_f32_16x16x32_bf16 v[184:187],a[40:43],a[152:155],v[184:187]
 v_mfma_f32_16x16x32_bf16 v[180:183],a[36:39],a[152:155],v[180:183]
 buffer_load_dwordx4 a[20:23],v1,s[60:63],s40 offen offset:3072 sc1
 v_mfma_f32_16x16x32_bf16 v[180:183],a[52:55],a[156:159],v[180:183]
 v_mfma_f32_16x16x32_bf16 v[176:179],a[48:51],a[156:159],v[176:179]
 v_mfma_f32_16x16x32_bf16 v[176:179],a[32:35],a[152:155],v[176:179]
 s_waitcnt vmcnt(62) lgkmcnt(0)
 s_barrier
 v_mfma_f32_16x16x32_bf16 v[192:195],a[32:35],a[160:163],v[192:195]
 ds_read_b64_tr_b16 a[128:129],v16 offset:16384
 v_mfma_f32_16x16x32_bf16 v[192:195],a[48:51],a[164:167],v[192:195]
 s_mov_b32 s59,262144
 ds_read_b64_tr_b16 a[130:131],v16 offset:20480
 v_mfma_f32_16x16x32_bf16 v[196:199],a[52:55],a[164:167],v[196:199]
 buffer_load_dwordx4 a[8:11],v1,s[60:63],s59 offen offset:0 sc1
 v_mfma_f32_16x16x32_bf16 v[196:199],a[36:39],a[160:163],v[196:199]
 ds_read_b64_tr_b16 a[132:133],v16 offset:24576
 v_mfma_f32_16x16x32_bf16 v[224:227],a[40:43],a[160:163],v[224:227]
 ds_read_b64_tr_b16 a[134:135],v16 offset:28672
 v_mfma_f32_16x16x32_bf16 v[224:227],a[56:59],a[164:167],v[224:227]
 v_mfma_f32_16x16x32_bf16 v[228:231],a[60:63],a[164:167],v[228:231]
 ds_read_b64_tr_b16 a[136:137],v17 offset:16384
 v_mfma_f32_16x16x32_bf16 v[228:231],a[44:47],a[160:163],v[228:231]
 ds_read_b64_tr_b16 a[138:139],v17 offset:20480
 buffer_load_dwordx4 a[12:15],v1,s[60:63],s59 offen offset:1024 sc1
 v_mfma_f32_16x16x32_bf16 v[236:239],a[44:47],a[168:171],v[236:239]
 v_mfma_f32_16x16x32_bf16 v[236:239],a[60:63],a[172:175],v[236:239]
 ds_read_b64_tr_b16 a[140:141],v17 offset:24576
 v_mfma_f32_16x16x32_bf16 v[232:235],a[56:59],a[172:175],v[232:235]
 ds_read_b64_tr_b16 a[142:143],v17 offset:28672
 v_mfma_f32_16x16x32_bf16 v[232:235],a[40:43],a[168:171],v[232:235]
 v_mfma_f32_16x16x32_bf16 v[204:207],a[36:39],a[168:171],v[204:207]
 ds_read_b64_tr_b16 a[144:145],v18 offset:16384
 buffer_load_dwordx4 a[24:27],v1,s[60:63],s59 offen offset:2048 sc1
 v_mfma_f32_16x16x32_bf16 v[204:207],a[52:55],a[172:175],v[204:207]
 ds_read_b64_tr_b16 a[146:147],v18 offset:20480
 v_mfma_f32_16x16x32_bf16 v[200:203],a[48:51],a[172:175],v[200:203]
 v_mfma_f32_16x16x32_bf16 v[200:203],a[32:35],a[168:171],v[200:203]
 ds_read_b64_tr_b16 a[148:149],v18 offset:24576
 v_mfma_f32_16x16x32_bf16 v[208:211],a[32:35],a[176:179],v[208:211]
 ds_read_b64_tr_b16 a[150:151],v18 offset:28672
 v_mfma_f32_16x16x32_bf16 v[208:211],a[48:51],a[180:183],v[208:211]
 buffer_load_dwordx4 a[28:31],v1,s[60:63],s59 offen offset:3072 sc1
 v_mfma_f32_16x16x32_bf16 v[212:215],a[52:55],a[180:183],v[212:215]
 ds_read_b64_tr_b16 a[152:153],v19 offset:16384
 v_mfma_f32_16x16x32_bf16 v[212:215],a[36:39],a[176:179],v[212:215]
 ds_read_b64_tr_b16 a[154:155],v19 offset:20480
 v_mfma_f32_16x16x32_bf16 v[240:243],a[40:43],a[176:179],v[240:243]
 s_add_u32 m0,s3,65536
 v_mfma_f32_16x16x32_bf16 v[240:243],a[56:59],a[180:183],v[240:243]
 s_mov_b32 s41,2621440
 ds_read_b64_tr_b16 a[156:157],v19 offset:24576
 v_mfma_f32_16x16x32_bf16 v[244:247],a[60:63],a[180:183],v[244:247]
 ds_read_b64_tr_b16 a[158:159],v19 offset:28672
 buffer_load_dwordx4 v32,s[8:11],s41 offen offset:0 lds
 v_mfma_f32_16x16x32_bf16 v[244:247],a[44:47],a[176:179],v[244:247]
 v_mfma_f32_16x16x32_bf16 v[252:255],a[44:47],a[184:187],v[252:255]
 v_mfma_f32_16x16x32_bf16 v[252:255],a[60:63],a[188:191],v[252:255]
 v_mfma_f32_16x16x32_bf16 v[248:251],a[56:59],a[188:191],v[248:251]
 v_mfma_f32_16x16x32_bf16 v[248:251],a[40:43],a[184:187],v[248:251]
 buffer_load_dwordx4 v33,s[8:11],s41 offen offset:1024 lds
 v_mfma_f32_16x16x32_bf16 v[220:223],a[36:39],a[184:187],v[220:223]
 v_mfma_f32_16x16x32_bf16 v[220:223],a[52:55],a[188:191],v[220:223]
 v_mfma_f32_16x16x32_bf16 v[216:219],a[48:51],a[188:191],v[216:219]
 v_mfma_f32_16x16x32_bf16 v[216:219],a[32:35],a[184:187],v[216:219]
 s_waitcnt vmcnt(23) lgkmcnt(0)
 s_cmp_eq_u32 s100,0
 s_cselect_b32 s44,3,3
L_mlp2_loop:
 v_mfma_f32_16x16x32_bf16 v[128:131],a[64:67],a[128:131],v[128:131]
 ds_read_b64_tr_b16 a[160:161],v20 offset:16384
 buffer_load_dword v53,v54,s[68:71],s76 offen sc1
 v_mfma_f32_16x16x32_bf16 v[128:131],a[80:83],a[132:135],v[128:131]
 s_add_u32 s40,s40,8192
 ds_read_b64_tr_b16 a[162:163],v20 offset:20480
 v_mfma_f32_16x16x32_bf16 v[132:135],a[84:87],a[132:135],v[132:135]
 buffer_load_dwordx4 a[32:35],v1,s[60:63],s40 offen offset:0 sc1
 v_mfma_f32_16x16x32_bf16 v[132:135],a[68:71],a[128:131],v[132:135]
 ds_read_b64_tr_b16 a[164:165],v20 offset:24576
 v_mfma_f32_16x16x32_bf16 v[136:139],a[72:75],a[128:131],v[136:139]
 ds_read_b64_tr_b16 a[166:167],v20 offset:28672
 v_mfma_f32_16x16x32_bf16 v[136:139],a[88:91],a[132:135],v[136:139]
 v_mfma_f32_16x16x32_bf16 v[140:143],a[92:95],a[132:135],v[140:143]
 ds_read_b64_tr_b16 a[168:169],v21 offset:16384
 v_mfma_f32_16x16x32_bf16 v[140:143],a[76:79],a[128:131],v[140:143]
 ds_read_b64_tr_b16 a[170:171],v21 offset:20480
 buffer_load_dwordx4 v34,s[8:11],s41 offen offset:2048 lds
 v_mfma_f32_16x16x32_bf16 v[156:159],a[76:79],a[136:139],v[156:159]
 v_mfma_f32_16x16x32_bf16 v[156:159],a[92:95],a[140:143],v[156:159]
 ds_read_b64_tr_b16 a[172:173],v21 offset:24576
 v_mfma_f32_16x16x32_bf16 v[152:155],a[88:91],a[140:143],v[152:155]
 ds_read_b64_tr_b16 a[174:175],v21 offset:28672
 v_mfma_f32_16x16x32_bf16 v[152:155],a[72:75],a[136:139],v[152:155]
 v_mfma_f32_16x16x32_bf16 v[148:151],a[68:71],a[136:139],v[148:151]
 ds_read_b64_tr_b16 a[176:177],v22 offset:16384
 buffer_load_dwordx4 a[36:39],v1,s[60:63],s40 offen offset:1024 sc1
 v_mfma_f32_16x16x32_bf16 v[148:151],a[84:87],a[140:143],v[148:151]
 ds_read_b64_tr_b16 a[178:179],v22 offset:20480
 v_mfma_f32_16x16x32_bf16 v[144:147],a[80:83],a[140:143],v[144:147]
 v_mfma_f32_16x16x32_bf16 v[144:147],a[64:67],a[136:139],v[144:147]
 ds_read_b64_tr_b16 a[180:181],v22 offset:24576
 v_mfma_f32_16x16x32_bf16 v[160:163],a[64:67],a[144:147],v[160:163]
 ds_read_b64_tr_b16 a[182:183],v22 offset:28672
 v_mfma_f32_16x16x32_bf16 v[160:163],a[80:83],a[148:151],v[160:163]
 buffer_load_dwordx4 a[48:51],v1,s[60:63],s40 offen offset:2048 sc1
 v_mfma_f32_16x16x32_bf16 v[164:167],a[84:87],a[148:151],v[164:167]
 ds_read_b64_tr_b16 a[184:185],v23 offset:16384
 v_mfma_f32_16x16x32_bf16 v[164:167],a[68:71],a[144:147],v[164:167]
 ds_read_b64_tr_b16 a[186:187],v23 offset:20480
 v_mfma_f32_16x16x32_bf16 v[168:171],a[72:75],a[144:147],v[168:171]
 v_mfma_f32_16x16x32_bf16 v[168:171],a[88:91],a[148:151],v[168:171]
 ds_read_b64_tr_b16 a[188:189],v23 offset:24576
 v_mfma_f32_16x16x32_bf16 v[172:175],a[92:95],a[148:151],v[172:175]
 ds_read_b64_tr_b16 a[190:191],v23 offset:28672
 buffer_load_dwordx4 v35,s[8:11],s41 offen offset:3072 lds
 v_mfma_f32_16x16x32_bf16 v[172:175],a[76:79],a[144:147],v[172:175]
 v_mfma_f32_16x16x32_bf16 v[188:191],a[76:79],a[152:155],v[188:191]
 v_mfma_f32_16x16x32_bf16 v[188:191],a[92:95],a[156:159],v[188:191]
 v_mfma_f32_16x16x32_bf16 v[184:187],a[88:91],a[156:159],v[184:187]
 v_mfma_f32_16x16x32_bf16 v[184:187],a[72:75],a[152:155],v[184:187]
 buffer_load_dwordx4 a[52:55],v1,s[60:63],s40 offen offset:3072 sc1
 v_mfma_f32_16x16x32_bf16 v[180:183],a[68:71],a[152:155],v[180:183]
 v_mfma_f32_16x16x32_bf16 v[180:183],a[84:87],a[156:159],v[180:183]
 v_mfma_f32_16x16x32_bf16 v[176:179],a[80:83],a[156:159],v[176:179]
 v_mfma_f32_16x16x32_bf16 v[176:179],a[64:67],a[152:155],v[176:179]
 s_waitcnt vmcnt(26) lgkmcnt(0)
 s_barrier
 v_mfma_f32_16x16x32_bf16 v[192:195],a[64:67],a[160:163],v[192:195]
 ds_read_b64_tr_b16 a[128:129],v24 offset:16384
 v_mfma_f32_16x16x32_bf16 v[192:195],a[80:83],a[164:167],v[192:195]
 s_add_u32 s59,s40,229376
 ds_read_b64_tr_b16 a[130:131],v24 offset:20480
 v_mfma_f32_16x16x32_bf16 v[196:199],a[84:87],a[164:167],v[196:199]
 buffer_load_dwordx4 a[40:43],v1,s[60:63],s59 offen offset:0 sc1
 v_mfma_f32_16x16x32_bf16 v[196:199],a[68:71],a[160:163],v[196:199]
 ds_read_b64_tr_b16 a[132:133],v24 offset:24576
 v_mfma_f32_16x16x32_bf16 v[224:227],a[72:75],a[160:163],v[224:227]
 ds_read_b64_tr_b16 a[134:135],v24 offset:28672
 v_mfma_f32_16x16x32_bf16 v[224:227],a[88:91],a[164:167],v[224:227]
 s_add_u32 m0,s3,16384
 v_mfma_f32_16x16x32_bf16 v[228:231],a[92:95],a[164:167],v[228:231]
 s_add_u32 s41,s41,524288
 ds_read_b64_tr_b16 a[136:137],v25 offset:16384
 v_mfma_f32_16x16x32_bf16 v[228:231],a[76:79],a[160:163],v[228:231]
 ds_read_b64_tr_b16 a[138:139],v25 offset:20480
 buffer_load_dwordx4 v32,s[8:11],s41 offen offset:0 lds
 v_mfma_f32_16x16x32_bf16 v[236:239],a[76:79],a[168:171],v[236:239]
 v_mfma_f32_16x16x32_bf16 v[236:239],a[92:95],a[172:175],v[236:239]
 ds_read_b64_tr_b16 a[140:141],v25 offset:24576
 v_mfma_f32_16x16x32_bf16 v[232:235],a[88:91],a[172:175],v[232:235]
 ds_read_b64_tr_b16 a[142:143],v25 offset:28672
 v_mfma_f32_16x16x32_bf16 v[232:235],a[72:75],a[168:171],v[232:235]
 v_mfma_f32_16x16x32_bf16 v[204:207],a[68:71],a[168:171],v[204:207]
 ds_read_b64_tr_b16 a[144:145],v26 offset:16384
 buffer_load_dwordx4 a[44:47],v1,s[60:63],s59 offen offset:1024 sc1
 v_mfma_f32_16x16x32_bf16 v[204:207],a[84:87],a[172:175],v[204:207]
 ds_read_b64_tr_b16 a[146:147],v26 offset:20480
 v_mfma_f32_16x16x32_bf16 v[200:203],a[80:83],a[172:175],v[200:203]
 v_mfma_f32_16x16x32_bf16 v[200:203],a[64:67],a[168:171],v[200:203]
 ds_read_b64_tr_b16 a[148:149],v26 offset:24576
 v_mfma_f32_16x16x32_bf16 v[208:211],a[64:67],a[176:179],v[208:211]
 ds_read_b64_tr_b16 a[150:151],v26 offset:28672
 v_mfma_f32_16x16x32_bf16 v[208:211],a[80:83],a[180:183],v[208:211]
 buffer_load_dwordx4 a[56:59],v1,s[60:63],s59 offen offset:2048 sc1
 v_mfma_f32_16x16x32_bf16 v[212:215],a[84:87],a[180:183],v[212:215]
 ds_read_b64_tr_b16 a[152:153],v27 offset:16384
 v_mfma_f32_16x16x32_bf16 v[212:215],a[68:71],a[176:179],v[212:215]
 ds_read_b64_tr_b16 a[154:155],v27 offset:20480
 v_mfma_f32_16x16x32_bf16 v[240:243],a[72:75],a[176:179],v[240:243]
 v_mfma_f32_16x16x32_bf16 v[240:243],a[88:91],a[180:183],v[240:243]
 ds_read_b64_tr_b16 a[156:157],v27 offset:24576
 v_mfma_f32_16x16x32_bf16 v[244:247],a[92:95],a[180:183],v[244:247]
 ds_read_b64_tr_b16 a[158:159],v27 offset:28672
 buffer_load_dwordx4 v33,s[8:11],s41 offen offset:1024 lds
 v_mfma_f32_16x16x32_bf16 v[244:247],a[76:79],a[176:179],v[244:247]
 v_mfma_f32_16x16x32_bf16 v[252:255],a[76:79],a[184:187],v[252:255]
 v_mfma_f32_16x16x32_bf16 v[252:255],a[92:95],a[188:191],v[252:255]
 v_mfma_f32_16x16x32_bf16 v[248:251],a[88:91],a[188:191],v[248:251]
 v_mfma_f32_16x16x32_bf16 v[248:251],a[72:75],a[184:187],v[248:251]
 buffer_load_dwordx4 a[60:63],v1,s[60:63],s59 offen offset:3072 sc1
 v_mfma_f32_16x16x32_bf16 v[220:223],a[68:71],a[184:187],v[220:223]
L_stub_m_1:
 s_cbranch_execz L_stub_m_5
 v_mfma_f32_16x16x32_bf16 v[220:223],a[84:87],a[188:191],v[220:223]
 v_mfma_f32_16x16x32_bf16 v[216:219],a[80:83],a[188:191],v[216:219]
 v_mfma_f32_16x16x32_bf16 v[216:219],a[64:67],a[184:187],v[216:219]
 s_waitcnt vmcnt(25) lgkmcnt(0)
 v_mfma_f32_16x16x32_bf16 v[128:131],a[96:99],a[128:131],v[128:131]
 ds_read_b64_tr_b16 a[160:161],v28 offset:16384
 v_mfma_f32_16x16x32_bf16 v[128:131],a[112:115],a[132:135],v[128:131]
 s_add_u32 s40,s40,8192
 ds_read_b64_tr_b16 a[162:163],v28 offset:20480
 v_mfma_f32_16x16x32_bf16 v[132:135],a[116:119],a[132:135],v[132:135]
 buffer_load_dwordx4 a[64:67],v1,s[60:63],s40 offen offset:0 sc1
 v_mfma_f32_16x16x32_bf16 v[132:135],a[100:103],a[128:131],v[132:135]
 ds_read_b64_tr_b16 a[164:165],v28 offset:24576
 v_mfma_f32_16x16x32_bf16 v[136:139],a[104:107],a[128:131],v[136:139]
 ds_read_b64_tr_b16 a[166:167],v28 offset:28672
 v_mfma_f32_16x16x32_bf16 v[136:139],a[120:123],a[132:135],v[136:139]
 v_mfma_f32_16x16x32_bf16 v[140:143],a[124:127],a[132:135],v[140:143]
 ds_read_b64_tr_b16 a[168:169],v29 offset:16384
 v_mfma_f32_16x16x32_bf16 v[140:143],a[108:111],a[128:131],v[140:143]
 ds_read_b64_tr_b16 a[170:171],v29 offset:20480
 buffer_load_dwordx4 v34,s[8:11],s41 offen offset:2048 lds
 v_mfma_f32_16x16x32_bf16 v[156:159],a[108:111],a[136:139],v[156:159]
 v_mfma_f32_16x16x32_bf16 v[156:159],a[124:127],a[140:143],v[156:159]
 ds_read_b64_tr_b16 a[172:173],v29 offset:24576
 v_mfma_f32_16x16x32_bf16 v[152:155],a[120:123],a[140:143],v[152:155]
 ds_read_b64_tr_b16 a[174:175],v29 offset:28672
 v_mfma_f32_16x16x32_bf16 v[152:155],a[104:107],a[136:139],v[152:155]
 v_mfma_f32_16x16x32_bf16 v[148:151],a[100:103],a[136:139],v[148:151]
 ds_read_b64_tr_b16 a[176:177],v30 offset:16384
 buffer_load_dwordx4 a[68:71],v1,s[60:63],s40 offen offset:1024 sc1
 v_mfma_f32_16x16x32_bf16 v[148:151],a[116:119],a[140:143],v[148:151]
 ds_read_b64_tr_b16 a[178:179],v30 offset:20480
 v_mfma_f32_16x16x32_bf16 v[144:147],a[112:115],a[140:143],v[144:147]
 v_mfma_f32_16x16x32_bf16 v[144:147],a[96:99],a[136:139],v[144:147]
 ds_read_b64_tr_b16 a[180:181],v30 offset:24576
 v_mfma_f32_16x16x32_bf16 v[160:163],a[96:99],a[144:147],v[160:163]
 ds_read_b64_tr_b16 a[182:183],v30 offset:28672
 v_mfma_f32_16x16x32_bf16 v[160:163],a[112:115],a[148:151],v[160:163]
 buffer_load_dwordx4 a[80:83],v1,s[60:63],s40 offen offset:2048 sc1
 v_mfma_f32_16x16x32_bf16 v[164:167],a[116:119],a[148:151],v[164:167]
 ds_read_b64_tr_b16 a[184:185],v31 offset:16384
 v_mfma_f32_16x16x32_bf16 v[164:167],a[100:103],a[144:147],v[164:167]
 ds_read_b64_tr_b16 a[186:187],v31 offset:20480
 v_mfma_f32_16x16x32_bf16 v[168:171],a[104:107],a[144:147],v[168:171]
 v_mfma_f32_16x16x32_bf16 v[168:171],a[120:123],a[148:151],v[168:171]
 ds_read_b64_tr_b16 a[188:189],v31 offset:24576
 v_mfma_f32_16x16x32_bf16 v[172:175],a[124:127],a[148:151],v[172:175]
 ds_read_b64_tr_b16 a[190:191],v31 offset:28672
 buffer_load_dwordx4 v35,s[8:11],s41 offen offset:3072 lds
 v_mfma_f32_16x16x32_bf16 v[172:175],a[108:111],a[144:147],v[172:175]
 v_mfma_f32_16x16x32_bf16 v[188:191],a[108:111],a[152:155],v[188:191]
 v_mfma_f32_16x16x32_bf16 v[188:191],a[124:127],a[156:159],v[188:191]
 v_mfma_f32_16x16x32_bf16 v[184:187],a[120:123],a[156:159],v[184:187]
 v_mfma_f32_16x16x32_bf16 v[184:187],a[104:107],a[152:155],v[184:187]
 buffer_load_dwordx4 a[84:87],v1,s[60:63],s40 offen offset:3072 sc1
 v_mfma_f32_16x16x32_bf16 v[180:183],a[100:103],a[152:155],v[180:183]
 v_mfma_f32_16x16x32_bf16 v[180:183],a[116:119],a[156:159],v[180:183]
 v_mfma_f32_16x16x32_bf16 v[176:179],a[112:115],a[156:159],v[176:179]
 v_mfma_f32_16x16x32_bf16 v[176:179],a[96:99],a[152:155],v[176:179]
 s_waitcnt vmcnt(26) lgkmcnt(0)
 s_barrier
 v_mfma_f32_16x16x32_bf16 v[192:195],a[96:99],a[160:163],v[192:195]
 ds_read_b64_tr_b16 a[128:129],v16 offset:0
 v_mfma_f32_16x16x32_bf16 v[192:195],a[112:115],a[164:167],v[192:195]
 s_add_u32 s59,s40,229376
 ds_read_b64_tr_b16 a[130:131],v16 offset:4096
 v_mfma_f32_16x16x32_bf16 v[196:199],a[116:119],a[164:167],v[196:199]
 buffer_load_dwordx4 a[72:75],v1,s[60:63],s59 offen offset:0 sc1
 v_mfma_f32_16x16x32_bf16 v[196:199],a[100:103],a[160:163],v[196:199]
 ds_read_b64_tr_b16 a[132:133],v16 offset:8192
 v_mfma_f32_16x16x32_bf16 v[224:227],a[104:107],a[160:163],v[224:227]
 ds_read_b64_tr_b16 a[134:135],v16 offset:12288
 v_mfma_f32_16x16x32_bf16 v[224:227],a[120:123],a[164:167],v[224:227]
 s_add_u32 m0,s3,81920
 v_mfma_f32_16x16x32_bf16 v[228:231],a[124:127],a[164:167],v[228:231]
 s_add_u32 s41,s41,524288
 ds_read_b64_tr_b16 a[136:137],v17 offset:0
 v_mfma_f32_16x16x32_bf16 v[228:231],a[108:111],a[160:163],v[228:231]
 ds_read_b64_tr_b16 a[138:139],v17 offset:4096
 buffer_load_dwordx4 v32,s[8:11],s41 offen offset:0 lds
 v_mfma_f32_16x16x32_bf16 v[236:239],a[108:111],a[168:171],v[236:239]
 v_mfma_f32_16x16x32_bf16 v[236:239],a[124:127],a[172:175],v[236:239]
 ds_read_b64_tr_b16 a[140:141],v17 offset:8192
 v_mfma_f32_16x16x32_bf16 v[232:235],a[120:123],a[172:175],v[232:235]
 ds_read_b64_tr_b16 a[142:143],v17 offset:12288
 v_mfma_f32_16x16x32_bf16 v[232:235],a[104:107],a[168:171],v[232:235]
 v_mfma_f32_16x16x32_bf16 v[204:207],a[100:103],a[168:171],v[204:207]
 ds_read_b64_tr_b16 a[144:145],v18 offset:0
 buffer_load_dwordx4 a[76:79],v1,s[60:63],s59 offen offset:1024 sc1
 v_mfma_f32_16x16x32_bf16 v[204:207],a[116:119],a[172:175],v[204:207]
 ds_read_b64_tr_b16 a[146:147],v18 offset:4096
 v_mfma_f32_16x16x32_bf16 v[200:203],a[112:115],a[172:175],v[200:203]
 v_mfma_f32_16x16x32_bf16 v[200:203],a[96:99],a[168:171],v[200:203]
 ds_read_b64_tr_b16 a[148:149],v18 offset:8192
 v_mfma_f32_16x16x32_bf16 v[208:211],a[96:99],a[176:179],v[208:211]
 ds_read_b64_tr_b16 a[150:151],v18 offset:12288
 v_mfma_f32_16x16x32_bf16 v[208:211],a[112:115],a[180:183],v[208:211]
 buffer_load_dwordx4 a[88:91],v1,s[60:63],s59 offen offset:2048 sc1
 v_mfma_f32_16x16x32_bf16 v[212:215],a[116:119],a[180:183],v[212:215]
 ds_read_b64_tr_b16 a[152:153],v19 offset:0
 v_mfma_f32_16x16x32_bf16 v[212:215],a[100:103],a[176:179],v[212:215]
 ds_read_b64_tr_b16 a[154:155],v19 offset:4096
 v_mfma_f32_16x16x32_bf16 v[240:243],a[104:107],a[176:179],v[240:243]
 v_mfma_f32_16x16x32_bf16 v[240:243],a[120:123],a[180:183],v[240:243]
 ds_read_b64_tr_b16 a[156:157],v19 offset:8192
 v_mfma_f32_16x16x32_bf16 v[244:247],a[124:127],a[180:183],v[244:247]
 ds_read_b64_tr_b16 a[158:159],v19 offset:12288
 buffer_load_dwordx4 v33,s[8:11],s41 offen offset:1024 lds
 v_mfma_f32_16x16x32_bf16 v[244:247],a[108:111],a[176:179],v[244:247]
 v_mfma_f32_16x16x32_bf16 v[252:255],a[108:111],a[184:187],v[252:255]
 v_mfma_f32_16x16x32_bf16 v[252:255],a[124:127],a[188:191],v[252:255]
 v_mfma_f32_16x16x32_bf16 v[248:251],a[120:123],a[188:191],v[248:251]
 v_mfma_f32_16x16x32_bf16 v[248:251],a[104:107],a[184:187],v[248:251]
 buffer_load_dwordx4 a[92:95],v1,s[60:63],s59 offen offset:3072 sc1
 v_mfma_f32_16x16x32_bf16 v[220:223],a[100:103],a[184:187],v[220:223]
 s_cmp_ge_u32 s44,1
 s_cbranch_scc1 L_hook_mlp2
L_hook_mlp2_ret:
 v_mfma_f32_16x16x32_bf16 v[220:223],a[116:119],a[188:191],v[220:223]
 v_mfma_f32_16x16x32_bf16 v[216:219],a[112:115],a[188:191],v[216:219]
 v_mfma_f32_16x16x32_bf16 v[216:219],a[96:99],a[184:187],v[216:219]
 s_waitcnt vmcnt(25) lgkmcnt(0)
 v_mfma_f32_16x16x32_bf16 v[128:131],a[0:3],a[128:131],v[128:131]
 ds_read_b64_tr_b16 a[160:161],v20 offset:0
 v_mfma_f32_16x16x32_bf16 v[128:131],a[16:19],a[132:135],v[128:131]
 s_add_u32 s40,s40,8192
 ds_read_b64_tr_b16 a[162:163],v20 offset:4096
 v_mfma_f32_16x16x32_bf16 v[132:135],a[20:23],a[132:135],v[132:135]
 buffer_load_dwordx4 a[96:99],v1,s[60:63],s40 offen offset:0 sc1
 v_mfma_f32_16x16x32_bf16 v[132:135],a[4:7],a[128:131],v[132:135]
 ds_read_b64_tr_b16 a[164:165],v20 offset:8192
 v_mfma_f32_16x16x32_bf16 v[136:139],a[8:11],a[128:131],v[136:139]
 ds_read_b64_tr_b16 a[166:167],v20 offset:12288
 v_mfma_f32_16x16x32_bf16 v[136:139],a[24:27],a[132:135],v[136:139]
 v_mfma_f32_16x16x32_bf16 v[140:143],a[28:31],a[132:135],v[140:143]
 ds_read_b64_tr_b16 a[168:169],v21 offset:0
 v_mfma_f32_16x16x32_bf16 v[140:143],a[12:15],a[128:131],v[140:143]
 ds_read_b64_tr_b16 a[170:171],v21 offset:4096
 buffer_load_dwordx4 v34,s[8:11],s41 offen offset:2048 lds
 v_mfma_f32_16x16x32_bf16 v[156:159],a[12:15],a[136:139],v[156:159]
 v_mfma_f32_16x16x32_bf16 v[156:159],a[28:31],a[140:143],v[156:159]
 ds_read_b64_tr_b16 a[172:173],v21 offset:8192
 v_mfma_f32_16x16x32_bf16 v[152:155],a[24:27],a[140:143],v[152:155]
 ds_read_b64_tr_b16 a[174:175],v21 offset:12288
 v_mfma_f32_16x16x32_bf16 v[152:155],a[8:11],a[136:139],v[152:155]
 v_mfma_f32_16x16x32_bf16 v[148:151],a[4:7],a[136:139],v[148:151]
 ds_read_b64_tr_b16 a[176:177],v22 offset:0
 buffer_load_dwordx4 a[100:103],v1,s[60:63],s40 offen offset:1024 sc1
 v_mfma_f32_16x16x32_bf16 v[148:151],a[20:23],a[140:143],v[148:151]
 ds_read_b64_tr_b16 a[178:179],v22 offset:4096
 v_mfma_f32_16x16x32_bf16 v[144:147],a[16:19],a[140:143],v[144:147]
 v_mfma_f32_16x16x32_bf16 v[144:147],a[0:3],a[136:139],v[144:147]
 ds_read_b64_tr_b16 a[180:181],v22 offset:8192
 v_mfma_f32_16x16x32_bf16 v[160:163],a[0:3],a[144:147],v[160:163]
 ds_read_b64_tr_b16 a[182:183],v22 offset:12288
 v_mfma_f32_16x16x32_bf16 v[160:163],a[16:19],a[148:151],v[160:163]
 buffer_load_dwordx4 a[112:115],v1,s[60:63],s40 offen offset:2048 sc1
 v_mfma_f32_16x16x32_bf16 v[164:167],a[20:23],a[148:151],v[164:167]
 ds_read_b64_tr_b16 a[184:185],v23 offset:0
 v_mfma_f32_16x16x32_bf16 v[164:167],a[4:7],a[144:147],v[164:167]
 ds_read_b64_tr_b16 a[186:187],v23 offset:4096
 v_mfma_f32_16x16x32_bf16 v[168:171],a[8:11],a[144:147],v[168:171]
 v_mfma_f32_16x16x32_bf16 v[168:171],a[24:27],a[148:151],v[168:171]
 ds_read_b64_tr_b16 a[188:189],v23 offset:8192
 v_mfma_f32_16x16x32_bf16 v[172:175],a[28:31],a[148:151],v[172:175]
 ds_read_b64_tr_b16 a[190:191],v23 offset:12288
 buffer_load_dwordx4 v35,s[8:11],s41 offen offset:3072 lds
 v_mfma_f32_16x16x32_bf16 v[172:175],a[12:15],a[144:147],v[172:175]
 v_mfma_f32_16x16x32_bf16 v[188:191],a[12:15],a[152:155],v[188:191]
 v_mfma_f32_16x16x32_bf16 v[188:191],a[28:31],a[156:159],v[188:191]
 v_mfma_f32_16x16x32_bf16 v[184:187],a[24:27],a[156:159],v[184:187]
 v_mfma_f32_16x16x32_bf16 v[184:187],a[8:11],a[152:155],v[184:187]
 buffer_load_dwordx4 a[116:119],v1,s[60:63],s40 offen offset:3072 sc1
 v_mfma_f32_16x16x32_bf16 v[180:183],a[4:7],a[152:155],v[180:183]
 v_mfma_f32_16x16x32_bf16 v[180:183],a[20:23],a[156:159],v[180:183]
 v_mfma_f32_16x16x32_bf16 v[176:179],a[16:19],a[156:159],v[176:179]
 v_mfma_f32_16x16x32_bf16 v[176:179],a[0:3],a[152:155],v[176:179]
 s_waitcnt vmcnt(25) lgkmcnt(0)
 s_barrier
 v_mfma_f32_16x16x32_bf16 v[192:195],a[0:3],a[160:163],v[192:195]
 ds_read_b64_tr_b16 a[128:129],v24 offset:0
 v_mfma_f32_16x16x32_bf16 v[192:195],a[16:19],a[164:167],v[192:195]
 s_add_u32 s59,s40,229376
 ds_read_b64_tr_b16 a[130:131],v24 offset:4096
 v_mfma_f32_16x16x32_bf16 v[196:199],a[20:23],a[164:167],v[196:199]
 buffer_load_dwordx4 a[104:107],v1,s[60:63],s59 offen offset:0 sc1
 v_mfma_f32_16x16x32_bf16 v[196:199],a[4:7],a[160:163],v[196:199]
 ds_read_b64_tr_b16 a[132:133],v24 offset:8192
 v_mfma_f32_16x16x32_bf16 v[224:227],a[8:11],a[160:163],v[224:227]
 ds_read_b64_tr_b16 a[134:135],v24 offset:12288
 v_mfma_f32_16x16x32_bf16 v[224:227],a[24:27],a[164:167],v[224:227]
 s_add_u32 m0,s3,0
 v_mfma_f32_16x16x32_bf16 v[228:231],a[28:31],a[164:167],v[228:231]
 s_add_u32 s41,s41,524288
 ds_read_b64_tr_b16 a[136:137],v25 offset:0
 v_mfma_f32_16x16x32_bf16 v[228:231],a[12:15],a[160:163],v[228:231]
 ds_read_b64_tr_b16 a[138:139],v25 offset:4096
 buffer_load_dwordx4 v32,s[8:11],s41 offen offset:0 lds
 v_mfma_f32_16x16x32_bf16 v[236:239],a[12:15],a[168:171],v[236:239]
 v_mfma_f32_16x16x32_bf16 v[236:239],a[28:31],a[172:175],v[236:239]
 ds_read_b64_tr_b16 a[140:141],v25 offset:8192
 v_mfma_f32_16x16x32_bf16 v[232:235],a[24:27],a[172:175],v[232:235]
 ds_read_b64_tr_b16 a[142:143],v25 offset:12288
 v_mfma_f32_16x16x32_bf16 v[232:235],a[8:11],a[168:171],v[232:235]
 v_mfma_f32_16x16x32_bf16 v[204:207],a[4:7],a[168:171],v[204:207]
 ds_read_b64_tr_b16 a[144:145],v26 offset:0
 buffer_load_dwordx4 a[108:111],v1,s[60:63],s59 offen offset:1024 sc1
 v_mfma_f32_16x16x32_bf16 v[204:207],a[20:23],a[172:175],v[204:207]
 ds_read_b64_tr_b16 a[146:147],v26 offset:4096
 v_mfma_f32_16x16x32_bf16 v[200:203],a[16:19],a[172:175],v[200:203]
 v_mfma_f32_16x16x32_bf16 v[200:203],a[0:3],a[168:171],v[200:203]
 ds_read_b64_tr_b16 a[148:149],v26 offset:8192
 v_mfma_f32_16x16x32_bf16 v[208:211],a[0:3],a[176:179],v[208:211]
 ds_read_b64_tr_b16 a[150:151],v26 offset:12288
 v_mfma_f32_16x16x32_bf16 v[208:211],a[16:19],a[180:183],v[208:211]
 buffer_load_dwordx4 a[120:123],v1,s[60:63],s59 offen offset:2048 sc1
 v_mfma_f32_16x16x32_bf16 v[212:215],a[20:23],a[180:183],v[212:215]
 ds_read_b64_tr_b16 a[152:153],v27 offset:0
 v_mfma_f32_16x16x32_bf16 v[212:215],a[4:7],a[176:179],v[212:215]
 ds_read_b64_tr_b16 a[154:155],v27 offset:4096
 v_mfma_f32_16x16x32_bf16 v[240:243],a[8:11],a[176:179],v[240:243]
 v_mfma_f32_16x16x32_bf16 v[240:243],a[24:27],a[180:183],v[240:243]
 ds_read_b64_tr_b16 a[156:157],v27 offset:8192
 v_mfma_f32_16x16x32_bf16 v[244:247],a[28:31],a[180:183],v[244:247]
 ds_read_b64_tr_b16 a[158:159],v27 offset:12288
 buffer_load_dwordx4 v33,s[8:11],s41 offen offset:1024 lds
 v_mfma_f32_16x16x32_bf16 v[244:247],a[12:15],a[176:179],v[244:247]
 v_mfma_f32_16x16x32_bf16 v[252:255],a[12:15],a[184:187],v[252:255]
 v_mfma_f32_16x16x32_bf16 v[252:255],a[28:31],a[188:191],v[252:255]
 v_mfma_f32_16x16x32_bf16 v[248:251],a[24:27],a[188:191],v[248:251]
 v_mfma_f32_16x16x32_bf16 v[248:251],a[8:11],a[184:187],v[248:251]
 buffer_load_dwordx4 a[124:127],v1,s[60:63],s59 offen offset:3072 sc1
 v_mfma_f32_16x16x32_bf16 v[220:223],a[4:7],a[184:187],v[220:223]
 v_mfma_f32_16x16x32_bf16 v[220:223],a[20:23],a[188:191],v[220:223]
 v_mfma_f32_16x16x32_bf16 v[216:219],a[16:19],a[188:191],v[216:219]
 v_mfma_f32_16x16x32_bf16 v[216:219],a[0:3],a[184:187],v[216:219]
 s_waitcnt vmcnt(24) lgkmcnt(0)
 v_mfma_f32_16x16x32_bf16 v[128:131],a[32:35],a[128:131],v[128:131]
 ds_read_b64_tr_b16 a[160:161],v28 offset:0
 v_mfma_f32_16x16x32_bf16 v[128:131],a[48:51],a[132:135],v[128:131]
 s_add_u32 s40,s40,8192
 ds_read_b64_tr_b16 a[162:163],v28 offset:4096
 v_mfma_f32_16x16x32_bf16 v[132:135],a[52:55],a[132:135],v[132:135]
 buffer_load_dwordx4 a[0:3],v1,s[60:63],s40 offen offset:0 sc1
 v_mfma_f32_16x16x32_bf16 v[132:135],a[36:39],a[128:131],v[132:135]
 ds_read_b64_tr_b16 a[164:165],v28 offset:8192
 v_mfma_f32_16x16x32_bf16 v[136:139],a[40:43],a[128:131],v[136:139]
 ds_read_b64_tr_b16 a[166:167],v28 offset:12288
 v_mfma_f32_16x16x32_bf16 v[136:139],a[56:59],a[132:135],v[136:139]
 v_mfma_f32_16x16x32_bf16 v[140:143],a[60:63],a[132:135],v[140:143]
 ds_read_b64_tr_b16 a[168:169],v29 offset:0
 v_mfma_f32_16x16x32_bf16 v[140:143],a[44:47],a[128:131],v[140:143]
 ds_read_b64_tr_b16 a[170:171],v29 offset:4096
 buffer_load_dwordx4 v34,s[8:11],s41 offen offset:2048 lds
 v_mfma_f32_16x16x32_bf16 v[156:159],a[44:47],a[136:139],v[156:159]
 v_mfma_f32_16x16x32_bf16 v[156:159],a[60:63],a[140:143],v[156:159]
 ds_read_b64_tr_b16 a[172:173],v29 offset:8192
 v_mfma_f32_16x16x32_bf16 v[152:155],a[56:59],a[140:143],v[152:155]
 ds_read_b64_tr_b16 a[174:175],v29 offset:12288
 v_mfma_f32_16x16x32_bf16 v[152:155],a[40:43],a[136:139],v[152:155]
 v_mfma_f32_16x16x32_bf16 v[148:151],a[36:39],a[136:139],v[148:151]
 ds_read_b64_tr_b16 a[176:177],v30 offset:0
 buffer_load_dwordx4 a[4:7],v1,s[60:63],s40 offen offset:1024 sc1
 v_mfma_f32_16x16x32_bf16 v[148:151],a[52:55],a[140:143],v[148:151]
 ds_read_b64_tr_b16 a[178:179],v30 offset:4096
 v_mfma_f32_16x16x32_bf16 v[144:147],a[48:51],a[140:143],v[144:147]
 v_mfma_f32_16x16x32_bf16 v[144:147],a[32:35],a[136:139],v[144:147]
 ds_read_b64_tr_b16 a[180:181],v30 offset:8192
 v_mfma_f32_16x16x32_bf16 v[160:163],a[32:35],a[144:147],v[160:163]
 ds_read_b64_tr_b16 a[182:183],v30 offset:12288
 v_mfma_f32_16x16x32_bf16 v[160:163],a[48:51],a[148:151],v[160:163]
 buffer_load_dwordx4 a[16:19],v1,s[60:63],s40 offen offset:2048 sc1
 v_mfma_f32_16x16x32_bf16 v[164:167],a[52:55],a[148:151],v[164:167]
 ds_read_b64_tr_b16 a[184:185],v31 offset:0
 v_mfma_f32_16x16x32_bf16 v[164:167],a[36:39],a[144:147],v[164:167]
 ds_read_b64_tr_b16 a[186:187],v31 offset:4096
 v_mfma_f32_16x16x32_bf16 v[168:171],a[40:43],a[144:147],v[168:171]
 v_mfma_f32_16x16x32_bf16 v[168:171],a[56:59],a[148:151],v[168:171]
 ds_read_b64_tr_b16 a[188:189],v31 offset:8192
 v_mfma_f32_16x16x32_bf16 v[172:175],a[60:63],a[148:151],v[172:175]
 ds_read_b64_tr_b16 a[190:191],v31 offset:12288
 buffer_load_dwordx4 v35,s[8:11],s41 offen offset:3072 lds
 v_mfma_f32_16x16x32_bf16 v[172:175],a[44:47],a[144:147],v[172:175]
 v_mfma_f32_16x16x32_bf16 v[188:191],a[44:47],a[152:155],v[188:191]
 v_mfma_f32_16x16x32_bf16 v[188:191],a[60:63],a[156:159],v[188:191]
 v_mfma_f32_16x16x32_bf16 v[184:187],a[56:59],a[156:159],v[184:187]
 v_mfma_f32_16x16x32_bf16 v[184:187],a[40:43],a[152:155],v[184:187]
 buffer_load_dwordx4 a[20:23],v1,s[60:63],s40 offen offset:3072 sc1
 v_mfma_f32_16x16x32_bf16 v[180:183],a[36:39],a[152:155],v[180:183]
 v_mfma_f32_16x16x32_bf16 v[180:183],a[52:55],a[156:159],v[180:183]
 v_mfma_f32_16x16x32_bf16 v[176:179],a[48:51],a[156:159],v[176:179]
 v_mfma_f32_16x16x32_bf16 v[176:179],a[32:35],a[152:155],v[176:179]
 s_waitcnt vmcnt(25) lgkmcnt(0)
 s_barrier
 v_mfma_f32_16x16x32_bf16 v[192:195],a[32:35],a[160:163],v[192:195]
 ds_read_b64_tr_b16 a[128:129],v16 offset:16384
 v_mfma_f32_16x16x32_bf16 v[192:195],a[48:51],a[164:167],v[192:195]
 s_add_u32 s59,s40,229376
 ds_read_b64_tr_b16 a[130:131],v16 offset:20480
 v_mfma_f32_16x16x32_bf16 v[196:199],a[52:55],a[164:167],v[196:199]
 buffer_load_dwordx4 a[8:11],v1,s[60:63],s59 offen offset:0 sc1
 v_mfma_f32_16x16x32_bf16 v[196:199],a[36:39],a[160:163],v[196:199]
 ds_read_b64_tr_b16 a[132:133],v16 offset:24576
 v_mfma_f32_16x16x32_bf16 v[224:227],a[40:43],a[160:163],v[224:227]
 ds_read_b64_tr_b16 a[134:135],v16 offset:28672
 v_mfma_f32_16x16x32_bf16 v[224:227],a[56:59],a[164:167],v[224:227]
 s_add_u32 m0,s3,65536
 v_mfma_f32_16x16x32_bf16 v[228:231],a[60:63],a[164:167],v[228:231]
 s_add_u32 s41,s41,524288
 ds_read_b64_tr_b16 a[136:137],v17 offset:16384
 v_mfma_f32_16x16x32_bf16 v[228:231],a[44:47],a[160:163],v[228:231]
 ds_read_b64_tr_b16 a[138:139],v17 offset:20480
 buffer_load_dwordx4 v32,s[8:11],s41 offen offset:0 lds
 v_mfma_f32_16x16x32_bf16 v[236:239],a[44:47],a[168:171],v[236:239]
 v_mfma_f32_16x16x32_bf16 v[236:239],a[60:63],a[172:175],v[236:239]
 ds_read_b64_tr_b16 a[140:141],v17 offset:24576
 v_mfma_f32_16x16x32_bf16 v[232:235],a[56:59],a[172:175],v[232:235]
 ds_read_b64_tr_b16 a[142:143],v17 offset:28672
 v_mfma_f32_16x16x32_bf16 v[232:235],a[40:43],a[168:171],v[232:235]
 v_mfma_f32_16x16x32_bf16 v[204:207],a[36:39],a[168:171],v[204:207]
 ds_read_b64_tr_b16 a[144:145],v18 offset:16384
 buffer_load_dwordx4 a[12:15],v1,s[60:63],s59 offen offset:1024 sc1
 v_mfma_f32_16x16x32_bf16 v[204:207],a[52:55],a[172:175],v[204:207]
 ds_read_b64_tr_b16 a[146:147],v18 offset:20480
 v_mfma_f32_16x16x32_bf16 v[200:203],a[48:51],a[172:175],v[200:203]
 v_mfma_f32_16x16x32_bf16 v[200:203],a[32:35],a[168:171],v[200:203]
 ds_read_b64_tr_b16 a[148:149],v18 offset:24576
 v_mfma_f32_16x16x32_bf16 v[208:211],a[32:35],a[176:179],v[208:211]
 ds_read_b64_tr_b16 a[150:151],v18 offset:28672
 v_mfma_f32_16x16x32_bf16 v[208:211],a[48:51],a[180:183],v[208:211]
 buffer_load_dwordx4 a[24:27],v1,s[60:63],s59 offen offset:2048 sc1
 v_mfma_f32_16x16x32_bf16 v[212:215],a[52:55],a[180:183],v[212:215]
 ds_read_b64_tr_b16 a[152:153],v19 offset:16384
 v_mfma_f32_16x16x32_bf16 v[212:215],a[36:39],a[176:179],v[212:215]
 ds_read_b64_tr_b16 a[154:155],v19 offset:20480
 v_mfma_f32_16x16x32_bf16 v[240:243],a[40:43],a[176:179],v[240:243]
 v_mfma_f32_16x16x32_bf16 v[240:243],a[56:59],a[180:183],v[240:243]
 ds_read_b64_tr_b16 a[156:157],v19 offset:24576
 v_mfma_f32_16x16x32_bf16 v[244:247],a[60:63],a[180:183],v[244:247]
 ds_read_b64_tr_b16 a[158:159],v19 offset:28672
 buffer_load_dwordx4 v33,s[8:11],s41 offen offset:1024 lds
 v_mfma_f32_16x16x32_bf16 v[244:247],a[44:47],a[176:179],v[244:247]
 v_mfma_f32_16x16x32_bf16 v[252:255],a[44:47],a[184:187],v[252:255]
 v_mfma_f32_16x16x32_bf16 v[252:255],a[60:63],a[188:191],v[252:255]
 v_mfma_f32_16x16x32_bf16 v[248:251],a[56:59],a[188:191],v[248:251]
 v_mfma_f32_16x16x32_bf16 v[248:251],a[40:43],a[184:187],v[248:251]
 buffer_load_dwordx4 a[28:31],v1,s[60:63],s59 offen offset:3072 sc1
 v_mfma_f32_16x16x32_bf16 v[220:223],a[36:39],a[184:187],v[220:223]
 s_sub_u32 s44,s44,1
 v_mfma_f32_16x16x32_bf16 v[220:223],a[52:55],a[188:191],v[220:223]
 s_cmp_lg_u32 s44,0
 v_mfma_f32_16x16x32_bf16 v[216:219],a[48:51],a[188:191],v[216:219]
 v_mfma_f32_16x16x32_bf16 v[216:219],a[32:35],a[184:187],v[216:219]
 s_waitcnt vmcnt(24) lgkmcnt(0)
 s_cbranch_scc1 L_mlp2_loop
 s_mov_b32 s77,s40
 s_mov_b32 s58,s41
 v_mfma_f32_16x16x32_bf16 v[128:131],a[64:67],a[128:131],v[128:131]
 ds_read_b64_tr_b16 a[160:161],v20 offset:16384
 v_mfma_f32_16x16x32_bf16 v[128:131],a[80:83],a[132:135],v[128:131]
 ds_read_b64_tr_b16 a[162:163],v20 offset:20480
 v_mfma_f32_16x16x32_bf16 v[132:135],a[84:87],a[132:135],v[132:135]
 buffer_load_dwordx4 v34,s[8:11],s41 offen offset:2048 lds
 v_mfma_f32_16x16x32_bf16 v[132:135],a[68:71],a[128:131],v[132:135]
 ds_read_b64_tr_b16 a[164:165],v20 offset:24576
 v_mfma_f32_16x16x32_bf16 v[136:139],a[72:75],a[128:131],v[136:139]
 ds_read_b64_tr_b16 a[166:167],v20 offset:28672
 v_mfma_f32_16x16x32_bf16 v[136:139],a[88:91],a[132:135],v[136:139]
 v_mfma_f32_16x16x32_bf16 v[140:143],a[92:95],a[132:135],v[140:143]
 ds_read_b64_tr_b16 a[168:169],v21 offset:16384
 buffer_load_dwordx4 v35,s[8:11],s41 offen offset:3072 lds
 v_mfma_f32_16x16x32_bf16 v[140:143],a[76:79],a[128:131],v[140:143]
 ds_read_b64_tr_b16 a[170:171],v21 offset:20480
 v_mfma_f32_16x16x32_bf16 v[156:159],a[76:79],a[136:139],v[156:159]
 v_mfma_f32_16x16x32_bf16 v[156:159],a[92:95],a[140:143],v[156:159]
 s_add_u32 s40,s77,8192
 ds_read_b64_tr_b16 a[172:173],v21 offset:24576
 v_mfma_f32_16x16x32_bf16 v[152:155],a[88:91],a[140:143],v[152:155]
 ds_read_b64_tr_b16 a[174:175],v21 offset:28672
 buffer_load_dwordx4 a[32:35],v1,s[60:63],s40 offen offset:0 sc1
 v_mfma_f32_16x16x32_bf16 v[152:155],a[72:75],a[136:139],v[152:155]
 v_mfma_f32_16x16x32_bf16 v[148:151],a[68:71],a[136:139],v[148:151]
 ds_read_b64_tr_b16 a[176:177],v22 offset:16384
 v_mfma_f32_16x16x32_bf16 v[148:151],a[84:87],a[140:143],v[148:151]
 ds_read_b64_tr_b16 a[178:179],v22 offset:20480
 v_mfma_f32_16x16x32_bf16 v[144:147],a[80:83],a[140:143],v[144:147]
 buffer_load_dwordx4 a[36:39],v1,s[60:63],s40 offen offset:1024 sc1
 v_mfma_f32_16x16x32_bf16 v[144:147],a[64:67],a[136:139],v[144:147]
 ds_read_b64_tr_b16 a[180:181],v22 offset:24576
 v_mfma_f32_16x16x32_bf16 v[160:163],a[64:67],a[144:147],v[160:163]
 ds_read_b64_tr_b16 a[182:183],v22 offset:28672
 v_mfma_f32_16x16x32_bf16 v[160:163],a[80:83],a[148:151],v[160:163]
 v_mfma_f32_16x16x32_bf16 v[164:167],a[84:87],a[148:151],v[164:167]
 ds_read_b64_tr_b16 a[184:185],v23 offset:16384
 v_mfma_f32_16x16x32_bf16 v[164:167],a[68:71],a[144:147],v[164:167]
 ds_read_b64_tr_b16 a[186:187],v23 offset:20480
 buffer_load_dwordx4 a[48:51],v1,s[60:63],s40 offen offset:2048 sc1
 v_mfma_f32_16x16x32_bf16 v[168:171],a[72:75],a[144:147],v[168:171]
 v_mfma_f32_16x16x32_bf16 v[168:171],a[88:91],a[148:151],v[168:171]
 ds_read_b64_tr_b16 a[188:189],v23 offset:24576
 v_mfma_f32_16x16x32_bf16 v[172:175],a[92:95],a[148:151],v[172:175]
 ds_read_b64_tr_b16 a[190:191],v23 offset:28672
 v_mfma_f32_16x16x32_bf16 v[172:175],a[76:79],a[144:147],v[172:175]
 buffer_load_dwordx4 a[52:55],v1,s[60:63],s40 offen offset:3072 sc1
 v_mfma_f32_16x16x32_bf16 v[188:191],a[76:79],a[152:155],v[188:191]
 v_mfma_f32_16x16x32_bf16 v[188:191],a[92:95],a[156:159],v[188:191]
 v_mfma_f32_16x16x32_bf16 v[184:187],a[88:91],a[156:159],v[184:187]
 s_add_u32 s59,s77,237568
 v_mfma_f32_16x16x32_bf16 v[184:187],a[72:75],a[152:155],v[184:187]
 buffer_load_dwordx4 a[40:43],v1,s[60:63],s59 offen offset:0 sc1
 v_mfma_f32_16x16x32_bf16 v[180:183],a[68:71],a[152:155],v[180:183]
 v_mfma_f32_16x16x32_bf16 v[180:183],a[84:87],a[156:159],v[180:183]
 v_mfma_f32_16x16x32_bf16 v[176:179],a[80:83],a[156:159],v[176:179]
 v_mfma_f32_16x16x32_bf16 v[176:179],a[64:67],a[152:155],v[176:179]
 s_waitcnt vmcnt(26) lgkmcnt(0)
 s_barrier
 v_mfma_f32_16x16x32_bf16 v[192:195],a[64:67],a[160:163],v[192:195]
 ds_read_b64_tr_b16 a[128:129],v24 offset:16384
 v_mfma_f32_16x16x32_bf16 v[192:195],a[80:83],a[164:167],v[192:195]
 ds_read_b64_tr_b16 a[130:131],v24 offset:20480
 v_mfma_f32_16x16x32_bf16 v[196:199],a[84:87],a[164:167],v[196:199]
 buffer_load_dwordx4 a[44:47],v1,s[60:63],s59 offen offset:1024 sc1
 v_mfma_f32_16x16x32_bf16 v[196:199],a[68:71],a[160:163],v[196:199]
 ds_read_b64_tr_b16 a[132:133],v24 offset:24576
 v_mfma_f32_16x16x32_bf16 v[224:227],a[72:75],a[160:163],v[224:227]
 ds_read_b64_tr_b16 a[134:135],v24 offset:28672
 v_mfma_f32_16x16x32_bf16 v[224:227],a[88:91],a[164:167],v[224:227]
 v_mfma_f32_16x16x32_bf16 v[228:231],a[92:95],a[164:167],v[228:231]
 ds_read_b64_tr_b16 a[136:137],v25 offset:16384
 buffer_load_dwordx4 a[56:59],v1,s[60:63],s59 offen offset:2048 sc1
 v_mfma_f32_16x16x32_bf16 v[228:231],a[76:79],a[160:163],v[228:231]
 ds_read_b64_tr_b16 a[138:139],v25 offset:20480
 v_mfma_f32_16x16x32_bf16 v[236:239],a[76:79],a[168:171],v[236:239]
 v_mfma_f32_16x16x32_bf16 v[236:239],a[92:95],a[172:175],v[236:239]
 ds_read_b64_tr_b16 a[140:141],v25 offset:24576
 v_mfma_f32_16x16x32_bf16 v[232:235],a[88:91],a[172:175],v[232:235]
 ds_read_b64_tr_b16 a[142:143],v25 offset:28672
 buffer_load_dwordx4 a[60:63],v1,s[60:63],s59 offen offset:3072 sc1
 v_mfma_f32_16x16x32_bf16 v[232:235],a[72:75],a[168:171],v[232:235]
 v_mfma_f32_16x16x32_bf16 v[204:207],a[68:71],a[168:171],v[204:207]
 s_add_u32 m0,s3,16384
 ds_read_b64_tr_b16 a[144:145],v26 offset:16384
 v_mfma_f32_16x16x32_bf16 v[204:207],a[84:87],a[172:175],v[204:207]
 s_add_u32 s41,s58,524288
 ds_read_b64_tr_b16 a[146:147],v26 offset:20480
 v_mfma_f32_16x16x32_bf16 v[200:203],a[80:83],a[172:175],v[200:203]
 buffer_load_dwordx4 v32,s[8:11],s41 offen offset:0 lds
 v_mfma_f32_16x16x32_bf16 v[200:203],a[64:67],a[168:171],v[200:203]
 ds_read_b64_tr_b16 a[148:149],v26 offset:24576
 v_mfma_f32_16x16x32_bf16 v[208:211],a[64:67],a[176:179],v[208:211]
 ds_read_b64_tr_b16 a[150:151],v26 offset:28672
 v_mfma_f32_16x16x32_bf16 v[208:211],a[80:83],a[180:183],v[208:211]
 v_mfma_f32_16x16x32_bf16 v[212:215],a[84:87],a[180:183],v[212:215]
 ds_read_b64_tr_b16 a[152:153],v27 offset:16384
 v_mfma_f32_16x16x32_bf16 v[212:215],a[68:71],a[176:179],v[212:215]
 ds_read_b64_tr_b16 a[154:155],v27 offset:20480
 buffer_load_dwordx4 v33,s[8:11],s41 offen offset:1024 lds
 v_mfma_f32_16x16x32_bf16 v[240:243],a[72:75],a[176:179],v[240:243]
 v_mfma_f32_16x16x32_bf16 v[240:243],a[88:91],a[180:183],v[240:243]
 ds_read_b64_tr_b16 a[156:157],v27 offset:24576
 v_mfma_f32_16x16x32_bf16 v[244:247],a[92:95],a[180:183],v[244:247]
 ds_read_b64_tr_b16 a[158:159],v27 offset:28672
 v_mfma_f32_16x16x32_bf16 v[244:247],a[76:79],a[176:179],v[244:247]
 buffer_load_dwordx4 v34,s[8:11],s41 offen offset:2048 lds
 v_mfma_f32_16x16x32_bf16 v[252:255],a[76:79],a[184:187],v[252:255]
 v_mfma_f32_16x16x32_bf16 v[252:255],a[92:95],a[188:191],v[252:255]
 v_mfma_f32_16x16x32_bf16 v[248:251],a[88:91],a[188:191],v[248:251]
 v_mfma_f32_16x16x32_bf16 v[248:251],a[72:75],a[184:187],v[248:251]
 buffer_load_dwordx4 v35,s[8:11],s41 offen offset:3072 lds
 v_mfma_f32_16x16x32_bf16 v[220:223],a[68:71],a[184:187],v[220:223]
 v_mfma_f32_16x16x32_bf16 v[220:223],a[84:87],a[188:191],v[220:223]
 v_mfma_f32_16x16x32_bf16 v[216:219],a[80:83],a[188:191],v[216:219]
 v_mfma_f32_16x16x32_bf16 v[216:219],a[64:67],a[184:187],v[216:219]
 s_waitcnt vmcnt(26) lgkmcnt(0)
 v_mfma_f32_16x16x32_bf16 v[128:131],a[96:99],a[128:131],v[128:131]
 ds_read_b64_tr_b16 a[160:161],v28 offset:16384
 v_mfma_f32_16x16x32_bf16 v[128:131],a[112:115],a[132:135],v[128:131]
 s_add_u32 s40,s77,16384
 ds_read_b64_tr_b16 a[162:163],v28 offset:20480
 v_mfma_f32_16x16x32_bf16 v[132:135],a[116:119],a[132:135],v[132:135]
 buffer_load_dwordx4 a[64:67],v1,s[60:63],s40 offen offset:0 sc1
 v_mfma_f32_16x16x32_bf16 v[132:135],a[100:103],a[128:131],v[132:135]
 ds_read_b64_tr_b16 a[164:165],v28 offset:24576
 v_mfma_f32_16x16x32_bf16 v[136:139],a[104:107],a[128:131],v[136:139]
 ds_read_b64_tr_b16 a[166:167],v28 offset:28672
 v_mfma_f32_16x16x32_bf16 v[136:139],a[120:123],a[132:135],v[136:139]
 v_mfma_f32_16x16x32_bf16 v[140:143],a[124:127],a[132:135],v[140:143]
 ds_read_b64_tr_b16 a[168:169],v29 offset:16384
 buffer_load_dwordx4 a[68:71],v1,s[60:63],s40 offen offset:1024 sc1
 v_mfma_f32_16x16x32_bf16 v[140:143],a[108:111],a[128:131],v[140:143]
 ds_read_b64_tr_b16 a[170:171],v29 offset:20480
 v_mfma_f32_16x16x32_bf16 v[156:159],a[108:111],a[136:139],v[156:159]
 v_mfma_f32_16x16x32_bf16 v[156:159],a[124:127],a[140:143],v[156:159]
 ds_read_b64_tr_b16 a[172:173],v29 offset:24576
 v_mfma_f32_16x16x32_bf16 v[152:155],a[120:123],a[140:143],v[152:155]
 ds_read_b64_tr_b16 a[174:175],v29 offset:28672
 buffer_load_dwordx4 a[80:83],v1,s[60:63],s40 offen offset:2048 sc1
 v_mfma_f32_16x16x32_bf16 v[152:155],a[104:107],a[136:139],v[152:155]
 v_mfma_f32_16x16x32_bf16 v[148:151],a[100:103],a[136:139],v[148:151]
 ds_read_b64_tr_b16 a[176:177],v30 offset:16384
 v_mfma_f32_16x16x32_bf16 v[148:151],a[116:119],a[140:143],v[148:151]
 ds_read_b64_tr_b16 a[178:179],v30 offset:20480
 v_mfma_f32_16x16x32_bf16 v[144:147],a[112:115],a[140:143],v[144:147]
 buffer_load_dwordx4 a[84:87],v1,s[60:63],s40 offen offset:3072 sc1
 v_mfma_f32_16x16x32_bf16 v[144:147],a[96:99],a[136:139],v[144:147]
 ds_read_b64_tr_b16 a[180:181],v30 offset:24576
 v_mfma_f32_16x16x32_bf16 v[160:163],a[96:99],a[144:147],v[160:163]
 ds_read_b64_tr_b16 a[182:183],v30 offset:28672
 v_mfma_f32_16x16x32_bf16 v[160:163],a[112:115],a[148:151],v[160:163]
 v_mfma_f32_16x16x32_bf16 v[164:167],a[116:119],a[148:151],v[164:167]
 s_add_u32 s59,s77,245760
 ds_read_b64_tr_b16 a[184:185],v31 offset:16384
 v_mfma_f32_16x16x32_bf16 v[164:167],a[100:103],a[144:147],v[164:167]
 ds_read_b64_tr_b16 a[186:187],v31 offset:20480
 buffer_load_dwordx4 a[72:75],v1,s[60:63],s59 offen offset:0 sc1
 v_mfma_f32_16x16x32_bf16 v[168:171],a[104:107],a[144:147],v[168:171]
 v_mfma_f32_16x16x32_bf16 v[168:171],a[120:123],a[148:151],v[168:171]
 ds_read_b64_tr_b16 a[188:189],v31 offset:24576
 v_mfma_f32_16x16x32_bf16 v[172:175],a[124:127],a[148:151],v[172:175]
 ds_read_b64_tr_b16 a[190:191],v31 offset:28672
 v_mfma_f32_16x16x32_bf16 v[172:175],a[108:111],a[144:147],v[172:175]
 buffer_load_dwordx4 a[76:79],v1,s[60:63],s59 offen offset:1024 sc1
 v_mfma_f32_16x16x32_bf16 v[188:191],a[108:111],a[152:155],v[188:191]
L_stub_m_2:
 s_cbranch_execz L_stub_m_6
 v_mfma_f32_16x16x32_bf16 v[188:191],a[124:127],a[156:159],v[188:191]
 v_mfma_f32_16x16x32_bf16 v[184:187],a[120:123],a[156:159],v[184:187]
 v_mfma_f32_16x16x32_bf16 v[184:187],a[104:107],a[152:155],v[184:187]
 buffer_load_dwordx4 a[88:91],v1,s[60:63],s59 offen offset:2048 sc1
 v_mfma_f32_16x16x32_bf16 v[180:183],a[100:103],a[152:155],v[180:183]
 v_mfma_f32_16x16x32_bf16 v[180:183],a[116:119],a[156:159],v[180:183]
 v_mfma_f32_16x16x32_bf16 v[176:179],a[112:115],a[156:159],v[176:179]
 v_mfma_f32_16x16x32_bf16 v[176:179],a[96:99],a[152:155],v[176:179]
 s_waitcnt vmcnt(28) lgkmcnt(0)
 s_barrier
 v_mfma_f32_16x16x32_bf16 v[192:195],a[96:99],a[160:163],v[192:195]
 ds_read_b64_tr_b16 a[128:129],v16 offset:0
 v_mfma_f32_16x16x32_bf16 v[192:195],a[112:115],a[164:167],v[192:195]
 ds_read_b64_tr_b16 a[130:131],v16 offset:4096
 v_mfma_f32_16x16x32_bf16 v[196:199],a[116:119],a[164:167],v[196:199]
 buffer_load_dwordx4 a[92:95],v1,s[60:63],s59 offen offset:3072 sc1
 v_mfma_f32_16x16x32_bf16 v[196:199],a[100:103],a[160:163],v[196:199]
 ds_read_b64_tr_b16 a[132:133],v16 offset:8192
 v_mfma_f32_16x16x32_bf16 v[224:227],a[104:107],a[160:163],v[224:227]
 s_add_u32 m0,s3,81920
 ds_read_b64_tr_b16 a[134:135],v16 offset:12288
 v_mfma_f32_16x16x32_bf16 v[224:227],a[120:123],a[164:167],v[224:227]
 s_add_u32 s41,s58,1048576
 v_mfma_f32_16x16x32_bf16 v[228:231],a[124:127],a[164:167],v[228:231]
 ds_read_b64_tr_b16 a[136:137],v17 offset:0
 buffer_load_dwordx4 v32,s[8:11],s41 offen offset:0 lds
 v_mfma_f32_16x16x32_bf16 v[228:231],a[108:111],a[160:163],v[228:231]
 ds_read_b64_tr_b16 a[138:139],v17 offset:4096
 v_mfma_f32_16x16x32_bf16 v[236:239],a[108:111],a[168:171],v[236:239]
 v_mfma_f32_16x16x32_bf16 v[236:239],a[124:127],a[172:175],v[236:239]
 ds_read_b64_tr_b16 a[140:141],v17 offset:8192
 v_mfma_f32_16x16x32_bf16 v[232:235],a[120:123],a[172:175],v[232:235]
 ds_read_b64_tr_b16 a[142:143],v17 offset:12288
 buffer_load_dwordx4 v33,s[8:11],s41 offen offset:1024 lds
 v_mfma_f32_16x16x32_bf16 v[232:235],a[104:107],a[168:171],v[232:235]
 v_mfma_f32_16x16x32_bf16 v[204:207],a[100:103],a[168:171],v[204:207]
 ds_read_b64_tr_b16 a[144:145],v18 offset:0
 v_mfma_f32_16x16x32_bf16 v[204:207],a[116:119],a[172:175],v[204:207]
 ds_read_b64_tr_b16 a[146:147],v18 offset:4096
 v_mfma_f32_16x16x32_bf16 v[200:203],a[112:115],a[172:175],v[200:203]
 buffer_load_dwordx4 v34,s[8:11],s41 offen offset:2048 lds
 v_mfma_f32_16x16x32_bf16 v[200:203],a[96:99],a[168:171],v[200:203]
 ds_read_b64_tr_b16 a[148:149],v18 offset:8192
 v_mfma_f32_16x16x32_bf16 v[208:211],a[96:99],a[176:179],v[208:211]
 ds_read_b64_tr_b16 a[150:151],v18 offset:12288
 v_mfma_f32_16x16x32_bf16 v[208:211],a[112:115],a[180:183],v[208:211]
 v_mfma_f32_16x16x32_bf16 v[212:215],a[116:119],a[180:183],v[212:215]
 ds_read_b64_tr_b16 a[152:153],v19 offset:0
 v_mfma_f32_16x16x32_bf16 v[212:215],a[100:103],a[176:179],v[212:215]
 ds_read_b64_tr_b16 a[154:155],v19 offset:4096
 buffer_load_dwordx4 v35,s[8:11],s41 offen offset:3072 lds
 v_mfma_f32_16x16x32_bf16 v[240:243],a[104:107],a[176:179],v[240:243]
 v_mfma_f32_16x16x32_bf16 v[240:243],a[120:123],a[180:183],v[240:243]
 s_add_u32 m0,s3,32768
 ds_read_b64_tr_b16 a[156:157],v19 offset:8192
 v_mfma_f32_16x16x32_bf16 v[244:247],a[124:127],a[180:183],v[244:247]
 s_add_u32 s41,s58,3670016
 ds_read_b64_tr_b16 a[158:159],v19 offset:12288
 v_mfma_f32_16x16x32_bf16 v[244:247],a[108:111],a[176:179],v[244:247]
 buffer_load_dwordx4 v32,s[8:11],s41 offen offset:0 lds
 v_mfma_f32_16x16x32_bf16 v[252:255],a[108:111],a[184:187],v[252:255]
 v_mfma_f32_16x16x32_bf16 v[252:255],a[124:127],a[188:191],v[252:255]
 v_mfma_f32_16x16x32_bf16 v[248:251],a[120:123],a[188:191],v[248:251]
 v_mfma_f32_16x16x32_bf16 v[248:251],a[104:107],a[184:187],v[248:251]
 buffer_load_dwordx4 v33,s[8:11],s41 offen offset:1024 lds
 v_mfma_f32_16x16x32_bf16 v[220:223],a[100:103],a[184:187],v[220:223]
 v_mfma_f32_16x16x32_bf16 v[220:223],a[116:119],a[188:191],v[220:223]
 v_mfma_f32_16x16x32_bf16 v[216:219],a[112:115],a[188:191],v[216:219]
 v_mfma_f32_16x16x32_bf16 v[216:219],a[96:99],a[184:187],v[216:219]
 s_waitcnt vmcnt(28) lgkmcnt(0)
 v_mfma_f32_16x16x32_bf16 v[128:131],a[0:3],a[128:131],v[128:131]
 ds_read_b64_tr_b16 a[160:161],v20 offset:0
 v_mfma_f32_16x16x32_bf16 v[128:131],a[16:19],a[132:135],v[128:131]
 ds_read_b64_tr_b16 a[162:163],v20 offset:4096
 v_mfma_f32_16x16x32_bf16 v[132:135],a[20:23],a[132:135],v[132:135]
 buffer_load_dwordx4 v34,s[8:11],s41 offen offset:2048 lds
 v_mfma_f32_16x16x32_bf16 v[132:135],a[4:7],a[128:131],v[132:135]
 ds_read_b64_tr_b16 a[164:165],v20 offset:8192
 v_mfma_f32_16x16x32_bf16 v[136:139],a[8:11],a[128:131],v[136:139]
 ds_read_b64_tr_b16 a[166:167],v20 offset:12288
 v_mfma_f32_16x16x32_bf16 v[136:139],a[24:27],a[132:135],v[136:139]
 v_mfma_f32_16x16x32_bf16 v[140:143],a[28:31],a[132:135],v[140:143]
 ds_read_b64_tr_b16 a[168:169],v21 offset:0
 buffer_load_dwordx4 v35,s[8:11],s41 offen offset:3072 lds
 v_mfma_f32_16x16x32_bf16 v[140:143],a[12:15],a[128:131],v[140:143]
 ds_read_b64_tr_b16 a[170:171],v21 offset:4096
 v_mfma_f32_16x16x32_bf16 v[156:159],a[12:15],a[136:139],v[156:159]
 v_mfma_f32_16x16x32_bf16 v[156:159],a[28:31],a[140:143],v[156:159]
 s_add_u32 s40,s77,24576
 ds_read_b64_tr_b16 a[172:173],v21 offset:8192
 v_mfma_f32_16x16x32_bf16 v[152:155],a[24:27],a[140:143],v[152:155]
 ds_read_b64_tr_b16 a[174:175],v21 offset:12288
 buffer_load_dwordx4 a[96:99],v1,s[60:63],s40 offen offset:0 sc1
 v_mfma_f32_16x16x32_bf16 v[152:155],a[8:11],a[136:139],v[152:155]
 v_mfma_f32_16x16x32_bf16 v[148:151],a[4:7],a[136:139],v[148:151]
 ds_read_b64_tr_b16 a[176:177],v22 offset:0
 v_mfma_f32_16x16x32_bf16 v[148:151],a[20:23],a[140:143],v[148:151]
 ds_read_b64_tr_b16 a[178:179],v22 offset:4096
 v_mfma_f32_16x16x32_bf16 v[144:147],a[16:19],a[140:143],v[144:147]
 buffer_load_dwordx4 a[100:103],v1,s[60:63],s40 offen offset:1024 sc1
 v_mfma_f32_16x16x32_bf16 v[144:147],a[0:3],a[136:139],v[144:147]
 ds_read_b64_tr_b16 a[180:181],v22 offset:8192
 v_mfma_f32_16x16x32_bf16 v[160:163],a[0:3],a[144:147],v[160:163]
 ds_read_b64_tr_b16 a[182:183],v22 offset:12288
 v_mfma_f32_16x16x32_bf16 v[160:163],a[16:19],a[148:151],v[160:163]
 v_mfma_f32_16x16x32_bf16 v[164:167],a[20:23],a[148:151],v[164:167]
 ds_read_b64_tr_b16 a[184:185],v23 offset:0
 v_mfma_f32_16x16x32_bf16 v[164:167],a[4:7],a[144:147],v[164:167]
 ds_read_b64_tr_b16 a[186:187],v23 offset:4096
 buffer_load_dwordx4 a[112:115],v1,s[60:63],s40 offen offset:2048 sc1
 v_mfma_f32_16x16x32_bf16 v[168:171],a[8:11],a[144:147],v[168:171]
 v_mfma_f32_16x16x32_bf16 v[168:171],a[24:27],a[148:151],v[168:171]
 ds_read_b64_tr_b16 a[188:189],v23 offset:8192
 v_mfma_f32_16x16x32_bf16 v[172:175],a[28:31],a[148:151],v[172:175]
 ds_read_b64_tr_b16 a[190:191],v23 offset:12288
 v_mfma_f32_16x16x32_bf16 v[172:175],a[12:15],a[144:147],v[172:175]
 buffer_load_dwordx4 a[116:119],v1,s[60:63],s40 offen offset:3072 sc1
 v_mfma_f32_16x16x32_bf16 v[188:191],a[12:15],a[152:155],v[188:191]
 v_mfma_f32_16x16x32_bf16 v[188:191],a[28:31],a[156:159],v[188:191]
 v_mfma_f32_16x16x32_bf16 v[184:187],a[24:27],a[156:159],v[184:187]
 s_add_u32 s59,s77,253952
 v_mfma_f32_16x16x32_bf16 v[184:187],a[8:11],a[152:155],v[184:187]
 buffer_load_dwordx4 a[104:107],v1,s[60:63],s59 offen offset:0 sc1
 v_mfma_f32_16x16x32_bf16 v[180:183],a[4:7],a[152:155],v[180:183]
 v_mfma_f32_16x16x32_bf16 v[180:183],a[20:23],a[156:159],v[180:183]
 v_mfma_f32_16x16x32_bf16 v[176:179],a[16:19],a[156:159],v[176:179]
 v_mfma_f32_16x16x32_bf16 v[176:179],a[0:3],a[152:155],v[176:179]
 s_waitcnt vmcnt(33) lgkmcnt(0)
 s_barrier
 v_mfma_f32_16x16x32_bf16 v[192:195],a[0:3],a[160:163],v[192:195]
 ds_read_b64_tr_b16 a[128:129],v24 offset:0
 v_mfma_f32_16x16x32_bf16 v[192:195],a[16:19],a[164:167],v[192:195]
 ds_read_b64_tr_b16 a[130:131],v24 offset:4096
 v_mfma_f32_16x16x32_bf16 v[196:199],a[20:23],a[164:167],v[196:199]
 buffer_load_dwordx4 a[108:111],v1,s[60:63],s59 offen offset:1024 sc1
 v_mfma_f32_16x16x32_bf16 v[196:199],a[4:7],a[160:163],v[196:199]
 ds_read_b64_tr_b16 a[132:133],v24 offset:8192
 v_mfma_f32_16x16x32_bf16 v[224:227],a[8:11],a[160:163],v[224:227]
 ds_read_b64_tr_b16 a[134:135],v24 offset:12288
 v_mfma_f32_16x16x32_bf16 v[224:227],a[24:27],a[164:167],v[224:227]
 v_mfma_f32_16x16x32_bf16 v[228:231],a[28:31],a[164:167],v[228:231]
 ds_read_b64_tr_b16 a[136:137],v25 offset:0
 buffer_load_dwordx4 a[120:123],v1,s[60:63],s59 offen offset:2048 sc1
 v_mfma_f32_16x16x32_bf16 v[228:231],a[12:15],a[160:163],v[228:231]
 ds_read_b64_tr_b16 a[138:139],v25 offset:4096
 v_mfma_f32_16x16x32_bf16 v[236:239],a[12:15],a[168:171],v[236:239]
 v_mfma_f32_16x16x32_bf16 v[236:239],a[28:31],a[172:175],v[236:239]
 ds_read_b64_tr_b16 a[140:141],v25 offset:8192
 v_mfma_f32_16x16x32_bf16 v[232:235],a[24:27],a[172:175],v[232:235]
 ds_read_b64_tr_b16 a[142:143],v25 offset:12288
 buffer_load_dwordx4 a[124:127],v1,s[60:63],s59 offen offset:3072 sc1
 v_mfma_f32_16x16x32_bf16 v[232:235],a[8:11],a[168:171],v[232:235]
 v_mfma_f32_16x16x32_bf16 v[204:207],a[4:7],a[168:171],v[204:207]
 s_add_u32 m0,s3,0
 ds_read_b64_tr_b16 a[144:145],v26 offset:0
 v_mfma_f32_16x16x32_bf16 v[204:207],a[20:23],a[172:175],v[204:207]
 s_add_u32 s41,s58,1572864
 ds_read_b64_tr_b16 a[146:147],v26 offset:4096
 v_mfma_f32_16x16x32_bf16 v[200:203],a[16:19],a[172:175],v[200:203]
 buffer_load_dwordx4 v32,s[8:11],s41 offen offset:0 lds
 v_mfma_f32_16x16x32_bf16 v[200:203],a[0:3],a[168:171],v[200:203]
 ds_read_b64_tr_b16 a[148:149],v26 offset:8192
 v_mfma_f32_16x16x32_bf16 v[208:211],a[0:3],a[176:179],v[208:211]
 ds_read_b64_tr_b16 a[150:151],v26 offset:12288
 v_mfma_f32_16x16x32_bf16 v[208:211],a[16:19],a[180:183],v[208:211]
 v_mfma_f32_16x16x32_bf16 v[212:215],a[20:23],a[180:183],v[212:215]
 ds_read_b64_tr_b16 a[152:153],v27 offset:0
 v_mfma_f32_16x16x32_bf16 v[212:215],a[4:7],a[176:179],v[212:215]
 ds_read_b64_tr_b16 a[154:155],v27 offset:4096
 buffer_load_dwordx4 v33,s[8:11],s41 offen offset:1024 lds
 v_mfma_f32_16x16x32_bf16 v[240:243],a[8:11],a[176:179],v[240:243]
 v_mfma_f32_16x16x32_bf16 v[240:243],a[24:27],a[180:183],v[240:243]
 ds_read_b64_tr_b16 a[156:157],v27 offset:8192
 v_mfma_f32_16x16x32_bf16 v[244:247],a[28:31],a[180:183],v[244:247]
 ds_read_b64_tr_b16 a[158:159],v27 offset:12288
 v_mfma_f32_16x16x32_bf16 v[244:247],a[12:15],a[176:179],v[244:247]
 buffer_load_dwordx4 v34,s[8:11],s41 offen offset:2048 lds
 v_mfma_f32_16x16x32_bf16 v[252:255],a[12:15],a[184:187],v[252:255]
 v_mfma_f32_16x16x32_bf16 v[252:255],a[28:31],a[188:191],v[252:255]
 v_mfma_f32_16x16x32_bf16 v[248:251],a[24:27],a[188:191],v[248:251]
 v_mfma_f32_16x16x32_bf16 v[248:251],a[8:11],a[184:187],v[248:251]
 buffer_load_dwordx4 v35,s[8:11],s41 offen offset:3072 lds
 v_mfma_f32_16x16x32_bf16 v[220:223],a[4:7],a[184:187],v[220:223]
 v_mfma_f32_16x16x32_bf16 v[220:223],a[20:23],a[188:191],v[220:223]
 v_mfma_f32_16x16x32_bf16 v[216:219],a[16:19],a[188:191],v[216:219]
 v_mfma_f32_16x16x32_bf16 v[216:219],a[0:3],a[184:187],v[216:219]
 s_waitcnt vmcnt(32) lgkmcnt(0)
 v_mfma_f32_16x16x32_bf16 v[128:131],a[32:35],a[128:131],v[128:131]
 ds_read_b64_tr_b16 a[160:161],v28 offset:0
 v_mfma_f32_16x16x32_bf16 v[128:131],a[48:51],a[132:135],v[128:131]
 s_add_u32 s40,s77,32768
 ds_read_b64_tr_b16 a[162:163],v28 offset:4096
 v_mfma_f32_16x16x32_bf16 v[132:135],a[52:55],a[132:135],v[132:135]
 buffer_load_dwordx4 a[0:3],v1,s[60:63],s40 offen offset:0 sc1
 v_mfma_f32_16x16x32_bf16 v[132:135],a[36:39],a[128:131],v[132:135]
 ds_read_b64_tr_b16 a[164:165],v28 offset:8192
 v_mfma_f32_16x16x32_bf16 v[136:139],a[40:43],a[128:131],v[136:139]
 ds_read_b64_tr_b16 a[166:167],v28 offset:12288
 v_mfma_f32_16x16x32_bf16 v[136:139],a[56:59],a[132:135],v[136:139]
 v_mfma_f32_16x16x32_bf16 v[140:143],a[60:63],a[132:135],v[140:143]
 ds_read_b64_tr_b16 a[168:169],v29 offset:0
 buffer_load_dwordx4 a[4:7],v1,s[60:63],s40 offen offset:1024 sc1
 v_mfma_f32_16x16x32_bf16 v[140:143],a[44:47],a[128:131],v[140:143]
 ds_read_b64_tr_b16 a[170:171],v29 offset:4096
 v_mfma_f32_16x16x32_bf16 v[156:159],a[44:47],a[136:139],v[156:159]
 v_mfma_f32_16x16x32_bf16 v[156:159],a[60:63],a[140:143],v[156:159]
 ds_read_b64_tr_b16 a[172:173],v29 offset:8192
 v_mfma_f32_16x16x32_bf16 v[152:155],a[56:59],a[140:143],v[152:155]
 ds_read_b64_tr_b16 a[174:175],v29 offset:12288
 buffer_load_dwordx4 a[16:19],v1,s[60:63],s40 offen offset:2048 sc1
 v_mfma_f32_16x16x32_bf16 v[152:155],a[40:43],a[136:139],v[152:155]
 v_mfma_f32_16x16x32_bf16 v[148:151],a[36:39],a[136:139],v[148:151]
 ds_read_b64_tr_b16 a[176:177],v30 offset:0
 v_mfma_f32_16x16x32_bf16 v[148:151],a[52:55],a[140:143],v[148:151]
 ds_read_b64_tr_b16 a[178:179],v30 offset:4096
 v_mfma_f32_16x16x32_bf16 v[144:147],a[48:51],a[140:143],v[144:147]
 buffer_load_dwordx4 a[20:23],v1,s[60:63],s40 offen offset:3072 sc1
 v_mfma_f32_16x16x32_bf16 v[144:147],a[32:35],a[136:139],v[144:147]
 ds_read_b64_tr_b16 a[180:181],v30 offset:8192
 v_mfma_f32_16x16x32_bf16 v[160:163],a[32:35],a[144:147],v[160:163]
 ds_read_b64_tr_b16 a[182:183],v30 offset:12288
 v_mfma_f32_16x16x32_bf16 v[160:163],a[48:51],a[148:151],v[160:163]
 v_mfma_f32_16x16x32_bf16 v[164:167],a[52:55],a[148:151],v[164:167]
 s_add_u32 s59,s77,262144
 ds_read_b64_tr_b16 a[184:185],v31 offset:0
 v_mfma_f32_16x16x32_bf16 v[164:167],a[36:39],a[144:147],v[164:167]
 ds_read_b64_tr_b16 a[186:187],v31 offset:4096
 buffer_load_dwordx4 a[8:11],v1,s[60:63],s59 offen offset:0 sc1
 v_mfma_f32_16x16x32_bf16 v[168:171],a[40:43],a[144:147],v[168:171]
 v_mfma_f32_16x16x32_bf16 v[168:171],a[56:59],a[148:151],v[168:171]
 ds_read_b64_tr_b16 a[188:189],v31 offset:8192
 v_mfma_f32_16x16x32_bf16 v[172:175],a[60:63],a[148:151],v[172:175]
 ds_read_b64_tr_b16 a[190:191],v31 offset:12288
 v_mfma_f32_16x16x32_bf16 v[172:175],a[44:47],a[144:147],v[172:175]
 buffer_load_dwordx4 a[12:15],v1,s[60:63],s59 offen offset:1024 sc1
 v_mfma_f32_16x16x32_bf16 v[188:191],a[44:47],a[152:155],v[188:191]
 v_mfma_f32_16x16x32_bf16 v[188:191],a[60:63],a[156:159],v[188:191]
 v_mfma_f32_16x16x32_bf16 v[184:187],a[56:59],a[156:159],v[184:187]
 v_mfma_f32_16x16x32_bf16 v[184:187],a[40:43],a[152:155],v[184:187]
 buffer_load_dwordx4 a[24:27],v1,s[60:63],s59 offen offset:2048 sc1
 v_mfma_f32_16x16x32_bf16 v[180:183],a[36:39],a[152:155],v[180:183]
 v_mfma_f32_16x16x32_bf16 v[180:183],a[52:55],a[156:159],v[180:183]
 v_mfma_f32_16x16x32_bf16 v[176:179],a[48:51],a[156:159],v[176:179]
 v_mfma_f32_16x16x32_bf16 v[176:179],a[32:35],a[152:155],v[176:179]
 s_waitcnt vmcnt(35) lgkmcnt(0)
 s_barrier
 v_mfma_f32_16x16x32_bf16 v[192:195],a[32:35],a[160:163],v[192:195]
 ds_read_b64_tr_b16 a[128:129],v16 offset:16384
 v_mfma_f32_16x16x32_bf16 v[192:195],a[48:51],a[164:167],v[192:195]
 ds_read_b64_tr_b16 a[130:131],v16 offset:20480
 v_mfma_f32_16x16x32_bf16 v[196:199],a[52:55],a[164:167],v[196:199]
 buffer_load_dwordx4 a[28:31],v1,s[60:63],s59 offen offset:3072 sc1
 v_mfma_f32_16x16x32_bf16 v[196:199],a[36:39],a[160:163],v[196:199]
 ds_read_b64_tr_b16 a[132:133],v16 offset:24576
 v_mfma_f32_16x16x32_bf16 v[224:227],a[40:43],a[160:163],v[224:227]
 s_add_u32 m0,s3,65536
 ds_read_b64_tr_b16 a[134:135],v16 offset:28672
 v_mfma_f32_16x16x32_bf16 v[224:227],a[56:59],a[164:167],v[224:227]
 s_add_u32 s41,s58,2097152
 v_mfma_f32_16x16x32_bf16 v[228:231],a[60:63],a[164:167],v[228:231]
 ds_read_b64_tr_b16 a[136:137],v17 offset:16384
 buffer_load_dwordx4 v32,s[8:11],s41 offen offset:0 lds
 v_mfma_f32_16x16x32_bf16 v[228:231],a[44:47],a[160:163],v[228:231]
 ds_read_b64_tr_b16 a[138:139],v17 offset:20480
 v_mfma_f32_16x16x32_bf16 v[236:239],a[44:47],a[168:171],v[236:239]
 v_mfma_f32_16x16x32_bf16 v[236:239],a[60:63],a[172:175],v[236:239]
 ds_read_b64_tr_b16 a[140:141],v17 offset:24576
 v_mfma_f32_16x16x32_bf16 v[232:235],a[56:59],a[172:175],v[232:235]
 ds_read_b64_tr_b16 a[142:143],v17 offset:28672
 buffer_load_dwordx4 v33,s[8:11],s41 offen offset:1024 lds
 v_mfma_f32_16x16x32_bf16 v[232:235],a[40:43],a[168:171],v[232:235]
 v_mfma_f32_16x16x32_bf16 v[204:207],a[36:39],a[168:171],v[204:207]
 ds_read_b64_tr_b16 a[144:145],v18 offset:16384
 v_mfma_f32_16x16x32_bf16 v[204:207],a[52:55],a[172:175],v[204:207]
 ds_read_b64_tr_b16 a[146:147],v18 offset:20480
 v_mfma_f32_16x16x32_bf16 v[200:203],a[48:51],a[172:175],v[200:203]
 buffer_load_dwordx4 v34,s[8:11],s41 offen offset:2048 lds
 v_mfma_f32_16x16x32_bf16 v[200:203],a[32:35],a[168:171],v[200:203]
 ds_read_b64_tr_b16 a[148:149],v18 offset:24576
 v_mfma_f32_16x16x32_bf16 v[208:211],a[32:35],a[176:179],v[208:211]
 ds_read_b64_tr_b16 a[150:151],v18 offset:28672
 v_mfma_f32_16x16x32_bf16 v[208:211],a[48:51],a[180:183],v[208:211]
 v_mfma_f32_16x16x32_bf16 v[212:215],a[52:55],a[180:183],v[212:215]
 ds_read_b64_tr_b16 a[152:153],v19 offset:16384
 v_mfma_f32_16x16x32_bf16 v[212:215],a[36:39],a[176:179],v[212:215]
 ds_read_b64_tr_b16 a[154:155],v19 offset:20480
 buffer_load_dwordx4 v35,s[8:11],s41 offen offset:3072 lds
 v_mfma_f32_16x16x32_bf16 v[240:243],a[40:43],a[176:179],v[240:243]
 v_mfma_f32_16x16x32_bf16 v[240:243],a[56:59],a[180:183],v[240:243]
 s_add_u32 m0,s3,98304
 ds_read_b64_tr_b16 a[156:157],v19 offset:24576
 v_mfma_f32_16x16x32_bf16 v[244:247],a[60:63],a[180:183],v[244:247]
 s_add_u32 s41,s58,4194304
 ds_read_b64_tr_b16 a[158:159],v19 offset:28672
 v_mfma_f32_16x16x32_bf16 v[244:247],a[44:47],a[176:179],v[244:247]
 buffer_load_dwordx4 v32,s[8:11],s41 offen offset:0 lds
 v_mfma_f32_16x16x32_bf16 v[252:255],a[44:47],a[184:187],v[252:255]
 v_mfma_f32_16x16x32_bf16 v[252:255],a[60:63],a[188:191],v[252:255]
 v_mfma_f32_16x16x32_bf16 v[248:251],a[56:59],a[188:191],v[248:251]
 v_mfma_f32_16x16x32_bf16 v[248:251],a[40:43],a[184:187],v[248:251]
 buffer_load_dwordx4 v33,s[8:11],s41 offen offset:1024 lds
 v_mfma_f32_16x16x32_bf16 v[220:223],a[36:39],a[184:187],v[220:223]
 v_mfma_f32_16x16x32_bf16 v[220:223],a[52:55],a[188:191],v[220:223]
 v_mfma_f32_16x16x32_bf16 v[216:219],a[48:51],a[188:191],v[216:219]
 v_mfma_f32_16x16x32_bf16 v[216:219],a[32:35],a[184:187],v[216:219]
 s_waitcnt vmcnt(34) lgkmcnt(0)
 v_mfma_f32_16x16x32_bf16 v[128:131],a[64:67],a[128:131],v[128:131]
 ds_read_b64_tr_b16 a[160:161],v20 offset:16384
 v_mfma_f32_16x16x32_bf16 v[128:131],a[80:83],a[132:135],v[128:131]
 ds_read_b64_tr_b16 a[162:163],v20 offset:20480
 v_mfma_f32_16x16x32_bf16 v[132:135],a[84:87],a[132:135],v[132:135]
 buffer_load_dwordx4 v34,s[8:11],s41 offen offset:2048 lds
 v_mfma_f32_16x16x32_bf16 v[132:135],a[68:71],a[128:131],v[132:135]
 ds_read_b64_tr_b16 a[164:165],v20 offset:24576
 v_mfma_f32_16x16x32_bf16 v[136:139],a[72:75],a[128:131],v[136:139]
 ds_read_b64_tr_b16 a[166:167],v20 offset:28672
 v_mfma_f32_16x16x32_bf16 v[136:139],a[88:91],a[132:135],v[136:139]
 v_mfma_f32_16x16x32_bf16 v[140:143],a[92:95],a[132:135],v[140:143]
 ds_read_b64_tr_b16 a[168:169],v21 offset:16384
 buffer_load_dwordx4 v35,s[8:11],s41 offen offset:3072 lds
 v_mfma_f32_16x16x32_bf16 v[140:143],a[76:79],a[128:131],v[140:143]
 ds_read_b64_tr_b16 a[170:171],v21 offset:20480
 v_mfma_f32_16x16x32_bf16 v[156:159],a[76:79],a[136:139],v[156:159]
 v_mfma_f32_16x16x32_bf16 v[156:159],a[92:95],a[140:143],v[156:159]
 s_add_u32 s40,s77,40960
 ds_read_b64_tr_b16 a[172:173],v21 offset:24576
 v_mfma_f32_16x16x32_bf16 v[152:155],a[88:91],a[140:143],v[152:155]
 ds_read_b64_tr_b16 a[174:175],v21 offset:28672
 buffer_load_dwordx4 a[32:35],v1,s[60:63],s40 offen offset:0 sc1
 v_mfma_f32_16x16x32_bf16 v[152:155],a[72:75],a[136:139],v[152:155]
 v_mfma_f32_16x16x32_bf16 v[148:151],a[68:71],a[136:139],v[148:151]
 ds_read_b64_tr_b16 a[176:177],v22 offset:16384
 v_mfma_f32_16x16x32_bf16 v[148:151],a[84:87],a[140:143],v[148:151]
 ds_read_b64_tr_b16 a[178:179],v22 offset:20480
 v_mfma_f32_16x16x32_bf16 v[144:147],a[80:83],a[140:143],v[144:147]
 buffer_load_dwordx4 a[36:39],v1,s[60:63],s40 offen offset:1024 sc1
 v_mfma_f32_16x16x32_bf16 v[144:147],a[64:67],a[136:139],v[144:147]
 ds_read_b64_tr_b16 a[180:181],v22 offset:24576
 v_mfma_f32_16x16x32_bf16 v[160:163],a[64:67],a[144:147],v[160:163]
 ds_read_b64_tr_b16 a[182:183],v22 offset:28672
 v_mfma_f32_16x16x32_bf16 v[160:163],a[80:83],a[148:151],v[160:163]
 v_mfma_f32_16x16x32_bf16 v[164:167],a[84:87],a[148:151],v[164:167]
 ds_read_b64_tr_b16 a[184:185],v23 offset:16384
 v_mfma_f32_16x16x32_bf16 v[164:167],a[68:71],a[144:147],v[164:167]
 ds_read_b64_tr_b16 a[186:187],v23 offset:20480
 buffer_load_dwordx4 a[48:51],v1,s[60:63],s40 offen offset:2048 sc1
 v_mfma_f32_16x16x32_bf16 v[168:171],a[72:75],a[144:147],v[168:171]
 v_mfma_f32_16x16x32_bf16 v[168:171],a[88:91],a[148:151],v[168:171]
 ds_read_b64_tr_b16 a[188:189],v23 offset:24576
 v_mfma_f32_16x16x32_bf16 v[172:175],a[92:95],a[148:151],v[172:175]
 ds_read_b64_tr_b16 a[190:191],v23 offset:28672
 v_mfma_f32_16x16x32_bf16 v[172:175],a[76:79],a[144:147],v[172:175]
 buffer_load_dwordx4 a[52:55],v1,s[60:63],s40 offen offset:3072 sc1
 v_mfma_f32_16x16x32_bf16 v[188:191],a[76:79],a[152:155],v[188:191]
 v_mfma_f32_16x16x32_bf16 v[188:191],a[92:95],a[156:159],v[188:191]
 v_mfma_f32_16x16x32_bf16 v[184:187],a[88:91],a[156:159],v[184:187]
 s_add_u32 s59,s77,270336
 v_mfma_f32_16x16x32_bf16 v[184:187],a[72:75],a[152:155],v[184:187]
 buffer_load_dwordx4 a[40:43],v1,s[60:63],s59 offen offset:0 sc1
 v_mfma_f32_16x16x32_bf16 v[180:183],a[68:71],a[152:155],v[180:183]
 v_mfma_f32_16x16x32_bf16 v[180:183],a[84:87],a[156:159],v[180:183]
 v_mfma_f32_16x16x32_bf16 v[176:179],a[80:83],a[156:159],v[176:179]
 v_mfma_f32_16x16x32_bf16 v[176:179],a[64:67],a[152:155],v[176:179]
 s_waitcnt vmcnt(37) lgkmcnt(0)
 s_barrier
 v_mfma_f32_16x16x32_bf16 v[192:195],a[64:67],a[160:163],v[192:195]
 ds_read_b64_tr_b16 a[128:129],v24 offset:16384
 v_mfma_f32_16x16x32_bf16 v[192:195],a[80:83],a[164:167],v[192:195]
 ds_read_b64_tr_b16 a[130:131],v24 offset:20480
 v_mfma_f32_16x16x32_bf16 v[196:199],a[84:87],a[164:167],v[196:199]
 buffer_load_dwordx4 a[44:47],v1,s[60:63],s59 offen offset:1024 sc1
 v_mfma_f32_16x16x32_bf16 v[196:199],a[68:71],a[160:163],v[196:199]
 ds_read_b64_tr_b16 a[132:133],v24 offset:24576
 v_mfma_f32_16x16x32_bf16 v[224:227],a[72:75],a[160:163],v[224:227]
 ds_read_b64_tr_b16 a[134:135],v24 offset:28672
 v_mfma_f32_16x16x32_bf16 v[224:227],a[88:91],a[164:167],v[224:227]
 v_mfma_f32_16x16x32_bf16 v[228:231],a[92:95],a[164:167],v[228:231]
 ds_read_b64_tr_b16 a[136:137],v25 offset:16384
 buffer_load_dwordx4 a[56:59],v1,s[60:63],s59 offen offset:2048 sc1
 v_mfma_f32_16x16x32_bf16 v[228:231],a[76:79],a[160:163],v[228:231]
 ds_read_b64_tr_b16 a[138:139],v25 offset:20480
 v_mfma_f32_16x16x32_bf16 v[236:239],a[76:79],a[168:171],v[236:239]
 v_mfma_f32_16x16x32_bf16 v[236:239],a[92:95],a[172:175],v[236:239]
 ds_read_b64_tr_b16 a[140:141],v25 offset:24576
 v_mfma_f32_16x16x32_bf16 v[232:235],a[88:91],a[172:175],v[232:235]
 ds_read_b64_tr_b16 a[142:143],v25 offset:28672
 buffer_load_dwordx4 a[60:63],v1,s[60:63],s59 offen offset:3072 sc1
 v_mfma_f32_16x16x32_bf16 v[232:235],a[72:75],a[168:171],v[232:235]
 v_mfma_f32_16x16x32_bf16 v[204:207],a[68:71],a[168:171],v[204:207]
 s_add_u32 m0,s3,16384
 ds_read_b64_tr_b16 a[144:145],v26 offset:16384
 v_mfma_f32_16x16x32_bf16 v[204:207],a[84:87],a[172:175],v[204:207]
 s_add_u32 s41,s58,2621440
 ds_read_b64_tr_b16 a[146:147],v26 offset:20480
 v_mfma_f32_16x16x32_bf16 v[200:203],a[80:83],a[172:175],v[200:203]
 buffer_load_dwordx4 v32,s[8:11],s41 offen offset:0 lds
 v_mfma_f32_16x16x32_bf16 v[200:203],a[64:67],a[168:171],v[200:203]
 ds_read_b64_tr_b16 a[148:149],v26 offset:24576
 v_mfma_f32_16x16x32_bf16 v[208:211],a[64:67],a[176:179],v[208:211]
 ds_read_b64_tr_b16 a[150:151],v26 offset:28672
 v_mfma_f32_16x16x32_bf16 v[208:211],a[80:83],a[180:183],v[208:211]
 v_mfma_f32_16x16x32_bf16 v[212:215],a[84:87],a[180:183],v[212:215]
 ds_read_b64_tr_b16 a[152:153],v27 offset:16384
 v_mfma_f32_16x16x32_bf16 v[212:215],a[68:71],a[176:179],v[212:215]
 ds_read_b64_tr_b16 a[154:155],v27 offset:20480
 buffer_load_dwordx4 v33,s[8:11],s41 offen offset:1024 lds
 v_mfma_f32_16x16x32_bf16 v[240:243],a[72:75],a[176:179],v[240:243]
 v_mfma_f32_16x16x32_bf16 v[240:243],a[88:91],a[180:183],v[240:243]
 ds_read_b64_tr_b16 a[156:157],v27 offset:24576
 v_mfma_f32_16x16x32_bf16 v[244:247],a[92:95],a[180:183],v[244:247]
 ds_read_b64_tr_b16 a[158:159],v27 offset:28672
 v_mfma_f32_16x16x32_bf16 v[244:247],a[76:79],a[176:179],v[244:247]
 buffer_load_dwordx4 v34,s[8:11],s41 offen offset:2048 lds
 v_mfma_f32_16x16x32_bf16 v[252:255],a[76:79],a[184:187],v[252:255]
 v_mfma_f32_16x16x32_bf16 v[252:255],a[92:95],a[188:191],v[252:255]
 v_mfma_f32_16x16x32_bf16 v[248:251],a[88:91],a[188:191],v[248:251]
 v_mfma_f32_16x16x32_bf16 v[248:251],a[72:75],a[184:187],v[248:251]
 buffer_load_dwordx4 v35,s[8:11],s41 offen offset:3072 lds
 v_mfma_f32_16x16x32_bf16 v[220:223],a[68:71],a[184:187],v[220:223]
 v_mfma_f32_16x16x32_bf16 v[220:223],a[84:87],a[188:191],v[220:223]
 v_mfma_f32_16x16x32_bf16 v[216:219],a[80:83],a[188:191],v[216:219]
 v_mfma_f32_16x16x32_bf16 v[216:219],a[64:67],a[184:187],v[216:219]
 s_waitcnt vmcnt(32) lgkmcnt(0)
 v_mfma_f32_16x16x32_bf16 v[128:131],a[96:99],a[128:131],v[128:131]
 ds_read_b64_tr_b16 a[160:161],v28 offset:16384
 v_mfma_f32_16x16x32_bf16 v[128:131],a[112:115],a[132:135],v[128:131]
 s_add_u32 s40,s77,49152
 ds_read_b64_tr_b16 a[162:163],v28 offset:20480
 v_mfma_f32_16x16x32_bf16 v[132:135],a[116:119],a[132:135],v[132:135]
 buffer_load_dwordx4 a[64:67],v1,s[60:63],s40 offen offset:0 sc1
 v_mfma_f32_16x16x32_bf16 v[132:135],a[100:103],a[128:131],v[132:135]
 ds_read_b64_tr_b16 a[164:165],v28 offset:24576
 v_mfma_f32_16x16x32_bf16 v[136:139],a[104:107],a[128:131],v[136:139]
 ds_read_b64_tr_b16 a[166:167],v28 offset:28672
 v_mfma_f32_16x16x32_bf16 v[136:139],a[120:123],a[132:135],v[136:139]
 v_mfma_f32_16x16x32_bf16 v[140:143],a[124:127],a[132:135],v[140:143]
 ds_read_b64_tr_b16 a[168:169],v29 offset:16384
 buffer_load_dwordx4 a[68:71],v1,s[60:63],s40 offen offset:1024 sc1
 v_mfma_f32_16x16x32_bf16 v[140:143],a[108:111],a[128:131],v[140:143]
 ds_read_b64_tr_b16 a[170:171],v29 offset:20480
 v_mfma_f32_16x16x32_bf16 v[156:159],a[108:111],a[136:139],v[156:159]
 v_mfma_f32_16x16x32_bf16 v[156:159],a[124:127],a[140:143],v[156:159]
 ds_read_b64_tr_b16 a[172:173],v29 offset:24576
 v_mfma_f32_16x16x32_bf16 v[152:155],a[120:123],a[140:143],v[152:155]
 ds_read_b64_tr_b16 a[174:175],v29 offset:28672
 buffer_load_dwordx4 a[80:83],v1,s[60:63],s40 offen offset:2048 sc1
 v_mfma_f32_16x16x32_bf16 v[152:155],a[104:107],a[136:139],v[152:155]
 v_mfma_f32_16x16x32_bf16 v[148:151],a[100:103],a[136:139],v[148:151]
 ds_read_b64_tr_b16 a[176:177],v30 offset:16384
 v_mfma_f32_16x16x32_bf16 v[148:151],a[116:119],a[140:143],v[148:151]
 ds_read_b64_tr_b16 a[178:179],v30 offset:20480
 v_mfma_f32_16x16x32_bf16 v[144:147],a[112:115],a[140:143],v[144:147]
 buffer_load_dwordx4 a[84:87],v1,s[60:63],s40 offen offset:3072 sc1
 v_mfma_f32_16x16x32_bf16 v[144:147],a[96:99],a[136:139],v[144:147]
 ds_read_b64_tr_b16 a[180:181],v30 offset:24576
 v_mfma_f32_16x16x32_bf16 v[160:163],a[96:99],a[144:147],v[160:163]
 ds_read_b64_tr_b16 a[182:183],v30 offset:28672
 v_mfma_f32_16x16x32_bf16 v[160:163],a[112:115],a[148:151],v[160:163]
 v_mfma_f32_16x16x32_bf16 v[164:167],a[116:119],a[148:151],v[164:167]
 s_add_u32 s59,s77,278528
 ds_read_b64_tr_b16 a[184:185],v31 offset:16384
 v_mfma_f32_16x16x32_bf16 v[164:167],a[100:103],a[144:147],v[164:167]
 ds_read_b64_tr_b16 a[186:187],v31 offset:20480
 buffer_load_dwordx4 a[72:75],v1,s[60:63],s59 offen offset:0 sc1
 v_mfma_f32_16x16x32_bf16 v[168:171],a[104:107],a[144:147],v[168:171]
 v_mfma_f32_16x16x32_bf16 v[168:171],a[120:123],a[148:151],v[168:171]
 ds_read_b64_tr_b16 a[188:189],v31 offset:24576
 v_mfma_f32_16x16x32_bf16 v[172:175],a[124:127],a[148:151],v[172:175]
 ds_read_b64_tr_b16 a[190:191],v31 offset:28672
 v_mfma_f32_16x16x32_bf16 v[172:175],a[108:111],a[144:147],v[172:175]
 buffer_load_dwordx4 a[76:79],v1,s[60:63],s59 offen offset:1024 sc1
 v_mfma_f32_16x16x32_bf16 v[188:191],a[108:111],a[152:155],v[188:191]
 v_mfma_f32_16x16x32_bf16 v[188:191],a[124:127],a[156:159],v[188:191]
 v_mfma_f32_16x16x32_bf16 v[184:187],a[120:123],a[156:159],v[184:187]
 v_mfma_f32_16x16x32_bf16 v[184:187],a[104:107],a[152:155],v[184:187]
 buffer_load_dwordx4 a[88:91],v1,s[60:63],s59 offen offset:2048 sc1
 v_mfma_f32_16x16x32_bf16 v[180:183],a[100:103],a[152:155],v[180:183]
 v_mfma_f32_16x16x32_bf16 v[180:183],a[116:119],a[156:159],v[180:183]
 v_mfma_f32_16x16x32_bf16 v[176:179],a[112:115],a[156:159],v[176:179]
 v_mfma_f32_16x16x32_bf16 v[176:179],a[96:99],a[152:155],v[176:179]
 s_waitcnt vmcnt(35) lgkmcnt(0)
 s_barrier
 v_mfma_f32_16x16x32_bf16 v[192:195],a[96:99],a[160:163],v[192:195]
 ds_read_b64_tr_b16 a[128:129],v16 offset:0
 v_mfma_f32_16x16x32_bf16 v[192:195],a[112:115],a[164:167],v[192:195]
 ds_read_b64_tr_b16 a[130:131],v16 offset:4096
 v_mfma_f32_16x16x32_bf16 v[196:199],a[116:119],a[164:167],v[196:199]
 buffer_load_dwordx4 a[92:95],v1,s[60:63],s59 offen offset:3072 sc1
 v_mfma_f32_16x16x32_bf16 v[196:199],a[100:103],a[160:163],v[196:199]
 ds_read_b64_tr_b16 a[132:133],v16 offset:8192
 v_mfma_f32_16x16x32_bf16 v[224:227],a[104:107],a[160:163],v[224:227]
 s_add_u32 m0,s3,81920
 ds_read_b64_tr_b16 a[134:135],v16 offset:12288
 v_mfma_f32_16x16x32_bf16 v[224:227],a[120:123],a[164:167],v[224:227]
 s_add_u32 s41,s58,3145728
 v_mfma_f32_16x16x32_bf16 v[228:231],a[124:127],a[164:167],v[228:231]
 ds_read_b64_tr_b16 a[136:137],v17 offset:0
 buffer_load_dwordx4 v32,s[8:11],s41 offen offset:0 lds
 v_mfma_f32_16x16x32_bf16 v[228:231],a[108:111],a[160:163],v[228:231]
 ds_read_b64_tr_b16 a[138:139],v17 offset:4096
 v_mfma_f32_16x16x32_bf16 v[236:239],a[108:111],a[168:171],v[236:239]
 v_mfma_f32_16x16x32_bf16 v[236:239],a[124:127],a[172:175],v[236:239]
 ds_read_b64_tr_b16 a[140:141],v17 offset:8192
 v_mfma_f32_16x16x32_bf16 v[232:235],a[120:123],a[172:175],v[232:235]
 ds_read_b64_tr_b16 a[142:143],v17 offset:12288
 buffer_load_dwordx4 v33,s[8:11],s41 offen offset:1024 lds
 v_mfma_f32_16x16x32_bf16 v[232:235],a[104:107],a[168:171],v[232:235]
 v_mfma_f32_16x16x32_bf16 v[204:207],a[100:103],a[168:171],v[204:207]
 ds_read_b64_tr_b16 a[144:145],v18 offset:0
 v_mfma_f32_16x16x32_bf16 v[204:207],a[116:119],a[172:175],v[204:207]
 ds_read_b64_tr_b16 a[146:147],v18 offset:4096
 v_mfma_f32_16x16x32_bf16 v[200:203],a[112:115],a[172:175],v[200:203]
 buffer_load_dwordx4 v34,s[8:11],s41 offen offset:2048 lds
 v_mfma_f32_16x16x32_bf16 v[200:203],a[96:99],a[168:171],v[200:203]
 ds_read_b64_tr_b16 a[148:149],v18 offset:8192
 v_mfma_f32_16x16x32_bf16 v[208:211],a[96:99],a[176:179],v[208:211]
 ds_read_b64_tr_b16 a[150:151],v18 offset:12288
 v_mfma_f32_16x16x32_bf16 v[208:211],a[112:115],a[180:183],v[208:211]
L_stub_m_3:
 s_cbranch_execz L_warm_m_ret
 v_mfma_f32_16x16x32_bf16 v[212:215],a[116:119],a[180:183],v[212:215]
 ds_read_b64_tr_b16 a[152:153],v19 offset:0
 v_mfma_f32_16x16x32_bf16 v[212:215],a[100:103],a[176:179],v[212:215]
 ds_read_b64_tr_b16 a[154:155],v19 offset:4096
 buffer_load_dwordx4 v35,s[8:11],s41 offen offset:3072 lds
 v_mfma_f32_16x16x32_bf16 v[240:243],a[104:107],a[176:179],v[240:243]
 v_mfma_f32_16x16x32_bf16 v[240:243],a[120:123],a[180:183],v[240:243]
 s_add_u32 m0,s3,49152
 ds_read_b64_tr_b16 a[156:157],v19 offset:8192
 v_mfma_f32_16x16x32_bf16 v[244:247],a[124:127],a[180:183],v[244:247]
 s_add_u32 s41,s58,4718592
 ds_read_b64_tr_b16 a[158:159],v19 offset:12288
 v_mfma_f32_16x16x32_bf16 v[244:247],a[108:111],a[176:179],v[244:247]
 buffer_load_dwordx4 v32,s[8:11],s41 offen offset:0 lds
 v_mfma_f32_16x16x32_bf16 v[252:255],a[108:111],a[184:187],v[252:255]
 v_mfma_f32_16x16x32_bf16 v[252:255],a[124:127],a[188:191],v[252:255]
 v_mfma_f32_16x16x32_bf16 v[248:251],a[120:123],a[188:191],v[248:251]
 v_mfma_f32_16x16x32_bf16 v[248:251],a[104:107],a[184:187],v[248:251]
 buffer_load_dwordx4 v33,s[8:11],s41 offen offset:1024 lds
 v_mfma_f32_16x16x32_bf16 v[220:223],a[100:103],a[184:187],v[220:223]
 v_mfma_f32_16x16x32_bf16 v[220:223],a[116:119],a[188:191],v[220:223]
 v_mfma_f32_16x16x32_bf16 v[216:219],a[112:115],a[188:191],v[216:219]
 v_mfma_f32_16x16x32_bf16 v[216:219],a[96:99],a[184:187],v[216:219]
 s_waitcnt vmcnt(34) lgkmcnt(0)
 v_mfma_f32_16x16x32_bf16 v[128:131],a[0:3],a[128:131],v[128:131]
 ds_read_b64_tr_b16 a[160:161],v20 offset:0
 v_mfma_f32_16x16x32_bf16 v[128:131],a[16:19],a[132:135],v[128:131]
 ds_read_b64_tr_b16 a[162:163],v20 offset:4096
 v_mfma_f32_16x16x32_bf16 v[132:135],a[20:23],a[132:135],v[132:135]
 buffer_load_dwordx4 v34,s[8:11],s41 offen offset:2048 lds
 v_mfma_f32_16x16x32_bf16 v[132:135],a[4:7],a[128:131],v[132:135]
 ds_read_b64_tr_b16 a[164:165],v20 offset:8192
 v_mfma_f32_16x16x32_bf16 v[136:139],a[8:11],a[128:131],v[136:139]
 ds_read_b64_tr_b16 a[166:167],v20 offset:12288
 v_mfma_f32_16x16x32_bf16 v[136:139],a[24:27],a[132:135],v[136:139]
 v_mfma_f32_16x16x32_bf16 v[140:143],a[28:31],a[132:135],v[140:143]
 ds_read_b64_tr_b16 a[168:169],v21 offset:0
 buffer_load_dwordx4 v35,s[8:11],s41 offen offset:3072 lds
 v_mfma_f32_16x16x32_bf16 v[140:143],a[12:15],a[128:131],v[140:143]
 ds_read_b64_tr_b16 a[170:171],v21 offset:4096
 v_mfma_f32_16x16x32_bf16 v[156:159],a[12:15],a[136:139],v[156:159]
 v_mfma_f32_16x16x32_bf16 v[156:159],a[28:31],a[140:143],v[156:159]
 s_add_u32 s40,s77,57344
 ds_read_b64_tr_b16 a[172:173],v21 offset:8192
 v_mfma_f32_16x16x32_bf16 v[152:155],a[24:27],a[140:143],v[152:155]
 ds_read_b64_tr_b16 a[174:175],v21 offset:12288
 buffer_load_dwordx4 a[96:99],v1,s[60:63],s40 offen offset:0 sc1
 v_mfma_f32_16x16x32_bf16 v[152:155],a[8:11],a[136:139],v[152:155]
 v_mfma_f32_16x16x32_bf16 v[148:151],a[4:7],a[136:139],v[148:151]
 ds_read_b64_tr_b16 a[176:177],v22 offset:0
 v_mfma_f32_16x16x32_bf16 v[148:151],a[20:23],a[140:143],v[148:151]
 ds_read_b64_tr_b16 a[178:179],v22 offset:4096
 v_mfma_f32_16x16x32_bf16 v[144:147],a[16:19],a[140:143],v[144:147]
 buffer_load_dwordx4 a[100:103],v1,s[60:63],s40 offen offset:1024 sc1
 v_mfma_f32_16x16x32_bf16 v[144:147],a[0:3],a[136:139],v[144:147]
 ds_read_b64_tr_b16 a[180:181],v22 offset:8192
 v_mfma_f32_16x16x32_bf16 v[160:163],a[0:3],a[144:147],v[160:163]
 ds_read_b64_tr_b16 a[182:183],v22 offset:12288
 v_mfma_f32_16x16x32_bf16 v[160:163],a[16:19],a[148:151],v[160:163]
 v_mfma_f32_16x16x32_bf16 v[164:167],a[20:23],a[148:151],v[164:167]
 ds_read_b64_tr_b16 a[184:185],v23 offset:0
 v_mfma_f32_16x16x32_bf16 v[164:167],a[4:7],a[144:147],v[164:167]
 ds_read_b64_tr_b16 a[186:187],v23 offset:4096
 buffer_load_dwordx4 a[112:115],v1,s[60:63],s40 offen offset:2048 sc1
 v_mfma_f32_16x16x32_bf16 v[168:171],a[8:11],a[144:147],v[168:171]
 v_mfma_f32_16x16x32_bf16 v[168:171],a[24:27],a[148:151],v[168:171]
 ds_read_b64_tr_b16 a[188:189],v23 offset:8192
 v_mfma_f32_16x16x32_bf16 v[172:175],a[28:31],a[148:151],v[172:175]
 ds_read_b64_tr_b16 a[190:191],v23 offset:12288
 v_mfma_f32_16x16x32_bf16 v[172:175],a[12:15],a[144:147],v[172:175]
 buffer_load_dwordx4 a[116:119],v1,s[60:63],s40 offen offset:3072 sc1
 v_mfma_f32_16x16x32_bf16 v[188:191],a[12:15],a[152:155],v[188:191]
 v_mfma_f32_16x16x32_bf16 v[188:191],a[28:31],a[156:159],v[188:191]
 v_mfma_f32_16x16x32_bf16 v[184:187],a[24:27],a[156:159],v[184:187]
 s_add_u32 s59,s77,286720
 v_mfma_f32_16x16x32_bf16 v[184:187],a[8:11],a[152:155],v[184:187]
 buffer_load_dwordx4 a[104:107],v1,s[60:63],s59 offen offset:0 sc1
 v_mfma_f32_16x16x32_bf16 v[180:183],a[4:7],a[152:155],v[180:183]
 v_mfma_f32_16x16x32_bf16 v[180:183],a[20:23],a[156:159],v[180:183]
 v_mfma_f32_16x16x32_bf16 v[176:179],a[16:19],a[156:159],v[176:179]
 v_mfma_f32_16x16x32_bf16 v[176:179],a[0:3],a[152:155],v[176:179]
 s_waitcnt vmcnt(37) lgkmcnt(0)
 s_barrier
 v_mfma_f32_16x16x32_bf16 v[192:195],a[0:3],a[160:163],v[192:195]
 ds_read_b64_tr_b16 a[128:129],v24 offset:0
 v_mfma_f32_16x16x32_bf16 v[192:195],a[16:19],a[164:167],v[192:195]
 ds_read_b64_tr_b16 a[130:131],v24 offset:4096
 v_mfma_f32_16x16x32_bf16 v[196:199],a[20:23],a[164:167],v[196:199]
 buffer_load_dwordx4 a[108:111],v1,s[60:63],s59 offen offset:1024 sc1
 v_mfma_f32_16x16x32_bf16 v[196:199],a[4:7],a[160:163],v[196:199]
 ds_read_b64_tr_b16 a[132:133],v24 offset:8192
 v_mfma_f32_16x16x32_bf16 v[224:227],a[8:11],a[160:163],v[224:227]
 ds_read_b64_tr_b16 a[134:135],v24 offset:12288
 v_mfma_f32_16x16x32_bf16 v[224:227],a[24:27],a[164:167],v[224:227]
 v_mfma_f32_16x16x32_bf16 v[228:231],a[28:31],a[164:167],v[228:231]
 ds_read_b64_tr_b16 a[136:137],v25 offset:0
 buffer_load_dwordx4 a[120:123],v1,s[60:63],s59 offen offset:2048 sc1
 v_mfma_f32_16x16x32_bf16 v[228:231],a[12:15],a[160:163],v[228:231]
 ds_read_b64_tr_b16 a[138:139],v25 offset:4096
 v_mfma_f32_16x16x32_bf16 v[236:239],a[12:15],a[168:171],v[236:239]
 v_mfma_f32_16x16x32_bf16 v[236:239],a[28:31],a[172:175],v[236:239]
 ds_read_b64_tr_b16 a[140:141],v25 offset:8192
 v_mfma_f32_16x16x32_bf16 v[232:235],a[24:27],a[172:175],v[232:235]
 ds_read_b64_tr_b16 a[142:143],v25 offset:12288
 buffer_load_dwordx4 a[124:127],v1,s[60:63],s59 offen offset:3072 sc1
 v_mfma_f32_16x16x32_bf16 v[232:235],a[8:11],a[168:171],v[232:235]
 v_mfma_f32_16x16x32_bf16 v[204:207],a[4:7],a[168:171],v[204:207]
 s_add_u32 m0,s3,114688
 ds_read_b64_tr_b16 a[144:145],v26 offset:0
 v_mfma_f32_16x16x32_bf16 v[204:207],a[20:23],a[172:175],v[204:207]
 s_add_u32 s41,s58,5242880
 ds_read_b64_tr_b16 a[146:147],v26 offset:4096
 v_mfma_f32_16x16x32_bf16 v[200:203],a[16:19],a[172:175],v[200:203]
 buffer_load_dwordx4 v32,s[8:11],s41 offen offset:0 lds
 v_mfma_f32_16x16x32_bf16 v[200:203],a[0:3],a[168:171],v[200:203]
 ds_read_b64_tr_b16 a[148:149],v26 offset:8192
 v_mfma_f32_16x16x32_bf16 v[208:211],a[0:3],a[176:179],v[208:211]
 ds_read_b64_tr_b16 a[150:151],v26 offset:12288
 v_mfma_f32_16x16x32_bf16 v[208:211],a[16:19],a[180:183],v[208:211]
 v_mfma_f32_16x16x32_bf16 v[212:215],a[20:23],a[180:183],v[212:215]
 ds_read_b64_tr_b16 a[152:153],v27 offset:0
 v_mfma_f32_16x16x32_bf16 v[212:215],a[4:7],a[176:179],v[212:215]
 ds_read_b64_tr_b16 a[154:155],v27 offset:4096
 buffer_load_dwordx4 v33,s[8:11],s41 offen offset:1024 lds
 v_mfma_f32_16x16x32_bf16 v[240:243],a[8:11],a[176:179],v[240:243]
 v_mfma_f32_16x16x32_bf16 v[240:243],a[24:27],a[180:183],v[240:243]
 ds_read_b64_tr_b16 a[156:157],v27 offset:8192
 v_mfma_f32_16x16x32_bf16 v[244:247],a[28:31],a[180:183],v[244:247]
 ds_read_b64_tr_b16 a[158:159],v27 offset:12288
 v_mfma_f32_16x16x32_bf16 v[244:247],a[12:15],a[176:179],v[244:247]
 buffer_load_dwordx4 v34,s[8:11],s41 offen offset:2048 lds
 v_mfma_f32_16x16x32_bf16 v[252:255],a[12:15],a[184:187],v[252:255]
 v_mfma_f32_16x16x32_bf16 v[252:255],a[28:31],a[188:191],v[252:255]
 v_mfma_f32_16x16x32_bf16 v[248:251],a[24:27],a[188:191],v[248:251]
 v_mfma_f32_16x16x32_bf16 v[248:251],a[8:11],a[184:187],v[248:251]
 buffer_load_dwordx4 v35,s[8:11],s41 offen offset:3072 lds
 v_mfma_f32_16x16x32_bf16 v[220:223],a[4:7],a[184:187],v[220:223]
 v_mfma_f32_16x16x32_bf16 v[220:223],a[20:23],a[188:191],v[220:223]
 v_mfma_f32_16x16x32_bf16 v[216:219],a[16:19],a[188:191],v[216:219]
 v_mfma_f32_16x16x32_bf16 v[216:219],a[0:3],a[184:187],v[216:219]
 s_waitcnt vmcnt(32) lgkmcnt(0)
 v_mfma_f32_16x16x32_bf16 v[128:131],a[32:35],a[128:131],v[128:131]
 ds_read_b64_tr_b16 a[160:161],v28 offset:0
 v_mfma_f32_16x16x32_bf16 v[128:131],a[48:51],a[132:135],v[128:131]
 s_add_u32 s40,s77,65536
 ds_read_b64_tr_b16 a[162:163],v28 offset:4096
 v_mfma_f32_16x16x32_bf16 v[132:135],a[52:55],a[132:135],v[132:135]
 buffer_load_dwordx4 a[0:3],v1,s[60:63],s40 offen offset:0 sc1
 v_mfma_f32_16x16x32_bf16 v[132:135],a[36:39],a[128:131],v[132:135]
 ds_read_b64_tr_b16 a[164:165],v28 offset:8192
 v_mfma_f32_16x16x32_bf16 v[136:139],a[40:43],a[128:131],v[136:139]
 ds_read_b64_tr_b16 a[166:167],v28 offset:12288
 v_mfma_f32_16x16x32_bf16 v[136:139],a[56:59],a[132:135],v[136:139]
 v_mfma_f32_16x16x32_bf16 v[140:143],a[60:63],a[132:135],v[140:143]
 ds_read_b64_tr_b16 a[168:169],v29 offset:0
 buffer_load_dwordx4 a[4:7],v1,s[60:63],s40 offen offset:1024 sc1
 v_mfma_f32_16x16x32_bf16 v[140:143],a[44:47],a[128:131],v[140:143]
 ds_read_b64_tr_b16 a[170:171],v29 offset:4096
 v_mfma_f32_16x16x32_bf16 v[156:159],a[44:47],a[136:139],v[156:159]
 v_mfma_f32_16x16x32_bf16 v[156:159],a[60:63],a[140:143],v[156:159]
 ds_read_b64_tr_b16 a[172:173],v29 offset:8192
 v_mfma_f32_16x16x32_bf16 v[152:155],a[56:59],a[140:143],v[152:155]
 ds_read_b64_tr_b16 a[174:175],v29 offset:12288
 buffer_load_dwordx4 a[16:19],v1,s[60:63],s40 offen offset:2048 sc1
 v_mfma_f32_16x16x32_bf16 v[152:155],a[40:43],a[136:139],v[152:155]
 v_mfma_f32_16x16x32_bf16 v[148:151],a[36:39],a[136:139],v[148:151]
 ds_read_b64_tr_b16 a[176:177],v30 offset:0
 v_mfma_f32_16x16x32_bf16 v[148:151],a[52:55],a[140:143],v[148:151]
 ds_read_b64_tr_b16 a[178:179],v30 offset:4096
 v_mfma_f32_16x16x32_bf16 v[144:147],a[48:51],a[140:143],v[144:147]
 buffer_load_dwordx4 a[20:23],v1,s[60:63],s40 offen offset:3072 sc1
 v_mfma_f32_16x16x32_bf16 v[144:147],a[32:35],a[136:139],v[144:147]
 ds_read_b64_tr_b16 a[180:181],v30 offset:8192
 v_mfma_f32_16x16x32_bf16 v[160:163],a[32:35],a[144:147],v[160:163]
 ds_read_b64_tr_b16 a[182:183],v30 offset:12288
 v_mfma_f32_16x16x32_bf16 v[160:163],a[48:51],a[148:151],v[160:163]
 v_mfma_f32_16x16x32_bf16 v[164:167],a[52:55],a[148:151],v[164:167]
 s_add_u32 s59,s77,294912
 ds_read_b64_tr_b16 a[184:185],v31 offset:0
 v_mfma_f32_16x16x32_bf16 v[164:167],a[36:39],a[144:147],v[164:167]
 ds_read_b64_tr_b16 a[186:187],v31 offset:4096
 buffer_load_dwordx4 a[8:11],v1,s[60:63],s59 offen offset:0 sc1
 v_mfma_f32_16x16x32_bf16 v[168:171],a[40:43],a[144:147],v[168:171]
 v_mfma_f32_16x16x32_bf16 v[168:171],a[56:59],a[148:151],v[168:171]
 ds_read_b64_tr_b16 a[188:189],v31 offset:8192
 v_mfma_f32_16x16x32_bf16 v[172:175],a[60:63],a[148:151],v[172:175]
 ds_read_b64_tr_b16 a[190:191],v31 offset:12288
 v_mfma_f32_16x16x32_bf16 v[172:175],a[44:47],a[144:147],v[172:175]
 buffer_load_dwordx4 a[12:15],v1,s[60:63],s59 offen offset:1024 sc1
 v_mfma_f32_16x16x32_bf16 v[188:191],a[44:47],a[152:155],v[188:191]
 v_mfma_f32_16x16x32_bf16 v[188:191],a[60:63],a[156:159],v[188:191]
 v_mfma_f32_16x16x32_bf16 v[184:187],a[56:59],a[156:159],v[184:187]
 v_mfma_f32_16x16x32_bf16 v[184:187],a[40:43],a[152:155],v[184:187]
 buffer_load_dwordx4 a[24:27],v1,s[60:63],s59 offen offset:2048 sc1
 v_mfma_f32_16x16x32_bf16 v[180:183],a[36:39],a[152:155],v[180:183]
 v_mfma_f32_16x16x32_bf16 v[180:183],a[52:55],a[156:159],v[180:183]
 v_mfma_f32_16x16x32_bf16 v[176:179],a[48:51],a[156:159],v[176:179]
 v_mfma_f32_16x16x32_bf16 v[176:179],a[32:35],a[152:155],v[176:179]
 s_waitcnt vmcnt(35) lgkmcnt(0)
 s_barrier
 v_mfma_f32_16x16x32_bf16 v[192:195],a[32:35],a[160:163],v[192:195]
 ds_read_b64_tr_b16 a[128:129],v16 offset:16384
 v_mfma_f32_16x16x32_bf16 v[192:195],a[48:51],a[164:167],v[192:195]
 ds_read_b64_tr_b16 a[130:131],v16 offset:20480
 v_mfma_f32_16x16x32_bf16 v[196:199],a[52:55],a[164:167],v[196:199]
 buffer_load_dwordx4 a[28:31],v1,s[60:63],s59 offen offset:3072 sc1
 v_mfma_f32_16x16x32_bf16 v[196:199],a[36:39],a[160:163],v[196:199]
 ds_read_b64_tr_b16 a[132:133],v16 offset:24576
 v_mfma_f32_16x16x32_bf16 v[224:227],a[40:43],a[160:163],v[224:227]
 ds_read_b64_tr_b16 a[134:135],v16 offset:28672
 v_mfma_f32_16x16x32_bf16 v[224:227],a[56:59],a[164:167],v[224:227]
 s_add_u32 s40,s77,81920
 v_mfma_f32_16x16x32_bf16 v[228:231],a[60:63],a[164:167],v[228:231]
 ds_read_b64_tr_b16 a[136:137],v17 offset:16384
 buffer_load_dwordx4 a[192:195],v1,s[60:63],s40 offen offset:0 sc1
 v_mfma_f32_16x16x32_bf16 v[228:231],a[44:47],a[160:163],v[228:231]
 ds_read_b64_tr_b16 a[138:139],v17 offset:20480
 v_mfma_f32_16x16x32_bf16 v[236:239],a[44:47],a[168:171],v[236:239]
 v_mfma_f32_16x16x32_bf16 v[236:239],a[60:63],a[172:175],v[236:239]
 ds_read_b64_tr_b16 a[140:141],v17 offset:24576
 v_mfma_f32_16x16x32_bf16 v[232:235],a[56:59],a[172:175],v[232:235]
 ds_read_b64_tr_b16 a[142:143],v17 offset:28672
 buffer_load_dwordx4 a[196:199],v1,s[60:63],s40 offen offset:1024 sc1
 v_mfma_f32_16x16x32_bf16 v[232:235],a[40:43],a[168:171],v[232:235]
 v_mfma_f32_16x16x32_bf16 v[204:207],a[36:39],a[168:171],v[204:207]
 ds_read_b64_tr_b16 a[144:145],v18 offset:16384
 v_mfma_f32_16x16x32_bf16 v[204:207],a[52:55],a[172:175],v[204:207]
 ds_read_b64_tr_b16 a[146:147],v18 offset:20480
 v_mfma_f32_16x16x32_bf16 v[200:203],a[48:51],a[172:175],v[200:203]
 buffer_load_dwordx4 a[208:211],v1,s[60:63],s40 offen offset:2048 sc1
 v_mfma_f32_16x16x32_bf16 v[200:203],a[32:35],a[168:171],v[200:203]
 ds_read_b64_tr_b16 a[148:149],v18 offset:24576
 v_mfma_f32_16x16x32_bf16 v[208:211],a[32:35],a[176:179],v[208:211]
 ds_read_b64_tr_b16 a[150:151],v18 offset:28672
 v_mfma_f32_16x16x32_bf16 v[208:211],a[48:51],a[180:183],v[208:211]
 v_mfma_f32_16x16x32_bf16 v[212:215],a[52:55],a[180:183],v[212:215]
 ds_read_b64_tr_b16 a[152:153],v19 offset:16384
 v_mfma_f32_16x16x32_bf16 v[212:215],a[36:39],a[176:179],v[212:215]
 ds_read_b64_tr_b16 a[154:155],v19 offset:20480
 buffer_load_dwordx4 a[212:215],v1,s[60:63],s40 offen offset:3072 sc1
 v_mfma_f32_16x16x32_bf16 v[240:243],a[40:43],a[176:179],v[240:243]
 v_mfma_f32_16x16x32_bf16 v[240:243],a[56:59],a[180:183],v[240:243]
 ds_read_b64_tr_b16 a[156:157],v19 offset:24576
 v_mfma_f32_16x16x32_bf16 v[244:247],a[60:63],a[180:183],v[244:247]
 s_add_u32 s59,s77,311296
 ds_read_b64_tr_b16 a[158:159],v19 offset:28672
 v_mfma_f32_16x16x32_bf16 v[244:247],a[44:47],a[176:179],v[244:247]
 buffer_load_dwordx4 a[200:203],v1,s[60:63],s59 offen offset:0 sc1
 v_mfma_f32_16x16x32_bf16 v[252:255],a[44:47],a[184:187],v[252:255]
 v_mfma_f32_16x16x32_bf16 v[252:255],a[60:63],a[188:191],v[252:255]
 v_mfma_f32_16x16x32_bf16 v[248:251],a[56:59],a[188:191],v[248:251]
 v_mfma_f32_16x16x32_bf16 v[248:251],a[40:43],a[184:187],v[248:251]
 buffer_load_dwordx4 a[204:207],v1,s[60:63],s59 offen offset:1024 sc1
 v_mfma_f32_16x16x32_bf16 v[220:223],a[36:39],a[184:187],v[220:223]
 v_mfma_f32_16x16x32_bf16 v[220:223],a[52:55],a[188:191],v[220:223]
 v_mfma_f32_16x16x32_bf16 v[216:219],a[48:51],a[188:191],v[216:219]
 v_mfma_f32_16x16x32_bf16 v[216:219],a[32:35],a[184:187],v[216:219]
 s_waitcnt vmcnt(34) lgkmcnt(0)
 v_mfma_f32_16x16x32_bf16 v[128:131],a[64:67],a[128:131],v[128:131]
 ds_read_b64_tr_b16 a[160:161],v20 offset:16384
 v_mfma_f32_16x16x32_bf16 v[128:131],a[80:83],a[132:135],v[128:131]
 ds_read_b64_tr_b16 a[162:163],v20 offset:20480
 v_mfma_f32_16x16x32_bf16 v[132:135],a[84:87],a[132:135],v[132:135]
 buffer_load_dwordx4 a[216:219],v1,s[60:63],s59 offen offset:2048 sc1
 v_mfma_f32_16x16x32_bf16 v[132:135],a[68:71],a[128:131],v[132:135]
 ds_read_b64_tr_b16 a[164:165],v20 offset:24576
 v_mfma_f32_16x16x32_bf16 v[136:139],a[72:75],a[128:131],v[136:139]
 ds_read_b64_tr_b16 a[166:167],v20 offset:28672
 v_mfma_f32_16x16x32_bf16 v[136:139],a[88:91],a[132:135],v[136:139]
 v_mfma_f32_16x16x32_bf16 v[140:143],a[92:95],a[132:135],v[140:143]
 ds_read_b64_tr_b16 a[168:169],v21 offset:16384
 buffer_load_dwordx4 a[220:223],v1,s[60:63],s59 offen offset:3072 sc1
 v_mfma_f32_16x16x32_bf16 v[140:143],a[76:79],a[128:131],v[140:143]
 ds_read_b64_tr_b16 a[170:171],v21 offset:20480
 v_mfma_f32_16x16x32_bf16 v[156:159],a[76:79],a[136:139],v[156:159]
 v_mfma_f32_16x16x32_bf16 v[156:159],a[92:95],a[140:143],v[156:159]
 s_add_u32 s40,s77,73728
 ds_read_b64_tr_b16 a[172:173],v21 offset:24576
 v_mfma_f32_16x16x32_bf16 v[152:155],a[88:91],a[140:143],v[152:155]
 ds_read_b64_tr_b16 a[174:175],v21 offset:28672
 buffer_load_dwordx4 a[32:35],v1,s[60:63],s40 offen offset:0 sc1
 v_mfma_f32_16x16x32_bf16 v[152:155],a[72:75],a[136:139],v[152:155]
 v_mfma_f32_16x16x32_bf16 v[148:151],a[68:71],a[136:139],v[148:151]
 ds_read_b64_tr_b16 a[176:177],v22 offset:16384
 v_mfma_f32_16x16x32_bf16 v[148:151],a[84:87],a[140:143],v[148:151]
 ds_read_b64_tr_b16 a[178:179],v22 offset:20480
 v_mfma_f32_16x16x32_bf16 v[144:147],a[80:83],a[140:143],v[144:147]
 buffer_load_dwordx4 a[36:39],v1,s[60:63],s40 offen offset:1024 sc1
 v_mfma_f32_16x16x32_bf16 v[144:147],a[64:67],a[136:139],v[144:147]
 ds_read_b64_tr_b16 a[180:181],v22 offset:24576
 v_mfma_f32_16x16x32_bf16 v[160:163],a[64:67],a[144:147],v[160:163]
 ds_read_b64_tr_b16 a[182:183],v22 offset:28672
 v_mfma_f32_16x16x32_bf16 v[160:163],a[80:83],a[148:151],v[160:163]
 v_mfma_f32_16x16x32_bf16 v[164:167],a[84:87],a[148:151],v[164:167]
 ds_read_b64_tr_b16 a[184:185],v23 offset:16384
 v_mfma_f32_16x16x32_bf16 v[164:167],a[68:71],a[144:147],v[164:167]
 ds_read_b64_tr_b16 a[186:187],v23 offset:20480
 buffer_load_dwordx4 a[48:51],v1,s[60:63],s40 offen offset:2048 sc1
 v_mfma_f32_16x16x32_bf16 v[168:171],a[72:75],a[144:147],v[168:171]
 v_mfma_f32_16x16x32_bf16 v[168:171],a[88:91],a[148:151],v[168:171]
 ds_read_b64_tr_b16 a[188:189],v23 offset:24576
 v_mfma_f32_16x16x32_bf16 v[172:175],a[92:95],a[148:151],v[172:175]
 ds_read_b64_tr_b16 a[190:191],v23 offset:28672
 v_mfma_f32_16x16x32_bf16 v[172:175],a[76:79],a[144:147],v[172:175]
 buffer_load_dwordx4 a[52:55],v1,s[60:63],s40 offen offset:3072 sc1
 v_mfma_f32_16x16x32_bf16 v[188:191],a[76:79],a[152:155],v[188:191]
 v_mfma_f32_16x16x32_bf16 v[188:191],a[92:95],a[156:159],v[188:191]
 v_mfma_f32_16x16x32_bf16 v[184:187],a[88:91],a[156:159],v[184:187]
 s_add_u32 s59,s77,303104
 v_mfma_f32_16x16x32_bf16 v[184:187],a[72:75],a[152:155],v[184:187]
 buffer_load_dwordx4 a[40:43],v1,s[60:63],s59 offen offset:0 sc1
 v_mfma_f32_16x16x32_bf16 v[180:183],a[68:71],a[152:155],v[180:183]
 v_mfma_f32_16x16x32_bf16 v[180:183],a[84:87],a[156:159],v[180:183]
 v_mfma_f32_16x16x32_bf16 v[176:179],a[80:83],a[156:159],v[176:179]
 v_mfma_f32_16x16x32_bf16 v[176:179],a[64:67],a[152:155],v[176:179]
 s_waitcnt vmcnt(37) lgkmcnt(0)
 s_barrier
 v_mfma_f32_16x16x32_bf16 v[192:195],a[64:67],a[160:163],v[192:195]
 ds_read_b64_tr_b16 a[128:129],v24 offset:16384
 v_mfma_f32_16x16x32_bf16 v[192:195],a[80:83],a[164:167],v[192:195]
 ds_read_b64_tr_b16 a[130:131],v24 offset:20480
 v_mfma_f32_16x16x32_bf16 v[196:199],a[84:87],a[164:167],v[196:199]
 buffer_load_dwordx4 a[44:47],v1,s[60:63],s59 offen offset:1024 sc1
 v_mfma_f32_16x16x32_bf16 v[196:199],a[68:71],a[160:163],v[196:199]
 ds_read_b64_tr_b16 a[132:133],v24 offset:24576
 v_mfma_f32_16x16x32_bf16 v[224:227],a[72:75],a[160:163],v[224:227]
 ds_read_b64_tr_b16 a[134:135],v24 offset:28672
 v_mfma_f32_16x16x32_bf16 v[224:227],a[88:91],a[164:167],v[224:227]
 v_mfma_f32_16x16x32_bf16 v[228:231],a[92:95],a[164:167],v[228:231]
 ds_read_b64_tr_b16 a[136:137],v25 offset:16384
 buffer_load_dwordx4 a[56:59],v1,s[60:63],s59 offen offset:2048 sc1
 v_mfma_f32_16x16x32_bf16 v[228:231],a[76:79],a[160:163],v[228:231]
 ds_read_b64_tr_b16 a[138:139],v25 offset:20480
 v_mfma_f32_16x16x32_bf16 v[236:239],a[76:79],a[168:171],v[236:239]
 v_mfma_f32_16x16x32_bf16 v[236:239],a[92:95],a[172:175],v[236:239]
 ds_read_b64_tr_b16 a[140:141],v25 offset:24576
 v_mfma_f32_16x16x32_bf16 v[232:235],a[88:91],a[172:175],v[232:235]
 ds_read_b64_tr_b16 a[142:143],v25 offset:28672
 buffer_load_dwordx4 a[60:63],v1,s[60:63],s59 offen offset:3072 sc1
 v_mfma_f32_16x16x32_bf16 v[232:235],a[72:75],a[168:171],v[232:235]
 v_mfma_f32_16x16x32_bf16 v[204:207],a[68:71],a[168:171],v[204:207]
 ds_read_b64_tr_b16 a[144:145],v26 offset:16384
 v_mfma_f32_16x16x32_bf16 v[204:207],a[84:87],a[172:175],v[204:207]
 s_add_u32 s40,s77,90112
 ds_read_b64_tr_b16 a[146:147],v26 offset:20480
 v_mfma_f32_16x16x32_bf16 v[200:203],a[80:83],a[172:175],v[200:203]
 buffer_load_dwordx4 a[224:227],v1,s[60:63],s40 offen offset:0 sc1
 v_mfma_f32_16x16x32_bf16 v[200:203],a[64:67],a[168:171],v[200:203]
 ds_read_b64_tr_b16 a[148:149],v26 offset:24576
 v_mfma_f32_16x16x32_bf16 v[208:211],a[64:67],a[176:179],v[208:211]
 ds_read_b64_tr_b16 a[150:151],v26 offset:28672
 v_mfma_f32_16x16x32_bf16 v[208:211],a[80:83],a[180:183],v[208:211]
 v_mfma_f32_16x16x32_bf16 v[212:215],a[84:87],a[180:183],v[212:215]
 ds_read_b64_tr_b16 a[152:153],v27 offset:16384
 v_mfma_f32_16x16x32_bf16 v[212:215],a[68:71],a[176:179],v[212:215]
 ds_read_b64_tr_b16 a[154:155],v27 offset:20480
 buffer_load_dwordx4 a[228:231],v1,s[60:63],s40 offen offset:1024 sc1
 v_mfma_f32_16x16x32_bf16 v[240:243],a[72:75],a[176:179],v[240:243]
 v_mfma_f32_16x16x32_bf16 v[240:243],a[88:91],a[180:183],v[240:243]
 ds_read_b64_tr_b16 a[156:157],v27 offset:24576
 v_mfma_f32_16x16x32_bf16 v[244:247],a[92:95],a[180:183],v[244:247]
 ds_read_b64_tr_b16 a[158:159],v27 offset:28672
 v_mfma_f32_16x16x32_bf16 v[244:247],a[76:79],a[176:179],v[244:247]
 buffer_load_dwordx4 a[240:243],v1,s[60:63],s40 offen offset:2048 sc1
 v_mfma_f32_16x16x32_bf16 v[252:255],a[76:79],a[184:187],v[252:255]
 v_mfma_f32_16x16x32_bf16 v[252:255],a[92:95],a[188:191],v[252:255]
 v_mfma_f32_16x16x32_bf16 v[248:251],a[88:91],a[188:191],v[248:251]
 v_mfma_f32_16x16x32_bf16 v[248:251],a[72:75],a[184:187],v[248:251]
 buffer_load_dwordx4 a[244:247],v1,s[60:63],s40 offen offset:3072 sc1
 v_mfma_f32_16x16x32_bf16 v[220:223],a[68:71],a[184:187],v[220:223]
 v_mfma_f32_16x16x32_bf16 v[220:223],a[84:87],a[188:191],v[220:223]
 v_mfma_f32_16x16x32_bf16 v[216:219],a[80:83],a[188:191],v[216:219]
 v_mfma_f32_16x16x32_bf16 v[216:219],a[64:67],a[184:187],v[216:219]
 s_waitcnt vmcnt(32) lgkmcnt(0)
 v_mfma_f32_16x16x32_bf16 v[128:131],a[96:99],a[128:131],v[128:131]
 ds_read_b64_tr_b16 a[160:161],v28 offset:16384
 v_mfma_f32_16x16x32_bf16 v[128:131],a[112:115],a[132:135],v[128:131]
 s_add_u32 s59,s77,319488
 ds_read_b64_tr_b16 a[162:163],v28 offset:20480
 v_mfma_f32_16x16x32_bf16 v[132:135],a[116:119],a[132:135],v[132:135]
 buffer_load_dwordx4 a[232:235],v1,s[60:63],s59 offen offset:0 sc1
 v_mfma_f32_16x16x32_bf16 v[132:135],a[100:103],a[128:131],v[132:135]
 ds_read_b64_tr_b16 a[164:165],v28 offset:24576
 v_mfma_f32_16x16x32_bf16 v[136:139],a[104:107],a[128:131],v[136:139]
 ds_read_b64_tr_b16 a[166:167],v28 offset:28672
 v_mfma_f32_16x16x32_bf16 v[136:139],a[120:123],a[132:135],v[136:139]
 v_mfma_f32_16x16x32_bf16 v[140:143],a[124:127],a[132:135],v[140:143]
 ds_read_b64_tr_b16 a[168:169],v29 offset:16384
 v_mfma_f32_16x16x32_bf16 v[140:143],a[108:111],a[128:131],v[140:143]
 ds_read_b64_tr_b16 a[170:171],v29 offset:20480
 buffer_load_dwordx4 a[236:239],v1,s[60:63],s59 offen offset:1024 sc1
 v_mfma_f32_16x16x32_bf16 v[156:159],a[108:111],a[136:139],v[156:159]
 v_mfma_f32_16x16x32_bf16 v[156:159],a[124:127],a[140:143],v[156:159]
 ds_read_b64_tr_b16 a[172:173],v29 offset:24576
 v_mfma_f32_16x16x32_bf16 v[152:155],a[120:123],a[140:143],v[152:155]
 ds_read_b64_tr_b16 a[174:175],v29 offset:28672
 v_mfma_f32_16x16x32_bf16 v[152:155],a[104:107],a[136:139],v[152:155]
 v_mfma_f32_16x16x32_bf16 v[148:151],a[100:103],a[136:139],v[148:151]
 ds_read_b64_tr_b16 a[176:177],v30 offset:16384
 buffer_load_dwordx4 a[248:251],v1,s[60:63],s59 offen offset:2048 sc1
 v_mfma_f32_16x16x32_bf16 v[148:151],a[116:119],a[140:143],v[148:151]
 ds_read_b64_tr_b16 a[178:179],v30 offset:20480
 v_mfma_f32_16x16x32_bf16 v[144:147],a[112:115],a[140:143],v[144:147]
 v_mfma_f32_16x16x32_bf16 v[144:147],a[96:99],a[136:139],v[144:147]
 ds_read_b64_tr_b16 a[180:181],v30 offset:24576
 v_mfma_f32_16x16x32_bf16 v[160:163],a[96:99],a[144:147],v[160:163]
 ds_read_b64_tr_b16 a[182:183],v30 offset:28672
 v_mfma_f32_16x16x32_bf16 v[160:163],a[112:115],a[148:151],v[160:163]
 buffer_load_dwordx4 a[252:255],v1,s[60:63],s59 offen offset:3072 sc1
 v_mfma_f32_16x16x32_bf16 v[164:167],a[116:119],a[148:151],v[164:167]
 ds_read_b64_tr_b16 a[184:185],v31 offset:16384
 v_mfma_f32_16x16x32_bf16 v[164:167],a[100:103],a[144:147],v[164:167]
 ds_read_b64_tr_b16 a[186:187],v31 offset:20480
 v_mfma_f32_16x16x32_bf16 v[168:171],a[104:107],a[144:147],v[168:171]
 v_mfma_f32_16x16x32_bf16 v[168:171],a[120:123],a[148:151],v[168:171]
 s_mov_b32 s47,0
 ds_read_b64_tr_b16 a[188:189],v31 offset:24576
 v_mfma_f32_16x16x32_bf16 v[172:175],a[124:127],a[148:151],v[172:175]
 ds_read_b64_tr_b16 a[190:191],v31 offset:28672
 buffer_load_dwordx4 v[64:67],v56,s[72:75],s47 offen
 v_mfma_f32_16x16x32_bf16 v[172:175],a[108:111],a[144:147],v[172:175]
 v_mfma_f32_16x16x32_bf16 v[188:191],a[108:111],a[152:155],v[188:191]
 v_mfma_f32_16x16x32_bf16 v[188:191],a[124:127],a[156:159],v[188:191]
 v_mfma_f32_16x16x32_bf16 v[184:187],a[120:123],a[156:159],v[184:187]
 s_mov_b32 s47,32768
 v_mfma_f32_16x16x32_bf16 v[184:187],a[104:107],a[152:155],v[184:187]
 buffer_load_dwordx4 v[68:71],v56,s[72:75],s47 offen
 v_mfma_f32_16x16x32_bf16 v[180:183],a[100:103],a[152:155],v[180:183]
 v_mfma_f32_16x16x32_bf16 v[180:183],a[116:119],a[156:159],v[180:183]
 v_mfma_f32_16x16x32_bf16 v[176:179],a[112:115],a[156:159],v[176:179]
 v_mfma_f32_16x16x32_bf16 v[176:179],a[96:99],a[152:155],v[176:179]
 s_waitcnt vmcnt(34) lgkmcnt(0)
 s_barrier
 v_mfma_f32_16x16x32_bf16 v[192:195],a[96:99],a[160:163],v[192:195]
 ds_read_b64_tr_b16 a[128:129],v16 offset:32768
 v_mfma_f32_16x16x32_bf16 v[192:195],a[112:115],a[164:167],v[192:195]
 s_mov_b32 s47,65536
 ds_read_b64_tr_b16 a[130:131],v16 offset:36864
 v_mfma_f32_16x16x32_bf16 v[196:199],a[116:119],a[164:167],v[196:199]
 buffer_load_dwordx4 v[72:75],v56,s[72:75],s47 offen
 v_mfma_f32_16x16x32_bf16 v[196:199],a[100:103],a[160:163],v[196:199]
 ds_read_b64_tr_b16 a[132:133],v16 offset:40960
 v_mfma_f32_16x16x32_bf16 v[224:227],a[104:107],a[160:163],v[224:227]
 ds_read_b64_tr_b16 a[134:135],v16 offset:45056
 v_mfma_f32_16x16x32_bf16 v[224:227],a[120:123],a[164:167],v[224:227]
 v_mfma_f32_16x16x32_bf16 v[228:231],a[124:127],a[164:167],v[228:231]
 ds_read_b64_tr_b16 a[136:137],v24 offset:32768
 v_mfma_f32_16x16x32_bf16 v[228:231],a[108:111],a[160:163],v[228:231]
 ds_read_b64_tr_b16 a[138:139],v24 offset:36864
 v_mfma_f32_16x16x32_bf16 v[236:239],a[108:111],a[168:171],v[236:239]
 v_mfma_f32_16x16x32_bf16 v[236:239],a[124:127],a[172:175],v[236:239]
 ds_read_b64_tr_b16 a[140:141],v24 offset:40960
 v_mfma_f32_16x16x32_bf16 v[232:235],a[120:123],a[172:175],v[232:235]
 ds_read_b64_tr_b16 a[142:143],v24 offset:45056
 v_mfma_f32_16x16x32_bf16 v[232:235],a[104:107],a[168:171],v[232:235]
 v_mfma_f32_16x16x32_bf16 v[204:207],a[100:103],a[168:171],v[204:207]
 ds_read_b64_tr_b16 a[144:145],v16 offset:49152
 v_mfma_f32_16x16x32_bf16 v[204:207],a[116:119],a[172:175],v[204:207]
 ds_read_b64_tr_b16 a[146:147],v16 offset:53248
 v_mfma_f32_16x16x32_bf16 v[200:203],a[112:115],a[172:175],v[200:203]
 v_mfma_f32_16x16x32_bf16 v[200:203],a[96:99],a[168:171],v[200:203]
 ds_read_b64_tr_b16 a[148:149],v16 offset:57344
 v_mfma_f32_16x16x32_bf16 v[208:211],a[96:99],a[176:179],v[208:211]
 s_mov_b32 s47,98304
 ds_read_b64_tr_b16 a[150:151],v16 offset:61440
 v_mfma_f32_16x16x32_bf16 v[208:211],a[112:115],a[180:183],v[208:211]
 buffer_load_dwordx4 v[76:79],v56,s[72:75],s47 offen
 v_mfma_f32_16x16x32_bf16 v[212:215],a[116:119],a[180:183],v[212:215]
 ds_read_b64_tr_b16 a[152:153],v24 offset:49152
 v_mfma_f32_16x16x32_bf16 v[212:215],a[100:103],a[176:179],v[212:215]
 ds_read_b64_tr_b16 a[154:155],v24 offset:53248
 v_mfma_f32_16x16x32_bf16 v[240:243],a[104:107],a[176:179],v[240:243]
 v_mfma_f32_16x16x32_bf16 v[240:243],a[120:123],a[180:183],v[240:243]
 ds_read_b64_tr_b16 a[156:157],v24 offset:57344
 v_mfma_f32_16x16x32_bf16 v[244:247],a[124:127],a[180:183],v[244:247]
 ds_read_b64_tr_b16 a[158:159],v24 offset:61440
 v_mfma_f32_16x16x32_bf16 v[244:247],a[108:111],a[176:179],v[244:247]
 v_mfma_f32_16x16x32_bf16 v[252:255],a[108:111],a[184:187],v[252:255]
 v_mfma_f32_16x16x32_bf16 v[252:255],a[124:127],a[188:191],v[252:255]
 v_mfma_f32_16x16x32_bf16 v[248:251],a[120:123],a[188:191],v[248:251]
 v_mfma_f32_16x16x32_bf16 v[248:251],a[104:107],a[184:187],v[248:251]
 v_mfma_f32_16x16x32_bf16 v[220:223],a[100:103],a[184:187],v[220:223]
 v_mfma_f32_16x16x32_bf16 v[220:223],a[116:119],a[188:191],v[220:223]
 v_mfma_f32_16x16x32_bf16 v[216:219],a[112:115],a[188:191],v[216:219]
 v_mfma_f32_16x16x32_bf16 v[216:219],a[96:99],a[184:187],v[216:219]
 s_waitcnt vmcnt(4) lgkmcnt(0)
 v_mfma_f32_16x16x32_bf16 v[128:131],a[0:3],a[128:131],v[128:131]
 ds_read_b64_tr_b16 a[160:161],v17 offset:32768
 v_mfma_f32_16x16x32_bf16 v[128:131],a[16:19],a[132:135],v[128:131]
 ds_read_b64_tr_b16 a[162:163],v17 offset:36864
 v_mfma_f32_16x16x32_bf16 v[128:131],a[32:35],a[136:139],v[128:131]
 ds_read_b64_tr_b16 a[164:165],v17 offset:40960
 v_mfma_f32_16x16x32_bf16 v[128:131],a[48:51],a[140:143],v[128:131]
 ds_read_b64_tr_b16 a[166:167],v17 offset:45056
 v_mfma_f32_16x16x32_bf16 v[132:135],a[52:55],a[140:143],v[132:135]
 ds_read_b64_tr_b16 a[168:169],v25 offset:32768
 v_mfma_f32_16x16x32_bf16 v[132:135],a[36:39],a[136:139],v[132:135]
 ds_read_b64_tr_b16 a[170:171],v25 offset:36864
 v_mfma_f32_16x16x32_bf16 v[132:135],a[20:23],a[132:135],v[132:135]
 ds_read_b64_tr_b16 a[172:173],v25 offset:40960
 v_mfma_f32_16x16x32_bf16 v[132:135],a[4:7],a[128:131],v[132:135]
 ds_read_b64_tr_b16 a[174:175],v25 offset:45056
 s_waitcnt lgkmcnt(8)
 v_mfma_f32_16x16x32_bf16 v[128:131],a[192:195],a[144:147],v[128:131]
 ds_read_b64_tr_b16 a[176:177],v17 offset:49152
 v_mfma_f32_16x16x32_bf16 v[128:131],a[208:211],a[148:151],v[128:131]
 ds_read_b64_tr_b16 a[178:179],v17 offset:53248
 v_mfma_f32_16x16x32_bf16 v[128:131],a[224:227],a[152:155],v[128:131]
 ds_read_b64_tr_b16 a[180:181],v17 offset:57344
 v_mfma_f32_16x16x32_bf16 v[128:131],a[240:243],a[156:159],v[128:131]
 ds_read_b64_tr_b16 a[182:183],v17 offset:61440
 v_mfma_f32_16x16x32_bf16 v[132:135],a[244:247],a[156:159],v[132:135]
 ds_read_b64_tr_b16 a[184:185],v25 offset:49152
 v_mfma_f32_16x16x32_bf16 v[132:135],a[228:231],a[152:155],v[132:135]
 ds_read_b64_tr_b16 a[186:187],v25 offset:53248
 v_mfma_f32_16x16x32_bf16 v[132:135],a[212:215],a[148:151],v[132:135]
 ds_read_b64_tr_b16 a[188:189],v25 offset:57344
 v_mfma_f32_16x16x32_bf16 v[132:135],a[196:199],a[144:147],v[132:135]
 ds_read_b64_tr_b16 a[190:191],v25 offset:61440
 s_waitcnt lgkmcnt(8)
 v_mfma_f32_16x16x32_bf16 v[144:147],a[0:3],a[160:163],v[144:147]
L_stub_m_4:
 s_cbranch_execz L_warm_m_ret
 ds_read_b64_tr_b16 a[128:129],v18 offset:32768
 v_mfma_f32_16x16x32_bf16 v[144:147],a[16:19],a[164:167],v[144:147]
 ds_read_b64_tr_b16 a[130:131],v18 offset:36864
 v_mfma_f32_16x16x32_bf16 v[144:147],a[32:35],a[168:171],v[144:147]
 ds_read_b64_tr_b16 a[132:133],v18 offset:40960
 v_cvt_pk_bf16_f32 v8,v128,v129
 v_mfma_f32_16x16x32_bf16 v[144:147],a[48:51],a[172:175],v[144:147]
 ds_read_b64_tr_b16 a[134:135],v18 offset:45056
 v_cvt_pk_bf16_f32 v9,v130,v131
 v_mfma_f32_16x16x32_bf16 v[148:151],a[52:55],a[172:175],v[148:151]
 ds_read_b64_tr_b16 a[136:137],v26 offset:32768
 v_cvt_pk_bf16_f32 v10,v132,v133
 v_mfma_f32_16x16x32_bf16 v[148:151],a[36:39],a[168:171],v[148:151]
 ds_read_b64_tr_b16 a[138:139],v26 offset:36864
 v_cvt_pk_bf16_f32 v11,v134,v135
 v_mfma_f32_16x16x32_bf16 v[148:151],a[20:23],a[164:167],v[148:151]
 ds_read_b64_tr_b16 a[140:141],v26 offset:40960
 v_min_u32 v8,-2,v8
 v_mfma_f32_16x16x32_bf16 v[148:151],a[4:7],a[160:163],v[148:151]
 ds_read_b64_tr_b16 a[142:143],v26 offset:45056
 s_waitcnt lgkmcnt(8)
 v_min_u32 v9,-2,v9
 v_mfma_f32_16x16x32_bf16 v[144:147],a[192:195],a[176:179],v[144:147]
 ds_read_b64_tr_b16 a[144:145],v18 offset:49152
 v_min_u32 v10,-2,v10
 v_mfma_f32_16x16x32_bf16 v[144:147],a[208:211],a[180:183],v[144:147]
 ds_read_b64_tr_b16 a[146:147],v18 offset:53248
 v_min_u32 v11,-2,v11
 v_mfma_f32_16x16x32_bf16 v[144:147],a[224:227],a[184:187],v[144:147]
 s_add_u32 s46,s12,0
 ds_read_b64_tr_b16 a[148:149],v18 offset:57344
 buffer_store_dwordx4 v[8:11],v1,s[20:23],s46 offen sc1
 v_mfma_f32_16x16x32_bf16 v[144:147],a[240:243],a[188:191],v[144:147]
 ds_read_b64_tr_b16 a[150:151],v18 offset:61440
 v_mfma_f32_16x16x32_bf16 v[148:151],a[244:247],a[188:191],v[148:151]
 ds_read_b64_tr_b16 a[152:153],v26 offset:49152
 v_mfma_f32_16x16x32_bf16 v[148:151],a[228:231],a[184:187],v[148:151]
 ds_read_b64_tr_b16 a[154:155],v26 offset:53248
 v_mfma_f32_16x16x32_bf16 v[148:151],a[212:215],a[180:183],v[148:151]
 ds_read_b64_tr_b16 a[156:157],v26 offset:57344
 v_mfma_f32_16x16x32_bf16 v[148:151],a[196:199],a[176:179],v[148:151]
 ds_read_b64_tr_b16 a[158:159],v26 offset:61440
 s_waitcnt lgkmcnt(8)
 v_mfma_f32_16x16x32_bf16 v[160:163],a[0:3],a[128:131],v[160:163]
 ds_read_b64_tr_b16 a[160:161],v19 offset:32768
 v_mfma_f32_16x16x32_bf16 v[160:163],a[16:19],a[132:135],v[160:163]
 ds_read_b64_tr_b16 a[162:163],v19 offset:36864
 v_mfma_f32_16x16x32_bf16 v[160:163],a[32:35],a[136:139],v[160:163]
 ds_read_b64_tr_b16 a[164:165],v19 offset:40960
 v_cvt_pk_bf16_f32 v12,v144,v145
 v_mfma_f32_16x16x32_bf16 v[160:163],a[48:51],a[140:143],v[160:163]
 ds_read_b64_tr_b16 a[166:167],v19 offset:45056
 v_cvt_pk_bf16_f32 v13,v146,v147
 v_mfma_f32_16x16x32_bf16 v[164:167],a[52:55],a[140:143],v[164:167]
 ds_read_b64_tr_b16 a[168:169],v27 offset:32768
 v_cvt_pk_bf16_f32 v14,v148,v149
 v_mfma_f32_16x16x32_bf16 v[164:167],a[36:39],a[136:139],v[164:167]
 ds_read_b64_tr_b16 a[170:171],v27 offset:36864
 v_cvt_pk_bf16_f32 v15,v150,v151
 v_mfma_f32_16x16x32_bf16 v[164:167],a[20:23],a[132:135],v[164:167]
 ds_read_b64_tr_b16 a[172:173],v27 offset:40960
 v_min_u32 v12,-2,v12
 v_mfma_f32_16x16x32_bf16 v[164:167],a[4:7],a[128:131],v[164:167]
 ds_read_b64_tr_b16 a[174:175],v27 offset:45056
 s_waitcnt lgkmcnt(8)
 v_min_u32 v13,-2,v13
 v_mfma_f32_16x16x32_bf16 v[160:163],a[192:195],a[144:147],v[160:163]
 ds_read_b64_tr_b16 a[176:177],v19 offset:49152
 v_min_u32 v14,-2,v14
 v_mfma_f32_16x16x32_bf16 v[160:163],a[208:211],a[148:151],v[160:163]
 ds_read_b64_tr_b16 a[178:179],v19 offset:53248
 v_min_u32 v15,-2,v15
 v_mfma_f32_16x16x32_bf16 v[160:163],a[224:227],a[152:155],v[160:163]
 s_add_u32 s46,s12,32768
 ds_read_b64_tr_b16 a[180:181],v19 offset:57344
 buffer_store_dwordx4 v[12:15],v1,s[20:23],s46 offen sc1
 v_mfma_f32_16x16x32_bf16 v[160:163],a[240:243],a[156:159],v[160:163]
 ds_read_b64_tr_b16 a[182:183],v19 offset:61440
 v_mfma_f32_16x16x32_bf16 v[164:167],a[244:247],a[156:159],v[164:167]
 ds_read_b64_tr_b16 a[184:185],v27 offset:49152
 v_mfma_f32_16x16x32_bf16 v[164:167],a[228:231],a[152:155],v[164:167]
 ds_read_b64_tr_b16 a[186:187],v27 offset:53248
 v_mfma_f32_16x16x32_bf16 v[164:167],a[212:215],a[148:151],v[164:167]
 ds_read_b64_tr_b16 a[188:189],v27 offset:57344
 v_mfma_f32_16x16x32_bf16 v[164:167],a[196:199],a[144:147],v[164:167]
 ds_read_b64_tr_b16 a[190:191],v27 offset:61440
 s_waitcnt lgkmcnt(8)
 v_mfma_f32_16x16x32_bf16 v[176:179],a[0:3],a[160:163],v[176:179]
 ds_read_b64_tr_b16 a[128:129],v20 offset:32768
 v_mfma_f32_16x16x32_bf16 v[176:179],a[16:19],a[164:167],v[176:179]
 ds_read_b64_tr_b16 a[130:131],v20 offset:36864
 v_mfma_f32_16x16x32_bf16 v[176:179],a[32:35],a[168:171],v[176:179]
 ds_read_b64_tr_b16 a[132:133],v20 offset:40960
 v_cvt_pk_bf16_f32 v44,v160,v161
 v_mfma_f32_16x16x32_bf16 v[176:179],a[48:51],a[172:175],v[176:179]
 ds_read_b64_tr_b16 a[134:135],v20 offset:45056
 v_cvt_pk_bf16_f32 v45,v162,v163
 v_mfma_f32_16x16x32_bf16 v[180:183],a[52:55],a[172:175],v[180:183]
 ds_read_b64_tr_b16 a[136:137],v28 offset:32768
 v_cvt_pk_bf16_f32 v46,v164,v165
 v_mfma_f32_16x16x32_bf16 v[180:183],a[36:39],a[168:171],v[180:183]
 ds_read_b64_tr_b16 a[138:139],v28 offset:36864
 v_cvt_pk_bf16_f32 v47,v166,v167
 v_mfma_f32_16x16x32_bf16 v[180:183],a[20:23],a[164:167],v[180:183]
 ds_read_b64_tr_b16 a[140:141],v28 offset:40960
 v_min_u32 v44,-2,v44
 v_mfma_f32_16x16x32_bf16 v[180:183],a[4:7],a[160:163],v[180:183]
 ds_read_b64_tr_b16 a[142:143],v28 offset:45056
 s_waitcnt lgkmcnt(8)
 v_min_u32 v45,-2,v45
 v_mfma_f32_16x16x32_bf16 v[176:179],a[192:195],a[176:179],v[176:179]
 ds_read_b64_tr_b16 a[144:145],v20 offset:49152
 v_min_u32 v46,-2,v46
 v_mfma_f32_16x16x32_bf16 v[176:179],a[208:211],a[180:183],v[176:179]
 ds_read_b64_tr_b16 a[146:147],v20 offset:53248
 v_min_u32 v47,-2,v47
 v_mfma_f32_16x16x32_bf16 v[176:179],a[224:227],a[184:187],v[176:179]
 s_add_u32 s46,s12,65536
 ds_read_b64_tr_b16 a[148:149],v20 offset:57344
 buffer_store_dwordx4 v[44:47],v1,s[20:23],s46 offen sc1
 v_mfma_f32_16x16x32_bf16 v[176:179],a[240:243],a[188:191],v[176:179]
 ds_read_b64_tr_b16 a[150:151],v20 offset:61440
 v_mfma_f32_16x16x32_bf16 v[180:183],a[244:247],a[188:191],v[180:183]
 ds_read_b64_tr_b16 a[152:153],v28 offset:49152
 v_mfma_f32_16x16x32_bf16 v[180:183],a[228:231],a[184:187],v[180:183]
 ds_read_b64_tr_b16 a[154:155],v28 offset:53248
 v_mfma_f32_16x16x32_bf16 v[180:183],a[212:215],a[180:183],v[180:183]
 ds_read_b64_tr_b16 a[156:157],v28 offset:57344
 v_mfma_f32_16x16x32_bf16 v[180:183],a[196:199],a[176:179],v[180:183]
 ds_read_b64_tr_b16 a[158:159],v28 offset:61440
 s_waitcnt lgkmcnt(8)
 v_mfma_f32_16x16x32_bf16 v[192:195],a[0:3],a[128:131],v[192:195]
 ds_read_b64_tr_b16 a[160:161],v21 offset:32768
 v_mfma_f32_16x16x32_bf16 v[192:195],a[16:19],a[132:135],v[192:195]
 ds_read_b64_tr_b16 a[162:163],v21 offset:36864
 v_mfma_f32_16x16x32_bf16 v[192:195],a[32:35],a[136:139],v[192:195]
 ds_read_b64_tr_b16 a[164:165],v21 offset:40960
 v_cvt_pk_bf16_f32 v48,v176,v177
 v_mfma_f32_16x16x32_bf16 v[192:195],a[48:51],a[140:143],v[192:195]
 ds_read_b64_tr_b16 a[166:167],v21 offset:45056
 v_cvt_pk_bf16_f32 v49,v178,v179
 v_mfma_f32_16x16x32_bf16 v[196:199],a[52:55],a[140:143],v[196:199]
 ds_read_b64_tr_b16 a[168:169],v29 offset:32768
 v_cvt_pk_bf16_f32 v50,v180,v181
 v_mfma_f32_16x16x32_bf16 v[196:199],a[36:39],a[136:139],v[196:199]
 ds_read_b64_tr_b16 a[170:171],v29 offset:36864
 v_cvt_pk_bf16_f32 v51,v182,v183
 v_mfma_f32_16x16x32_bf16 v[196:199],a[20:23],a[132:135],v[196:199]
 ds_read_b64_tr_b16 a[172:173],v29 offset:40960
 v_min_u32 v48,-2,v48
 v_mfma_f32_16x16x32_bf16 v[196:199],a[4:7],a[128:131],v[196:199]
 ds_read_b64_tr_b16 a[174:175],v29 offset:45056
 s_waitcnt lgkmcnt(8)
 v_min_u32 v49,-2,v49
 v_mfma_f32_16x16x32_bf16 v[192:195],a[192:195],a[144:147],v[192:195]
 ds_read_b64_tr_b16 a[176:177],v21 offset:49152
 v_min_u32 v50,-2,v50
 v_mfma_f32_16x16x32_bf16 v[192:195],a[208:211],a[148:151],v[192:195]
 ds_read_b64_tr_b16 a[178:179],v21 offset:53248
 v_min_u32 v51,-2,v51
 v_mfma_f32_16x16x32_bf16 v[192:195],a[224:227],a[152:155],v[192:195]
 s_add_u32 s46,s12,98304
 ds_read_b64_tr_b16 a[180:181],v21 offset:57344
 buffer_store_dwordx4 v[48:51],v1,s[20:23],s46 offen sc1
 v_mfma_f32_16x16x32_bf16 v[192:195],a[240:243],a[156:159],v[192:195]
 ds_read_b64_tr_b16 a[182:183],v21 offset:61440
 v_mfma_f32_16x16x32_bf16 v[196:199],a[244:247],a[156:159],v[196:199]
 ds_read_b64_tr_b16 a[184:185],v29 offset:49152
 v_mfma_f32_16x16x32_bf16 v[196:199],a[228:231],a[152:155],v[196:199]
 ds_read_b64_tr_b16 a[186:187],v29 offset:53248
 v_mfma_f32_16x16x32_bf16 v[196:199],a[212:215],a[148:151],v[196:199]
 ds_read_b64_tr_b16 a[188:189],v29 offset:57344
 v_mfma_f32_16x16x32_bf16 v[196:199],a[196:199],a[144:147],v[196:199]
 ds_read_b64_tr_b16 a[190:191],v29 offset:61440
 s_waitcnt lgkmcnt(8)
 v_mfma_f32_16x16x32_bf16 v[200:203],a[0:3],a[160:163],v[200:203]
 ds_read_b64_tr_b16 a[128:129],v22 offset:32768
 v_mfma_f32_16x16x32_bf16 v[200:203],a[16:19],a[164:167],v[200:203]
 ds_read_b64_tr_b16 a[130:131],v22 offset:36864
 v_mfma_f32_16x16x32_bf16 v[200:203],a[32:35],a[168:171],v[200:203]
 ds_read_b64_tr_b16 a[132:133],v22 offset:40960
 v_cvt_pk_bf16_f32 v8,v192,v193
 v_mfma_f32_16x16x32_bf16 v[200:203],a[48:51],a[172:175],v[200:203]
 ds_read_b64_tr_b16 a[134:135],v22 offset:45056
 v_cvt_pk_bf16_f32 v9,v194,v195
 v_mfma_f32_16x16x32_bf16 v[204:207],a[52:55],a[172:175],v[204:207]
 ds_read_b64_tr_b16 a[136:137],v30 offset:32768
 v_cvt_pk_bf16_f32 v10,v196,v197
 v_mfma_f32_16x16x32_bf16 v[204:207],a[36:39],a[168:171],v[204:207]
 ds_read_b64_tr_b16 a[138:139],v30 offset:36864
 v_cvt_pk_bf16_f32 v11,v198,v199
 v_mfma_f32_16x16x32_bf16 v[204:207],a[20:23],a[164:167],v[204:207]
 ds_read_b64_tr_b16 a[140:141],v30 offset:40960
 v_min_u32 v8,-2,v8
 v_mfma_f32_16x16x32_bf16 v[204:207],a[4:7],a[160:163],v[204:207]
 ds_read_b64_tr_b16 a[142:143],v30 offset:45056
 s_waitcnt lgkmcnt(8)
 v_min_u32 v9,-2,v9
 v_mfma_f32_16x16x32_bf16 v[200:203],a[192:195],a[176:179],v[200:203]
 ds_read_b64_tr_b16 a[144:145],v22 offset:49152
 v_min_u32 v10,-2,v10
 v_mfma_f32_16x16x32_bf16 v[200:203],a[208:211],a[180:183],v[200:203]
 ds_read_b64_tr_b16 a[146:147],v22 offset:53248
 v_min_u32 v11,-2,v11
 v_mfma_f32_16x16x32_bf16 v[200:203],a[224:227],a[184:187],v[200:203]
 s_add_u32 s46,s13,0
 ds_read_b64_tr_b16 a[148:149],v22 offset:57344
 buffer_store_dwordx4 v[8:11],v1,s[20:23],s46 offen sc1
 v_mfma_f32_16x16x32_bf16 v[200:203],a[240:243],a[188:191],v[200:203]
 ds_read_b64_tr_b16 a[150:151],v22 offset:61440
 v_mfma_f32_16x16x32_bf16 v[204:207],a[244:247],a[188:191],v[204:207]
 ds_read_b64_tr_b16 a[152:153],v30 offset:49152
 v_mfma_f32_16x16x32_bf16 v[204:207],a[228:231],a[184:187],v[204:207]
 ds_read_b64_tr_b16 a[154:155],v30 offset:53248
 v_mfma_f32_16x16x32_bf16 v[204:207],a[212:215],a[180:183],v[204:207]
 ds_read_b64_tr_b16 a[156:157],v30 offset:57344
 v_mfma_f32_16x16x32_bf16 v[204:207],a[196:199],a[176:179],v[204:207]
 ds_read_b64_tr_b16 a[158:159],v30 offset:61440
 s_waitcnt lgkmcnt(8)
 v_mfma_f32_16x16x32_bf16 v[208:211],a[0:3],a[128:131],v[208:211]
 ds_read_b64_tr_b16 a[160:161],v23 offset:32768
 v_mfma_f32_16x16x32_bf16 v[208:211],a[16:19],a[132:135],v[208:211]
 s_add_u32 s47,s15,0
 ds_read_b64_tr_b16 a[162:163],v23 offset:36864
 v_mfma_f32_16x16x32_bf16 v[208:211],a[32:35],a[136:139],v[208:211]
 ds_read_b64_tr_b16 a[164:165],v23 offset:40960
 buffer_load_dwordx4 v[80:83],v1,s[20:23],s47 offen sc1
 v_mfma_f32_16x16x32_bf16 v[208:211],a[48:51],a[140:143],v[208:211]
 ds_read_b64_tr_b16 a[166:167],v23 offset:45056
 v_cvt_pk_bf16_f32 v12,v200,v201
 v_mfma_f32_16x16x32_bf16 v[212:215],a[52:55],a[140:143],v[212:215]
 ds_read_b64_tr_b16 a[168:169],v31 offset:32768
 v_cvt_pk_bf16_f32 v13,v202,v203
 v_mfma_f32_16x16x32_bf16 v[212:215],a[36:39],a[136:139],v[212:215]
 ds_read_b64_tr_b16 a[170:171],v31 offset:36864
 v_cvt_pk_bf16_f32 v14,v204,v205
 v_mfma_f32_16x16x32_bf16 v[212:215],a[20:23],a[132:135],v[212:215]
 ds_read_b64_tr_b16 a[172:173],v31 offset:40960
 v_cvt_pk_bf16_f32 v15,v206,v207
 v_mfma_f32_16x16x32_bf16 v[212:215],a[4:7],a[128:131],v[212:215]
 ds_read_b64_tr_b16 a[174:175],v31 offset:45056
 s_waitcnt lgkmcnt(8)
 v_min_u32 v12,-2,v12
 v_mfma_f32_16x16x32_bf16 v[208:211],a[192:195],a[144:147],v[208:211]
 ds_read_b64_tr_b16 a[176:177],v23 offset:49152
 v_min_u32 v13,-2,v13
 v_mfma_f32_16x16x32_bf16 v[208:211],a[208:211],a[148:151],v[208:211]
 ds_read_b64_tr_b16 a[178:179],v23 offset:53248
 v_min_u32 v14,-2,v14
 v_mfma_f32_16x16x32_bf16 v[208:211],a[224:227],a[152:155],v[208:211]
 ds_read_b64_tr_b16 a[180:181],v23 offset:57344
 v_min_u32 v15,-2,v15
 v_mfma_f32_16x16x32_bf16 v[208:211],a[240:243],a[156:159],v[208:211]
 s_add_u32 s46,s13,32768
 ds_read_b64_tr_b16 a[182:183],v23 offset:61440
 buffer_store_dwordx4 v[12:15],v1,s[20:23],s46 offen sc1
 v_mfma_f32_16x16x32_bf16 v[212:215],a[244:247],a[156:159],v[212:215]
 ds_read_b64_tr_b16 a[184:185],v31 offset:49152
 v_mfma_f32_16x16x32_bf16 v[212:215],a[228:231],a[152:155],v[212:215]
 ds_read_b64_tr_b16 a[186:187],v31 offset:53248
 v_mfma_f32_16x16x32_bf16 v[212:215],a[212:215],a[148:151],v[212:215]
 ds_read_b64_tr_b16 a[188:189],v31 offset:57344
 v_mfma_f32_16x16x32_bf16 v[212:215],a[196:199],a[144:147],v[212:215]
 ds_read_b64_tr_b16 a[190:191],v31 offset:61440
 s_waitcnt lgkmcnt(8)
 v_mfma_f32_16x16x32_bf16 v[216:219],a[0:3],a[160:163],v[216:219]
 ds_read_b64_tr_b16 a[128:129],v16 offset:32768
 v_mfma_f32_16x16x32_bf16 v[216:219],a[16:19],a[164:167],v[216:219]
 s_add_u32 s47,s15,32768
 ds_read_b64_tr_b16 a[130:131],v16 offset:36864
 v_mfma_f32_16x16x32_bf16 v[216:219],a[32:35],a[168:171],v[216:219]
 ds_read_b64_tr_b16 a[132:133],v16 offset:40960
 buffer_load_dwordx4 v[84:87],v1,s[20:23],s47 offen sc1
 v_mfma_f32_16x16x32_bf16 v[216:219],a[48:51],a[172:175],v[216:219]
 ds_read_b64_tr_b16 a[134:135],v16 offset:45056
 v_cvt_pk_bf16_f32 v44,v208,v209
 v_mfma_f32_16x16x32_bf16 v[220:223],a[52:55],a[172:175],v[220:223]
 ds_read_b64_tr_b16 a[136:137],v24 offset:32768
 v_cvt_pk_bf16_f32 v45,v210,v211
 v_mfma_f32_16x16x32_bf16 v[220:223],a[36:39],a[168:171],v[220:223]
 ds_read_b64_tr_b16 a[138:139],v24 offset:36864
 v_cvt_pk_bf16_f32 v46,v212,v213
 v_mfma_f32_16x16x32_bf16 v[220:223],a[20:23],a[164:167],v[220:223]
 ds_read_b64_tr_b16 a[140:141],v24 offset:40960
 v_cvt_pk_bf16_f32 v47,v214,v215
 v_mfma_f32_16x16x32_bf16 v[220:223],a[4:7],a[160:163],v[220:223]
 ds_read_b64_tr_b16 a[142:143],v24 offset:45056
 s_waitcnt lgkmcnt(8)
 v_min_u32 v44,-2,v44
 v_mfma_f32_16x16x32_bf16 v[216:219],a[192:195],a[176:179],v[216:219]
 ds_read_b64_tr_b16 a[144:145],v16 offset:49152
 v_min_u32 v45,-2,v45
 v_mfma_f32_16x16x32_bf16 v[216:219],a[208:211],a[180:183],v[216:219]
 ds_read_b64_tr_b16 a[146:147],v16 offset:53248
 v_min_u32 v46,-2,v46
 v_mfma_f32_16x16x32_bf16 v[216:219],a[224:227],a[184:187],v[216:219]
 ds_read_b64_tr_b16 a[148:149],v16 offset:57344
 v_min_u32 v47,-2,v47
 v_mfma_f32_16x16x32_bf16 v[216:219],a[240:243],a[188:191],v[216:219]
 s_add_u32 s46,s13,65536
 ds_read_b64_tr_b16 a[150:151],v16 offset:61440
 buffer_store_dwordx4 v[44:47],v1,s[20:23],s46 offen sc1
 v_mfma_f32_16x16x32_bf16 v[220:223],a[244:247],a[188:191],v[220:223]
 ds_read_b64_tr_b16 a[152:153],v24 offset:49152
 v_mfma_f32_16x16x32_bf16 v[220:223],a[228:231],a[184:187],v[220:223]
 ds_read_b64_tr_b16 a[154:155],v24 offset:53248
 v_mfma_f32_16x16x32_bf16 v[220:223],a[212:215],a[180:183],v[220:223]
 ds_read_b64_tr_b16 a[156:157],v24 offset:57344
 v_mfma_f32_16x16x32_bf16 v[220:223],a[196:199],a[176:179],v[220:223]
 ds_read_b64_tr_b16 a[158:159],v24 offset:61440
 s_waitcnt lgkmcnt(8)
 v_mfma_f32_16x16x32_bf16 v[136:139],a[8:11],a[128:131],v[136:139]
 ds_read_b64_tr_b16 a[160:161],v17 offset:32768
 v_mfma_f32_16x16x32_bf16 v[136:139],a[24:27],a[132:135],v[136:139]
 s_add_u32 s47,s15,65536
 ds_read_b64_tr_b16 a[162:163],v17 offset:36864
 v_mfma_f32_16x16x32_bf16 v[136:139],a[40:43],a[136:139],v[136:139]
 ds_read_b64_tr_b16 a[164:165],v17 offset:40960
 buffer_load_dwordx4 v[88:91],v1,s[20:23],s47 offen sc1
 v_mfma_f32_16x16x32_bf16 v[136:139],a[56:59],a[140:143],v[136:139]
 ds_read_b64_tr_b16 a[166:167],v17 offset:45056
 v_cvt_pk_bf16_f32 v48,v216,v217
 v_mfma_f32_16x16x32_bf16 v[140:143],a[60:63],a[140:143],v[140:143]
 ds_read_b64_tr_b16 a[168:169],v25 offset:32768
 v_cvt_pk_bf16_f32 v49,v218,v219
 v_mfma_f32_16x16x32_bf16 v[140:143],a[44:47],a[136:139],v[140:143]
 ds_read_b64_tr_b16 a[170:171],v25 offset:36864
 v_cvt_pk_bf16_f32 v50,v220,v221
 v_mfma_f32_16x16x32_bf16 v[140:143],a[28:31],a[132:135],v[140:143]
 ds_read_b64_tr_b16 a[172:173],v25 offset:40960
 v_cvt_pk_bf16_f32 v51,v222,v223
 v_mfma_f32_16x16x32_bf16 v[140:143],a[12:15],a[128:131],v[140:143]
 ds_read_b64_tr_b16 a[174:175],v25 offset:45056
 s_waitcnt lgkmcnt(8)
 v_min_u32 v48,-2,v48
 v_mfma_f32_16x16x32_bf16 v[136:139],a[200:203],a[144:147],v[136:139]
 ds_read_b64_tr_b16 a[176:177],v17 offset:49152
 v_min_u32 v49,-2,v49
 v_mfma_f32_16x16x32_bf16 v[136:139],a[216:219],a[148:151],v[136:139]
 ds_read_b64_tr_b16 a[178:179],v17 offset:53248
 v_min_u32 v50,-2,v50
 v_mfma_f32_16x16x32_bf16 v[136:139],a[232:235],a[152:155],v[136:139]
 ds_read_b64_tr_b16 a[180:181],v17 offset:57344
 v_min_u32 v51,-2,v51
 v_mfma_f32_16x16x32_bf16 v[136:139],a[248:251],a[156:159],v[136:139]
 s_add_u32 s46,s13,98304
 ds_read_b64_tr_b16 a[182:183],v17 offset:61440
 buffer_store_dwordx4 v[48:51],v1,s[20:23],s46 offen sc1
 v_mfma_f32_16x16x32_bf16 v[140:143],a[252:255],a[156:159],v[140:143]
 ds_read_b64_tr_b16 a[184:185],v25 offset:49152
 v_mfma_f32_16x16x32_bf16 v[140:143],a[236:239],a[152:155],v[140:143]
 ds_read_b64_tr_b16 a[186:187],v25 offset:53248
 v_mfma_f32_16x16x32_bf16 v[140:143],a[220:223],a[148:151],v[140:143]
 ds_read_b64_tr_b16 a[188:189],v25 offset:57344
 v_mfma_f32_16x16x32_bf16 v[140:143],a[204:207],a[144:147],v[140:143]
 ds_read_b64_tr_b16 a[190:191],v25 offset:61440
 s_waitcnt lgkmcnt(8)
 v_mfma_f32_16x16x32_bf16 v[152:155],a[8:11],a[160:163],v[152:155]
 ds_read_b64_tr_b16 a[128:129],v18 offset:32768
 v_mfma_f32_16x16x32_bf16 v[152:155],a[24:27],a[164:167],v[152:155]
 s_add_u32 s47,s15,98304
 ds_read_b64_tr_b16 a[130:131],v18 offset:36864
 v_mfma_f32_16x16x32_bf16 v[152:155],a[40:43],a[168:171],v[152:155]
 ds_read_b64_tr_b16 a[132:133],v18 offset:40960
 buffer_load_dwordx4 v[92:95],v1,s[20:23],s47 offen sc1
 v_mfma_f32_16x16x32_bf16 v[152:155],a[56:59],a[172:175],v[152:155]
 ds_read_b64_tr_b16 a[134:135],v18 offset:45056
 v_mfma_f32_16x16x32_bf16 v[156:159],a[60:63],a[172:175],v[156:159]
 ds_read_b64_tr_b16 a[136:137],v26 offset:32768
 v_cvt_pk_bf16_f32 v8,v136,v137
 v_mfma_f32_16x16x32_bf16 v[156:159],a[44:47],a[168:171],v[156:159]
 ds_read_b64_tr_b16 a[138:139],v26 offset:36864
 v_cvt_pk_bf16_f32 v9,v138,v139
 v_mfma_f32_16x16x32_bf16 v[156:159],a[28:31],a[164:167],v[156:159]
 ds_read_b64_tr_b16 a[140:141],v26 offset:40960
 v_cvt_pk_bf16_f32 v10,v140,v141
 v_mfma_f32_16x16x32_bf16 v[156:159],a[12:15],a[160:163],v[156:159]
 ds_read_b64_tr_b16 a[142:143],v26 offset:45056
 s_waitcnt lgkmcnt(8)
 v_cvt_pk_bf16_f32 v11,v142,v143
 v_mfma_f32_16x16x32_bf16 v[152:155],a[200:203],a[176:179],v[152:155]
 ds_read_b64_tr_b16 a[144:145],v18 offset:49152
 v_min_u32 v8,-2,v8
 v_mfma_f32_16x16x32_bf16 v[152:155],a[216:219],a[180:183],v[152:155]
 ds_read_b64_tr_b16 a[146:147],v18 offset:53248
 v_min_u32 v9,-2,v9
 v_mfma_f32_16x16x32_bf16 v[152:155],a[232:235],a[184:187],v[152:155]
 ds_read_b64_tr_b16 a[148:149],v18 offset:57344
 v_min_u32 v10,-2,v10
 v_mfma_f32_16x16x32_bf16 v[152:155],a[248:251],a[188:191],v[152:155]
 ds_read_b64_tr_b16 a[150:151],v18 offset:61440
 v_min_u32 v11,-2,v11
 v_mfma_f32_16x16x32_bf16 v[156:159],a[252:255],a[188:191],v[156:159]
 s_add_u32 s46,s14,0
 ds_read_b64_tr_b16 a[152:153],v26 offset:49152
 buffer_store_dwordx4 v[8:11],v1,s[20:23],s46 offen sc1
 v_mfma_f32_16x16x32_bf16 v[156:159],a[236:239],a[184:187],v[156:159]
 ds_read_b64_tr_b16 a[154:155],v26 offset:53248
 v_mfma_f32_16x16x32_bf16 v[156:159],a[220:223],a[180:183],v[156:159]
 ds_read_b64_tr_b16 a[156:157],v26 offset:57344
 v_mfma_f32_16x16x32_bf16 v[156:159],a[204:207],a[176:179],v[156:159]
 ds_read_b64_tr_b16 a[158:159],v26 offset:61440
 s_waitcnt lgkmcnt(8)
 v_mfma_f32_16x16x32_bf16 v[168:171],a[8:11],a[128:131],v[168:171]
 ds_read_b64_tr_b16 a[160:161],v19 offset:32768
 v_mfma_f32_16x16x32_bf16 v[168:171],a[24:27],a[132:135],v[168:171]
 s_add_u32 s47,s15,131072
 ds_read_b64_tr_b16 a[162:163],v19 offset:36864
 v_mfma_f32_16x16x32_bf16 v[168:171],a[40:43],a[136:139],v[168:171]
 ds_read_b64_tr_b16 a[164:165],v19 offset:40960
 buffer_load_dwordx4 v[96:99],v1,s[20:23],s47 offen sc1
 v_mfma_f32_16x16x32_bf16 v[168:171],a[56:59],a[140:143],v[168:171]
 ds_read_b64_tr_b16 a[166:167],v19 offset:45056
 v_mfma_f32_16x16x32_bf16 v[172:175],a[60:63],a[140:143],v[172:175]
 ds_read_b64_tr_b16 a[168:169],v27 offset:32768
 v_cvt_pk_bf16_f32 v12,v152,v153
 v_mfma_f32_16x16x32_bf16 v[172:175],a[44:47],a[136:139],v[172:175]
 ds_read_b64_tr_b16 a[170:171],v27 offset:36864
 v_cvt_pk_bf16_f32 v13,v154,v155
 v_mfma_f32_16x16x32_bf16 v[172:175],a[28:31],a[132:135],v[172:175]
 ds_read_b64_tr_b16 a[172:173],v27 offset:40960
 v_cvt_pk_bf16_f32 v14,v156,v157
 v_mfma_f32_16x16x32_bf16 v[172:175],a[12:15],a[128:131],v[172:175]
 ds_read_b64_tr_b16 a[174:175],v27 offset:45056
 s_waitcnt lgkmcnt(8)
 v_cvt_pk_bf16_f32 v15,v158,v159
 v_mfma_f32_16x16x32_bf16 v[168:171],a[200:203],a[144:147],v[168:171]
 ds_read_b64_tr_b16 a[176:177],v19 offset:49152
 v_min_u32 v12,-2,v12
 v_mfma_f32_16x16x32_bf16 v[168:171],a[216:219],a[148:151],v[168:171]
 ds_read_b64_tr_b16 a[178:179],v19 offset:53248
 v_min_u32 v13,-2,v13
 v_mfma_f32_16x16x32_bf16 v[168:171],a[232:235],a[152:155],v[168:171]
 ds_read_b64_tr_b16 a[180:181],v19 offset:57344
 v_min_u32 v14,-2,v14
 v_mfma_f32_16x16x32_bf16 v[168:171],a[248:251],a[156:159],v[168:171]
 ds_read_b64_tr_b16 a[182:183],v19 offset:61440
 v_min_u32 v15,-2,v15
 v_mfma_f32_16x16x32_bf16 v[172:175],a[252:255],a[156:159],v[172:175]
 s_add_u32 s46,s14,32768
 ds_read_b64_tr_b16 a[184:185],v27 offset:49152
 buffer_store_dwordx4 v[12:15],v1,s[20:23],s46 offen sc1
 v_mfma_f32_16x16x32_bf16 v[172:175],a[236:239],a[152:155],v[172:175]
 ds_read_b64_tr_b16 a[186:187],v27 offset:53248
 v_mfma_f32_16x16x32_bf16 v[172:175],a[220:223],a[148:151],v[172:175]
 ds_read_b64_tr_b16 a[188:189],v27 offset:57344
 v_mfma_f32_16x16x32_bf16 v[172:175],a[204:207],a[144:147],v[172:175]
 ds_read_b64_tr_b16 a[190:191],v27 offset:61440
 s_waitcnt lgkmcnt(8)
 v_mfma_f32_16x16x32_bf16 v[184:187],a[8:11],a[160:163],v[184:187]
 ds_read_b64_tr_b16 a[128:129],v20 offset:32768
 v_mfma_f32_16x16x32_bf16 v[184:187],a[24:27],a[164:167],v[184:187]
 s_add_u32 s47,s15,163840
 ds_read_b64_tr_b16 a[130:131],v20 offset:36864
 v_mfma_f32_16x16x32_bf16 v[184:187],a[40:43],a[168:171],v[184:187]
 ds_read_b64_tr_b16 a[132:133],v20 offset:40960
 buffer_load_dwordx4 v[100:103],v1,s[20:23],s47 offen sc1
 v_mfma_f32_16x16x32_bf16 v[184:187],a[56:59],a[172:175],v[184:187]
 ds_read_b64_tr_b16 a[134:135],v20 offset:45056
 v_mfma_f32_16x16x32_bf16 v[188:191],a[60:63],a[172:175],v[188:191]
 ds_read_b64_tr_b16 a[136:137],v28 offset:32768
 v_cvt_pk_bf16_f32 v44,v168,v169
 v_mfma_f32_16x16x32_bf16 v[188:191],a[44:47],a[168:171],v[188:191]
 ds_read_b64_tr_b16 a[138:139],v28 offset:36864
 v_cvt_pk_bf16_f32 v45,v170,v171
 v_mfma_f32_16x16x32_bf16 v[188:191],a[28:31],a[164:167],v[188:191]
 ds_read_b64_tr_b16 a[140:141],v28 offset:40960
 v_cvt_pk_bf16_f32 v46,v172,v173
 v_mfma_f32_16x16x32_bf16 v[188:191],a[12:15],a[160:163],v[188:191]
 ds_read_b64_tr_b16 a[142:143],v28 offset:45056
 s_waitcnt lgkmcnt(8)
 v_cvt_pk_bf16_f32 v47,v174,v175
 v_mfma_f32_16x16x32_bf16 v[184:187],a[200:203],a[176:179],v[184:187]
 ds_read_b64_tr_b16 a[144:145],v20 offset:49152
 v_min_u32 v44,-2,v44
 v_mfma_f32_16x16x32_bf16 v[184:187],a[216:219],a[180:183],v[184:187]
 ds_read_b64_tr_b16 a[146:147],v20 offset:53248
 v_min_u32 v45,-2,v45
 v_mfma_f32_16x16x32_bf16 v[184:187],a[232:235],a[184:187],v[184:187]
 ds_read_b64_tr_b16 a[148:149],v20 offset:57344
 v_min_u32 v46,-2,v46
 v_mfma_f32_16x16x32_bf16 v[184:187],a[248:251],a[188:191],v[184:187]
 ds_read_b64_tr_b16 a[150:151],v20 offset:61440
 v_min_u32 v47,-2,v47
 v_mfma_f32_16x16x32_bf16 v[188:191],a[252:255],a[188:191],v[188:191]
 s_add_u32 s46,s14,65536
 ds_read_b64_tr_b16 a[152:153],v28 offset:49152
 buffer_store_dwordx4 v[44:47],v1,s[20:23],s46 offen sc1
 v_mfma_f32_16x16x32_bf16 v[188:191],a[236:239],a[184:187],v[188:191]
 ds_read_b64_tr_b16 a[154:155],v28 offset:53248
 v_mfma_f32_16x16x32_bf16 v[188:191],a[220:223],a[180:183],v[188:191]
 ds_read_b64_tr_b16 a[156:157],v28 offset:57344
 v_mfma_f32_16x16x32_bf16 v[188:191],a[204:207],a[176:179],v[188:191]
 ds_read_b64_tr_b16 a[158:159],v28 offset:61440
 s_waitcnt lgkmcnt(8)
 v_mfma_f32_16x16x32_bf16 v[224:227],a[8:11],a[128:131],v[224:227]
 ds_read_b64_tr_b16 a[160:161],v21 offset:32768
 v_mfma_f32_16x16x32_bf16 v[224:227],a[24:27],a[132:135],v[224:227]
 s_add_u32 s47,s15,196608
 ds_read_b64_tr_b16 a[162:163],v21 offset:36864
 v_mfma_f32_16x16x32_bf16 v[224:227],a[40:43],a[136:139],v[224:227]
 ds_read_b64_tr_b16 a[164:165],v21 offset:40960
 buffer_load_dwordx4 v[104:107],v1,s[20:23],s47 offen sc1
 v_mfma_f32_16x16x32_bf16 v[224:227],a[56:59],a[140:143],v[224:227]
 ds_read_b64_tr_b16 a[166:167],v21 offset:45056
 v_mfma_f32_16x16x32_bf16 v[228:231],a[60:63],a[140:143],v[228:231]
 ds_read_b64_tr_b16 a[168:169],v29 offset:32768
 v_cvt_pk_bf16_f32 v48,v184,v185
 v_mfma_f32_16x16x32_bf16 v[228:231],a[44:47],a[136:139],v[228:231]
 ds_read_b64_tr_b16 a[170:171],v29 offset:36864
 v_cvt_pk_bf16_f32 v49,v186,v187
 v_mfma_f32_16x16x32_bf16 v[228:231],a[28:31],a[132:135],v[228:231]
 ds_read_b64_tr_b16 a[172:173],v29 offset:40960
 v_cvt_pk_bf16_f32 v50,v188,v189
 v_mfma_f32_16x16x32_bf16 v[228:231],a[12:15],a[128:131],v[228:231]
 ds_read_b64_tr_b16 a[174:175],v29 offset:45056
 s_waitcnt lgkmcnt(8)
 v_cvt_pk_bf16_f32 v51,v190,v191
 v_mfma_f32_16x16x32_bf16 v[224:227],a[200:203],a[144:147],v[224:227]
 s_add_u32 s47,s15,229376
 ds_read_b64_tr_b16 a[176:177],v21 offset:49152
 v_min_u32 v48,-2,v48
 v_mfma_f32_16x16x32_bf16 v[224:227],a[216:219],a[148:151],v[224:227]
 ds_read_b64_tr_b16 a[178:179],v21 offset:53248
 buffer_load_dwordx4 v[108:111],v1,s[20:23],s47 offen sc1
 v_mfma_f32_16x16x32_bf16 v[224:227],a[232:235],a[152:155],v[224:227]
 ds_read_b64_tr_b16 a[180:181],v21 offset:57344
 v_min_u32 v49,-2,v49
 v_mfma_f32_16x16x32_bf16 v[224:227],a[248:251],a[156:159],v[224:227]
 ds_read_b64_tr_b16 a[182:183],v21 offset:61440
 v_min_u32 v50,-2,v50
 v_mfma_f32_16x16x32_bf16 v[228:231],a[252:255],a[156:159],v[228:231]
 ds_read_b64_tr_b16 a[184:185],v29 offset:49152
 v_min_u32 v51,-2,v51
 v_mfma_f32_16x16x32_bf16 v[228:231],a[236:239],a[152:155],v[228:231]
 s_add_u32 s46,s14,98304
 ds_read_b64_tr_b16 a[186:187],v29 offset:53248
 buffer_store_dwordx4 v[48:51],v1,s[20:23],s46 offen sc1
 v_mfma_f32_16x16x32_bf16 v[228:231],a[220:223],a[148:151],v[228:231]
 ds_read_b64_tr_b16 a[188:189],v29 offset:57344
 v_mfma_f32_16x16x32_bf16 v[228:231],a[204:207],a[144:147],v[228:231]
 ds_read_b64_tr_b16 a[190:191],v29 offset:61440
 s_waitcnt lgkmcnt(8)
 v_mfma_f32_16x16x32_bf16 v[232:235],a[8:11],a[160:163],v[232:235]
 ds_read_b64_tr_b16 a[128:129],v22 offset:32768
 v_mfma_f32_16x16x32_bf16 v[232:235],a[24:27],a[164:167],v[232:235]
 s_add_u32 s47,s15,262144
 ds_read_b64_tr_b16 a[130:131],v22 offset:36864
 v_mfma_f32_16x16x32_bf16 v[232:235],a[40:43],a[168:171],v[232:235]
L_stub_m_5:
 s_cbranch_execz L_warm_m_ret
 ds_read_b64_tr_b16 a[132:133],v22 offset:40960
 buffer_load_dwordx4 v[112:115],v1,s[20:23],s47 offen sc1
 v_mfma_f32_16x16x32_bf16 v[232:235],a[56:59],a[172:175],v[232:235]
 ds_read_b64_tr_b16 a[134:135],v22 offset:45056
 v_mfma_f32_16x16x32_bf16 v[236:239],a[60:63],a[172:175],v[236:239]
 ds_read_b64_tr_b16 a[136:137],v30 offset:32768
 v_mfma_f32_16x16x32_bf16 v[236:239],a[44:47],a[168:171],v[236:239]
 ds_read_b64_tr_b16 a[138:139],v30 offset:36864
 v_mfma_f32_16x16x32_bf16 v[236:239],a[28:31],a[164:167],v[236:239]
 ds_read_b64_tr_b16 a[140:141],v30 offset:40960
 v_mfma_f32_16x16x32_bf16 v[236:239],a[12:15],a[160:163],v[236:239]
 ds_read_b64_tr_b16 a[142:143],v30 offset:45056
 s_waitcnt lgkmcnt(8)
 v_mfma_f32_16x16x32_bf16 v[232:235],a[200:203],a[176:179],v[232:235]
 s_add_u32 s47,s15,294912
 ds_read_b64_tr_b16 a[144:145],v22 offset:49152
 v_mfma_f32_16x16x32_bf16 v[232:235],a[216:219],a[180:183],v[232:235]
 ds_read_b64_tr_b16 a[146:147],v22 offset:53248
 buffer_load_dwordx4 v[116:119],v1,s[20:23],s47 offen sc1
 v_mfma_f32_16x16x32_bf16 v[232:235],a[232:235],a[184:187],v[232:235]
 ds_read_b64_tr_b16 a[148:149],v22 offset:57344
 v_mfma_f32_16x16x32_bf16 v[232:235],a[248:251],a[188:191],v[232:235]
 ds_read_b64_tr_b16 a[150:151],v22 offset:61440
 v_mfma_f32_16x16x32_bf16 v[236:239],a[252:255],a[188:191],v[236:239]
 ds_read_b64_tr_b16 a[152:153],v30 offset:49152
 v_mfma_f32_16x16x32_bf16 v[236:239],a[236:239],a[184:187],v[236:239]
 ds_read_b64_tr_b16 a[154:155],v30 offset:53248
 v_mfma_f32_16x16x32_bf16 v[236:239],a[220:223],a[180:183],v[236:239]
 ds_read_b64_tr_b16 a[156:157],v30 offset:57344
 v_mfma_f32_16x16x32_bf16 v[236:239],a[204:207],a[176:179],v[236:239]
 ds_read_b64_tr_b16 a[158:159],v30 offset:61440
 s_waitcnt lgkmcnt(8)
 v_mfma_f32_16x16x32_bf16 v[240:243],a[8:11],a[128:131],v[240:243]
 ds_read_b64_tr_b16 a[160:161],v23 offset:32768
 v_mfma_f32_16x16x32_bf16 v[240:243],a[24:27],a[132:135],v[240:243]
 s_add_u32 s47,s15,327680
 ds_read_b64_tr_b16 a[162:163],v23 offset:36864
 v_mfma_f32_16x16x32_bf16 v[240:243],a[40:43],a[136:139],v[240:243]
 ds_read_b64_tr_b16 a[164:165],v23 offset:40960
 buffer_load_dwordx4 v[120:123],v1,s[20:23],s47 offen sc1
 v_mfma_f32_16x16x32_bf16 v[240:243],a[56:59],a[140:143],v[240:243]
 ds_read_b64_tr_b16 a[166:167],v23 offset:45056
 v_mfma_f32_16x16x32_bf16 v[244:247],a[60:63],a[140:143],v[244:247]
 ds_read_b64_tr_b16 a[168:169],v31 offset:32768
 v_mfma_f32_16x16x32_bf16 v[244:247],a[44:47],a[136:139],v[244:247]
 ds_read_b64_tr_b16 a[170:171],v31 offset:36864
 v_mfma_f32_16x16x32_bf16 v[244:247],a[28:31],a[132:135],v[244:247]
 ds_read_b64_tr_b16 a[172:173],v31 offset:40960
 v_mfma_f32_16x16x32_bf16 v[244:247],a[12:15],a[128:131],v[244:247]
 ds_read_b64_tr_b16 a[174:175],v31 offset:45056
 s_waitcnt lgkmcnt(8)
 v_mfma_f32_16x16x32_bf16 v[240:243],a[200:203],a[144:147],v[240:243]
 s_add_u32 s47,s15,360448
 ds_read_b64_tr_b16 a[176:177],v23 offset:49152
 v_mfma_f32_16x16x32_bf16 v[240:243],a[216:219],a[148:151],v[240:243]
 ds_read_b64_tr_b16 a[178:179],v23 offset:53248
 buffer_load_dwordx4 v[124:127],v1,s[20:23],s47 offen sc1
 v_mfma_f32_16x16x32_bf16 v[240:243],a[232:235],a[152:155],v[240:243]
 ds_read_b64_tr_b16 a[180:181],v23 offset:57344
 v_mfma_f32_16x16x32_bf16 v[240:243],a[248:251],a[156:159],v[240:243]
 ds_read_b64_tr_b16 a[182:183],v23 offset:61440
 v_mfma_f32_16x16x32_bf16 v[244:247],a[252:255],a[156:159],v[244:247]
 ds_read_b64_tr_b16 a[184:185],v31 offset:49152
 v_mfma_f32_16x16x32_bf16 v[244:247],a[236:239],a[152:155],v[244:247]
 ds_read_b64_tr_b16 a[186:187],v31 offset:53248
 v_mfma_f32_16x16x32_bf16 v[244:247],a[220:223],a[148:151],v[244:247]
 ds_read_b64_tr_b16 a[188:189],v31 offset:57344
 v_mfma_f32_16x16x32_bf16 v[244:247],a[204:207],a[144:147],v[244:247]
 ds_read_b64_tr_b16 a[190:191],v31 offset:61440
 s_waitcnt lgkmcnt(8)
 v_mfma_f32_16x16x32_bf16 v[248:251],a[8:11],a[160:163],v[248:251]
 v_mfma_f32_16x16x32_bf16 v[248:251],a[24:27],a[164:167],v[248:251]
 v_mfma_f32_16x16x32_bf16 v[248:251],a[40:43],a[168:171],v[248:251]
 v_mfma_f32_16x16x32_bf16 v[248:251],a[56:59],a[172:175],v[248:251]
 v_mfma_f32_16x16x32_bf16 v[252:255],a[60:63],a[172:175],v[252:255]
 v_mfma_f32_16x16x32_bf16 v[252:255],a[44:47],a[168:171],v[252:255]
 v_mfma_f32_16x16x32_bf16 v[252:255],a[28:31],a[164:167],v[252:255]
 v_mfma_f32_16x16x32_bf16 v[252:255],a[12:15],a[160:163],v[252:255]
 s_waitcnt lgkmcnt(0)
 v_mfma_f32_16x16x32_bf16 v[248:251],a[200:203],a[176:179],v[248:251]
 v_mfma_f32_16x16x32_bf16 v[248:251],a[216:219],a[180:183],v[248:251]
 v_mfma_f32_16x16x32_bf16 v[248:251],a[232:235],a[184:187],v[248:251]
 v_mfma_f32_16x16x32_bf16 v[248:251],a[248:251],a[188:191],v[248:251]
 v_mfma_f32_16x16x32_bf16 v[252:255],a[252:255],a[188:191],v[252:255]
 v_mfma_f32_16x16x32_bf16 v[252:255],a[236:239],a[184:187],v[252:255]
 v_mfma_f32_16x16x32_bf16 v[252:255],a[220:223],a[180:183],v[252:255]
 v_mfma_f32_16x16x32_bf16 v[252:255],a[204:207],a[176:179],v[252:255]
 s_mov_b32 s48,0xbfb8aa3b
 s_mov_b32 s101,524288
L_m_check:
 s_waitcnt vmcnt(0)
 v_max_u32 v4,v80,v81
 v_max3_u32 v4,v82,v83,v4
 v_max3_u32 v4,v84,v85,v4
 v_max3_u32 v4,v86,v87,v4
 v_max3_u32 v4,v88,v89,v4
 v_max3_u32 v4,v90,v91,v4
 v_max3_u32 v4,v92,v93,v4
 v_max3_u32 v4,v94,v95,v4
 v_max_u32 v5,v96,v97
 v_max3_u32 v5,v98,v99,v5
 v_max3_u32 v5,v100,v101,v5
 v_max3_u32 v5,v102,v103,v5
 v_max3_u32 v5,v104,v105,v5
 v_max3_u32 v5,v106,v107,v5
 v_max3_u32 v5,v108,v109,v5
 v_max3_u32 v5,v110,v111,v5
 v_max_u32 v6,v112,v113
 v_max3_u32 v6,v114,v115,v6
 v_max3_u32 v6,v116,v117,v6
 v_max3_u32 v6,v118,v119,v6
 v_max3_u32 v6,v120,v121,v6
 v_max3_u32 v6,v122,v123,v6
 v_max3_u32 v6,v124,v125,v6
 v_max3_u32 v6,v126,v127,v6
 v_max3_u32 v7,v4,v5,v6
 v_cmp_eq_u32 vcc,-1,v7
 s_nop 1
 s_cmp_lg_u64 vcc,0
 s_cbranch_scc1 L_m_late
L_m_ok:
 v_mfma_f32_16x16x32_bf16 v[224:227],v[36:39],v[112:115],v[224:227]
 v_mfma_f32_16x16x32_bf16 v[228:231],v[40:43],v[112:115],v[228:231]
 v_mfma_f32_16x16x32_bf16 v[232:235],v[36:39],v[116:119],v[232:235]
 v_mfma_f32_16x16x32_bf16 v[236:239],v[40:43],v[116:119],v[236:239]
 v_mfma_f32_16x16x32_bf16 v[128:131],v[36:39],v[80:83],0
 v_mfma_f32_16x16x32_bf16 v[128:131],v[36:39],v[96:99],v[128:131]
 v_mfma_f32_16x16x32_bf16 v[132:135],v[40:43],v[80:83],0
 v_mfma_f32_16x16x32_bf16 v[132:135],v[40:43],v[96:99],v[132:135]
 v_mfma_f32_16x16x32_bf16 v[160:163],v[36:39],v[64:67],0
 v_mfma_f32_16x16x32_bf16 v[164:167],v[40:43],v[64:67],0
 v_exp_f32 v192,v224
 v_exp_f32 v193,v225
 v_exp_f32 v194,v226
 v_mfma_f32_16x16x32_bf16 v[240:243],v[36:39],v[120:123],v[240:243]
 v_exp_f32 v195,v227
 v_exp_f32 v196,v228
 v_exp_f32 v197,v229
 v_mfma_f32_16x16x32_bf16 v[244:247],v[40:43],v[120:123],v[244:247]
 v_exp_f32 v198,v230
 v_exp_f32 v199,v231
 v_fma_f32 v192,v192,s48,s48
 v_fma_f32 v193,v193,s48,s48
 v_mfma_f32_16x16x32_bf16 v[136:139],v[36:39],v[84:87],0
 v_fma_f32 v194,v194,s48,s48
 v_fma_f32 v195,v195,s48,s48
 v_fma_f32 v196,v196,s48,s48
 v_fma_f32 v197,v197,s48,s48
 v_fma_f32 v198,v198,s48,s48
 v_fma_f32 v199,v199,s48,s48
 v_mfma_f32_16x16x32_bf16 v[136:139],v[36:39],v[100:103],v[136:139]
 v_rcp_f32 v192,v192
 v_rcp_f32 v193,v193
 v_rcp_f32 v194,v194
 v_mfma_f32_16x16x32_bf16 v[140:143],v[40:43],v[84:87],0
 v_rcp_f32 v195,v195
 v_rcp_f32 v196,v196
 v_rcp_f32 v197,v197
 v_mfma_f32_16x16x32_bf16 v[140:143],v[40:43],v[100:103],v[140:143]
 v_rcp_f32 v198,v198
 v_rcp_f32 v199,v199
 v_mul_f32 v224,v192,v224
 v_mul_f32 v225,v193,v225
 v_mfma_f32_16x16x32_bf16 v[168:171],v[36:39],v[68:71],0
 v_mul_f32 v226,v194,v226
 v_mul_f32 v227,v195,v227
 v_mul_f32 v228,v196,v228
 v_mul_f32 v229,v197,v229
 v_mul_f32 v230,v198,v230
 v_mul_f32 v231,v199,v231
 v_mfma_f32_16x16x32_bf16 v[172:175],v[40:43],v[68:71],0
 v_fma_f32 v224,v128,v224,v160
 v_fma_f32 v225,v129,v225,v161
 v_fma_f32 v226,v130,v226,v162
 v_fma_f32 v227,v131,v227,v163
 v_fma_f32 v228,v132,v228,v164
 v_fma_f32 v229,v133,v229,v165
 v_mfma_f32_16x16x32_bf16 v[248:251],v[36:39],v[124:127],v[248:251]
 v_fma_f32 v230,v134,v230,v166
 v_fma_f32 v231,v135,v231,v167
 v_cvt_pk_bf16_f32 v200,v224,v225
 v_cvt_pk_bf16_f32 v201,v226,v227
 v_cvt_pk_bf16_f32 v202,v228,v229
 v_cvt_pk_bf16_f32 v203,v230,v231
 v_mfma_f32_16x16x32_bf16 v[252:255],v[40:43],v[124:127],v[252:255]
 s_mov_b32 s46,0
 buffer_store_dwordx4 v[200:203],v56,s[16:19],s46 offen sc1
 v_exp_f32 v192,v232
 v_exp_f32 v193,v233
 v_mfma_f32_16x16x32_bf16 v[144:147],v[36:39],v[88:91],0
 v_exp_f32 v194,v234
 v_exp_f32 v195,v235
 v_exp_f32 v196,v236
 v_mfma_f32_16x16x32_bf16 v[144:147],v[36:39],v[104:107],v[144:147]
 v_exp_f32 v197,v237
 v_exp_f32 v198,v238
 v_exp_f32 v199,v239
 v_mfma_f32_16x16x32_bf16 v[148:151],v[40:43],v[88:91],0
 v_fma_f32 v192,v192,s48,s48
 v_fma_f32 v193,v193,s48,s48
 v_fma_f32 v194,v194,s48,s48
 v_fma_f32 v195,v195,s48,s48
 v_fma_f32 v196,v196,s48,s48
 v_fma_f32 v197,v197,s48,s48
 v_mfma_f32_16x16x32_bf16 v[148:151],v[40:43],v[104:107],v[148:151]
 v_fma_f32 v198,v198,s48,s48
 v_fma_f32 v199,v199,s48,s48
 v_rcp_f32 v192,v192
 v_rcp_f32 v193,v193
 v_mfma_f32_16x16x32_bf16 v[176:179],v[36:39],v[72:75],0
 v_rcp_f32 v194,v194
 v_rcp_f32 v195,v195
 v_rcp_f32 v196,v196
 v_mfma_f32_16x16x32_bf16 v[180:183],v[40:43],v[72:75],0
 v_rcp_f32 v197,v197
 v_rcp_f32 v198,v198
 v_rcp_f32 v199,v199
 v_mfma_f32_16x16x32_bf16 v[152:155],v[36:39],v[92:95],0
 v_mul_f32 v232,v192,v232
 v_mul_f32 v233,v193,v233
 v_mul_f32 v234,v194,v234
 v_mul_f32 v235,v195,v235
 v_mul_f32 v236,v196,v236
 v_mul_f32 v237,v197,v237
 v_mfma_f32_16x16x32_bf16 v[152:155],v[36:39],v[108:111],v[152:155]
 v_mul_f32 v238,v198,v238
 v_mul_f32 v239,v199,v239
 v_fma_f32 v232,v136,v232,v168
 v_fma_f32 v233,v137,v233,v169
 v_fma_f32 v234,v138,v234,v170
 v_fma_f32 v235,v139,v235,v171
 v_mfma_f32_16x16x32_bf16 v[156:159],v[40:43],v[92:95],0
 v_fma_f32 v236,v140,v236,v172
 v_fma_f32 v237,v141,v237,v173
 v_fma_f32 v238,v142,v238,v174
 v_fma_f32 v239,v143,v239,v175
 v_cvt_pk_bf16_f32 v204,v232,v233
 v_cvt_pk_bf16_f32 v205,v234,v235
 v_mfma_f32_16x16x32_bf16 v[156:159],v[40:43],v[108:111],v[156:159]
 v_cvt_pk_bf16_f32 v206,v236,v237
 v_cvt_pk_bf16_f32 v207,v238,v239
 s_mov_b32 s46,32768
 v_mfma_f32_16x16x32_bf16 v[184:187],v[36:39],v[76:79],0
 buffer_store_dwordx4 v[204:207],v56,s[16:19],s46 offen sc1
 v_exp_f32 v192,v240
 v_exp_f32 v193,v241
 v_mfma_f32_16x16x32_bf16 v[188:191],v[40:43],v[76:79],0
 v_exp_f32 v194,v242
 v_exp_f32 v195,v243
 v_exp_f32 v196,v244
 v_exp_f32 v197,v245
 v_exp_f32 v198,v246
 v_exp_f32 v199,v247
 v_fma_f32 v192,v192,s48,s48
 v_fma_f32 v193,v193,s48,s48
 v_fma_f32 v194,v194,s48,s48
 v_fma_f32 v195,v195,s48,s48
 v_fma_f32 v196,v196,s48,s48
 v_fma_f32 v197,v197,s48,s48
 v_fma_f32 v198,v198,s48,s48
 v_fma_f32 v199,v199,s48,s48
 v_rcp_f32 v192,v192
 v_rcp_f32 v193,v193
 v_rcp_f32 v194,v194
 v_rcp_f32 v195,v195
 v_rcp_f32 v196,v196
 v_rcp_f32 v197,v197
 v_rcp_f32 v198,v198
 v_rcp_f32 v199,v199
 v_mul_f32 v240,v192,v240
 v_mul_f32 v241,v193,v241
 v_mul_f32 v242,v194,v242
 v_mul_f32 v243,v195,v243
 v_mul_f32 v244,v196,v244
 v_mul_f32 v245,v197,v245
 v_mul_f32 v246,v198,v246
 v_mul_f32 v247,v199,v247
 v_fma_f32 v240,v144,v240,v176
 v_fma_f32 v241,v145,v241,v177
 v_fma_f32 v242,v146,v242,v178
 v_fma_f32 v243,v147,v243,v179
 v_fma_f32 v244,v148,v244,v180
 v_fma_f32 v245,v149,v245,v181
 v_fma_f32 v246,v150,v246,v182
 v_fma_f32 v247,v151,v247,v183
 v_cvt_pk_bf16_f32 v208,v240,v241
 v_cvt_pk_bf16_f32 v209,v242,v243
 v_cvt_pk_bf16_f32 v210,v244,v245
 v_cvt_pk_bf16_f32 v211,v246,v247
 s_mov_b32 s46,65536
 buffer_store_dwordx4 v[208:211],v56,s[16:19],s46 offen sc1
 v_exp_f32 v192,v248
 v_exp_f32 v193,v249
 v_exp_f32 v194,v250
 v_exp_f32 v195,v251
 v_exp_f32 v196,v252
 v_exp_f32 v197,v253
 v_exp_f32 v198,v254
 v_exp_f32 v199,v255
 v_fma_f32 v192,v192,s48,s48
 v_fma_f32 v193,v193,s48,s48
 v_fma_f32 v194,v194,s48,s48
 v_fma_f32 v195,v195,s48,s48
 v_fma_f32 v196,v196,s48,s48
 v_fma_f32 v197,v197,s48,s48
 v_fma_f32 v198,v198,s48,s48
 v_fma_f32 v199,v199,s48,s48
 v_rcp_f32 v192,v192
 v_rcp_f32 v193,v193
 v_rcp_f32 v194,v194
 v_rcp_f32 v195,v195
 v_rcp_f32 v196,v196
 v_rcp_f32 v197,v197
 v_rcp_f32 v198,v198
 v_rcp_f32 v199,v199
 v_mul_f32 v248,v192,v248
 v_mul_f32 v249,v193,v249
 v_mul_f32 v250,v194,v250
 v_mul_f32 v251,v195,v251
 v_mul_f32 v252,v196,v252
 v_mul_f32 v253,v197,v253
 v_mul_f32 v254,v198,v254
 v_mul_f32 v255,v199,v255
 v_fma_f32 v248,v152,v248,v184
 v_fma_f32 v249,v153,v249,v185
 v_fma_f32 v250,v154,v250,v186
 v_fma_f32 v251,v155,v251,v187
 v_fma_f32 v252,v156,v252,v188
 v_fma_f32 v253,v157,v253,v189
 v_fma_f32 v254,v158,v254,v190
 v_fma_f32 v255,v159,v255,v191
 v_cvt_pk_bf16_f32 v212,v248,v249
 v_cvt_pk_bf16_f32 v213,v250,v251
 v_cvt_pk_bf16_f32 v214,v252,v253
 v_cvt_pk_bf16_f32 v215,v254,v255
 s_mov_b32 s46,98304
 buffer_store_dwordx4 v[212:215],v56,s[16:19],s46 offen sc1
L_done:
 s_waitcnt vmcnt(0) lgkmcnt(0)
L_end:
 s_endpgm
L_m_late:
 s_sub_u32 s101,s101,1
 s_cbranch_scc1 L_m_ok
 v_cmp_eq_u32 vcc,-1,v4
 s_nop 1
 s_cmp_lg_u64 vcc,0
 s_cbranch_scc0 L_m_has0
 s_add_u32 s47,s15,0
 buffer_load_dwordx4 v[80:83],v1,s[20:23],s47 offen sc1
 s_add_u32 s47,s15,32768
 buffer_load_dwordx4 v[84:87],v1,s[20:23],s47 offen sc1
 s_add_u32 s47,s15,65536
 buffer_load_dwordx4 v[88:91],v1,s[20:23],s47 offen sc1
 s_add_u32 s47,s15,98304
 buffer_load_dwordx4 v[92:95],v1,s[20:23],s47 offen sc1
L_m_has0:
 v_cmp_eq_u32 vcc,-1,v5
 s_nop 1
 s_cmp_lg_u64 vcc,0
 s_cbranch_scc0 L_m_has1
 s_add_u32 s47,s15,131072
 buffer_load_dwordx4 v[96:99],v1,s[20:23],s47 offen sc1
 s_add_u32 s47,s15,163840
 buffer_load_dwordx4 v[100:103],v1,s[20:23],s47 offen sc1
 s_add_u32 s47,s15,196608
 buffer_load_dwordx4 v[104:107],v1,s[20:23],s47 offen sc1
 s_add_u32 s47,s15,229376
 buffer_load_dwordx4 v[108:111],v1,s[20:23],s47 offen sc1
L_m_has1:
 v_cmp_eq_u32 vcc,-1,v6
 s_nop 1
 s_cmp_lg_u64 vcc,0
 s_cbranch_scc0 L_m_has2
 s_add_u32 s47,s15,262144
 buffer_load_dwordx4 v[112:115],v1,s[20:23],s47 offen sc1
 s_add_u32 s47,s15,294912
 buffer_load_dwordx4 v[116:119],v1,s[20:23],s47 offen sc1
 s_add_u32 s47,s15,327680
 buffer_load_dwordx4 v[120:123],v1,s[20:23],s47 offen sc1
 s_add_u32 s47,s15,360448
 buffer_load_dwordx4 v[124:127],v1,s[20:23],s47 offen sc1
L_m_has2:
 s_branch L_m_check
L_ina_late:
 s_sub_u32 s101,s101,1
 s_cbranch_scc1 L_ina_ok
 s_add_u32 s19,s17,0
 buffer_load_dwordx4 v[64:67],v1,s[20:23],s19 offen offset:0 sc1
 buffer_load_dwordx4 v[68:71],v1,s[20:23],s19 offen offset:1024 sc1
 buffer_load_dwordx4 v[72:75],v1,s[20:23],s19 offen offset:2048 sc1
 buffer_load_dwordx4 v[76:79],v1,s[20:23],s19 offen offset:3072 sc1
 s_waitcnt vmcnt(0)
 s_branch L_ina_check
L_inb_late:
 s_sub_u32 s101,s101,1
 s_cbranch_scc1 L_inb_ok
 s_add_u32 s19,s17,4096
 buffer_load_dwordx4 v[80:83],v1,s[20:23],s19 offen offset:0 sc1
 buffer_load_dwordx4 v[84:87],v1,s[20:23],s19 offen offset:1024 sc1
 buffer_load_dwordx4 v[88:91],v1,s[20:23],s19 offen offset:2048 sc1
 buffer_load_dwordx4 v[92:95],v1,s[20:23],s19 offen offset:3072 sc1
 s_waitcnt vmcnt(0)
 s_branch L_inb_check
L_spin_p:
 s_mov_b32 s101,524288
L_poll_p:
 buffer_load_dword v53,v52,s[68:71],s16 offen sc1
 s_waitcnt vmcnt(0)
 v_readfirstlane_b32 s48,v53
 s_sub_u32 s101,s101,1
 s_cbranch_scc1 L_spin_p_ret
 s_cmp_eq_u32 s48,0
 s_cbranch_scc1 L_poll_p
 s_branch L_spin_p_ret
L_spin_r:
 s_mov_b32 s101,524288
L_poll_r:
 buffer_load_dword v63,v62,s[4:7],s51 offen sc1
 buffer_load_dword v30,v31,s[4:7],s50 offen sc1
 s_waitcnt vmcnt(0)
 v_readfirstlane_b32 s100,v63
 v_cmp_gt_u32 vcc,4,v30
 s_nop 1
 s_cmp_lg_u64 vcc,0
 s_cselect_b32 s100,0,s100
 s_sub_u32 s101,s101,1
 s_cbranch_scc1 L_spin_r_ret
 s_cmp_eq_u32 s100,0
 s_cbranch_scc1 L_poll_r
 s_branch L_spin_r_ret
L_u_late:
L_stub_m_6:
 s_cbranch_execz L_warm_m_ret
 s_waitcnt vmcnt(10)
 v_cmp_eq_u32 vcc,0,v53
 s_nop 1
 s_cmp_lg_u64 vcc,0
 s_cbranch_scc0 L_u_go
 s_waitcnt vmcnt(0)
 buffer_store_dword v55,v52,s[68:71],s77 offen sc1
 v_mov_b32 v62,v54
 v_mov_b32 v54,v63
 s_mov_b32 s101,524288
L_poll_u:
 buffer_load_dword v53,v54,s[68:71],s76 offen sc1
 s_sub_u32 s101,s101,1
 s_cbranch_scc1 L_poll_u_out
 s_waitcnt vmcnt(0)
 v_cmp_gt_u32 vcc,1,v53
 s_nop 1
 s_cmp_lg_u64 vcc,0
 s_cbranch_scc1 L_poll_u
L_poll_u_out:
 v_mov_b32 v54,v62
L_u_go:
 s_mov_b32 s62,454656
 s_mov_b32 s40,0
 buffer_load_dwordx4 a[0:3],v1,s[60:63],s40 offen offset:0 sc1
 buffer_load_dwordx4 a[4:7],v1,s[60:63],s40 offen offset:1024 sc1
 buffer_load_dwordx4 a[16:19],v1,s[60:63],s40 offen offset:2048 sc1
 buffer_load_dwordx4 a[20:23],v1,s[60:63],s40 offen offset:3072 sc1
 buffer_load_dword v57,v52,s[68:71],0 offen
 s_mov_b32 s59,229376
 buffer_load_dwordx4 a[8:11],v1,s[60:63],s59 offen offset:0 sc1
 buffer_load_dwordx4 a[12:15],v1,s[60:63],s59 offen offset:1024 sc1
 buffer_load_dwordx4 a[24:27],v1,s[60:63],s59 offen offset:2048 sc1
 buffer_load_dwordx4 a[28:31],v1,s[60:63],s59 offen offset:3072 sc1
 buffer_load_dword v57,v52,s[68:71],0 offen
 buffer_load_dword v57,v52,s[68:71],0 offen
 s_mov_b32 s40,8192
 buffer_load_dwordx4 a[32:35],v1,s[60:63],s40 offen offset:0 sc1
 buffer_load_dwordx4 a[36:39],v1,s[60:63],s40 offen offset:1024 sc1
 buffer_load_dwordx4 a[48:51],v1,s[60:63],s40 offen offset:2048 sc1
 buffer_load_dwordx4 a[52:55],v1,s[60:63],s40 offen offset:3072 sc1
 buffer_load_dword v57,v52,s[68:71],0 offen
 s_mov_b32 s59,237568
 buffer_load_dwordx4 a[40:43],v1,s[60:63],s59 offen offset:0 sc1
 buffer_load_dwordx4 a[44:47],v1,s[60:63],s59 offen offset:1024 sc1
 buffer_load_dwordx4 a[56:59],v1,s[60:63],s59 offen offset:2048 sc1
 buffer_load_dwordx4 a[60:63],v1,s[60:63],s59 offen offset:3072 sc1
 buffer_load_dword v57,v52,s[68:71],0 offen
 s_branch L_u_late_ret
L_poll_more:
 s_mov_b32 s101,524288
L_poll_u2:
 buffer_load_dword v53,v54,s[68:71],s76 offen sc1
 s_sub_u32 s101,s101,1
 s_cbranch_scc1 L_hook_mlp2_ret
 s_waitcnt vmcnt(0)
 v_cmp_eq_u32 vcc,0,v53
 s_nop 1
 s_or_b32 s49,vcc_lo,vcc_hi
 s_and_b32 s49,s48,s49
 s_cbranch_scc1 L_poll_u2
 s_branch L_hook_mlp2_ret
L_spin_o:
 s_mov_b32 s101,524288
L_poll_o:
 buffer_load_dword v53,v54,s[68:71],s76 offen sc1
 s_sub_u32 s101,s101,1
 s_cbranch_scc1 L_poll_o_out
 s_waitcnt vmcnt(0)
 v_cmp_gt_u32 vcc,1,v53
 s_nop 1
 s_cmp_lg_u64 vcc,0
 s_cbranch_scc1 L_poll_o
L_poll_o_out:
 s_branch L_spin_o_ret
L_spin_h:
 s_mov_b32 s101,524288
L_poll_h:
 buffer_load_dword v53,v54,s[72:75],0 offen sc1
 s_sub_u32 s101,s101,1
 s_cbranch_scc1 L_poll_h_out
 s_waitcnt vmcnt(0)
 v_cmp_gt_u32 vcc,4,v53
 s_nop 1
 s_cmp_lg_u64 vcc,0
 s_cbranch_scc1 L_poll_h
L_poll_h_out:
 s_branch L_spin_h_ret
L_fallback:
 s_mov_b32 s45,1
 s_waitcnt vmcnt(0) lgkmcnt(0)
 s_barrier
 s_nop 7
 s_branch L_restart
L_fb_hook:
 v_lshlrev_b32 v63,4,v0
 s_lshl_b32 s48,s2,12
 s_add_u32 s48,s48,46137344
 s_add_u32 s8,s30,s48
 s_addc_u32 s9,s31,0
 s_mov_b32 s10,4096
 s_mov_b32 s11,0x20000
 s_cmp_eq_u32 s45,1
 s_cbranch_scc1 L_fb_scan
 buffer_load_dwordx4 v[248:251],v63,s[8:11],0 offen sc1
 s_waitcnt vmcnt(0)
 v_mov_b32 v44,v248
 v_mov_b32 v48,v249
 v_mov_b32 v52,v250
 v_mov_b32 v56,v251
 s_add_u32 s8,s30,75497472
 s_addc_u32 s9,s31,0
 s_mov_b32 s10,20971520
 s_mov_b32 s11,0x20000
 s_mov_b32 s48,0
 s_branch L_fb_ret
L_fb_scan:
 s_mov_b32 s42,0
 s_mov_b32 s44,32
L_fb_loop:
 s_waitcnt vmcnt(0) lgkmcnt(0)
 s_barrier
 s_add_u32 m0,s3,0
 s_nop 0
 buffer_load_dwordx4 v24,s[12:15],s42 offen offset:0 lds
 buffer_load_dwordx4 v25,s[12:15],s42 offen offset:1024 lds
 buffer_load_dwordx4 v26,s[12:15],s42 offen offset:2048 lds
 buffer_load_dwordx4 v27,s[12:15],s42 offen offset:3072 lds
 s_add_u32 s42,s42,0x4000
 s_waitcnt vmcnt(0)
 s_barrier
 ds_read_b128 a[128:131],v4 offset:0
 ds_read_b128 a[132:135],v5 offset:0
 ds_read_b128 a[136:139],v6 offset:0
 ds_read_b128 a[140:143],v7 offset:0
 ds_read_b128 a[144:147],v4 offset:4096
 ds_read_b128 a[148:151],v5 offset:4096
 ds_read_b128 a[152:155],v6 offset:4096
 ds_read_b128 a[156:159],v7 offset:4096
 s_waitcnt lgkmcnt(0)
 ds_read_b128 a[160:163],v4 offset:8192
 ds_read_b128 a[164:167],v5 offset:8192
 ds_read_b128 a[168:171],v6 offset:8192
 ds_read_b128 a[172:175],v7 offset:8192
 ds_read_b128 a[176:179],v4 offset:12288
 ds_read_b128 a[180:183],v5 offset:12288
 ds_read_b128 a[184:187],v6 offset:12288
 ds_read_b128 a[188:191],v7 offset:12288
 s_waitcnt lgkmcnt(0)
 v_mfma_f32_16x16x32_bf16 v[128:131],a[128:131],v[64:67],0
 v_mfma_f32_16x16x32_bf16 v[128:131],a[132:135],v[68:71],v[128:131]
 v_mfma_f32_16x16x32_bf16 v[128:131],a[136:139],v[72:75],v[128:131]
 v_mfma_f32_16x16x32_bf16 v[128:131],a[140:143],v[76:79],v[128:131]
 v_mfma_f32_16x16x32_bf16 v[132:135],a[140:143],v[92:95],0
 v_mfma_f32_16x16x32_bf16 v[132:135],a[136:139],v[88:91],v[132:135]
 v_mfma_f32_16x16x32_bf16 v[132:135],a[132:135],v[84:87],v[132:135]
 v_mfma_f32_16x16x32_bf16 v[132:135],a[128:131],v[80:83],v[132:135]
 v_mfma_f32_16x16x32_bf16 v[136:139],a[128:131],v[96:99],0
 v_mfma_f32_16x16x32_bf16 v[136:139],a[132:135],v[100:103],v[136:139]
 v_mfma_f32_16x16x32_bf16 v[136:139],a[136:139],v[104:107],v[136:139]
 v_mfma_f32_16x16x32_bf16 v[136:139],a[140:143],v[108:111],v[136:139]
 v_mfma_f32_16x16x32_bf16 v[140:143],a[140:143],v[124:127],0
 v_mfma_f32_16x16x32_bf16 v[140:143],a[136:139],v[120:123],v[140:143]
 v_mfma_f32_16x16x32_bf16 v[140:143],a[132:135],v[116:119],v[140:143]
 v_mfma_f32_16x16x32_bf16 v[140:143],a[128:131],v[112:115],v[140:143]
 v_mfma_f32_16x16x32_bf16 v[156:159],a[144:147],v[112:115],0
 v_mfma_f32_16x16x32_bf16 v[156:159],a[148:151],v[116:119],v[156:159]
 v_mfma_f32_16x16x32_bf16 v[156:159],a[152:155],v[120:123],v[156:159]
 v_mfma_f32_16x16x32_bf16 v[156:159],a[156:159],v[124:127],v[156:159]
 v_mfma_f32_16x16x32_bf16 v[152:155],a[156:159],v[108:111],0
 v_mfma_f32_16x16x32_bf16 v[152:155],a[152:155],v[104:107],v[152:155]
 v_mfma_f32_16x16x32_bf16 v[152:155],a[148:151],v[100:103],v[152:155]
 v_mfma_f32_16x16x32_bf16 v[152:155],a[144:147],v[96:99],v[152:155]
 v_mfma_f32_16x16x32_bf16 v[148:151],a[144:147],v[80:83],0
 v_mfma_f32_16x16x32_bf16 v[148:151],a[148:151],v[84:87],v[148:151]
 v_mfma_f32_16x16x32_bf16 v[148:151],a[152:155],v[88:91],v[148:151]
 v_mfma_f32_16x16x32_bf16 v[148:151],a[156:159],v[92:95],v[148:151]
 v_mfma_f32_16x16x32_bf16 v[144:147],a[156:159],v[76:79],0
 v_mfma_f32_16x16x32_bf16 v[144:147],a[152:155],v[72:75],v[144:147]
 v_mfma_f32_16x16x32_bf16 v[144:147],a[148:151],v[68:71],v[144:147]
 v_mfma_f32_16x16x32_bf16 v[144:147],a[144:147],v[64:67],v[144:147]
 v_mfma_f32_16x16x32_bf16 v[160:163],a[160:163],v[64:67],0
 v_mfma_f32_16x16x32_bf16 v[160:163],a[164:167],v[68:71],v[160:163]
 v_mfma_f32_16x16x32_bf16 v[160:163],a[168:171],v[72:75],v[160:163]
 v_mfma_f32_16x16x32_bf16 v[160:163],a[172:175],v[76:79],v[160:163]
 v_mfma_f32_16x16x32_bf16 v[164:167],a[172:175],v[92:95],0
 v_mfma_f32_16x16x32_bf16 v[164:167],a[168:171],v[88:91],v[164:167]
 v_mfma_f32_16x16x32_bf16 v[164:167],a[164:167],v[84:87],v[164:167]
 v_mfma_f32_16x16x32_bf16 v[164:167],a[160:163],v[80:83],v[164:167]
 v_mfma_f32_16x16x32_bf16 v[168:171],a[160:163],v[96:99],0
 v_mfma_f32_16x16x32_bf16 v[168:171],a[164:167],v[100:103],v[168:171]
 v_mfma_f32_16x16x32_bf16 v[168:171],a[168:171],v[104:107],v[168:171]
 v_mfma_f32_16x16x32_bf16 v[168:171],a[172:175],v[108:111],v[168:171]
 v_mfma_f32_16x16x32_bf16 v[172:175],a[172:175],v[124:127],0
 v_mfma_f32_16x16x32_bf16 v[172:175],a[168:171],v[120:123],v[172:175]
 v_mfma_f32_16x16x32_bf16 v[172:175],a[164:167],v[116:119],v[172:175]
 v_mfma_f32_16x16x32_bf16 v[172:175],a[160:163],v[112:115],v[172:175]
 v_mfma_f32_16x16x32_bf16 v[188:191],a[176:179],v[112:115],0
 v_mfma_f32_16x16x32_bf16 v[188:191],a[180:183],v[116:119],v[188:191]
 v_mfma_f32_16x16x32_bf16 v[188:191],a[184:187],v[120:123],v[188:191]
 v_mfma_f32_16x16x32_bf16 v[188:191],a[188:191],v[124:127],v[188:191]
 v_mfma_f32_16x16x32_bf16 v[184:187],a[188:191],v[108:111],0
 v_mfma_f32_16x16x32_bf16 v[184:187],a[184:187],v[104:107],v[184:187]
 v_mfma_f32_16x16x32_bf16 v[184:187],a[180:183],v[100:103],v[184:187]
 v_mfma_f32_16x16x32_bf16 v[184:187],a[176:179],v[96:99],v[184:187]
 v_mfma_f32_16x16x32_bf16 v[180:183],a[176:179],v[80:83],0
 v_mfma_f32_16x16x32_bf16 v[180:183],a[180:183],v[84:87],v[180:183]
 v_mfma_f32_16x16x32_bf16 v[180:183],a[184:187],v[88:91],v[180:183]
 v_mfma_f32_16x16x32_bf16 v[180:183],a[188:191],v[92:95],v[180:183]
 v_mfma_f32_16x16x32_bf16 v[176:179],a[188:191],v[76:79],0
 v_mfma_f32_16x16x32_bf16 v[176:179],a[184:187],v[72:75],v[176:179]
 v_mfma_f32_16x16x32_bf16 v[176:179],a[180:183],v[68:71],v[176:179]
 v_mfma_f32_16x16x32_bf16 v[176:179],a[176:179],v[64:67],v[176:179]
 s_nop 7
 v_max3_f32 v44,v128,v129,v44
 v_max3_f32 v44,v130,v131,v44
 v_max3_f32 v44,v144,v145,v44
 v_max3_f32 v44,v146,v147,v44
 v_max3_f32 v48,v132,v133,v48
 v_max3_f32 v48,v134,v135,v48
 v_max3_f32 v48,v148,v149,v48
 v_max3_f32 v48,v150,v151,v48
 v_max3_f32 v52,v136,v137,v52
 v_max3_f32 v52,v138,v139,v52
 v_max3_f32 v52,v152,v153,v52
 v_max3_f32 v52,v154,v155,v52
 v_max3_f32 v56,v140,v141,v56
 v_max3_f32 v56,v142,v143,v56
 v_max3_f32 v56,v156,v157,v56
 v_max3_f32 v56,v158,v159,v56
 v_max3_f32 v44,v160,v161,v44
 v_max3_f32 v44,v162,v163,v44
 v_max3_f32 v44,v176,v177,v44
 v_max3_f32 v44,v178,v179,v44
 v_max3_f32 v48,v164,v165,v48
 v_max3_f32 v48,v166,v167,v48
 v_max3_f32 v48,v180,v181,v48
 v_max3_f32 v48,v182,v183,v48
 v_max3_f32 v52,v168,v169,v52
 v_max3_f32 v52,v170,v171,v52
 v_max3_f32 v52,v184,v185,v52
 v_max3_f32 v52,v186,v187,v52
 v_max3_f32 v56,v172,v173,v56
 v_max3_f32 v56,v174,v175,v56
 v_max3_f32 v56,v188,v189,v56
 v_max3_f32 v56,v190,v191,v56
 s_sub_u32 s44,s44,1
 s_cmp_lg_u32 s44,0
 s_cbranch_scc1 L_fb_loop
 v_mov_b32 v45,v44
 v_mov_b32 v49,v48
 v_mov_b32 v53,v52
 v_mov_b32 v57,v56
 v_permlane16_swap_b32 v44,v45
 v_permlane16_swap_b32 v48,v49
 v_permlane16_swap_b32 v52,v53
 v_permlane16_swap_b32 v56,v57
 v_max_f32 v44,v44,v45
 v_max_f32 v48,v48,v49
 v_max_f32 v52,v52,v53
 v_max_f32 v56,v56,v57
 v_mov_b32 v45,v44
 v_mov_b32 v49,v48
 v_mov_b32 v53,v52
 v_mov_b32 v57,v56
 v_permlane32_swap_b32 v44,v45
 v_permlane32_swap_b32 v48,v49
 v_permlane32_swap_b32 v52,v53
 v_permlane32_swap_b32 v56,v57
 v_max_f32 v44,v44,v45
 v_max_f32 v48,v48,v49
 v_max_f32 v52,v52,v53
 v_max_f32 v56,v56,v57
 v_mov_b32 v248,v44
 v_mov_b32 v249,v48
 v_mov_b32 v250,v52
 v_mov_b32 v251,v56
 buffer_store_dwordx4 v[248:251],v63,s[8:11],0 offen sc1
 s_mov_b32 s45,3
 s_waitcnt vmcnt(0)
 s_barrier
 s_branch L_restart
L_code_end:
.section .rodata,"a"
.p2align 6
.amdhsa_kernel recurrent_scan__mha_block_cached__mixer_token_mlp__prompt_kernel
  .amdhsa_next_free_vgpr 512
  .amdhsa_next_free_sgpr 102
  .amdhsa_accum_offset 256
  .amdhsa_group_segment_fixed_size 0
  .amdhsa_float_denorm_mode_32 3
  .amdhsa_kernarg_size 104
  .amdhsa_user_sgpr_count 2
  .amdhsa_user_sgpr_kernarg_segment_ptr 1
  .amdhsa_system_sgpr_workgroup_id_x 1
.end_amdhsa_kernel
```
